```python
import torch

def _softmax(x, axis=-1):
    return torch.softmax(x, dim=axis)
def _gelu(x):
    return torch.nn.functional.gelu(x, approximate="tanh")
def _silu(x):
    return torch.nn.functional.silu(x)
def _sigmoid(x):
    return torch.sigmoid(x)
def _layernorm(x, axis=-1, eps=1e-5):
    m = x.mean(dim=axis, keepdim=True)
    v = x.var(dim=axis, keepdim=True, unbiased=False)
    return (x - m) / torch.sqrt(v + eps)
def _scatter_add(tgt, idx, src, axis=0):
    return tgt.clone().index_add_(axis, idx, src)
def _segment_sum(src, seg, n):
    out = torch.zeros((n,) + src.shape[1:], dtype=src.dtype)
    return out.index_add_(0, seg, src)
def _pad(x, pw):
    flat = tuple(v for pair in reversed(pw) for v in pair)
    return torch.nn.functional.pad(x, flat)

kernel_name = 'gated_mix__spectral_gfnet__ssm_conv_s5__prompt'

def setup_inputs():

    _w = (lambda a: (lambda t: t.to(torch.bfloat16) if t.is_floating_point() else t)(torch.as_tensor(a)))
    def _A_setup():
        B, S, D = 1, 2048, 1024
        Df = D // 2 + 1
        return {
            "x": _w((lambda *s: torch.randn(*s, dtype=torch.bfloat16) * 0.05)(B, S, D)),
            "w_r": _w((lambda *s: torch.randn(*s, dtype=torch.bfloat16) * 0.8)(S, Df) * 0.02),
            "w_i": _w((lambda *s: torch.randn(*s, dtype=torch.bfloat16) * 0.8)(S, Df) * 0.02),
        }
    _A_in = _A_setup()

    def _B_setup():
        B, S, D = 1, 2048, 1024
        P = D
        Lambda_re = -0.5 * (lambda _x: torch.exp(torch.as_tensor(_x)))((lambda *s: torch.randn(*s, dtype=torch.bfloat16) * 0.2)(P))
        Lambda_im = (lambda *s: torch.randn(*s, dtype=torch.bfloat16) * 0.4)(P) * 1.0
        B_re = (lambda *s: torch.randn(*s, dtype=torch.bfloat16) * 0.2)(P, D) * (D ** -0.5)
        B_im = (lambda *s: torch.randn(*s, dtype=torch.bfloat16) * 0.2)(P, D) * (D ** -0.5)
        C_re = (lambda *s: torch.randn(*s, dtype=torch.bfloat16) * 0.2)(D, P) * (P ** -0.5)
        C_im = (lambda *s: torch.randn(*s, dtype=torch.bfloat16) * 0.2)(D, P) * (P ** -0.5)
        log_dt = (lambda *s: torch.randn(*s, dtype=torch.bfloat16) * 0.2)(P) * 0.3 - 2.0
        Dskip = (lambda *s: torch.randn(*s, dtype=torch.bfloat16) * 0.05)(D)
        return {
            "x": _w((lambda *s: torch.randn(*s, dtype=torch.bfloat16) * 0.05)(B, S, D)),
            "Lambda_re": _w(Lambda_re),
            "Lambda_im": _w(Lambda_im),
            "B_re": _w(B_re),
            "B_im": _w(B_im),
            "C_re": _w(C_re),
            "C_im": _w(C_im),
            "log_dt": _w(log_dt),
            "Dskip": _w(Dskip),
        }
    _B_in = _B_setup()

    return {
        "A_x": _A_in["x"],
        "A_w_r": _A_in["w_r"],
        "A_w_i": _A_in["w_i"],
        "B_x": _B_in["x"],
        "B_Lambda_re": _B_in["Lambda_re"],
        "B_Lambda_im": _B_in["Lambda_im"],
        "B_B_re": _B_in["B_re"],
        "B_B_im": _B_in["B_im"],
        "B_C_re": _B_in["C_re"],
        "B_C_im": _B_in["C_im"],
        "B_log_dt": _B_in["log_dt"],
        "B_Dskip": _B_in["Dskip"],
        "gate_w": _w((lambda *s: torch.randn(*s, dtype=torch.bfloat16) * 0.05)(1024) * 16.0),
    }

def reference(A_x, A_w_r, A_w_i, B_x, B_Lambda_re, B_Lambda_im, B_B_re, B_B_im, B_C_re, B_C_im, B_log_dt, B_Dskip, gate_w):
    def _A_ref(x, w_r, w_i):
        B, S, D = x.shape
        X = (lambda x, axes=(-2,-1): torch.fft.rfft2(x.float(), dim=axes))(x, axes=(-2, -1))
        W = w_r + 1j * w_i
        X = X * W
        y = (lambda x, s, axes=(-2,-1): torch.fft.irfft2(x, s=s, dim=axes).to(torch.bfloat16))(X, (S, D), axes=(-2, -1))
        return y

    def _B_ref(x, Lambda_re, Lambda_im, B_re, B_im, C_re, C_im, log_dt, Dskip):
        Bsz, L, H = x.shape
        Lam = Lambda_re + 1j * Lambda_im
        Bmat = B_re + 1j * B_im
        Cmat = C_re + 1j * C_im
        dt = torch.exp(log_dt)
        Lam_bar = torch.exp(dt * Lam)
        B_bar = ((Lam_bar - 1.0) / Lam)[:, None] * Bmat
        Bu = torch.einsum("bld,pd->blp", x + 0j, B_bar)
        h = torch.zeros_like(Bu[:, 0, :])
        hs = []
        for t in range(L):
            h = Lam_bar[None, :] * h + Bu[:, t, :]
            hs.append(h)
        hseq = torch.stack(hs, 1)
        y = 2.0 * torch.einsum("blp,dp->bld", hseq, Cmat).real + x * Dskip[None, None, :]
        return y

    x = A_x
    g = _sigmoid((x * gate_w).sum(-1, keepdims=True))
    a = _A_ref(x, A_w_r, A_w_i)
    b = _B_ref(x, B_Lambda_re, B_Lambda_im, B_B_re, B_B_im, B_C_re, B_C_im, B_log_dt, B_Dskip)
    return g * a + (1 - g) * b
```

```asm
; @launch kernel=k1_kernel grid=(256,1,1) block=(256,1,1) lds=163840
; @launch kernel=k2_kernel grid=(256,1,1) block=(256,1,1) lds=163840
.amdgcn_target "amdgcn-amd-amdhsa--gfx950"
.text
.globl k1_kernel
.p2align 8
.type k1_kernel,@function
k1_kernel:
    s_cmp_ge_u32 s2, 256
    s_cbranch_scc1 K1_END
    s_nop 0
    s_load_dwordx4 s[44:47], s[0:1], 0
    s_load_dwordx2 s[48:49], s[0:1], 16
    s_load_dwordx8 s[52:59], s[0:1], 32
    s_load_dwordx2 s[50:51], s[0:1], 80
    s_load_dwordx2 s[60:61], s[0:1], 120
    v_lshrrev_b32 v3, 6, v0
    v_and_b32 v0, 63, v0
    v_readfirstlane_b32 s34, v3
    v_and_b32 v1, 15, v0
    v_lshrrev_b32 v2, 4, v0
    s_and_b32 s38, s2, 3
    s_lshl_b32 s38, s38, 2
    s_bfe_u32 s39, s2, 0x20003
    s_add_u32 s32, s38, s39
    s_bfe_u32 s38, s2, 0x10002
    s_lshl_b32 s38, s38, 3
    s_lshr_b32 s39, s2, 5
    s_add_u32 s33, s38, s39
    s_getpc_b64 s[28:29]
K1_PC:
    s_mov_b32 s30, K1_CODE_END-K1_PC
    s_mov_b32 s31, 0x00020000
    s_bfe_u32 s38, s2, 0x30003
    s_lshl_b32 s38, s38, 2
    s_add_u32 s38, s38, s34
    s_lshl_b32 s38, s38, 11
    v_lshl_add_u32 v3, v1, 7, s38
    v_cmp_gt_u32 vcc, 16, v0
    s_nop 1
    v_cndmask_b32 v3, 2.0, v3, vcc
    buffer_load_dword v255, v3, s[28:31], 0 offen
    v_lshrrev_b32 v5, 2, v1
    v_lshlrev_b32 v5, 1, v5
    v_and_b32_e64 v6, 1, v1
    v_bfe_u32 v7, v1, 1, 1
    v_lshl_add_u32 v5, v7, 3, v5
    v_add_u32 v4, v5, v6
    v_lshlrev_b32 v5, 9, v2
    v_lshl_add_u32 v5, v4, 2, v5
    s_waitcnt lgkmcnt(0)
    s_add_u32 s40, s60, 28598272
    s_addc_u32 s41, s61, 0
    s_load_dword s62, s[40:41], 0
    s_mov_b32 s8, s44
    s_mov_b32 s9, s45
    s_mov_b32 s10, 4194304
    s_mov_b32 s11, 0x00020000
    s_lshl_b32 s38, s32, 7
    s_and_b32 s39, s34, 1
    s_lshl_b32 s39, s39, 6
    s_add_u32 s38, s38, s39
    s_lshl_b32 s39, s33, 1
    s_add_u32 s38, s38, s39
    s_lshr_b32 s39, s34, 1
    s_add_u32 s38, s38, s39
    s_lshl_b32 s38, s38, 11
    s_nop 0
    s_add_u32 s39, s38, 65536
    buffer_load_dword v184, v5, s[8:11], s38 offen offset:0
    buffer_load_dword v185, v5, s[8:11], s38 offen offset:128
    buffer_load_dword v186, v5, s[8:11], s38 offen offset:256
    buffer_load_dword v187, v5, s[8:11], s38 offen offset:384
    buffer_load_dword v188, v5, s[8:11], s38 offen offset:64
    buffer_load_dword v189, v5, s[8:11], s38 offen offset:192
    buffer_load_dword v190, v5, s[8:11], s38 offen offset:320
    buffer_load_dword v191, v5, s[8:11], s38 offen offset:448
    buffer_load_dword v192, v5, s[8:11], s39 offen offset:0
    buffer_load_dword v193, v5, s[8:11], s39 offen offset:128
    buffer_load_dword v194, v5, s[8:11], s39 offen offset:256
    buffer_load_dword v195, v5, s[8:11], s39 offen offset:384
    buffer_load_dword v196, v5, s[8:11], s39 offen offset:64
    buffer_load_dword v197, v5, s[8:11], s39 offen offset:192
    buffer_load_dword v198, v5, s[8:11], s39 offen offset:320
    buffer_load_dword v199, v5, s[8:11], s39 offen offset:448
    s_cmp_lt_u32 s34, 2
    s_cselect_b32 s12, s56, s58
    s_cselect_b32 s13, s57, s59
    s_mov_b32 s14, 0x200000
    s_mov_b32 s15, 0x00020000
    s_lshl_b32 s37, s34, 12
    s_mov_b32 s36, 0
    v_and_b32 v6, 7, v0
    v_xor_b32 v6, v6, v2
    v_lshlrev_b32 v6, 4, v6
    v_xor_b32 v7, 64, v6
    v_lshrrev_b32 v8, 5, v0
    v_lshlrev_b32_e64 v8, 5, v8
    v_bfe_u32 v9, v0, 3, 1
    v_lshl_add_u32 v8, v9, 4, v8
    v_bfe_u32 v9, v0, 4, 1
    v_add_u32 v8, v8, v9
    s_lshl_b32 s38, s32, 7
    s_lshl_b32 s39, s34, 2
    s_add_u32 s38, s38, s39
    v_add_u32 v8, s38, v8
    v_lshrrev_b32 v9, 3, v0
    s_lshl_b32 s38, s33, 6
    s_and_b32 s39, s34, 1
    s_lshl_b32 s39, s39, 5
    s_add_u32 s38, s38, s39
    v_add_u32 v9, s38, v9
    v_add_u32 v10, 0, v8
    v_lshl_add_u32 v16, v10, 11, v6
    v_add_u32_e64 v10, 0, v9
    v_lshl_add_u32 v20, v10, 11, v6
    v_add_u32_e64 v10, 64, v8
    v_lshl_add_u32 v17, v10, 11, v7
    v_add_u32_e64 v10, 8, v9
    v_lshl_add_u32 v21, v10, 11, v7
    v_add_u32_e64 v10, 2, v8
    v_lshl_add_u32 v18, v10, 11, v6
    v_add_u32_e64 v10, 16, v9
    v_lshl_add_u32 v22, v10, 11, v6
    v_add_u32 v10, 66, v8
    v_lshl_add_u32 v19, v10, 11, v7
    v_add_u32_e64 v10, 24, v9
    v_lshl_add_u32 v23, v10, 11, v7
    s_add_u32 m0, s37, 0
    s_nop 0
    buffer_load_dwordx4 v16, s[8:11], s36 offen lds
    s_add_u32 m0, s37, 1024
    s_nop 0
    buffer_load_dwordx4 v17, s[8:11], s36 offen lds
    s_add_u32 m0, s37, 2048
    s_nop 0
    buffer_load_dwordx4 v18, s[8:11], s36 offen lds
    s_add_u32 m0, s37, 3072
    s_nop 0
    buffer_load_dwordx4 v19, s[8:11], s36 offen lds
    s_add_u32 m0, s37, 16384
    s_nop 0
    buffer_load_dwordx4 v20, s[12:15], s36 offen lds
    s_add_u32 m0, s37, 17408
    s_nop 0
    buffer_load_dwordx4 v21, s[12:15], s36 offen lds
    s_add_u32 m0, s37, 18432
    s_nop 0
    buffer_load_dwordx4 v22, s[12:15], s36 offen lds
    s_add_u32 m0, s37, 19456
    s_nop 0
    buffer_load_dwordx4 v23, s[12:15], s36 offen lds
    s_add_u32 s36, s36, 128
    s_mov_b32 s16, s46
    s_mov_b32 s17, s47
    s_mov_b32 s18, 2101248
    s_mov_b32 s19, 0x00020000
    s_mov_b32 s20, s48
    s_mov_b32 s21, s49
    s_mov_b32 s22, 2101248
    s_mov_b32 s23, 0x00020000
    s_mov_b32 s24, s60
    s_mov_b32 s25, s61
    s_mov_b32 s26, 33554432
    s_mov_b32 s27, 0x00020000
    s_lshr_b32 s38, s2, 6
    s_lshl_b32 s38, s38, 4
    s_and_b32 s39, s2, 3
    s_lshl_b32 s39, s39, 2
    s_add_u32 s38, s38, s39
    s_bfe_u32 s39, s2, 0x40002
    s_lshl_b32 s39, s39, 7
    s_add_u32 s38, s38, s39
    v_and_b32 v6, 3, v0
    v_add_u32 v6, s38, v6
    v_lshrrev_b32 v7, 2, v0
    s_lshl_b32 s39, s34, 4
    v_add_u32 v7, s39, v7
    s_movk_i32 s40, 1026
    v_mul_u32_u24_e64 v8, s40, v6
    v_lshl_add_u32 v9, v7, 3, v8
    v_sub_u32 v10, 2048, v6
    v_and_b32 v11, 2047, v10
    v_subrev_u32 v10, 64, v10
    v_lshlrev_b32 v12, 3, v7
    v_sub_u32 v12, 1018, v12
    v_mad_u32_u24 v11, v11, s40, v12
    v_mad_u32_u24 v10, v10, s40, v12
    s_mov_b32 s41, 65664
    v_add_u32 v8, 512, v8
    v_cmp_eq_u32 vcc, 0, v7
    s_nop 1
    v_cndmask_b32_e64 v8, 2.0, v8, vcc
    buffer_load_dwordx2 v[208:209], v9, s[16:19], 0 offen nt
    buffer_load_dwordx2 v[210:211], v9, s[20:23], 0 offen nt
    buffer_load_dwordx2 v[212:213], v11, s[16:19], 0 offen nt
    buffer_load_dwordx2 v[214:215], v11, s[20:23], 0 offen nt
    buffer_load_ushort v224, v8, s[16:19], 0 offen nt
    buffer_load_ushort v225, v8, s[20:23], 0 offen nt
    buffer_load_dwordx2 v[216:217], v9, s[16:19], s41 offen nt
    buffer_load_dwordx2 v[218:219], v9, s[20:23], s41 offen nt
    buffer_load_dwordx2 v[220:221], v10, s[16:19], 0 offen nt
    buffer_load_dwordx2 v[222:223], v10, s[20:23], 0 offen nt
    buffer_load_ushort v226, v8, s[16:19], s41 offen nt
    buffer_load_ushort v227, v8, s[20:23], s41 offen nt
    v_and_b32 v12, 3, v0
    v_lshlrev_b32 v12, 4, v12
    s_mov_b32 s40, 65536
    v_mad_u32_u24 v13, v7, s40, v12
    v_add_u32 v14, 4194304, v12
    v_cndmask_b32_e64 v14, 2.0, v14, vcc
    s_add_u32 m0, s37, 32768
    s_nop 0
    buffer_load_dwordx4 v16, s[8:11], s36 offen lds
    s_add_u32 m0, s37, 33792
    s_nop 0
    buffer_load_dwordx4 v17, s[8:11], s36 offen lds
    s_add_u32 m0, s37, 34816
    s_nop 0
    buffer_load_dwordx4 v18, s[8:11], s36 offen lds
    s_add_u32 m0, s37, 35840
    s_nop 0
    buffer_load_dwordx4 v19, s[8:11], s36 offen lds
    s_add_u32 m0, s37, 49152
    s_nop 0
    buffer_load_dwordx4 v20, s[12:15], s36 offen lds
    s_add_u32 m0, s37, 50176
    s_nop 0
    buffer_load_dwordx4 v21, s[12:15], s36 offen lds
    s_add_u32 m0, s37, 51200
    s_nop 0
    buffer_load_dwordx4 v22, s[12:15], s36 offen lds
    s_add_u32 m0, s37, 52224
    s_nop 0
    buffer_load_dwordx4 v23, s[12:15], s36 offen lds
    s_add_u32 s36, s36, 128
    s_add_u32 m0, s37, 65536
    s_nop 0
    buffer_load_dwordx4 v16, s[8:11], s36 offen lds
    s_add_u32 m0, s37, 66560
    s_nop 0
    buffer_load_dwordx4 v17, s[8:11], s36 offen lds
    s_add_u32 m0, s37, 67584
    s_nop 0
    buffer_load_dwordx4 v18, s[8:11], s36 offen lds
    s_add_u32 m0, s37, 68608
    s_nop 0
    buffer_load_dwordx4 v19, s[8:11], s36 offen lds
    s_add_u32 m0, s37, 81920
    s_nop 0
    buffer_load_dwordx4 v20, s[12:15], s36 offen lds
    s_add_u32 m0, s37, 82944
    s_nop 0
    buffer_load_dwordx4 v21, s[12:15], s36 offen lds
    s_add_u32 m0, s37, 83968
    s_nop 0
    buffer_load_dwordx4 v22, s[12:15], s36 offen lds
    s_add_u32 m0, s37, 84992
    s_nop 0
    buffer_load_dwordx4 v23, s[12:15], s36 offen lds
    s_add_u32 s36, s36, 128
    s_cmp_eq_u32 s34, 1
    s_cselect_b32 s28, s56, s44
    s_cselect_b32 s29, s57, s45
    s_cmp_eq_u32 s34, 2
    s_cselect_b32 s28, s58, s28
    s_cselect_b32 s29, s59, s29
    s_lshl_b32 s38, s32, 7
    s_and_b32 s39, s33, 7
    s_lshl_b32 s39, s39, 4
    s_add_u32 s38, s38, s39
    s_lshl_b32 s39, s33, 6
    s_and_b32 s40, s32, 3
    s_lshl_b32 s40, s40, 4
    s_add_u32 s39, s39, s40
    s_cmp_eq_u32 s34, 0
    s_cselect_b32 s38, s38, s39
    s_mov_b32 s30, 0x200000
    s_cselect_b32 s30, 0x400000, s30
    s_cmp_eq_u32 s34, 3
    s_cselect_b32 s30, 0, s30
    s_lshl_b32 s38, s38, 11
    v_lshlrev_b32 v6, 11, v1
    v_lshl_add_u32 v6, v2, 7, v6
    buffer_load_dword v255, v6, s[28:31], s38 offen offset:384
    buffer_load_dword v255, v6, s[28:31], s38 offen offset:896
    buffer_load_dword v255, v6, s[28:31], s38 offen offset:1408
    buffer_load_dword v255, v6, s[28:31], s38 offen offset:1536
    s_lshl_b32 s38, s33, 6
    s_lshl_b32 s39, s34, 4
    s_add_u32 s38, s38, s39
    s_nop 0
    v_add_lshl_u32 v6, v1, s38, 1
    global_load_ushort v148, v6, s[52:53]
    global_load_ushort v149, v6, s[54:55]
    global_load_ushort v150, v6, s[50:51]
    v_cvt_f32_u32 v6, v1
    v_cvt_f32_u32 v7, v2
    v_cvt_f32_u32_e64 v8, v4
    v_mul_f32 v9, 0x3d800000, v6
    v_mul_f32 v15, 4.0, v7
    v_mul_f32 v15, v15, v9
    v_fmamk_f32 v12, v9, 0x00000000, v15
    v_cos_f32 v10, v12
    v_sin_f32 v11, v12
    s_nop 0
    s_nop 0
    v_cvt_pk_bf16_f32 v3, v10, v11
    v_cvt_pk_bf16_f32 v5, -v11, v10
    v_accvgpr_write_b32 a32, v3
    v_accvgpr_write_b32 a36, v5
    v_fmamk_f32 v12, v9, 0x3f800000, v15
    v_cos_f32 v10, v12
    v_sin_f32 v11, v12
    s_nop 0
    s_nop 0
    v_cvt_pk_bf16_f32 v3, v10, v11
    v_cvt_pk_bf16_f32 v5, -v11, v10
    v_accvgpr_write_b32 a33, v3
    v_accvgpr_write_b32 a37, v5
    v_fmamk_f32 v12, v9, 0x40000000, v15
    v_cos_f32 v10, v12
    v_sin_f32 v11, v12
    s_nop 0
    s_nop 0
    v_cvt_pk_bf16_f32 v3, v10, v11
    v_cvt_pk_bf16_f32 v5, -v11, v10
    v_accvgpr_write_b32 a34, v3
    v_accvgpr_write_b32 a38, v5
    v_fmamk_f32 v12, v9, 0x40400000, v15
    v_cos_f32 v10, v12
    v_sin_f32 v11, v12
    s_nop 0
    s_nop 0
    v_cvt_pk_bf16_f32 v3, v10, v11
    v_cvt_pk_bf16_f32 v5, -v11, v10
    v_accvgpr_write_b32 a35, v3
    v_accvgpr_write_b32 a39, v5
    v_mul_f32 v9, 0x3b000000, v6
    v_add_f32 v15, v7, v7
    v_mul_f32 v15, v15, v9
    v_fmamk_f32 v12, v9, 0x00000000, v15
    v_cos_f32 v232, v12
    v_sin_f32 v240, v12
    v_fmamk_f32 v12, v9, 0x3f800000, v15
    v_cos_f32 v233, v12
    v_sin_f32 v241, v12
    v_fmamk_f32 v12, v9, 0x41000000, v15
    v_cos_f32 v234, v12
    v_sin_f32 v242, v12
    v_fmamk_f32 v12, v9, 0x41100000, v15
    v_cos_f32 v235, v12
    v_sin_f32 v243, v12
    v_fmamk_f32 v12, v9, 0x41800000, v15
    v_cos_f32 v236, v12
    v_sin_f32 v244, v12
    v_fmamk_f32 v12, v9, 0x41880000, v15
    v_cos_f32 v237, v12
    v_sin_f32 v245, v12
    v_fmamk_f32 v12, v9, 0x41c00000, v15
    v_cos_f32 v238, v12
    v_sin_f32 v246, v12
    v_fmamk_f32 v12, v9, 0x41c80000, v15
    v_cos_f32 v239, v12
    v_sin_f32 v247, v12
    v_mul_f32 v9, 0x3d000000, v8
    v_add_f32 v15, v7, v7
    v_mul_f32 v15, v15, v9
    v_and_b32_e64 v248, 1, v1
    v_mul_u32_u24 v248, 0x8000, v248
    v_lshl_or_b32 v248, v248, 16, v248
    v_fmamk_f32 v12, v9, 0x00000000, v15
    v_cos_f32 v10, v12
    v_sin_f32 v11, v12
    s_nop 0
    v_cvt_pk_bf16_f32 v3, v10, v11
    v_xor_b32 v5, v248, v3
    v_accvgpr_write_b32 a0, v3
    v_accvgpr_write_b32 a8, v5
    v_accvgpr_write_b32 a16, v3
    v_accvgpr_write_b32 a24, v5
    v_cvt_pk_bf16_f32 v3, -v11, v10
    v_xor_b32_e64 v5, v248, v3
    v_accvgpr_write_b32 a4, v3
    v_accvgpr_write_b32 a12, v5
    v_accvgpr_write_b32 a20, v3
    v_accvgpr_write_b32 a28, v5
    v_fmamk_f32 v12, v9, 0x3f800000, v15
    v_cos_f32 v10, v12
    v_sin_f32 v11, v12
    s_nop 0
    v_cvt_pk_bf16_f32 v3, v10, v11
    v_xor_b32 v5, v248, v3
    v_accvgpr_write_b32 a1, v3
    v_accvgpr_write_b32 a9, v5
    v_xor_b32 v3, 0x80008000, v3
    v_xor_b32 v5, 0x80008000, v5
    v_accvgpr_write_b32 a17, v3
    v_accvgpr_write_b32 a25, v5
    v_cvt_pk_bf16_f32 v3, -v11, v10
    v_xor_b32_e64 v5, v248, v3
    v_accvgpr_write_b32 a5, v3
    v_accvgpr_write_b32 a13, v5
    v_xor_b32 v3, 0x80008000, v3
    v_xor_b32 v5, 0x80008000, v5
    v_accvgpr_write_b32 a21, v3
    v_accvgpr_write_b32 a29, v5
    v_fmamk_f32 v12, v9, 0x41000000, v15
    v_cos_f32 v10, v12
    v_sin_f32 v11, v12
    s_nop 0
    v_cvt_pk_bf16_f32 v3, v10, v11
    v_xor_b32 v5, v248, v3
    v_accvgpr_write_b32 a2, v3
    v_accvgpr_write_b32 a10, v5
    v_accvgpr_write_b32 a18, v3
    v_accvgpr_write_b32 a26, v5
    v_cvt_pk_bf16_f32 v3, -v11, v10
    v_xor_b32_e64 v5, v248, v3
    v_accvgpr_write_b32 a6, v3
    v_accvgpr_write_b32 a14, v5
    v_accvgpr_write_b32 a22, v3
    v_accvgpr_write_b32 a30, v5
    v_fmamk_f32 v12, v9, 0x41100000, v15
    v_cos_f32 v10, v12
    v_sin_f32 v11, v12
    s_nop 0
    v_cvt_pk_bf16_f32 v3, v10, v11
    v_xor_b32 v5, v248, v3
    v_accvgpr_write_b32 a3, v3
    v_accvgpr_write_b32 a11, v5
    v_xor_b32 v3, 0x80008000, v3
    v_xor_b32 v5, 0x80008000, v5
    v_accvgpr_write_b32 a19, v3
    v_accvgpr_write_b32 a27, v5
    v_cvt_pk_bf16_f32 v3, -v11, v10
    v_xor_b32_e64 v5, v248, v3
    v_accvgpr_write_b32 a7, v3
    v_accvgpr_write_b32 a15, v5
    v_xor_b32 v3, 0x80008000, v3
    v_xor_b32 v5, 0x80008000, v5
    v_accvgpr_write_b32 a23, v3
    v_accvgpr_write_b32 a31, v5
    s_lshl_b32 s38, s34, 4
    v_add_u32 v9, s38, v1
    v_cvt_f32_u32_e64 v9, v9
    v_mul_f32 v9, 0x3c800000, v9
    v_mul_f32 v15, 4.0, v7
    v_mul_f32 v15, v15, v9
    v_fmamk_f32 v12, v9, 0x00000000, v15
    v_cos_f32 v10, v12
    v_sin_f32 v11, v12
    s_nop 0
    s_nop 0
    v_cvt_pk_bf16_f32 v3, v10, v11
    v_cvt_pk_bf16_f32 v5, -v11, v10
    v_accvgpr_write_b32 a40, v3
    v_accvgpr_write_b32 a44, v5
    v_fmamk_f32 v12, v9, 0x3f800000, v15
    v_cos_f32 v10, v12
    v_sin_f32 v11, v12
    s_nop 0
    s_nop 0
    v_cvt_pk_bf16_f32 v3, v10, v11
    v_cvt_pk_bf16_f32 v5, -v11, v10
    v_accvgpr_write_b32 a41, v3
    v_accvgpr_write_b32 a45, v5
    v_fmamk_f32 v12, v9, 0x40000000, v15
    v_cos_f32 v10, v12
    v_sin_f32 v11, v12
    s_nop 0
    s_nop 0
    v_cvt_pk_bf16_f32 v3, v10, v11
    v_cvt_pk_bf16_f32 v5, -v11, v10
    v_accvgpr_write_b32 a42, v3
    v_accvgpr_write_b32 a46, v5
    v_fmamk_f32 v12, v9, 0x40400000, v15
    v_cos_f32 v10, v12
    v_sin_f32 v11, v12
    s_nop 0
    s_nop 0
    v_cvt_pk_bf16_f32 v3, v10, v11
    v_cvt_pk_bf16_f32 v5, -v11, v10
    v_accvgpr_write_b32 a43, v3
    v_accvgpr_write_b32 a47, v5
    v_fmamk_f32 v12, v9, 0x41800000, v15
    v_cos_f32 v10, v12
    v_sin_f32 v11, v12
    s_nop 0
    s_nop 0
    v_cvt_pk_bf16_f32 v3, v10, v11
    v_cvt_pk_bf16_f32 v5, -v11, v10
    v_accvgpr_write_b32 a48, v3
    v_accvgpr_write_b32 a52, v5
    v_fmamk_f32 v12, v9, 0x41880000, v15
    v_cos_f32 v10, v12
    v_sin_f32 v11, v12
    s_nop 0
    s_nop 0
    v_cvt_pk_bf16_f32 v3, v10, v11
    v_cvt_pk_bf16_f32 v5, -v11, v10
    v_accvgpr_write_b32 a49, v3
    v_accvgpr_write_b32 a53, v5
    v_fmamk_f32 v12, v9, 0x41900000, v15
    v_cos_f32 v10, v12
    v_sin_f32 v11, v12
    s_nop 0
    s_nop 0
    v_cvt_pk_bf16_f32 v3, v10, v11
    v_cvt_pk_bf16_f32 v5, -v11, v10
    v_accvgpr_write_b32 a50, v3
    v_accvgpr_write_b32 a54, v5
    v_fmamk_f32 v12, v9, 0x41980000, v15
    v_cos_f32 v10, v12
    v_sin_f32 v11, v12
    s_nop 0
    s_nop 0
    v_cvt_pk_bf16_f32 v3, v10, v11
    v_cvt_pk_bf16_f32 v5, -v11, v10
    v_accvgpr_write_b32 a51, v3
    v_accvgpr_write_b32 a55, v5
    v_fmamk_f32 v12, v9, 0x42000000, v15
    v_cos_f32 v10, v12
    v_sin_f32 v11, v12
    s_nop 0
    s_nop 0
    v_cvt_pk_bf16_f32 v3, v10, v11
    v_cvt_pk_bf16_f32 v5, -v11, v10
    v_accvgpr_write_b32 a56, v3
    v_accvgpr_write_b32 a60, v5
    v_fmamk_f32 v12, v9, 0x42040000, v15
    v_cos_f32 v10, v12
    v_sin_f32 v11, v12
    s_nop 0
    s_nop 0
    v_cvt_pk_bf16_f32 v3, v10, v11
    v_cvt_pk_bf16_f32 v5, -v11, v10
    v_accvgpr_write_b32 a57, v3
    v_accvgpr_write_b32 a61, v5
    v_fmamk_f32 v12, v9, 0x42080000, v15
    v_cos_f32 v10, v12
    v_sin_f32 v11, v12
    s_nop 0
    s_nop 0
    v_cvt_pk_bf16_f32 v3, v10, v11
    v_cvt_pk_bf16_f32 v5, -v11, v10
    v_accvgpr_write_b32 a58, v3
    v_accvgpr_write_b32 a62, v5
    v_fmamk_f32 v12, v9, 0x420c0000, v15
    v_cos_f32 v10, v12
    v_sin_f32 v11, v12
    s_nop 0
    s_nop 0
    v_cvt_pk_bf16_f32 v3, v10, v11
    v_cvt_pk_bf16_f32 v5, -v11, v10
    v_accvgpr_write_b32 a59, v3
    v_accvgpr_write_b32 a63, v5
    v_fmamk_f32 v12, v9, 0x42400000, v15
    v_cos_f32 v10, v12
    v_sin_f32 v11, v12
    s_nop 0
    s_nop 0
    v_cvt_pk_bf16_f32 v3, v10, v11
    v_cvt_pk_bf16_f32 v5, -v11, v10
    v_accvgpr_write_b32 a64, v3
    v_accvgpr_write_b32 a68, v5
    v_fmamk_f32 v12, v9, 0x42440000, v15
    v_cos_f32 v10, v12
    v_sin_f32 v11, v12
    s_nop 0
    s_nop 0
    v_cvt_pk_bf16_f32 v3, v10, v11
    v_cvt_pk_bf16_f32 v5, -v11, v10
    v_accvgpr_write_b32 a65, v3
    v_accvgpr_write_b32 a69, v5
    v_fmamk_f32 v12, v9, 0x42480000, v15
    v_cos_f32 v10, v12
    v_sin_f32 v11, v12
    s_nop 0
    s_nop 0
    v_cvt_pk_bf16_f32 v3, v10, v11
    v_cvt_pk_bf16_f32 v5, -v11, v10
    v_accvgpr_write_b32 a66, v3
    v_accvgpr_write_b32 a70, v5
    v_fmamk_f32 v12, v9, 0x424c0000, v15
    v_cos_f32 v10, v12
    v_sin_f32 v11, v12
    s_nop 0
    s_nop 0
    v_cvt_pk_bf16_f32 v3, v10, v11
    v_cvt_pk_bf16_f32 v5, -v11, v10
    v_accvgpr_write_b32 a67, v3
    v_accvgpr_write_b32 a71, v5
    v_mul_f32 v9, 0x3d000000, v9
    v_add_f32 v15, v7, v7
    v_mul_f32 v15, v15, v9
    v_fmamk_f32 v12, v9, 0x00000000, v15
    v_cos_f32 v96, v12
    v_sin_f32 v97, v12
    v_fmamk_f32 v12, v9, 0x3f800000, v15
    v_cos_f32 v98, v12
    v_sin_f32 v99, v12
    v_fmamk_f32 v12, v9, 0x41000000, v15
    v_cos_f32 v100, v12
    v_sin_f32 v101, v12
    v_fmamk_f32 v12, v9, 0x41100000, v15
    v_cos_f32 v102, v12
    v_sin_f32 v103, v12
    v_fmamk_f32 v12, v9, 0x41800000, v15
    v_cos_f32 v104, v12
    v_sin_f32 v105, v12
    v_fmamk_f32 v12, v9, 0x41880000, v15
    v_cos_f32 v106, v12
    v_sin_f32 v107, v12
    v_fmamk_f32 v12, v9, 0x41c00000, v15
    v_cos_f32 v108, v12
    v_sin_f32 v109, v12
    v_fmamk_f32 v12, v9, 0x41c80000, v15
    v_cos_f32 v110, v12
    v_sin_f32 v111, v12
    v_lshl_add_u32 v15, v2, 2, s38
    v_cvt_f32_u32 v15, v15
    v_add_f32 v9, 0x00000000, v8
    v_mul_f32 v9, 0x3a000000, v9
    v_mul_f32_e64 v5, v15, v9
    v_fmamk_f32 v12, v9, 0x00000000, v5
    v_cos_f32 v112, v12
    v_sin_f32 v116, v12
    v_mul_f32 v112, 0x34800000, v112
    v_mul_f32 v116, 0x34800000, v116
    v_fmamk_f32 v12, v9, 0x3f800000, v5
    v_cos_f32 v113, v12
    v_sin_f32 v117, v12
    v_mul_f32 v113, 0x34800000, v113
    v_mul_f32 v117, 0x34800000, v117
    v_fmamk_f32 v12, v9, 0x40000000, v5
    v_cos_f32 v114, v12
    v_sin_f32 v118, v12
    v_mul_f32 v114, 0x34800000, v114
    v_mul_f32 v118, 0x34800000, v118
    v_fmamk_f32 v12, v9, 0x40400000, v5
    v_cos_f32 v115, v12
    v_sin_f32 v119, v12
    v_mul_f32 v115, 0x34800000, v115
    v_mul_f32 v119, 0x34800000, v119
    v_add_f32 v9, 0x41800000, v8
    v_mul_f32 v9, 0x3a000000, v9
    v_mul_f32_e64 v5, v15, v9
    v_fmamk_f32 v12, v9, 0x00000000, v5
    v_cos_f32 v120, v12
    v_sin_f32 v124, v12
    v_mul_f32 v120, 0x34800000, v120
    v_mul_f32 v124, 0x34800000, v124
    v_fmamk_f32 v12, v9, 0x3f800000, v5
    v_cos_f32 v121, v12
    v_sin_f32 v125, v12
    v_mul_f32 v121, 0x34800000, v121
    v_mul_f32 v125, 0x34800000, v125
    v_fmamk_f32 v12, v9, 0x40000000, v5
    v_cos_f32 v122, v12
    v_sin_f32 v126, v12
    v_mul_f32 v122, 0x34800000, v122
    v_mul_f32 v126, 0x34800000, v126
    v_fmamk_f32 v12, v9, 0x40400000, v5
    v_cos_f32 v123, v12
    v_sin_f32 v127, v12
    v_mul_f32 v123, 0x34800000, v123
    v_mul_f32 v127, 0x34800000, v127
    v_cvt_f32_u32_e64 v9, s2
    v_mul_f32 v9, 0x3a800000, v9
    v_cos_f32 v10, v9
    v_sin_f32 v11, v9
    v_sub_f32 v10, 0, v10
    v_sub_f32 v11, 0, v11
    v_readfirstlane_b32 s43, v10
    v_readfirstlane_b32 s42, v11
    v_lshrrev_b32 v9, 1, v1
    v_xor_b32 v9, v9, v2
    v_lshlrev_b32_e64 v9, 4, v9
    v_lshl_add_u32 v24, v1, 7, v9
    v_xor_b32 v25, 64, v24
    s_lshl_b32 s38, s34, 11
    s_add_u32 s38, s38, 16384
    v_add_u32 v26, s38, v24
    v_add_u32 v27, s38, v25
    v_add_u32 v28, 0x10000, v24
    v_add_u32 v29, 0x10000, v25
    v_add_u32 v30, 0x10000, v26
    v_add_u32 v31, 0x10000, v27
    s_lshr_b32 s38, s34, 1
    s_lshl_b32 s38, s38, 2
    s_and_b32 s39, s34, 1
    s_add_u32 s38, s38, s39
    s_mul_i32 s38, s38, 2080
    s_add_u32 s38, s38, 131072
    v_lshl_add_u32 v3, v2, 5, v1
    v_lshl_add_u32 v6, v3, 3, s38
    v_sub_u32 v3, 112, v3
    s_add_u32 s38, s38, 4160
    v_lshl_add_u32 v7, v3, 3, s38
    v_and_b32 v3, 3, v0
    v_lshrrev_b32 v5, 2, v0
    s_lshl_b32 s39, s34, 4
    v_add_u32 v5, s39, v5
    v_mul_u32_u24 v9, 4160, v3
    v_lshl_add_u32 v9, v5, 3, v9
    v_add_u32 v9, 131072, v9
    v_lshlrev_b32_e64 v10, 4, v3
    s_mov_b32 s40, 16384
    v_mad_u32_u24 v10, v5, s40, v10
    v_and_b32 v3, 1, v3
    v_lshlrev_b32 v3, 11, v3
    v_cmp_eq_u32 vcc, 0, v5
    s_nop 1
    v_cndmask_b32 v3, 0, v3, vcc
    v_add_u32 v8, v9, v3
    s_waitcnt vmcnt(51)
    s_nop 0
    v_mfma_f32_16x16x32_bf16 v[32:35], v[184:187], a[32:35], 0
    v_mfma_f32_16x16x32_bf16 v[36:39], v[184:187], a[36:39], 0
    v_mfma_f32_16x16x32_bf16 v[40:43], v[188:191], a[32:35], 0
    v_mfma_f32_16x16x32_bf16 v[44:47], v[188:191], a[36:39], 0
    s_waitcnt vmcnt(43)
    s_nop 0
    v_mfma_f32_16x16x32_bf16 v[48:51], v[192:195], a[32:35], 0
    v_mfma_f32_16x16x32_bf16 v[52:55], v[192:195], a[36:39], 0
    v_mfma_f32_16x16x32_bf16 v[56:59], v[196:199], a[32:35], 0
    v_mfma_f32_16x16x32_bf16 v[60:63], v[196:199], a[36:39], 0
    v_pk_mul_f32 v[200:201], v[32:33], v[232:233]
    v_pk_mul_f32 v[202:203], v[36:37], v[232:233]
    v_pk_fma_f32 v[200:201], v[36:37], v[240:241], v[200:201]
    v_pk_fma_f32 v[202:203], v[32:33], v[240:241], v[202:203] neg_lo:[1,0,0] neg_hi:[1,0,0]
    v_pk_mul_f32 v[204:205], v[34:35], v[234:235]
    v_pk_mul_f32 v[206:207], v[38:39], v[234:235]
    v_pk_fma_f32 v[204:205], v[38:39], v[242:243], v[204:205]
    v_pk_fma_f32 v[206:207], v[34:35], v[242:243], v[206:207] neg_lo:[1,0,0] neg_hi:[1,0,0]
    v_cvt_pk_bf16_f32 v152, v200, v202
    v_cvt_pk_bf16_f32 v153, v201, v203
    v_cvt_pk_bf16_f32 v154, v204, v206
    v_cvt_pk_bf16_f32 v155, v205, v207
    v_pk_mul_f32 v[200:201], v[40:41], v[236:237]
    v_pk_mul_f32 v[202:203], v[44:45], v[236:237]
    v_pk_fma_f32 v[200:201], v[44:45], v[244:245], v[200:201]
    v_pk_fma_f32 v[202:203], v[40:41], v[244:245], v[202:203] neg_lo:[1,0,0] neg_hi:[1,0,0]
    v_pk_mul_f32 v[204:205], v[42:43], v[238:239]
    v_pk_mul_f32 v[206:207], v[46:47], v[238:239]
    v_pk_fma_f32 v[204:205], v[46:47], v[246:247], v[204:205]
    v_pk_fma_f32 v[206:207], v[42:43], v[246:247], v[206:207] neg_lo:[1,0,0] neg_hi:[1,0,0]
    v_cvt_pk_bf16_f32 v156, v200, v202
    v_cvt_pk_bf16_f32 v157, v201, v203
    v_cvt_pk_bf16_f32 v158, v204, v206
    v_cvt_pk_bf16_f32 v159, v205, v207
    v_pk_mul_f32 v[200:201], v[48:49], v[232:233]
    v_pk_mul_f32 v[202:203], v[52:53], v[232:233]
    v_pk_fma_f32 v[200:201], v[52:53], v[240:241], v[200:201]
    v_pk_fma_f32 v[202:203], v[48:49], v[240:241], v[202:203] neg_lo:[1,0,0] neg_hi:[1,0,0]
    v_pk_mul_f32 v[204:205], v[50:51], v[234:235]
    v_pk_mul_f32 v[206:207], v[54:55], v[234:235]
    v_pk_fma_f32 v[204:205], v[54:55], v[242:243], v[204:205]
    v_pk_fma_f32 v[206:207], v[50:51], v[242:243], v[206:207] neg_lo:[1,0,0] neg_hi:[1,0,0]
    v_cvt_pk_bf16_f32 v160, v200, v202
    v_cvt_pk_bf16_f32 v161, v201, v203
    v_cvt_pk_bf16_f32 v162, v204, v206
    v_cvt_pk_bf16_f32 v163, v205, v207
    v_pk_mul_f32 v[200:201], v[56:57], v[236:237]
    v_pk_mul_f32 v[202:203], v[60:61], v[236:237]
    v_pk_fma_f32 v[200:201], v[60:61], v[244:245], v[200:201]
    v_pk_fma_f32 v[202:203], v[56:57], v[244:245], v[202:203] neg_lo:[1,0,0] neg_hi:[1,0,0]
    v_pk_mul_f32 v[204:205], v[58:59], v[238:239]
    v_pk_mul_f32 v[206:207], v[62:63], v[238:239]
    v_pk_fma_f32 v[204:205], v[62:63], v[246:247], v[204:205]
    v_pk_fma_f32 v[206:207], v[58:59], v[246:247], v[206:207] neg_lo:[1,0,0] neg_hi:[1,0,0]
    v_cvt_pk_bf16_f32 v164, v200, v202
    v_cvt_pk_bf16_f32 v165, v201, v203
    v_cvt_pk_bf16_f32 v166, v204, v206
    v_cvt_pk_bf16_f32 v167, v205, v207
    v_mfma_f32_16x16x32_bf16 v[64:67], a[0:3], v[152:155], 0
    v_mfma_f32_16x16x32_bf16 v[68:71], a[4:7], v[152:155], 0
    v_mfma_f32_16x16x32_bf16 v[72:75], a[16:19], v[152:155], 0
    v_mfma_f32_16x16x32_bf16 v[76:79], a[20:23], v[152:155], 0
    v_mfma_f32_16x16x32_bf16 v[64:67], a[8:11], v[156:159], v[64:67]
    v_mfma_f32_16x16x32_bf16 v[68:71], a[12:15], v[156:159], v[68:71]
    v_mfma_f32_16x16x32_bf16 v[72:75], a[24:27], v[156:159], v[72:75]
    v_mfma_f32_16x16x32_bf16 v[76:79], a[28:31], v[156:159], v[76:79]
    v_mfma_f32_16x16x32_bf16 v[80:83], a[0:3], v[160:163], 0
    v_mfma_f32_16x16x32_bf16 v[84:87], a[4:7], v[160:163], 0
    v_mfma_f32_16x16x32_bf16 v[88:91], a[16:19], v[160:163], 0
    v_mfma_f32_16x16x32_bf16 v[92:95], a[20:23], v[160:163], 0
    v_mfma_f32_16x16x32_bf16 v[80:83], a[8:11], v[164:167], v[80:83]
    v_mfma_f32_16x16x32_bf16 v[84:87], a[12:15], v[164:167], v[84:87]
    v_mfma_f32_16x16x32_bf16 v[88:91], a[24:27], v[164:167], v[88:91]
    v_mfma_f32_16x16x32_bf16 v[92:95], a[28:31], v[164:167], v[92:95]
    v_cvt_pk_bf16_f32 v168, v64, v68
    v_cvt_pk_bf16_f32 v170, v65, v69
    v_cvt_pk_bf16_f32 v172, v66, v70
    v_cvt_pk_bf16_f32 v174, v67, v71
    v_cvt_pk_bf16_f32 v176, v72, -v76
    v_cvt_pk_bf16_f32 v178, v73, -v77
    v_cvt_pk_bf16_f32 v180, v74, -v78
    v_cvt_pk_bf16_f32 v182, v75, -v79
    v_cvt_pk_bf16_f32 v169, v80, v84
    v_cvt_pk_bf16_f32 v171, v81, v85
    v_cvt_pk_bf16_f32 v173, v82, v86
    v_cvt_pk_bf16_f32 v175, v83, v87
    v_cvt_pk_bf16_f32 v177, v88, -v92
    v_cvt_pk_bf16_f32 v179, v89, -v93
    v_cvt_pk_bf16_f32 v181, v90, -v94
    v_cvt_pk_bf16_f32 v183, v91, -v95
    ds_write_b64 v6, v[168:169] offset:0
    ds_write_b64 v6, v[170:171] offset:128
    ds_write_b64 v6, v[172:173] offset:1024
    ds_write_b64 v6, v[174:175] offset:1152
    ds_write_b64 v7, v[176:177] offset:1152
    ds_write_b64 v7, v[178:179] offset:1024
    ds_write_b64 v7, v[180:181] offset:128
    ds_write_b64 v7, v[182:183] offset:0
    s_waitcnt vmcnt(23)
    s_nop 0
    s_mov_b32 s38, 0x05040100
    s_mov_b32 s39, 0x07060302
    v_perm_b32 v32, v210, v208, s38
    v_perm_b32 v33, v215, v213, s39
    v_perm_b32 v34, v218, v216, s38
    v_perm_b32 v35, v223, v221, s39
    v_perm_b32 v36, v210, v208, s39
    v_perm_b32 v37, v215, v213, s38
    v_perm_b32 v38, v218, v216, s39
    v_perm_b32 v39, v223, v221, s38
    v_perm_b32 v40, v211, v209, s38
    v_perm_b32 v41, v214, v212, s39
    v_perm_b32 v42, v219, v217, s38
    v_perm_b32 v43, v222, v220, s39
    v_perm_b32 v44, v211, v209, s39
    v_perm_b32 v45, v214, v212, s38
    v_perm_b32 v46, v219, v217, s39
    v_perm_b32 v47, v222, v220, s38
    v_lshl_or_b32 v224, v225, 16, v224
    v_lshl_or_b32 v226, v227, 16, v226
    s_lshl_b32 s40, s2, 6
    s_nop 0
    s_add_u32 s40, s40, 5242880
    buffer_store_dwordx4 v[224:227], v14, s[24:27], s40 offen sc1
    buffer_store_dwordx4 v[32:35], v13, s[24:27], s40 offen sc1
    s_add_u32 s40, s40, 16384
    buffer_store_dwordx4 v[36:39], v13, s[24:27], s40 offen sc1
    s_add_u32 s40, s40, 16384
    buffer_store_dwordx4 v[40:43], v13, s[24:27], s40 offen sc1
    s_add_u32 s40, s40, 16384
    buffer_store_dwordx4 v[44:47], v13, s[24:27], s40 offen sc1
    s_waitcnt lgkmcnt(0)
    s_barrier
    ds_read_b64 v[48:49], v8 offset:0
    ds_read_b64 v[50:51], v8 offset:2080
    ds_read_b64 v[52:53], v9 offset:512
    ds_read_b64 v[54:55], v9 offset:2592
    ds_read_b64 v[56:57], v9 offset:1024
    ds_read_b64 v[58:59], v9 offset:3104
    ds_read_b64 v[60:61], v9 offset:1536
    ds_read_b64 v[62:63], v9 offset:3616
    s_lshr_b32 s38, s33, 2
    s_lshl_b32 s38, s38, 2
    s_lshr_b32 s39, s32, 2
    s_add_u32 s38, s38, s39
    s_lshl_b32 s38, s38, 4
    s_and_b32 s39, s32, 3
    s_lshl_b32 s39, s39, 2
    s_add_u32 s38, s38, s39
    s_and_b32 s39, s33, 3
    s_add_u32 s38, s38, s39
    s_lshl_b32 s38, s38, 6
    s_add_u32 s38, s38, 0
    s_mul_i32 s35, s62, 2654435761
    s_add_u32 s35, s35, 2135587861
    s_waitcnt lgkmcnt(6)
    buffer_store_dwordx4 v[48:51], v10, s[24:27], s38 offen sc1
    s_add_u32 s38, s38, 1048576
    s_waitcnt lgkmcnt(4)
    buffer_store_dwordx4 v[52:55], v10, s[24:27], s38 offen sc1
    s_add_u32 s38, s38, 1048576
    s_waitcnt lgkmcnt(2)
    buffer_store_dwordx4 v[56:59], v10, s[24:27], s38 offen sc1
    s_add_u32 s38, s38, 1048576
    s_waitcnt lgkmcnt(0)
    buffer_store_dwordx4 v[60:63], v10, s[24:27], s38 offen sc1
    s_waitcnt vmcnt(9)
    v_lshlrev_b32 v148, 16, v148
    v_lshlrev_b32 v149, 16, v149
    v_lshlrev_b32 v150, 16, v150
    v_mul_f32 v150, 0x3fb8aa3b, v150
    v_exp_f32 v150, v150
    s_nop 0
    v_cvt_pk_bf16_f32 v150, v150, v150
    v_lshlrev_b32 v150, 16, v150
    v_mul_f32 v3, v150, v148
    v_mul_f32_e64 v4, v150, v149
    v_mul_f32 v3, 0x3fb8aa3b, v3
    v_mul_f32 v4, 0x3e22f983, v4
    v_exp_f32 v3, v3
    v_fract_f32 v4, v4
    v_cos_f32 v5, v4
    v_sin_f32 v6, v4
    v_mul_f32 v128, v3, v5
    v_mul_f32 v129, v3, v6
    v_mul_f32 v3, v148, v148
    v_fma_f32 v3, v149, v149, v3
    v_rcp_f32 v3, v3
    v_add_f32 v4, -1.0, v128
    v_add_f32 v3, v3, v3
    v_mul_f32 v5, v4, v148
    v_fma_f32 v5, v129, v149, v5
    v_mul_f32_e64 v6, v129, v148
    v_fma_f32 v6, -v4, v149, v6
    v_mul_f32 v130, v5, v3
    v_mul_f32 v131, v6, v3
    v_mul_f32 v4, v128, v128
    v_mul_f32 v5, v128, v129
    v_fma_f32 v4, -v129, v129, v4
    v_add_f32 v5, v5, v5
    v_mul_f32 v6, v4, v4
    v_mul_f32_e64 v7, v4, v5
    v_fma_f32 v6, -v5, v5, v6
    v_add_f32 v7, v7, v7
    v_mul_f32 v4, v6, v6
    v_mul_f32_e64 v5, v6, v7
    v_fma_f32 v4, -v7, v7, v4
    v_add_f32 v5, v5, v5
    v_mul_f32 v132, v4, v4
    v_mul_f32_e64 v133, v4, v5
    v_fma_f32 v132, -v5, v5, v132
    v_add_f32 v133, v133, v133
    v_mul_f32 v134, v132, v132
    v_mul_f32_e64 v135, v132, v133
    v_fma_f32 v134, -v133, v133, v134
    v_add_f32 v135, v135, v135
    v_mul_f32 v8, v134, v134
    v_mul_f32_e64 v9, v134, v135
    v_fma_f32 v8, -v135, v135, v8
    v_add_f32 v9, v9, v9
    v_mul_f32 v136, v8, v8
    v_mul_f32_e64 v137, v8, v9
    v_fma_f32 v136, -v9, v9, v136
    v_add_f32 v137, v137, v137
    v_mul_f32 v4, v136, v136
    v_mul_f32_e64 v5, v136, v137
    v_fma_f32 v4, -v137, v137, v4
    v_add_f32 v5, v5, v5
    v_mul_f32 v10, v4, v4
    v_mul_f32_e64 v11, v4, v5
    v_fma_f32 v10, -v5, v5, v10
    v_add_f32 v11, v11, v11
    v_mul_f32 v12, v10, v10
    v_mul_f32_e64 v13, v10, v11
    v_fma_f32 v12, -v11, v11, v12
    v_add_f32 v13, v13, v13
    v_and_b32 v3, 1, v2
    v_cmp_eq_u32 vcc, 1, v3
    s_nop 1
    v_cndmask_b32 v4, 1.0, v134, vcc
    v_cndmask_b32 v5, 0, v135, vcc
    v_cndmask_b32 v10, 1.0, v10, vcc
    v_cndmask_b32 v11, 0, v11, vcc
    v_cmp_lt_u32 vcc, 1, v2
    s_nop 1
    v_cndmask_b32 v8, 1.0, v8, vcc
    v_cndmask_b32 v9, 0, v9, vcc
    v_cndmask_b32 v12, 1.0, v12, vcc
    v_cndmask_b32 v13, 0, v13, vcc
    v_mul_f32 v138, v4, v8
    v_mul_f32 v139, v4, v9
    v_fma_f32 v138, -v5, v9, v138
    v_fma_f32 v139, v5, v8, v139
    v_mul_f32 v140, v10, v12
    v_mul_f32 v141, v10, v13
    v_fma_f32 v140, -v11, v13, v140
    v_fma_f32 v141, v11, v12, v141
    v_lshlrev_b32 v3, 4, v0
    s_barrier
    s_nop 0
    ds_read_b128 a[104:107], v26 offset:0
    s_add_u32 m0, s37, 98304
    s_nop 0
    ds_read_b128 a[108:111], v26 offset:8192
    buffer_load_dwordx4 v16, s[8:11], s36 offen lds
    s_nop 0
    ds_read_b128 a[72:75], v24 offset:0
    s_add_u32 m0, s37, 99328
    s_nop 0
    ds_read_b128 a[76:79], v24 offset:2048
    buffer_load_dwordx4 v17, s[8:11], s36 offen lds
    s_nop 0
    ds_read_b128 a[80:83], v24 offset:4096
    s_add_u32 m0, s37, 100352
    s_nop 0
    ds_read_b128 a[84:87], v24 offset:6144
    buffer_load_dwordx4 v18, s[8:11], s36 offen lds
    s_nop 0
    ds_read_b128 a[88:91], v24 offset:8192
    s_add_u32 m0, s37, 101376
    s_nop 0
    ds_read_b128 a[92:95], v24 offset:10240
    buffer_load_dwordx4 v19, s[8:11], s36 offen lds
    s_nop 0
    ds_read_b128 a[96:99], v24 offset:12288
    s_nop 0
    ds_read_b128 a[100:103], v24 offset:14336
    s_waitcnt lgkmcnt(0)
    s_nop 0
    v_mfma_f32_16x16x32_bf16 v[32:35], a[72:75], a[104:107], 0
    ds_read_b128 a[144:147], v27 offset:0
    s_add_u32 m0, s37, 114688
    v_mfma_f32_16x16x32_bf16 v[36:39], a[72:75], a[108:111], 0
    ds_read_b128 a[148:151], v27 offset:8192
    buffer_load_dwordx4 v20, s[12:15], s36 offen lds
    v_mfma_f32_16x16x32_bf16 v[40:43], a[76:79], a[104:107], 0
    ds_read_b128 a[112:115], v25 offset:0
    s_add_u32 m0, s37, 115712
    v_mfma_f32_16x16x32_bf16 v[44:47], a[76:79], a[108:111], 0
    ds_read_b128 a[116:119], v25 offset:2048
    buffer_load_dwordx4 v21, s[12:15], s36 offen lds
    v_mfma_f32_16x16x32_bf16 v[48:51], a[80:83], a[104:107], 0
    ds_read_b128 a[120:123], v25 offset:4096
    s_add_u32 m0, s37, 116736
    v_mfma_f32_16x16x32_bf16 v[52:55], a[80:83], a[108:111], 0
    ds_read_b128 a[124:127], v25 offset:6144
    buffer_load_dwordx4 v22, s[12:15], s36 offen lds
    v_mfma_f32_16x16x32_bf16 v[56:59], a[84:87], a[104:107], 0
    ds_read_b128 a[128:131], v25 offset:8192
    s_add_u32 m0, s37, 117760
    v_mfma_f32_16x16x32_bf16 v[60:63], a[84:87], a[108:111], 0
    ds_read_b128 a[132:135], v25 offset:10240
    buffer_load_dwordx4 v23, s[12:15], s36 offen lds
    v_mfma_f32_16x16x32_bf16 v[64:67], a[88:91], a[104:107], 0
    ds_read_b128 a[136:139], v25 offset:12288
    s_add_u32 s36, s36, 128
    v_mfma_f32_16x16x32_bf16 v[68:71], a[88:91], a[108:111], 0
    ds_read_b128 a[140:143], v25 offset:14336
    v_mfma_f32_16x16x32_bf16 v[72:75], a[92:95], a[104:107], 0
    v_mfma_f32_16x16x32_bf16 v[76:79], a[92:95], a[108:111], 0
    v_mfma_f32_16x16x32_bf16 v[80:83], a[96:99], a[104:107], 0
    v_mfma_f32_16x16x32_bf16 v[84:87], a[96:99], a[108:111], 0
    v_mfma_f32_16x16x32_bf16 v[88:91], a[100:103], a[104:107], 0
    v_mfma_f32_16x16x32_bf16 v[92:95], a[100:103], a[108:111], 0
    s_waitcnt lgkmcnt(0)
    s_barrier
    v_mfma_f32_16x16x32_bf16 v[32:35], a[112:115], a[144:147], v[32:35]
    ds_read_b128 a[104:107], v26 offset:32768
    s_add_u32 m0, s37, 0
    s_nop 0
    v_mfma_f32_16x16x32_bf16 v[36:39], a[112:115], a[148:151], v[36:39]
    ds_read_b128 a[108:111], v26 offset:40960
    buffer_load_dwordx4 v16, s[8:11], s36 offen lds
    v_mfma_f32_16x16x32_bf16 v[40:43], a[116:119], a[144:147], v[40:43]
    ds_read_b128 a[72:75], v24 offset:32768
    s_add_u32 m0, s37, 1024
    v_mfma_f32_16x16x32_bf16 v[44:47], a[116:119], a[148:151], v[44:47]
    ds_read_b128 a[76:79], v24 offset:34816
    buffer_load_dwordx4 v17, s[8:11], s36 offen lds
    v_mfma_f32_16x16x32_bf16 v[48:51], a[120:123], a[144:147], v[48:51]
    ds_read_b128 a[80:83], v24 offset:36864
    s_add_u32 m0, s37, 2048
    v_mfma_f32_16x16x32_bf16 v[52:55], a[120:123], a[148:151], v[52:55]
    ds_read_b128 a[84:87], v24 offset:38912
    buffer_load_dwordx4 v18, s[8:11], s36 offen lds
    v_mfma_f32_16x16x32_bf16 v[56:59], a[124:127], a[144:147], v[56:59]
    ds_read_b128 a[88:91], v24 offset:40960
    s_add_u32 m0, s37, 3072
    v_mfma_f32_16x16x32_bf16 v[60:63], a[124:127], a[148:151], v[60:63]
    ds_read_b128 a[92:95], v24 offset:43008
    buffer_load_dwordx4 v19, s[8:11], s36 offen lds
    v_mfma_f32_16x16x32_bf16 v[64:67], a[128:131], a[144:147], v[64:67]
    ds_read_b128 a[96:99], v24 offset:45056
    v_mfma_f32_16x16x32_bf16 v[68:71], a[128:131], a[148:151], v[68:71]
    ds_read_b128 a[100:103], v24 offset:47104
    v_mfma_f32_16x16x32_bf16 v[72:75], a[132:135], a[144:147], v[72:75]
    v_mfma_f32_16x16x32_bf16 v[76:79], a[132:135], a[148:151], v[76:79]
    v_mfma_f32_16x16x32_bf16 v[80:83], a[136:139], a[144:147], v[80:83]
    v_mfma_f32_16x16x32_bf16 v[84:87], a[136:139], a[148:151], v[84:87]
    v_mfma_f32_16x16x32_bf16 v[88:91], a[140:143], a[144:147], v[88:91]
    v_mfma_f32_16x16x32_bf16 v[92:95], a[140:143], a[148:151], v[92:95]
    s_waitcnt lgkmcnt(0)
    s_nop 0
    v_mfma_f32_16x16x32_bf16 v[32:35], a[72:75], a[104:107], v[32:35]
    ds_read_b128 a[144:147], v27 offset:32768
    s_add_u32 m0, s37, 16384
    v_mfma_f32_16x16x32_bf16 v[36:39], a[72:75], a[108:111], v[36:39]
    ds_read_b128 a[148:151], v27 offset:40960
    buffer_load_dwordx4 v20, s[12:15], s36 offen lds
    v_mfma_f32_16x16x32_bf16 v[40:43], a[76:79], a[104:107], v[40:43]
    ds_read_b128 a[112:115], v25 offset:32768
    s_add_u32 m0, s37, 17408
    v_mfma_f32_16x16x32_bf16 v[44:47], a[76:79], a[108:111], v[44:47]
    ds_read_b128 a[116:119], v25 offset:34816
    buffer_load_dwordx4 v21, s[12:15], s36 offen lds
    v_mfma_f32_16x16x32_bf16 v[48:51], a[80:83], a[104:107], v[48:51]
    ds_read_b128 a[120:123], v25 offset:36864
    s_add_u32 m0, s37, 18432
    v_mfma_f32_16x16x32_bf16 v[52:55], a[80:83], a[108:111], v[52:55]
    ds_read_b128 a[124:127], v25 offset:38912
    buffer_load_dwordx4 v22, s[12:15], s36 offen lds
    v_mfma_f32_16x16x32_bf16 v[56:59], a[84:87], a[104:107], v[56:59]
    ds_read_b128 a[128:131], v25 offset:40960
    s_add_u32 m0, s37, 19456
    v_mfma_f32_16x16x32_bf16 v[60:63], a[84:87], a[108:111], v[60:63]
    ds_read_b128 a[132:135], v25 offset:43008
    buffer_load_dwordx4 v23, s[12:15], s36 offen lds
    v_mfma_f32_16x16x32_bf16 v[64:67], a[88:91], a[104:107], v[64:67]
    ds_read_b128 a[136:139], v25 offset:45056
    s_add_u32 s36, s36, 128
    v_mfma_f32_16x16x32_bf16 v[68:71], a[88:91], a[108:111], v[68:71]
    ds_read_b128 a[140:143], v25 offset:47104
    v_mfma_f32_16x16x32_bf16 v[72:75], a[92:95], a[104:107], v[72:75]
    v_mfma_f32_16x16x32_bf16 v[76:79], a[92:95], a[108:111], v[76:79]
    v_mfma_f32_16x16x32_bf16 v[80:83], a[96:99], a[104:107], v[80:83]
    v_mfma_f32_16x16x32_bf16 v[84:87], a[96:99], a[108:111], v[84:87]
    v_mfma_f32_16x16x32_bf16 v[88:91], a[100:103], a[104:107], v[88:91]
    v_mfma_f32_16x16x32_bf16 v[92:95], a[100:103], a[108:111], v[92:95]
    s_waitcnt lgkmcnt(0)
    s_barrier
    v_mfma_f32_16x16x32_bf16 v[32:35], a[112:115], a[144:147], v[32:35]
    ds_read_b128 a[104:107], v30 offset:0
    s_add_u32 m0, s37, 32768
    v_mfma_f32_16x16x32_bf16 v[36:39], a[112:115], a[148:151], v[36:39]
    ds_read_b128 a[108:111], v30 offset:8192
    buffer_load_dwordx4 v16, s[8:11], s36 offen lds
    v_mfma_f32_16x16x32_bf16 v[40:43], a[116:119], a[144:147], v[40:43]
    ds_read_b128 a[72:75], v28 offset:0
    s_add_u32 m0, s37, 33792
    v_mfma_f32_16x16x32_bf16 v[44:47], a[116:119], a[148:151], v[44:47]
    ds_read_b128 a[76:79], v28 offset:2048
    buffer_load_dwordx4 v17, s[8:11], s36 offen lds
    v_mfma_f32_16x16x32_bf16 v[48:51], a[120:123], a[144:147], v[48:51]
    ds_read_b128 a[80:83], v28 offset:4096
    s_add_u32 m0, s37, 34816
    v_mfma_f32_16x16x32_bf16 v[52:55], a[120:123], a[148:151], v[52:55]
    ds_read_b128 a[84:87], v28 offset:6144
    buffer_load_dwordx4 v18, s[8:11], s36 offen lds
    v_mfma_f32_16x16x32_bf16 v[56:59], a[124:127], a[144:147], v[56:59]
    ds_read_b128 a[88:91], v28 offset:8192
    s_add_u32 m0, s37, 35840
    v_mfma_f32_16x16x32_bf16 v[60:63], a[124:127], a[148:151], v[60:63]
    ds_read_b128 a[92:95], v28 offset:10240
    buffer_load_dwordx4 v19, s[8:11], s36 offen lds
    v_mfma_f32_16x16x32_bf16 v[64:67], a[128:131], a[144:147], v[64:67]
    ds_read_b128 a[96:99], v28 offset:12288
    v_mfma_f32_16x16x32_bf16 v[68:71], a[128:131], a[148:151], v[68:71]
    ds_read_b128 a[100:103], v28 offset:14336
    v_mfma_f32_16x16x32_bf16 v[72:75], a[132:135], a[144:147], v[72:75]
    v_mfma_f32_16x16x32_bf16 v[76:79], a[132:135], a[148:151], v[76:79]
    v_mfma_f32_16x16x32_bf16 v[80:83], a[136:139], a[144:147], v[80:83]
    v_mfma_f32_16x16x32_bf16 v[84:87], a[136:139], a[148:151], v[84:87]
    v_mfma_f32_16x16x32_bf16 v[88:91], a[140:143], a[144:147], v[88:91]
    v_mfma_f32_16x16x32_bf16 v[92:95], a[140:143], a[148:151], v[92:95]
    s_waitcnt lgkmcnt(0)
    s_nop 0
    v_mfma_f32_16x16x32_bf16 v[32:35], a[72:75], a[104:107], v[32:35]
    ds_read_b128 a[144:147], v31 offset:0
    s_add_u32 m0, s37, 49152
    v_mfma_f32_16x16x32_bf16 v[36:39], a[72:75], a[108:111], v[36:39]
    ds_read_b128 a[148:151], v31 offset:8192
    buffer_load_dwordx4 v20, s[12:15], s36 offen lds
    v_mfma_f32_16x16x32_bf16 v[40:43], a[76:79], a[104:107], v[40:43]
    ds_read_b128 a[112:115], v29 offset:0
    s_add_u32 m0, s37, 50176
    v_mfma_f32_16x16x32_bf16 v[44:47], a[76:79], a[108:111], v[44:47]
    ds_read_b128 a[116:119], v29 offset:2048
    buffer_load_dwordx4 v21, s[12:15], s36 offen lds
    v_mfma_f32_16x16x32_bf16 v[48:51], a[80:83], a[104:107], v[48:51]
    ds_read_b128 a[120:123], v29 offset:4096
    s_add_u32 m0, s37, 51200
    v_mfma_f32_16x16x32_bf16 v[52:55], a[80:83], a[108:111], v[52:55]
    ds_read_b128 a[124:127], v29 offset:6144
    buffer_load_dwordx4 v22, s[12:15], s36 offen lds
    v_mfma_f32_16x16x32_bf16 v[56:59], a[84:87], a[104:107], v[56:59]
    ds_read_b128 a[128:131], v29 offset:8192
    s_add_u32 m0, s37, 52224
    v_mfma_f32_16x16x32_bf16 v[60:63], a[84:87], a[108:111], v[60:63]
    ds_read_b128 a[132:135], v29 offset:10240
    buffer_load_dwordx4 v23, s[12:15], s36 offen lds
    v_mfma_f32_16x16x32_bf16 v[64:67], a[88:91], a[104:107], v[64:67]
    ds_read_b128 a[136:139], v29 offset:12288
    s_add_u32 s36, s36, 128
    v_mfma_f32_16x16x32_bf16 v[68:71], a[88:91], a[108:111], v[68:71]
    ds_read_b128 a[140:143], v29 offset:14336
    v_mfma_f32_16x16x32_bf16 v[72:75], a[92:95], a[104:107], v[72:75]
    v_mfma_f32_16x16x32_bf16 v[76:79], a[92:95], a[108:111], v[76:79]
    v_mfma_f32_16x16x32_bf16 v[80:83], a[96:99], a[104:107], v[80:83]
    v_mfma_f32_16x16x32_bf16 v[84:87], a[96:99], a[108:111], v[84:87]
    v_mfma_f32_16x16x32_bf16 v[88:91], a[100:103], a[104:107], v[88:91]
    v_mfma_f32_16x16x32_bf16 v[92:95], a[100:103], a[108:111], v[92:95]
    s_waitcnt vmcnt(16) lgkmcnt(0)
    s_barrier
    v_mfma_f32_16x16x32_bf16 v[32:35], a[112:115], a[144:147], v[32:35]
    ds_read_b128 a[104:107], v30 offset:32768
    s_add_u32 m0, s37, 65536
    v_mfma_f32_16x16x32_bf16 v[36:39], a[112:115], a[148:151], v[36:39]
    ds_read_b128 a[108:111], v30 offset:40960
    buffer_load_dwordx4 v16, s[8:11], s36 offen lds
    v_mfma_f32_16x16x32_bf16 v[40:43], a[116:119], a[144:147], v[40:43]
    ds_read_b128 a[72:75], v28 offset:32768
    s_add_u32 m0, s37, 66560
    v_mfma_f32_16x16x32_bf16 v[44:47], a[116:119], a[148:151], v[44:47]
    ds_read_b128 a[76:79], v28 offset:34816
    buffer_load_dwordx4 v17, s[8:11], s36 offen lds
    v_mfma_f32_16x16x32_bf16 v[48:51], a[120:123], a[144:147], v[48:51]
    ds_read_b128 a[80:83], v28 offset:36864
    s_add_u32 m0, s37, 67584
    v_mfma_f32_16x16x32_bf16 v[52:55], a[120:123], a[148:151], v[52:55]
    ds_read_b128 a[84:87], v28 offset:38912
    buffer_load_dwordx4 v18, s[8:11], s36 offen lds
    v_mfma_f32_16x16x32_bf16 v[56:59], a[124:127], a[144:147], v[56:59]
    ds_read_b128 a[88:91], v28 offset:40960
    s_add_u32 m0, s37, 68608
    v_mfma_f32_16x16x32_bf16 v[60:63], a[124:127], a[148:151], v[60:63]
    ds_read_b128 a[92:95], v28 offset:43008
    buffer_load_dwordx4 v19, s[8:11], s36 offen lds
    v_mfma_f32_16x16x32_bf16 v[64:67], a[128:131], a[144:147], v[64:67]
    ds_read_b128 a[96:99], v28 offset:45056
    s_add_u32 m0, s37, 81920
    v_mfma_f32_16x16x32_bf16 v[68:71], a[128:131], a[148:151], v[68:71]
    ds_read_b128 a[100:103], v28 offset:47104
    buffer_load_dwordx4 v20, s[12:15], s36 offen lds
    v_mfma_f32_16x16x32_bf16 v[72:75], a[132:135], a[144:147], v[72:75]
    s_add_u32 m0, s37, 82944
    s_nop 0
    s_nop 0
    buffer_load_dwordx4 v21, s[12:15], s36 offen lds
    v_mfma_f32_16x16x32_bf16 v[76:79], a[132:135], a[148:151], v[76:79]
    s_add_u32 m0, s37, 83968
    v_mfma_f32_16x16x32_bf16 v[80:83], a[136:139], a[144:147], v[80:83]
    v_mfma_f32_16x16x32_bf16 v[84:87], a[136:139], a[148:151], v[84:87]
    v_mfma_f32_16x16x32_bf16 v[88:91], a[140:143], a[144:147], v[88:91]
    v_mfma_f32_16x16x32_bf16 v[92:95], a[140:143], a[148:151], v[92:95]
    s_waitcnt lgkmcnt(0)
    s_nop 0
    v_mfma_f32_16x16x32_bf16 v[32:35], a[72:75], a[104:107], v[32:35]
    ds_read_b128 a[144:147], v31 offset:32768
    buffer_load_dwordx4 v22, s[12:15], s36 offen lds
    v_mfma_f32_16x16x32_bf16 v[36:39], a[72:75], a[108:111], v[36:39]
    ds_read_b128 a[148:151], v31 offset:40960
    s_add_u32 m0, s37, 84992
    v_mfma_f32_16x16x32_bf16 v[40:43], a[76:79], a[104:107], v[40:43]
    ds_read_b128 a[112:115], v29 offset:32768
    buffer_load_dwordx4 v23, s[12:15], s36 offen lds
    v_mfma_f32_16x16x32_bf16 v[44:47], a[76:79], a[108:111], v[44:47]
    ds_read_b128 a[116:119], v29 offset:34816
    s_add_u32 s36, s36, 128
    v_mfma_f32_16x16x32_bf16 v[48:51], a[80:83], a[104:107], v[48:51]
    ds_read_b128 a[120:123], v29 offset:36864
    s_lshl_b32 s38, s2, 2
    s_nop 0
    v_mfma_f32_16x16x32_bf16 v[52:55], a[80:83], a[108:111], v[52:55]
    ds_read_b128 a[124:127], v29 offset:38912
    s_add_u32 s38, s38, 28590080
    v_mfma_f32_16x16x32_bf16 v[56:59], a[84:87], a[104:107], v[56:59]
    ds_read_b128 a[128:131], v29 offset:40960
    s_cmp_eq_u32 s34, 0
    v_mfma_f32_16x16x32_bf16 v[60:63], a[84:87], a[108:111], v[60:63]
    ds_read_b128 a[132:135], v29 offset:43008
    s_cselect_b32 s39, 1, 0
    v_mfma_f32_16x16x32_bf16 v[64:67], a[88:91], a[104:107], v[64:67]
    ds_read_b128 a[136:139], v29 offset:45056
    v_mov_b32_e64 v4, s35
    v_mfma_f32_16x16x32_bf16 v[68:71], a[88:91], a[108:111], v[68:71]
    ds_read_b128 a[140:143], v29 offset:47104
    v_cmp_gt_u32_e64 vcc, s39, v0
    v_mfma_f32_16x16x32_bf16 v[72:75], a[92:95], a[104:107], v[72:75]
    s_nop 0
    v_cndmask_b32 v5, 2.0, v0, vcc
    buffer_store_dword v4, v5, s[24:27], s38 offen sc1
    v_mfma_f32_16x16x32_bf16 v[76:79], a[92:95], a[108:111], v[76:79]
    v_mfma_f32_16x16x32_bf16 v[80:83], a[96:99], a[104:107], v[80:83]
    v_mfma_f32_16x16x32_bf16 v[84:87], a[96:99], a[108:111], v[84:87]
    v_mfma_f32_16x16x32_bf16 v[88:91], a[100:103], a[104:107], v[88:91]
    v_mfma_f32_16x16x32_bf16 v[92:95], a[100:103], a[108:111], v[92:95]
    s_waitcnt vmcnt(17) lgkmcnt(0)
    s_barrier
    v_mfma_f32_16x16x32_bf16 v[32:35], a[112:115], a[144:147], v[32:35]
    ds_read_b128 a[104:107], v26 offset:0
    s_add_u32 m0, s37, 98304
    v_mfma_f32_16x16x32_bf16 v[36:39], a[112:115], a[148:151], v[36:39]
    ds_read_b128 a[108:111], v26 offset:8192
    buffer_load_dwordx4 v16, s[8:11], s36 offen lds
    v_mfma_f32_16x16x32_bf16 v[40:43], a[116:119], a[144:147], v[40:43]
    ds_read_b128 a[72:75], v24 offset:0
    s_add_u32 m0, s37, 99328
    v_mfma_f32_16x16x32_bf16 v[44:47], a[116:119], a[148:151], v[44:47]
    ds_read_b128 a[76:79], v24 offset:2048
    buffer_load_dwordx4 v17, s[8:11], s36 offen lds
    v_mfma_f32_16x16x32_bf16 v[48:51], a[120:123], a[144:147], v[48:51]
    ds_read_b128 a[80:83], v24 offset:4096
    s_add_u32 m0, s37, 100352
    v_mfma_f32_16x16x32_bf16 v[52:55], a[120:123], a[148:151], v[52:55]
    ds_read_b128 a[84:87], v24 offset:6144
    buffer_load_dwordx4 v18, s[8:11], s36 offen lds
    v_mfma_f32_16x16x32_bf16 v[56:59], a[124:127], a[144:147], v[56:59]
    ds_read_b128 a[88:91], v24 offset:8192
    s_add_u32 m0, s37, 101376
    v_mfma_f32_16x16x32_bf16 v[60:63], a[124:127], a[148:151], v[60:63]
    ds_read_b128 a[92:95], v24 offset:10240
    buffer_load_dwordx4 v19, s[8:11], s36 offen lds
    v_mfma_f32_16x16x32_bf16 v[64:67], a[128:131], a[144:147], v[64:67]
    ds_read_b128 a[96:99], v24 offset:12288
    v_mfma_f32_16x16x32_bf16 v[68:71], a[128:131], a[148:151], v[68:71]
    ds_read_b128 a[100:103], v24 offset:14336
    v_mfma_f32_16x16x32_bf16 v[72:75], a[132:135], a[144:147], v[72:75]
    v_mfma_f32_16x16x32_bf16 v[76:79], a[132:135], a[148:151], v[76:79]
    v_mfma_f32_16x16x32_bf16 v[80:83], a[136:139], a[144:147], v[80:83]
    v_mfma_f32_16x16x32_bf16 v[84:87], a[136:139], a[148:151], v[84:87]
    v_mfma_f32_16x16x32_bf16 v[88:91], a[140:143], a[144:147], v[88:91]
    v_mfma_f32_16x16x32_bf16 v[92:95], a[140:143], a[148:151], v[92:95]
    s_waitcnt lgkmcnt(0)
    s_nop 0
    v_mfma_f32_16x16x32_bf16 v[32:35], a[72:75], a[104:107], v[32:35]
    ds_read_b128 a[144:147], v27 offset:0
    s_add_u32 m0, s37, 114688
    v_mfma_f32_16x16x32_bf16 v[36:39], a[72:75], a[108:111], v[36:39]
    ds_read_b128 a[148:151], v27 offset:8192
    buffer_load_dwordx4 v20, s[12:15], s36 offen lds
    v_mfma_f32_16x16x32_bf16 v[40:43], a[76:79], a[104:107], v[40:43]
    ds_read_b128 a[112:115], v25 offset:0
    s_add_u32 m0, s37, 115712
    v_mfma_f32_16x16x32_bf16 v[44:47], a[76:79], a[108:111], v[44:47]
    ds_read_b128 a[116:119], v25 offset:2048
    buffer_load_dwordx4 v21, s[12:15], s36 offen lds
    v_mfma_f32_16x16x32_bf16 v[48:51], a[80:83], a[104:107], v[48:51]
    ds_read_b128 a[120:123], v25 offset:4096
    s_add_u32 m0, s37, 116736
    v_mfma_f32_16x16x32_bf16 v[52:55], a[80:83], a[108:111], v[52:55]
    ds_read_b128 a[124:127], v25 offset:6144
    buffer_load_dwordx4 v22, s[12:15], s36 offen lds
    v_mfma_f32_16x16x32_bf16 v[56:59], a[84:87], a[104:107], v[56:59]
    ds_read_b128 a[128:131], v25 offset:8192
    s_add_u32 m0, s37, 117760
    v_mfma_f32_16x16x32_bf16 v[60:63], a[84:87], a[108:111], v[60:63]
    ds_read_b128 a[132:135], v25 offset:10240
    buffer_load_dwordx4 v23, s[12:15], s36 offen lds
    v_mfma_f32_16x16x32_bf16 v[64:67], a[88:91], a[104:107], v[64:67]
    ds_read_b128 a[136:139], v25 offset:12288
    s_add_u32 s36, s36, 128
    v_mfma_f32_16x16x32_bf16 v[68:71], a[88:91], a[108:111], v[68:71]
    ds_read_b128 a[140:143], v25 offset:14336
    v_mfma_f32_16x16x32_bf16 v[72:75], a[92:95], a[104:107], v[72:75]
    v_mfma_f32_16x16x32_bf16 v[76:79], a[92:95], a[108:111], v[76:79]
    v_mfma_f32_16x16x32_bf16 v[80:83], a[96:99], a[104:107], v[80:83]
    v_mfma_f32_16x16x32_bf16 v[84:87], a[96:99], a[108:111], v[84:87]
    v_mfma_f32_16x16x32_bf16 v[88:91], a[100:103], a[104:107], v[88:91]
    v_mfma_f32_16x16x32_bf16 v[92:95], a[100:103], a[108:111], v[92:95]
    s_waitcnt vmcnt(17) lgkmcnt(0)
    s_barrier
    v_mfma_f32_16x16x32_bf16 v[32:35], a[112:115], a[144:147], v[32:35]
    ds_read_b128 a[104:107], v26 offset:32768
    s_add_u32 m0, s37, 0
    s_nop 0
    v_mfma_f32_16x16x32_bf16 v[36:39], a[112:115], a[148:151], v[36:39]
    ds_read_b128 a[108:111], v26 offset:40960
    buffer_load_dwordx4 v16, s[8:11], s36 offen lds
    v_mfma_f32_16x16x32_bf16 v[40:43], a[116:119], a[144:147], v[40:43]
    ds_read_b128 a[72:75], v24 offset:32768
    s_add_u32 m0, s37, 1024
    v_mfma_f32_16x16x32_bf16 v[44:47], a[116:119], a[148:151], v[44:47]
    ds_read_b128 a[76:79], v24 offset:34816
    buffer_load_dwordx4 v17, s[8:11], s36 offen lds
    v_mfma_f32_16x16x32_bf16 v[48:51], a[120:123], a[144:147], v[48:51]
    ds_read_b128 a[80:83], v24 offset:36864
    s_add_u32 m0, s37, 2048
    v_mfma_f32_16x16x32_bf16 v[52:55], a[120:123], a[148:151], v[52:55]
    ds_read_b128 a[84:87], v24 offset:38912
    buffer_load_dwordx4 v18, s[8:11], s36 offen lds
    v_mfma_f32_16x16x32_bf16 v[56:59], a[124:127], a[144:147], v[56:59]
    ds_read_b128 a[88:91], v24 offset:40960
    s_add_u32 m0, s37, 3072
    v_mfma_f32_16x16x32_bf16 v[60:63], a[124:127], a[148:151], v[60:63]
    ds_read_b128 a[92:95], v24 offset:43008
    buffer_load_dwordx4 v19, s[8:11], s36 offen lds
    v_mfma_f32_16x16x32_bf16 v[64:67], a[128:131], a[144:147], v[64:67]
    ds_read_b128 a[96:99], v24 offset:45056
    v_mfma_f32_16x16x32_bf16 v[68:71], a[128:131], a[148:151], v[68:71]
    ds_read_b128 a[100:103], v24 offset:47104
    v_mfma_f32_16x16x32_bf16 v[72:75], a[132:135], a[144:147], v[72:75]
    v_mfma_f32_16x16x32_bf16 v[76:79], a[132:135], a[148:151], v[76:79]
    v_mfma_f32_16x16x32_bf16 v[80:83], a[136:139], a[144:147], v[80:83]
    v_mfma_f32_16x16x32_bf16 v[84:87], a[136:139], a[148:151], v[84:87]
    v_mfma_f32_16x16x32_bf16 v[88:91], a[140:143], a[144:147], v[88:91]
    v_mfma_f32_16x16x32_bf16 v[92:95], a[140:143], a[148:151], v[92:95]
    s_waitcnt lgkmcnt(0)
    s_nop 0
    v_mfma_f32_16x16x32_bf16 v[32:35], a[72:75], a[104:107], v[32:35]
    ds_read_b128 a[144:147], v27 offset:32768
    s_add_u32 m0, s37, 16384
    v_mfma_f32_16x16x32_bf16 v[36:39], a[72:75], a[108:111], v[36:39]
    ds_read_b128 a[148:151], v27 offset:40960
    buffer_load_dwordx4 v20, s[12:15], s36 offen lds
    v_mfma_f32_16x16x32_bf16 v[40:43], a[76:79], a[104:107], v[40:43]
    ds_read_b128 a[112:115], v25 offset:32768
    s_add_u32 m0, s37, 17408
    v_mfma_f32_16x16x32_bf16 v[44:47], a[76:79], a[108:111], v[44:47]
    ds_read_b128 a[116:119], v25 offset:34816
    buffer_load_dwordx4 v21, s[12:15], s36 offen lds
    v_mfma_f32_16x16x32_bf16 v[48:51], a[80:83], a[104:107], v[48:51]
    ds_read_b128 a[120:123], v25 offset:36864
    s_add_u32 m0, s37, 18432
    v_mfma_f32_16x16x32_bf16 v[52:55], a[80:83], a[108:111], v[52:55]
    ds_read_b128 a[124:127], v25 offset:38912
    buffer_load_dwordx4 v22, s[12:15], s36 offen lds
    v_mfma_f32_16x16x32_bf16 v[56:59], a[84:87], a[104:107], v[56:59]
    ds_read_b128 a[128:131], v25 offset:40960
    s_add_u32 m0, s37, 19456
    v_mfma_f32_16x16x32_bf16 v[60:63], a[84:87], a[108:111], v[60:63]
    ds_read_b128 a[132:135], v25 offset:43008
    buffer_load_dwordx4 v23, s[12:15], s36 offen lds
    v_mfma_f32_16x16x32_bf16 v[64:67], a[88:91], a[104:107], v[64:67]
    ds_read_b128 a[136:139], v25 offset:45056
    s_add_u32 s36, s36, 128
    v_mfma_f32_16x16x32_bf16 v[68:71], a[88:91], a[108:111], v[68:71]
    ds_read_b128 a[140:143], v25 offset:47104
    v_mfma_f32_16x16x32_bf16 v[72:75], a[92:95], a[104:107], v[72:75]
    v_mfma_f32_16x16x32_bf16 v[76:79], a[92:95], a[108:111], v[76:79]
    v_mfma_f32_16x16x32_bf16 v[80:83], a[96:99], a[104:107], v[80:83]
    v_mfma_f32_16x16x32_bf16 v[84:87], a[96:99], a[108:111], v[84:87]
    v_mfma_f32_16x16x32_bf16 v[88:91], a[100:103], a[104:107], v[88:91]
    v_mfma_f32_16x16x32_bf16 v[92:95], a[100:103], a[108:111], v[92:95]
    s_waitcnt vmcnt(17) lgkmcnt(0)
    s_barrier
    v_mfma_f32_16x16x32_bf16 v[32:35], a[112:115], a[144:147], v[32:35]
    ds_read_b128 a[104:107], v30 offset:0
    s_add_u32 m0, s37, 32768
    v_mfma_f32_16x16x32_bf16 v[36:39], a[112:115], a[148:151], v[36:39]
    ds_read_b128 a[108:111], v30 offset:8192
    buffer_load_dwordx4 v16, s[8:11], s36 offen lds
    v_mfma_f32_16x16x32_bf16 v[40:43], a[116:119], a[144:147], v[40:43]
    ds_read_b128 a[72:75], v28 offset:0
    s_add_u32 m0, s37, 33792
    v_mfma_f32_16x16x32_bf16 v[44:47], a[116:119], a[148:151], v[44:47]
    ds_read_b128 a[76:79], v28 offset:2048
    buffer_load_dwordx4 v17, s[8:11], s36 offen lds
    v_mfma_f32_16x16x32_bf16 v[48:51], a[120:123], a[144:147], v[48:51]
    ds_read_b128 a[80:83], v28 offset:4096
    s_add_u32 m0, s37, 34816
    v_mfma_f32_16x16x32_bf16 v[52:55], a[120:123], a[148:151], v[52:55]
    ds_read_b128 a[84:87], v28 offset:6144
    buffer_load_dwordx4 v18, s[8:11], s36 offen lds
    v_mfma_f32_16x16x32_bf16 v[56:59], a[124:127], a[144:147], v[56:59]
    ds_read_b128 a[88:91], v28 offset:8192
    s_add_u32 m0, s37, 35840
    v_mfma_f32_16x16x32_bf16 v[60:63], a[124:127], a[148:151], v[60:63]
    ds_read_b128 a[92:95], v28 offset:10240
    buffer_load_dwordx4 v19, s[8:11], s36 offen lds
    v_mfma_f32_16x16x32_bf16 v[64:67], a[128:131], a[144:147], v[64:67]
    ds_read_b128 a[96:99], v28 offset:12288
    v_mfma_f32_16x16x32_bf16 v[68:71], a[128:131], a[148:151], v[68:71]
    ds_read_b128 a[100:103], v28 offset:14336
    v_mfma_f32_16x16x32_bf16 v[72:75], a[132:135], a[144:147], v[72:75]
    v_mfma_f32_16x16x32_bf16 v[76:79], a[132:135], a[148:151], v[76:79]
    v_mfma_f32_16x16x32_bf16 v[80:83], a[136:139], a[144:147], v[80:83]
    v_mfma_f32_16x16x32_bf16 v[84:87], a[136:139], a[148:151], v[84:87]
    v_mfma_f32_16x16x32_bf16 v[88:91], a[140:143], a[144:147], v[88:91]
    v_mfma_f32_16x16x32_bf16 v[92:95], a[140:143], a[148:151], v[92:95]
    s_waitcnt lgkmcnt(0)
    s_nop 0
    v_mfma_f32_16x16x32_bf16 v[32:35], a[72:75], a[104:107], v[32:35]
    ds_read_b128 a[144:147], v31 offset:0
    s_add_u32 m0, s37, 49152
    v_mfma_f32_16x16x32_bf16 v[36:39], a[72:75], a[108:111], v[36:39]
    ds_read_b128 a[148:151], v31 offset:8192
    buffer_load_dwordx4 v20, s[12:15], s36 offen lds
    v_mfma_f32_16x16x32_bf16 v[40:43], a[76:79], a[104:107], v[40:43]
    ds_read_b128 a[112:115], v29 offset:0
    s_add_u32 m0, s37, 50176
    v_mfma_f32_16x16x32_bf16 v[44:47], a[76:79], a[108:111], v[44:47]
    ds_read_b128 a[116:119], v29 offset:2048
    buffer_load_dwordx4 v21, s[12:15], s36 offen lds
    v_mfma_f32_16x16x32_bf16 v[48:51], a[80:83], a[104:107], v[48:51]
    ds_read_b128 a[120:123], v29 offset:4096
    s_add_u32 m0, s37, 51200
    v_mfma_f32_16x16x32_bf16 v[52:55], a[80:83], a[108:111], v[52:55]
    ds_read_b128 a[124:127], v29 offset:6144
    buffer_load_dwordx4 v22, s[12:15], s36 offen lds
    v_mfma_f32_16x16x32_bf16 v[56:59], a[84:87], a[104:107], v[56:59]
    ds_read_b128 a[128:131], v29 offset:8192
    s_add_u32 m0, s37, 52224
    v_mfma_f32_16x16x32_bf16 v[60:63], a[84:87], a[108:111], v[60:63]
    ds_read_b128 a[132:135], v29 offset:10240
    buffer_load_dwordx4 v23, s[12:15], s36 offen lds
    v_mfma_f32_16x16x32_bf16 v[64:67], a[88:91], a[104:107], v[64:67]
    ds_read_b128 a[136:139], v29 offset:12288
    s_add_u32 s36, s36, 128
    v_mfma_f32_16x16x32_bf16 v[68:71], a[88:91], a[108:111], v[68:71]
    ds_read_b128 a[140:143], v29 offset:14336
    v_mfma_f32_16x16x32_bf16 v[72:75], a[92:95], a[104:107], v[72:75]
    v_mfma_f32_16x16x32_bf16 v[76:79], a[92:95], a[108:111], v[76:79]
    v_mfma_f32_16x16x32_bf16 v[80:83], a[96:99], a[104:107], v[80:83]
    v_mfma_f32_16x16x32_bf16 v[84:87], a[96:99], a[108:111], v[84:87]
    v_mfma_f32_16x16x32_bf16 v[88:91], a[100:103], a[104:107], v[88:91]
    v_mfma_f32_16x16x32_bf16 v[92:95], a[100:103], a[108:111], v[92:95]
    s_waitcnt vmcnt(16) lgkmcnt(0)
    s_barrier
    v_mfma_f32_16x16x32_bf16 v[32:35], a[112:115], a[144:147], v[32:35]
    ds_read_b128 a[104:107], v30 offset:32768
    s_add_u32 m0, s37, 65536
    v_mfma_f32_16x16x32_bf16 v[36:39], a[112:115], a[148:151], v[36:39]
    ds_read_b128 a[108:111], v30 offset:40960
    buffer_load_dwordx4 v16, s[8:11], s36 offen lds
    v_mfma_f32_16x16x32_bf16 v[40:43], a[116:119], a[144:147], v[40:43]
    ds_read_b128 a[72:75], v28 offset:32768
    s_add_u32 m0, s37, 66560
    v_mfma_f32_16x16x32_bf16 v[44:47], a[116:119], a[148:151], v[44:47]
    ds_read_b128 a[76:79], v28 offset:34816
    buffer_load_dwordx4 v17, s[8:11], s36 offen lds
    v_mfma_f32_16x16x32_bf16 v[48:51], a[120:123], a[144:147], v[48:51]
    ds_read_b128 a[80:83], v28 offset:36864
    s_add_u32 m0, s37, 67584
    v_mfma_f32_16x16x32_bf16 v[52:55], a[120:123], a[148:151], v[52:55]
    ds_read_b128 a[84:87], v28 offset:38912
    buffer_load_dwordx4 v18, s[8:11], s36 offen lds
    v_mfma_f32_16x16x32_bf16 v[56:59], a[124:127], a[144:147], v[56:59]
    ds_read_b128 a[88:91], v28 offset:40960
    s_add_u32 m0, s37, 68608
    v_mfma_f32_16x16x32_bf16 v[60:63], a[124:127], a[148:151], v[60:63]
    ds_read_b128 a[92:95], v28 offset:43008
    buffer_load_dwordx4 v19, s[8:11], s36 offen lds
    v_mfma_f32_16x16x32_bf16 v[64:67], a[128:131], a[144:147], v[64:67]
    ds_read_b128 a[96:99], v28 offset:45056
    v_mfma_f32_16x16x32_bf16 v[68:71], a[128:131], a[148:151], v[68:71]
    ds_read_b128 a[100:103], v28 offset:47104
    v_mfma_f32_16x16x32_bf16 v[72:75], a[132:135], a[144:147], v[72:75]
    v_mfma_f32_16x16x32_bf16 v[76:79], a[132:135], a[148:151], v[76:79]
    v_mfma_f32_16x16x32_bf16 v[80:83], a[136:139], a[144:147], v[80:83]
    v_mfma_f32_16x16x32_bf16 v[84:87], a[136:139], a[148:151], v[84:87]
    v_mfma_f32_16x16x32_bf16 v[88:91], a[140:143], a[144:147], v[88:91]
    v_mfma_f32_16x16x32_bf16 v[92:95], a[140:143], a[148:151], v[92:95]
    s_waitcnt lgkmcnt(0)
    s_nop 0
    v_mfma_f32_16x16x32_bf16 v[32:35], a[72:75], a[104:107], v[32:35]
    ds_read_b128 a[144:147], v31 offset:32768
    s_add_u32 m0, s37, 81920
    v_mfma_f32_16x16x32_bf16 v[36:39], a[72:75], a[108:111], v[36:39]
    ds_read_b128 a[148:151], v31 offset:40960
    buffer_load_dwordx4 v20, s[12:15], s36 offen lds
    v_mfma_f32_16x16x32_bf16 v[40:43], a[76:79], a[104:107], v[40:43]
    ds_read_b128 a[112:115], v29 offset:32768
    s_add_u32 m0, s37, 82944
    v_mfma_f32_16x16x32_bf16 v[44:47], a[76:79], a[108:111], v[44:47]
    ds_read_b128 a[116:119], v29 offset:34816
    buffer_load_dwordx4 v21, s[12:15], s36 offen lds
    v_mfma_f32_16x16x32_bf16 v[48:51], a[80:83], a[104:107], v[48:51]
    ds_read_b128 a[120:123], v29 offset:36864
    s_add_u32 m0, s37, 83968
    v_mfma_f32_16x16x32_bf16 v[52:55], a[80:83], a[108:111], v[52:55]
    ds_read_b128 a[124:127], v29 offset:38912
    buffer_load_dwordx4 v22, s[12:15], s36 offen lds
    v_mfma_f32_16x16x32_bf16 v[56:59], a[84:87], a[104:107], v[56:59]
    ds_read_b128 a[128:131], v29 offset:40960
    s_add_u32 m0, s37, 84992
    v_mfma_f32_16x16x32_bf16 v[60:63], a[84:87], a[108:111], v[60:63]
    ds_read_b128 a[132:135], v29 offset:43008
    buffer_load_dwordx4 v23, s[12:15], s36 offen lds
    v_mfma_f32_16x16x32_bf16 v[64:67], a[88:91], a[104:107], v[64:67]
    ds_read_b128 a[136:139], v29 offset:45056
    s_add_u32 s36, s36, 128
    v_mfma_f32_16x16x32_bf16 v[68:71], a[88:91], a[108:111], v[68:71]
    ds_read_b128 a[140:143], v29 offset:47104
    v_mfma_f32_16x16x32_bf16 v[72:75], a[92:95], a[104:107], v[72:75]
    v_mfma_f32_16x16x32_bf16 v[76:79], a[92:95], a[108:111], v[76:79]
    v_mfma_f32_16x16x32_bf16 v[80:83], a[96:99], a[104:107], v[80:83]
    v_mfma_f32_16x16x32_bf16 v[84:87], a[96:99], a[108:111], v[84:87]
    v_mfma_f32_16x16x32_bf16 v[88:91], a[100:103], a[104:107], v[88:91]
    v_mfma_f32_16x16x32_bf16 v[92:95], a[100:103], a[108:111], v[92:95]
    s_waitcnt vmcnt(16) lgkmcnt(0)
    s_barrier
    v_mfma_f32_16x16x32_bf16 v[32:35], a[112:115], a[144:147], v[32:35]
    ds_read_b128 a[104:107], v26 offset:0
    s_add_u32 m0, s37, 98304
    v_mfma_f32_16x16x32_bf16 v[36:39], a[112:115], a[148:151], v[36:39]
    ds_read_b128 a[108:111], v26 offset:8192
    buffer_load_dwordx4 v16, s[8:11], s36 offen lds
    v_mfma_f32_16x16x32_bf16 v[40:43], a[116:119], a[144:147], v[40:43]
    ds_read_b128 a[72:75], v24 offset:0
    s_add_u32 m0, s37, 99328
    v_mfma_f32_16x16x32_bf16 v[44:47], a[116:119], a[148:151], v[44:47]
    ds_read_b128 a[76:79], v24 offset:2048
    buffer_load_dwordx4 v17, s[8:11], s36 offen lds
    v_mfma_f32_16x16x32_bf16 v[48:51], a[120:123], a[144:147], v[48:51]
    ds_read_b128 a[80:83], v24 offset:4096
    s_add_u32 m0, s37, 100352
    v_mfma_f32_16x16x32_bf16 v[52:55], a[120:123], a[148:151], v[52:55]
    ds_read_b128 a[84:87], v24 offset:6144
    buffer_load_dwordx4 v18, s[8:11], s36 offen lds
    v_mfma_f32_16x16x32_bf16 v[56:59], a[124:127], a[144:147], v[56:59]
    ds_read_b128 a[88:91], v24 offset:8192
    s_add_u32 m0, s37, 101376
    v_mfma_f32_16x16x32_bf16 v[60:63], a[124:127], a[148:151], v[60:63]
    ds_read_b128 a[92:95], v24 offset:10240
    buffer_load_dwordx4 v19, s[8:11], s36 offen lds
    v_mfma_f32_16x16x32_bf16 v[64:67], a[128:131], a[144:147], v[64:67]
    ds_read_b128 a[96:99], v24 offset:12288
    v_mfma_f32_16x16x32_bf16 v[68:71], a[128:131], a[148:151], v[68:71]
    ds_read_b128 a[100:103], v24 offset:14336
    v_mfma_f32_16x16x32_bf16 v[72:75], a[132:135], a[144:147], v[72:75]
    v_mfma_f32_16x16x32_bf16 v[76:79], a[132:135], a[148:151], v[76:79]
    v_mfma_f32_16x16x32_bf16 v[80:83], a[136:139], a[144:147], v[80:83]
    v_mfma_f32_16x16x32_bf16 v[84:87], a[136:139], a[148:151], v[84:87]
    v_mfma_f32_16x16x32_bf16 v[88:91], a[140:143], a[144:147], v[88:91]
    v_mfma_f32_16x16x32_bf16 v[92:95], a[140:143], a[148:151], v[92:95]
    s_waitcnt lgkmcnt(0)
    s_nop 0
    v_mfma_f32_16x16x32_bf16 v[32:35], a[72:75], a[104:107], v[32:35]
    ds_read_b128 a[144:147], v27 offset:0
    s_add_u32 m0, s37, 114688
    v_mfma_f32_16x16x32_bf16 v[36:39], a[72:75], a[108:111], v[36:39]
    ds_read_b128 a[148:151], v27 offset:8192
    buffer_load_dwordx4 v20, s[12:15], s36 offen lds
    v_mfma_f32_16x16x32_bf16 v[40:43], a[76:79], a[104:107], v[40:43]
    ds_read_b128 a[112:115], v25 offset:0
    s_add_u32 m0, s37, 115712
    v_mfma_f32_16x16x32_bf16 v[44:47], a[76:79], a[108:111], v[44:47]
    ds_read_b128 a[116:119], v25 offset:2048
    buffer_load_dwordx4 v21, s[12:15], s36 offen lds
    v_mfma_f32_16x16x32_bf16 v[48:51], a[80:83], a[104:107], v[48:51]
    ds_read_b128 a[120:123], v25 offset:4096
    s_add_u32 m0, s37, 116736
    v_mfma_f32_16x16x32_bf16 v[52:55], a[80:83], a[108:111], v[52:55]
    ds_read_b128 a[124:127], v25 offset:6144
    buffer_load_dwordx4 v22, s[12:15], s36 offen lds
    v_mfma_f32_16x16x32_bf16 v[56:59], a[84:87], a[104:107], v[56:59]
    ds_read_b128 a[128:131], v25 offset:8192
    s_add_u32 m0, s37, 117760
    v_mfma_f32_16x16x32_bf16 v[60:63], a[84:87], a[108:111], v[60:63]
    ds_read_b128 a[132:135], v25 offset:10240
    buffer_load_dwordx4 v23, s[12:15], s36 offen lds
    v_mfma_f32_16x16x32_bf16 v[64:67], a[88:91], a[104:107], v[64:67]
    ds_read_b128 a[136:139], v25 offset:12288
    s_add_u32 s36, s36, 128
    v_mfma_f32_16x16x32_bf16 v[68:71], a[88:91], a[108:111], v[68:71]
    ds_read_b128 a[140:143], v25 offset:14336
    v_mfma_f32_16x16x32_bf16 v[72:75], a[92:95], a[104:107], v[72:75]
    v_mfma_f32_16x16x32_bf16 v[76:79], a[92:95], a[108:111], v[76:79]
    v_mfma_f32_16x16x32_bf16 v[80:83], a[96:99], a[104:107], v[80:83]
    v_mfma_f32_16x16x32_bf16 v[84:87], a[96:99], a[108:111], v[84:87]
    v_mfma_f32_16x16x32_bf16 v[88:91], a[100:103], a[104:107], v[88:91]
    v_mfma_f32_16x16x32_bf16 v[92:95], a[100:103], a[108:111], v[92:95]
    s_waitcnt vmcnt(16) lgkmcnt(0)
    s_barrier
    v_mfma_f32_16x16x32_bf16 v[32:35], a[112:115], a[144:147], v[32:35]
    ds_read_b128 a[104:107], v26 offset:32768
    s_add_u32 m0, s37, 0
    s_nop 0
    v_mfma_f32_16x16x32_bf16 v[36:39], a[112:115], a[148:151], v[36:39]
    ds_read_b128 a[108:111], v26 offset:40960
    buffer_load_dwordx4 v16, s[8:11], s36 offen lds
    v_mfma_f32_16x16x32_bf16 v[40:43], a[116:119], a[144:147], v[40:43]
    ds_read_b128 a[72:75], v24 offset:32768
    s_add_u32 m0, s37, 1024
    v_mfma_f32_16x16x32_bf16 v[44:47], a[116:119], a[148:151], v[44:47]
    ds_read_b128 a[76:79], v24 offset:34816
    buffer_load_dwordx4 v17, s[8:11], s36 offen lds
    v_mfma_f32_16x16x32_bf16 v[48:51], a[120:123], a[144:147], v[48:51]
    ds_read_b128 a[80:83], v24 offset:36864
    s_add_u32 m0, s37, 2048
    v_mfma_f32_16x16x32_bf16 v[52:55], a[120:123], a[148:151], v[52:55]
    ds_read_b128 a[84:87], v24 offset:38912
    buffer_load_dwordx4 v18, s[8:11], s36 offen lds
    v_mfma_f32_16x16x32_bf16 v[56:59], a[124:127], a[144:147], v[56:59]
    ds_read_b128 a[88:91], v24 offset:40960
    s_add_u32 m0, s37, 3072
    v_mfma_f32_16x16x32_bf16 v[60:63], a[124:127], a[148:151], v[60:63]
    ds_read_b128 a[92:95], v24 offset:43008
    buffer_load_dwordx4 v19, s[8:11], s36 offen lds
    v_mfma_f32_16x16x32_bf16 v[64:67], a[128:131], a[144:147], v[64:67]
    ds_read_b128 a[96:99], v24 offset:45056
    v_mfma_f32_16x16x32_bf16 v[68:71], a[128:131], a[148:151], v[68:71]
    ds_read_b128 a[100:103], v24 offset:47104
    v_mfma_f32_16x16x32_bf16 v[72:75], a[132:135], a[144:147], v[72:75]
    v_mfma_f32_16x16x32_bf16 v[76:79], a[132:135], a[148:151], v[76:79]
    v_mfma_f32_16x16x32_bf16 v[80:83], a[136:139], a[144:147], v[80:83]
    v_mfma_f32_16x16x32_bf16 v[84:87], a[136:139], a[148:151], v[84:87]
    v_mfma_f32_16x16x32_bf16 v[88:91], a[140:143], a[144:147], v[88:91]
    v_mfma_f32_16x16x32_bf16 v[92:95], a[140:143], a[148:151], v[92:95]
    s_waitcnt lgkmcnt(0)
    s_nop 0
    v_mfma_f32_16x16x32_bf16 v[32:35], a[72:75], a[104:107], v[32:35]
    ds_read_b128 a[144:147], v27 offset:32768
    s_add_u32 m0, s37, 16384
    v_mfma_f32_16x16x32_bf16 v[36:39], a[72:75], a[108:111], v[36:39]
    ds_read_b128 a[148:151], v27 offset:40960
    buffer_load_dwordx4 v20, s[12:15], s36 offen lds
    v_mfma_f32_16x16x32_bf16 v[40:43], a[76:79], a[104:107], v[40:43]
    ds_read_b128 a[112:115], v25 offset:32768
    s_add_u32 m0, s37, 17408
    v_mfma_f32_16x16x32_bf16 v[44:47], a[76:79], a[108:111], v[44:47]
    ds_read_b128 a[116:119], v25 offset:34816
    buffer_load_dwordx4 v21, s[12:15], s36 offen lds
    v_mfma_f32_16x16x32_bf16 v[48:51], a[80:83], a[104:107], v[48:51]
    ds_read_b128 a[120:123], v25 offset:36864
    s_add_u32 m0, s37, 18432
    v_mfma_f32_16x16x32_bf16 v[52:55], a[80:83], a[108:111], v[52:55]
    ds_read_b128 a[124:127], v25 offset:38912
    buffer_load_dwordx4 v22, s[12:15], s36 offen lds
    v_mfma_f32_16x16x32_bf16 v[56:59], a[84:87], a[104:107], v[56:59]
    ds_read_b128 a[128:131], v25 offset:40960
    s_add_u32 m0, s37, 19456
    v_mfma_f32_16x16x32_bf16 v[60:63], a[84:87], a[108:111], v[60:63]
    ds_read_b128 a[132:135], v25 offset:43008
    buffer_load_dwordx4 v23, s[12:15], s36 offen lds
    v_mfma_f32_16x16x32_bf16 v[64:67], a[88:91], a[104:107], v[64:67]
    ds_read_b128 a[136:139], v25 offset:45056
    s_add_u32 s36, s36, 128
    v_mfma_f32_16x16x32_bf16 v[68:71], a[88:91], a[108:111], v[68:71]
    ds_read_b128 a[140:143], v25 offset:47104
    v_mfma_f32_16x16x32_bf16 v[72:75], a[92:95], a[104:107], v[72:75]
    v_mfma_f32_16x16x32_bf16 v[76:79], a[92:95], a[108:111], v[76:79]
    v_mfma_f32_16x16x32_bf16 v[80:83], a[96:99], a[104:107], v[80:83]
    v_mfma_f32_16x16x32_bf16 v[84:87], a[96:99], a[108:111], v[84:87]
    v_mfma_f32_16x16x32_bf16 v[88:91], a[100:103], a[104:107], v[88:91]
    v_mfma_f32_16x16x32_bf16 v[92:95], a[100:103], a[108:111], v[92:95]
    s_waitcnt vmcnt(16) lgkmcnt(0)
    s_barrier
    v_mfma_f32_16x16x32_bf16 v[32:35], a[112:115], a[144:147], v[32:35]
    ds_read_b128 a[104:107], v30 offset:0
    s_add_u32 m0, s37, 32768
    v_mfma_f32_16x16x32_bf16 v[36:39], a[112:115], a[148:151], v[36:39]
    ds_read_b128 a[108:111], v30 offset:8192
    buffer_load_dwordx4 v16, s[8:11], s36 offen lds
    v_mfma_f32_16x16x32_bf16 v[40:43], a[116:119], a[144:147], v[40:43]
    ds_read_b128 a[72:75], v28 offset:0
    s_add_u32 m0, s37, 33792
    v_mfma_f32_16x16x32_bf16 v[44:47], a[116:119], a[148:151], v[44:47]
    ds_read_b128 a[76:79], v28 offset:2048
    buffer_load_dwordx4 v17, s[8:11], s36 offen lds
    v_mfma_f32_16x16x32_bf16 v[48:51], a[120:123], a[144:147], v[48:51]
    ds_read_b128 a[80:83], v28 offset:4096
    s_add_u32 m0, s37, 34816
    v_mfma_f32_16x16x32_bf16 v[52:55], a[120:123], a[148:151], v[52:55]
    ds_read_b128 a[84:87], v28 offset:6144
    buffer_load_dwordx4 v18, s[8:11], s36 offen lds
    v_mfma_f32_16x16x32_bf16 v[56:59], a[124:127], a[144:147], v[56:59]
    ds_read_b128 a[88:91], v28 offset:8192
    s_add_u32 m0, s37, 35840
    v_mfma_f32_16x16x32_bf16 v[60:63], a[124:127], a[148:151], v[60:63]
    ds_read_b128 a[92:95], v28 offset:10240
    buffer_load_dwordx4 v19, s[8:11], s36 offen lds
    v_mfma_f32_16x16x32_bf16 v[64:67], a[128:131], a[144:147], v[64:67]
    ds_read_b128 a[96:99], v28 offset:12288
    v_mfma_f32_16x16x32_bf16 v[68:71], a[128:131], a[148:151], v[68:71]
    ds_read_b128 a[100:103], v28 offset:14336
    v_mfma_f32_16x16x32_bf16 v[72:75], a[132:135], a[144:147], v[72:75]
    v_mfma_f32_16x16x32_bf16 v[76:79], a[132:135], a[148:151], v[76:79]
    v_mfma_f32_16x16x32_bf16 v[80:83], a[136:139], a[144:147], v[80:83]
    v_mfma_f32_16x16x32_bf16 v[84:87], a[136:139], a[148:151], v[84:87]
    v_mfma_f32_16x16x32_bf16 v[88:91], a[140:143], a[144:147], v[88:91]
    v_mfma_f32_16x16x32_bf16 v[92:95], a[140:143], a[148:151], v[92:95]
    s_waitcnt lgkmcnt(0)
    s_nop 0
    v_mfma_f32_16x16x32_bf16 v[32:35], a[72:75], a[104:107], v[32:35]
    ds_read_b128 a[144:147], v31 offset:0
    s_add_u32 m0, s37, 49152
    v_mfma_f32_16x16x32_bf16 v[36:39], a[72:75], a[108:111], v[36:39]
    ds_read_b128 a[148:151], v31 offset:8192
    buffer_load_dwordx4 v20, s[12:15], s36 offen lds
    v_mfma_f32_16x16x32_bf16 v[40:43], a[76:79], a[104:107], v[40:43]
    ds_read_b128 a[112:115], v29 offset:0
    s_add_u32 m0, s37, 50176
    v_mfma_f32_16x16x32_bf16 v[44:47], a[76:79], a[108:111], v[44:47]
    ds_read_b128 a[116:119], v29 offset:2048
    buffer_load_dwordx4 v21, s[12:15], s36 offen lds
    v_mfma_f32_16x16x32_bf16 v[48:51], a[80:83], a[104:107], v[48:51]
    ds_read_b128 a[120:123], v29 offset:4096
    s_add_u32 m0, s37, 51200
    v_mfma_f32_16x16x32_bf16 v[52:55], a[80:83], a[108:111], v[52:55]
    ds_read_b128 a[124:127], v29 offset:6144
    buffer_load_dwordx4 v22, s[12:15], s36 offen lds
    v_mfma_f32_16x16x32_bf16 v[56:59], a[84:87], a[104:107], v[56:59]
    ds_read_b128 a[128:131], v29 offset:8192
    s_add_u32 m0, s37, 52224
    v_mfma_f32_16x16x32_bf16 v[60:63], a[84:87], a[108:111], v[60:63]
    ds_read_b128 a[132:135], v29 offset:10240
    buffer_load_dwordx4 v23, s[12:15], s36 offen lds
    v_mfma_f32_16x16x32_bf16 v[64:67], a[88:91], a[104:107], v[64:67]
    ds_read_b128 a[136:139], v29 offset:12288
    s_add_u32 s36, s36, 128
    v_mfma_f32_16x16x32_bf16 v[68:71], a[88:91], a[108:111], v[68:71]
    ds_read_b128 a[140:143], v29 offset:14336
    v_mfma_f32_16x16x32_bf16 v[72:75], a[92:95], a[104:107], v[72:75]
    v_mfma_f32_16x16x32_bf16 v[76:79], a[92:95], a[108:111], v[76:79]
    v_mfma_f32_16x16x32_bf16 v[80:83], a[96:99], a[104:107], v[80:83]
    v_mfma_f32_16x16x32_bf16 v[84:87], a[96:99], a[108:111], v[84:87]
    v_mfma_f32_16x16x32_bf16 v[88:91], a[100:103], a[104:107], v[88:91]
    v_mfma_f32_16x16x32_bf16 v[92:95], a[100:103], a[108:111], v[92:95]
    s_waitcnt vmcnt(16) lgkmcnt(0)
    s_barrier
    v_mfma_f32_16x16x32_bf16 v[32:35], a[112:115], a[144:147], v[32:35]
    ds_read_b128 a[104:107], v30 offset:32768
    s_mov_b32 s38, 28590080
    v_mfma_f32_16x16x32_bf16 v[36:39], a[112:115], a[148:151], v[36:39]
    ds_read_b128 a[108:111], v30 offset:40960
    buffer_load_dwordx4 v[216:219], v3, s[24:27], s38 offen sc1
    v_mfma_f32_16x16x32_bf16 v[40:43], a[116:119], a[144:147], v[40:43]
    ds_read_b128 a[72:75], v28 offset:32768
    s_add_u32 m0, s37, 65536
    v_mfma_f32_16x16x32_bf16 v[44:47], a[116:119], a[148:151], v[44:47]
    ds_read_b128 a[76:79], v28 offset:34816
    buffer_load_dwordx4 v16, s[8:11], s36 offen lds
    v_mfma_f32_16x16x32_bf16 v[48:51], a[120:123], a[144:147], v[48:51]
    ds_read_b128 a[80:83], v28 offset:36864
    s_add_u32 m0, s37, 66560
    v_mfma_f32_16x16x32_bf16 v[52:55], a[120:123], a[148:151], v[52:55]
    ds_read_b128 a[84:87], v28 offset:38912
    buffer_load_dwordx4 v17, s[8:11], s36 offen lds
    v_mfma_f32_16x16x32_bf16 v[56:59], a[124:127], a[144:147], v[56:59]
    ds_read_b128 a[88:91], v28 offset:40960
    s_add_u32 m0, s37, 67584
    v_mfma_f32_16x16x32_bf16 v[60:63], a[124:127], a[148:151], v[60:63]
    ds_read_b128 a[92:95], v28 offset:43008
    buffer_load_dwordx4 v18, s[8:11], s36 offen lds
    v_mfma_f32_16x16x32_bf16 v[64:67], a[128:131], a[144:147], v[64:67]
    ds_read_b128 a[96:99], v28 offset:45056
    s_add_u32 m0, s37, 68608
    v_mfma_f32_16x16x32_bf16 v[68:71], a[128:131], a[148:151], v[68:71]
    ds_read_b128 a[100:103], v28 offset:47104
    buffer_load_dwordx4 v19, s[8:11], s36 offen lds
    v_mfma_f32_16x16x32_bf16 v[72:75], a[132:135], a[144:147], v[72:75]
    v_mfma_f32_16x16x32_bf16 v[76:79], a[132:135], a[148:151], v[76:79]
    v_mfma_f32_16x16x32_bf16 v[80:83], a[136:139], a[144:147], v[80:83]
    v_mfma_f32_16x16x32_bf16 v[84:87], a[136:139], a[148:151], v[84:87]
    v_mfma_f32_16x16x32_bf16 v[88:91], a[140:143], a[144:147], v[88:91]
    v_mfma_f32_16x16x32_bf16 v[92:95], a[140:143], a[148:151], v[92:95]
    s_waitcnt lgkmcnt(0)
    s_nop 0
    v_mfma_f32_16x16x32_bf16 v[32:35], a[72:75], a[104:107], v[32:35]
    ds_read_b128 a[144:147], v31 offset:32768
    s_add_u32 m0, s37, 81920
    v_mfma_f32_16x16x32_bf16 v[36:39], a[72:75], a[108:111], v[36:39]
    ds_read_b128 a[148:151], v31 offset:40960
    buffer_load_dwordx4 v20, s[12:15], s36 offen lds
    v_mfma_f32_16x16x32_bf16 v[40:43], a[76:79], a[104:107], v[40:43]
    ds_read_b128 a[112:115], v29 offset:32768
    s_add_u32 m0, s37, 82944
    v_mfma_f32_16x16x32_bf16 v[44:47], a[76:79], a[108:111], v[44:47]
    ds_read_b128 a[116:119], v29 offset:34816
    buffer_load_dwordx4 v21, s[12:15], s36 offen lds
    v_mfma_f32_16x16x32_bf16 v[48:51], a[80:83], a[104:107], v[48:51]
    ds_read_b128 a[120:123], v29 offset:36864
    s_add_u32 m0, s37, 83968
    v_mfma_f32_16x16x32_bf16 v[52:55], a[80:83], a[108:111], v[52:55]
    ds_read_b128 a[124:127], v29 offset:38912
    buffer_load_dwordx4 v22, s[12:15], s36 offen lds
    v_mfma_f32_16x16x32_bf16 v[56:59], a[84:87], a[104:107], v[56:59]
    ds_read_b128 a[128:131], v29 offset:40960
    s_add_u32 m0, s37, 84992
    v_mfma_f32_16x16x32_bf16 v[60:63], a[84:87], a[108:111], v[60:63]
    ds_read_b128 a[132:135], v29 offset:43008
    buffer_load_dwordx4 v23, s[12:15], s36 offen lds
    v_mfma_f32_16x16x32_bf16 v[64:67], a[88:91], a[104:107], v[64:67]
    ds_read_b128 a[136:139], v29 offset:45056
    s_add_u32 s36, s36, 128
    v_mfma_f32_16x16x32_bf16 v[68:71], a[88:91], a[108:111], v[68:71]
    ds_read_b128 a[140:143], v29 offset:47104
    v_mfma_f32_16x16x32_bf16 v[72:75], a[92:95], a[104:107], v[72:75]
    v_mfma_f32_16x16x32_bf16 v[76:79], a[92:95], a[108:111], v[76:79]
    v_mfma_f32_16x16x32_bf16 v[80:83], a[96:99], a[104:107], v[80:83]
    v_mfma_f32_16x16x32_bf16 v[84:87], a[96:99], a[108:111], v[84:87]
    v_mfma_f32_16x16x32_bf16 v[88:91], a[100:103], a[104:107], v[88:91]
    v_mfma_f32_16x16x32_bf16 v[92:95], a[100:103], a[108:111], v[92:95]
    s_waitcnt vmcnt(17) lgkmcnt(0)
    s_barrier
    v_mfma_f32_16x16x32_bf16 v[32:35], a[112:115], a[144:147], v[32:35]
    ds_read_b128 a[104:107], v26 offset:0
    s_add_u32 m0, s37, 98304
    v_mfma_f32_16x16x32_bf16 v[36:39], a[112:115], a[148:151], v[36:39]
    ds_read_b128 a[108:111], v26 offset:8192
    buffer_load_dwordx4 v16, s[8:11], s36 offen lds
    v_mfma_f32_16x16x32_bf16 v[40:43], a[116:119], a[144:147], v[40:43]
    ds_read_b128 a[72:75], v24 offset:0
    s_add_u32 m0, s37, 99328
    v_mfma_f32_16x16x32_bf16 v[44:47], a[116:119], a[148:151], v[44:47]
    ds_read_b128 a[76:79], v24 offset:2048
    buffer_load_dwordx4 v17, s[8:11], s36 offen lds
    v_mfma_f32_16x16x32_bf16 v[48:51], a[120:123], a[144:147], v[48:51]
    ds_read_b128 a[80:83], v24 offset:4096
    s_add_u32 m0, s37, 100352
    v_mfma_f32_16x16x32_bf16 v[52:55], a[120:123], a[148:151], v[52:55]
    ds_read_b128 a[84:87], v24 offset:6144
    buffer_load_dwordx4 v18, s[8:11], s36 offen lds
    v_mfma_f32_16x16x32_bf16 v[56:59], a[124:127], a[144:147], v[56:59]
    ds_read_b128 a[88:91], v24 offset:8192
    s_add_u32 m0, s37, 101376
    v_mfma_f32_16x16x32_bf16 v[60:63], a[124:127], a[148:151], v[60:63]
    ds_read_b128 a[92:95], v24 offset:10240
    buffer_load_dwordx4 v19, s[8:11], s36 offen lds
    v_mfma_f32_16x16x32_bf16 v[64:67], a[128:131], a[144:147], v[64:67]
    ds_read_b128 a[96:99], v24 offset:12288
    v_mfma_f32_16x16x32_bf16 v[68:71], a[128:131], a[148:151], v[68:71]
    ds_read_b128 a[100:103], v24 offset:14336
    v_mfma_f32_16x16x32_bf16 v[72:75], a[132:135], a[144:147], v[72:75]
    v_mfma_f32_16x16x32_bf16 v[76:79], a[132:135], a[148:151], v[76:79]
    v_mfma_f32_16x16x32_bf16 v[80:83], a[136:139], a[144:147], v[80:83]
    v_mfma_f32_16x16x32_bf16 v[84:87], a[136:139], a[148:151], v[84:87]
    v_mfma_f32_16x16x32_bf16 v[88:91], a[140:143], a[144:147], v[88:91]
    v_mfma_f32_16x16x32_bf16 v[92:95], a[140:143], a[148:151], v[92:95]
    s_waitcnt lgkmcnt(0)
    s_nop 0
    v_mfma_f32_16x16x32_bf16 v[32:35], a[72:75], a[104:107], v[32:35]
    ds_read_b128 a[144:147], v27 offset:0
    s_add_u32 m0, s37, 114688
    v_mfma_f32_16x16x32_bf16 v[36:39], a[72:75], a[108:111], v[36:39]
    ds_read_b128 a[148:151], v27 offset:8192
    buffer_load_dwordx4 v20, s[12:15], s36 offen lds
    v_mfma_f32_16x16x32_bf16 v[40:43], a[76:79], a[104:107], v[40:43]
    ds_read_b128 a[112:115], v25 offset:0
    s_add_u32 m0, s37, 115712
    v_mfma_f32_16x16x32_bf16 v[44:47], a[76:79], a[108:111], v[44:47]
    ds_read_b128 a[116:119], v25 offset:2048
    buffer_load_dwordx4 v21, s[12:15], s36 offen lds
    v_mfma_f32_16x16x32_bf16 v[48:51], a[80:83], a[104:107], v[48:51]
    ds_read_b128 a[120:123], v25 offset:4096
    s_add_u32 m0, s37, 116736
    v_mfma_f32_16x16x32_bf16 v[52:55], a[80:83], a[108:111], v[52:55]
    ds_read_b128 a[124:127], v25 offset:6144
    buffer_load_dwordx4 v22, s[12:15], s36 offen lds
    v_mfma_f32_16x16x32_bf16 v[56:59], a[84:87], a[104:107], v[56:59]
    ds_read_b128 a[128:131], v25 offset:8192
    s_add_u32 m0, s37, 117760
    v_mfma_f32_16x16x32_bf16 v[60:63], a[84:87], a[108:111], v[60:63]
    ds_read_b128 a[132:135], v25 offset:10240
    buffer_load_dwordx4 v23, s[12:15], s36 offen lds
    v_mfma_f32_16x16x32_bf16 v[64:67], a[88:91], a[104:107], v[64:67]
    ds_read_b128 a[136:139], v25 offset:12288
    s_add_u32 s36, s36, 128
    v_mfma_f32_16x16x32_bf16 v[68:71], a[88:91], a[108:111], v[68:71]
    ds_read_b128 a[140:143], v25 offset:14336
    v_mfma_f32_16x16x32_bf16 v[72:75], a[92:95], a[104:107], v[72:75]
    v_mfma_f32_16x16x32_bf16 v[76:79], a[92:95], a[108:111], v[76:79]
    v_mfma_f32_16x16x32_bf16 v[80:83], a[96:99], a[104:107], v[80:83]
    v_mfma_f32_16x16x32_bf16 v[84:87], a[96:99], a[108:111], v[84:87]
    v_mfma_f32_16x16x32_bf16 v[88:91], a[100:103], a[104:107], v[88:91]
    v_mfma_f32_16x16x32_bf16 v[92:95], a[100:103], a[108:111], v[92:95]
    s_waitcnt vmcnt(16) lgkmcnt(0)
    s_barrier
    s_mov_b32 s39, 0
K1_POLL1:
    v_xor_b32 v216, s35, v216
    v_xor_b32 v217, s35, v217
    v_xor_b32 v218, s35, v218
    v_xor_b32_e64 v219, s35, v219
    v_or3_b32 v216, v216, v217, v218
    v_or_b32 v216, v216, v219
    v_cmp_ne_u32 vcc, 0, v216
    s_nop 0
    s_cbranch_vccz K1_POLL1_OK
    s_sleep 2
    buffer_load_dwordx4 v[216:219], v3, s[24:27], s38 offen sc1
    s_add_u32 s39, s39, 1
    s_cmp_lt_u32 s39, 200000
    s_waitcnt vmcnt(0)
    s_cbranch_scc1 K1_POLL1
K1_POLL1_OK:
    v_mfma_f32_16x16x32_bf16 v[32:35], a[112:115], a[144:147], v[32:35]
    ds_read_b128 a[104:107], v26 offset:32768
    s_mul_i32 s38, s2, 16384
    v_mfma_f32_16x16x32_bf16 v[36:39], a[112:115], a[148:151], v[36:39]
    ds_read_b128 a[108:111], v26 offset:40960
    s_add_u32 s38, s38, s37
    s_nop 0
    v_mfma_f32_16x16x32_bf16 v[40:43], a[116:119], a[144:147], v[40:43]
    ds_read_b128 a[72:75], v24 offset:32768
    s_add_u32 s39, s38, 5242880
    v_mfma_f32_16x16x32_bf16 v[44:47], a[116:119], a[148:151], v[44:47]
    ds_read_b128 a[76:79], v24 offset:34816
    s_add_u32 s38, s38, 0
    s_nop 0
    v_mfma_f32_16x16x32_bf16 v[48:51], a[120:123], a[144:147], v[48:51]
    ds_read_b128 a[80:83], v24 offset:36864
    buffer_load_dwordx4 v[184:187], v3, s[24:27], s38 offen offset:0 sc1
    v_mfma_f32_16x16x32_bf16 v[52:55], a[120:123], a[148:151], v[52:55]
    ds_read_b128 a[84:87], v24 offset:38912
    buffer_load_dwordx4 v[188:191], v3, s[24:27], s38 offen offset:1024 sc1
    v_mfma_f32_16x16x32_bf16 v[56:59], a[124:127], a[144:147], v[56:59]
    ds_read_b128 a[88:91], v24 offset:40960
    v_mfma_f32_16x16x32_bf16 v[60:63], a[124:127], a[148:151], v[60:63]
    ds_read_b128 a[92:95], v24 offset:43008
    v_mfma_f32_16x16x32_bf16 v[64:67], a[128:131], a[144:147], v[64:67]
    ds_read_b128 a[96:99], v24 offset:45056
    v_mfma_f32_16x16x32_bf16 v[68:71], a[128:131], a[148:151], v[68:71]
    ds_read_b128 a[100:103], v24 offset:47104
    v_mfma_f32_16x16x32_bf16 v[72:75], a[132:135], a[144:147], v[72:75]
    v_mfma_f32_16x16x32_bf16 v[76:79], a[132:135], a[148:151], v[76:79]
    v_mfma_f32_16x16x32_bf16 v[80:83], a[136:139], a[144:147], v[80:83]
    v_mfma_f32_16x16x32_bf16 v[84:87], a[136:139], a[148:151], v[84:87]
    v_mfma_f32_16x16x32_bf16 v[88:91], a[140:143], a[144:147], v[88:91]
    v_mfma_f32_16x16x32_bf16 v[92:95], a[140:143], a[148:151], v[92:95]
    s_waitcnt lgkmcnt(0)
    s_nop 0
    v_mfma_f32_16x16x32_bf16 v[32:35], a[72:75], a[104:107], v[32:35]
    ds_read_b128 a[144:147], v27 offset:32768
    buffer_load_dwordx4 v[192:195], v3, s[24:27], s38 offen offset:2048 sc1
    v_mfma_f32_16x16x32_bf16 v[36:39], a[72:75], a[108:111], v[36:39]
    ds_read_b128 a[148:151], v27 offset:40960
    buffer_load_dwordx4 v[196:199], v3, s[24:27], s38 offen offset:3072 sc1
    v_mfma_f32_16x16x32_bf16 v[40:43], a[76:79], a[104:107], v[40:43]
    ds_read_b128 a[112:115], v25 offset:32768
    buffer_load_dwordx4 v[200:203], v3, s[24:27], s39 offen offset:0 sc1
    v_mfma_f32_16x16x32_bf16 v[44:47], a[76:79], a[108:111], v[44:47]
    ds_read_b128 a[116:119], v25 offset:34816
    buffer_load_dwordx4 v[204:207], v3, s[24:27], s39 offen offset:1024 sc1
    v_mfma_f32_16x16x32_bf16 v[48:51], a[80:83], a[104:107], v[48:51]
    ds_read_b128 a[120:123], v25 offset:36864
    buffer_load_dwordx4 v[208:211], v3, s[24:27], s39 offen offset:2048 sc1
    v_mfma_f32_16x16x32_bf16 v[52:55], a[80:83], a[108:111], v[52:55]
    ds_read_b128 a[124:127], v25 offset:38912
    buffer_load_dwordx4 v[212:215], v3, s[24:27], s39 offen offset:3072 sc1
    v_mfma_f32_16x16x32_bf16 v[56:59], a[84:87], a[104:107], v[56:59]
    ds_read_b128 a[128:131], v25 offset:40960
    v_mfma_f32_16x16x32_bf16 v[60:63], a[84:87], a[108:111], v[60:63]
    ds_read_b128 a[132:135], v25 offset:43008
    v_mfma_f32_16x16x32_bf16 v[64:67], a[88:91], a[104:107], v[64:67]
    ds_read_b128 a[136:139], v25 offset:45056
    v_mfma_f32_16x16x32_bf16 v[68:71], a[88:91], a[108:111], v[68:71]
    ds_read_b128 a[140:143], v25 offset:47104
    v_mfma_f32_16x16x32_bf16 v[72:75], a[92:95], a[104:107], v[72:75]
    v_mfma_f32_16x16x32_bf16 v[76:79], a[92:95], a[108:111], v[76:79]
    v_mfma_f32_16x16x32_bf16 v[80:83], a[96:99], a[104:107], v[80:83]
    v_mfma_f32_16x16x32_bf16 v[84:87], a[96:99], a[108:111], v[84:87]
    v_mfma_f32_16x16x32_bf16 v[88:91], a[100:103], a[104:107], v[88:91]
    v_mfma_f32_16x16x32_bf16 v[92:95], a[100:103], a[108:111], v[92:95]
    s_waitcnt vmcnt(16) lgkmcnt(0)
    s_barrier
    v_mfma_f32_16x16x32_bf16 v[32:35], a[112:115], a[144:147], v[32:35]
    ds_read_b128 a[104:107], v30 offset:0
    v_mfma_f32_16x16x32_bf16 v[36:39], a[112:115], a[148:151], v[36:39]
    ds_read_b128 a[108:111], v30 offset:8192
    v_mfma_f32_16x16x32_bf16 v[40:43], a[116:119], a[144:147], v[40:43]
    ds_read_b128 a[72:75], v28 offset:0
    v_mfma_f32_16x16x32_bf16 v[44:47], a[116:119], a[148:151], v[44:47]
    ds_read_b128 a[76:79], v28 offset:2048
    v_mfma_f32_16x16x32_bf16 v[48:51], a[120:123], a[144:147], v[48:51]
    ds_read_b128 a[80:83], v28 offset:4096
    v_mfma_f32_16x16x32_bf16 v[52:55], a[120:123], a[148:151], v[52:55]
    ds_read_b128 a[84:87], v28 offset:6144
    v_mfma_f32_16x16x32_bf16 v[56:59], a[124:127], a[144:147], v[56:59]
    ds_read_b128 a[88:91], v28 offset:8192
    v_mfma_f32_16x16x32_bf16 v[60:63], a[124:127], a[148:151], v[60:63]
    ds_read_b128 a[92:95], v28 offset:10240
    v_mfma_f32_16x16x32_bf16 v[64:67], a[128:131], a[144:147], v[64:67]
    ds_read_b128 a[96:99], v28 offset:12288
    v_mfma_f32_16x16x32_bf16 v[68:71], a[128:131], a[148:151], v[68:71]
    ds_read_b128 a[100:103], v28 offset:14336
    v_mfma_f32_16x16x32_bf16 v[72:75], a[132:135], a[144:147], v[72:75]
    v_mfma_f32_16x16x32_bf16 v[76:79], a[132:135], a[148:151], v[76:79]
    v_mfma_f32_16x16x32_bf16 v[80:83], a[136:139], a[144:147], v[80:83]
    v_mfma_f32_16x16x32_bf16 v[84:87], a[136:139], a[148:151], v[84:87]
    v_mfma_f32_16x16x32_bf16 v[88:91], a[140:143], a[144:147], v[88:91]
    v_mfma_f32_16x16x32_bf16 v[92:95], a[140:143], a[148:151], v[92:95]
    s_waitcnt lgkmcnt(0)
    s_nop 0
    v_mfma_f32_16x16x32_bf16 v[32:35], a[72:75], a[104:107], v[32:35]
    ds_read_b128 a[144:147], v31 offset:0
    v_mfma_f32_16x16x32_bf16 v[36:39], a[72:75], a[108:111], v[36:39]
    ds_read_b128 a[148:151], v31 offset:8192
    v_mfma_f32_16x16x32_bf16 v[40:43], a[76:79], a[104:107], v[40:43]
    ds_read_b128 a[112:115], v29 offset:0
    v_mfma_f32_16x16x32_bf16 v[44:47], a[76:79], a[108:111], v[44:47]
    ds_read_b128 a[116:119], v29 offset:2048
    v_mfma_f32_16x16x32_bf16 v[48:51], a[80:83], a[104:107], v[48:51]
    ds_read_b128 a[120:123], v29 offset:4096
    v_mfma_f32_16x16x32_bf16 v[52:55], a[80:83], a[108:111], v[52:55]
    ds_read_b128 a[124:127], v29 offset:6144
    v_mfma_f32_16x16x32_bf16 v[56:59], a[84:87], a[104:107], v[56:59]
    ds_read_b128 a[128:131], v29 offset:8192
    v_mfma_f32_16x16x32_bf16 v[60:63], a[84:87], a[108:111], v[60:63]
    ds_read_b128 a[132:135], v29 offset:10240
    v_mfma_f32_16x16x32_bf16 v[64:67], a[88:91], a[104:107], v[64:67]
    ds_read_b128 a[136:139], v29 offset:12288
    v_mfma_f32_16x16x32_bf16 v[68:71], a[88:91], a[108:111], v[68:71]
    ds_read_b128 a[140:143], v29 offset:14336
    v_mfma_f32_16x16x32_bf16 v[72:75], a[92:95], a[104:107], v[72:75]
    v_mfma_f32_16x16x32_bf16 v[76:79], a[92:95], a[108:111], v[76:79]
    v_mfma_f32_16x16x32_bf16 v[80:83], a[96:99], a[104:107], v[80:83]
    v_mfma_f32_16x16x32_bf16 v[84:87], a[96:99], a[108:111], v[84:87]
    v_mfma_f32_16x16x32_bf16 v[88:91], a[100:103], a[104:107], v[88:91]
    v_mfma_f32_16x16x32_bf16 v[92:95], a[100:103], a[108:111], v[92:95]
    s_waitcnt vmcnt(8) lgkmcnt(0)
    s_barrier
    v_mfma_f32_16x16x32_bf16 v[32:35], a[112:115], a[144:147], v[32:35]
    ds_read_b128 a[104:107], v30 offset:32768
    v_mfma_f32_16x16x32_bf16 v[36:39], a[112:115], a[148:151], v[36:39]
    ds_read_b128 a[108:111], v30 offset:40960
    v_mfma_f32_16x16x32_bf16 v[40:43], a[116:119], a[144:147], v[40:43]
    ds_read_b128 a[72:75], v28 offset:32768
    v_mfma_f32_16x16x32_bf16 v[44:47], a[116:119], a[148:151], v[44:47]
    ds_read_b128 a[76:79], v28 offset:34816
    v_mfma_f32_16x16x32_bf16 v[48:51], a[120:123], a[144:147], v[48:51]
    ds_read_b128 a[80:83], v28 offset:36864
    v_mfma_f32_16x16x32_bf16 v[52:55], a[120:123], a[148:151], v[52:55]
    ds_read_b128 a[84:87], v28 offset:38912
    v_mfma_f32_16x16x32_bf16 v[56:59], a[124:127], a[144:147], v[56:59]
    ds_read_b128 a[88:91], v28 offset:40960
    v_mfma_f32_16x16x32_bf16 v[60:63], a[124:127], a[148:151], v[60:63]
    ds_read_b128 a[92:95], v28 offset:43008
    v_mfma_f32_16x16x32_bf16 v[64:67], a[128:131], a[144:147], v[64:67]
    ds_read_b128 a[96:99], v28 offset:45056
    v_mfma_f32_16x16x32_bf16 v[68:71], a[128:131], a[148:151], v[68:71]
    ds_read_b128 a[100:103], v28 offset:47104
    v_mfma_f32_16x16x32_bf16 v[72:75], a[132:135], a[144:147], v[72:75]
    v_mfma_f32_16x16x32_bf16 v[76:79], a[132:135], a[148:151], v[76:79]
    v_mfma_f32_16x16x32_bf16 v[80:83], a[136:139], a[144:147], v[80:83]
    v_mfma_f32_16x16x32_bf16 v[84:87], a[136:139], a[148:151], v[84:87]
    v_mfma_f32_16x16x32_bf16 v[88:91], a[140:143], a[144:147], v[88:91]
    v_mfma_f32_16x16x32_bf16 v[92:95], a[140:143], a[148:151], v[92:95]
    s_waitcnt lgkmcnt(0)
    s_nop 0
    v_mfma_f32_16x16x32_bf16 v[32:35], a[72:75], a[104:107], v[32:35]
    ds_read_b128 a[144:147], v31 offset:32768
    v_mfma_f32_16x16x32_bf16 v[36:39], a[72:75], a[108:111], v[36:39]
    ds_read_b128 a[148:151], v31 offset:40960
    v_mfma_f32_16x16x32_bf16 v[40:43], a[76:79], a[104:107], v[40:43]
    ds_read_b128 a[112:115], v29 offset:32768
    v_mfma_f32_16x16x32_bf16 v[44:47], a[76:79], a[108:111], v[44:47]
    ds_read_b128 a[116:119], v29 offset:34816
    v_mfma_f32_16x16x32_bf16 v[48:51], a[80:83], a[104:107], v[48:51]
    ds_read_b128 a[120:123], v29 offset:36864
    v_mfma_f32_16x16x32_bf16 v[52:55], a[80:83], a[108:111], v[52:55]
    ds_read_b128 a[124:127], v29 offset:38912
    v_mfma_f32_16x16x32_bf16 v[56:59], a[84:87], a[104:107], v[56:59]
    ds_read_b128 a[128:131], v29 offset:40960
    v_mfma_f32_16x16x32_bf16 v[60:63], a[84:87], a[108:111], v[60:63]
    ds_read_b128 a[132:135], v29 offset:43008
    v_mfma_f32_16x16x32_bf16 v[64:67], a[88:91], a[104:107], v[64:67]
    ds_read_b128 a[136:139], v29 offset:45056
    v_mfma_f32_16x16x32_bf16 v[68:71], a[88:91], a[108:111], v[68:71]
    ds_read_b128 a[140:143], v29 offset:47104
    v_mfma_f32_16x16x32_bf16 v[72:75], a[92:95], a[104:107], v[72:75]
    v_mfma_f32_16x16x32_bf16 v[76:79], a[92:95], a[108:111], v[76:79]
    v_mfma_f32_16x16x32_bf16 v[80:83], a[96:99], a[104:107], v[80:83]
    v_mfma_f32_16x16x32_bf16 v[84:87], a[96:99], a[108:111], v[84:87]
    v_mfma_f32_16x16x32_bf16 v[88:91], a[100:103], a[104:107], v[88:91]
    v_mfma_f32_16x16x32_bf16 v[92:95], a[100:103], a[108:111], v[92:95]
    s_waitcnt lgkmcnt(0)
    v_mfma_f32_16x16x32_bf16 v[32:35], a[112:115], a[144:147], v[32:35]
    s_add_u32 s38, s37, 131072
    v_add_u32 v4, s38, v3
    v_mfma_f32_16x16x32_bf16 v[36:39], a[112:115], a[148:151], v[36:39]
    s_waitcnt vmcnt(4)
    s_nop 0
    ds_write_b128 v4, v[184:187] offset:0
    v_mfma_f32_16x16x32_bf16 v[40:43], a[116:119], a[144:147], v[40:43]
    ds_write_b128 v4, v[188:191] offset:1024
    ds_write_b128 v4, v[192:195] offset:2048
    v_mfma_f32_16x16x32_bf16 v[44:47], a[116:119], a[148:151], v[44:47]
    ds_write_b128 v4, v[196:199] offset:3072
    v_mfma_f32_16x16x32_bf16 v[48:51], a[120:123], a[144:147], v[48:51]
    v_mfma_f32_16x16x32_bf16 v[52:55], a[120:123], a[148:151], v[52:55]
    v_mfma_f32_16x16x32_bf16 v[56:59], a[124:127], a[144:147], v[56:59]
    v_mfma_f32_16x16x32_bf16 v[60:63], a[124:127], a[148:151], v[60:63]
    v_mfma_f32_16x16x32_bf16 v[64:67], a[128:131], a[144:147], v[64:67]
    v_mfma_f32_16x16x32_bf16 v[68:71], a[128:131], a[148:151], v[68:71]
    v_mfma_f32_16x16x32_bf16 v[72:75], a[132:135], a[144:147], v[72:75]
    v_mfma_f32_16x16x32_bf16 v[76:79], a[132:135], a[148:151], v[76:79]
    v_mfma_f32_16x16x32_bf16 v[80:83], a[136:139], a[144:147], v[80:83]
    v_mfma_f32_16x16x32_bf16 v[84:87], a[136:139], a[148:151], v[84:87]
    v_mfma_f32_16x16x32_bf16 v[88:91], a[140:143], a[144:147], v[88:91]
    v_mfma_f32_16x16x32_bf16 v[92:95], a[140:143], a[148:151], v[92:95]
    v_pk_fma_f32 v[4:5], v[32:33], v[128:129], v[34:35] op_sel_hi:[1,0,1]
    v_pk_fma_f32 v[6:7], v[36:37], v[128:129], v[38:39] op_sel_hi:[1,0,1]
    v_pk_fma_f32 v[4:5], v[36:37], v[128:129], v[4:5] op_sel:[0,1,0] neg_lo:[1,0,0] neg_hi:[1,0,0]
    v_pk_fma_f32 v[6:7], v[32:33], v[128:129], v[6:7] op_sel:[0,1,0]
    v_pk_fma_f32 v[8:9], v[4:5], v[128:129], v[40:41] op_sel_hi:[1,0,1]
    v_pk_fma_f32 v[10:11], v[6:7], v[128:129], v[44:45] op_sel_hi:[1,0,1]
    v_pk_fma_f32 v[8:9], v[6:7], v[128:129], v[8:9] op_sel:[0,1,0] neg_lo:[1,0,0] neg_hi:[1,0,0]
    v_pk_fma_f32 v[10:11], v[4:5], v[128:129], v[10:11] op_sel:[0,1,0]
    v_pk_fma_f32 v[4:5], v[8:9], v[128:129], v[42:43] op_sel_hi:[1,0,1]
    v_pk_fma_f32 v[6:7], v[10:11], v[128:129], v[46:47] op_sel_hi:[1,0,1]
    v_pk_fma_f32 v[4:5], v[10:11], v[128:129], v[4:5] op_sel:[0,1,0] neg_lo:[1,0,0] neg_hi:[1,0,0]
    v_pk_fma_f32 v[6:7], v[8:9], v[128:129], v[6:7] op_sel:[0,1,0]
    v_pk_fma_f32 v[8:9], v[4:5], v[128:129], v[48:49] op_sel_hi:[1,0,1]
    v_pk_fma_f32 v[10:11], v[6:7], v[128:129], v[52:53] op_sel_hi:[1,0,1]
    v_pk_fma_f32 v[8:9], v[6:7], v[128:129], v[8:9] op_sel:[0,1,0] neg_lo:[1,0,0] neg_hi:[1,0,0]
    v_pk_fma_f32 v[10:11], v[4:5], v[128:129], v[10:11] op_sel:[0,1,0]
    v_pk_fma_f32 v[4:5], v[8:9], v[128:129], v[50:51] op_sel_hi:[1,0,1]
    v_pk_fma_f32 v[6:7], v[10:11], v[128:129], v[54:55] op_sel_hi:[1,0,1]
    v_pk_fma_f32 v[4:5], v[10:11], v[128:129], v[4:5] op_sel:[0,1,0] neg_lo:[1,0,0] neg_hi:[1,0,0]
    v_pk_fma_f32 v[6:7], v[8:9], v[128:129], v[6:7] op_sel:[0,1,0]
    v_pk_fma_f32 v[8:9], v[4:5], v[128:129], v[56:57] op_sel_hi:[1,0,1]
    v_pk_fma_f32 v[10:11], v[6:7], v[128:129], v[60:61] op_sel_hi:[1,0,1]
    v_pk_fma_f32 v[8:9], v[6:7], v[128:129], v[8:9] op_sel:[0,1,0] neg_lo:[1,0,0] neg_hi:[1,0,0]
    v_pk_fma_f32 v[10:11], v[4:5], v[128:129], v[10:11] op_sel:[0,1,0]
    v_pk_fma_f32 v[4:5], v[8:9], v[128:129], v[58:59] op_sel_hi:[1,0,1]
    v_pk_fma_f32 v[6:7], v[10:11], v[128:129], v[62:63] op_sel_hi:[1,0,1]
    v_pk_fma_f32 v[4:5], v[10:11], v[128:129], v[4:5] op_sel:[0,1,0] neg_lo:[1,0,0] neg_hi:[1,0,0]
    v_pk_fma_f32 v[6:7], v[8:9], v[128:129], v[6:7] op_sel:[0,1,0]
    v_pk_fma_f32 v[8:9], v[4:5], v[128:129], v[64:65] op_sel_hi:[1,0,1]
    v_pk_fma_f32 v[10:11], v[6:7], v[128:129], v[68:69] op_sel_hi:[1,0,1]
    v_pk_fma_f32 v[8:9], v[6:7], v[128:129], v[8:9] op_sel:[0,1,0] neg_lo:[1,0,0] neg_hi:[1,0,0]
    v_pk_fma_f32 v[10:11], v[4:5], v[128:129], v[10:11] op_sel:[0,1,0]
    v_pk_fma_f32 v[4:5], v[8:9], v[128:129], v[66:67] op_sel_hi:[1,0,1]
    v_pk_fma_f32 v[6:7], v[10:11], v[128:129], v[70:71] op_sel_hi:[1,0,1]
    v_pk_fma_f32 v[4:5], v[10:11], v[128:129], v[4:5] op_sel:[0,1,0] neg_lo:[1,0,0] neg_hi:[1,0,0]
    v_pk_fma_f32 v[6:7], v[8:9], v[128:129], v[6:7] op_sel:[0,1,0]
    v_pk_fma_f32 v[8:9], v[4:5], v[128:129], v[72:73] op_sel_hi:[1,0,1]
    v_pk_fma_f32 v[10:11], v[6:7], v[128:129], v[76:77] op_sel_hi:[1,0,1]
    v_pk_fma_f32 v[8:9], v[6:7], v[128:129], v[8:9] op_sel:[0,1,0] neg_lo:[1,0,0] neg_hi:[1,0,0]
    v_pk_fma_f32 v[10:11], v[4:5], v[128:129], v[10:11] op_sel:[0,1,0]
    v_pk_fma_f32 v[4:5], v[8:9], v[128:129], v[74:75] op_sel_hi:[1,0,1]
    v_pk_fma_f32 v[6:7], v[10:11], v[128:129], v[78:79] op_sel_hi:[1,0,1]
    v_pk_fma_f32 v[4:5], v[10:11], v[128:129], v[4:5] op_sel:[0,1,0] neg_lo:[1,0,0] neg_hi:[1,0,0]
    v_pk_fma_f32 v[6:7], v[8:9], v[128:129], v[6:7] op_sel:[0,1,0]
    v_pk_fma_f32 v[8:9], v[4:5], v[128:129], v[80:81] op_sel_hi:[1,0,1]
    v_pk_fma_f32 v[10:11], v[6:7], v[128:129], v[84:85] op_sel_hi:[1,0,1]
    v_pk_fma_f32 v[8:9], v[6:7], v[128:129], v[8:9] op_sel:[0,1,0] neg_lo:[1,0,0] neg_hi:[1,0,0]
    v_pk_fma_f32 v[10:11], v[4:5], v[128:129], v[10:11] op_sel:[0,1,0]
    v_pk_fma_f32 v[4:5], v[8:9], v[128:129], v[82:83] op_sel_hi:[1,0,1]
    v_pk_fma_f32 v[6:7], v[10:11], v[128:129], v[86:87] op_sel_hi:[1,0,1]
    v_pk_fma_f32 v[4:5], v[10:11], v[128:129], v[4:5] op_sel:[0,1,0] neg_lo:[1,0,0] neg_hi:[1,0,0]
    v_pk_fma_f32 v[6:7], v[8:9], v[128:129], v[6:7] op_sel:[0,1,0]
    v_pk_fma_f32 v[8:9], v[4:5], v[128:129], v[88:89] op_sel_hi:[1,0,1]
    v_pk_fma_f32 v[10:11], v[6:7], v[128:129], v[92:93] op_sel_hi:[1,0,1]
    v_pk_fma_f32 v[8:9], v[6:7], v[128:129], v[8:9] op_sel:[0,1,0] neg_lo:[1,0,0] neg_hi:[1,0,0]
    v_pk_fma_f32 v[10:11], v[4:5], v[128:129], v[10:11] op_sel:[0,1,0]
    v_pk_fma_f32 v[142:143], v[8:9], v[128:129], v[90:91] op_sel_hi:[1,0,1]
    v_pk_fma_f32 v[144:145], v[10:11], v[128:129], v[94:95] op_sel_hi:[1,0,1]
    v_pk_fma_f32 v[142:143], v[10:11], v[128:129], v[142:143] op_sel:[0,1,0] neg_lo:[1,0,0] neg_hi:[1,0,0]
    v_pk_fma_f32 v[144:145], v[8:9], v[128:129], v[144:145] op_sel:[0,1,0]
    v_pk_mul_f32 v[4:5], v[142:143], v[130:131] op_sel_hi:[1,0]
    v_pk_mul_f32 v[6:7], v[144:145], v[130:131] op_sel_hi:[1,0]
    v_pk_fma_f32 v[4:5], v[144:145], v[130:131], v[4:5] op_sel:[0,1,0] neg_lo:[1,0,0] neg_hi:[1,0,0]
    v_pk_fma_f32 v[144:145], v[142:143], v[130:131], v[6:7] op_sel:[0,1,0]
    v_mov_b32 v142, v4
    v_mov_b32 v143, v5
    v_fma_f32 v4, v142, v132, v143
    v_fma_f32 v8, v142, v133, v145
    v_fma_f32 v4, -v144, v133, v4
    v_fma_f32 v8, v144, v132, v8
    v_mov_b32 v6, v4
    v_mov_b32 v10, v8
    s_nop 0
    v_permlane32_swap_b32 v4, v6
    v_permlane32_swap_b32 v8, v10
    v_mov_b32 v5, v4
    v_mov_b32 v7, v6
    v_mov_b32 v9, v8
    v_mov_b32 v11, v10
    v_permlane16_swap_b32 v4, v5
    v_permlane16_swap_b32 v6, v7
    v_permlane16_swap_b32 v8, v9
    v_permlane16_swap_b32 v10, v11
    s_nop 0
    v_fma_f32 v12, v4, v134, v5
    v_fma_f32 v13, v4, v135, v9
    v_fma_f32 v12, -v8, v135, v12
    v_fma_f32 v13, v8, v134, v13
    v_fma_f32 v14, v12, v134, v6
    v_fma_f32 v15, v12, v135, v10
    v_fma_f32 v14, -v13, v135, v14
    v_fma_f32 v15, v13, v134, v15
    v_fma_f32 v220, v14, v134, v7
    v_fma_f32 v221, v14, v135, v11
    v_fma_f32 v220, -v15, v135, v220
    v_fma_f32 v221, v15, v134, v221
    v_mov_b32 v222, s35
    v_mov_b32 v223, s35
    s_lshl_b32 s38, s33, 4
    s_add_u32 s38, s38, s32
    s_lshl_b32 s38, s38, 2
    s_add_u32 s38, s38, s34
    s_lshl_b32 s38, s38, 8
    s_add_u32 s38, s38, 28311552
    v_cmp_gt_u32 vcc, 16, v0
    s_nop 1
    v_cndmask_b32 v5, 2.0, v3, vcc
    buffer_store_dwordx4 v[220:223], v5, s[24:27], s38 offen sc1
    v_cndmask_b32 v146, v4, 0, vcc
    v_cndmask_b32 v147, v8, 0, vcc
    v_cmp_eq_u32 vcc, 2, v2
    s_nop 1
    v_cndmask_b32 v146, v146, v12, vcc
    v_cndmask_b32 v147, v147, v13, vcc
    v_cmp_eq_u32 vcc, 3, v2
    s_nop 1
    v_cndmask_b32 v146, v146, v14, vcc
    v_cndmask_b32 v147, v147, v15, vcc
    s_waitcnt lgkmcnt(0)
    s_barrier
    v_add_u32 v4, 131072, v3
    ds_read_b128 a[72:75], v4 offset:0
    ds_read_b128 a[76:79], v4 offset:1024
    ds_read_b128 a[80:83], v4 offset:2048
    ds_read_b128 a[84:87], v4 offset:3072
    ds_read_b128 a[88:91], v4 offset:4096
    ds_read_b128 a[92:95], v4 offset:5120
    ds_read_b128 a[96:99], v4 offset:6144
    ds_read_b128 a[100:103], v4 offset:7168
    ds_read_b128 a[104:107], v4 offset:8192
    ds_read_b128 a[108:111], v4 offset:9216
    ds_read_b128 a[112:115], v4 offset:10240
    ds_read_b128 a[116:119], v4 offset:11264
    ds_read_b128 a[120:123], v4 offset:12288
    ds_read_b128 a[124:127], v4 offset:13312
    ds_read_b128 a[128:131], v4 offset:14336
    ds_read_b128 a[132:135], v4 offset:15360
    s_waitcnt lgkmcnt(12)
    v_mfma_f32_16x16x32_bf16 v[224:227], a[72:75], a[40:43], 0
    s_waitcnt vmcnt(1)
    v_mfma_f32_16x16x32_bf16 v[228:231], a[72:75], a[44:47], 0
    v_lshlrev_b32_e64 v152, 16, v200
    v_mfma_f32_16x16x32_bf16 v[224:227], a[76:79], a[48:51], v[224:227]
    v_and_b32 v160, 0xffff0000, v200
    v_mfma_f32_16x16x32_bf16 v[228:231], a[76:79], a[52:55], v[228:231]
    v_lshlrev_b32_e64 v168, 16, v201
    v_mfma_f32_16x16x32_bf16 v[224:227], a[80:83], a[56:59], v[224:227]
    v_and_b32 v176, 0xffff0000, v201
    v_mfma_f32_16x16x32_bf16 v[228:231], a[80:83], a[60:63], v[228:231]
    v_lshlrev_b32_e64 v153, 16, v202
    v_mfma_f32_16x16x32_bf16 v[224:227], a[84:87], a[64:67], v[224:227]
    v_and_b32 v161, 0xffff0000, v202
    v_mfma_f32_16x16x32_bf16 v[228:231], a[84:87], a[68:71], v[228:231]
    v_lshlrev_b32 v169, 16, v203
    s_waitcnt lgkmcnt(8)
    v_and_b32 v177, 0xffff0000, v203
    v_mfma_f32_16x16x32_bf16 v[232:235], a[88:91], a[40:43], 0
    v_lshlrev_b32_e64 v154, 16, v204
    v_mfma_f32_16x16x32_bf16 v[236:239], a[88:91], a[44:47], 0
    v_and_b32 v162, 0xffff0000, v204
    v_mfma_f32_16x16x32_bf16 v[232:235], a[92:95], a[48:51], v[232:235]
    v_lshlrev_b32_e64 v170, 16, v205
    v_mfma_f32_16x16x32_bf16 v[236:239], a[92:95], a[52:55], v[236:239]
    v_and_b32 v178, 0xffff0000, v205
    v_mfma_f32_16x16x32_bf16 v[232:235], a[96:99], a[56:59], v[232:235]
    v_lshlrev_b32_e64 v155, 16, v206
    v_mfma_f32_16x16x32_bf16 v[236:239], a[96:99], a[60:63], v[236:239]
    v_and_b32 v163, 0xffff0000, v206
    v_mfma_f32_16x16x32_bf16 v[232:235], a[100:103], a[64:67], v[232:235]
    v_lshlrev_b32_e64 v171, 16, v207
    v_mfma_f32_16x16x32_bf16 v[236:239], a[100:103], a[68:71], v[236:239]
    v_and_b32 v179, 0xffff0000, v207
    s_waitcnt lgkmcnt(4)
    v_lshlrev_b32 v156, 16, v208
    v_mfma_f32_16x16x32_bf16 v[240:243], a[104:107], a[40:43], 0
    v_and_b32 v164, 0xffff0000, v208
    v_mfma_f32_16x16x32_bf16 v[244:247], a[104:107], a[44:47], 0
    v_lshlrev_b32_e64 v172, 16, v209
    v_mfma_f32_16x16x32_bf16 v[240:243], a[108:111], a[48:51], v[240:243]
    v_and_b32 v180, 0xffff0000, v209
    v_mfma_f32_16x16x32_bf16 v[244:247], a[108:111], a[52:55], v[244:247]
    v_lshlrev_b32_e64 v157, 16, v210
    v_mfma_f32_16x16x32_bf16 v[240:243], a[112:115], a[56:59], v[240:243]
    v_and_b32 v165, 0xffff0000, v210
    v_mfma_f32_16x16x32_bf16 v[244:247], a[112:115], a[60:63], v[244:247]
    v_lshlrev_b32_e64 v173, 16, v211
    v_mfma_f32_16x16x32_bf16 v[240:243], a[116:119], a[64:67], v[240:243]
    v_and_b32 v181, 0xffff0000, v211
    v_mfma_f32_16x16x32_bf16 v[244:247], a[116:119], a[68:71], v[244:247]
    v_lshlrev_b32 v158, 16, v212
    s_waitcnt lgkmcnt(0)
    v_and_b32 v166, 0xffff0000, v212
    v_mfma_f32_16x16x32_bf16 v[248:251], a[120:123], a[40:43], 0
    v_lshlrev_b32_e64 v174, 16, v213
    v_mfma_f32_16x16x32_bf16 v[252:255], a[120:123], a[44:47], 0
    v_and_b32 v182, 0xffff0000, v213
    v_mfma_f32_16x16x32_bf16 v[248:251], a[124:127], a[48:51], v[248:251]
    v_lshlrev_b32_e64 v159, 16, v214
    v_mfma_f32_16x16x32_bf16 v[252:255], a[124:127], a[52:55], v[252:255]
    v_and_b32 v167, 0xffff0000, v214
    v_mfma_f32_16x16x32_bf16 v[248:251], a[128:131], a[56:59], v[248:251]
    v_lshlrev_b32_e64 v175, 16, v215
    v_mfma_f32_16x16x32_bf16 v[252:255], a[128:131], a[60:63], v[252:255]
    v_and_b32 v183, 0xffff0000, v215
    v_mfma_f32_16x16x32_bf16 v[248:251], a[132:135], a[64:67], v[248:251]
    v_mfma_f32_16x16x32_bf16 v[252:255], a[132:135], a[68:71], v[252:255]
    v_pk_mul_f32 v[4:5], v[224:225], v[96:97] op_sel_hi:[1,0]
    v_pk_mul_f32 v[6:7], v[228:229], v[96:97] op_sel_hi:[1,0]
    v_pk_fma_f32 v[4:5], v[228:229], v[96:97], v[4:5] op_sel:[0,1,0]
    v_pk_fma_f32 v[6:7], v[224:225], v[96:97], v[6:7] op_sel:[0,1,0] neg_lo:[1,0,0] neg_hi:[1,0,0]
    v_pk_mul_f32 v[8:9], v[226:227], v[98:99] op_sel_hi:[1,0]
    v_pk_mul_f32 v[10:11], v[230:231], v[98:99] op_sel_hi:[1,0]
    v_pk_fma_f32 v[8:9], v[230:231], v[98:99], v[8:9] op_sel:[0,1,0]
    v_pk_fma_f32 v[10:11], v[226:227], v[98:99], v[10:11] op_sel:[0,1,0] neg_lo:[1,0,0] neg_hi:[1,0,0]
    v_cvt_pk_bf16_f32 v184, v4, v6
    v_cvt_pk_bf16_f32 v192, v5, v7
    v_cvt_pk_bf16_f32 v185, v8, v10
    v_cvt_pk_bf16_f32 v193, v9, v11
    v_pk_mul_f32 v[4:5], v[232:233], v[100:101] op_sel_hi:[1,0]
    v_pk_mul_f32 v[6:7], v[236:237], v[100:101] op_sel_hi:[1,0]
    v_pk_fma_f32 v[4:5], v[236:237], v[100:101], v[4:5] op_sel:[0,1,0]
    v_pk_fma_f32 v[6:7], v[232:233], v[100:101], v[6:7] op_sel:[0,1,0] neg_lo:[1,0,0] neg_hi:[1,0,0]
    v_pk_mul_f32 v[8:9], v[234:235], v[102:103] op_sel_hi:[1,0]
    v_pk_mul_f32 v[10:11], v[238:239], v[102:103] op_sel_hi:[1,0]
    v_pk_fma_f32 v[8:9], v[238:239], v[102:103], v[8:9] op_sel:[0,1,0]
    v_pk_fma_f32 v[10:11], v[234:235], v[102:103], v[10:11] op_sel:[0,1,0] neg_lo:[1,0,0] neg_hi:[1,0,0]
    v_cvt_pk_bf16_f32 v186, v4, v6
    v_cvt_pk_bf16_f32 v194, v5, v7
    v_cvt_pk_bf16_f32 v187, v8, v10
    v_cvt_pk_bf16_f32 v195, v9, v11
    v_pk_mul_f32 v[4:5], v[240:241], v[104:105] op_sel_hi:[1,0]
    v_pk_mul_f32 v[6:7], v[244:245], v[104:105] op_sel_hi:[1,0]
    v_pk_fma_f32 v[4:5], v[244:245], v[104:105], v[4:5] op_sel:[0,1,0]
    v_pk_fma_f32 v[6:7], v[240:241], v[104:105], v[6:7] op_sel:[0,1,0] neg_lo:[1,0,0] neg_hi:[1,0,0]
    v_pk_mul_f32 v[8:9], v[242:243], v[106:107] op_sel_hi:[1,0]
    v_pk_mul_f32 v[10:11], v[246:247], v[106:107] op_sel_hi:[1,0]
    v_pk_fma_f32 v[8:9], v[246:247], v[106:107], v[8:9] op_sel:[0,1,0]
    v_pk_fma_f32 v[10:11], v[242:243], v[106:107], v[10:11] op_sel:[0,1,0] neg_lo:[1,0,0] neg_hi:[1,0,0]
    v_cvt_pk_bf16_f32 v188, v4, v6
    v_cvt_pk_bf16_f32 v196, v5, v7
    v_cvt_pk_bf16_f32 v189, v8, v10
    v_cvt_pk_bf16_f32 v197, v9, v11
    v_pk_mul_f32 v[4:5], v[248:249], v[108:109] op_sel_hi:[1,0]
    v_pk_mul_f32 v[6:7], v[252:253], v[108:109] op_sel_hi:[1,0]
    v_pk_fma_f32 v[4:5], v[252:253], v[108:109], v[4:5] op_sel:[0,1,0]
    v_pk_fma_f32 v[6:7], v[248:249], v[108:109], v[6:7] op_sel:[0,1,0] neg_lo:[1,0,0] neg_hi:[1,0,0]
    v_pk_mul_f32 v[8:9], v[250:251], v[110:111] op_sel_hi:[1,0]
    v_pk_mul_f32 v[10:11], v[254:255], v[110:111] op_sel_hi:[1,0]
    v_pk_fma_f32 v[8:9], v[254:255], v[110:111], v[8:9] op_sel:[0,1,0]
    v_pk_fma_f32 v[10:11], v[250:251], v[110:111], v[10:11] op_sel:[0,1,0] neg_lo:[1,0,0] neg_hi:[1,0,0]
    v_cvt_pk_bf16_f32 v190, v4, v6
    v_cvt_pk_bf16_f32 v198, v5, v7
    v_cvt_pk_bf16_f32 v191, v8, v10
    v_cvt_pk_bf16_f32 v199, v9, v11
    v_mfma_f32_16x16x32_bf16 v[224:227], a[0:3], v[184:187], 0
    v_mfma_f32_16x16x32_bf16 v[228:231], a[4:7], v[184:187], 0
    v_mfma_f32_16x16x32_bf16 v[240:243], a[0:3], v[192:195], 0
    v_mfma_f32_16x16x32_bf16 v[244:247], a[4:7], v[192:195], 0
    v_mfma_f32_16x16x32_bf16 v[232:235], a[16:19], v[184:187], 0
    v_mfma_f32_16x16x32_bf16 v[236:239], a[20:23], v[184:187], 0
    v_mfma_f32_16x16x32_bf16 v[248:251], a[16:19], v[192:195], 0
    v_mfma_f32_16x16x32_bf16 v[252:255], a[20:23], v[192:195], 0
    v_mfma_f32_16x16x32_bf16 v[224:227], a[8:11], v[188:191], v[224:227]
    v_mfma_f32_16x16x32_bf16 v[228:231], a[12:15], v[188:191], v[228:231]
    v_mfma_f32_16x16x32_bf16 v[240:243], a[8:11], v[196:199], v[240:243]
    v_mfma_f32_16x16x32_bf16 v[244:247], a[12:15], v[196:199], v[244:247]
    v_mfma_f32_16x16x32_bf16 v[232:235], a[24:27], v[188:191], v[232:235]
    v_mfma_f32_16x16x32_bf16 v[236:239], a[28:31], v[188:191], v[236:239]
    v_mfma_f32_16x16x32_bf16 v[248:251], a[24:27], v[196:199], v[248:251]
    v_mfma_f32_16x16x32_bf16 v[252:255], a[28:31], v[196:199], v[252:255]
    s_cmp_lg_u32 s2, 0
    s_cbranch_scc1 K1_NOSPECIAL
    s_nop 7
    s_mov_b32 s38, 9437184
    s_add_u32 s38, s38, s37
    buffer_load_dwordx4 v[184:187], v3, s[24:27], s38 offen offset:0 sc1
    buffer_load_dwordx4 v[188:191], v3, s[24:27], s38 offen offset:1024 sc1
    buffer_load_dwordx4 v[192:195], v3, s[24:27], s38 offen offset:2048 sc1
    buffer_load_dwordx4 v[196:199], v3, s[24:27], s38 offen offset:3072 sc1
    s_lshl_b32 s38, s34, 4
    v_lshl_add_u32 v4, v2, 7, v1
    v_add_u32 v4, s38, v4
    v_sub_u32 v5, 448, v4
    v_lshlrev_b32 v4, 2, v4
    v_lshlrev_b32 v5, 2, v5
    v_add_u32 v4, 65536, v4
    v_add_u32 v5, 65536, v5
    v_pk_mul_f32 v[224:225], v[224:225], 0.5 op_sel_hi:[1,0]
    v_pk_mul_f32 v[228:229], v[228:229], 0.5 op_sel_hi:[1,0]
    v_pk_mul_f32 v[226:227], v[226:227], 0.5 op_sel_hi:[1,0]
    v_pk_mul_f32 v[230:231], v[230:231], 0.5 op_sel_hi:[1,0]
    v_pk_mul_f32 v[232:233], v[232:233], 0.5 op_sel_hi:[1,0]
    v_pk_mul_f32 v[236:237], v[236:237], 0.5 op_sel_hi:[1,0]
    v_pk_mul_f32 v[234:235], v[234:235], 0.5 op_sel_hi:[1,0]
    v_pk_mul_f32 v[238:239], v[238:239], 0.5 op_sel_hi:[1,0]
    ds_write2st64_b32 v4, v224, v228 offset0:0 offset1:40
    ds_write2st64_b32 v4, v200, v201 offset0:80 offset1:120
    ds_write2st64_b32 v4, v225, v229 offset0:1 offset1:41
    ds_write2st64_b32 v4, v202, v203 offset0:81 offset1:121
    ds_write2st64_b32 v4, v226, v230 offset0:8 offset1:48
    ds_write2st64_b32 v4, v204, v205 offset0:88 offset1:128
    ds_write2st64_b32 v4, v227, v231 offset0:9 offset1:49
    ds_write2st64_b32 v4, v206, v207 offset0:89 offset1:129
    ds_write2st64_b32 v4, v232, v236 offset0:16 offset1:56
    ds_write2st64_b32 v4, v208, v209 offset0:96 offset1:136
    ds_write2st64_b32 v4, v233, v237 offset0:17 offset1:57
    ds_write2st64_b32 v4, v210, v211 offset0:97 offset1:137
    ds_write2st64_b32 v4, v234, v238 offset0:24 offset1:64
    ds_write2st64_b32 v4, v212, v213 offset0:104 offset1:144
    ds_write2st64_b32 v4, v235, v239 offset0:25 offset1:65
    ds_write2st64_b32 v4, v214, v215 offset0:105 offset1:145
    ds_write2st64_b32 v4, v224, v228 offset0:32 offset1:72
    ds_write2st64_b32 v4, v200, v201 offset0:112 offset1:152
    s_waitcnt vmcnt(0)
    v_lshlrev_b32 v6, 16, v184
    v_and_b32 v7, 0xffff0000, v184
    v_mul_f32 v6, 4.0, v6
    v_mul_f32 v7, 4.0, v7
    v_mul_f32 v8, v6, v240
    v_mul_f32 v9, v6, v244
    v_fma_f32 v8, -v7, v244, v8
    v_fma_f32 v9, v7, v240, v9
    v_cvt_pk_bf16_f32 v8, v8, -v9
    v_accvgpr_write_b32 a160, v8
    v_lshlrev_b32_e64 v6, 16, v186
    v_and_b32 v7, 0xffff0000, v186
    v_mul_f32 v6, 4.0, v6
    v_mul_f32 v7, 4.0, v7
    v_mul_f32 v8, v6, v241
    v_mul_f32 v9, v6, v245
    v_fma_f32 v8, -v7, v245, v8
    v_fma_f32 v9, v7, v241, v9
    v_cvt_pk_bf16_f32 v8, v8, -v9
    v_accvgpr_write_b32 a161, v8
    v_lshlrev_b32_e64 v6, 16, v188
    v_and_b32 v7, 0xffff0000, v188
    v_mul_f32 v6, 4.0, v6
    v_mul_f32 v7, 4.0, v7
    v_mul_f32 v8, v6, v242
    v_mul_f32 v9, v6, v246
    v_fma_f32 v8, -v7, v246, v8
    v_fma_f32 v9, v7, v242, v9
    v_cvt_pk_bf16_f32 v8, v8, -v9
    v_accvgpr_write_b32 a162, v8
    v_lshlrev_b32_e64 v6, 16, v190
    v_and_b32 v7, 0xffff0000, v190
    v_mul_f32 v6, 4.0, v6
    v_mul_f32 v7, 4.0, v7
    v_mul_f32 v8, v6, v243
    v_mul_f32 v9, v6, v247
    v_fma_f32 v8, -v7, v247, v8
    v_fma_f32 v9, v7, v243, v9
    v_cvt_pk_bf16_f32 v8, v8, -v9
    v_accvgpr_write_b32 a163, v8
    v_lshlrev_b32_e64 v6, 16, v192
    v_and_b32 v7, 0xffff0000, v192
    v_mul_f32 v6, 4.0, v6
    v_mul_f32 v7, 4.0, v7
    v_mul_f32 v8, v6, v248
    v_mul_f32 v9, v6, v252
    v_fma_f32 v8, -v7, v252, v8
    v_fma_f32 v9, v7, v248, v9
    v_cvt_pk_bf16_f32 v8, v8, -v9
    v_accvgpr_write_b32 a164, v8
    v_lshlrev_b32_e64 v6, 16, v194
    v_and_b32 v7, 0xffff0000, v194
    v_mul_f32 v6, 4.0, v6
    v_mul_f32 v7, 4.0, v7
    v_mul_f32 v8, v6, v249
    v_mul_f32 v9, v6, v253
    v_fma_f32 v8, -v7, v253, v8
    v_fma_f32 v9, v7, v249, v9
    v_cvt_pk_bf16_f32 v8, v8, -v9
    v_accvgpr_write_b32 a165, v8
    v_lshlrev_b32_e64 v6, 16, v196
    v_and_b32 v7, 0xffff0000, v196
    v_mul_f32 v6, 4.0, v6
    v_mul_f32 v7, 4.0, v7
    v_mul_f32 v8, v6, v250
    v_mul_f32 v9, v6, v254
    v_fma_f32 v8, -v7, v254, v8
    v_fma_f32 v9, v7, v250, v9
    v_cvt_pk_bf16_f32 v8, v8, -v9
    v_accvgpr_write_b32 a166, v8
    v_lshlrev_b32_e64 v6, 16, v198
    v_and_b32 v7, 0xffff0000, v198
    v_mul_f32 v6, 4.0, v6
    v_mul_f32 v7, 4.0, v7
    v_mul_f32 v8, v6, v251
    v_mul_f32 v9, v6, v255
    v_fma_f32 v8, -v7, v255, v8
    v_fma_f32 v9, v7, v251, v9
    v_cvt_pk_bf16_f32 v8, v8, -v9
    v_accvgpr_write_b32 a167, v8
    s_waitcnt lgkmcnt(0)
    s_barrier
    ds_read2st64_b32 v[240:241], v5 offset0:25 offset1:24
    ds_read2st64_b32 v[244:245], v5 offset0:65 offset1:64
    ds_read2st64_b32 v[184:185], v5 offset0:105 offset1:104
    ds_read2st64_b32 v[186:187], v5 offset0:145 offset1:144
    ds_read2st64_b32 v[242:243], v5 offset0:17 offset1:16
    ds_read2st64_b32 v[246:247], v5 offset0:57 offset1:56
    ds_read2st64_b32 v[188:189], v5 offset0:97 offset1:96
    ds_read2st64_b32 v[190:191], v5 offset0:137 offset1:136
    ds_read2st64_b32 v[248:249], v5 offset0:9 offset1:8
    ds_read2st64_b32 v[252:253], v5 offset0:49 offset1:48
    ds_read2st64_b32 v[192:193], v5 offset0:89 offset1:88
    ds_read2st64_b32 v[194:195], v5 offset0:129 offset1:128
    ds_read2st64_b32 v[250:251], v5 offset0:1 offset1:0
    ds_read2st64_b32 v[254:255], v5 offset0:41 offset1:40
    ds_read2st64_b32 v[196:197], v5 offset0:81 offset1:80
    ds_read2st64_b32 v[198:199], v5 offset0:121 offset1:120
    s_waitcnt lgkmcnt(0)
    v_xor_b32 v244, 0x80000000, v244
    v_lshlrev_b32 v6, 16, v184
    v_and_b32 v7, 0xffff0000, v184
    v_add_f32 v152, v152, v6
    v_sub_f32 v160, v160, v7
    v_lshlrev_b32_e64 v6, 16, v186
    v_and_b32 v7, 0xffff0000, v186
    v_add_f32 v168, v168, v6
    v_sub_f32 v176, v176, v7
    v_xor_b32 v245, 0x80000000, v245
    v_lshlrev_b32_e64 v6, 16, v185
    v_and_b32 v7, 0xffff0000, v185
    v_add_f32 v153, v153, v6
    v_sub_f32 v161, v161, v7
    v_lshlrev_b32_e64 v6, 16, v187
    v_and_b32 v7, 0xffff0000, v187
    v_add_f32 v169, v169, v6
    v_sub_f32 v177, v177, v7
    v_xor_b32 v246, 0x80000000, v246
    v_lshlrev_b32_e64 v6, 16, v188
    v_and_b32 v7, 0xffff0000, v188
    v_add_f32 v154, v154, v6
    v_sub_f32 v162, v162, v7
    v_lshlrev_b32_e64 v6, 16, v190
    v_and_b32 v7, 0xffff0000, v190
    v_add_f32 v170, v170, v6
    v_sub_f32 v178, v178, v7
    v_xor_b32 v247, 0x80000000, v247
    v_lshlrev_b32_e64 v6, 16, v189
    v_and_b32 v7, 0xffff0000, v189
    v_add_f32 v155, v155, v6
    v_sub_f32 v163, v163, v7
    v_lshlrev_b32_e64 v6, 16, v191
    v_and_b32 v7, 0xffff0000, v191
    v_add_f32 v171, v171, v6
    v_sub_f32 v179, v179, v7
    v_xor_b32 v252, 0x80000000, v252
    v_lshlrev_b32_e64 v6, 16, v192
    v_and_b32 v7, 0xffff0000, v192
    v_add_f32 v156, v156, v6
    v_sub_f32 v164, v164, v7
    v_lshlrev_b32_e64 v6, 16, v194
    v_and_b32 v7, 0xffff0000, v194
    v_add_f32 v172, v172, v6
    v_sub_f32 v180, v180, v7
    v_xor_b32 v253, 0x80000000, v253
    v_lshlrev_b32_e64 v6, 16, v193
    v_and_b32 v7, 0xffff0000, v193
    v_add_f32 v157, v157, v6
    v_sub_f32 v165, v165, v7
    v_lshlrev_b32_e64 v6, 16, v195
    v_and_b32 v7, 0xffff0000, v195
    v_add_f32 v173, v173, v6
    v_sub_f32 v181, v181, v7
    v_xor_b32 v254, 0x80000000, v254
    v_lshlrev_b32_e64 v6, 16, v196
    v_and_b32 v7, 0xffff0000, v196
    v_add_f32 v158, v158, v6
    v_sub_f32 v166, v166, v7
    v_lshlrev_b32_e64 v6, 16, v198
    v_and_b32 v7, 0xffff0000, v198
    v_add_f32 v174, v174, v6
    v_sub_f32 v182, v182, v7
    v_xor_b32 v255, 0x80000000, v255
    v_lshlrev_b32_e64 v6, 16, v197
    v_and_b32 v7, 0xffff0000, v197
    v_add_f32 v159, v159, v6
    v_sub_f32 v167, v167, v7
    v_lshlrev_b32_e64 v6, 16, v199
    v_and_b32 v7, 0xffff0000, v199
    v_add_f32 v175, v175, v6
    v_sub_f32 v183, v183, v7
    s_add_u32 s38, s62, 1
    v_mov_b32 v6, s38
    v_mov_b32 v7, 28598272
    buffer_store_dword v6, v7, s[24:27], 0 offen sc1
K1_NOSPECIAL:
    s_nop 7
    s_nop 0
    v_pk_add_f32 v[4:5], v[224:225], v[240:241] neg_lo:[0,1] neg_hi:[0,1]
    v_pk_add_f32 v[6:7], v[228:229], v[244:245] neg_lo:[0,1] neg_hi:[0,1]
    v_pk_add_f32 v[224:225], v[224:225], v[240:241]
    v_pk_add_f32 v[228:229], v[228:229], v[244:245]
    v_pk_mul_f32 v[8:9], v[4:5], s[42:43] op_sel_hi:[1,0]
    v_pk_mul_f32 v[10:11], v[6:7], s[42:43] op_sel_hi:[1,0]
    v_pk_fma_f32 v[8:9], v[6:7], s[42:43], v[8:9] op_sel:[0,1,0] neg_lo:[1,0,0] neg_hi:[1,0,0]
    v_pk_fma_f32 v[10:11], v[4:5], s[42:43], v[10:11] op_sel:[0,1,0]
    v_pk_add_f32 v[240:241], v[224:225], v[8:9] neg_lo:[0,1] neg_hi:[0,1]
    v_pk_add_f32 v[244:245], v[228:229], v[10:11] neg_lo:[0,1] neg_hi:[0,1]
    v_pk_add_f32 v[224:225], v[224:225], v[8:9]
    v_pk_add_f32 v[228:229], v[228:229], v[10:11]
    v_pk_mul_f32 v[4:5], v[224:225], v[152:153]
    v_pk_mul_f32 v[6:7], v[228:229], v[152:153]
    v_pk_mul_f32 v[8:9], v[240:241], v[168:169]
    v_pk_mul_f32 v[10:11], v[244:245], v[168:169]
    v_pk_fma_f32 v[4:5], v[228:229], v[160:161], v[4:5] neg_lo:[1,0,0] neg_hi:[1,0,0]
    v_pk_fma_f32 v[6:7], v[224:225], v[160:161], v[6:7]
    v_pk_fma_f32 v[8:9], v[244:245], v[176:177], v[8:9]
    v_pk_fma_f32 v[10:11], v[240:241], v[176:177], v[10:11] neg_lo:[1,0,0] neg_hi:[1,0,0]
    v_pk_add_f32 v[240:241], v[4:5], v[8:9] neg_lo:[0,1] neg_hi:[0,1]
    v_pk_add_f32 v[244:245], v[6:7], v[10:11] neg_lo:[0,1] neg_hi:[0,1]
    v_pk_add_f32 v[224:225], v[4:5], v[8:9]
    v_pk_add_f32 v[228:229], v[6:7], v[10:11]
    v_pk_mul_f32 v[4:5], v[240:241], s[42:43] op_sel_hi:[1,0]
    v_pk_mul_f32 v[6:7], v[244:245], s[42:43] op_sel_hi:[1,0]
    v_pk_fma_f32 v[4:5], v[244:245], s[42:43], v[4:5] op_sel:[0,1,0]
    v_pk_fma_f32 v[6:7], v[240:241], s[42:43], v[6:7] op_sel:[0,1,0] neg_lo:[1,0,0] neg_hi:[1,0,0]
    v_pk_add_f32 v[240:241], v[224:225], v[4:5] neg_lo:[0,1] neg_hi:[0,1]
    v_pk_add_f32 v[244:245], v[228:229], v[6:7] neg_lo:[0,1] neg_hi:[0,1]
    v_pk_add_f32 v[224:225], v[224:225], v[4:5]
    v_pk_add_f32 v[228:229], v[228:229], v[6:7]
    v_cvt_pk_bf16_f32 v184, v224, -v228
    v_cvt_pk_bf16_f32 v185, v225, -v229
    v_cvt_pk_bf16_f32 v192, v240, -v244
    v_cvt_pk_bf16_f32 v193, v241, -v245
    v_pk_add_f32 v[4:5], v[226:227], v[242:243] neg_lo:[0,1] neg_hi:[0,1]
    v_pk_add_f32 v[6:7], v[230:231], v[246:247] neg_lo:[0,1] neg_hi:[0,1]
    v_pk_add_f32 v[226:227], v[226:227], v[242:243]
    v_pk_add_f32 v[230:231], v[230:231], v[246:247]
    v_pk_mul_f32 v[8:9], v[4:5], s[42:43] op_sel_hi:[1,0]
    v_pk_mul_f32 v[10:11], v[6:7], s[42:43] op_sel_hi:[1,0]
    v_pk_fma_f32 v[8:9], v[6:7], s[42:43], v[8:9] op_sel:[0,1,0] neg_lo:[1,0,0] neg_hi:[1,0,0]
    v_pk_fma_f32 v[10:11], v[4:5], s[42:43], v[10:11] op_sel:[0,1,0]
    v_pk_add_f32 v[242:243], v[226:227], v[8:9] neg_lo:[0,1] neg_hi:[0,1]
    v_pk_add_f32 v[246:247], v[230:231], v[10:11] neg_lo:[0,1] neg_hi:[0,1]
    v_pk_add_f32 v[226:227], v[226:227], v[8:9]
    v_pk_add_f32 v[230:231], v[230:231], v[10:11]
    v_pk_mul_f32 v[4:5], v[226:227], v[154:155]
    v_pk_mul_f32 v[6:7], v[230:231], v[154:155]
    v_pk_mul_f32 v[8:9], v[242:243], v[170:171]
    v_pk_mul_f32 v[10:11], v[246:247], v[170:171]
    v_pk_fma_f32 v[4:5], v[230:231], v[162:163], v[4:5] neg_lo:[1,0,0] neg_hi:[1,0,0]
    v_pk_fma_f32 v[6:7], v[226:227], v[162:163], v[6:7]
    v_pk_fma_f32 v[8:9], v[246:247], v[178:179], v[8:9]
    v_pk_fma_f32 v[10:11], v[242:243], v[178:179], v[10:11] neg_lo:[1,0,0] neg_hi:[1,0,0]
    v_pk_add_f32 v[242:243], v[4:5], v[8:9] neg_lo:[0,1] neg_hi:[0,1]
    v_pk_add_f32 v[246:247], v[6:7], v[10:11] neg_lo:[0,1] neg_hi:[0,1]
    v_pk_add_f32 v[226:227], v[4:5], v[8:9]
    v_pk_add_f32 v[230:231], v[6:7], v[10:11]
    v_pk_mul_f32 v[4:5], v[242:243], s[42:43] op_sel_hi:[1,0]
    v_pk_mul_f32 v[6:7], v[246:247], s[42:43] op_sel_hi:[1,0]
    v_pk_fma_f32 v[4:5], v[246:247], s[42:43], v[4:5] op_sel:[0,1,0]
    v_pk_fma_f32 v[6:7], v[242:243], s[42:43], v[6:7] op_sel:[0,1,0] neg_lo:[1,0,0] neg_hi:[1,0,0]
    v_pk_add_f32 v[242:243], v[226:227], v[4:5] neg_lo:[0,1] neg_hi:[0,1]
    v_pk_add_f32 v[246:247], v[230:231], v[6:7] neg_lo:[0,1] neg_hi:[0,1]
    v_pk_add_f32 v[226:227], v[226:227], v[4:5]
    v_pk_add_f32 v[230:231], v[230:231], v[6:7]
    v_cvt_pk_bf16_f32 v186, v226, -v230
    v_cvt_pk_bf16_f32 v187, v227, -v231
    v_cvt_pk_bf16_f32 v194, v242, -v246
    v_cvt_pk_bf16_f32 v195, v243, -v247
    v_pk_add_f32 v[4:5], v[232:233], v[248:249] neg_lo:[0,1] neg_hi:[0,1]
    v_pk_add_f32 v[6:7], v[236:237], v[252:253] neg_lo:[0,1] neg_hi:[0,1]
    v_pk_add_f32 v[232:233], v[232:233], v[248:249]
    v_pk_add_f32 v[236:237], v[236:237], v[252:253]
    v_pk_mul_f32 v[8:9], v[4:5], s[42:43] op_sel_hi:[1,0]
    v_pk_mul_f32 v[10:11], v[6:7], s[42:43] op_sel_hi:[1,0]
    v_pk_fma_f32 v[8:9], v[6:7], s[42:43], v[8:9] op_sel:[0,1,0] neg_lo:[1,0,0] neg_hi:[1,0,0]
    v_pk_fma_f32 v[10:11], v[4:5], s[42:43], v[10:11] op_sel:[0,1,0]
    v_pk_add_f32 v[248:249], v[232:233], v[8:9] neg_lo:[0,1] neg_hi:[0,1]
    v_pk_add_f32 v[252:253], v[236:237], v[10:11] neg_lo:[0,1] neg_hi:[0,1]
    v_pk_add_f32 v[232:233], v[232:233], v[8:9]
    v_pk_add_f32 v[236:237], v[236:237], v[10:11]
    v_pk_mul_f32 v[4:5], v[232:233], v[156:157]
    v_pk_mul_f32 v[6:7], v[236:237], v[156:157]
    v_pk_mul_f32 v[8:9], v[248:249], v[172:173]
    v_pk_mul_f32 v[10:11], v[252:253], v[172:173]
    v_pk_fma_f32 v[4:5], v[236:237], v[164:165], v[4:5] neg_lo:[1,0,0] neg_hi:[1,0,0]
    v_pk_fma_f32 v[6:7], v[232:233], v[164:165], v[6:7]
    v_pk_fma_f32 v[8:9], v[252:253], v[180:181], v[8:9]
    v_pk_fma_f32 v[10:11], v[248:249], v[180:181], v[10:11] neg_lo:[1,0,0] neg_hi:[1,0,0]
    v_pk_add_f32 v[248:249], v[4:5], v[8:9] neg_lo:[0,1] neg_hi:[0,1]
    v_pk_add_f32 v[252:253], v[6:7], v[10:11] neg_lo:[0,1] neg_hi:[0,1]
    v_pk_add_f32 v[232:233], v[4:5], v[8:9]
    v_pk_add_f32 v[236:237], v[6:7], v[10:11]
    v_pk_mul_f32 v[4:5], v[248:249], s[42:43] op_sel_hi:[1,0]
    v_pk_mul_f32 v[6:7], v[252:253], s[42:43] op_sel_hi:[1,0]
    v_pk_fma_f32 v[4:5], v[252:253], s[42:43], v[4:5] op_sel:[0,1,0]
    v_pk_fma_f32 v[6:7], v[248:249], s[42:43], v[6:7] op_sel:[0,1,0] neg_lo:[1,0,0] neg_hi:[1,0,0]
    v_pk_add_f32 v[248:249], v[232:233], v[4:5] neg_lo:[0,1] neg_hi:[0,1]
    v_pk_add_f32 v[252:253], v[236:237], v[6:7] neg_lo:[0,1] neg_hi:[0,1]
    v_pk_add_f32 v[232:233], v[232:233], v[4:5]
    v_pk_add_f32 v[236:237], v[236:237], v[6:7]
    v_cvt_pk_bf16_f32 v188, v232, -v236
    v_cvt_pk_bf16_f32 v189, v233, -v237
    v_cvt_pk_bf16_f32 v196, v248, -v252
    v_cvt_pk_bf16_f32 v197, v249, -v253
    v_pk_add_f32 v[4:5], v[234:235], v[250:251] neg_lo:[0,1] neg_hi:[0,1]
    v_pk_add_f32 v[6:7], v[238:239], v[254:255] neg_lo:[0,1] neg_hi:[0,1]
    v_pk_add_f32 v[234:235], v[234:235], v[250:251]
    v_pk_add_f32 v[238:239], v[238:239], v[254:255]
    v_pk_mul_f32 v[8:9], v[4:5], s[42:43] op_sel_hi:[1,0]
    v_pk_mul_f32 v[10:11], v[6:7], s[42:43] op_sel_hi:[1,0]
    v_pk_fma_f32 v[8:9], v[6:7], s[42:43], v[8:9] op_sel:[0,1,0] neg_lo:[1,0,0] neg_hi:[1,0,0]
    v_pk_fma_f32 v[10:11], v[4:5], s[42:43], v[10:11] op_sel:[0,1,0]
    v_pk_add_f32 v[250:251], v[234:235], v[8:9] neg_lo:[0,1] neg_hi:[0,1]
    v_pk_add_f32 v[254:255], v[238:239], v[10:11] neg_lo:[0,1] neg_hi:[0,1]
    v_pk_add_f32 v[234:235], v[234:235], v[8:9]
    v_pk_add_f32 v[238:239], v[238:239], v[10:11]
    v_pk_mul_f32 v[4:5], v[234:235], v[158:159]
    v_pk_mul_f32 v[6:7], v[238:239], v[158:159]
    v_pk_mul_f32 v[8:9], v[250:251], v[174:175]
    v_pk_mul_f32 v[10:11], v[254:255], v[174:175]
    v_pk_fma_f32 v[4:5], v[238:239], v[166:167], v[4:5] neg_lo:[1,0,0] neg_hi:[1,0,0]
    v_pk_fma_f32 v[6:7], v[234:235], v[166:167], v[6:7]
    v_pk_fma_f32 v[8:9], v[254:255], v[182:183], v[8:9]
    v_pk_fma_f32 v[10:11], v[250:251], v[182:183], v[10:11] neg_lo:[1,0,0] neg_hi:[1,0,0]
    v_pk_add_f32 v[250:251], v[4:5], v[8:9] neg_lo:[0,1] neg_hi:[0,1]
    v_pk_add_f32 v[254:255], v[6:7], v[10:11] neg_lo:[0,1] neg_hi:[0,1]
    v_pk_add_f32 v[234:235], v[4:5], v[8:9]
    v_pk_add_f32 v[238:239], v[6:7], v[10:11]
    v_pk_mul_f32 v[4:5], v[250:251], s[42:43] op_sel_hi:[1,0]
    v_pk_mul_f32 v[6:7], v[254:255], s[42:43] op_sel_hi:[1,0]
    v_pk_fma_f32 v[4:5], v[254:255], s[42:43], v[4:5] op_sel:[0,1,0]
    v_pk_fma_f32 v[6:7], v[250:251], s[42:43], v[6:7] op_sel:[0,1,0] neg_lo:[1,0,0] neg_hi:[1,0,0]
    v_pk_add_f32 v[250:251], v[234:235], v[4:5] neg_lo:[0,1] neg_hi:[0,1]
    v_pk_add_f32 v[254:255], v[238:239], v[6:7] neg_lo:[0,1] neg_hi:[0,1]
    v_pk_add_f32 v[234:235], v[234:235], v[4:5]
    v_pk_add_f32 v[238:239], v[238:239], v[6:7]
    v_cvt_pk_bf16_f32 v190, v234, -v238
    v_cvt_pk_bf16_f32 v191, v235, -v239
    v_cvt_pk_bf16_f32 v198, v250, -v254
    v_cvt_pk_bf16_f32 v199, v251, -v255
    s_cmp_lg_u32 s2, 0
    s_cbranch_scc1 K1_NOSPECIAL2
    v_accvgpr_read_b32 v192, a160
    v_accvgpr_read_b32 v193, a161
    v_accvgpr_read_b32 v194, a162
    v_accvgpr_read_b32 v195, a163
    v_accvgpr_read_b32 v196, a164
    v_accvgpr_read_b32 v197, a165
    v_accvgpr_read_b32 v198, a166
    v_accvgpr_read_b32 v199, a167
K1_NOSPECIAL2:
    s_nop 1
    s_lshl_b32 s40, s33, 14
    s_lshl_b32 s39, s34, 8
    s_add_u32 s40, s40, s39
    s_add_u32 s40, s40, 28311552
    v_lshlrev_b32 v4, 2, v2
    v_sub_u32 v4, s32, v4
    v_subrev_u32 v5, 1, v4
    v_cmp_le_i32 vcc, 0, v5
    v_lshlrev_b32_e64 v5, 10, v5
    v_lshl_add_u32 v5, v1, 4, v5
    v_cndmask_b32 v152, 2.0, v5, vcc
    v_subrev_u32 v5, 2, v4
    v_cmp_le_i32 vcc, 0, v5
    v_lshlrev_b32 v5, 10, v5
    v_lshl_add_u32 v5, v1, 4, v5
    v_cndmask_b32 v153, 2.0, v5, vcc
    v_subrev_u32 v5, 3, v4
    v_cmp_le_i32 vcc, 0, v5
    v_lshlrev_b32 v5, 10, v5
    v_lshl_add_u32 v5, v1, 4, v5
    v_cndmask_b32 v154, 2.0, v5, vcc
    v_subrev_u32 v5, 4, v4
    v_cmp_le_i32 vcc, 0, v5
    v_lshlrev_b32 v5, 10, v5
    v_lshl_add_u32 v5, v1, 4, v5
    v_cndmask_b32_e64 v155, 2.0, v5, vcc
    v_mfma_f32_16x16x32_bf16 v[224:227], v[184:187], a[0:3], 0
    buffer_load_dwordx4 v[200:203], v152, s[24:27], s40 offen sc1
    v_mfma_f32_16x16x32_bf16 v[228:231], v[184:187], a[4:7], 0
    buffer_load_dwordx4 v[204:207], v153, s[24:27], s40 offen sc1
    v_mfma_f32_16x16x32_bf16 v[232:235], v[184:187], a[16:19], 0
    buffer_load_dwordx4 v[208:211], v154, s[24:27], s40 offen sc1
    v_mfma_f32_16x16x32_bf16 v[236:239], v[184:187], a[20:23], 0
    buffer_load_dwordx4 v[212:215], v155, s[24:27], s40 offen sc1
    v_mfma_f32_16x16x32_bf16 v[240:243], v[192:195], a[0:3], 0
    v_bfe_u32 v12, v1, 1, 1
    v_mfma_f32_16x16x32_bf16 v[244:247], v[192:195], a[4:7], 0
    v_mul_u32_u24 v12, 4112, v12
    v_mfma_f32_16x16x32_bf16 v[248:251], v[192:195], a[16:19], 0
    v_and_b32_e64 v13, 1, v1
    v_mfma_f32_16x16x32_bf16 v[252:255], v[192:195], a[20:23], 0
    v_lshl_add_u32 v12, v13, 5, v12
    v_mfma_f32_16x16x32_bf16 v[224:227], v[188:191], a[8:11], v[224:227]
    v_and_b32_e64 v13, 60, v0
    v_mfma_f32_16x16x32_bf16 v[228:231], v[188:191], a[12:15], v[228:231]
    v_lshl_add_u32 v12, v13, 4, v12
    v_mfma_f32_16x16x32_bf16 v[232:235], v[188:191], a[24:27], v[232:235]
    s_lshl_b32 s38, s34, 10
    v_mfma_f32_16x16x32_bf16 v[236:239], v[188:191], a[28:31], v[236:239]
    v_add_u32 v12, s38, v12
    v_mfma_f32_16x16x32_bf16 v[240:243], v[196:199], a[8:11], v[240:243]
    v_mfma_f32_16x16x32_bf16 v[244:247], v[196:199], a[12:15], v[244:247]
    v_mfma_f32_16x16x32_bf16 v[248:251], v[196:199], a[24:27], v[248:251]
    v_mfma_f32_16x16x32_bf16 v[252:255], v[196:199], a[28:31], v[252:255]
    v_pk_mul_f32 v[4:5], v[224:225], v[112:113]
    v_pk_mul_f32 v[6:7], v[228:229], v[112:113]
    v_pk_fma_f32 v[4:5], v[228:229], v[116:117], v[4:5]
    v_pk_fma_f32 v[6:7], v[224:225], v[116:117], v[6:7] neg_lo:[1,0,0] neg_hi:[1,0,0]
    v_pk_mul_f32 v[8:9], v[226:227], v[114:115]
    v_pk_mul_f32 v[10:11], v[230:231], v[114:115]
    v_pk_fma_f32 v[8:9], v[230:231], v[118:119], v[8:9]
    v_pk_fma_f32 v[10:11], v[226:227], v[118:119], v[10:11] neg_lo:[1,0,0] neg_hi:[1,0,0]
    v_cvt_pk_bf16_f32 v184, v4, v6
    v_cvt_pk_bf16_f32 v185, v5, v7
    v_cvt_pk_bf16_f32 v186, v8, v10
    v_cvt_pk_bf16_f32 v187, v9, v11
    ds_write_b128 v12, v[184:187] offset:0
    v_pk_mul_f32 v[4:5], v[232:233], v[120:121]
    v_pk_mul_f32 v[6:7], v[236:237], v[120:121]
    v_pk_fma_f32 v[4:5], v[236:237], v[124:125], v[4:5]
    v_pk_fma_f32 v[6:7], v[232:233], v[124:125], v[6:7] neg_lo:[1,0,0] neg_hi:[1,0,0]
    v_pk_mul_f32 v[8:9], v[234:235], v[122:123]
    v_pk_mul_f32 v[10:11], v[238:239], v[122:123]
    v_pk_fma_f32 v[8:9], v[238:239], v[126:127], v[8:9]
    v_pk_fma_f32 v[10:11], v[234:235], v[126:127], v[10:11] neg_lo:[1,0,0] neg_hi:[1,0,0]
    v_cvt_pk_bf16_f32 v188, v4, v6
    v_cvt_pk_bf16_f32 v189, v5, v7
    v_cvt_pk_bf16_f32 v190, v8, v10
    v_cvt_pk_bf16_f32 v191, v9, v11
    ds_write_b128 v12, v[188:191] offset:8224
    v_pk_mul_f32 v[4:5], v[240:241], v[112:113]
    v_pk_mul_f32 v[6:7], v[244:245], v[112:113]
    v_pk_fma_f32 v[4:5], v[244:245], v[116:117], v[4:5]
    v_pk_fma_f32 v[6:7], v[240:241], v[116:117], v[6:7] neg_lo:[1,0,0] neg_hi:[1,0,0]
    v_pk_mul_f32 v[8:9], v[242:243], v[114:115]
    v_pk_mul_f32 v[10:11], v[246:247], v[114:115]
    v_pk_fma_f32 v[8:9], v[246:247], v[118:119], v[8:9]
    v_pk_fma_f32 v[10:11], v[242:243], v[118:119], v[10:11] neg_lo:[1,0,0] neg_hi:[1,0,0]
    v_cvt_pk_bf16_f32 v192, v4, v6
    v_cvt_pk_bf16_f32 v193, v5, v7
    v_cvt_pk_bf16_f32 v194, v8, v10
    v_cvt_pk_bf16_f32 v195, v9, v11
    ds_write_b128 v12, v[192:195] offset:16
    v_pk_mul_f32 v[4:5], v[248:249], v[120:121]
    v_pk_mul_f32 v[6:7], v[252:253], v[120:121]
    v_pk_fma_f32 v[4:5], v[252:253], v[124:125], v[4:5]
    v_pk_fma_f32 v[6:7], v[248:249], v[124:125], v[6:7] neg_lo:[1,0,0] neg_hi:[1,0,0]
    v_pk_mul_f32 v[8:9], v[250:251], v[122:123]
    v_pk_mul_f32 v[10:11], v[254:255], v[122:123]
    v_pk_fma_f32 v[8:9], v[254:255], v[126:127], v[8:9]
    v_pk_fma_f32 v[10:11], v[250:251], v[126:127], v[10:11] neg_lo:[1,0,0] neg_hi:[1,0,0]
    v_cvt_pk_bf16_f32 v196, v4, v6
    v_cvt_pk_bf16_f32 v197, v5, v7
    v_cvt_pk_bf16_f32 v198, v8, v10
    v_cvt_pk_bf16_f32 v199, v9, v11
    ds_write_b128 v12, v[196:199] offset:8240
    s_waitcnt lgkmcnt(0)
    s_barrier
    ds_read_b128 a[72:75], v3 offset:0
    ds_read_b128 a[76:79], v3 offset:1024
    ds_read_b128 a[80:83], v3 offset:2048
    ds_read_b128 a[84:87], v3 offset:3072
    ds_read_b128 a[88:91], v3 offset:4112
    ds_read_b128 a[92:95], v3 offset:5136
    ds_read_b128 a[96:99], v3 offset:6160
    ds_read_b128 a[100:103], v3 offset:7184
    ds_read_b128 a[104:107], v3 offset:8224
    ds_read_b128 a[108:111], v3 offset:9248
    ds_read_b128 a[112:115], v3 offset:10272
    ds_read_b128 a[116:119], v3 offset:11296
    ds_read_b128 a[120:123], v3 offset:12336
    ds_read_b128 a[124:127], v3 offset:13360
    ds_read_b128 a[128:131], v3 offset:14384
    ds_read_b128 a[132:135], v3 offset:15408
    v_pk_mul_f32 v[4:5], v[36:37], v[130:131] op_sel:[0,1]
    v_pk_mul_f32 v[6:7], v[32:33], v[130:131] op_sel:[0,1]
    v_pk_fma_f32 v[32:33], v[32:33], v[130:131], v[4:5] op_sel_hi:[1,0,1] neg_lo:[0,0,1] neg_hi:[0,0,1]
    v_pk_fma_f32 v[36:37], v[36:37], v[130:131], v[6:7] op_sel_hi:[1,0,1]
    v_pk_mul_f32 v[8:9], v[38:39], v[130:131] op_sel:[0,1]
    v_pk_mul_f32 v[10:11], v[34:35], v[130:131] op_sel:[0,1]
    v_pk_fma_f32 v[34:35], v[34:35], v[130:131], v[8:9] op_sel_hi:[1,0,1] neg_lo:[0,0,1] neg_hi:[0,0,1]
    v_pk_fma_f32 v[38:39], v[38:39], v[130:131], v[10:11] op_sel_hi:[1,0,1]
    v_pk_mul_f32 v[4:5], v[44:45], v[130:131] op_sel:[0,1]
    v_pk_mul_f32 v[6:7], v[40:41], v[130:131] op_sel:[0,1]
    v_pk_fma_f32 v[40:41], v[40:41], v[130:131], v[4:5] op_sel_hi:[1,0,1] neg_lo:[0,0,1] neg_hi:[0,0,1]
    v_pk_fma_f32 v[44:45], v[44:45], v[130:131], v[6:7] op_sel_hi:[1,0,1]
    v_pk_mul_f32 v[8:9], v[46:47], v[130:131] op_sel:[0,1]
    v_pk_mul_f32 v[10:11], v[42:43], v[130:131] op_sel:[0,1]
    v_pk_fma_f32 v[42:43], v[42:43], v[130:131], v[8:9] op_sel_hi:[1,0,1] neg_lo:[0,0,1] neg_hi:[0,0,1]
    v_pk_fma_f32 v[46:47], v[46:47], v[130:131], v[10:11] op_sel_hi:[1,0,1]
    v_pk_mul_f32 v[4:5], v[52:53], v[130:131] op_sel:[0,1]
    v_pk_mul_f32 v[6:7], v[48:49], v[130:131] op_sel:[0,1]
    v_pk_fma_f32 v[48:49], v[48:49], v[130:131], v[4:5] op_sel_hi:[1,0,1] neg_lo:[0,0,1] neg_hi:[0,0,1]
    v_pk_fma_f32 v[52:53], v[52:53], v[130:131], v[6:7] op_sel_hi:[1,0,1]
    v_pk_mul_f32 v[8:9], v[54:55], v[130:131] op_sel:[0,1]
    v_pk_mul_f32 v[10:11], v[50:51], v[130:131] op_sel:[0,1]
    v_pk_fma_f32 v[50:51], v[50:51], v[130:131], v[8:9] op_sel_hi:[1,0,1] neg_lo:[0,0,1] neg_hi:[0,0,1]
    v_pk_fma_f32 v[54:55], v[54:55], v[130:131], v[10:11] op_sel_hi:[1,0,1]
    v_pk_mul_f32 v[4:5], v[60:61], v[130:131] op_sel:[0,1]
    v_pk_mul_f32 v[6:7], v[56:57], v[130:131] op_sel:[0,1]
    v_pk_fma_f32 v[56:57], v[56:57], v[130:131], v[4:5] op_sel_hi:[1,0,1] neg_lo:[0,0,1] neg_hi:[0,0,1]
    v_pk_fma_f32 v[60:61], v[60:61], v[130:131], v[6:7] op_sel_hi:[1,0,1]
    v_pk_mul_f32 v[8:9], v[62:63], v[130:131] op_sel:[0,1]
    v_pk_mul_f32 v[10:11], v[58:59], v[130:131] op_sel:[0,1]
    v_pk_fma_f32 v[58:59], v[58:59], v[130:131], v[8:9] op_sel_hi:[1,0,1] neg_lo:[0,0,1] neg_hi:[0,0,1]
    v_pk_fma_f32 v[62:63], v[62:63], v[130:131], v[10:11] op_sel_hi:[1,0,1]
    v_pk_mul_f32 v[4:5], v[68:69], v[130:131] op_sel:[0,1]
    v_pk_mul_f32 v[6:7], v[64:65], v[130:131] op_sel:[0,1]
    v_pk_fma_f32 v[64:65], v[64:65], v[130:131], v[4:5] op_sel_hi:[1,0,1] neg_lo:[0,0,1] neg_hi:[0,0,1]
    v_pk_fma_f32 v[68:69], v[68:69], v[130:131], v[6:7] op_sel_hi:[1,0,1]
    v_pk_mul_f32 v[8:9], v[70:71], v[130:131] op_sel:[0,1]
    v_pk_mul_f32 v[10:11], v[66:67], v[130:131] op_sel:[0,1]
    v_pk_fma_f32 v[66:67], v[66:67], v[130:131], v[8:9] op_sel_hi:[1,0,1] neg_lo:[0,0,1] neg_hi:[0,0,1]
    v_pk_fma_f32 v[70:71], v[70:71], v[130:131], v[10:11] op_sel_hi:[1,0,1]
    v_pk_mul_f32 v[4:5], v[76:77], v[130:131] op_sel:[0,1]
    v_pk_mul_f32 v[6:7], v[72:73], v[130:131] op_sel:[0,1]
    v_pk_fma_f32 v[72:73], v[72:73], v[130:131], v[4:5] op_sel_hi:[1,0,1] neg_lo:[0,0,1] neg_hi:[0,0,1]
    v_pk_fma_f32 v[76:77], v[76:77], v[130:131], v[6:7] op_sel_hi:[1,0,1]
    v_pk_mul_f32 v[8:9], v[78:79], v[130:131] op_sel:[0,1]
    v_pk_mul_f32 v[10:11], v[74:75], v[130:131] op_sel:[0,1]
    v_pk_fma_f32 v[74:75], v[74:75], v[130:131], v[8:9] op_sel_hi:[1,0,1] neg_lo:[0,0,1] neg_hi:[0,0,1]
    v_pk_fma_f32 v[78:79], v[78:79], v[130:131], v[10:11] op_sel_hi:[1,0,1]
    v_pk_mul_f32 v[4:5], v[84:85], v[130:131] op_sel:[0,1]
    v_pk_mul_f32 v[6:7], v[80:81], v[130:131] op_sel:[0,1]
    v_pk_fma_f32 v[80:81], v[80:81], v[130:131], v[4:5] op_sel_hi:[1,0,1] neg_lo:[0,0,1] neg_hi:[0,0,1]
    v_pk_fma_f32 v[84:85], v[84:85], v[130:131], v[6:7] op_sel_hi:[1,0,1]
    v_pk_mul_f32 v[8:9], v[86:87], v[130:131] op_sel:[0,1]
    v_pk_mul_f32 v[10:11], v[82:83], v[130:131] op_sel:[0,1]
    v_pk_fma_f32 v[82:83], v[82:83], v[130:131], v[8:9] op_sel_hi:[1,0,1] neg_lo:[0,0,1] neg_hi:[0,0,1]
    v_pk_fma_f32 v[86:87], v[86:87], v[130:131], v[10:11] op_sel_hi:[1,0,1]
    v_pk_mul_f32 v[4:5], v[92:93], v[130:131] op_sel:[0,1]
    v_pk_mul_f32 v[6:7], v[88:89], v[130:131] op_sel:[0,1]
    v_pk_fma_f32 v[88:89], v[88:89], v[130:131], v[4:5] op_sel_hi:[1,0,1] neg_lo:[0,0,1] neg_hi:[0,0,1]
    v_pk_fma_f32 v[92:93], v[92:93], v[130:131], v[6:7] op_sel_hi:[1,0,1]
    v_pk_mul_f32 v[8:9], v[94:95], v[130:131] op_sel:[0,1]
    v_pk_mul_f32 v[10:11], v[90:91], v[130:131] op_sel:[0,1]
    v_pk_fma_f32 v[90:91], v[90:91], v[130:131], v[8:9] op_sel_hi:[1,0,1] neg_lo:[0,0,1] neg_hi:[0,0,1]
    v_pk_fma_f32 v[94:95], v[94:95], v[130:131], v[10:11] op_sel_hi:[1,0,1]
    v_lshlrev_b32 v12, 4, v2
    v_lshrrev_b32 v13, 2, v1
    v_add_u32 v12, v12, v13
    v_and_b32 v13, 3, v1
    v_lshlrev_b32_e64 v13, 4, v13
    s_mov_b32 s38, 16384
    v_mad_u32_u24 v12, v12, s38, v13
    s_mul_i32 s38, s34, 1048576
    s_lshl_b32 s39, s2, 6
    s_add_u32 s38, s38, s39
    s_add_u32 s38, s38, 10485760
    s_waitcnt lgkmcnt(12)
    s_nop 0
    v_mfma_f32_16x16x32_bf16 v[224:227], a[40:43], a[72:75], 0
    v_mfma_f32_16x16x32_bf16 v[228:231], a[44:47], a[72:75], 0
    v_mfma_f32_16x16x32_bf16 v[224:227], a[48:51], a[76:79], v[224:227]
    v_mfma_f32_16x16x32_bf16 v[228:231], a[52:55], a[76:79], v[228:231]
    v_mfma_f32_16x16x32_bf16 v[224:227], a[56:59], a[80:83], v[224:227]
    v_mfma_f32_16x16x32_bf16 v[228:231], a[60:63], a[80:83], v[228:231]
    v_mfma_f32_16x16x32_bf16 v[224:227], a[64:67], a[84:87], v[224:227]
    v_mfma_f32_16x16x32_bf16 v[228:231], a[68:71], a[84:87], v[228:231]
    s_waitcnt lgkmcnt(8)
    s_nop 0
    v_mfma_f32_16x16x32_bf16 v[232:235], a[40:43], a[88:91], 0
    v_mfma_f32_16x16x32_bf16 v[236:239], a[44:47], a[88:91], 0
    v_mfma_f32_16x16x32_bf16 v[232:235], a[48:51], a[92:95], v[232:235]
    v_mfma_f32_16x16x32_bf16 v[236:239], a[52:55], a[92:95], v[236:239]
    v_mfma_f32_16x16x32_bf16 v[232:235], a[56:59], a[96:99], v[232:235]
    s_nop 1
    s_nop 0
    v_cvt_pk_bf16_f32 v184, v224, v228
    v_cvt_pk_bf16_f32 v185, v225, v229
    v_mfma_f32_16x16x32_bf16 v[236:239], a[60:63], a[96:99], v[236:239]
    v_cvt_pk_bf16_f32 v186, v226, v230
    v_cvt_pk_bf16_f32 v187, v227, v231
    v_mfma_f32_16x16x32_bf16 v[232:235], a[64:67], a[100:103], v[232:235]
    buffer_store_dwordx4 v[184:187], v12, s[24:27], s38 offen
    s_add_u32 s38, s38, 65536
    v_mfma_f32_16x16x32_bf16 v[236:239], a[68:71], a[100:103], v[236:239]
    s_waitcnt lgkmcnt(4)
    s_nop 0
    v_mfma_f32_16x16x32_bf16 v[240:243], a[40:43], a[104:107], 0
    v_mfma_f32_16x16x32_bf16 v[244:247], a[44:47], a[104:107], 0
    v_mfma_f32_16x16x32_bf16 v[240:243], a[48:51], a[108:111], v[240:243]
    v_mfma_f32_16x16x32_bf16 v[244:247], a[52:55], a[108:111], v[244:247]
    v_mfma_f32_16x16x32_bf16 v[240:243], a[56:59], a[112:115], v[240:243]
    s_nop 1
    s_nop 0
    v_cvt_pk_bf16_f32 v188, v232, v236
    v_cvt_pk_bf16_f32 v189, v233, v237
    v_mfma_f32_16x16x32_bf16 v[244:247], a[60:63], a[112:115], v[244:247]
    v_cvt_pk_bf16_f32 v190, v234, v238
    v_cvt_pk_bf16_f32 v191, v235, v239
    v_mfma_f32_16x16x32_bf16 v[240:243], a[64:67], a[116:119], v[240:243]
    buffer_store_dwordx4 v[188:191], v12, s[24:27], s38 offen
    s_add_u32 s38, s38, 65536
    v_mfma_f32_16x16x32_bf16 v[244:247], a[68:71], a[116:119], v[244:247]
    s_waitcnt lgkmcnt(0)
    s_nop 0
    v_mfma_f32_16x16x32_bf16 v[248:251], a[40:43], a[120:123], 0
    v_mfma_f32_16x16x32_bf16 v[252:255], a[44:47], a[120:123], 0
    v_mfma_f32_16x16x32_bf16 v[248:251], a[48:51], a[124:127], v[248:251]
    v_mfma_f32_16x16x32_bf16 v[252:255], a[52:55], a[124:127], v[252:255]
    v_mfma_f32_16x16x32_bf16 v[248:251], a[56:59], a[128:131], v[248:251]
    s_nop 1
    s_nop 0
    v_cvt_pk_bf16_f32 v192, v240, v244
    v_cvt_pk_bf16_f32 v193, v241, v245
    v_mfma_f32_16x16x32_bf16 v[252:255], a[60:63], a[128:131], v[252:255]
    v_cvt_pk_bf16_f32 v194, v242, v246
    v_cvt_pk_bf16_f32 v195, v243, v247
    v_mfma_f32_16x16x32_bf16 v[248:251], a[64:67], a[132:135], v[248:251]
    buffer_store_dwordx4 v[192:195], v12, s[24:27], s38 offen
    s_add_u32 s38, s38, 65536
    v_mfma_f32_16x16x32_bf16 v[252:255], a[68:71], a[132:135], v[252:255]
    s_nop 7
    s_nop 0
    v_cvt_pk_bf16_f32 v196, v248, v252
    v_cvt_pk_bf16_f32 v197, v249, v253
    v_cvt_pk_bf16_f32 v198, v250, v254
    v_cvt_pk_bf16_f32 v199, v251, v255
    buffer_store_dwordx4 v[196:199], v12, s[24:27], s38 offen
    s_waitcnt vmcnt(4)
    s_mov_b32 s39, 0
K1_POLL2:
    v_cmp_ne_u32 vcc, 2.0, v152
    v_xor_b32 v4, s35, v202
    s_nop 0
    v_cndmask_b32 v4, 0, v4, vcc
    v_cmp_ne_u32 vcc, 2.0, v153
    v_xor_b32 v5, s35, v206
    s_nop 0
    v_cndmask_b32 v5, 0, v5, vcc
    v_cmp_ne_u32 vcc, 2.0, v154
    v_xor_b32 v6, s35, v210
    s_nop 0
    v_cndmask_b32 v6, 0, v6, vcc
    v_cmp_ne_u32 vcc, 2.0, v155
    v_xor_b32 v7, s35, v214
    s_nop 0
    v_cndmask_b32 v7, 0, v7, vcc
    v_or3_b32 v4, v4, v5, v6
    v_or_b32 v4, v4, v7
    v_cmp_ne_u32 vcc, 0, v4
    s_nop 0
    s_cbranch_vccz K1_POLL2_OK
    s_sleep 1
    s_nop 0
    buffer_load_dwordx4 v[200:203], v152, s[24:27], s40 offen sc1
    buffer_load_dwordx4 v[204:207], v153, s[24:27], s40 offen sc1
    buffer_load_dwordx4 v[208:211], v154, s[24:27], s40 offen sc1
    buffer_load_dwordx4 v[212:215], v155, s[24:27], s40 offen sc1
    s_add_u32 s39, s39, 1
    s_cmp_lt_u32 s39, 200000
    s_waitcnt vmcnt(0)
    s_cbranch_scc1 K1_POLL2
K1_POLL2_OK:
    s_nop 0
    v_fma_f32 v4, v212, v136, v208
    v_fma_f32 v5, v212, v137, v209
    v_fma_f32 v4, -v213, v137, v4
    v_fma_f32 v5, v213, v136, v5
    v_fma_f32 v6, v4, v136, v204
    v_fma_f32 v7, v4, v137, v205
    v_fma_f32 v6, -v5, v137, v6
    v_fma_f32 v7, v5, v136, v7
    v_fma_f32 v4, v6, v136, v200
    v_fma_f32 v5, v6, v137, v201
    v_fma_f32 v4, -v7, v137, v4
    v_fma_f32 v5, v7, v136, v5
    v_mul_f32 v6, v4, v140
    v_mul_f32 v8, v4, v141
    v_fma_f32 v6, -v5, v141, v6
    v_fma_f32 v8, v5, v140, v8
    v_mov_b32 v7, v6
    v_mov_b32 v9, v8
    s_nop 0
    v_permlane32_swap_b32 v6, v7
    v_permlane32_swap_b32 v8, v9
    v_add_f32 v6, v6, v7
    v_add_f32 v8, v8, v9
    v_mov_b32 v7, v6
    v_mov_b32 v9, v8
    s_nop 0
    v_permlane16_swap_b32 v6, v7
    v_permlane16_swap_b32 v8, v9
    v_add_f32 v6, v6, v7
    v_add_f32 v8, v8, v9
    v_fma_f32 v10, v6, v138, v146
    v_fma_f32 v12, v6, v139, v147
    v_fma_f32 v10, -v8, v139, v10
    v_fma_f32 v12, v8, v138, v12
    v_fma_f32 v11, v10, v132, v142
    v_fma_f32 v13, v10, v133, v144
    v_fma_f32 v11, -v12, v133, v11
    v_fma_f32 v13, v12, v132, v13
    v_and_b32 v14, 8, v1
    v_and_b32 v15, 3, v1
    v_lshl_or_b32 v14, v15, 1, v14
    v_bfe_u32 v15, v1, 2, 1
    v_or_b32 v14, v14, v15
    v_lshlrev_b32 v15, 2, v2
    v_xor_b32 v14, v14, v15
    v_lshlrev_b32 v14, 4, v14
    v_lshl_add_u32 v14, v1, 8, v14
    s_lshl_b32 s38, s34, 13
    s_add_u32 s38, s38, 32768
    v_add_u32 v4, s38, v14
    v_xor_b32 v5, 16, v4
    v_xor_b32 v6, 32, v4
    v_xor_b32 v7, 48, v4
    v_and_b32 v14, 1, v2
    v_lshrrev_b32_e64 v15, 2, v1
    v_lshl_add_u32 v8, v14, 3, v15
    v_lshlrev_b32 v8, 8, v8
    v_lshrrev_b32 v9, 1, v2
    v_lshl_add_u32 v8, v9, 12, v8
    v_lshlrev_b32_e64 v14, 3, v14
    v_lshl_or_b32 v14, v15, 1, v14
    v_bfe_u32 v15, v1, 1, 1
    v_xor_b32_e64 v14, v14, v15
    v_lshl_add_u32 v8, v14, 4, v8
    v_and_b32_e64 v15, 1, v1
    v_lshl_add_u32 v8, v15, 3, v8
    v_add_u32_e64 v8, s38, v8
    v_pk_fma_f32 v[32:33], v[10:11], v[128:129], v[32:33] op_sel_hi:[1,0,1]
    v_pk_fma_f32 v[36:37], v[12:13], v[128:129], v[36:37] op_sel_hi:[1,0,1]
    v_pk_fma_f32 v[32:33], v[12:13], v[128:129], v[32:33] op_sel:[0,1,0] neg_lo:[1,0,0] neg_hi:[1,0,0]
    v_pk_fma_f32 v[36:37], v[10:11], v[128:129], v[36:37] op_sel:[0,1,0]
    v_pk_fma_f32 v[34:35], v[32:33], v[128:129], v[34:35] op_sel_hi:[1,0,1]
    v_pk_fma_f32 v[38:39], v[36:37], v[128:129], v[38:39] op_sel_hi:[1,0,1]
    v_pk_fma_f32 v[34:35], v[36:37], v[128:129], v[34:35] op_sel:[0,1,0] neg_lo:[1,0,0] neg_hi:[1,0,0]
    v_pk_fma_f32 v[38:39], v[32:33], v[128:129], v[38:39] op_sel:[0,1,0]
    v_cvt_pk_bf16_f32 v184, v32, v34
    v_cvt_pk_bf16_f32 v192, v33, v35
    v_cvt_pk_bf16_f32 v200, -v36, -v38
    v_cvt_pk_bf16_f32 v208, -v37, -v39
    v_pk_fma_f32 v[40:41], v[34:35], v[128:129], v[40:41] op_sel_hi:[1,0,1]
    v_pk_fma_f32 v[44:45], v[38:39], v[128:129], v[44:45] op_sel_hi:[1,0,1]
    v_pk_fma_f32 v[40:41], v[38:39], v[128:129], v[40:41] op_sel:[0,1,0] neg_lo:[1,0,0] neg_hi:[1,0,0]
    v_pk_fma_f32 v[44:45], v[34:35], v[128:129], v[44:45] op_sel:[0,1,0]
    v_pk_fma_f32 v[42:43], v[40:41], v[128:129], v[42:43] op_sel_hi:[1,0,1]
    v_pk_fma_f32 v[46:47], v[44:45], v[128:129], v[46:47] op_sel_hi:[1,0,1]
    v_pk_fma_f32 v[42:43], v[44:45], v[128:129], v[42:43] op_sel:[0,1,0] neg_lo:[1,0,0] neg_hi:[1,0,0]
    v_pk_fma_f32 v[46:47], v[40:41], v[128:129], v[46:47] op_sel:[0,1,0]
    v_cvt_pk_bf16_f32 v185, v40, v42
    v_cvt_pk_bf16_f32 v193, v41, v43
    v_cvt_pk_bf16_f32 v201, -v44, -v46
    v_cvt_pk_bf16_f32 v209, -v45, -v47
    v_pk_fma_f32 v[48:49], v[42:43], v[128:129], v[48:49] op_sel_hi:[1,0,1]
    v_pk_fma_f32 v[52:53], v[46:47], v[128:129], v[52:53] op_sel_hi:[1,0,1]
    v_pk_fma_f32 v[48:49], v[46:47], v[128:129], v[48:49] op_sel:[0,1,0] neg_lo:[1,0,0] neg_hi:[1,0,0]
    v_pk_fma_f32 v[52:53], v[42:43], v[128:129], v[52:53] op_sel:[0,1,0]
    v_pk_fma_f32 v[50:51], v[48:49], v[128:129], v[50:51] op_sel_hi:[1,0,1]
    v_pk_fma_f32 v[54:55], v[52:53], v[128:129], v[54:55] op_sel_hi:[1,0,1]
    v_pk_fma_f32 v[50:51], v[52:53], v[128:129], v[50:51] op_sel:[0,1,0] neg_lo:[1,0,0] neg_hi:[1,0,0]
    v_pk_fma_f32 v[54:55], v[48:49], v[128:129], v[54:55] op_sel:[0,1,0]
    v_cvt_pk_bf16_f32 v186, v48, v50
    v_cvt_pk_bf16_f32 v194, v49, v51
    v_cvt_pk_bf16_f32 v202, -v52, -v54
    v_cvt_pk_bf16_f32 v210, -v53, -v55
    v_pk_fma_f32 v[56:57], v[50:51], v[128:129], v[56:57] op_sel_hi:[1,0,1]
    v_pk_fma_f32 v[60:61], v[54:55], v[128:129], v[60:61] op_sel_hi:[1,0,1]
    v_pk_fma_f32 v[56:57], v[54:55], v[128:129], v[56:57] op_sel:[0,1,0] neg_lo:[1,0,0] neg_hi:[1,0,0]
    v_pk_fma_f32 v[60:61], v[50:51], v[128:129], v[60:61] op_sel:[0,1,0]
    v_pk_fma_f32 v[58:59], v[56:57], v[128:129], v[58:59] op_sel_hi:[1,0,1]
    v_pk_fma_f32 v[62:63], v[60:61], v[128:129], v[62:63] op_sel_hi:[1,0,1]
    v_pk_fma_f32 v[58:59], v[60:61], v[128:129], v[58:59] op_sel:[0,1,0] neg_lo:[1,0,0] neg_hi:[1,0,0]
    v_pk_fma_f32 v[62:63], v[56:57], v[128:129], v[62:63] op_sel:[0,1,0]
    v_cvt_pk_bf16_f32 v187, v56, v58
    v_cvt_pk_bf16_f32 v195, v57, v59
    v_cvt_pk_bf16_f32 v203, -v60, -v62
    v_cvt_pk_bf16_f32 v211, -v61, -v63
    ds_write_b128 v4, v[184:187] offset:0
    ds_write_b128 v6, v[192:195] offset:0
    ds_write_b128 v4, v[200:203] offset:4096
    ds_write_b128 v6, v[208:211] offset:4096
    v_pk_fma_f32 v[64:65], v[58:59], v[128:129], v[64:65] op_sel_hi:[1,0,1]
    v_pk_fma_f32 v[68:69], v[62:63], v[128:129], v[68:69] op_sel_hi:[1,0,1]
    v_pk_fma_f32 v[64:65], v[62:63], v[128:129], v[64:65] op_sel:[0,1,0] neg_lo:[1,0,0] neg_hi:[1,0,0]
    v_pk_fma_f32 v[68:69], v[58:59], v[128:129], v[68:69] op_sel:[0,1,0]
    v_pk_fma_f32 v[66:67], v[64:65], v[128:129], v[66:67] op_sel_hi:[1,0,1]
    v_pk_fma_f32 v[70:71], v[68:69], v[128:129], v[70:71] op_sel_hi:[1,0,1]
    v_pk_fma_f32 v[66:67], v[68:69], v[128:129], v[66:67] op_sel:[0,1,0] neg_lo:[1,0,0] neg_hi:[1,0,0]
    v_pk_fma_f32 v[70:71], v[64:65], v[128:129], v[70:71] op_sel:[0,1,0]
    v_cvt_pk_bf16_f32 v188, v64, v66
    v_cvt_pk_bf16_f32 v196, v65, v67
    v_cvt_pk_bf16_f32 v204, -v68, -v70
    v_cvt_pk_bf16_f32 v212, -v69, -v71
    v_pk_fma_f32 v[72:73], v[66:67], v[128:129], v[72:73] op_sel_hi:[1,0,1]
    v_pk_fma_f32 v[76:77], v[70:71], v[128:129], v[76:77] op_sel_hi:[1,0,1]
    v_pk_fma_f32 v[72:73], v[70:71], v[128:129], v[72:73] op_sel:[0,1,0] neg_lo:[1,0,0] neg_hi:[1,0,0]
    v_pk_fma_f32 v[76:77], v[66:67], v[128:129], v[76:77] op_sel:[0,1,0]
    v_pk_fma_f32 v[74:75], v[72:73], v[128:129], v[74:75] op_sel_hi:[1,0,1]
    v_pk_fma_f32 v[78:79], v[76:77], v[128:129], v[78:79] op_sel_hi:[1,0,1]
    v_pk_fma_f32 v[74:75], v[76:77], v[128:129], v[74:75] op_sel:[0,1,0] neg_lo:[1,0,0] neg_hi:[1,0,0]
    v_pk_fma_f32 v[78:79], v[72:73], v[128:129], v[78:79] op_sel:[0,1,0]
    v_cvt_pk_bf16_f32 v189, v72, v74
    v_cvt_pk_bf16_f32 v197, v73, v75
    v_cvt_pk_bf16_f32 v205, -v76, -v78
    v_cvt_pk_bf16_f32 v213, -v77, -v79
    v_pk_fma_f32 v[80:81], v[74:75], v[128:129], v[80:81] op_sel_hi:[1,0,1]
    v_pk_fma_f32 v[84:85], v[78:79], v[128:129], v[84:85] op_sel_hi:[1,0,1]
    v_pk_fma_f32 v[80:81], v[78:79], v[128:129], v[80:81] op_sel:[0,1,0] neg_lo:[1,0,0] neg_hi:[1,0,0]
    v_pk_fma_f32 v[84:85], v[74:75], v[128:129], v[84:85] op_sel:[0,1,0]
    v_pk_fma_f32 v[82:83], v[80:81], v[128:129], v[82:83] op_sel_hi:[1,0,1]
    v_pk_fma_f32 v[86:87], v[84:85], v[128:129], v[86:87] op_sel_hi:[1,0,1]
    v_pk_fma_f32 v[82:83], v[84:85], v[128:129], v[82:83] op_sel:[0,1,0] neg_lo:[1,0,0] neg_hi:[1,0,0]
    v_pk_fma_f32 v[86:87], v[80:81], v[128:129], v[86:87] op_sel:[0,1,0]
    v_cvt_pk_bf16_f32 v190, v80, v82
    v_cvt_pk_bf16_f32 v198, v81, v83
    v_cvt_pk_bf16_f32 v206, -v84, -v86
    v_cvt_pk_bf16_f32 v214, -v85, -v87
    v_pk_fma_f32 v[88:89], v[82:83], v[128:129], v[88:89] op_sel_hi:[1,0,1]
    v_pk_fma_f32 v[92:93], v[86:87], v[128:129], v[92:93] op_sel_hi:[1,0,1]
    v_pk_fma_f32 v[88:89], v[86:87], v[128:129], v[88:89] op_sel:[0,1,0] neg_lo:[1,0,0] neg_hi:[1,0,0]
    v_pk_fma_f32 v[92:93], v[82:83], v[128:129], v[92:93] op_sel:[0,1,0]
    v_pk_fma_f32 v[90:91], v[88:89], v[128:129], v[90:91] op_sel_hi:[1,0,1]
    v_pk_fma_f32 v[94:95], v[92:93], v[128:129], v[94:95] op_sel_hi:[1,0,1]
    v_pk_fma_f32 v[90:91], v[92:93], v[128:129], v[90:91] op_sel:[0,1,0] neg_lo:[1,0,0] neg_hi:[1,0,0]
    v_pk_fma_f32 v[94:95], v[88:89], v[128:129], v[94:95] op_sel:[0,1,0]
    v_cvt_pk_bf16_f32 v191, v88, v90
    v_cvt_pk_bf16_f32 v199, v89, v91
    v_cvt_pk_bf16_f32 v207, -v92, -v94
    v_cvt_pk_bf16_f32 v215, -v93, -v95
    ds_write_b128 v5, v[188:191] offset:0
    ds_write_b128 v7, v[196:199] offset:0
    ds_write_b128 v5, v[204:207] offset:4096
    ds_write_b128 v7, v[212:215] offset:4096
    s_lshl_b32 s38, s32, 19
    s_lshl_b32 s39, s33, 12
    s_add_u32 s38, s38, s39
    s_lshl_b32 s39, s34, 10
    s_add_u32 s38, s38, s39
    s_add_u32 s38, s38, 15728640
    v_xor_b32 v152, 0, v8
    v_xor_b32 v153, 16, v8
    v_xor_b32 v154, 32, v8
    v_xor_b32 v155, 48, v8
    v_xor_b32 v156, 64, v8
    v_xor_b32 v157, 80, v8
    v_xor_b32 v158, 96, v8
    v_xor_b32 v159, 112, v8
    v_xor_b32 v160, 128, v8
    v_xor_b32 v161, 144, v8
    v_xor_b32 v162, 160, v8
    v_xor_b32 v163, 176, v8
    v_xor_b32 v164, 192, v8
    v_xor_b32 v165, 208, v8
    v_xor_b32 v166, 224, v8
    v_xor_b32 v167, 240, v8
    s_waitcnt lgkmcnt(0)
    s_nop 0
    ds_read_b64_tr_b16 v[32:33], v152
    ds_read_b64_tr_b16 v[34:35], v153 offset:1024
    ds_read_b64_tr_b16 v[36:37], v154
    ds_read_b64_tr_b16 v[38:39], v155 offset:1024
    ds_read_b64_tr_b16 v[40:41], v156
    ds_read_b64_tr_b16 v[42:43], v157 offset:1024
    ds_read_b64_tr_b16 v[44:45], v158
    ds_read_b64_tr_b16 v[46:47], v159 offset:1024
    ds_read_b64_tr_b16 v[48:49], v160
    ds_read_b64_tr_b16 v[50:51], v161 offset:1024
    ds_read_b64_tr_b16 v[52:53], v162
    ds_read_b64_tr_b16 v[54:55], v163 offset:1024
    ds_read_b64_tr_b16 v[56:57], v164
    ds_read_b64_tr_b16 v[58:59], v165 offset:1024
    ds_read_b64_tr_b16 v[60:61], v166
    ds_read_b64_tr_b16 v[62:63], v167 offset:1024
    s_waitcnt lgkmcnt(14)
    buffer_store_dwordx4 v[32:35], v3, s[24:27], s38 offen
    s_add_u32 s38, s38, 65536
    s_waitcnt lgkmcnt(12)
    buffer_store_dwordx4 v[36:39], v3, s[24:27], s38 offen
    s_add_u32 s38, s38, 65536
    s_waitcnt lgkmcnt(10)
    buffer_store_dwordx4 v[40:43], v3, s[24:27], s38 offen
    s_add_u32 s38, s38, 65536
    s_waitcnt lgkmcnt(8)
    buffer_store_dwordx4 v[44:47], v3, s[24:27], s38 offen
    s_add_u32 s38, s38, 65536
    s_waitcnt lgkmcnt(6)
    buffer_store_dwordx4 v[48:51], v3, s[24:27], s38 offen
    s_add_u32 s38, s38, 65536
    s_waitcnt lgkmcnt(4)
    buffer_store_dwordx4 v[52:55], v3, s[24:27], s38 offen
    s_add_u32 s38, s38, 65536
    s_waitcnt lgkmcnt(2)
    buffer_store_dwordx4 v[56:59], v3, s[24:27], s38 offen
    s_add_u32 s38, s38, 65536
    s_waitcnt lgkmcnt(0)
    buffer_store_dwordx4 v[60:63], v3, s[24:27], s38 offen
K1_END:
    s_endpgm
K1_CODE_END:
.globl k2_kernel
.p2align 8
.type k2_kernel,@function
k2_kernel:
    s_cmp_ge_u32 s2, 256
    s_cbranch_scc1 K2_END
    s_nop 0
    s_load_dwordx2 s[44:45], s[0:1], 0
    s_load_dwordx4 s[48:51], s[0:1], 64
    s_load_dwordx4 s[52:55], s[0:1], 88
    s_load_dwordx2 s[56:57], s[0:1], 104
    s_load_dwordx2 s[60:61], s[0:1], 120
    v_lshrrev_b32 v3, 6, v0
    v_and_b32 v0, 63, v0
    v_readfirstlane_b32 s34, v3
    v_and_b32 v1, 15, v0
    v_lshrrev_b32 v2, 4, v0
    v_lshlrev_b32 v3, 4, v0
    s_and_b32 s38, s2, 3
    s_lshl_b32 s38, s38, 2
    s_bfe_u32 s39, s2, 0x20003
    s_add_u32 s32, s38, s39
    s_bfe_u32 s38, s2, 0x10002
    s_lshl_b32 s38, s38, 3
    s_lshr_b32 s39, s2, 5
    s_add_u32 s33, s38, s39
    s_getpc_b64 s[28:29]
K2_PC:
    s_mov_b32 s30, K2_CODE_END-K2_PC
    s_mov_b32 s31, 0x00020000
    s_bfe_u32 s38, s2, 0x30003
    s_lshl_b32 s38, s38, 2
    s_add_u32 s38, s38, s34
    s_lshl_b32 s38, s38, 11
    v_lshl_add_u32 v4, v1, 7, s38
    v_cmp_gt_u32 vcc, 16, v0
    s_nop 1
    v_cndmask_b32_e64 v4, 2.0, v4, vcc
    buffer_load_dword v255, v4, s[28:31], 0 offen
    v_lshlrev_b32_e64 v5, 9, v2
    v_lshl_add_u32 v5, v1, 3, v5
    s_lshl_b32 s37, s34, 12
    s_lshl_b32 s38, s32, 4
    s_add_u32 s38, s38, s33
    s_mul_i32 s38, s38, 16384
    s_lshl_b32 s39, s34, 10
    s_add_u32 s38, s38, s39
    s_add_u32 s38, s38, 10485760
    s_waitcnt lgkmcnt(0)
    s_add_u32 s40, s60, 28598272
    s_addc_u32 s41, s61, 0
    s_load_dword s62, s[40:41], 0
    s_mov_b32 s24, s60
    s_mov_b32 s25, s61
    s_mov_b32 s26, 33554432
    s_mov_b32 s27, 0x00020000
    s_mov_b32 s8, s44
    s_mov_b32 s9, s45
    s_nop 0
    s_mov_b32 s10, 4194304
    s_mov_b32 s11, 0x00020000
    buffer_load_dwordx4 v[152:155], v3, s[24:27], s38 offen
    s_add_u32 s38, s38, 4096
    buffer_load_dwordx4 v[156:159], v3, s[24:27], s38 offen
    s_add_u32 s38, s38, 4096
    buffer_load_dwordx4 v[160:163], v3, s[24:27], s38 offen
    s_add_u32 s38, s38, 4096
    buffer_load_dwordx4 v[164:167], v3, s[24:27], s38 offen
    s_lshl_b32 s38, s32, 7
    s_and_b32 s39, s34, 1
    s_lshl_b32 s39, s39, 6
    s_add_u32 s38, s38, s39
    s_lshl_b32 s39, s33, 1
    s_add_u32 s38, s38, s39
    s_lshr_b32 s39, s34, 1
    s_add_u32 s38, s38, s39
    s_lshl_b32 s38, s38, 11
    s_nop 0
    s_add_u32 s39, s38, 65536
    buffer_load_dwordx2 v[168:169], v5, s[8:11], s38 offen offset:0
    buffer_load_dwordx2 v[170:171], v5, s[8:11], s38 offen offset:128
    buffer_load_dwordx2 v[172:173], v5, s[8:11], s38 offen offset:256
    buffer_load_dwordx2 v[174:175], v5, s[8:11], s38 offen offset:384
    buffer_load_dwordx2 v[176:177], v5, s[8:11], s39 offen offset:0
    buffer_load_dwordx2 v[178:179], v5, s[8:11], s39 offen offset:128
    buffer_load_dwordx2 v[180:181], v5, s[8:11], s39 offen offset:256
    buffer_load_dwordx2 v[182:183], v5, s[8:11], s39 offen offset:384
    global_load_dwordx2 v[184:185], v5, s[54:55] offset:0
    global_load_dwordx2 v[192:193], v5, s[52:53] offset:0
    global_load_dwordx2 v[186:187], v5, s[54:55] offset:128
    global_load_dwordx2 v[194:195], v5, s[52:53] offset:128
    global_load_dwordx2 v[188:189], v5, s[54:55] offset:256
    global_load_dwordx2 v[196:197], v5, s[52:53] offset:256
    global_load_dwordx2 v[190:191], v5, s[54:55] offset:384
    global_load_dwordx2 v[198:199], v5, s[52:53] offset:384
    s_cmp_lt_u32 s34, 2
    s_cselect_b32 s12, s48, s50
    s_cselect_b32 s13, s49, s51
    s_mov_b32 s14, 0x200000
    s_mov_b32 s15, 0x00020000
    v_and_b32 v6, 7, v0
    v_xor_b32 v6, v6, v2
    v_lshlrev_b32 v6, 4, v6
    v_xor_b32 v7, 64, v6
    v_lshrrev_b32 v8, 3, v0
    v_lshlrev_b32 v8, 2, v8
    s_lshl_b32 s38, s33, 6
    s_and_b32 s39, s34, 1
    s_lshl_b32 s39, s39, 1
    s_add_u32 s38, s38, s39
    v_add_u32 v8, s38, v8
    v_add_u32_e64 v9, 0, v8
    v_lshl_add_u32 v16, v9, 11, v6
    v_add_u32_e64 v9, 32, v8
    v_lshl_add_u32 v17, v9, 11, v7
    v_add_u32_e64 v9, 1, v8
    v_lshl_add_u32 v18, v9, 11, v6
    v_add_u32_e64 v9, 33, v8
    v_lshl_add_u32 v19, v9, 11, v7
    s_and_b32 s36, s33, 8
    s_lshl_b32 s36, s36, 7
    s_and_b32 s38, s34, 1
    s_lshl_b32 s38, s38, 2
    s_lshr_b32 s39, s34, 1
    s_add_u32 s38, s38, s39
    s_lshl_b32 s39, s32, 3
    s_add_u32 s38, s38, s39
    s_lshl_b32 s38, s38, 16
    s_add_u32 s58, s38, 15728640
    s_lshl_b32 s42, s36, 5
    s_add_u32 s42, s42, s58
    s_add_u32 s43, s42, 0x20000
    s_add_u32 m0, s37, 0
    buffer_load_dwordx4 a[0:3], v3, s[24:27], s42 offen offset:0
    buffer_load_dwordx4 v16, s[12:15], s36 offen lds
    buffer_load_dwordx4 a[16:19], v3, s[24:27], s43 offen offset:0
    s_add_u32 m0, s37, 1024
    buffer_load_dwordx4 a[4:7], v3, s[24:27], s42 offen offset:1024
    buffer_load_dwordx4 v17, s[12:15], s36 offen lds
    buffer_load_dwordx4 a[20:23], v3, s[24:27], s43 offen offset:1024
    s_add_u32 m0, s37, 2048
    buffer_load_dwordx4 a[8:11], v3, s[24:27], s42 offen offset:2048
    buffer_load_dwordx4 v18, s[12:15], s36 offen lds
    buffer_load_dwordx4 a[24:27], v3, s[24:27], s43 offen offset:2048
    s_add_u32 m0, s37, 3072
    buffer_load_dwordx4 a[12:15], v3, s[24:27], s42 offen offset:3072
    buffer_load_dwordx4 v19, s[12:15], s36 offen lds
    buffer_load_dwordx4 a[28:31], v3, s[24:27], s43 offen offset:3072
    s_add_u32 s36, s36, 128
    s_and_b32 s36, s36, 2047
    s_lshl_b32 s42, s36, 5
    s_add_u32 s42, s42, s58
    s_add_u32 s43, s42, 0x20000
    s_add_u32 m0, s37, 16384
    buffer_load_dwordx4 a[32:35], v3, s[24:27], s42 offen offset:0
    buffer_load_dwordx4 v16, s[12:15], s36 offen lds
    buffer_load_dwordx4 a[48:51], v3, s[24:27], s43 offen offset:0
    s_add_u32 m0, s37, 17408
    buffer_load_dwordx4 a[36:39], v3, s[24:27], s42 offen offset:1024
    buffer_load_dwordx4 v17, s[12:15], s36 offen lds
    buffer_load_dwordx4 a[52:55], v3, s[24:27], s43 offen offset:1024
    s_add_u32 m0, s37, 18432
    buffer_load_dwordx4 a[40:43], v3, s[24:27], s42 offen offset:2048
    buffer_load_dwordx4 v18, s[12:15], s36 offen lds
    buffer_load_dwordx4 a[56:59], v3, s[24:27], s43 offen offset:2048
    s_add_u32 m0, s37, 19456
    buffer_load_dwordx4 a[44:47], v3, s[24:27], s42 offen offset:3072
    buffer_load_dwordx4 v19, s[12:15], s36 offen lds
    buffer_load_dwordx4 a[60:63], v3, s[24:27], s43 offen offset:3072
    s_add_u32 s36, s36, 128
    s_and_b32 s36, s36, 2047
    s_lshl_b32 s42, s36, 5
    s_add_u32 s42, s42, s58
    s_add_u32 s43, s42, 0x20000
    s_add_u32 m0, s37, 32768
    buffer_load_dwordx4 a[64:67], v3, s[24:27], s42 offen offset:0
    buffer_load_dwordx4 v16, s[12:15], s36 offen lds
    buffer_load_dwordx4 a[80:83], v3, s[24:27], s43 offen offset:0
    s_add_u32 m0, s37, 33792
    buffer_load_dwordx4 a[68:71], v3, s[24:27], s42 offen offset:1024
    buffer_load_dwordx4 v17, s[12:15], s36 offen lds
    buffer_load_dwordx4 a[84:87], v3, s[24:27], s43 offen offset:1024
    s_add_u32 m0, s37, 34816
    buffer_load_dwordx4 a[72:75], v3, s[24:27], s42 offen offset:2048
    buffer_load_dwordx4 v18, s[12:15], s36 offen lds
    buffer_load_dwordx4 a[88:91], v3, s[24:27], s43 offen offset:2048
    s_add_u32 m0, s37, 35840
    buffer_load_dwordx4 a[76:79], v3, s[24:27], s42 offen offset:3072
    buffer_load_dwordx4 v19, s[12:15], s36 offen lds
    buffer_load_dwordx4 a[92:95], v3, s[24:27], s43 offen offset:3072
    s_add_u32 s36, s36, 128
    s_and_b32 s36, s36, 2047
    v_cvt_f32_u32 v6, v1
    v_cvt_f32_u32 v7, v2
    v_mul_f32_e64 v7, 4.0, v7
    v_fma_f32 v8, v6, 2.0, 0
    v_mul_f32 v9, 0x3d000000, v8
    v_mul_f32_e64 v15, v7, v9
    v_fmamk_f32 v12, v9, 0x00000000, v15
    v_cos_f32 v10, v12
    v_sin_f32 v11, v12
    s_nop 0
    s_nop 0
    v_cvt_pk_bf16_f32 v200, v10, v11
    v_cvt_pk_bf16_f32 v204, -v11, v10
    v_cvt_pk_bf16_f32 v208, v10, -v11
    v_cvt_pk_bf16_f32 v212, -v11, -v10
    v_mul_f32 v12, 0x3d800000, v12
    v_cos_f32 v96, v12
    v_sin_f32 v104, v12
    v_fmamk_f32 v12, v9, 0x3f800000, v15
    v_cos_f32 v10, v12
    v_sin_f32 v11, v12
    s_nop 0
    s_nop 0
    v_cvt_pk_bf16_f32 v201, v10, v11
    v_cvt_pk_bf16_f32 v205, -v11, v10
    v_cvt_pk_bf16_f32 v209, v10, -v11
    v_cvt_pk_bf16_f32 v213, -v11, -v10
    v_mul_f32 v12, 0x3d800000, v12
    v_cos_f32 v97, v12
    v_sin_f32 v105, v12
    v_fmamk_f32 v12, v9, 0x40000000, v15
    v_cos_f32 v10, v12
    v_sin_f32 v11, v12
    s_nop 0
    s_nop 0
    v_cvt_pk_bf16_f32 v202, v10, v11
    v_cvt_pk_bf16_f32 v206, -v11, v10
    v_cvt_pk_bf16_f32 v210, v10, -v11
    v_cvt_pk_bf16_f32 v214, -v11, -v10
    v_mul_f32 v12, 0x3d800000, v12
    v_cos_f32 v98, v12
    v_sin_f32 v106, v12
    v_fmamk_f32 v12, v9, 0x40400000, v15
    v_cos_f32 v10, v12
    v_sin_f32 v11, v12
    s_nop 0
    s_nop 0
    v_cvt_pk_bf16_f32 v203, v10, v11
    v_cvt_pk_bf16_f32 v207, -v11, v10
    v_cvt_pk_bf16_f32 v211, v10, -v11
    v_cvt_pk_bf16_f32 v215, -v11, -v10
    v_mul_f32 v12, 0x3d800000, v12
    v_cos_f32 v99, v12
    v_sin_f32 v107, v12
    v_fma_f32 v8, v6, 2.0, 1.0
    v_mul_f32 v9, 0x3d000000, v8
    v_mul_f32_e64 v15, v7, v9
    v_fmamk_f32 v12, v9, 0x00000000, v15
    v_cos_f32 v10, v12
    v_sin_f32 v11, v12
    s_nop 0
    s_nop 0
    v_cvt_pk_bf16_f32 v216, v10, v11
    v_cvt_pk_bf16_f32 v220, -v11, v10
    v_cvt_pk_bf16_f32 v224, -v10, v11
    v_cvt_pk_bf16_f32 v228, v11, v10
    v_mul_f32 v12, 0x3d800000, v12
    v_cos_f32 v100, v12
    v_sin_f32 v108, v12
    v_fmamk_f32 v12, v9, 0x3f800000, v15
    v_cos_f32 v10, v12
    v_sin_f32 v11, v12
    s_nop 0
    s_nop 0
    v_cvt_pk_bf16_f32 v217, v10, v11
    v_cvt_pk_bf16_f32 v221, -v11, v10
    v_cvt_pk_bf16_f32 v225, -v10, v11
    v_cvt_pk_bf16_f32 v229, v11, v10
    v_mul_f32 v12, 0x3d800000, v12
    v_cos_f32 v101, v12
    v_sin_f32 v109, v12
    v_fmamk_f32 v12, v9, 0x40000000, v15
    v_cos_f32 v10, v12
    v_sin_f32 v11, v12
    s_nop 0
    s_nop 0
    v_cvt_pk_bf16_f32 v218, v10, v11
    v_cvt_pk_bf16_f32 v222, -v11, v10
    v_cvt_pk_bf16_f32 v226, -v10, v11
    v_cvt_pk_bf16_f32 v230, v11, v10
    v_mul_f32 v12, 0x3d800000, v12
    v_cos_f32 v102, v12
    v_sin_f32 v110, v12
    v_fmamk_f32 v12, v9, 0x40400000, v15
    v_cos_f32 v10, v12
    v_sin_f32 v11, v12
    s_nop 0
    s_nop 0
    v_cvt_pk_bf16_f32 v219, v10, v11
    v_cvt_pk_bf16_f32 v223, -v11, v10
    v_cvt_pk_bf16_f32 v227, -v10, v11
    v_cvt_pk_bf16_f32 v231, v11, v10
    v_mul_f32 v12, 0x3d800000, v12
    v_cos_f32 v103, v12
    v_sin_f32 v111, v12
    v_mul_f32 v9, 0x3d800000, v6
    v_mul_f32_e64 v15, v7, v9
    v_fmamk_f32 v12, v9, 0x00000000, v15
    v_cos_f32 v10, v12
    v_sin_f32 v11, v12
    s_nop 0
    v_cvt_pk_bf16_f32 v232, v10, v11
    v_cvt_pk_bf16_f32 v236, v11, -v10
    v_fmamk_f32 v12, v9, 0x3f800000, v15
    v_cos_f32 v10, v12
    v_sin_f32 v11, v12
    s_nop 0
    v_cvt_pk_bf16_f32 v233, v10, v11
    v_cvt_pk_bf16_f32 v237, v11, -v10
    v_fmamk_f32 v12, v9, 0x40000000, v15
    v_cos_f32 v10, v12
    v_sin_f32 v11, v12
    s_nop 0
    v_cvt_pk_bf16_f32 v234, v10, v11
    v_cvt_pk_bf16_f32 v238, v11, -v10
    v_fmamk_f32 v12, v9, 0x40400000, v15
    v_cos_f32 v10, v12
    v_sin_f32 v11, v12
    s_nop 0
    v_cvt_pk_bf16_f32 v235, v10, v11
    v_cvt_pk_bf16_f32 v239, v11, -v10
    v_and_b32 v8, 1, v2
    v_lshrrev_b32 v9, 1, v1
    v_xor_b32 v8, v8, v9
    v_lshlrev_b32 v8, 4, v8
    v_lshl_add_u32 v8, v1, 7, v8
    v_lshrrev_b32_e64 v9, 1, v2
    v_lshl_add_u32 v8, v9, 13, v8
    v_xor_b32_e64 v20, 0, v8
    v_add_u32 v24, 0x10000, v20
    v_xor_b32_e64 v21, 32, v8
    v_add_u32 v25, 0x10000, v21
    v_xor_b32_e64 v22, 64, v8
    v_add_u32 v26, 0x10000, v22
    v_xor_b32 v23, 96, v8
    v_add_u32 v27, 0x10000, v23
    s_lshr_b32 s38, s34, 1
    s_lshl_b32 s38, s38, 2
    s_and_b32 s39, s34, 1
    s_add_u32 s38, s38, s39
    s_mul_i32 s38, s38, 2080
    s_add_u32 s38, s38, 131072
    v_lshl_add_u32 v4, v2, 6, v1
    v_lshl_add_u32 v6, v4, 3, s38
    v_sub_u32 v4, 208, v4
    s_add_u32 s38, s38, 4160
    v_lshl_add_u32 v7, v4, 3, s38
    v_and_b32 v4, 3, v0
    v_lshrrev_b32 v5, 2, v0
    s_lshl_b32 s39, s34, 4
    v_add_u32 v5, s39, v5
    v_mul_u32_u24 v9, 4160, v4
    v_lshl_add_u32 v9, v5, 3, v9
    v_add_u32 v9, 131072, v9
    v_and_b32 v4, 1, v4
    v_lshlrev_b32 v4, 11, v4
    v_cmp_eq_u32 vcc, 0, v5
    s_nop 1
    v_cndmask_b32 v4, 0, v4, vcc
    v_add_u32 v8, v9, v4
    s_waitcnt vmcnt(52)
    s_nop 0
    ds_write_b64 v8, v[152:153] offset:0
    ds_write_b64 v8, v[154:155] offset:2080
    ds_write_b64 v9, v[156:157] offset:512
    ds_write_b64 v9, v[158:159] offset:2592
    ds_write_b64 v9, v[160:161] offset:1024
    ds_write_b64 v9, v[162:163] offset:3104
    ds_write_b64 v9, v[164:165] offset:1536
    ds_write_b64 v9, v[166:167] offset:3616
    s_waitcnt vmcnt(36)
    s_nop 0
    v_dot2_f32_bf16 v10, v168, v184, 0
    v_dot2_f32_bf16 v11, v176, v184, 0
    v_dot2_f32_bf16 v10, v169, v185, v10
    v_dot2_f32_bf16 v11, v177, v185, v11
    v_dot2_f32_bf16 v10, v170, v186, v10
    v_dot2_f32_bf16 v11, v178, v186, v11
    v_dot2_f32_bf16 v10, v171, v187, v10
    v_dot2_f32_bf16 v11, v179, v187, v11
    v_dot2_f32_bf16 v10, v172, v188, v10
    v_dot2_f32_bf16 v11, v180, v188, v11
    v_dot2_f32_bf16 v10, v173, v189, v10
    v_dot2_f32_bf16 v11, v181, v189, v11
    v_dot2_f32_bf16 v10, v174, v190, v10
    v_dot2_f32_bf16 v11, v182, v190, v11
    v_dot2_f32_bf16 v10, v175, v191, v10
    v_dot2_f32_bf16 v11, v183, v191, v11
    s_waitcnt lgkmcnt(0)
    s_barrier
    ds_read2_b32 v[152:153], v6 offset0:0 offset1:32
    ds_read2_b32 v[154:155], v6 offset0:64 offset1:96
    ds_read2_b32 v[156:157], v7 offset0:96 offset1:64
    ds_read2_b32 v[158:159], v7 offset0:32 offset1:0
    ds_read2_b32 v[160:161], v6 offset0:1 offset1:33
    ds_read2_b32 v[162:163], v6 offset0:65 offset1:97
    ds_read2_b32 v[164:165], v7 offset0:97 offset1:65
    ds_read2_b32 v[166:167], v7 offset0:33 offset1:1
    s_lshl_b32 s42, s36, 5
    s_add_u32 s42, s42, s58
    s_add_u32 s43, s42, 0x20000
    s_add_u32 m0, s37, 49152
    buffer_load_dwordx4 a[96:99], v3, s[24:27], s42 offen offset:0
    buffer_load_dwordx4 v16, s[12:15], s36 offen lds
    buffer_load_dwordx4 a[112:115], v3, s[24:27], s43 offen offset:0
    s_add_u32 m0, s37, 50176
    buffer_load_dwordx4 a[100:103], v3, s[24:27], s42 offen offset:1024
    buffer_load_dwordx4 v17, s[12:15], s36 offen lds
    buffer_load_dwordx4 a[116:119], v3, s[24:27], s43 offen offset:1024
    s_add_u32 m0, s37, 51200
    buffer_load_dwordx4 a[104:107], v3, s[24:27], s42 offen offset:2048
    buffer_load_dwordx4 v18, s[12:15], s36 offen lds
    buffer_load_dwordx4 a[120:123], v3, s[24:27], s43 offen offset:2048
    s_add_u32 m0, s37, 52224
    buffer_load_dwordx4 a[108:111], v3, s[24:27], s42 offen offset:3072
    buffer_load_dwordx4 v19, s[12:15], s36 offen lds
    buffer_load_dwordx4 a[124:127], v3, s[24:27], s43 offen offset:3072
    s_add_u32 s36, s36, 128
    s_and_b32 s36, s36, 2047
    v_add_f32_dpp v10, v10, v10 row_ror:8 row_mask:0xf bank_mask:0xf
    v_add_f32_dpp v11, v11, v11 row_ror:8 row_mask:0xf bank_mask:0xf
    s_nop 0
    v_add_f32_dpp v10, v10, v10 row_ror:4 row_mask:0xf bank_mask:0xf
    v_add_f32_dpp v11, v11, v11 row_ror:4 row_mask:0xf bank_mask:0xf
    s_nop 0
    v_add_f32_dpp v10, v10, v10 row_ror:2 row_mask:0xf bank_mask:0xf
    v_add_f32_dpp v11, v11, v11 row_ror:2 row_mask:0xf bank_mask:0xf
    s_nop 0
    v_add_f32_dpp v10, v10, v10 row_ror:1 row_mask:0xf bank_mask:0xf
    v_add_f32_dpp v11, v11, v11 row_ror:1 row_mask:0xf bank_mask:0xf
    v_mov_b32 v12, v10
    v_mov_b32 v13, v11
    s_nop 0
    v_permlane32_swap_b32 v10, v12
    v_permlane32_swap_b32 v11, v13
    v_add_f32 v10, v10, v12
    v_add_f32 v11, v11, v13
    v_mov_b32 v12, v10
    v_mov_b32 v13, v11
    s_nop 0
    v_permlane16_swap_b32 v10, v12
    v_permlane16_swap_b32 v11, v13
    v_add_f32 v10, v10, v12
    v_add_f32_e64 v11, v11, v13
    v_cvt_pk_bf16_f32 v12, v10, v11
    v_lshlrev_b32_e64 v10, 16, v12
    v_and_b32 v11, 0xffff0000, v12
    v_mul_f32 v10, 0xbfb8aa3b, v10
    v_mul_f32 v11, 0xbfb8aa3b, v11
    v_exp_f32 v10, v10
    v_exp_f32 v11, v11
    v_add_f32 v10, 1.0, v10
    v_add_f32 v11, 1.0, v11
    v_rcp_f32 v10, v10
    v_rcp_f32 v11, v11
    s_nop 0
    v_cvt_pk_bf16_f32 v12, v10, v11
    v_lshlrev_b32 v10, 16, v12
    v_and_b32 v11, 0xffff0000, v12
    v_sub_f32 v12, 1.0, v10
    v_sub_f32 v13, 1.0, v11
    v_cvt_pk_bf16_f32 v13, v12, v13
    v_lshlrev_b32_e64 v12, 16, v13
    v_and_b32 v13, 0xffff0000, v13
    s_waitcnt lgkmcnt(4)
    v_mfma_f32_16x16x32_bf16 v[32:35], v[152:155], v[200:203], 0
    v_lshlrev_b32 v64, 16, v192
    v_and_b32 v68, 0xffff0000, v192
    v_mfma_f32_16x16x32_bf16 v[36:39], v[152:155], v[204:207], 0
    v_lshlrev_b32_e64 v120, 16, v168
    v_and_b32 v124, 0xffff0000, v168
    v_mfma_f32_16x16x32_bf16 v[40:43], v[152:155], v[216:219], 0
    v_lshlrev_b32_e64 v136, 16, v176
    v_and_b32 v140, 0xffff0000, v176
    v_mfma_f32_16x16x32_bf16 v[44:47], v[152:155], v[220:223], 0
    v_lshlrev_b32_e64 v72, 16, v193
    v_and_b32 v76, 0xffff0000, v193
    v_mfma_f32_16x16x32_bf16 v[32:35], v[156:159], v[208:211], v[32:35]
    v_lshlrev_b32_e64 v128, 16, v169
    v_and_b32 v132, 0xffff0000, v169
    v_mfma_f32_16x16x32_bf16 v[36:39], v[156:159], v[212:215], v[36:39]
    v_lshlrev_b32_e64 v144, 16, v177
    v_and_b32 v148, 0xffff0000, v177
    v_mfma_f32_16x16x32_bf16 v[40:43], v[156:159], v[224:227], v[40:43]
    v_lshlrev_b32_e64 v65, 16, v194
    v_and_b32 v69, 0xffff0000, v194
    v_mfma_f32_16x16x32_bf16 v[44:47], v[156:159], v[228:231], v[44:47]
    v_lshlrev_b32_e64 v121, 16, v170
    v_and_b32 v125, 0xffff0000, v170
    s_waitcnt lgkmcnt(0)
    v_lshlrev_b32 v137, 16, v178
    v_and_b32 v141, 0xffff0000, v178
    v_mfma_f32_16x16x32_bf16 v[48:51], v[160:163], v[200:203], 0
    v_lshlrev_b32_e64 v73, 16, v195
    v_and_b32 v77, 0xffff0000, v195
    v_mfma_f32_16x16x32_bf16 v[52:55], v[160:163], v[204:207], 0
    v_lshlrev_b32_e64 v129, 16, v171
    v_and_b32 v133, 0xffff0000, v171
    v_mfma_f32_16x16x32_bf16 v[56:59], v[160:163], v[216:219], 0
    v_lshlrev_b32_e64 v145, 16, v179
    v_and_b32 v149, 0xffff0000, v179
    v_mfma_f32_16x16x32_bf16 v[60:63], v[160:163], v[220:223], 0
    v_lshlrev_b32_e64 v66, 16, v196
    v_and_b32 v70, 0xffff0000, v196
    v_mfma_f32_16x16x32_bf16 v[48:51], v[164:167], v[208:211], v[48:51]
    v_lshlrev_b32_e64 v122, 16, v172
    v_and_b32 v126, 0xffff0000, v172
    v_mfma_f32_16x16x32_bf16 v[52:55], v[164:167], v[212:215], v[52:55]
    v_lshlrev_b32_e64 v138, 16, v180
    v_and_b32 v142, 0xffff0000, v180
    v_mfma_f32_16x16x32_bf16 v[56:59], v[164:167], v[224:227], v[56:59]
    v_lshlrev_b32_e64 v74, 16, v197
    v_and_b32 v78, 0xffff0000, v197
    v_mfma_f32_16x16x32_bf16 v[60:63], v[164:167], v[228:231], v[60:63]
    v_lshlrev_b32_e64 v130, 16, v173
    v_and_b32 v134, 0xffff0000, v173
    v_lshlrev_b32_e64 v146, 16, v181
    v_and_b32 v150, 0xffff0000, v181
    v_lshlrev_b32_e64 v67, 16, v198
    v_and_b32 v71, 0xffff0000, v198
    v_lshlrev_b32_e64 v123, 16, v174
    v_and_b32 v127, 0xffff0000, v174
    v_lshlrev_b32_e64 v139, 16, v182
    v_and_b32 v143, 0xffff0000, v182
    v_lshlrev_b32_e64 v75, 16, v199
    v_and_b32 v79, 0xffff0000, v199
    v_lshlrev_b32_e64 v131, 16, v175
    v_and_b32 v135, 0xffff0000, v175
    v_lshlrev_b32_e64 v147, 16, v183
    v_and_b32 v151, 0xffff0000, v183
    v_pk_mul_f32 v[120:121], v[120:121], v[64:65]
    v_pk_mul_f32 v[122:123], v[122:123], v[66:67]
    v_pk_mul_f32 v[124:125], v[124:125], v[68:69]
    v_pk_mul_f32 v[126:127], v[126:127], v[70:71]
    v_pk_mul_f32 v[128:129], v[128:129], v[72:73]
    v_pk_mul_f32 v[130:131], v[130:131], v[74:75]
    v_pk_mul_f32 v[132:133], v[132:133], v[76:77]
    v_pk_mul_f32 v[134:135], v[134:135], v[78:79]
    v_pk_mul_f32 v[136:137], v[136:137], v[64:65]
    v_pk_mul_f32 v[138:139], v[138:139], v[66:67]
    v_pk_mul_f32 v[140:141], v[140:141], v[68:69]
    v_pk_mul_f32 v[142:143], v[142:143], v[70:71]
    v_pk_mul_f32 v[144:145], v[144:145], v[72:73]
    v_pk_mul_f32 v[146:147], v[146:147], v[74:75]
    v_pk_mul_f32 v[148:149], v[148:149], v[76:77]
    v_pk_mul_f32 v[150:151], v[150:151], v[78:79]
    v_pk_mul_f32 v[120:121], v[120:121], v[12:13] op_sel_hi:[1,0]
    v_pk_mul_f32 v[122:123], v[122:123], v[12:13] op_sel_hi:[1,0]
    v_pk_mul_f32 v[124:125], v[124:125], v[12:13] op_sel_hi:[1,0]
    v_pk_mul_f32 v[126:127], v[126:127], v[12:13] op_sel_hi:[1,0]
    v_pk_mul_f32 v[128:129], v[128:129], v[12:13] op_sel_hi:[1,0]
    v_pk_mul_f32 v[130:131], v[130:131], v[12:13] op_sel_hi:[1,0]
    v_pk_mul_f32 v[132:133], v[132:133], v[12:13] op_sel_hi:[1,0]
    v_pk_mul_f32 v[134:135], v[134:135], v[12:13] op_sel_hi:[1,0]
    v_pk_mul_f32 v[136:137], v[136:137], v[12:13] op_sel:[0,1]
    v_pk_mul_f32 v[138:139], v[138:139], v[12:13] op_sel:[0,1]
    v_pk_mul_f32 v[140:141], v[140:141], v[12:13] op_sel:[0,1]
    v_pk_mul_f32 v[142:143], v[142:143], v[12:13] op_sel:[0,1]
    v_pk_mul_f32 v[144:145], v[144:145], v[12:13] op_sel:[0,1]
    v_pk_mul_f32 v[146:147], v[146:147], v[12:13] op_sel:[0,1]
    v_pk_mul_f32 v[148:149], v[148:149], v[12:13] op_sel:[0,1]
    v_pk_mul_f32 v[150:151], v[150:151], v[12:13] op_sel:[0,1]
    v_pk_mul_f32 v[80:81], v[32:33], v[96:97]
    v_pk_mul_f32 v[82:83], v[36:37], v[96:97]
    v_pk_fma_f32 v[80:81], v[36:37], v[104:105], v[80:81]
    v_pk_fma_f32 v[82:83], v[32:33], v[104:105], v[82:83] neg_lo:[1,0,0] neg_hi:[1,0,0]
    v_pk_mul_f32 v[84:85], v[34:35], v[98:99]
    v_pk_mul_f32 v[86:87], v[38:39], v[98:99]
    v_pk_fma_f32 v[84:85], v[38:39], v[106:107], v[84:85]
    v_pk_fma_f32 v[86:87], v[34:35], v[106:107], v[86:87] neg_lo:[1,0,0] neg_hi:[1,0,0]
    v_cvt_pk_bf16_f32 v168, v80, v82
    v_cvt_pk_bf16_f32 v169, v81, v83
    v_cvt_pk_bf16_f32 v170, v84, v86
    v_cvt_pk_bf16_f32 v171, v85, v87
    v_pk_mul_f32 v[80:81], v[40:41], v[100:101]
    v_pk_mul_f32 v[82:83], v[44:45], v[100:101]
    v_pk_fma_f32 v[80:81], v[44:45], v[108:109], v[80:81]
    v_pk_fma_f32 v[82:83], v[40:41], v[108:109], v[82:83] neg_lo:[1,0,0] neg_hi:[1,0,0]
    v_pk_mul_f32 v[84:85], v[42:43], v[102:103]
    v_pk_mul_f32 v[86:87], v[46:47], v[102:103]
    v_pk_fma_f32 v[84:85], v[46:47], v[110:111], v[84:85]
    v_pk_fma_f32 v[86:87], v[42:43], v[110:111], v[86:87] neg_lo:[1,0,0] neg_hi:[1,0,0]
    v_cvt_pk_bf16_f32 v172, v80, v82
    v_cvt_pk_bf16_f32 v173, v81, v83
    v_cvt_pk_bf16_f32 v174, v84, v86
    v_cvt_pk_bf16_f32 v175, v85, v87
    v_pk_mul_f32 v[80:81], v[48:49], v[96:97]
    v_pk_mul_f32 v[82:83], v[52:53], v[96:97]
    v_pk_fma_f32 v[80:81], v[52:53], v[104:105], v[80:81]
    v_pk_fma_f32 v[82:83], v[48:49], v[104:105], v[82:83] neg_lo:[1,0,0] neg_hi:[1,0,0]
    v_pk_mul_f32 v[84:85], v[50:51], v[98:99]
    v_pk_mul_f32 v[86:87], v[54:55], v[98:99]
    v_pk_fma_f32 v[84:85], v[54:55], v[106:107], v[84:85]
    v_pk_fma_f32 v[86:87], v[50:51], v[106:107], v[86:87] neg_lo:[1,0,0] neg_hi:[1,0,0]
    v_cvt_pk_bf16_f32 v176, v80, v82
    v_cvt_pk_bf16_f32 v177, v81, v83
    v_cvt_pk_bf16_f32 v178, v84, v86
    v_cvt_pk_bf16_f32 v179, v85, v87
    v_pk_mul_f32 v[80:81], v[56:57], v[100:101]
    v_pk_mul_f32 v[82:83], v[60:61], v[100:101]
    v_pk_fma_f32 v[80:81], v[60:61], v[108:109], v[80:81]
    v_pk_fma_f32 v[82:83], v[56:57], v[108:109], v[82:83] neg_lo:[1,0,0] neg_hi:[1,0,0]
    v_pk_mul_f32 v[84:85], v[58:59], v[102:103]
    v_pk_mul_f32 v[86:87], v[62:63], v[102:103]
    v_pk_fma_f32 v[84:85], v[62:63], v[110:111], v[84:85]
    v_pk_fma_f32 v[86:87], v[58:59], v[110:111], v[86:87] neg_lo:[1,0,0] neg_hi:[1,0,0]
    v_cvt_pk_bf16_f32 v180, v80, v82
    v_cvt_pk_bf16_f32 v181, v81, v83
    v_cvt_pk_bf16_f32 v182, v84, v86
    v_cvt_pk_bf16_f32 v183, v85, v87
    v_mfma_f32_16x16x32_bf16 v[32:35], v[232:235], v[168:171], 0
    s_lshl_b32 s38, s33, 1
    s_lshr_b32 s39, s34, 1
    s_add_u32 s38, s38, s39
    v_mfma_f32_16x16x32_bf16 v[36:39], v[236:239], v[168:171], 0
    s_lshr_b32 s39, s38, 4
    s_lshl_b32 s39, s39, 1
    s_and_b32 s40, s34, 1
    s_add_u32 s39, s39, s40
    v_mfma_f32_16x16x32_bf16 v[40:43], v[232:235], v[172:175], 0
    s_lshl_b32 s41, s32, 2
    s_add_u32 s41, s41, s39
    s_lshl_b32 s41, s41, 4
    s_and_b32 s40, s38, 15
    v_mfma_f32_16x16x32_bf16 v[44:47], v[236:239], v[172:175], 0
    s_add_u32 s41, s41, s40
    s_lshl_b32 s41, s41, 3
    s_add_u32 s41, s41, 28573696
    s_lshl_b32 s39, s39, 12
    v_mfma_f32_16x16x32_bf16 v[48:51], v[232:235], v[176:179], 0
    s_and_b32 s40, s38, 3
    s_lshl_b32 s40, s40, 10
    s_add_u32 s39, s39, s40
    v_mfma_f32_16x16x32_bf16 v[52:55], v[236:239], v[176:179], 0
    s_bfe_u32 s40, s38, 0x20002
    s_lshl_b32 s40, s40, 8
    s_add_u32 s39, s39, s40
    s_lshl_b32 s40, s32, 18
    v_mfma_f32_16x16x32_bf16 v[56:59], v[232:235], v[180:183], 0
    s_add_u32 s39, s39, s40
    s_add_u32 s39, s39, 24117248
    v_lshlrev_b32 v4, 16, v2
    v_lshl_add_u32 v4, v1, 4, v4
    v_mfma_f32_16x16x32_bf16 v[60:63], v[236:239], v[180:183], 0
    v_cmp_eq_u32 vcc, 0, v0
    s_nop 1
    v_cndmask_b32_e64 v5, 2.0, v0, vcc
    s_mul_i32 s35, s62, 2654435761
    s_add_u32 s35, s35, 2135587861
    buffer_store_dwordx2 v[12:13], v5, s[24:27], s41 offen sc1
    v_pk_fma_f32 v[120:121], v[32:33], v[10:11], v[120:121] op_sel_hi:[1,0,1]
    v_pk_fma_f32 v[124:125], v[36:37], v[10:11], v[124:125] op_sel_hi:[1,0,1]
    v_pk_fma_f32 v[128:129], v[40:41], v[10:11], v[128:129] op_sel_hi:[1,0,1]
    v_pk_fma_f32 v[132:133], v[44:45], v[10:11], v[132:133] op_sel_hi:[1,0,1]
    v_pk_fma_f32 v[136:137], v[48:49], v[10:11], v[136:137] op_sel:[0,1,0]
    v_pk_fma_f32 v[140:141], v[52:53], v[10:11], v[140:141] op_sel:[0,1,0]
    v_pk_fma_f32 v[144:145], v[56:57], v[10:11], v[144:145] op_sel:[0,1,0]
    v_pk_fma_f32 v[148:149], v[60:61], v[10:11], v[148:149] op_sel:[0,1,0]
    v_cvt_pk_bf16_f32 v152, v120, v124
    v_cvt_pk_bf16_f32 v153, v128, v132
    v_cvt_pk_bf16_f32 v154, v136, v140
    v_cvt_pk_bf16_f32 v155, v144, v148
    buffer_store_dwordx4 v[152:155], v4, s[24:27], s39 offen sc1
    s_add_u32 s39, s39, 16384
    v_cvt_pk_bf16_f32 v156, v121, v125
    v_cvt_pk_bf16_f32 v157, v129, v133
    v_cvt_pk_bf16_f32 v158, v137, v141
    v_cvt_pk_bf16_f32 v159, v145, v149
    buffer_store_dwordx4 v[156:159], v4, s[24:27], s39 offen sc1
    s_add_u32 s39, s39, 16384
    v_pk_fma_f32 v[122:123], v[34:35], v[10:11], v[122:123] op_sel_hi:[1,0,1]
    v_pk_fma_f32 v[126:127], v[38:39], v[10:11], v[126:127] op_sel_hi:[1,0,1]
    v_pk_fma_f32 v[130:131], v[42:43], v[10:11], v[130:131] op_sel_hi:[1,0,1]
    v_pk_fma_f32 v[134:135], v[46:47], v[10:11], v[134:135] op_sel_hi:[1,0,1]
    v_pk_fma_f32 v[138:139], v[50:51], v[10:11], v[138:139] op_sel:[0,1,0]
    v_pk_fma_f32 v[142:143], v[54:55], v[10:11], v[142:143] op_sel:[0,1,0]
    v_pk_fma_f32 v[146:147], v[58:59], v[10:11], v[146:147] op_sel:[0,1,0]
    v_pk_fma_f32 v[150:151], v[62:63], v[10:11], v[150:151] op_sel:[0,1,0]
    v_cvt_pk_bf16_f32 v160, v122, v126
    v_cvt_pk_bf16_f32 v161, v130, v134
    v_cvt_pk_bf16_f32 v162, v138, v142
    v_cvt_pk_bf16_f32 v163, v146, v150
    buffer_store_dwordx4 v[160:163], v4, s[24:27], s39 offen sc1
    s_add_u32 s39, s39, 16384
    v_cvt_pk_bf16_f32 v164, v123, v127
    v_cvt_pk_bf16_f32 v165, v131, v135
    v_cvt_pk_bf16_f32 v166, v139, v143
    v_cvt_pk_bf16_f32 v167, v147, v151
    buffer_store_dwordx4 v[164:167], v4, s[24:27], s39 offen sc1
    s_mov_b32 s16, s56
    s_mov_b32 s17, s57
    s_mov_b32 s18, 8388608
    s_mov_b32 s19, 0x00020000
    s_waitcnt vmcnt(41)
    s_barrier
    ds_read_b128 v[64:67], v20 offset:0
    ds_read_b128 v[68:71], v20 offset:2048
    ds_read_b128 v[72:75], v20 offset:4096
    ds_read_b128 v[76:79], v20 offset:6144
    s_lshl_b32 s42, s36, 5
    s_add_u32 s42, s42, s58
    s_add_u32 s43, s42, 0x20000
    s_add_u32 m0, s37, 65536
    buffer_load_dwordx4 a[128:131], v3, s[24:27], s42 offen offset:0
    s_waitcnt lgkmcnt(0)
    s_nop 0
    v_mfma_f32_16x16x32_bf16 v[32:35], a[0:3], v[64:67], 0
    ds_read_b128 v[80:83], v21 offset:0
    buffer_load_dwordx4 v16, s[12:15], s36 offen lds
    v_mfma_f32_16x16x32_bf16 v[48:51], a[16:19], v[64:67], 0
    ds_read_b128 v[84:87], v21 offset:2048
    buffer_load_dwordx4 a[144:147], v3, s[24:27], s43 offen offset:0
    v_mfma_f32_16x16x32_bf16 v[36:39], a[0:3], v[68:71], 0
    ds_read_b128 v[88:91], v21 offset:4096
    s_add_u32 m0, s37, 66560
    v_mfma_f32_16x16x32_bf16 v[52:55], a[16:19], v[68:71], 0
    ds_read_b128 v[92:95], v21 offset:6144
    buffer_load_dwordx4 a[132:135], v3, s[24:27], s42 offen offset:1024
    v_mfma_f32_16x16x32_bf16 v[40:43], a[0:3], v[72:75], 0
    buffer_load_dwordx4 v17, s[12:15], s36 offen lds
    v_mfma_f32_16x16x32_bf16 v[56:59], a[16:19], v[72:75], 0
    v_mfma_f32_16x16x32_bf16 v[44:47], a[0:3], v[76:79], 0
    v_mfma_f32_16x16x32_bf16 v[60:63], a[16:19], v[76:79], 0
    s_waitcnt lgkmcnt(0)
    s_nop 0
    v_mfma_f32_16x16x32_bf16 v[32:35], a[4:7], v[80:83], v[32:35]
    ds_read_b128 v[64:67], v22 offset:0
    buffer_load_dwordx4 a[148:151], v3, s[24:27], s43 offen offset:1024
    v_mfma_f32_16x16x32_bf16 v[48:51], a[20:23], v[80:83], v[48:51]
    ds_read_b128 v[68:71], v22 offset:2048
    s_add_u32 m0, s37, 67584
    v_mfma_f32_16x16x32_bf16 v[36:39], a[4:7], v[84:87], v[36:39]
    ds_read_b128 v[72:75], v22 offset:4096
    buffer_load_dwordx4 a[136:139], v3, s[24:27], s42 offen offset:2048
    v_mfma_f32_16x16x32_bf16 v[52:55], a[20:23], v[84:87], v[52:55]
    ds_read_b128 v[76:79], v22 offset:6144
    buffer_load_dwordx4 v18, s[12:15], s36 offen lds
    v_mfma_f32_16x16x32_bf16 v[40:43], a[4:7], v[88:91], v[40:43]
    buffer_load_dwordx4 a[152:155], v3, s[24:27], s43 offen offset:2048
    v_mfma_f32_16x16x32_bf16 v[56:59], a[20:23], v[88:91], v[56:59]
    v_mfma_f32_16x16x32_bf16 v[44:47], a[4:7], v[92:95], v[44:47]
    v_mfma_f32_16x16x32_bf16 v[60:63], a[20:23], v[92:95], v[60:63]
    s_waitcnt lgkmcnt(0)
    s_nop 0
    v_mfma_f32_16x16x32_bf16 v[32:35], a[8:11], v[64:67], v[32:35]
    ds_read_b128 v[80:83], v23 offset:0
    s_add_u32 m0, s37, 68608
    v_mfma_f32_16x16x32_bf16 v[48:51], a[24:27], v[64:67], v[48:51]
    ds_read_b128 v[84:87], v23 offset:2048
    buffer_load_dwordx4 a[140:143], v3, s[24:27], s42 offen offset:3072
    v_mfma_f32_16x16x32_bf16 v[36:39], a[8:11], v[68:71], v[36:39]
    ds_read_b128 v[88:91], v23 offset:4096
    buffer_load_dwordx4 v19, s[12:15], s36 offen lds
    v_mfma_f32_16x16x32_bf16 v[52:55], a[24:27], v[68:71], v[52:55]
    ds_read_b128 v[92:95], v23 offset:6144
    buffer_load_dwordx4 a[156:159], v3, s[24:27], s43 offen offset:3072
    v_mfma_f32_16x16x32_bf16 v[40:43], a[8:11], v[72:75], v[40:43]
    s_add_u32 s36, s36, 128
    s_and_b32 s36, s36, 2047
    v_mfma_f32_16x16x32_bf16 v[56:59], a[24:27], v[72:75], v[56:59]
    v_mfma_f32_16x16x32_bf16 v[44:47], a[8:11], v[76:79], v[44:47]
    v_mfma_f32_16x16x32_bf16 v[60:63], a[24:27], v[76:79], v[60:63]
    s_waitcnt vmcnt(41) lgkmcnt(0)
    s_barrier
    v_mfma_f32_16x16x32_bf16 v[32:35], a[12:15], v[80:83], v[32:35]
    ds_read_b128 v[64:67], v20 offset:16384
    s_lshl_b32 s42, s36, 5
    v_mfma_f32_16x16x32_bf16 v[48:51], a[28:31], v[80:83], v[48:51]
    ds_read_b128 v[68:71], v20 offset:18432
    s_add_u32 s42, s42, s58
    v_mfma_f32_16x16x32_bf16 v[36:39], a[12:15], v[84:87], v[36:39]
    ds_read_b128 v[72:75], v20 offset:20480
    s_add_u32 s43, s42, 0x20000
    v_mfma_f32_16x16x32_bf16 v[52:55], a[28:31], v[84:87], v[52:55]
    ds_read_b128 v[76:79], v20 offset:22528
    s_add_u32 m0, s37, 81920
    v_mfma_f32_16x16x32_bf16 v[40:43], a[12:15], v[88:91], v[40:43]
    buffer_load_dwordx4 a[0:3], v3, s[24:27], s42 offen offset:0
    v_mfma_f32_16x16x32_bf16 v[56:59], a[28:31], v[88:91], v[56:59]
    v_mfma_f32_16x16x32_bf16 v[44:47], a[12:15], v[92:95], v[44:47]
    v_mfma_f32_16x16x32_bf16 v[60:63], a[28:31], v[92:95], v[60:63]
    s_waitcnt lgkmcnt(0)
    s_nop 0
    v_mfma_f32_16x16x32_bf16 v[32:35], a[32:35], v[64:67], v[32:35]
    ds_read_b128 v[80:83], v21 offset:16384
    buffer_load_dwordx4 v16, s[12:15], s36 offen lds
    v_mfma_f32_16x16x32_bf16 v[48:51], a[48:51], v[64:67], v[48:51]
    ds_read_b128 v[84:87], v21 offset:18432
    buffer_load_dwordx4 a[16:19], v3, s[24:27], s43 offen offset:0
    v_mfma_f32_16x16x32_bf16 v[36:39], a[32:35], v[68:71], v[36:39]
    ds_read_b128 v[88:91], v21 offset:20480
    s_add_u32 m0, s37, 82944
    v_mfma_f32_16x16x32_bf16 v[52:55], a[48:51], v[68:71], v[52:55]
    ds_read_b128 v[92:95], v21 offset:22528
    buffer_load_dwordx4 a[4:7], v3, s[24:27], s42 offen offset:1024
    v_mfma_f32_16x16x32_bf16 v[40:43], a[32:35], v[72:75], v[40:43]
    buffer_load_dwordx4 v17, s[12:15], s36 offen lds
    v_mfma_f32_16x16x32_bf16 v[56:59], a[48:51], v[72:75], v[56:59]
    v_mfma_f32_16x16x32_bf16 v[44:47], a[32:35], v[76:79], v[44:47]
    v_mfma_f32_16x16x32_bf16 v[60:63], a[48:51], v[76:79], v[60:63]
    s_waitcnt lgkmcnt(0)
    s_nop 0
    v_mfma_f32_16x16x32_bf16 v[32:35], a[36:39], v[80:83], v[32:35]
    ds_read_b128 v[64:67], v22 offset:16384
    buffer_load_dwordx4 a[20:23], v3, s[24:27], s43 offen offset:1024
    v_mfma_f32_16x16x32_bf16 v[48:51], a[52:55], v[80:83], v[48:51]
    ds_read_b128 v[68:71], v22 offset:18432
    s_add_u32 m0, s37, 83968
    v_mfma_f32_16x16x32_bf16 v[36:39], a[36:39], v[84:87], v[36:39]
    ds_read_b128 v[72:75], v22 offset:20480
    buffer_load_dwordx4 a[8:11], v3, s[24:27], s42 offen offset:2048
    v_mfma_f32_16x16x32_bf16 v[52:55], a[52:55], v[84:87], v[52:55]
    ds_read_b128 v[76:79], v22 offset:22528
    buffer_load_dwordx4 v18, s[12:15], s36 offen lds
    v_mfma_f32_16x16x32_bf16 v[40:43], a[36:39], v[88:91], v[40:43]
    buffer_load_dwordx4 a[24:27], v3, s[24:27], s43 offen offset:2048
    v_mfma_f32_16x16x32_bf16 v[56:59], a[52:55], v[88:91], v[56:59]
    v_mfma_f32_16x16x32_bf16 v[44:47], a[36:39], v[92:95], v[44:47]
    v_mfma_f32_16x16x32_bf16 v[60:63], a[52:55], v[92:95], v[60:63]
    s_waitcnt lgkmcnt(0)
    s_nop 0
    v_mfma_f32_16x16x32_bf16 v[32:35], a[40:43], v[64:67], v[32:35]
    ds_read_b128 v[80:83], v23 offset:16384
    s_add_u32 m0, s37, 84992
    v_mfma_f32_16x16x32_bf16 v[48:51], a[56:59], v[64:67], v[48:51]
    ds_read_b128 v[84:87], v23 offset:18432
    buffer_load_dwordx4 a[12:15], v3, s[24:27], s42 offen offset:3072
    v_mfma_f32_16x16x32_bf16 v[36:39], a[40:43], v[68:71], v[36:39]
    ds_read_b128 v[88:91], v23 offset:20480
    buffer_load_dwordx4 v19, s[12:15], s36 offen lds
    v_mfma_f32_16x16x32_bf16 v[52:55], a[56:59], v[68:71], v[52:55]
    ds_read_b128 v[92:95], v23 offset:22528
    buffer_load_dwordx4 a[28:31], v3, s[24:27], s43 offen offset:3072
    v_mfma_f32_16x16x32_bf16 v[40:43], a[40:43], v[72:75], v[40:43]
    s_add_u32 s36, s36, 128
    s_and_b32 s36, s36, 2047
    v_mfma_f32_16x16x32_bf16 v[56:59], a[56:59], v[72:75], v[56:59]
    v_mfma_f32_16x16x32_bf16 v[44:47], a[40:43], v[76:79], v[44:47]
    v_mfma_f32_16x16x32_bf16 v[60:63], a[56:59], v[76:79], v[60:63]
    s_waitcnt vmcnt(41) lgkmcnt(0)
    s_barrier
    v_mfma_f32_16x16x32_bf16 v[32:35], a[44:47], v[80:83], v[32:35]
    ds_read_b128 v[64:67], v20 offset:32768
    s_lshl_b32 s42, s36, 5
    v_mfma_f32_16x16x32_bf16 v[48:51], a[60:63], v[80:83], v[48:51]
    ds_read_b128 v[68:71], v20 offset:34816
    s_add_u32 s42, s42, s58
    v_mfma_f32_16x16x32_bf16 v[36:39], a[44:47], v[84:87], v[36:39]
    ds_read_b128 v[72:75], v20 offset:36864
    s_add_u32 s43, s42, 0x20000
    v_mfma_f32_16x16x32_bf16 v[52:55], a[60:63], v[84:87], v[52:55]
    ds_read_b128 v[76:79], v20 offset:38912
    s_add_u32 m0, s37, 98304
    v_mfma_f32_16x16x32_bf16 v[40:43], a[44:47], v[88:91], v[40:43]
    buffer_load_dwordx4 a[32:35], v3, s[24:27], s42 offen offset:0
    v_mfma_f32_16x16x32_bf16 v[56:59], a[60:63], v[88:91], v[56:59]
    v_mfma_f32_16x16x32_bf16 v[44:47], a[44:47], v[92:95], v[44:47]
    v_mfma_f32_16x16x32_bf16 v[60:63], a[60:63], v[92:95], v[60:63]
    s_waitcnt lgkmcnt(0)
    s_nop 0
    v_mfma_f32_16x16x32_bf16 v[32:35], a[64:67], v[64:67], v[32:35]
    ds_read_b128 v[80:83], v21 offset:32768
    buffer_load_dwordx4 v16, s[12:15], s36 offen lds
    v_mfma_f32_16x16x32_bf16 v[48:51], a[80:83], v[64:67], v[48:51]
    ds_read_b128 v[84:87], v21 offset:34816
    buffer_load_dwordx4 a[48:51], v3, s[24:27], s43 offen offset:0
    v_mfma_f32_16x16x32_bf16 v[36:39], a[64:67], v[68:71], v[36:39]
    ds_read_b128 v[88:91], v21 offset:36864
    s_add_u32 m0, s37, 99328
    v_mfma_f32_16x16x32_bf16 v[52:55], a[80:83], v[68:71], v[52:55]
    ds_read_b128 v[92:95], v21 offset:38912
    buffer_load_dwordx4 a[36:39], v3, s[24:27], s42 offen offset:1024
    v_mfma_f32_16x16x32_bf16 v[40:43], a[64:67], v[72:75], v[40:43]
    buffer_load_dwordx4 v17, s[12:15], s36 offen lds
    v_mfma_f32_16x16x32_bf16 v[56:59], a[80:83], v[72:75], v[56:59]
    v_mfma_f32_16x16x32_bf16 v[44:47], a[64:67], v[76:79], v[44:47]
    v_mfma_f32_16x16x32_bf16 v[60:63], a[80:83], v[76:79], v[60:63]
    s_waitcnt lgkmcnt(0)
    s_nop 0
    v_mfma_f32_16x16x32_bf16 v[32:35], a[68:71], v[80:83], v[32:35]
    ds_read_b128 v[64:67], v22 offset:32768
    buffer_load_dwordx4 a[52:55], v3, s[24:27], s43 offen offset:1024
    v_mfma_f32_16x16x32_bf16 v[48:51], a[84:87], v[80:83], v[48:51]
    ds_read_b128 v[68:71], v22 offset:34816
    s_add_u32 m0, s37, 100352
    v_mfma_f32_16x16x32_bf16 v[36:39], a[68:71], v[84:87], v[36:39]
    ds_read_b128 v[72:75], v22 offset:36864
    buffer_load_dwordx4 a[40:43], v3, s[24:27], s42 offen offset:2048
    v_mfma_f32_16x16x32_bf16 v[52:55], a[84:87], v[84:87], v[52:55]
    ds_read_b128 v[76:79], v22 offset:38912
    buffer_load_dwordx4 v18, s[12:15], s36 offen lds
    v_mfma_f32_16x16x32_bf16 v[40:43], a[68:71], v[88:91], v[40:43]
    buffer_load_dwordx4 a[56:59], v3, s[24:27], s43 offen offset:2048
    v_mfma_f32_16x16x32_bf16 v[56:59], a[84:87], v[88:91], v[56:59]
    v_mfma_f32_16x16x32_bf16 v[44:47], a[68:71], v[92:95], v[44:47]
    v_mfma_f32_16x16x32_bf16 v[60:63], a[84:87], v[92:95], v[60:63]
    s_waitcnt lgkmcnt(0)
    s_nop 0
    v_mfma_f32_16x16x32_bf16 v[32:35], a[72:75], v[64:67], v[32:35]
    ds_read_b128 v[80:83], v23 offset:32768
    s_add_u32 m0, s37, 101376
    v_mfma_f32_16x16x32_bf16 v[48:51], a[88:91], v[64:67], v[48:51]
    ds_read_b128 v[84:87], v23 offset:34816
    buffer_load_dwordx4 a[44:47], v3, s[24:27], s42 offen offset:3072
    v_mfma_f32_16x16x32_bf16 v[36:39], a[72:75], v[68:71], v[36:39]
    ds_read_b128 v[88:91], v23 offset:36864
    buffer_load_dwordx4 v19, s[12:15], s36 offen lds
    v_mfma_f32_16x16x32_bf16 v[52:55], a[88:91], v[68:71], v[52:55]
    ds_read_b128 v[92:95], v23 offset:38912
    buffer_load_dwordx4 a[60:63], v3, s[24:27], s43 offen offset:3072
    v_mfma_f32_16x16x32_bf16 v[40:43], a[72:75], v[72:75], v[40:43]
    s_add_u32 s36, s36, 128
    s_and_b32 s36, s36, 2047
    v_mfma_f32_16x16x32_bf16 v[56:59], a[88:91], v[72:75], v[56:59]
    v_mfma_f32_16x16x32_bf16 v[44:47], a[72:75], v[76:79], v[44:47]
    v_mfma_f32_16x16x32_bf16 v[60:63], a[88:91], v[76:79], v[60:63]
    s_waitcnt vmcnt(41) lgkmcnt(0)
    s_barrier
    v_mfma_f32_16x16x32_bf16 v[32:35], a[76:79], v[80:83], v[32:35]
    ds_read_b128 v[64:67], v20 offset:49152
    s_lshl_b32 s42, s36, 5
    v_mfma_f32_16x16x32_bf16 v[48:51], a[92:95], v[80:83], v[48:51]
    ds_read_b128 v[68:71], v20 offset:51200
    s_add_u32 s42, s42, s58
    v_mfma_f32_16x16x32_bf16 v[36:39], a[76:79], v[84:87], v[36:39]
    ds_read_b128 v[72:75], v20 offset:53248
    s_add_u32 s43, s42, 0x20000
    v_mfma_f32_16x16x32_bf16 v[52:55], a[92:95], v[84:87], v[52:55]
    ds_read_b128 v[76:79], v20 offset:55296
    s_add_u32 m0, s37, 114688
    v_mfma_f32_16x16x32_bf16 v[40:43], a[76:79], v[88:91], v[40:43]
    buffer_load_dwordx4 a[64:67], v3, s[24:27], s42 offen offset:0
    v_mfma_f32_16x16x32_bf16 v[56:59], a[92:95], v[88:91], v[56:59]
    v_mfma_f32_16x16x32_bf16 v[44:47], a[76:79], v[92:95], v[44:47]
    v_mfma_f32_16x16x32_bf16 v[60:63], a[92:95], v[92:95], v[60:63]
    s_waitcnt lgkmcnt(0)
    s_nop 0
    v_mfma_f32_16x16x32_bf16 v[32:35], a[96:99], v[64:67], v[32:35]
    ds_read_b128 v[80:83], v21 offset:49152
    buffer_load_dwordx4 v16, s[12:15], s36 offen lds
    v_mfma_f32_16x16x32_bf16 v[48:51], a[112:115], v[64:67], v[48:51]
    ds_read_b128 v[84:87], v21 offset:51200
    buffer_load_dwordx4 a[80:83], v3, s[24:27], s43 offen offset:0
    v_mfma_f32_16x16x32_bf16 v[36:39], a[96:99], v[68:71], v[36:39]
    ds_read_b128 v[88:91], v21 offset:53248
    s_add_u32 m0, s37, 115712
    v_mfma_f32_16x16x32_bf16 v[52:55], a[112:115], v[68:71], v[52:55]
    ds_read_b128 v[92:95], v21 offset:55296
    buffer_load_dwordx4 a[68:71], v3, s[24:27], s42 offen offset:1024
    v_mfma_f32_16x16x32_bf16 v[40:43], a[96:99], v[72:75], v[40:43]
    buffer_load_dwordx4 v17, s[12:15], s36 offen lds
    v_mfma_f32_16x16x32_bf16 v[56:59], a[112:115], v[72:75], v[56:59]
    v_mfma_f32_16x16x32_bf16 v[44:47], a[96:99], v[76:79], v[44:47]
    v_mfma_f32_16x16x32_bf16 v[60:63], a[112:115], v[76:79], v[60:63]
    s_waitcnt lgkmcnt(0)
    s_nop 0
    v_mfma_f32_16x16x32_bf16 v[32:35], a[100:103], v[80:83], v[32:35]
    ds_read_b128 v[64:67], v22 offset:49152
    buffer_load_dwordx4 a[84:87], v3, s[24:27], s43 offen offset:1024
    v_mfma_f32_16x16x32_bf16 v[48:51], a[116:119], v[80:83], v[48:51]
    ds_read_b128 v[68:71], v22 offset:51200
    s_add_u32 m0, s37, 116736
    v_mfma_f32_16x16x32_bf16 v[36:39], a[100:103], v[84:87], v[36:39]
    ds_read_b128 v[72:75], v22 offset:53248
    buffer_load_dwordx4 a[72:75], v3, s[24:27], s42 offen offset:2048
    v_mfma_f32_16x16x32_bf16 v[52:55], a[116:119], v[84:87], v[52:55]
    ds_read_b128 v[76:79], v22 offset:55296
    buffer_load_dwordx4 v18, s[12:15], s36 offen lds
    v_mfma_f32_16x16x32_bf16 v[40:43], a[100:103], v[88:91], v[40:43]
    buffer_load_dwordx4 a[88:91], v3, s[24:27], s43 offen offset:2048
    v_mfma_f32_16x16x32_bf16 v[56:59], a[116:119], v[88:91], v[56:59]
    v_mfma_f32_16x16x32_bf16 v[44:47], a[100:103], v[92:95], v[44:47]
    v_mfma_f32_16x16x32_bf16 v[60:63], a[116:119], v[92:95], v[60:63]
    s_waitcnt lgkmcnt(0)
    s_nop 0
    v_mfma_f32_16x16x32_bf16 v[32:35], a[104:107], v[64:67], v[32:35]
    ds_read_b128 v[80:83], v23 offset:49152
    s_add_u32 m0, s37, 117760
    v_mfma_f32_16x16x32_bf16 v[48:51], a[120:123], v[64:67], v[48:51]
    ds_read_b128 v[84:87], v23 offset:51200
    buffer_load_dwordx4 a[76:79], v3, s[24:27], s42 offen offset:3072
    v_mfma_f32_16x16x32_bf16 v[36:39], a[104:107], v[68:71], v[36:39]
    ds_read_b128 v[88:91], v23 offset:53248
    buffer_load_dwordx4 v19, s[12:15], s36 offen lds
    v_mfma_f32_16x16x32_bf16 v[52:55], a[120:123], v[68:71], v[52:55]
    ds_read_b128 v[92:95], v23 offset:55296
    buffer_load_dwordx4 a[92:95], v3, s[24:27], s43 offen offset:3072
    v_mfma_f32_16x16x32_bf16 v[40:43], a[104:107], v[72:75], v[40:43]
    s_add_u32 s36, s36, 128
    s_and_b32 s36, s36, 2047
    v_mfma_f32_16x16x32_bf16 v[56:59], a[120:123], v[72:75], v[56:59]
    v_mfma_f32_16x16x32_bf16 v[44:47], a[104:107], v[76:79], v[44:47]
    v_mfma_f32_16x16x32_bf16 v[60:63], a[120:123], v[76:79], v[60:63]
    s_waitcnt vmcnt(36) lgkmcnt(0)
    s_barrier
    v_mfma_f32_16x16x32_bf16 v[32:35], a[108:111], v[80:83], v[32:35]
    ds_read_b128 v[64:67], v24 offset:0
    s_lshl_b32 s42, s36, 5
    v_mfma_f32_16x16x32_bf16 v[48:51], a[124:127], v[80:83], v[48:51]
    ds_read_b128 v[68:71], v24 offset:2048
    s_add_u32 s42, s42, s58
    v_mfma_f32_16x16x32_bf16 v[36:39], a[108:111], v[84:87], v[36:39]
    ds_read_b128 v[72:75], v24 offset:4096
    s_add_u32 s43, s42, 0x20000
    v_mfma_f32_16x16x32_bf16 v[52:55], a[124:127], v[84:87], v[52:55]
    ds_read_b128 v[76:79], v24 offset:6144
    s_add_u32 m0, s37, 0
    s_nop 0
    v_mfma_f32_16x16x32_bf16 v[40:43], a[108:111], v[88:91], v[40:43]
    buffer_load_dwordx4 a[96:99], v3, s[24:27], s42 offen offset:0
    buffer_load_dwordx4 v16, s[12:15], s36 offen lds
    v_mfma_f32_16x16x32_bf16 v[56:59], a[124:127], v[88:91], v[56:59]
    buffer_load_dwordx4 a[112:115], v3, s[24:27], s43 offen offset:0
    s_add_u32 m0, s37, 1024
    v_mfma_f32_16x16x32_bf16 v[44:47], a[108:111], v[92:95], v[44:47]
    v_mfma_f32_16x16x32_bf16 v[60:63], a[124:127], v[92:95], v[60:63]
    s_waitcnt lgkmcnt(0)
    s_nop 0
    v_mfma_f32_16x16x32_bf16 v[32:35], a[128:131], v[64:67], v[32:35]
    ds_read_b128 v[80:83], v25 offset:0
    buffer_load_dwordx4 a[100:103], v3, s[24:27], s42 offen offset:1024
    v_mfma_f32_16x16x32_bf16 v[48:51], a[144:147], v[64:67], v[48:51]
    ds_read_b128 v[84:87], v25 offset:2048
    buffer_load_dwordx4 v17, s[12:15], s36 offen lds
    v_mfma_f32_16x16x32_bf16 v[36:39], a[128:131], v[68:71], v[36:39]
    ds_read_b128 v[88:91], v25 offset:4096
    buffer_load_dwordx4 a[116:119], v3, s[24:27], s43 offen offset:1024
    v_mfma_f32_16x16x32_bf16 v[52:55], a[144:147], v[68:71], v[52:55]
    ds_read_b128 v[92:95], v25 offset:6144
    s_add_u32 m0, s37, 2048
    v_mfma_f32_16x16x32_bf16 v[40:43], a[128:131], v[72:75], v[40:43]
    buffer_load_dwordx4 a[104:107], v3, s[24:27], s42 offen offset:2048
    buffer_load_dwordx4 v18, s[12:15], s36 offen lds
    v_mfma_f32_16x16x32_bf16 v[56:59], a[144:147], v[72:75], v[56:59]
    buffer_load_dwordx4 a[120:123], v3, s[24:27], s43 offen offset:2048
    s_add_u32 m0, s37, 3072
    v_mfma_f32_16x16x32_bf16 v[44:47], a[128:131], v[76:79], v[44:47]
    v_mfma_f32_16x16x32_bf16 v[60:63], a[144:147], v[76:79], v[60:63]
    s_waitcnt lgkmcnt(0)
    s_nop 0
    v_mfma_f32_16x16x32_bf16 v[32:35], a[132:135], v[80:83], v[32:35]
    ds_read_b128 v[64:67], v26 offset:0
    buffer_load_dwordx4 a[108:111], v3, s[24:27], s42 offen offset:3072
    v_mfma_f32_16x16x32_bf16 v[48:51], a[148:151], v[80:83], v[48:51]
    ds_read_b128 v[68:71], v26 offset:2048
    buffer_load_dwordx4 v19, s[12:15], s36 offen lds
    v_mfma_f32_16x16x32_bf16 v[36:39], a[132:135], v[84:87], v[36:39]
    ds_read_b128 v[72:75], v26 offset:4096
    buffer_load_dwordx4 a[124:127], v3, s[24:27], s43 offen offset:3072
    v_mfma_f32_16x16x32_bf16 v[52:55], a[148:151], v[84:87], v[52:55]
    ds_read_b128 v[76:79], v26 offset:6144
    s_add_u32 s36, s36, 128
    v_mfma_f32_16x16x32_bf16 v[40:43], a[132:135], v[88:91], v[40:43]
    s_and_b32 s36, s36, 2047
    s_lshl_b32 s38, s32, 7
    v_mfma_f32_16x16x32_bf16 v[56:59], a[148:151], v[88:91], v[56:59]
    s_add_u32 s38, s38, 28594176
    s_lshl_b32 s40, s33, 2
    v_mfma_f32_16x16x32_bf16 v[44:47], a[132:135], v[92:95], v[44:47]
    v_mfma_f32_16x16x32_bf16 v[60:63], a[148:151], v[92:95], v[60:63]
    s_waitcnt lgkmcnt(0)
    v_mfma_f32_16x16x32_bf16 v[32:35], a[136:139], v[64:67], v[32:35]
    ds_read_b128 v[80:83], v27 offset:0
    s_add_u32 s40, s40, s38
    v_mfma_f32_16x16x32_bf16 v[48:51], a[152:155], v[64:67], v[48:51]
    ds_read_b128 v[84:87], v27 offset:2048
    s_cmp_eq_u32 s34, 0
    v_mfma_f32_16x16x32_bf16 v[36:39], a[136:139], v[68:71], v[36:39]
    ds_read_b128 v[88:91], v27 offset:4096
    s_cselect_b32 s39, 1, 0
    v_mfma_f32_16x16x32_bf16 v[52:55], a[152:155], v[68:71], v[52:55]
    ds_read_b128 v[92:95], v27 offset:6144
    v_mov_b32_e64 v4, s35
    v_mfma_f32_16x16x32_bf16 v[40:43], a[136:139], v[72:75], v[40:43]
    v_cmp_gt_u32 vcc, s39, v0
    s_nop 1
    v_cndmask_b32_e64 v5, 2.0, v0, vcc
    v_mfma_f32_16x16x32_bf16 v[56:59], a[152:155], v[72:75], v[56:59]
    buffer_store_dword v4, v5, s[24:27], s40 offen sc1
    v_lshlrev_b32_e64 v6, 2, v1
    v_mfma_f32_16x16x32_bf16 v[44:47], a[136:139], v[76:79], v[44:47]
    v_mfma_f32_16x16x32_bf16 v[60:63], a[152:155], v[76:79], v[60:63]
    s_waitcnt vmcnt(37) lgkmcnt(0)
    s_barrier
    v_mfma_f32_16x16x32_bf16 v[32:35], a[140:143], v[80:83], v[32:35]
    ds_read_b128 v[64:67], v24 offset:16384
    s_lshl_b32 s42, s36, 5
    v_mfma_f32_16x16x32_bf16 v[48:51], a[156:159], v[80:83], v[48:51]
    ds_read_b128 v[68:71], v24 offset:18432
    s_add_u32 s42, s42, s58
    v_mfma_f32_16x16x32_bf16 v[36:39], a[140:143], v[84:87], v[36:39]
    ds_read_b128 v[72:75], v24 offset:20480
    s_add_u32 s43, s42, 0x20000
    v_mfma_f32_16x16x32_bf16 v[52:55], a[156:159], v[84:87], v[52:55]
    ds_read_b128 v[76:79], v24 offset:22528
    s_add_u32 m0, s37, 16384
    v_mfma_f32_16x16x32_bf16 v[40:43], a[140:143], v[88:91], v[40:43]
    buffer_load_dwordx4 a[128:131], v3, s[24:27], s42 offen offset:0
    v_mfma_f32_16x16x32_bf16 v[56:59], a[156:159], v[88:91], v[56:59]
    v_mfma_f32_16x16x32_bf16 v[44:47], a[140:143], v[92:95], v[44:47]
    v_mfma_f32_16x16x32_bf16 v[60:63], a[156:159], v[92:95], v[60:63]
    s_waitcnt lgkmcnt(0)
    s_nop 0
    v_mfma_f32_16x16x32_bf16 v[32:35], a[0:3], v[64:67], v[32:35]
    ds_read_b128 v[80:83], v25 offset:16384
    buffer_load_dwordx4 v16, s[12:15], s36 offen lds
    v_mfma_f32_16x16x32_bf16 v[48:51], a[16:19], v[64:67], v[48:51]
    ds_read_b128 v[84:87], v25 offset:18432
    buffer_load_dwordx4 a[144:147], v3, s[24:27], s43 offen offset:0
    v_mfma_f32_16x16x32_bf16 v[36:39], a[0:3], v[68:71], v[36:39]
    ds_read_b128 v[88:91], v25 offset:20480
    s_add_u32 m0, s37, 17408
    v_mfma_f32_16x16x32_bf16 v[52:55], a[16:19], v[68:71], v[52:55]
    ds_read_b128 v[92:95], v25 offset:22528
    buffer_load_dwordx4 a[132:135], v3, s[24:27], s42 offen offset:1024
    v_mfma_f32_16x16x32_bf16 v[40:43], a[0:3], v[72:75], v[40:43]
    buffer_load_dwordx4 v17, s[12:15], s36 offen lds
    v_mfma_f32_16x16x32_bf16 v[56:59], a[16:19], v[72:75], v[56:59]
    v_mfma_f32_16x16x32_bf16 v[44:47], a[0:3], v[76:79], v[44:47]
    v_mfma_f32_16x16x32_bf16 v[60:63], a[16:19], v[76:79], v[60:63]
    s_waitcnt lgkmcnt(0)
    s_nop 0
    v_mfma_f32_16x16x32_bf16 v[32:35], a[4:7], v[80:83], v[32:35]
    ds_read_b128 v[64:67], v26 offset:16384
    buffer_load_dwordx4 a[148:151], v3, s[24:27], s43 offen offset:1024
    v_mfma_f32_16x16x32_bf16 v[48:51], a[20:23], v[80:83], v[48:51]
    ds_read_b128 v[68:71], v26 offset:18432
    s_add_u32 m0, s37, 18432
    v_mfma_f32_16x16x32_bf16 v[36:39], a[4:7], v[84:87], v[36:39]
    ds_read_b128 v[72:75], v26 offset:20480
    buffer_load_dwordx4 a[136:139], v3, s[24:27], s42 offen offset:2048
    v_mfma_f32_16x16x32_bf16 v[52:55], a[20:23], v[84:87], v[52:55]
    ds_read_b128 v[76:79], v26 offset:22528
    buffer_load_dwordx4 v18, s[12:15], s36 offen lds
    v_mfma_f32_16x16x32_bf16 v[40:43], a[4:7], v[88:91], v[40:43]
    buffer_load_dwordx4 a[152:155], v3, s[24:27], s43 offen offset:2048
    v_mfma_f32_16x16x32_bf16 v[56:59], a[20:23], v[88:91], v[56:59]
    v_mfma_f32_16x16x32_bf16 v[44:47], a[4:7], v[92:95], v[44:47]
    v_mfma_f32_16x16x32_bf16 v[60:63], a[20:23], v[92:95], v[60:63]
    s_waitcnt lgkmcnt(0)
    s_nop 0
    v_mfma_f32_16x16x32_bf16 v[32:35], a[8:11], v[64:67], v[32:35]
    ds_read_b128 v[80:83], v27 offset:16384
    s_add_u32 m0, s37, 19456
    v_mfma_f32_16x16x32_bf16 v[48:51], a[24:27], v[64:67], v[48:51]
    ds_read_b128 v[84:87], v27 offset:18432
    buffer_load_dwordx4 a[140:143], v3, s[24:27], s42 offen offset:3072
    v_mfma_f32_16x16x32_bf16 v[36:39], a[8:11], v[68:71], v[36:39]
    ds_read_b128 v[88:91], v27 offset:20480
    buffer_load_dwordx4 v19, s[12:15], s36 offen lds
    v_mfma_f32_16x16x32_bf16 v[52:55], a[24:27], v[68:71], v[52:55]
    ds_read_b128 v[92:95], v27 offset:22528
    buffer_load_dwordx4 a[156:159], v3, s[24:27], s43 offen offset:3072
    v_mfma_f32_16x16x32_bf16 v[40:43], a[8:11], v[72:75], v[40:43]
    s_add_u32 s36, s36, 128
    s_and_b32 s36, s36, 2047
    v_mfma_f32_16x16x32_bf16 v[56:59], a[24:27], v[72:75], v[56:59]
    v_mfma_f32_16x16x32_bf16 v[44:47], a[8:11], v[76:79], v[44:47]
    v_mfma_f32_16x16x32_bf16 v[60:63], a[24:27], v[76:79], v[60:63]
    s_waitcnt vmcnt(37) lgkmcnt(0)
    s_barrier
    v_mfma_f32_16x16x32_bf16 v[32:35], a[12:15], v[80:83], v[32:35]
    ds_read_b128 v[64:67], v24 offset:32768
    s_lshl_b32 s42, s36, 5
    v_mfma_f32_16x16x32_bf16 v[48:51], a[28:31], v[80:83], v[48:51]
    ds_read_b128 v[68:71], v24 offset:34816
    s_add_u32 s42, s42, s58
    v_mfma_f32_16x16x32_bf16 v[36:39], a[12:15], v[84:87], v[36:39]
    ds_read_b128 v[72:75], v24 offset:36864
    s_add_u32 s43, s42, 0x20000
    v_mfma_f32_16x16x32_bf16 v[52:55], a[28:31], v[84:87], v[52:55]
    ds_read_b128 v[76:79], v24 offset:38912
    s_add_u32 m0, s37, 32768
    v_mfma_f32_16x16x32_bf16 v[40:43], a[12:15], v[88:91], v[40:43]
    buffer_load_dwordx4 a[0:3], v3, s[24:27], s42 offen offset:0
    v_mfma_f32_16x16x32_bf16 v[56:59], a[28:31], v[88:91], v[56:59]
    v_mfma_f32_16x16x32_bf16 v[44:47], a[12:15], v[92:95], v[44:47]
    v_mfma_f32_16x16x32_bf16 v[60:63], a[28:31], v[92:95], v[60:63]
    s_waitcnt lgkmcnt(0)
    s_nop 0
    v_mfma_f32_16x16x32_bf16 v[32:35], a[32:35], v[64:67], v[32:35]
    ds_read_b128 v[80:83], v25 offset:32768
    buffer_load_dwordx4 v16, s[12:15], s36 offen lds
    v_mfma_f32_16x16x32_bf16 v[48:51], a[48:51], v[64:67], v[48:51]
    ds_read_b128 v[84:87], v25 offset:34816
    buffer_load_dwordx4 a[16:19], v3, s[24:27], s43 offen offset:0
    v_mfma_f32_16x16x32_bf16 v[36:39], a[32:35], v[68:71], v[36:39]
    ds_read_b128 v[88:91], v25 offset:36864
    s_add_u32 m0, s37, 33792
    v_mfma_f32_16x16x32_bf16 v[52:55], a[48:51], v[68:71], v[52:55]
    ds_read_b128 v[92:95], v25 offset:38912
    buffer_load_dwordx4 a[4:7], v3, s[24:27], s42 offen offset:1024
    v_mfma_f32_16x16x32_bf16 v[40:43], a[32:35], v[72:75], v[40:43]
    buffer_load_dwordx4 v17, s[12:15], s36 offen lds
    v_mfma_f32_16x16x32_bf16 v[56:59], a[48:51], v[72:75], v[56:59]
    v_mfma_f32_16x16x32_bf16 v[44:47], a[32:35], v[76:79], v[44:47]
    v_mfma_f32_16x16x32_bf16 v[60:63], a[48:51], v[76:79], v[60:63]
    s_waitcnt lgkmcnt(0)
    s_nop 0
    v_mfma_f32_16x16x32_bf16 v[32:35], a[36:39], v[80:83], v[32:35]
    ds_read_b128 v[64:67], v26 offset:32768
    buffer_load_dwordx4 a[20:23], v3, s[24:27], s43 offen offset:1024
    v_mfma_f32_16x16x32_bf16 v[48:51], a[52:55], v[80:83], v[48:51]
    ds_read_b128 v[68:71], v26 offset:34816
    s_add_u32 m0, s37, 34816
    v_mfma_f32_16x16x32_bf16 v[36:39], a[36:39], v[84:87], v[36:39]
    ds_read_b128 v[72:75], v26 offset:36864
    buffer_load_dwordx4 a[8:11], v3, s[24:27], s42 offen offset:2048
    v_mfma_f32_16x16x32_bf16 v[52:55], a[52:55], v[84:87], v[52:55]
    ds_read_b128 v[76:79], v26 offset:38912
    buffer_load_dwordx4 v18, s[12:15], s36 offen lds
    v_mfma_f32_16x16x32_bf16 v[40:43], a[36:39], v[88:91], v[40:43]
    buffer_load_dwordx4 a[24:27], v3, s[24:27], s43 offen offset:2048
    v_mfma_f32_16x16x32_bf16 v[56:59], a[52:55], v[88:91], v[56:59]
    v_mfma_f32_16x16x32_bf16 v[44:47], a[36:39], v[92:95], v[44:47]
    v_mfma_f32_16x16x32_bf16 v[60:63], a[52:55], v[92:95], v[60:63]
    s_waitcnt lgkmcnt(0)
    s_nop 0
    v_mfma_f32_16x16x32_bf16 v[32:35], a[40:43], v[64:67], v[32:35]
    ds_read_b128 v[80:83], v27 offset:32768
    s_add_u32 m0, s37, 35840
    v_mfma_f32_16x16x32_bf16 v[48:51], a[56:59], v[64:67], v[48:51]
    ds_read_b128 v[84:87], v27 offset:34816
    buffer_load_dwordx4 a[12:15], v3, s[24:27], s42 offen offset:3072
    v_mfma_f32_16x16x32_bf16 v[36:39], a[40:43], v[68:71], v[36:39]
    ds_read_b128 v[88:91], v27 offset:36864
    buffer_load_dwordx4 v19, s[12:15], s36 offen lds
    v_mfma_f32_16x16x32_bf16 v[52:55], a[56:59], v[68:71], v[52:55]
    ds_read_b128 v[92:95], v27 offset:38912
    buffer_load_dwordx4 a[28:31], v3, s[24:27], s43 offen offset:3072
    v_mfma_f32_16x16x32_bf16 v[40:43], a[40:43], v[72:75], v[40:43]
    s_add_u32 s36, s36, 128
    s_and_b32 s36, s36, 2047
    v_mfma_f32_16x16x32_bf16 v[56:59], a[56:59], v[72:75], v[56:59]
    v_mfma_f32_16x16x32_bf16 v[44:47], a[40:43], v[76:79], v[44:47]
    v_mfma_f32_16x16x32_bf16 v[60:63], a[56:59], v[76:79], v[60:63]
    s_waitcnt vmcnt(37) lgkmcnt(0)
    s_barrier
    v_mfma_f32_16x16x32_bf16 v[32:35], a[44:47], v[80:83], v[32:35]
    ds_read_b128 v[64:67], v24 offset:49152
    s_lshl_b32 s42, s36, 5
    v_mfma_f32_16x16x32_bf16 v[48:51], a[60:63], v[80:83], v[48:51]
    ds_read_b128 v[68:71], v24 offset:51200
    s_add_u32 s42, s42, s58
    v_mfma_f32_16x16x32_bf16 v[36:39], a[44:47], v[84:87], v[36:39]
    ds_read_b128 v[72:75], v24 offset:53248
    s_add_u32 s43, s42, 0x20000
    v_mfma_f32_16x16x32_bf16 v[52:55], a[60:63], v[84:87], v[52:55]
    ds_read_b128 v[76:79], v24 offset:55296
    s_add_u32 m0, s37, 49152
    v_mfma_f32_16x16x32_bf16 v[40:43], a[44:47], v[88:91], v[40:43]
    buffer_load_dwordx4 a[32:35], v3, s[24:27], s42 offen offset:0
    v_mfma_f32_16x16x32_bf16 v[56:59], a[60:63], v[88:91], v[56:59]
    v_mfma_f32_16x16x32_bf16 v[44:47], a[44:47], v[92:95], v[44:47]
    v_mfma_f32_16x16x32_bf16 v[60:63], a[60:63], v[92:95], v[60:63]
    s_waitcnt lgkmcnt(0)
    s_nop 0
    v_mfma_f32_16x16x32_bf16 v[32:35], a[64:67], v[64:67], v[32:35]
    ds_read_b128 v[80:83], v25 offset:49152
    buffer_load_dwordx4 v16, s[12:15], s36 offen lds
    v_mfma_f32_16x16x32_bf16 v[48:51], a[80:83], v[64:67], v[48:51]
    ds_read_b128 v[84:87], v25 offset:51200
    buffer_load_dwordx4 a[48:51], v3, s[24:27], s43 offen offset:0
    v_mfma_f32_16x16x32_bf16 v[36:39], a[64:67], v[68:71], v[36:39]
    ds_read_b128 v[88:91], v25 offset:53248
    s_add_u32 m0, s37, 50176
    v_mfma_f32_16x16x32_bf16 v[52:55], a[80:83], v[68:71], v[52:55]
    ds_read_b128 v[92:95], v25 offset:55296
    buffer_load_dwordx4 a[36:39], v3, s[24:27], s42 offen offset:1024
    v_mfma_f32_16x16x32_bf16 v[40:43], a[64:67], v[72:75], v[40:43]
    buffer_load_dwordx4 v17, s[12:15], s36 offen lds
    v_mfma_f32_16x16x32_bf16 v[56:59], a[80:83], v[72:75], v[56:59]
    v_mfma_f32_16x16x32_bf16 v[44:47], a[64:67], v[76:79], v[44:47]
    v_mfma_f32_16x16x32_bf16 v[60:63], a[80:83], v[76:79], v[60:63]
    s_waitcnt lgkmcnt(0)
    s_nop 0
    v_mfma_f32_16x16x32_bf16 v[32:35], a[68:71], v[80:83], v[32:35]
    ds_read_b128 v[64:67], v26 offset:49152
    buffer_load_dwordx4 a[52:55], v3, s[24:27], s43 offen offset:1024
    v_mfma_f32_16x16x32_bf16 v[48:51], a[84:87], v[80:83], v[48:51]
    ds_read_b128 v[68:71], v26 offset:51200
    s_add_u32 m0, s37, 51200
    v_mfma_f32_16x16x32_bf16 v[36:39], a[68:71], v[84:87], v[36:39]
    ds_read_b128 v[72:75], v26 offset:53248
    buffer_load_dwordx4 a[40:43], v3, s[24:27], s42 offen offset:2048
    v_mfma_f32_16x16x32_bf16 v[52:55], a[84:87], v[84:87], v[52:55]
    ds_read_b128 v[76:79], v26 offset:55296
    buffer_load_dwordx4 v18, s[12:15], s36 offen lds
    v_mfma_f32_16x16x32_bf16 v[40:43], a[68:71], v[88:91], v[40:43]
    buffer_load_dwordx4 a[56:59], v3, s[24:27], s43 offen offset:2048
    v_mfma_f32_16x16x32_bf16 v[56:59], a[84:87], v[88:91], v[56:59]
    v_mfma_f32_16x16x32_bf16 v[44:47], a[68:71], v[92:95], v[44:47]
    v_mfma_f32_16x16x32_bf16 v[60:63], a[84:87], v[92:95], v[60:63]
    s_waitcnt lgkmcnt(0)
    s_nop 0
    v_mfma_f32_16x16x32_bf16 v[32:35], a[72:75], v[64:67], v[32:35]
    ds_read_b128 v[80:83], v27 offset:49152
    s_add_u32 m0, s37, 52224
    v_mfma_f32_16x16x32_bf16 v[48:51], a[88:91], v[64:67], v[48:51]
    ds_read_b128 v[84:87], v27 offset:51200
    buffer_load_dwordx4 a[44:47], v3, s[24:27], s42 offen offset:3072
    v_mfma_f32_16x16x32_bf16 v[36:39], a[72:75], v[68:71], v[36:39]
    ds_read_b128 v[88:91], v27 offset:53248
    buffer_load_dwordx4 v19, s[12:15], s36 offen lds
    v_mfma_f32_16x16x32_bf16 v[52:55], a[88:91], v[68:71], v[52:55]
    ds_read_b128 v[92:95], v27 offset:55296
    buffer_load_dwordx4 a[60:63], v3, s[24:27], s43 offen offset:3072
    v_mfma_f32_16x16x32_bf16 v[40:43], a[72:75], v[72:75], v[40:43]
    s_add_u32 s36, s36, 128
    s_and_b32 s36, s36, 2047
    v_mfma_f32_16x16x32_bf16 v[56:59], a[88:91], v[72:75], v[56:59]
    v_mfma_f32_16x16x32_bf16 v[44:47], a[72:75], v[76:79], v[44:47]
    v_mfma_f32_16x16x32_bf16 v[60:63], a[88:91], v[76:79], v[60:63]
    s_waitcnt vmcnt(37) lgkmcnt(0)
    s_barrier
    v_mfma_f32_16x16x32_bf16 v[32:35], a[76:79], v[80:83], v[32:35]
    ds_read_b128 v[64:67], v20 offset:0
    s_lshl_b32 s42, s36, 5
    v_mfma_f32_16x16x32_bf16 v[48:51], a[92:95], v[80:83], v[48:51]
    ds_read_b128 v[68:71], v20 offset:2048
    s_add_u32 s42, s42, s58
    v_mfma_f32_16x16x32_bf16 v[36:39], a[76:79], v[84:87], v[36:39]
    ds_read_b128 v[72:75], v20 offset:4096
    s_add_u32 s43, s42, 0x20000
    v_mfma_f32_16x16x32_bf16 v[52:55], a[92:95], v[84:87], v[52:55]
    ds_read_b128 v[76:79], v20 offset:6144
    s_add_u32 m0, s37, 65536
    v_mfma_f32_16x16x32_bf16 v[40:43], a[76:79], v[88:91], v[40:43]
    buffer_load_dwordx4 a[64:67], v3, s[24:27], s42 offen offset:0
    v_mfma_f32_16x16x32_bf16 v[56:59], a[92:95], v[88:91], v[56:59]
    v_mfma_f32_16x16x32_bf16 v[44:47], a[76:79], v[92:95], v[44:47]
    v_mfma_f32_16x16x32_bf16 v[60:63], a[92:95], v[92:95], v[60:63]
    s_waitcnt lgkmcnt(0)
    s_nop 0
    v_mfma_f32_16x16x32_bf16 v[32:35], a[96:99], v[64:67], v[32:35]
    ds_read_b128 v[80:83], v21 offset:0
    buffer_load_dwordx4 v16, s[12:15], s36 offen lds
    v_mfma_f32_16x16x32_bf16 v[48:51], a[112:115], v[64:67], v[48:51]
    ds_read_b128 v[84:87], v21 offset:2048
    buffer_load_dwordx4 a[80:83], v3, s[24:27], s43 offen offset:0
    v_mfma_f32_16x16x32_bf16 v[36:39], a[96:99], v[68:71], v[36:39]
    ds_read_b128 v[88:91], v21 offset:4096
    s_add_u32 m0, s37, 66560
    v_mfma_f32_16x16x32_bf16 v[52:55], a[112:115], v[68:71], v[52:55]
    ds_read_b128 v[92:95], v21 offset:6144
    buffer_load_dwordx4 a[68:71], v3, s[24:27], s42 offen offset:1024
    v_mfma_f32_16x16x32_bf16 v[40:43], a[96:99], v[72:75], v[40:43]
    buffer_load_dwordx4 v17, s[12:15], s36 offen lds
    v_mfma_f32_16x16x32_bf16 v[56:59], a[112:115], v[72:75], v[56:59]
    v_mfma_f32_16x16x32_bf16 v[44:47], a[96:99], v[76:79], v[44:47]
    v_mfma_f32_16x16x32_bf16 v[60:63], a[112:115], v[76:79], v[60:63]
    s_waitcnt lgkmcnt(0)
    s_nop 0
    v_mfma_f32_16x16x32_bf16 v[32:35], a[100:103], v[80:83], v[32:35]
    ds_read_b128 v[64:67], v22 offset:0
    buffer_load_dwordx4 a[84:87], v3, s[24:27], s43 offen offset:1024
    v_mfma_f32_16x16x32_bf16 v[48:51], a[116:119], v[80:83], v[48:51]
    ds_read_b128 v[68:71], v22 offset:2048
    s_add_u32 m0, s37, 67584
    v_mfma_f32_16x16x32_bf16 v[36:39], a[100:103], v[84:87], v[36:39]
    ds_read_b128 v[72:75], v22 offset:4096
    buffer_load_dwordx4 a[72:75], v3, s[24:27], s42 offen offset:2048
    v_mfma_f32_16x16x32_bf16 v[52:55], a[116:119], v[84:87], v[52:55]
    ds_read_b128 v[76:79], v22 offset:6144
    buffer_load_dwordx4 v18, s[12:15], s36 offen lds
    v_mfma_f32_16x16x32_bf16 v[40:43], a[100:103], v[88:91], v[40:43]
    buffer_load_dwordx4 a[88:91], v3, s[24:27], s43 offen offset:2048
    v_mfma_f32_16x16x32_bf16 v[56:59], a[116:119], v[88:91], v[56:59]
    v_mfma_f32_16x16x32_bf16 v[44:47], a[100:103], v[92:95], v[44:47]
    v_mfma_f32_16x16x32_bf16 v[60:63], a[116:119], v[92:95], v[60:63]
    s_waitcnt lgkmcnt(0)
    s_nop 0
    v_mfma_f32_16x16x32_bf16 v[32:35], a[104:107], v[64:67], v[32:35]
    ds_read_b128 v[80:83], v23 offset:0
    s_add_u32 m0, s37, 68608
    v_mfma_f32_16x16x32_bf16 v[48:51], a[120:123], v[64:67], v[48:51]
    ds_read_b128 v[84:87], v23 offset:2048
    buffer_load_dwordx4 a[76:79], v3, s[24:27], s42 offen offset:3072
    v_mfma_f32_16x16x32_bf16 v[36:39], a[104:107], v[68:71], v[36:39]
    ds_read_b128 v[88:91], v23 offset:4096
    buffer_load_dwordx4 v19, s[12:15], s36 offen lds
    v_mfma_f32_16x16x32_bf16 v[52:55], a[120:123], v[68:71], v[52:55]
    ds_read_b128 v[92:95], v23 offset:6144
    buffer_load_dwordx4 a[92:95], v3, s[24:27], s43 offen offset:3072
    v_mfma_f32_16x16x32_bf16 v[40:43], a[104:107], v[72:75], v[40:43]
    s_add_u32 s36, s36, 128
    s_and_b32 s36, s36, 2047
    v_mfma_f32_16x16x32_bf16 v[56:59], a[120:123], v[72:75], v[56:59]
    v_mfma_f32_16x16x32_bf16 v[44:47], a[104:107], v[76:79], v[44:47]
    v_mfma_f32_16x16x32_bf16 v[60:63], a[120:123], v[76:79], v[60:63]
    s_waitcnt vmcnt(36) lgkmcnt(0)
    s_barrier
    v_mfma_f32_16x16x32_bf16 v[32:35], a[108:111], v[80:83], v[32:35]
    ds_read_b128 v[64:67], v20 offset:16384
    s_lshl_b32 s42, s36, 5
    v_mfma_f32_16x16x32_bf16 v[48:51], a[124:127], v[80:83], v[48:51]
    ds_read_b128 v[68:71], v20 offset:18432
    s_add_u32 s42, s42, s58
    v_mfma_f32_16x16x32_bf16 v[36:39], a[108:111], v[84:87], v[36:39]
    ds_read_b128 v[72:75], v20 offset:20480
    s_add_u32 s43, s42, 0x20000
    v_mfma_f32_16x16x32_bf16 v[52:55], a[124:127], v[84:87], v[52:55]
    ds_read_b128 v[76:79], v20 offset:22528
    s_add_u32 m0, s37, 81920
    v_mfma_f32_16x16x32_bf16 v[40:43], a[108:111], v[88:91], v[40:43]
    buffer_load_dwordx4 a[96:99], v3, s[24:27], s42 offen offset:0
    v_mfma_f32_16x16x32_bf16 v[56:59], a[124:127], v[88:91], v[56:59]
    v_mfma_f32_16x16x32_bf16 v[44:47], a[108:111], v[92:95], v[44:47]
    v_mfma_f32_16x16x32_bf16 v[60:63], a[124:127], v[92:95], v[60:63]
    s_waitcnt lgkmcnt(0)
    s_nop 0
    v_mfma_f32_16x16x32_bf16 v[32:35], a[128:131], v[64:67], v[32:35]
    ds_read_b128 v[80:83], v21 offset:16384
    buffer_load_dwordx4 v16, s[12:15], s36 offen lds
    v_mfma_f32_16x16x32_bf16 v[48:51], a[144:147], v[64:67], v[48:51]
    ds_read_b128 v[84:87], v21 offset:18432
    buffer_load_dwordx4 a[112:115], v3, s[24:27], s43 offen offset:0
    v_mfma_f32_16x16x32_bf16 v[36:39], a[128:131], v[68:71], v[36:39]
    ds_read_b128 v[88:91], v21 offset:20480
    s_add_u32 m0, s37, 82944
    v_mfma_f32_16x16x32_bf16 v[52:55], a[144:147], v[68:71], v[52:55]
    ds_read_b128 v[92:95], v21 offset:22528
    buffer_load_dwordx4 a[100:103], v3, s[24:27], s42 offen offset:1024
    v_mfma_f32_16x16x32_bf16 v[40:43], a[128:131], v[72:75], v[40:43]
    buffer_load_dwordx4 v17, s[12:15], s36 offen lds
    v_mfma_f32_16x16x32_bf16 v[56:59], a[144:147], v[72:75], v[56:59]
    v_mfma_f32_16x16x32_bf16 v[44:47], a[128:131], v[76:79], v[44:47]
    v_mfma_f32_16x16x32_bf16 v[60:63], a[144:147], v[76:79], v[60:63]
    s_waitcnt lgkmcnt(0)
    s_nop 0
    v_mfma_f32_16x16x32_bf16 v[32:35], a[132:135], v[80:83], v[32:35]
    ds_read_b128 v[64:67], v22 offset:16384
    buffer_load_dwordx4 a[116:119], v3, s[24:27], s43 offen offset:1024
    v_mfma_f32_16x16x32_bf16 v[48:51], a[148:151], v[80:83], v[48:51]
    ds_read_b128 v[68:71], v22 offset:18432
    s_add_u32 m0, s37, 83968
    v_mfma_f32_16x16x32_bf16 v[36:39], a[132:135], v[84:87], v[36:39]
    ds_read_b128 v[72:75], v22 offset:20480
    buffer_load_dwordx4 a[104:107], v3, s[24:27], s42 offen offset:2048
    v_mfma_f32_16x16x32_bf16 v[52:55], a[148:151], v[84:87], v[52:55]
    ds_read_b128 v[76:79], v22 offset:22528
    buffer_load_dwordx4 v18, s[12:15], s36 offen lds
    v_mfma_f32_16x16x32_bf16 v[40:43], a[132:135], v[88:91], v[40:43]
    buffer_load_dwordx4 a[120:123], v3, s[24:27], s43 offen offset:2048
    v_mfma_f32_16x16x32_bf16 v[56:59], a[148:151], v[88:91], v[56:59]
    v_mfma_f32_16x16x32_bf16 v[44:47], a[132:135], v[92:95], v[44:47]
    v_mfma_f32_16x16x32_bf16 v[60:63], a[148:151], v[92:95], v[60:63]
    s_waitcnt lgkmcnt(0)
    s_nop 0
    v_mfma_f32_16x16x32_bf16 v[32:35], a[136:139], v[64:67], v[32:35]
    ds_read_b128 v[80:83], v23 offset:16384
    s_add_u32 m0, s37, 84992
    v_mfma_f32_16x16x32_bf16 v[48:51], a[152:155], v[64:67], v[48:51]
    ds_read_b128 v[84:87], v23 offset:18432
    buffer_load_dwordx4 a[108:111], v3, s[24:27], s42 offen offset:3072
    v_mfma_f32_16x16x32_bf16 v[36:39], a[136:139], v[68:71], v[36:39]
    ds_read_b128 v[88:91], v23 offset:20480
    buffer_load_dwordx4 v19, s[12:15], s36 offen lds
    v_mfma_f32_16x16x32_bf16 v[52:55], a[152:155], v[68:71], v[52:55]
    ds_read_b128 v[92:95], v23 offset:22528
    buffer_load_dwordx4 a[124:127], v3, s[24:27], s43 offen offset:3072
    v_mfma_f32_16x16x32_bf16 v[40:43], a[136:139], v[72:75], v[40:43]
    s_add_u32 s36, s36, 128
    s_and_b32 s36, s36, 2047
    v_mfma_f32_16x16x32_bf16 v[56:59], a[152:155], v[72:75], v[56:59]
    v_mfma_f32_16x16x32_bf16 v[44:47], a[136:139], v[76:79], v[44:47]
    v_mfma_f32_16x16x32_bf16 v[60:63], a[152:155], v[76:79], v[60:63]
    s_waitcnt vmcnt(36) lgkmcnt(0)
    s_barrier
    v_mfma_f32_16x16x32_bf16 v[32:35], a[140:143], v[80:83], v[32:35]
    ds_read_b128 v[64:67], v20 offset:32768
    s_lshl_b32 s42, s36, 5
    v_mfma_f32_16x16x32_bf16 v[48:51], a[156:159], v[80:83], v[48:51]
    ds_read_b128 v[68:71], v20 offset:34816
    s_add_u32 s42, s42, s58
    v_mfma_f32_16x16x32_bf16 v[36:39], a[140:143], v[84:87], v[36:39]
    ds_read_b128 v[72:75], v20 offset:36864
    s_add_u32 s43, s42, 0x20000
    v_mfma_f32_16x16x32_bf16 v[52:55], a[156:159], v[84:87], v[52:55]
    ds_read_b128 v[76:79], v20 offset:38912
    s_add_u32 m0, s37, 98304
    v_mfma_f32_16x16x32_bf16 v[40:43], a[140:143], v[88:91], v[40:43]
    buffer_load_dwordx4 a[128:131], v3, s[24:27], s42 offen offset:0
    v_mfma_f32_16x16x32_bf16 v[56:59], a[156:159], v[88:91], v[56:59]
    v_mfma_f32_16x16x32_bf16 v[44:47], a[140:143], v[92:95], v[44:47]
    v_mfma_f32_16x16x32_bf16 v[60:63], a[156:159], v[92:95], v[60:63]
    s_waitcnt lgkmcnt(0)
    s_nop 0
    v_mfma_f32_16x16x32_bf16 v[32:35], a[0:3], v[64:67], v[32:35]
    ds_read_b128 v[80:83], v21 offset:32768
    buffer_load_dwordx4 v16, s[12:15], s36 offen lds
    v_mfma_f32_16x16x32_bf16 v[48:51], a[16:19], v[64:67], v[48:51]
    ds_read_b128 v[84:87], v21 offset:34816
    buffer_load_dwordx4 a[144:147], v3, s[24:27], s43 offen offset:0
    v_mfma_f32_16x16x32_bf16 v[36:39], a[0:3], v[68:71], v[36:39]
    ds_read_b128 v[88:91], v21 offset:36864
    s_add_u32 m0, s37, 99328
    v_mfma_f32_16x16x32_bf16 v[52:55], a[16:19], v[68:71], v[52:55]
    ds_read_b128 v[92:95], v21 offset:38912
    buffer_load_dwordx4 a[132:135], v3, s[24:27], s42 offen offset:1024
    v_mfma_f32_16x16x32_bf16 v[40:43], a[0:3], v[72:75], v[40:43]
    buffer_load_dwordx4 v17, s[12:15], s36 offen lds
    v_mfma_f32_16x16x32_bf16 v[56:59], a[16:19], v[72:75], v[56:59]
    v_mfma_f32_16x16x32_bf16 v[44:47], a[0:3], v[76:79], v[44:47]
    v_mfma_f32_16x16x32_bf16 v[60:63], a[16:19], v[76:79], v[60:63]
    s_waitcnt lgkmcnt(0)
    s_nop 0
    v_mfma_f32_16x16x32_bf16 v[32:35], a[4:7], v[80:83], v[32:35]
    ds_read_b128 v[64:67], v22 offset:32768
    buffer_load_dwordx4 a[148:151], v3, s[24:27], s43 offen offset:1024
    v_mfma_f32_16x16x32_bf16 v[48:51], a[20:23], v[80:83], v[48:51]
    ds_read_b128 v[68:71], v22 offset:34816
    s_add_u32 m0, s37, 100352
    v_mfma_f32_16x16x32_bf16 v[36:39], a[4:7], v[84:87], v[36:39]
    ds_read_b128 v[72:75], v22 offset:36864
    buffer_load_dwordx4 a[136:139], v3, s[24:27], s42 offen offset:2048
    v_mfma_f32_16x16x32_bf16 v[52:55], a[20:23], v[84:87], v[52:55]
    ds_read_b128 v[76:79], v22 offset:38912
    buffer_load_dwordx4 v18, s[12:15], s36 offen lds
    v_mfma_f32_16x16x32_bf16 v[40:43], a[4:7], v[88:91], v[40:43]
    buffer_load_dwordx4 a[152:155], v3, s[24:27], s43 offen offset:2048
    v_mfma_f32_16x16x32_bf16 v[56:59], a[20:23], v[88:91], v[56:59]
    v_mfma_f32_16x16x32_bf16 v[44:47], a[4:7], v[92:95], v[44:47]
    v_mfma_f32_16x16x32_bf16 v[60:63], a[20:23], v[92:95], v[60:63]
    s_waitcnt lgkmcnt(0)
    s_nop 0
    v_mfma_f32_16x16x32_bf16 v[32:35], a[8:11], v[64:67], v[32:35]
    ds_read_b128 v[80:83], v23 offset:32768
    s_add_u32 m0, s37, 101376
    v_mfma_f32_16x16x32_bf16 v[48:51], a[24:27], v[64:67], v[48:51]
    ds_read_b128 v[84:87], v23 offset:34816
    buffer_load_dwordx4 a[140:143], v3, s[24:27], s42 offen offset:3072
    v_mfma_f32_16x16x32_bf16 v[36:39], a[8:11], v[68:71], v[36:39]
    ds_read_b128 v[88:91], v23 offset:36864
    buffer_load_dwordx4 v19, s[12:15], s36 offen lds
    v_mfma_f32_16x16x32_bf16 v[52:55], a[24:27], v[68:71], v[52:55]
    ds_read_b128 v[92:95], v23 offset:38912
    buffer_load_dwordx4 a[156:159], v3, s[24:27], s43 offen offset:3072
    v_mfma_f32_16x16x32_bf16 v[40:43], a[8:11], v[72:75], v[40:43]
    s_add_u32 s36, s36, 128
    s_and_b32 s36, s36, 2047
    v_mfma_f32_16x16x32_bf16 v[56:59], a[24:27], v[72:75], v[56:59]
    v_mfma_f32_16x16x32_bf16 v[44:47], a[8:11], v[76:79], v[44:47]
    v_mfma_f32_16x16x32_bf16 v[60:63], a[24:27], v[76:79], v[60:63]
    s_waitcnt vmcnt(36) lgkmcnt(0)
    s_barrier
    v_mfma_f32_16x16x32_bf16 v[32:35], a[12:15], v[80:83], v[32:35]
    ds_read_b128 v[64:67], v20 offset:49152
    buffer_load_dword v4, v6, s[24:27], s38 offen sc1
    v_mfma_f32_16x16x32_bf16 v[48:51], a[28:31], v[80:83], v[48:51]
    ds_read_b128 v[68:71], v20 offset:51200
    s_lshl_b32 s42, s36, 5
    v_mfma_f32_16x16x32_bf16 v[36:39], a[12:15], v[84:87], v[36:39]
    ds_read_b128 v[72:75], v20 offset:53248
    s_add_u32 s42, s42, s58
    v_mfma_f32_16x16x32_bf16 v[52:55], a[28:31], v[84:87], v[52:55]
    ds_read_b128 v[76:79], v20 offset:55296
    s_add_u32 s43, s42, 0x20000
    v_mfma_f32_16x16x32_bf16 v[40:43], a[12:15], v[88:91], v[40:43]
    s_add_u32 m0, s37, 114688
    v_mfma_f32_16x16x32_bf16 v[56:59], a[28:31], v[88:91], v[56:59]
    v_mfma_f32_16x16x32_bf16 v[44:47], a[12:15], v[92:95], v[44:47]
    v_mfma_f32_16x16x32_bf16 v[60:63], a[28:31], v[92:95], v[60:63]
    s_waitcnt lgkmcnt(0)
    s_nop 0
    v_mfma_f32_16x16x32_bf16 v[32:35], a[32:35], v[64:67], v[32:35]
    ds_read_b128 v[80:83], v21 offset:49152
    buffer_load_dwordx4 a[0:3], v3, s[24:27], s42 offen offset:0
    v_mfma_f32_16x16x32_bf16 v[48:51], a[48:51], v[64:67], v[48:51]
    ds_read_b128 v[84:87], v21 offset:51200
    buffer_load_dwordx4 v16, s[12:15], s36 offen lds
    v_mfma_f32_16x16x32_bf16 v[36:39], a[32:35], v[68:71], v[36:39]
    ds_read_b128 v[88:91], v21 offset:53248
    buffer_load_dwordx4 a[16:19], v3, s[24:27], s43 offen offset:0
    v_mfma_f32_16x16x32_bf16 v[52:55], a[48:51], v[68:71], v[52:55]
    ds_read_b128 v[92:95], v21 offset:55296
    s_add_u32 m0, s37, 115712
    v_mfma_f32_16x16x32_bf16 v[40:43], a[32:35], v[72:75], v[40:43]
    buffer_load_dwordx4 a[4:7], v3, s[24:27], s42 offen offset:1024
    buffer_load_dwordx4 v17, s[12:15], s36 offen lds
    v_mfma_f32_16x16x32_bf16 v[56:59], a[48:51], v[72:75], v[56:59]
    v_mfma_f32_16x16x32_bf16 v[44:47], a[32:35], v[76:79], v[44:47]
    v_mfma_f32_16x16x32_bf16 v[60:63], a[48:51], v[76:79], v[60:63]
    s_waitcnt lgkmcnt(0)
    s_nop 0
    v_mfma_f32_16x16x32_bf16 v[32:35], a[36:39], v[80:83], v[32:35]
    ds_read_b128 v[64:67], v22 offset:49152
    buffer_load_dwordx4 a[20:23], v3, s[24:27], s43 offen offset:1024
    v_mfma_f32_16x16x32_bf16 v[48:51], a[52:55], v[80:83], v[48:51]
    ds_read_b128 v[68:71], v22 offset:51200
    s_add_u32 m0, s37, 116736
    v_mfma_f32_16x16x32_bf16 v[36:39], a[36:39], v[84:87], v[36:39]
    ds_read_b128 v[72:75], v22 offset:53248
    buffer_load_dwordx4 a[8:11], v3, s[24:27], s42 offen offset:2048
    v_mfma_f32_16x16x32_bf16 v[52:55], a[52:55], v[84:87], v[52:55]
    ds_read_b128 v[76:79], v22 offset:55296
    buffer_load_dwordx4 v18, s[12:15], s36 offen lds
    v_mfma_f32_16x16x32_bf16 v[40:43], a[36:39], v[88:91], v[40:43]
    buffer_load_dwordx4 a[24:27], v3, s[24:27], s43 offen offset:2048
    v_mfma_f32_16x16x32_bf16 v[56:59], a[52:55], v[88:91], v[56:59]
    v_mfma_f32_16x16x32_bf16 v[44:47], a[36:39], v[92:95], v[44:47]
    v_mfma_f32_16x16x32_bf16 v[60:63], a[52:55], v[92:95], v[60:63]
    s_waitcnt lgkmcnt(0)
    s_nop 0
    v_mfma_f32_16x16x32_bf16 v[32:35], a[40:43], v[64:67], v[32:35]
    ds_read_b128 v[80:83], v23 offset:49152
    s_add_u32 m0, s37, 117760
    v_mfma_f32_16x16x32_bf16 v[48:51], a[56:59], v[64:67], v[48:51]
    ds_read_b128 v[84:87], v23 offset:51200
    buffer_load_dwordx4 a[12:15], v3, s[24:27], s42 offen offset:3072
    v_mfma_f32_16x16x32_bf16 v[36:39], a[40:43], v[68:71], v[36:39]
    ds_read_b128 v[88:91], v23 offset:53248
    buffer_load_dwordx4 v19, s[12:15], s36 offen lds
    v_mfma_f32_16x16x32_bf16 v[52:55], a[56:59], v[68:71], v[52:55]
    ds_read_b128 v[92:95], v23 offset:55296
    buffer_load_dwordx4 a[28:31], v3, s[24:27], s43 offen offset:3072
    v_mfma_f32_16x16x32_bf16 v[40:43], a[40:43], v[72:75], v[40:43]
    s_add_u32 s36, s36, 128
    s_and_b32 s36, s36, 2047
    v_mfma_f32_16x16x32_bf16 v[56:59], a[56:59], v[72:75], v[56:59]
    v_mfma_f32_16x16x32_bf16 v[44:47], a[40:43], v[76:79], v[44:47]
    v_mfma_f32_16x16x32_bf16 v[60:63], a[56:59], v[76:79], v[60:63]
    s_waitcnt vmcnt(37) lgkmcnt(0)
    s_barrier
    v_mfma_f32_16x16x32_bf16 v[32:35], a[44:47], v[80:83], v[32:35]
    ds_read_b128 v[64:67], v24 offset:0
    v_mfma_f32_16x16x32_bf16 v[48:51], a[60:63], v[80:83], v[48:51]
    ds_read_b128 v[68:71], v24 offset:2048
    v_mfma_f32_16x16x32_bf16 v[36:39], a[44:47], v[84:87], v[36:39]
    ds_read_b128 v[72:75], v24 offset:4096
    v_mfma_f32_16x16x32_bf16 v[52:55], a[60:63], v[84:87], v[52:55]
    ds_read_b128 v[76:79], v24 offset:6144
    v_mfma_f32_16x16x32_bf16 v[40:43], a[44:47], v[88:91], v[40:43]
    v_mfma_f32_16x16x32_bf16 v[56:59], a[60:63], v[88:91], v[56:59]
    v_mfma_f32_16x16x32_bf16 v[44:47], a[44:47], v[92:95], v[44:47]
    v_mfma_f32_16x16x32_bf16 v[60:63], a[60:63], v[92:95], v[60:63]
    s_waitcnt lgkmcnt(0)
    s_nop 0
    v_mfma_f32_16x16x32_bf16 v[32:35], a[64:67], v[64:67], v[32:35]
    ds_read_b128 v[80:83], v25 offset:0
    v_mfma_f32_16x16x32_bf16 v[48:51], a[80:83], v[64:67], v[48:51]
    ds_read_b128 v[84:87], v25 offset:2048
    v_mfma_f32_16x16x32_bf16 v[36:39], a[64:67], v[68:71], v[36:39]
    ds_read_b128 v[88:91], v25 offset:4096
    v_mfma_f32_16x16x32_bf16 v[52:55], a[80:83], v[68:71], v[52:55]
    ds_read_b128 v[92:95], v25 offset:6144
    v_mfma_f32_16x16x32_bf16 v[40:43], a[64:67], v[72:75], v[40:43]
    v_mfma_f32_16x16x32_bf16 v[56:59], a[80:83], v[72:75], v[56:59]
    v_mfma_f32_16x16x32_bf16 v[44:47], a[64:67], v[76:79], v[44:47]
    v_mfma_f32_16x16x32_bf16 v[60:63], a[80:83], v[76:79], v[60:63]
    s_waitcnt lgkmcnt(0)
    s_nop 0
    v_mfma_f32_16x16x32_bf16 v[32:35], a[68:71], v[80:83], v[32:35]
    ds_read_b128 v[64:67], v26 offset:0
    v_mfma_f32_16x16x32_bf16 v[48:51], a[84:87], v[80:83], v[48:51]
    ds_read_b128 v[68:71], v26 offset:2048
    v_mfma_f32_16x16x32_bf16 v[36:39], a[68:71], v[84:87], v[36:39]
    ds_read_b128 v[72:75], v26 offset:4096
    v_mfma_f32_16x16x32_bf16 v[52:55], a[84:87], v[84:87], v[52:55]
    ds_read_b128 v[76:79], v26 offset:6144
    v_mfma_f32_16x16x32_bf16 v[40:43], a[68:71], v[88:91], v[40:43]
    v_mfma_f32_16x16x32_bf16 v[56:59], a[84:87], v[88:91], v[56:59]
    v_mfma_f32_16x16x32_bf16 v[44:47], a[68:71], v[92:95], v[44:47]
    v_mfma_f32_16x16x32_bf16 v[60:63], a[84:87], v[92:95], v[60:63]
    s_waitcnt lgkmcnt(0)
    s_nop 0
    v_mfma_f32_16x16x32_bf16 v[32:35], a[72:75], v[64:67], v[32:35]
    ds_read_b128 v[80:83], v27 offset:0
    v_mfma_f32_16x16x32_bf16 v[48:51], a[88:91], v[64:67], v[48:51]
    ds_read_b128 v[84:87], v27 offset:2048
    v_mfma_f32_16x16x32_bf16 v[36:39], a[72:75], v[68:71], v[36:39]
    ds_read_b128 v[88:91], v27 offset:4096
    v_mfma_f32_16x16x32_bf16 v[52:55], a[88:91], v[68:71], v[52:55]
    ds_read_b128 v[92:95], v27 offset:6144
    v_mfma_f32_16x16x32_bf16 v[40:43], a[72:75], v[72:75], v[40:43]
    v_mfma_f32_16x16x32_bf16 v[56:59], a[88:91], v[72:75], v[56:59]
    v_mfma_f32_16x16x32_bf16 v[44:47], a[72:75], v[76:79], v[44:47]
    v_mfma_f32_16x16x32_bf16 v[60:63], a[88:91], v[76:79], v[60:63]
    s_waitcnt vmcnt(25) lgkmcnt(0)
    s_barrier
    v_mfma_f32_16x16x32_bf16 v[32:35], a[76:79], v[80:83], v[32:35]
    ds_read_b128 v[64:67], v24 offset:16384
    v_mfma_f32_16x16x32_bf16 v[48:51], a[92:95], v[80:83], v[48:51]
    ds_read_b128 v[68:71], v24 offset:18432
    v_mfma_f32_16x16x32_bf16 v[36:39], a[76:79], v[84:87], v[36:39]
    ds_read_b128 v[72:75], v24 offset:20480
    v_mfma_f32_16x16x32_bf16 v[52:55], a[92:95], v[84:87], v[52:55]
    ds_read_b128 v[76:79], v24 offset:22528
    v_mfma_f32_16x16x32_bf16 v[40:43], a[76:79], v[88:91], v[40:43]
    v_mfma_f32_16x16x32_bf16 v[56:59], a[92:95], v[88:91], v[56:59]
    v_mfma_f32_16x16x32_bf16 v[44:47], a[76:79], v[92:95], v[44:47]
    v_mfma_f32_16x16x32_bf16 v[60:63], a[92:95], v[92:95], v[60:63]
    s_waitcnt lgkmcnt(0)
    s_nop 0
    v_mfma_f32_16x16x32_bf16 v[32:35], a[96:99], v[64:67], v[32:35]
    ds_read_b128 v[80:83], v25 offset:16384
    v_mfma_f32_16x16x32_bf16 v[48:51], a[112:115], v[64:67], v[48:51]
    ds_read_b128 v[84:87], v25 offset:18432
    v_mfma_f32_16x16x32_bf16 v[36:39], a[96:99], v[68:71], v[36:39]
    ds_read_b128 v[88:91], v25 offset:20480
    v_mfma_f32_16x16x32_bf16 v[52:55], a[112:115], v[68:71], v[52:55]
    ds_read_b128 v[92:95], v25 offset:22528
    v_mfma_f32_16x16x32_bf16 v[40:43], a[96:99], v[72:75], v[40:43]
    v_mfma_f32_16x16x32_bf16 v[56:59], a[112:115], v[72:75], v[56:59]
    v_mfma_f32_16x16x32_bf16 v[44:47], a[96:99], v[76:79], v[44:47]
    v_mfma_f32_16x16x32_bf16 v[60:63], a[112:115], v[76:79], v[60:63]
    s_waitcnt lgkmcnt(0)
    s_nop 0
    v_mfma_f32_16x16x32_bf16 v[32:35], a[100:103], v[80:83], v[32:35]
    ds_read_b128 v[64:67], v26 offset:16384
    v_mfma_f32_16x16x32_bf16 v[48:51], a[116:119], v[80:83], v[48:51]
    ds_read_b128 v[68:71], v26 offset:18432
    v_mfma_f32_16x16x32_bf16 v[36:39], a[100:103], v[84:87], v[36:39]
    ds_read_b128 v[72:75], v26 offset:20480
    v_mfma_f32_16x16x32_bf16 v[52:55], a[116:119], v[84:87], v[52:55]
    ds_read_b128 v[76:79], v26 offset:22528
    v_mfma_f32_16x16x32_bf16 v[40:43], a[100:103], v[88:91], v[40:43]
    v_mfma_f32_16x16x32_bf16 v[56:59], a[116:119], v[88:91], v[56:59]
    v_mfma_f32_16x16x32_bf16 v[44:47], a[100:103], v[92:95], v[44:47]
    v_mfma_f32_16x16x32_bf16 v[60:63], a[116:119], v[92:95], v[60:63]
    s_waitcnt lgkmcnt(0)
    s_nop 0
    v_mfma_f32_16x16x32_bf16 v[32:35], a[104:107], v[64:67], v[32:35]
    ds_read_b128 v[80:83], v27 offset:16384
    v_mfma_f32_16x16x32_bf16 v[48:51], a[120:123], v[64:67], v[48:51]
    ds_read_b128 v[84:87], v27 offset:18432
    v_mfma_f32_16x16x32_bf16 v[36:39], a[104:107], v[68:71], v[36:39]
    ds_read_b128 v[88:91], v27 offset:20480
    v_mfma_f32_16x16x32_bf16 v[52:55], a[120:123], v[68:71], v[52:55]
    ds_read_b128 v[92:95], v27 offset:22528
    v_mfma_f32_16x16x32_bf16 v[40:43], a[104:107], v[72:75], v[40:43]
    v_mfma_f32_16x16x32_bf16 v[56:59], a[120:123], v[72:75], v[56:59]
    v_mfma_f32_16x16x32_bf16 v[44:47], a[104:107], v[76:79], v[44:47]
    v_mfma_f32_16x16x32_bf16 v[60:63], a[120:123], v[76:79], v[60:63]
    s_waitcnt vmcnt(12) lgkmcnt(0)
    s_barrier
    s_mov_b32 s39, 0
K2_POLL:
    v_cmp_ne_u32 vcc, s35, v4
    s_nop 0
    s_cbranch_vccz K2_POLL_OK
    s_sleep 2
    buffer_load_dword v4, v6, s[24:27], s38 offen sc1
    s_add_u32 s39, s39, 1
    s_cmp_lt_u32 s39, 200000
    s_waitcnt vmcnt(0)
    s_cbranch_scc1 K2_POLL
K2_POLL_OK:
    v_mfma_f32_16x16x32_bf16 v[32:35], a[108:111], v[80:83], v[32:35]
    ds_read_b128 v[64:67], v24 offset:32768
    s_lshl_b32 s38, s32, 4
    v_mfma_f32_16x16x32_bf16 v[48:51], a[124:127], v[80:83], v[48:51]
    ds_read_b128 v[68:71], v24 offset:34816
    s_add_u32 s38, s38, s33
    v_mfma_f32_16x16x32_bf16 v[36:39], a[108:111], v[84:87], v[36:39]
    ds_read_b128 v[72:75], v24 offset:36864
    s_lshl_b32 s38, s38, 14
    v_mfma_f32_16x16x32_bf16 v[52:55], a[124:127], v[84:87], v[52:55]
    ds_read_b128 v[76:79], v24 offset:38912
    s_add_u32 s38, s38, s37
    v_mfma_f32_16x16x32_bf16 v[40:43], a[108:111], v[88:91], v[40:43]
    v_mfma_f32_16x16x32_bf16 v[56:59], a[124:127], v[88:91], v[56:59]
    v_mfma_f32_16x16x32_bf16 v[44:47], a[108:111], v[92:95], v[44:47]
    v_mfma_f32_16x16x32_bf16 v[60:63], a[124:127], v[92:95], v[60:63]
    s_waitcnt lgkmcnt(0)
    s_nop 0
    v_mfma_f32_16x16x32_bf16 v[32:35], a[128:131], v[64:67], v[32:35]
    ds_read_b128 v[80:83], v25 offset:32768
    s_add_u32 s38, s38, 24117248
    v_mfma_f32_16x16x32_bf16 v[48:51], a[144:147], v[64:67], v[48:51]
    ds_read_b128 v[84:87], v25 offset:34816
    s_lshl_b32 s39, s32, 2
    v_mfma_f32_16x16x32_bf16 v[36:39], a[128:131], v[68:71], v[36:39]
    ds_read_b128 v[88:91], v25 offset:36864
    s_add_u32 s39, s39, s34
    v_mfma_f32_16x16x32_bf16 v[52:55], a[144:147], v[68:71], v[52:55]
    ds_read_b128 v[92:95], v25 offset:38912
    s_lshl_b32 s39, s39, 7
    s_nop 0
    v_mfma_f32_16x16x32_bf16 v[40:43], a[128:131], v[72:75], v[40:43]
    v_mfma_f32_16x16x32_bf16 v[56:59], a[144:147], v[72:75], v[56:59]
    v_mfma_f32_16x16x32_bf16 v[44:47], a[128:131], v[76:79], v[44:47]
    v_mfma_f32_16x16x32_bf16 v[60:63], a[144:147], v[76:79], v[60:63]
    s_waitcnt lgkmcnt(0)
    s_nop 0
    v_mfma_f32_16x16x32_bf16 v[32:35], a[132:135], v[80:83], v[32:35]
    ds_read_b128 v[64:67], v26 offset:32768
    s_add_u32 s39, s39, 28573696
    v_mfma_f32_16x16x32_bf16 v[48:51], a[148:151], v[80:83], v[48:51]
    ds_read_b128 v[68:71], v26 offset:34816
    v_lshlrev_b32_e64 v7, 5, v2
    v_mfma_f32_16x16x32_bf16 v[36:39], a[132:135], v[84:87], v[36:39]
    ds_read_b128 v[72:75], v26 offset:36864
    buffer_load_dwordx4 v[96:99], v3, s[24:27], s38 offen offset:0 sc1
    v_mfma_f32_16x16x32_bf16 v[52:55], a[148:151], v[84:87], v[52:55]
    ds_read_b128 v[76:79], v26 offset:38912
    buffer_load_dwordx4 v[100:103], v3, s[24:27], s38 offen offset:1024 sc1
    v_mfma_f32_16x16x32_bf16 v[40:43], a[132:135], v[88:91], v[40:43]
    v_mfma_f32_16x16x32_bf16 v[56:59], a[148:151], v[88:91], v[56:59]
    v_mfma_f32_16x16x32_bf16 v[44:47], a[132:135], v[92:95], v[44:47]
    v_mfma_f32_16x16x32_bf16 v[60:63], a[148:151], v[92:95], v[60:63]
    s_waitcnt lgkmcnt(0)
    s_nop 0
    v_mfma_f32_16x16x32_bf16 v[32:35], a[136:139], v[64:67], v[32:35]
    ds_read_b128 v[80:83], v27 offset:32768
    buffer_load_dwordx4 v[104:107], v3, s[24:27], s38 offen offset:2048 sc1
    v_mfma_f32_16x16x32_bf16 v[48:51], a[152:155], v[64:67], v[48:51]
    ds_read_b128 v[84:87], v27 offset:34816
    buffer_load_dwordx4 v[108:111], v3, s[24:27], s38 offen offset:3072 sc1
    v_mfma_f32_16x16x32_bf16 v[36:39], a[136:139], v[68:71], v[36:39]
    ds_read_b128 v[88:91], v27 offset:36864
    buffer_load_dwordx4 v[112:115], v7, s[24:27], s39 offen offset:0 sc1
    v_mfma_f32_16x16x32_bf16 v[52:55], a[152:155], v[68:71], v[52:55]
    ds_read_b128 v[92:95], v27 offset:38912
    buffer_load_dwordx4 v[116:119], v7, s[24:27], s39 offen offset:16 sc1
    v_mfma_f32_16x16x32_bf16 v[40:43], a[136:139], v[72:75], v[40:43]
    v_mfma_f32_16x16x32_bf16 v[56:59], a[152:155], v[72:75], v[56:59]
    v_mfma_f32_16x16x32_bf16 v[44:47], a[136:139], v[76:79], v[44:47]
    v_mfma_f32_16x16x32_bf16 v[60:63], a[152:155], v[76:79], v[60:63]
    s_waitcnt vmcnt(6) lgkmcnt(0)
    s_barrier
    v_mfma_f32_16x16x32_bf16 v[32:35], a[140:143], v[80:83], v[32:35]
    ds_read_b128 v[64:67], v24 offset:49152
    v_mfma_f32_16x16x32_bf16 v[48:51], a[156:159], v[80:83], v[48:51]
    ds_read_b128 v[68:71], v24 offset:51200
    v_mfma_f32_16x16x32_bf16 v[36:39], a[140:143], v[84:87], v[36:39]
    ds_read_b128 v[72:75], v24 offset:53248
    v_mfma_f32_16x16x32_bf16 v[52:55], a[156:159], v[84:87], v[52:55]
    ds_read_b128 v[76:79], v24 offset:55296
    v_mfma_f32_16x16x32_bf16 v[40:43], a[140:143], v[88:91], v[40:43]
    v_mfma_f32_16x16x32_bf16 v[56:59], a[156:159], v[88:91], v[56:59]
    v_mfma_f32_16x16x32_bf16 v[44:47], a[140:143], v[92:95], v[44:47]
    v_mfma_f32_16x16x32_bf16 v[60:63], a[156:159], v[92:95], v[60:63]
    s_waitcnt lgkmcnt(0)
    s_nop 0
    v_mfma_f32_16x16x32_bf16 v[32:35], a[0:3], v[64:67], v[32:35]
    ds_read_b128 v[80:83], v25 offset:49152
    v_mfma_f32_16x16x32_bf16 v[48:51], a[16:19], v[64:67], v[48:51]
    ds_read_b128 v[84:87], v25 offset:51200
    v_mfma_f32_16x16x32_bf16 v[36:39], a[0:3], v[68:71], v[36:39]
    ds_read_b128 v[88:91], v25 offset:53248
    v_mfma_f32_16x16x32_bf16 v[52:55], a[16:19], v[68:71], v[52:55]
    ds_read_b128 v[92:95], v25 offset:55296
    v_mfma_f32_16x16x32_bf16 v[40:43], a[0:3], v[72:75], v[40:43]
    v_mfma_f32_16x16x32_bf16 v[56:59], a[16:19], v[72:75], v[56:59]
    v_mfma_f32_16x16x32_bf16 v[44:47], a[0:3], v[76:79], v[44:47]
    v_mfma_f32_16x16x32_bf16 v[60:63], a[16:19], v[76:79], v[60:63]
    s_waitcnt lgkmcnt(0)
    s_nop 0
    v_mfma_f32_16x16x32_bf16 v[32:35], a[4:7], v[80:83], v[32:35]
    ds_read_b128 v[64:67], v26 offset:49152
    v_mfma_f32_16x16x32_bf16 v[48:51], a[20:23], v[80:83], v[48:51]
    ds_read_b128 v[68:71], v26 offset:51200
    v_mfma_f32_16x16x32_bf16 v[36:39], a[4:7], v[84:87], v[36:39]
    ds_read_b128 v[72:75], v26 offset:53248
    v_mfma_f32_16x16x32_bf16 v[52:55], a[20:23], v[84:87], v[52:55]
    ds_read_b128 v[76:79], v26 offset:55296
    v_mfma_f32_16x16x32_bf16 v[40:43], a[4:7], v[88:91], v[40:43]
    v_mfma_f32_16x16x32_bf16 v[56:59], a[20:23], v[88:91], v[56:59]
    v_mfma_f32_16x16x32_bf16 v[44:47], a[4:7], v[92:95], v[44:47]
    v_mfma_f32_16x16x32_bf16 v[60:63], a[20:23], v[92:95], v[60:63]
    s_waitcnt lgkmcnt(0)
    s_nop 0
    v_mfma_f32_16x16x32_bf16 v[32:35], a[8:11], v[64:67], v[32:35]
    ds_read_b128 v[80:83], v27 offset:49152
    v_mfma_f32_16x16x32_bf16 v[48:51], a[24:27], v[64:67], v[48:51]
    ds_read_b128 v[84:87], v27 offset:51200
    v_mfma_f32_16x16x32_bf16 v[36:39], a[8:11], v[68:71], v[36:39]
    ds_read_b128 v[88:91], v27 offset:53248
    v_mfma_f32_16x16x32_bf16 v[52:55], a[24:27], v[68:71], v[52:55]
    ds_read_b128 v[92:95], v27 offset:55296
    v_mfma_f32_16x16x32_bf16 v[40:43], a[8:11], v[72:75], v[40:43]
    v_mfma_f32_16x16x32_bf16 v[56:59], a[24:27], v[72:75], v[56:59]
    v_mfma_f32_16x16x32_bf16 v[44:47], a[8:11], v[76:79], v[44:47]
    v_mfma_f32_16x16x32_bf16 v[60:63], a[24:27], v[76:79], v[60:63]
    s_waitcnt lgkmcnt(0)
    v_mfma_f32_16x16x32_bf16 v[32:35], a[12:15], v[80:83], v[32:35]
    s_lshl_b32 s38, s32, 7
    s_and_b32 s39, s34, 1
    v_mfma_f32_16x16x32_bf16 v[48:51], a[28:31], v[80:83], v[48:51]
    s_lshl_b32 s39, s39, 6
    s_add_u32 s38, s38, s39
    v_mfma_f32_16x16x32_bf16 v[36:39], a[12:15], v[84:87], v[36:39]
    s_lshr_b32 s39, s34, 1
    s_lshl_b32 s39, s39, 4
    v_mfma_f32_16x16x32_bf16 v[52:55], a[28:31], v[84:87], v[52:55]
    s_add_u32 s38, s38, s39
    s_lshl_b32 s38, s38, 12
    v_mfma_f32_16x16x32_bf16 v[40:43], a[12:15], v[88:91], v[40:43]
    s_lshl_b32 s39, s33, 8
    s_add_u32 s38, s38, s39
    v_mfma_f32_16x16x32_bf16 v[56:59], a[28:31], v[88:91], v[56:59]
    v_lshlrev_b32 v4, 14, v2
    v_lshl_add_u32 v4, v1, 4, v4
    v_mfma_f32_16x16x32_bf16 v[44:47], a[12:15], v[92:95], v[44:47]
    v_mfma_f32_16x16x32_bf16 v[60:63], a[28:31], v[92:95], v[60:63]
    s_waitcnt vmcnt(0)
    v_lshlrev_b32 v120, 16, v96
    v_and_b32 v121, 0xffff0000, v96
    v_lshlrev_b32_e64 v122, 16, v97
    v_and_b32 v123, 0xffff0000, v97
    v_fmac_f32 v120, v32, v112
    v_fmac_f32 v121, v36, v112
    v_fmac_f32 v122, v40, v112
    v_fmac_f32 v123, v44, v112
    s_mov_b32 s39, s38
    buffer_store_dwordx4 v[120:123], v4, s[16:19], s39 offen
    v_lshlrev_b32 v124, 16, v98
    v_and_b32 v125, 0xffff0000, v98
    v_lshlrev_b32_e64 v126, 16, v99
    v_and_b32 v127, 0xffff0000, v99
    v_fmac_f32 v124, v48, v113
    v_fmac_f32 v125, v52, v113
    v_fmac_f32 v126, v56, v113
    v_fmac_f32 v127, v60, v113
    s_add_u32 s39, s38, 131072
    buffer_store_dwordx4 v[124:127], v4, s[16:19], s39 offen
    v_lshlrev_b32_e64 v128, 16, v100
    v_and_b32 v129, 0xffff0000, v100
    v_lshlrev_b32_e64 v130, 16, v101
    v_and_b32 v131, 0xffff0000, v101
    v_fmac_f32 v128, v33, v114
    v_fmac_f32 v129, v37, v114
    v_fmac_f32 v130, v41, v114
    v_fmac_f32 v131, v45, v114
    s_add_u32 s39, s38, 4096
    buffer_store_dwordx4 v[128:131], v4, s[16:19], s39 offen
    v_lshlrev_b32_e64 v132, 16, v102
    v_and_b32 v133, 0xffff0000, v102
    v_lshlrev_b32_e64 v134, 16, v103
    v_and_b32 v135, 0xffff0000, v103
    v_fmac_f32 v132, v49, v115
    v_fmac_f32 v133, v53, v115
    v_fmac_f32 v134, v57, v115
    v_fmac_f32 v135, v61, v115
    s_add_u32 s39, s38, 135168
    buffer_store_dwordx4 v[132:135], v4, s[16:19], s39 offen
    v_lshlrev_b32_e64 v136, 16, v104
    v_and_b32 v137, 0xffff0000, v104
    v_lshlrev_b32_e64 v138, 16, v105
    v_and_b32 v139, 0xffff0000, v105
    v_fmac_f32 v136, v34, v116
    v_fmac_f32 v137, v38, v116
    v_fmac_f32 v138, v42, v116
    v_fmac_f32 v139, v46, v116
    s_add_u32 s39, s38, 8192
    buffer_store_dwordx4 v[136:139], v4, s[16:19], s39 offen
    v_lshlrev_b32_e64 v140, 16, v106
    v_and_b32 v141, 0xffff0000, v106
    v_lshlrev_b32_e64 v142, 16, v107
    v_and_b32 v143, 0xffff0000, v107
    v_fmac_f32 v140, v50, v117
    v_fmac_f32 v141, v54, v117
    v_fmac_f32 v142, v58, v117
    v_fmac_f32 v143, v62, v117
    s_add_u32 s39, s38, 139264
    buffer_store_dwordx4 v[140:143], v4, s[16:19], s39 offen
    v_lshlrev_b32_e64 v144, 16, v108
    v_and_b32 v145, 0xffff0000, v108
    v_lshlrev_b32_e64 v146, 16, v109
    v_and_b32 v147, 0xffff0000, v109
    v_fmac_f32 v144, v35, v118
    v_fmac_f32 v145, v39, v118
    v_fmac_f32 v146, v43, v118
    v_fmac_f32 v147, v47, v118
    s_add_u32 s39, s38, 12288
    buffer_store_dwordx4 v[144:147], v4, s[16:19], s39 offen
    v_lshlrev_b32_e64 v148, 16, v110
    v_and_b32 v149, 0xffff0000, v110
    v_lshlrev_b32_e64 v150, 16, v111
    v_and_b32 v151, 0xffff0000, v111
    v_fmac_f32 v148, v51, v119
    v_fmac_f32 v149, v55, v119
    v_fmac_f32 v150, v59, v119
    v_fmac_f32 v151, v63, v119
    s_add_u32 s39, s38, 143360
    buffer_store_dwordx4 v[148:151], v4, s[16:19], s39 offen
K2_END:
    s_endpgm
K2_CODE_END:
.section .rodata,"a"
.p2align 6
.amdhsa_kernel k1_kernel
  .amdhsa_next_free_vgpr 432
  .amdhsa_next_free_sgpr 100
  .amdhsa_accum_offset 256
  .amdhsa_group_segment_fixed_size 0
  .amdhsa_kernarg_size 128
  .amdhsa_user_sgpr_count 2
  .amdhsa_user_sgpr_kernarg_segment_ptr 1
  .amdhsa_system_sgpr_workgroup_id_x 1
.end_amdhsa_kernel
.p2align 6
.amdhsa_kernel k2_kernel
  .amdhsa_next_free_vgpr 416
  .amdhsa_next_free_sgpr 100
  .amdhsa_accum_offset 256
  .amdhsa_group_segment_fixed_size 0
  .amdhsa_kernarg_size 128
  .amdhsa_user_sgpr_count 2
  .amdhsa_user_sgpr_kernarg_segment_ptr 1
  .amdhsa_system_sgpr_workgroup_id_x 1
.end_amdhsa_kernel
```

```asm
; @launch grid=(256,1,1) block=(256,1,1) lds=163840
.amdgcn_target "amdgcn-amd-amdhsa--gfx950"
.text
.globl gated_mix__spectral_gfnet__ssm_conv_s5__prompt_kernel
.p2align 8
.type gated_mix__spectral_gfnet__ssm_conv_s5__prompt_kernel,@function
gated_mix__spectral_gfnet__ssm_conv_s5__prompt_kernel:
    s_cmp_ge_u32 s2, 256
    s_cbranch_scc1 K_END
    s_nop 0
    s_load_dwordx4 s[44:47], s[0:1], 0
    s_load_dwordx8 s[52:59], s[0:1], 32
    s_load_dwordx2 s[48:49], s[0:1], 16
    s_load_dwordx2 s[60:61], s[0:1], 120
    s_load_dwordx8 s[80:87], s[0:1], 64
    s_load_dwordx4 s[88:91], s[0:1], 96
    v_lshrrev_b32 v3, 6, v0
    v_and_b32 v0, 63, v0
    v_readfirstlane_b32 s34, v3
    v_and_b32 v1, 15, v0
    v_lshrrev_b32 v2, 4, v0
    v_lshlrev_b32 v3, 4, v0
    s_and_b32 s38, s2, 3
    s_lshl_b32 s38, s38, 2
    s_bfe_u32 s39, s2, 0x20003
    s_add_u32 s32, s38, s39
    s_bfe_u32 s38, s2, 0x10002
    s_lshl_b32 s38, s38, 3
    s_lshr_b32 s39, s2, 5
    s_add_u32 s33, s38, s39
    s_getpc_b64 s[28:29]
K_PC:
    s_mov_b32 s30, K_CODE_END-K_PC
    s_mov_b32 s31, 0x00020000
    s_bfe_u32 s38, s2, 0x30003
    s_lshl_b32 s38, s38, 2
    s_add_u32 s38, s38, s34
    s_lshl_b32 s38, s38, 11
    v_lshl_add_u32 v4, v1, 7, s38
    v_cmp_gt_u32 vcc, 16, v0
    s_nop 1
    v_cndmask_b32_e64 v4, 2.0, v4, vcc
    buffer_load_dword v255, v4, s[28:31], 0 offen
    v_lshrrev_b32 v5, 2, v1
    v_lshlrev_b32 v5, 1, v5
    v_and_b32_e64 v6, 1, v1
    v_bfe_u32 v7, v1, 1, 1
    v_lshl_add_u32 v5, v7, 3, v5
    v_add_u32 v4, v5, v6
    v_lshlrev_b32 v5, 9, v2
    v_lshl_add_u32 v30, v1, 3, v5
    v_lshl_add_u32 v5, v4, 2, v5
    s_lshl_b32 s68, s32, 7
    s_and_b32 s39, s34, 1
    s_lshl_b32 s39, s39, 6
    s_add_u32 s68, s68, s39
    s_lshl_b32 s39, s33, 1
    s_add_u32 s68, s68, s39
    s_lshr_b32 s39, s34, 1
    s_add_u32 s68, s68, s39
    s_lshl_b32 s68, s68, 11
    s_add_u32 s69, s68, 65536
    s_lshl_b32 s37, s34, 12
    v_and_b32 v6, 7, v0
    v_xor_b32 v6, v6, v2
    v_lshlrev_b32 v6, 4, v6
    v_xor_b32 v7, 64, v6
    v_lshrrev_b32 v8, 5, v0
    v_lshlrev_b32 v8, 5, v8
    v_bfe_u32 v9, v0, 3, 1
    v_lshl_add_u32 v8, v9, 4, v8
    v_bfe_u32 v9, v0, 4, 1
    v_add_u32 v8, v8, v9
    s_lshl_b32 s38, s32, 7
    s_lshl_b32 s39, s34, 2
    s_add_u32 s38, s38, s39
    v_add_u32 v8, s38, v8
    v_lshrrev_b32 v9, 3, v0
    s_lshl_b32 s38, s33, 6
    s_and_b32 s39, s34, 1
    s_lshl_b32 s39, s39, 5
    s_add_u32 s38, s38, s39
    v_add_u32 v9, s38, v9
    v_add_u32 v10, 0, v8
    v_lshl_add_u32 v16, v10, 11, v6
    v_add_u32_e64 v10, 0, v9
    v_lshl_add_u32 v20, v10, 11, v6
    v_add_u32_e64 v10, 64, v8
    v_lshl_add_u32 v17, v10, 11, v7
    v_add_u32_e64 v10, 8, v9
    v_lshl_add_u32 v21, v10, 11, v7
    v_add_u32_e64 v10, 2, v8
    v_lshl_add_u32 v18, v10, 11, v6
    v_add_u32_e64 v10, 16, v9
    v_lshl_add_u32 v22, v10, 11, v6
    v_add_u32 v10, 66, v8
    v_lshl_add_u32 v19, v10, 11, v7
    v_add_u32_e64 v10, 24, v9
    v_lshl_add_u32 v23, v10, 11, v7
    s_add_u32 s38, s32, s33
    s_and_b32 s38, s38, 3
    s_mov_b32 s66, 1703092544
    s_mov_b32 s67, 4275808711
    s_cmp_eq_u32 s38, 1
    s_cselect_b32 s66, 2036348193, s66
    s_cselect_b32 s67, 3488136612, s67
    s_cmp_eq_u32 s38, 2
    s_cselect_b32 s66, 2758893618, s66
    s_cselect_b32 s67, 3707365557, s67
    s_cmp_eq_u32 s38, 3
    s_cselect_b32 s66, 1699160323, s66
    s_cselect_b32 s67, 3989809547, s67
    s_waitcnt lgkmcnt(0)
    s_add_u32 s40, s60, 22315008
    s_addc_u32 s41, s61, 0
    s_load_dword s62, s[40:41], 0
    s_mov_b32 s8, s44
    s_mov_b32 s9, s45
    s_nop 0
    s_mov_b32 s10, 4194304
    s_mov_b32 s11, 0x00020000
    buffer_load_dword v184, v5, s[8:11], s68 offen offset:0
    buffer_load_dword v185, v5, s[8:11], s68 offen offset:128
    buffer_load_dword v186, v5, s[8:11], s68 offen offset:256
    buffer_load_dword v187, v5, s[8:11], s68 offen offset:384
    buffer_load_dword v188, v5, s[8:11], s68 offen offset:64
    buffer_load_dword v189, v5, s[8:11], s68 offen offset:192
    buffer_load_dword v190, v5, s[8:11], s68 offen offset:320
    buffer_load_dword v191, v5, s[8:11], s68 offen offset:448
    buffer_load_dword v192, v5, s[8:11], s69 offen offset:0
    buffer_load_dword v193, v5, s[8:11], s69 offen offset:128
    buffer_load_dword v194, v5, s[8:11], s69 offen offset:256
    buffer_load_dword v195, v5, s[8:11], s69 offen offset:384
    buffer_load_dword v196, v5, s[8:11], s69 offen offset:64
    buffer_load_dword v197, v5, s[8:11], s69 offen offset:192
    buffer_load_dword v198, v5, s[8:11], s69 offen offset:320
    buffer_load_dword v199, v5, s[8:11], s69 offen offset:448
    s_cmp_lt_u32 s34, 2
    s_cselect_b32 s12, s56, s58
    s_cselect_b32 s13, s57, s59
    s_mov_b32 s14, 0x200000
    s_mov_b32 s15, 0x00020000
    v_cvt_f32_u32 v6, v1
    s_bfe_u32 s36, s66, 262144
    v_cvt_f32_u32 v7, v2
    v_cvt_f32_u32 v8, v4
    s_lshl_b32 s36, s36, 7
    v_mul_f32 v9, 0x3d800000, v6
    v_mul_f32 v15, 4.0, v7
    s_add_u32 m0, s37, 0
    v_mul_f32 v15, v15, v9
    v_fmamk_f32 v12, v9, 0x00000000, v15
    buffer_load_dwordx4 v16, s[8:11], s36 offen lds
    v_cos_f32 v10, v12
    v_sin_f32 v11, v12
    s_nop 0
    s_nop 0
    v_cvt_pk_bf16_f32 v13, v10, v11
    s_add_u32 m0, s37, 1024
    v_cvt_pk_bf16_f32 v14, -v11, v10
    v_accvgpr_write_b32 a32, v13
    buffer_load_dwordx4 v17, s[8:11], s36 offen lds
    v_accvgpr_write_b32 a36, v14
    v_fmamk_f32 v12, v9, 0x3f800000, v15
    s_add_u32 m0, s37, 2048
    v_cos_f32 v10, v12
    v_sin_f32 v11, v12
    buffer_load_dwordx4 v18, s[8:11], s36 offen lds
    v_cvt_pk_bf16_f32 v13, v10, v11
    v_cvt_pk_bf16_f32 v14, -v11, v10
    v_accvgpr_write_b32 a33, v13
    s_add_u32 m0, s37, 3072
    v_accvgpr_write_b32 a37, v14
    v_fmamk_f32 v12, v9, 0x40000000, v15
    buffer_load_dwordx4 v19, s[8:11], s36 offen lds
    v_cos_f32 v10, v12
    v_sin_f32 v11, v12
    s_add_u32 m0, s37, 16384
    v_cvt_pk_bf16_f32 v13, v10, v11
    v_cvt_pk_bf16_f32 v14, -v11, v10
    v_accvgpr_write_b32 a34, v13
    buffer_load_dwordx4 v20, s[12:15], s36 offen lds
    v_accvgpr_write_b32 a38, v14
    v_fmamk_f32 v12, v9, 0x40400000, v15
    s_add_u32 m0, s37, 17408
    v_cos_f32 v10, v12
    v_sin_f32 v11, v12
    buffer_load_dwordx4 v21, s[12:15], s36 offen lds
    v_cvt_pk_bf16_f32 v13, v10, v11
    v_cvt_pk_bf16_f32 v14, -v11, v10
    s_add_u32 m0, s37, 18432
    v_accvgpr_write_b32 a35, v13
    v_accvgpr_write_b32 a39, v14
    v_mul_f32 v9, 0x3b000000, v6
    buffer_load_dwordx4 v22, s[12:15], s36 offen lds
    v_add_f32 v15, v7, v7
    v_mul_f32 v15, v15, v9
    s_add_u32 m0, s37, 19456
    v_fmamk_f32 v12, v9, 0x00000000, v15
    v_cos_f32_e64 v232, v12
    buffer_load_dwordx4 v23, s[12:15], s36 offen lds
    v_sin_f32_e64 v240, v12
    v_fmamk_f32 v12, v9, 0x3f800000, v15
    v_cos_f32 v233, v12
    v_sin_f32 v241, v12
    v_fmamk_f32 v12, v9, 0x41000000, v15
    v_cos_f32 v234, v12
    v_sin_f32 v242, v12
    v_fmamk_f32 v12, v9, 0x41100000, v15
    v_cos_f32 v235, v12
    v_sin_f32 v243, v12
    v_fmamk_f32 v12, v9, 0x41800000, v15
    v_cos_f32 v236, v12
    v_sin_f32 v244, v12
    v_fmamk_f32 v12, v9, 0x41880000, v15
    v_cos_f32 v237, v12
    v_sin_f32 v245, v12
    v_fmamk_f32 v12, v9, 0x41c00000, v15
    v_cos_f32 v238, v12
    v_sin_f32 v246, v12
    v_fmamk_f32 v12, v9, 0x41c80000, v15
    v_cos_f32 v239, v12
    v_sin_f32 v247, v12
    v_mul_f32 v9, 0x3d000000, v8
    v_add_f32 v15, v7, v7
    v_mul_f32 v15, v15, v9
    v_and_b32_e64 v248, 1, v1
    v_mul_u32_u24 v248, 0x8000, v248
    v_lshl_or_b32 v248, v248, 16, v248
    v_fmamk_f32 v12, v9, 0x00000000, v15
    v_cos_f32 v10, v12
    v_sin_f32 v11, v12
    s_nop 0
    v_cvt_pk_bf16_f32 v13, v10, v11
    v_xor_b32 v14, v248, v13
    v_accvgpr_write_b32 a0, v13
    v_accvgpr_write_b32 a8, v14
    v_accvgpr_write_b32 a16, v13
    v_accvgpr_write_b32 a24, v14
    v_cvt_pk_bf16_f32 v13, -v11, v10
    v_xor_b32_e64 v14, v248, v13
    v_accvgpr_write_b32 a4, v13
    v_accvgpr_write_b32 a12, v14
    v_accvgpr_write_b32 a20, v13
    v_accvgpr_write_b32 a28, v14
    v_fmamk_f32 v12, v9, 0x3f800000, v15
    v_cos_f32 v10, v12
    v_sin_f32 v11, v12
    s_nop 0
    v_cvt_pk_bf16_f32 v13, v10, v11
    v_xor_b32 v14, v248, v13
    v_accvgpr_write_b32 a1, v13
    v_accvgpr_write_b32 a9, v14
    v_xor_b32 v13, 0x80008000, v13
    v_xor_b32 v14, 0x80008000, v14
    v_accvgpr_write_b32 a17, v13
    v_accvgpr_write_b32 a25, v14
    v_cvt_pk_bf16_f32 v13, -v11, v10
    v_xor_b32_e64 v14, v248, v13
    v_accvgpr_write_b32 a5, v13
    v_accvgpr_write_b32 a13, v14
    v_xor_b32 v13, 0x80008000, v13
    v_xor_b32 v14, 0x80008000, v14
    v_accvgpr_write_b32 a21, v13
    v_accvgpr_write_b32 a29, v14
    v_fmamk_f32 v12, v9, 0x41000000, v15
    v_cos_f32 v10, v12
    v_sin_f32 v11, v12
    s_nop 0
    v_cvt_pk_bf16_f32 v13, v10, v11
    v_xor_b32 v14, v248, v13
    v_accvgpr_write_b32 a2, v13
    v_accvgpr_write_b32 a10, v14
    v_accvgpr_write_b32 a18, v13
    v_accvgpr_write_b32 a26, v14
    v_cvt_pk_bf16_f32 v13, -v11, v10
    v_xor_b32_e64 v14, v248, v13
    v_accvgpr_write_b32 a6, v13
    v_accvgpr_write_b32 a14, v14
    v_accvgpr_write_b32 a22, v13
    v_accvgpr_write_b32 a30, v14
    v_fmamk_f32 v12, v9, 0x41100000, v15
    v_cos_f32 v10, v12
    v_sin_f32 v11, v12
    s_nop 0
    v_cvt_pk_bf16_f32 v13, v10, v11
    v_xor_b32 v14, v248, v13
    v_accvgpr_write_b32 a3, v13
    v_accvgpr_write_b32 a11, v14
    v_xor_b32 v13, 0x80008000, v13
    v_xor_b32 v14, 0x80008000, v14
    v_accvgpr_write_b32 a19, v13
    v_accvgpr_write_b32 a27, v14
    v_cvt_pk_bf16_f32 v13, -v11, v10
    v_xor_b32_e64 v14, v248, v13
    v_accvgpr_write_b32 a7, v13
    v_accvgpr_write_b32 a15, v14
    v_xor_b32 v13, 0x80008000, v13
    v_xor_b32 v14, 0x80008000, v14
    v_accvgpr_write_b32 a23, v13
    v_accvgpr_write_b32 a31, v14
    v_mov_b32 v249, v6
    v_mov_b32 v250, v7
    v_mov_b32 v251, v8
    s_mov_b32 s16, s46
    s_mov_b32 s17, s47
    s_mov_b32 s18, 2101248
    s_mov_b32 s19, 0x00020000
    s_mov_b32 s20, s48
    s_mov_b32 s21, s49
    s_mov_b32 s22, 2101248
    s_mov_b32 s23, 0x00020000
    s_mov_b32 s24, s60
    s_mov_b32 s25, s61
    s_mov_b32 s26, 33554432
    s_mov_b32 s27, 0x00020000
    s_lshr_b32 s38, s2, 6
    s_lshl_b32 s38, s38, 4
    s_and_b32 s39, s2, 3
    s_lshl_b32 s39, s39, 2
    s_add_u32 s38, s38, s39
    s_bfe_u32 s39, s2, 0x40002
    s_lshl_b32 s39, s39, 7
    s_add_u32 s38, s38, s39
    v_and_b32 v6, 3, v0
    v_add_u32 v6, s38, v6
    v_lshrrev_b32 v7, 2, v0
    s_lshl_b32 s39, s34, 4
    v_add_u32 v7, s39, v7
    s_movk_i32 s40, 1026
    v_mul_u32_u24_e64 v8, s40, v6
    v_lshl_add_u32 v9, v7, 3, v8
    v_sub_u32 v10, 2048, v6
    v_and_b32 v11, 2047, v10
    v_subrev_u32 v10, 64, v10
    v_lshlrev_b32 v12, 3, v7
    v_sub_u32 v12, 1018, v12
    v_mad_u32_u24 v11, v11, s40, v12
    v_mad_u32_u24 v10, v10, s40, v12
    s_mov_b32 s70, 65664
    v_add_u32 v8, 512, v8
    v_cmp_eq_u32 vcc, 0, v7
    s_nop 1
    v_cndmask_b32 v8, 2.0, v8, vcc
    v_and_b32 v12, 3, v0
    v_lshlrev_b32_e64 v12, 4, v12
    s_mov_b32 s40, 131072
    v_mad_u32_u24 v13, v7, s40, v12
    v_add_u32 v14, 8388608, v12
    v_cndmask_b32 v14, 2.0, v14, vcc
    v_lshrrev_b32 v15, 1, v1
    v_xor_b32 v15, v15, v2
    v_lshlrev_b32 v15, 4, v15
    v_lshl_add_u32 v24, v1, 7, v15
    v_xor_b32 v25, 64, v24
    s_lshl_b32 s38, s34, 11
    s_add_u32 s38, s38, 16384
    v_add_u32 v26, s38, v24
    v_add_u32 v27, s38, v25
    v_add_u32 v148, 0x10000, v24
    v_add_u32 v149, 0x10000, v25
    v_add_u32 v150, 0x10000, v26
    v_add_u32 v151, 0x10000, v27
    s_lshr_b32 s38, s34, 1
    s_lshl_b32 s38, s38, 2
    s_and_b32 s39, s34, 1
    s_add_u32 s38, s38, s39
    s_mul_i32 s38, s38, 2080
    s_add_u32 s38, s38, 131072
    v_lshl_add_u32 v15, v2, 5, v1
    v_lshl_add_u32 v252, v15, 3, s38
    v_sub_u32 v15, 112, v15
    s_add_u32 s38, s38, 4160
    v_lshl_add_u32 v253, v15, 3, s38
    v_and_b32_e64 v15, 3, v0
    v_mul_u32_u24 v229, 4160, v15
    v_lshl_add_u32 v229, v7, 3, v229
    v_add_u32 v229, 131072, v229
    s_mov_b32 s40, 32768
    v_mad_u32_u24 v230, v7, s40, v12
    v_and_b32 v15, 1, v15
    v_lshlrev_b32 v15, 11, v15
    v_cndmask_b32 v15, 0, v15, vcc
    v_add_u32 v228, v229, v15
    s_waitcnt vmcnt(16)
    s_nop 0
    v_mfma_f32_16x16x32_bf16 v[32:35], v[184:187], a[32:35], 0
    buffer_load_dwordx2 v[208:209], v9, s[16:19], 0 offen
    buffer_load_dwordx2 v[210:211], v9, s[20:23], 0 offen
    v_mfma_f32_16x16x32_bf16 v[36:39], v[184:187], a[36:39], 0
    buffer_load_dwordx2 v[212:213], v11, s[16:19], 0 offen
    v_mfma_f32_16x16x32_bf16 v[40:43], v[188:191], a[32:35], 0
    buffer_load_dwordx2 v[214:215], v11, s[20:23], 0 offen
    v_mfma_f32_16x16x32_bf16 v[44:47], v[188:191], a[36:39], 0
    buffer_load_ushort v224, v8, s[16:19], 0 offen
    buffer_load_ushort v225, v8, s[20:23], 0 offen
    s_waitcnt vmcnt(14)
    s_nop 0
    buffer_load_dwordx2 v[216:217], v9, s[16:19], s70 offen
    v_mfma_f32_16x16x32_bf16 v[48:51], v[192:195], a[32:35], 0
    buffer_load_dwordx2 v[218:219], v9, s[20:23], s70 offen
    v_mfma_f32_16x16x32_bf16 v[52:55], v[192:195], a[36:39], 0
    buffer_load_dwordx2 v[220:221], v10, s[16:19], 0 offen
    buffer_load_dwordx2 v[222:223], v10, s[20:23], 0 offen
    v_mfma_f32_16x16x32_bf16 v[56:59], v[196:199], a[32:35], 0
    buffer_load_ushort v226, v8, s[16:19], s70 offen
    v_mfma_f32_16x16x32_bf16 v[60:63], v[196:199], a[36:39], 0
    buffer_load_ushort v227, v8, s[20:23], s70 offen
    v_pk_mul_f32 v[200:201], v[32:33], v[232:233]
    v_pk_mul_f32 v[202:203], v[36:37], v[232:233]
    v_pk_fma_f32 v[200:201], v[36:37], v[240:241], v[200:201]
    v_pk_fma_f32 v[202:203], v[32:33], v[240:241], v[202:203] neg_lo:[1,0,0] neg_hi:[1,0,0]
    v_pk_mul_f32 v[204:205], v[34:35], v[234:235]
    v_pk_mul_f32 v[206:207], v[38:39], v[234:235]
    v_pk_fma_f32 v[204:205], v[38:39], v[242:243], v[204:205]
    v_pk_fma_f32 v[206:207], v[34:35], v[242:243], v[206:207] neg_lo:[1,0,0] neg_hi:[1,0,0]
    v_cvt_pk_bf16_f32 v152, v200, v202
    v_cvt_pk_bf16_f32 v153, v201, v203
    v_cvt_pk_bf16_f32 v154, v204, v206
    v_cvt_pk_bf16_f32 v155, v205, v207
    v_pk_mul_f32 v[200:201], v[40:41], v[236:237]
    v_pk_mul_f32 v[202:203], v[44:45], v[236:237]
    v_pk_fma_f32 v[200:201], v[44:45], v[244:245], v[200:201]
    v_pk_fma_f32 v[202:203], v[40:41], v[244:245], v[202:203] neg_lo:[1,0,0] neg_hi:[1,0,0]
    v_pk_mul_f32 v[204:205], v[42:43], v[238:239]
    v_pk_mul_f32 v[206:207], v[46:47], v[238:239]
    v_pk_fma_f32 v[204:205], v[46:47], v[246:247], v[204:205]
    v_pk_fma_f32 v[206:207], v[42:43], v[246:247], v[206:207] neg_lo:[1,0,0] neg_hi:[1,0,0]
    v_cvt_pk_bf16_f32 v156, v200, v202
    v_cvt_pk_bf16_f32 v157, v201, v203
    v_cvt_pk_bf16_f32 v158, v204, v206
    v_cvt_pk_bf16_f32 v159, v205, v207
    v_pk_mul_f32 v[200:201], v[48:49], v[232:233]
    v_pk_mul_f32 v[202:203], v[52:53], v[232:233]
    v_pk_fma_f32 v[200:201], v[52:53], v[240:241], v[200:201]
    v_pk_fma_f32 v[202:203], v[48:49], v[240:241], v[202:203] neg_lo:[1,0,0] neg_hi:[1,0,0]
    v_pk_mul_f32 v[204:205], v[50:51], v[234:235]
    v_pk_mul_f32 v[206:207], v[54:55], v[234:235]
    v_pk_fma_f32 v[204:205], v[54:55], v[242:243], v[204:205]
    v_pk_fma_f32 v[206:207], v[50:51], v[242:243], v[206:207] neg_lo:[1,0,0] neg_hi:[1,0,0]
    v_cvt_pk_bf16_f32 v160, v200, v202
    v_cvt_pk_bf16_f32 v161, v201, v203
    v_cvt_pk_bf16_f32 v162, v204, v206
    v_cvt_pk_bf16_f32 v163, v205, v207
    v_pk_mul_f32 v[200:201], v[56:57], v[236:237]
    v_pk_mul_f32 v[202:203], v[60:61], v[236:237]
    v_pk_fma_f32 v[200:201], v[60:61], v[244:245], v[200:201]
    v_pk_fma_f32 v[202:203], v[56:57], v[244:245], v[202:203] neg_lo:[1,0,0] neg_hi:[1,0,0]
    v_pk_mul_f32 v[204:205], v[58:59], v[238:239]
    v_pk_mul_f32 v[206:207], v[62:63], v[238:239]
    v_pk_fma_f32 v[204:205], v[62:63], v[246:247], v[204:205]
    v_pk_fma_f32 v[206:207], v[58:59], v[246:247], v[206:207] neg_lo:[1,0,0] neg_hi:[1,0,0]
    v_cvt_pk_bf16_f32 v164, v200, v202
    v_cvt_pk_bf16_f32 v165, v201, v203
    v_cvt_pk_bf16_f32 v166, v204, v206
    v_cvt_pk_bf16_f32 v167, v205, v207
    v_mfma_f32_16x16x32_bf16 v[64:67], a[0:3], v[152:155], 0
    buffer_load_dwordx2 v[96:97], v30, s[8:11], s68 offen offset:0
    buffer_load_dwordx2 v[98:99], v30, s[8:11], s68 offen offset:128
    v_mfma_f32_16x16x32_bf16 v[68:71], a[4:7], v[152:155], 0
    buffer_load_dwordx2 v[100:101], v30, s[8:11], s68 offen offset:256
    v_mfma_f32_16x16x32_bf16 v[72:75], a[16:19], v[152:155], 0
    buffer_load_dwordx2 v[102:103], v30, s[8:11], s68 offen offset:384
    buffer_load_dwordx2 v[104:105], v30, s[8:11], s69 offen offset:0
    v_mfma_f32_16x16x32_bf16 v[76:79], a[20:23], v[152:155], 0
    buffer_load_dwordx2 v[106:107], v30, s[8:11], s69 offen offset:128
    v_mfma_f32_16x16x32_bf16 v[64:67], a[8:11], v[156:159], v[64:67]
    buffer_load_dwordx2 v[108:109], v30, s[8:11], s69 offen offset:256
    buffer_load_dwordx2 v[110:111], v30, s[8:11], s69 offen offset:384
    v_mfma_f32_16x16x32_bf16 v[68:71], a[12:15], v[156:159], v[68:71]
    global_load_dwordx2 v[112:113], v30, s[88:89] offset:0
    v_mfma_f32_16x16x32_bf16 v[72:75], a[24:27], v[156:159], v[72:75]
    global_load_dwordx2 v[120:121], v30, s[86:87] offset:0
    global_load_dwordx2 v[114:115], v30, s[88:89] offset:128
    v_mfma_f32_16x16x32_bf16 v[76:79], a[28:31], v[156:159], v[76:79]
    global_load_dwordx2 v[122:123], v30, s[86:87] offset:128
    v_mfma_f32_16x16x32_bf16 v[80:83], a[0:3], v[160:163], 0
    global_load_dwordx2 v[116:117], v30, s[88:89] offset:256
    v_mfma_f32_16x16x32_bf16 v[84:87], a[4:7], v[160:163], 0
    global_load_dwordx2 v[124:125], v30, s[86:87] offset:256
    global_load_dwordx2 v[118:119], v30, s[88:89] offset:384
    v_mfma_f32_16x16x32_bf16 v[88:91], a[16:19], v[160:163], 0
    global_load_dwordx2 v[126:127], v30, s[86:87] offset:384
    v_mfma_f32_16x16x32_bf16 v[92:95], a[20:23], v[160:163], 0
    s_lshl_b32 s38, s33, 6
    s_lshl_b32 s39, s34, 4
    v_mfma_f32_16x16x32_bf16 v[80:83], a[8:11], v[164:167], v[80:83]
    s_add_u32 s38, s38, s39
    s_nop 0
    v_mfma_f32_16x16x32_bf16 v[84:87], a[12:15], v[164:167], v[84:87]
    v_add_lshl_u32 v15, v1, s38, 1
    global_load_ushort v142, v15, s[52:53]
    v_mfma_f32_16x16x32_bf16 v[88:91], a[24:27], v[164:167], v[88:91]
    global_load_ushort v143, v15, s[54:55]
    v_mfma_f32_16x16x32_bf16 v[92:95], a[28:31], v[164:167], v[92:95]
    global_load_ushort v144, v15, s[84:85]
    v_cvt_pk_bf16_f32 v168, v64, v68
    s_bfe_u32 s36, s66, 262148
    v_cvt_pk_bf16_f32 v169, v80, v84
    s_lshl_b32 s36, s36, 7
    s_nop 0
    ds_write_b64 v252, v[168:169] offset:0
    s_add_u32 m0, s37, 32768
    v_cvt_pk_bf16_f32 v170, v65, v69
    v_cvt_pk_bf16_f32 v171, v81, v85
    buffer_load_dwordx4 v16, s[8:11], s36 offen lds
    ds_write_b64 v252, v[170:171] offset:128
    s_add_u32 m0, s37, 33792
    v_cvt_pk_bf16_f32 v172, v66, v70
    buffer_load_dwordx4 v17, s[8:11], s36 offen lds
    v_cvt_pk_bf16_f32 v173, v82, v86
    ds_write_b64 v252, v[172:173] offset:1024
    s_add_u32 m0, s37, 34816
    v_cvt_pk_bf16_f32 v174, v67, v71
    buffer_load_dwordx4 v18, s[8:11], s36 offen lds
    v_cvt_pk_bf16_f32 v175, v83, v87
    s_add_u32 m0, s37, 35840
    ds_write_b64 v252, v[174:175] offset:1152
    v_cvt_pk_bf16_f32 v176, v72, -v76
    buffer_load_dwordx4 v19, s[8:11], s36 offen lds
    v_cvt_pk_bf16_f32 v177, v88, -v92
    s_add_u32 m0, s37, 49152
    ds_write_b64 v253, v[176:177] offset:1152
    buffer_load_dwordx4 v20, s[12:15], s36 offen lds
    v_cvt_pk_bf16_f32 v178, v73, -v77
    v_cvt_pk_bf16_f32 v179, v89, -v93
    s_add_u32 m0, s37, 50176
    ds_write_b64 v253, v[178:179] offset:1024
    buffer_load_dwordx4 v21, s[12:15], s36 offen lds
    v_cvt_pk_bf16_f32 v180, v74, -v78
    s_add_u32 m0, s37, 51200
    v_cvt_pk_bf16_f32 v181, v90, -v94
    ds_write_b64 v253, v[180:181] offset:128
    buffer_load_dwordx4 v22, s[12:15], s36 offen lds
    v_cvt_pk_bf16_f32 v182, v75, -v79
    s_add_u32 m0, s37, 52224
    v_cvt_pk_bf16_f32 v183, v91, -v95
    buffer_load_dwordx4 v23, s[12:15], s36 offen lds
    ds_write_b64 v253, v[182:183] offset:0
    s_waitcnt lgkmcnt(0)
    s_barrier
    ds_read_b64 v[48:49], v228 offset:0
    ds_read_b64 v[50:51], v228 offset:2080
    ds_read_b64 v[52:53], v229 offset:512
    ds_read_b64 v[54:55], v229 offset:2592
    ds_read_b64 v[56:57], v229 offset:1024
    ds_read_b64 v[58:59], v229 offset:3104
    ds_read_b64 v[60:61], v229 offset:1536
    ds_read_b64 v[62:63], v229 offset:3616
    s_lshr_b32 s38, s33, 2
    s_lshl_b32 s38, s38, 2
    s_lshr_b32 s39, s32, 2
    s_add_u32 s38, s38, s39
    s_lshl_b32 s38, s38, 4
    s_and_b32 s39, s32, 3
    s_lshl_b32 s39, s39, 2
    s_add_u32 s38, s38, s39
    s_and_b32 s39, s33, 3
    s_add_u32 s38, s38, s39
    s_lshl_b32 s38, s38, 6
    s_mul_i32 s35, s62, 2654435761
    s_add_u32 s35, s35, 2135587861
    s_waitcnt lgkmcnt(6)
    buffer_store_dwordx4 v[48:51], v230, s[24:27], s38 offen sc1
    s_add_u32 s38, s38, 2097152
    s_waitcnt lgkmcnt(4)
    buffer_store_dwordx4 v[52:55], v230, s[24:27], s38 offen sc1
    s_add_u32 s38, s38, 2097152
    s_waitcnt lgkmcnt(2)
    buffer_store_dwordx4 v[56:59], v230, s[24:27], s38 offen sc1
    s_add_u32 s38, s38, 2097152
    s_waitcnt lgkmcnt(0)
    buffer_store_dwordx4 v[60:63], v230, s[24:27], s38 offen sc1
    s_waitcnt vmcnt(31)
    s_mov_b32 s38, 0x05040100
    s_mov_b32 s39, 0x07060302
    s_lshl_b32 s40, s2, 6
    s_nop 0
    s_add_u32 s40, s40, 16384
    v_lshl_or_b32 v224, v225, 16, v224
    v_lshl_or_b32 v226, v227, 16, v226
    buffer_store_dwordx4 v[224:227], v14, s[24:27], s40 offen sc1
    v_perm_b32 v32, v210, v208, s38
    v_perm_b32 v33, v215, v213, s39
    v_perm_b32 v34, v218, v216, s38
    v_perm_b32 v35, v223, v221, s39
    buffer_store_dwordx4 v[32:35], v13, s[24:27], s40 offen sc1
    s_add_u32 s40, s40, 32768
    v_perm_b32 v36, v210, v208, s39
    v_perm_b32 v37, v215, v213, s38
    v_perm_b32 v38, v218, v216, s39
    v_perm_b32 v39, v223, v221, s38
    buffer_store_dwordx4 v[36:39], v13, s[24:27], s40 offen sc1
    s_add_u32 s40, s40, 32768
    v_perm_b32 v40, v211, v209, s38
    v_perm_b32 v41, v214, v212, s39
    v_perm_b32 v42, v219, v217, s38
    v_perm_b32 v43, v222, v220, s39
    buffer_store_dwordx4 v[40:43], v13, s[24:27], s40 offen sc1
    s_add_u32 s40, s40, 32768
    v_perm_b32 v44, v211, v209, s39
    v_perm_b32 v45, v214, v212, s38
    v_perm_b32 v46, v219, v217, s39
    v_perm_b32 v47, v222, v220, s38
    buffer_store_dwordx4 v[44:47], v13, s[24:27], s40 offen sc1
    s_waitcnt vmcnt(17)
    s_nop 0
    s_bfe_u32 s36, s66, 262152
    v_dot2_f32_bf16 v10, v96, v112, 0
    v_dot2_f32_bf16 v11, v104, v112, 0
    v_dot2_f32_bf16 v10, v97, v113, v10
    v_dot2_f32_bf16 v11, v105, v113, v11
    v_dot2_f32_bf16 v10, v98, v114, v10
    s_lshl_b32 s36, s36, 7
    s_nop 0
    v_dot2_f32_bf16 v11, v106, v114, v11
    v_dot2_f32_bf16 v10, v99, v115, v10
    v_dot2_f32_bf16 v11, v107, v115, v11
    v_dot2_f32_bf16 v10, v100, v116, v10
    v_dot2_f32_bf16 v11, v108, v116, v11
    s_add_u32 m0, s37, 65536
    v_dot2_f32_bf16 v10, v101, v117, v10
    v_dot2_f32_bf16 v11, v109, v117, v11
    v_dot2_f32_bf16 v10, v102, v118, v10
    v_dot2_f32_bf16 v11, v110, v118, v11
    v_dot2_f32_bf16 v10, v103, v119, v10
    v_dot2_f32_bf16 v11, v111, v119, v11
    buffer_load_dwordx4 v16, s[8:11], s36 offen lds
    v_lshlrev_b32_e64 v216, 16, v120
    v_add_f32_dpp v10, v10, v10 row_ror:8 row_mask:0xf bank_mask:0xf
    v_and_b32 v220, 0xffff0000, v120
    v_add_f32_dpp v11, v11, v11 row_ror:8 row_mask:0xf bank_mask:0xf
    v_lshlrev_b32_e64 v184, 16, v96
    s_add_u32 m0, s37, 66560
    v_add_f32_dpp v10, v10, v10 row_ror:4 row_mask:0xf bank_mask:0xf
    v_and_b32 v188, 0xffff0000, v96
    v_add_f32_dpp v11, v11, v11 row_ror:4 row_mask:0xf bank_mask:0xf
    v_lshlrev_b32_e64 v200, 16, v104
    v_add_f32_dpp v10, v10, v10 row_ror:2 row_mask:0xf bank_mask:0xf
    v_and_b32 v204, 0xffff0000, v104
    buffer_load_dwordx4 v17, s[8:11], s36 offen lds
    v_lshlrev_b32_e64 v224, 16, v121
    v_add_f32_dpp v11, v11, v11 row_ror:2 row_mask:0xf bank_mask:0xf
    v_and_b32 v228, 0xffff0000, v121
    v_add_f32_dpp v10, v10, v10 row_ror:1 row_mask:0xf bank_mask:0xf
    v_lshlrev_b32_e64 v192, 16, v97
    s_add_u32 m0, s37, 67584
    v_add_f32_dpp v11, v11, v11 row_ror:1 row_mask:0xf bank_mask:0xf
    v_and_b32 v196, 0xffff0000, v97
    v_mov_b32 v12, v10
    v_lshlrev_b32 v208, 16, v105
    v_and_b32 v212, 0xffff0000, v105
    v_mov_b32_e64 v13, v11
    buffer_load_dwordx4 v18, s[8:11], s36 offen lds
    v_lshlrev_b32 v217, 16, v122
    v_permlane32_swap_b32 v10, v12
    v_and_b32 v221, 0xffff0000, v122
    v_permlane32_swap_b32 v11, v13
    v_lshlrev_b32 v185, 16, v98
    s_add_u32 m0, s37, 68608
    v_add_f32_e64 v10, v10, v12
    v_and_b32 v189, 0xffff0000, v98
    v_lshlrev_b32 v201, 16, v106
    v_add_f32 v11, v11, v13
    v_and_b32 v205, 0xffff0000, v106
    v_mov_b32_e64 v12, v10
    buffer_load_dwordx4 v19, s[8:11], s36 offen lds
    v_lshlrev_b32 v225, 16, v123
    v_mov_b32 v13, v11
    v_and_b32 v229, 0xffff0000, v123
    v_permlane16_swap_b32 v10, v12
    v_lshlrev_b32 v193, 16, v99
    s_add_u32 m0, s37, 81920
    v_permlane16_swap_b32 v11, v13
    v_and_b32 v197, 0xffff0000, v99
    v_lshlrev_b32 v209, 16, v107
    v_add_f32_e64 v10, v10, v12
    v_and_b32 v213, 0xffff0000, v107
    v_add_f32_e64 v11, v11, v13
    buffer_load_dwordx4 v20, s[12:15], s36 offen lds
    v_lshlrev_b32_e64 v218, 16, v124
    v_cvt_pk_bf16_f32 v12, v10, v11
    v_and_b32 v222, 0xffff0000, v124
    v_lshlrev_b32 v10, 16, v12
    v_lshlrev_b32 v186, 16, v100
    s_add_u32 m0, s37, 82944
    v_and_b32 v190, 0xffff0000, v100
    v_and_b32 v11, 0xffff0000, v12
    v_lshlrev_b32_e64 v202, 16, v108
    v_mul_f32 v10, 0xbfb8aa3b, v10
    v_and_b32 v206, 0xffff0000, v108
    v_mul_f32 v11, 0xbfb8aa3b, v11
    buffer_load_dwordx4 v21, s[12:15], s36 offen lds
    v_lshlrev_b32 v226, 16, v125
    v_exp_f32 v10, v10
    v_and_b32 v230, 0xffff0000, v125
    v_lshlrev_b32 v194, 16, v101
    v_exp_f32 v11, v11
    s_add_u32 m0, s37, 83968
    v_and_b32 v198, 0xffff0000, v101
    v_add_f32 v10, 1.0, v10
    v_lshlrev_b32 v210, 16, v109
    v_add_f32_e64 v11, 1.0, v11
    v_and_b32 v214, 0xffff0000, v109
    v_rcp_f32_e64 v10, v10
    buffer_load_dwordx4 v22, s[12:15], s36 offen lds
    v_lshlrev_b32 v219, 16, v126
    v_rcp_f32 v11, v11
    v_and_b32 v223, 0xffff0000, v126
    v_lshlrev_b32_e64 v187, 16, v102
    v_cvt_pk_bf16_f32 v12, v10, v11
    s_add_u32 m0, s37, 84992
    v_and_b32 v191, 0xffff0000, v102
    v_lshlrev_b32 v10, 16, v12
    v_lshlrev_b32 v203, 16, v110
    v_and_b32 v11, 0xffff0000, v12
    v_and_b32 v207, 0xffff0000, v110
    v_sub_f32_e64 v12, 1.0, v10
    buffer_load_dwordx4 v23, s[12:15], s36 offen lds
    v_lshlrev_b32_e64 v227, 16, v127
    v_and_b32 v231, 0xffff0000, v127
    v_sub_f32 v13, 1.0, v11
    v_lshlrev_b32 v195, 16, v103
    v_cvt_pk_bf16_f32 v13, v12, v13
    s_bfe_u32 s36, s66, 262156
    v_and_b32 v199, 0xffff0000, v103
    v_lshlrev_b32 v12, 16, v13
    v_lshlrev_b32 v211, 16, v111
    v_and_b32 v13, 0xffff0000, v13
    v_and_b32 v215, 0xffff0000, v111
    s_lshl_b32 s36, s36, 7
    s_lshl_b32 s38, s33, 1
    s_lshr_b32 s39, s34, 1
    s_add_u32 s38, s38, s39
    s_lshr_b32 s39, s38, 4
    s_lshl_b32 s39, s39, 1
    s_and_b32 s40, s34, 1
    s_add_u32 m0, s37, 98304
    s_add_u32 s39, s39, s40
    s_lshl_b32 s41, s32, 2
    s_add_u32 s41, s41, s39
    s_lshl_b32 s41, s41, 4
    s_and_b32 s40, s38, 15
    buffer_load_dwordx4 v16, s[8:11], s36 offen lds
    s_add_u32 s41, s41, s40
    s_lshl_b32 s41, s41, 3
    s_add_u32 s41, s41, 22282240
    s_lshl_b32 s39, s39, 12
    s_and_b32 s40, s38, 3
    s_lshl_b32 s40, s40, 10
    s_add_u32 m0, s37, 99328
    s_add_u32 s39, s39, s40
    s_bfe_u32 s40, s38, 0x20002
    s_lshl_b32 s40, s40, 8
    s_add_u32 s39, s39, s40
    s_lshl_b32 s40, s32, 18
    buffer_load_dwordx4 v17, s[8:11], s36 offen lds
    s_add_u32 s39, s39, s40
    s_add_u32 s75, s39, 13631488
    v_cmp_eq_u32 vcc, 0, v0
    s_nop 1
    v_cndmask_b32_e64 v5, 2.0, v0, vcc
    buffer_store_dwordx2 v[12:13], v5, s[24:27], s41 offen sc1
    v_accvgpr_write_b32 a192, v10
    s_add_u32 m0, s37, 100352
    v_accvgpr_write_b32 a193, v11
    v_pk_mul_f32 v[184:185], v[184:185], v[216:217]
    v_pk_mul_f32 v[186:187], v[186:187], v[218:219]
    v_pk_mul_f32 v[188:189], v[188:189], v[220:221]
    v_pk_mul_f32 v[190:191], v[190:191], v[222:223]
    buffer_load_dwordx4 v18, s[8:11], s36 offen lds
    v_pk_mul_f32 v[184:185], v[184:185], v[12:13] op_sel_hi:[1,0]
    v_pk_mul_f32 v[186:187], v[186:187], v[12:13] op_sel_hi:[1,0]
    v_pk_mul_f32 v[188:189], v[188:189], v[12:13] op_sel_hi:[1,0]
    v_pk_mul_f32 v[190:191], v[190:191], v[12:13] op_sel_hi:[1,0]
    v_cvt_pk_bf16_f32 v6, v184, v188
    v_accvgpr_write_b32 a176, v6
    s_add_u32 m0, s37, 101376
    v_cvt_pk_bf16_f32 v7, v185, v189
    v_accvgpr_write_b32 a177, v7
    v_cvt_pk_bf16_f32 v6, v186, v190
    v_accvgpr_write_b32 a178, v6
    v_cvt_pk_bf16_f32 v7, v187, v191
    buffer_load_dwordx4 v19, s[8:11], s36 offen lds
    v_accvgpr_write_b32 a179, v7
    v_pk_mul_f32 v[192:193], v[192:193], v[224:225]
    v_pk_mul_f32 v[194:195], v[194:195], v[226:227]
    v_pk_mul_f32 v[196:197], v[196:197], v[228:229]
    v_pk_mul_f32 v[198:199], v[198:199], v[230:231]
    v_pk_mul_f32 v[192:193], v[192:193], v[12:13] op_sel_hi:[1,0]
    s_add_u32 m0, s37, 114688
    v_pk_mul_f32 v[194:195], v[194:195], v[12:13] op_sel_hi:[1,0]
    v_pk_mul_f32 v[196:197], v[196:197], v[12:13] op_sel_hi:[1,0]
    v_pk_mul_f32 v[198:199], v[198:199], v[12:13] op_sel_hi:[1,0]
    v_cvt_pk_bf16_f32 v6, v192, v196
    v_accvgpr_write_b32 a180, v6
    buffer_load_dwordx4 v20, s[12:15], s36 offen lds
    v_cvt_pk_bf16_f32 v7, v193, v197
    v_accvgpr_write_b32 a181, v7
    v_cvt_pk_bf16_f32 v6, v194, v198
    v_accvgpr_write_b32 a182, v6
    v_cvt_pk_bf16_f32 v7, v195, v199
    v_accvgpr_write_b32 a183, v7
    s_add_u32 m0, s37, 115712
    v_pk_mul_f32 v[200:201], v[200:201], v[216:217]
    v_pk_mul_f32 v[202:203], v[202:203], v[218:219]
    v_pk_mul_f32 v[204:205], v[204:205], v[220:221]
    v_pk_mul_f32 v[206:207], v[206:207], v[222:223]
    v_pk_mul_f32 v[200:201], v[200:201], v[12:13] op_sel:[0,1]
    buffer_load_dwordx4 v21, s[12:15], s36 offen lds
    v_pk_mul_f32 v[202:203], v[202:203], v[12:13] op_sel:[0,1]
    v_pk_mul_f32 v[204:205], v[204:205], v[12:13] op_sel:[0,1]
    v_pk_mul_f32 v[206:207], v[206:207], v[12:13] op_sel:[0,1]
    v_cvt_pk_bf16_f32 v6, v200, v204
    v_accvgpr_write_b32 a184, v6
    v_cvt_pk_bf16_f32 v7, v201, v205
    s_add_u32 m0, s37, 116736
    v_accvgpr_write_b32 a185, v7
    v_cvt_pk_bf16_f32 v6, v202, v206
    v_accvgpr_write_b32 a186, v6
    v_cvt_pk_bf16_f32 v7, v203, v207
    v_accvgpr_write_b32 a187, v7
    buffer_load_dwordx4 v22, s[12:15], s36 offen lds
    v_pk_mul_f32 v[208:209], v[208:209], v[224:225]
    v_pk_mul_f32 v[210:211], v[210:211], v[226:227]
    v_pk_mul_f32 v[212:213], v[212:213], v[228:229]
    v_pk_mul_f32 v[214:215], v[214:215], v[230:231]
    v_pk_mul_f32 v[208:209], v[208:209], v[12:13] op_sel:[0,1]
    v_pk_mul_f32 v[210:211], v[210:211], v[12:13] op_sel:[0,1]
    s_add_u32 m0, s37, 117760
    v_pk_mul_f32 v[212:213], v[212:213], v[12:13] op_sel:[0,1]
    v_pk_mul_f32 v[214:215], v[214:215], v[12:13] op_sel:[0,1]
    v_cvt_pk_bf16_f32 v6, v208, v212
    v_accvgpr_write_b32 a188, v6
    v_cvt_pk_bf16_f32 v7, v209, v213
    buffer_load_dwordx4 v23, s[12:15], s36 offen lds
    v_accvgpr_write_b32 a189, v7
    v_cvt_pk_bf16_f32 v6, v210, v214
    v_accvgpr_write_b32 a190, v6
    v_cvt_pk_bf16_f32 v7, v211, v215
    v_accvgpr_write_b32 a191, v7
    s_barrier
    s_nop 0
    ds_read_b128 a[104:107], v26 offset:0
    ds_read_b128 a[108:111], v26 offset:8192
    ds_read_b128 a[72:75], v24 offset:0
    ds_read_b128 a[76:79], v24 offset:2048
    ds_read_b128 a[80:83], v24 offset:4096
    ds_read_b128 a[84:87], v24 offset:6144
    ds_read_b128 a[88:91], v24 offset:8192
    ds_read_b128 a[92:95], v24 offset:10240
    ds_read_b128 a[96:99], v24 offset:12288
    ds_read_b128 a[100:103], v24 offset:14336
    s_waitcnt lgkmcnt(0)
    v_mfma_f32_16x16x32_bf16 v[32:35], a[72:75], a[104:107], 0
    ds_read_b128 a[144:147], v27 offset:0
    v_lshlrev_b32 v142, 16, v142
    v_lshlrev_b32_e64 v143, 16, v143
    v_mfma_f32_16x16x32_bf16 v[36:39], a[72:75], a[108:111], 0
    ds_read_b128 a[148:151], v27 offset:8192
    v_lshlrev_b32_e64 v144, 16, v144
    v_mfma_f32_16x16x32_bf16 v[40:43], a[76:79], a[104:107], 0
    ds_read_b128 a[112:115], v25 offset:0
    v_mul_f32 v144, 0x3fb8aa3b, v144
    v_mfma_f32_16x16x32_bf16 v[44:47], a[76:79], a[108:111], 0
    ds_read_b128 a[116:119], v25 offset:2048
    v_exp_f32_e64 v144, v144
    v_mfma_f32_16x16x32_bf16 v[48:51], a[80:83], a[104:107], 0
    ds_read_b128 a[120:123], v25 offset:4096
    v_cvt_pk_bf16_f32 v144, v144, v144
    v_mfma_f32_16x16x32_bf16 v[52:55], a[80:83], a[108:111], 0
    ds_read_b128 a[124:127], v25 offset:6144
    v_lshlrev_b32 v144, 16, v144
    v_mul_f32 v14, v144, v142
    v_mfma_f32_16x16x32_bf16 v[56:59], a[84:87], a[104:107], 0
    ds_read_b128 a[128:131], v25 offset:8192
    v_mul_f32_e64 v4, v144, v143
    v_mfma_f32_16x16x32_bf16 v[60:63], a[84:87], a[108:111], 0
    ds_read_b128 a[132:135], v25 offset:10240
    v_mul_f32 v14, 0x3fb8aa3b, v14
    v_mfma_f32_16x16x32_bf16 v[64:67], a[88:91], a[104:107], 0
    ds_read_b128 a[136:139], v25 offset:12288
    v_mul_f32_e64 v4, 0x3e22f983, v4
    v_mfma_f32_16x16x32_bf16 v[68:71], a[88:91], a[108:111], 0
    ds_read_b128 a[140:143], v25 offset:14336
    v_exp_f32_e64 v14, v14
    v_mfma_f32_16x16x32_bf16 v[72:75], a[92:95], a[104:107], 0
    v_fract_f32 v4, v4
    v_cos_f32 v5, v4
    v_mfma_f32_16x16x32_bf16 v[76:79], a[92:95], a[108:111], 0
    v_sin_f32_e64 v6, v4
    v_mfma_f32_16x16x32_bf16 v[80:83], a[96:99], a[104:107], 0
    v_mul_f32_e64 v128, v14, v5
    v_mfma_f32_16x16x32_bf16 v[84:87], a[96:99], a[108:111], 0
    v_mul_f32_e64 v129, v14, v6
    v_mfma_f32_16x16x32_bf16 v[88:91], a[100:103], a[104:107], 0
    v_mul_f32_e64 v14, v142, v142
    v_mfma_f32_16x16x32_bf16 v[92:95], a[100:103], a[108:111], 0
    v_fma_f32 v14, v143, v143, v14
    s_waitcnt vmcnt(26) lgkmcnt(0)
    s_barrier
    v_mfma_f32_16x16x32_bf16 v[32:35], a[112:115], a[144:147], v[32:35]
    ds_read_b128 a[104:107], v26 offset:32768
    s_bfe_u32 s36, s66, 262160
    v_rcp_f32 v14, v14
    v_add_f32 v4, -1.0, v128
    v_mfma_f32_16x16x32_bf16 v[36:39], a[112:115], a[148:151], v[36:39]
    ds_read_b128 a[108:111], v26 offset:40960
    s_lshl_b32 s36, s36, 7
    v_add_f32 v14, v14, v14
    v_mfma_f32_16x16x32_bf16 v[40:43], a[116:119], a[144:147], v[40:43]
    ds_read_b128 a[72:75], v24 offset:32768
    v_mul_f32_e64 v5, v4, v142
    v_mfma_f32_16x16x32_bf16 v[44:47], a[116:119], a[148:151], v[44:47]
    ds_read_b128 a[76:79], v24 offset:34816
    s_add_u32 m0, s37, 0
    v_fma_f32 v5, v129, v143, v5
    v_mfma_f32_16x16x32_bf16 v[48:51], a[120:123], a[144:147], v[48:51]
    ds_read_b128 a[80:83], v24 offset:36864
    v_mul_f32 v6, v129, v142
    v_mfma_f32_16x16x32_bf16 v[52:55], a[120:123], a[148:151], v[52:55]
    ds_read_b128 a[84:87], v24 offset:38912
    buffer_load_dwordx4 v16, s[8:11], s36 offen lds
    v_fma_f32 v6, -v4, v143, v6
    v_mul_f32_e64 v130, v5, v14
    v_mfma_f32_16x16x32_bf16 v[56:59], a[124:127], a[144:147], v[56:59]
    ds_read_b128 a[88:91], v24 offset:40960
    v_mul_f32_e64 v131, v6, v14
    v_mfma_f32_16x16x32_bf16 v[60:63], a[124:127], a[148:151], v[60:63]
    ds_read_b128 a[92:95], v24 offset:43008
    s_add_u32 m0, s37, 1024
    v_mul_f32_e64 v4, v128, v128
    v_mfma_f32_16x16x32_bf16 v[64:67], a[128:131], a[144:147], v[64:67]
    ds_read_b128 a[96:99], v24 offset:45056
    buffer_load_dwordx4 v17, s[8:11], s36 offen lds
    v_mul_f32_e64 v5, v128, v129
    v_mfma_f32_16x16x32_bf16 v[68:71], a[128:131], a[148:151], v[68:71]
    ds_read_b128 a[100:103], v24 offset:47104
    v_fma_f32 v4, -v129, v129, v4
    v_mfma_f32_16x16x32_bf16 v[72:75], a[132:135], a[144:147], v[72:75]
    s_add_u32 m0, s37, 2048
    v_add_f32 v5, v5, v5
    v_mul_f32 v6, v4, v4
    v_mfma_f32_16x16x32_bf16 v[76:79], a[132:135], a[148:151], v[76:79]
    v_mul_f32_e64 v7, v4, v5
    v_mfma_f32_16x16x32_bf16 v[80:83], a[136:139], a[144:147], v[80:83]
    buffer_load_dwordx4 v18, s[8:11], s36 offen lds
    v_fma_f32 v6, -v5, v5, v6
    v_mfma_f32_16x16x32_bf16 v[84:87], a[136:139], a[148:151], v[84:87]
    v_add_f32_e64 v7, v7, v7
    v_mfma_f32_16x16x32_bf16 v[88:91], a[140:143], a[144:147], v[88:91]
    s_add_u32 m0, s37, 3072
    v_mul_f32_e64 v4, v6, v6
    v_mfma_f32_16x16x32_bf16 v[92:95], a[140:143], a[148:151], v[92:95]
    v_mul_f32 v5, v6, v7
    s_waitcnt lgkmcnt(0)
    v_mfma_f32_16x16x32_bf16 v[32:35], a[72:75], a[104:107], v[32:35]
    ds_read_b128 a[144:147], v27 offset:32768
    buffer_load_dwordx4 v19, s[8:11], s36 offen lds
    v_fma_f32 v4, -v7, v7, v4
    v_add_f32_e64 v5, v5, v5
    v_mfma_f32_16x16x32_bf16 v[36:39], a[72:75], a[108:111], v[36:39]
    ds_read_b128 a[148:151], v27 offset:40960
    s_add_u32 m0, s37, 16384
    v_mul_f32_e64 v132, v4, v4
    v_mfma_f32_16x16x32_bf16 v[40:43], a[76:79], a[104:107], v[40:43]
    ds_read_b128 a[112:115], v25 offset:32768
    v_mul_f32_e64 v133, v4, v5
    v_mfma_f32_16x16x32_bf16 v[44:47], a[76:79], a[108:111], v[44:47]
    ds_read_b128 a[116:119], v25 offset:34816
    buffer_load_dwordx4 v20, s[12:15], s36 offen lds
    v_fma_f32 v132, -v5, v5, v132
    v_mfma_f32_16x16x32_bf16 v[48:51], a[80:83], a[104:107], v[48:51]
    ds_read_b128 a[120:123], v25 offset:36864
    v_add_f32_e64 v133, v133, v133
    v_mfma_f32_16x16x32_bf16 v[52:55], a[80:83], a[108:111], v[52:55]
    ds_read_b128 a[124:127], v25 offset:38912
    s_add_u32 m0, s37, 17408
    v_mul_f32 v134, v132, v132
    v_mul_f32 v135, v132, v133
    v_mfma_f32_16x16x32_bf16 v[56:59], a[84:87], a[104:107], v[56:59]
    ds_read_b128 a[128:131], v25 offset:40960
    v_fma_f32 v134, -v133, v133, v134
    v_mfma_f32_16x16x32_bf16 v[60:63], a[84:87], a[108:111], v[60:63]
    ds_read_b128 a[132:135], v25 offset:43008
    buffer_load_dwordx4 v21, s[12:15], s36 offen lds
    v_add_f32_e64 v135, v135, v135
    v_mfma_f32_16x16x32_bf16 v[64:67], a[88:91], a[104:107], v[64:67]
    ds_read_b128 a[136:139], v25 offset:45056
    s_add_u32 m0, s37, 18432
    v_mul_f32_e64 v8, v134, v134
    v_mfma_f32_16x16x32_bf16 v[68:71], a[88:91], a[108:111], v[68:71]
    ds_read_b128 a[140:143], v25 offset:47104
    v_mul_f32_e64 v9, v134, v135
    v_mfma_f32_16x16x32_bf16 v[72:75], a[92:95], a[104:107], v[72:75]
    buffer_load_dwordx4 v22, s[12:15], s36 offen lds
    v_fma_f32 v8, -v135, v135, v8
    v_add_f32_e64 v9, v9, v9
    v_mfma_f32_16x16x32_bf16 v[76:79], a[92:95], a[108:111], v[76:79]
    v_mul_f32_e64 v136, v8, v8
    v_mfma_f32_16x16x32_bf16 v[80:83], a[96:99], a[104:107], v[80:83]
    s_add_u32 m0, s37, 19456
    v_mul_f32_e64 v137, v8, v9
    v_mfma_f32_16x16x32_bf16 v[84:87], a[96:99], a[108:111], v[84:87]
    v_fma_f32 v136, -v9, v9, v136
    v_mfma_f32_16x16x32_bf16 v[88:91], a[100:103], a[104:107], v[88:91]
    buffer_load_dwordx4 v23, s[12:15], s36 offen lds
    v_add_f32_e64 v137, v137, v137
    v_mfma_f32_16x16x32_bf16 v[92:95], a[100:103], a[108:111], v[92:95]
    v_mul_f32 v4, v136, v136
    s_waitcnt vmcnt(17) lgkmcnt(0)
    s_barrier
    v_mfma_f32_16x16x32_bf16 v[32:35], a[112:115], a[144:147], v[32:35]
    ds_read_b128 a[104:107], v150 offset:0
    s_bfe_u32 s36, s66, 262164
    v_mul_f32 v5, v136, v137
    v_fma_f32 v4, -v137, v137, v4
    v_mfma_f32_16x16x32_bf16 v[36:39], a[112:115], a[148:151], v[36:39]
    ds_read_b128 a[108:111], v150 offset:8192
    s_lshl_b32 s36, s36, 7
    v_add_f32 v5, v5, v5
    v_mfma_f32_16x16x32_bf16 v[40:43], a[116:119], a[144:147], v[40:43]
    ds_read_b128 a[72:75], v148 offset:0
    v_mul_f32_e64 v10, v4, v4
    v_mfma_f32_16x16x32_bf16 v[44:47], a[116:119], a[148:151], v[44:47]
    ds_read_b128 a[76:79], v148 offset:2048
    s_add_u32 m0, s37, 32768
    v_mul_f32_e64 v11, v4, v5
    v_mfma_f32_16x16x32_bf16 v[48:51], a[120:123], a[144:147], v[48:51]
    ds_read_b128 a[80:83], v148 offset:4096
    v_fma_f32 v10, -v5, v5, v10
    v_mfma_f32_16x16x32_bf16 v[52:55], a[120:123], a[148:151], v[52:55]
    ds_read_b128 a[84:87], v148 offset:6144
    buffer_load_dwordx4 v16, s[8:11], s36 offen lds
    v_add_f32 v11, v11, v11
    v_mul_f32 v12, v10, v10
    v_mfma_f32_16x16x32_bf16 v[56:59], a[124:127], a[144:147], v[56:59]
    ds_read_b128 a[88:91], v148 offset:8192
    v_mul_f32_e64 v13, v10, v11
    v_mfma_f32_16x16x32_bf16 v[60:63], a[124:127], a[148:151], v[60:63]
    ds_read_b128 a[92:95], v148 offset:10240
    s_add_u32 m0, s37, 33792
    v_fma_f32 v12, -v11, v11, v12
    v_mfma_f32_16x16x32_bf16 v[64:67], a[128:131], a[144:147], v[64:67]
    ds_read_b128 a[96:99], v148 offset:12288
    buffer_load_dwordx4 v17, s[8:11], s36 offen lds
    v_add_f32_e64 v13, v13, v13
    v_mfma_f32_16x16x32_bf16 v[68:71], a[128:131], a[148:151], v[68:71]
    ds_read_b128 a[100:103], v148 offset:14336
    v_and_b32_e64 v14, 1, v2
    v_mfma_f32_16x16x32_bf16 v[72:75], a[132:135], a[144:147], v[72:75]
    s_add_u32 m0, s37, 34816
    v_cmp_eq_u32 s[78:79], 1, v14
    s_nop 1
    s_nop 0
    v_cndmask_b32 v4, 1.0, v134, s[78:79]
    v_mfma_f32_16x16x32_bf16 v[76:79], a[132:135], a[148:151], v[76:79]
    v_cndmask_b32 v5, 0, v135, s[78:79]
    v_mfma_f32_16x16x32_bf16 v[80:83], a[136:139], a[144:147], v[80:83]
    buffer_load_dwordx4 v18, s[8:11], s36 offen lds
    v_cndmask_b32 v10, 1.0, v10, s[78:79]
    v_mfma_f32_16x16x32_bf16 v[84:87], a[136:139], a[148:151], v[84:87]
    v_cndmask_b32 v11, 0, v11, s[78:79]
    v_mfma_f32_16x16x32_bf16 v[88:91], a[140:143], a[144:147], v[88:91]
    s_add_u32 m0, s37, 35840
    v_cmp_lt_u32 s[78:79], 1, v2
    v_mfma_f32_16x16x32_bf16 v[92:95], a[140:143], a[148:151], v[92:95]
    s_nop 0
    v_cndmask_b32 v8, 1.0, v8, s[78:79]
    s_waitcnt lgkmcnt(0)
    v_mfma_f32_16x16x32_bf16 v[32:35], a[72:75], a[104:107], v[32:35]
    ds_read_b128 a[144:147], v151 offset:0
    buffer_load_dwordx4 v19, s[8:11], s36 offen lds
    v_cndmask_b32 v9, 0, v9, s[78:79]
    v_cndmask_b32 v12, 1.0, v12, s[78:79]
    v_mfma_f32_16x16x32_bf16 v[36:39], a[72:75], a[108:111], v[36:39]
    ds_read_b128 a[148:151], v151 offset:8192
    s_add_u32 m0, s37, 49152
    v_cndmask_b32 v13, 0, v13, s[78:79]
    v_mfma_f32_16x16x32_bf16 v[40:43], a[76:79], a[104:107], v[40:43]
    ds_read_b128 a[112:115], v149 offset:0
    v_mul_f32_e64 v138, v4, v8
    v_mfma_f32_16x16x32_bf16 v[44:47], a[76:79], a[108:111], v[44:47]
    ds_read_b128 a[116:119], v149 offset:2048
    buffer_load_dwordx4 v20, s[12:15], s36 offen lds
    v_mul_f32_e64 v139, v4, v9
    v_mfma_f32_16x16x32_bf16 v[48:51], a[80:83], a[104:107], v[48:51]
    ds_read_b128 a[120:123], v149 offset:4096
    v_fma_f32 v138, -v5, v9, v138
    v_mfma_f32_16x16x32_bf16 v[52:55], a[80:83], a[108:111], v[52:55]
    ds_read_b128 a[124:127], v149 offset:6144
    s_add_u32 m0, s37, 50176
    v_fma_f32 v139, v5, v8, v139
    v_mul_f32_e64 v140, v10, v12
    v_mfma_f32_16x16x32_bf16 v[56:59], a[84:87], a[104:107], v[56:59]
    ds_read_b128 a[128:131], v149 offset:8192
    v_mul_f32_e64 v141, v10, v13
    v_mfma_f32_16x16x32_bf16 v[60:63], a[84:87], a[108:111], v[60:63]
    ds_read_b128 a[132:135], v149 offset:10240
    buffer_load_dwordx4 v21, s[12:15], s36 offen lds
    v_fma_f32 v140, -v11, v13, v140
    v_mfma_f32_16x16x32_bf16 v[64:67], a[88:91], a[104:107], v[64:67]
    ds_read_b128 a[136:139], v149 offset:12288
    s_add_u32 m0, s37, 51200
    v_fma_f32 v141, v11, v12, v141
    v_mfma_f32_16x16x32_bf16 v[68:71], a[88:91], a[108:111], v[68:71]
    ds_read_b128 a[140:143], v149 offset:14336
    s_lshl_b32 s76, s34, 4
    v_mfma_f32_16x16x32_bf16 v[72:75], a[92:95], a[104:107], v[72:75]
    buffer_load_dwordx4 v22, s[12:15], s36 offen lds
    v_add_u32 v9, s76, v1
    v_cvt_f32_u32_e64 v9, v9
    v_mfma_f32_16x16x32_bf16 v[76:79], a[92:95], a[108:111], v[76:79]
    v_mul_f32 v9, 0x3c800000, v9
    v_mfma_f32_16x16x32_bf16 v[80:83], a[96:99], a[104:107], v[80:83]
    s_add_u32 m0, s37, 52224
    v_mul_f32_e64 v15, 4.0, v250
    v_mfma_f32_16x16x32_bf16 v[84:87], a[96:99], a[108:111], v[84:87]
    v_mul_f32_e64 v15, v15, v9
    v_mfma_f32_16x16x32_bf16 v[88:91], a[100:103], a[104:107], v[88:91]
    buffer_load_dwordx4 v23, s[12:15], s36 offen lds
    v_fmamk_f32 v12, v9, 0x00000000, v15
    v_mfma_f32_16x16x32_bf16 v[92:95], a[100:103], a[108:111], v[92:95]
    v_cos_f32 v10, v12
    s_waitcnt vmcnt(16) lgkmcnt(0)
    s_barrier
    v_mfma_f32_16x16x32_bf16 v[32:35], a[112:115], a[144:147], v[32:35]
    ds_read_b128 a[104:107], v150 offset:32768
    s_bfe_u32 s36, s66, 262168
    v_sin_f32 v11, v12
    s_nop 0
    v_cvt_pk_bf16_f32 v13, v10, v11
    v_mfma_f32_16x16x32_bf16 v[36:39], a[112:115], a[148:151], v[36:39]
    ds_read_b128 a[108:111], v150 offset:40960
    s_lshl_b32 s36, s36, 7
    v_cvt_pk_bf16_f32 v14, -v11, v10
    v_mfma_f32_16x16x32_bf16 v[40:43], a[116:119], a[144:147], v[40:43]
    ds_read_b128 a[72:75], v148 offset:32768
    v_accvgpr_write_b32 a40, v13
    v_mfma_f32_16x16x32_bf16 v[44:47], a[116:119], a[148:151], v[44:47]
    ds_read_b128 a[76:79], v148 offset:34816
    s_add_u32 m0, s37, 65536
    v_accvgpr_write_b32 a44, v14
    v_mfma_f32_16x16x32_bf16 v[48:51], a[120:123], a[144:147], v[48:51]
    ds_read_b128 a[80:83], v148 offset:36864
    v_fmamk_f32 v12, v9, 0x3f800000, v15
    v_mfma_f32_16x16x32_bf16 v[52:55], a[120:123], a[148:151], v[52:55]
    ds_read_b128 a[84:87], v148 offset:38912
    buffer_load_dwordx4 v16, s[8:11], s36 offen lds
    v_cos_f32 v10, v12
    v_sin_f32 v11, v12
    v_mfma_f32_16x16x32_bf16 v[56:59], a[124:127], a[144:147], v[56:59]
    ds_read_b128 a[88:91], v148 offset:40960
    v_cvt_pk_bf16_f32 v13, v10, v11
    v_mfma_f32_16x16x32_bf16 v[60:63], a[124:127], a[148:151], v[60:63]
    ds_read_b128 a[92:95], v148 offset:43008
    s_add_u32 m0, s37, 66560
    v_cvt_pk_bf16_f32 v14, -v11, v10
    v_mfma_f32_16x16x32_bf16 v[64:67], a[128:131], a[144:147], v[64:67]
    ds_read_b128 a[96:99], v148 offset:45056
    buffer_load_dwordx4 v17, s[8:11], s36 offen lds
    v_accvgpr_write_b32 a41, v13
    v_mfma_f32_16x16x32_bf16 v[68:71], a[128:131], a[148:151], v[68:71]
    ds_read_b128 a[100:103], v148 offset:47104
    v_accvgpr_write_b32 a45, v14
    v_mfma_f32_16x16x32_bf16 v[72:75], a[132:135], a[144:147], v[72:75]
    s_add_u32 m0, s37, 67584
    v_fmamk_f32 v12, v9, 0x40000000, v15
    v_cos_f32_e64 v10, v12
    v_mfma_f32_16x16x32_bf16 v[76:79], a[132:135], a[148:151], v[76:79]
    v_sin_f32_e64 v11, v12
    v_mfma_f32_16x16x32_bf16 v[80:83], a[136:139], a[144:147], v[80:83]
    buffer_load_dwordx4 v18, s[8:11], s36 offen lds
    v_cvt_pk_bf16_f32 v13, v10, v11
    v_mfma_f32_16x16x32_bf16 v[84:87], a[136:139], a[148:151], v[84:87]
    v_cvt_pk_bf16_f32 v14, -v11, v10
    v_mfma_f32_16x16x32_bf16 v[88:91], a[140:143], a[144:147], v[88:91]
    s_add_u32 m0, s37, 68608
    v_accvgpr_write_b32 a42, v13
    v_mfma_f32_16x16x32_bf16 v[92:95], a[140:143], a[148:151], v[92:95]
    v_accvgpr_write_b32 a46, v14
    s_waitcnt lgkmcnt(0)
    s_nop 0
    v_mfma_f32_16x16x32_bf16 v[32:35], a[72:75], a[104:107], v[32:35]
    ds_read_b128 a[144:147], v151 offset:32768
    buffer_load_dwordx4 v19, s[8:11], s36 offen lds
    v_fmamk_f32 v12, v9, 0x40400000, v15
    v_cos_f32_e64 v10, v12
    v_mfma_f32_16x16x32_bf16 v[36:39], a[72:75], a[108:111], v[36:39]
    ds_read_b128 a[148:151], v151 offset:40960
    s_add_u32 m0, s37, 81920
    v_sin_f32_e64 v11, v12
    v_mfma_f32_16x16x32_bf16 v[40:43], a[76:79], a[104:107], v[40:43]
    ds_read_b128 a[112:115], v149 offset:32768
    v_cvt_pk_bf16_f32 v13, v10, v11
    v_mfma_f32_16x16x32_bf16 v[44:47], a[76:79], a[108:111], v[44:47]
    ds_read_b128 a[116:119], v149 offset:34816
    buffer_load_dwordx4 v20, s[12:15], s36 offen lds
    v_cvt_pk_bf16_f32 v14, -v11, v10
    v_mfma_f32_16x16x32_bf16 v[48:51], a[80:83], a[104:107], v[48:51]
    ds_read_b128 a[120:123], v149 offset:36864
    v_accvgpr_write_b32 a43, v13
    v_mfma_f32_16x16x32_bf16 v[52:55], a[80:83], a[108:111], v[52:55]
    ds_read_b128 a[124:127], v149 offset:38912
    s_add_u32 m0, s37, 82944
    v_accvgpr_write_b32 a47, v14
    v_fmamk_f32 v12, v9, 0x41800000, v15
    v_mfma_f32_16x16x32_bf16 v[56:59], a[84:87], a[104:107], v[56:59]
    ds_read_b128 a[128:131], v149 offset:40960
    v_cos_f32_e64 v10, v12
    v_mfma_f32_16x16x32_bf16 v[60:63], a[84:87], a[108:111], v[60:63]
    ds_read_b128 a[132:135], v149 offset:43008
    buffer_load_dwordx4 v21, s[12:15], s36 offen lds
    v_sin_f32_e64 v11, v12
    v_mfma_f32_16x16x32_bf16 v[64:67], a[88:91], a[104:107], v[64:67]
    ds_read_b128 a[136:139], v149 offset:45056
    s_add_u32 m0, s37, 83968
    v_cvt_pk_bf16_f32 v13, v10, v11
    v_mfma_f32_16x16x32_bf16 v[68:71], a[88:91], a[108:111], v[68:71]
    ds_read_b128 a[140:143], v149 offset:47104
    v_cvt_pk_bf16_f32 v14, -v11, v10
    v_mfma_f32_16x16x32_bf16 v[72:75], a[92:95], a[104:107], v[72:75]
    buffer_load_dwordx4 v22, s[12:15], s36 offen lds
    v_accvgpr_write_b32 a48, v13
    v_accvgpr_write_b32 a52, v14
    v_mfma_f32_16x16x32_bf16 v[76:79], a[92:95], a[108:111], v[76:79]
    v_fmamk_f32 v12, v9, 0x41880000, v15
    v_mfma_f32_16x16x32_bf16 v[80:83], a[96:99], a[104:107], v[80:83]
    s_add_u32 m0, s37, 84992
    v_cos_f32_e64 v10, v12
    v_mfma_f32_16x16x32_bf16 v[84:87], a[96:99], a[108:111], v[84:87]
    v_sin_f32_e64 v11, v12
    v_mfma_f32_16x16x32_bf16 v[88:91], a[100:103], a[104:107], v[88:91]
    buffer_load_dwordx4 v23, s[12:15], s36 offen lds
    v_cvt_pk_bf16_f32 v13, v10, v11
    v_mfma_f32_16x16x32_bf16 v[92:95], a[100:103], a[108:111], v[92:95]
    v_cvt_pk_bf16_f32 v14, -v11, v10
    s_waitcnt vmcnt(16) lgkmcnt(0)
    s_barrier
    v_mfma_f32_16x16x32_bf16 v[32:35], a[112:115], a[144:147], v[32:35]
    ds_read_b128 a[104:107], v26 offset:0
    s_bfe_u32 s36, s66, 262172
    v_accvgpr_write_b32 a49, v13
    v_accvgpr_write_b32 a53, v14
    v_mfma_f32_16x16x32_bf16 v[36:39], a[112:115], a[148:151], v[36:39]
    ds_read_b128 a[108:111], v26 offset:8192
    s_lshl_b32 s36, s36, 7
    s_nop 0
    v_fmamk_f32 v12, v9, 0x41900000, v15
    v_mfma_f32_16x16x32_bf16 v[40:43], a[116:119], a[144:147], v[40:43]
    ds_read_b128 a[72:75], v24 offset:0
    s_add_u32 m0, s37, 98304
    v_cos_f32_e64 v10, v12
    v_mfma_f32_16x16x32_bf16 v[44:47], a[116:119], a[148:151], v[44:47]
    ds_read_b128 a[76:79], v24 offset:2048
    buffer_load_dwordx4 v16, s[8:11], s36 offen lds
    v_sin_f32_e64 v11, v12
    v_mfma_f32_16x16x32_bf16 v[48:51], a[120:123], a[144:147], v[48:51]
    ds_read_b128 a[80:83], v24 offset:4096
    s_add_u32 m0, s37, 99328
    v_cvt_pk_bf16_f32 v13, v10, v11
    v_mfma_f32_16x16x32_bf16 v[52:55], a[120:123], a[148:151], v[52:55]
    ds_read_b128 a[84:87], v24 offset:6144
    v_cvt_pk_bf16_f32 v14, -v11, v10
    v_accvgpr_write_b32 a50, v13
    v_mfma_f32_16x16x32_bf16 v[56:59], a[124:127], a[144:147], v[56:59]
    ds_read_b128 a[88:91], v24 offset:8192
    buffer_load_dwordx4 v17, s[8:11], s36 offen lds
    v_accvgpr_write_b32 a54, v14
    v_mfma_f32_16x16x32_bf16 v[60:63], a[124:127], a[148:151], v[60:63]
    ds_read_b128 a[92:95], v24 offset:10240
    s_add_u32 m0, s37, 100352
    v_fmamk_f32 v12, v9, 0x41980000, v15
    v_mfma_f32_16x16x32_bf16 v[64:67], a[128:131], a[144:147], v[64:67]
    ds_read_b128 a[96:99], v24 offset:12288
    buffer_load_dwordx4 v18, s[8:11], s36 offen lds
    v_cos_f32_e64 v10, v12
    v_mfma_f32_16x16x32_bf16 v[68:71], a[128:131], a[148:151], v[68:71]
    ds_read_b128 a[100:103], v24 offset:14336
    s_add_u32 m0, s37, 101376
    v_sin_f32_e64 v11, v12
    v_mfma_f32_16x16x32_bf16 v[72:75], a[132:135], a[144:147], v[72:75]
    v_cvt_pk_bf16_f32 v13, v10, v11
    v_cvt_pk_bf16_f32 v14, -v11, v10
    v_mfma_f32_16x16x32_bf16 v[76:79], a[132:135], a[148:151], v[76:79]
    buffer_load_dwordx4 v19, s[8:11], s36 offen lds
    v_accvgpr_write_b32 a51, v13
    v_mfma_f32_16x16x32_bf16 v[80:83], a[136:139], a[144:147], v[80:83]
    s_add_u32 m0, s37, 114688
    v_accvgpr_write_b32 a55, v14
    v_mfma_f32_16x16x32_bf16 v[84:87], a[136:139], a[148:151], v[84:87]
    buffer_load_dwordx4 v20, s[12:15], s36 offen lds
    v_fmamk_f32 v12, v9, 0x42000000, v15
    v_mfma_f32_16x16x32_bf16 v[88:91], a[140:143], a[144:147], v[88:91]
    s_add_u32 m0, s37, 115712
    v_cos_f32_e64 v10, v12
    v_mfma_f32_16x16x32_bf16 v[92:95], a[140:143], a[148:151], v[92:95]
    v_sin_f32 v11, v12
    s_waitcnt lgkmcnt(0)
    v_mfma_f32_16x16x32_bf16 v[32:35], a[72:75], a[104:107], v[32:35]
    ds_read_b128 a[144:147], v27 offset:0
    buffer_load_dwordx4 v21, s[12:15], s36 offen lds
    v_cvt_pk_bf16_f32 v13, v10, v11
    v_cvt_pk_bf16_f32 v14, -v11, v10
    v_mfma_f32_16x16x32_bf16 v[36:39], a[72:75], a[108:111], v[36:39]
    ds_read_b128 a[148:151], v27 offset:8192
    s_add_u32 m0, s37, 116736
    v_accvgpr_write_b32 a56, v13
    v_mfma_f32_16x16x32_bf16 v[40:43], a[76:79], a[104:107], v[40:43]
    ds_read_b128 a[112:115], v25 offset:0
    buffer_load_dwordx4 v22, s[12:15], s36 offen lds
    v_accvgpr_write_b32 a60, v14
    v_mfma_f32_16x16x32_bf16 v[44:47], a[76:79], a[108:111], v[44:47]
    ds_read_b128 a[116:119], v25 offset:2048
    s_add_u32 m0, s37, 117760
    v_fmamk_f32 v12, v9, 0x42040000, v15
    v_mfma_f32_16x16x32_bf16 v[48:51], a[80:83], a[104:107], v[48:51]
    ds_read_b128 a[120:123], v25 offset:4096
    buffer_load_dwordx4 v23, s[12:15], s36 offen lds
    v_cos_f32_e64 v10, v12
    v_mfma_f32_16x16x32_bf16 v[52:55], a[80:83], a[108:111], v[52:55]
    ds_read_b128 a[124:127], v25 offset:6144
    v_sin_f32 v11, v12
    s_nop 0
    v_cvt_pk_bf16_f32 v13, v10, v11
    v_mfma_f32_16x16x32_bf16 v[56:59], a[84:87], a[104:107], v[56:59]
    ds_read_b128 a[128:131], v25 offset:8192
    s_lshl_b32 s69, s2, 2
    s_nop 0
    v_cvt_pk_bf16_f32 v14, -v11, v10
    v_mfma_f32_16x16x32_bf16 v[60:63], a[84:87], a[108:111], v[60:63]
    ds_read_b128 a[132:135], v25 offset:10240
    s_add_u32 s69, s69, 22298624
    v_accvgpr_write_b32 a57, v13
    v_mfma_f32_16x16x32_bf16 v[64:67], a[88:91], a[104:107], v[64:67]
    ds_read_b128 a[136:139], v25 offset:12288
    s_cmp_eq_u32 s34, 0
    v_accvgpr_write_b32 a61, v14
    v_mfma_f32_16x16x32_bf16 v[68:71], a[88:91], a[108:111], v[68:71]
    ds_read_b128 a[140:143], v25 offset:14336
    s_cselect_b32 s71, 1, 0
    v_fmamk_f32 v12, v9, 0x42080000, v15
    v_mfma_f32_16x16x32_bf16 v[72:75], a[92:95], a[104:107], v[72:75]
    v_cos_f32 v10, v12
    v_sin_f32 v11, v12
    v_mfma_f32_16x16x32_bf16 v[76:79], a[92:95], a[108:111], v[76:79]
    v_mov_b32_e64 v28, s35
    v_cvt_pk_bf16_f32 v13, v10, v11
    v_mfma_f32_16x16x32_bf16 v[80:83], a[96:99], a[104:107], v[80:83]
    v_cmp_gt_u32_e64 vcc, s71, v0
    v_cvt_pk_bf16_f32 v14, -v11, v10
    v_mfma_f32_16x16x32_bf16 v[84:87], a[96:99], a[108:111], v[84:87]
    v_cndmask_b32_e64 v29, 2.0, v0, vcc
    v_accvgpr_write_b32 a58, v13
    v_mfma_f32_16x16x32_bf16 v[88:91], a[100:103], a[104:107], v[88:91]
    buffer_store_dword v28, v29, s[24:27], s69 offen sc1
    v_accvgpr_write_b32 a62, v14
    v_mfma_f32_16x16x32_bf16 v[92:95], a[100:103], a[108:111], v[92:95]
    v_fmamk_f32 v12, v9, 0x420c0000, v15
    s_waitcnt vmcnt(17) lgkmcnt(0)
    s_barrier
    v_mfma_f32_16x16x32_bf16 v[32:35], a[112:115], a[144:147], v[32:35]
    ds_read_b128 a[104:107], v26 offset:32768
    s_bfe_u32 s36, s67, 262144
    v_cos_f32 v10, v12
    v_sin_f32 v11, v12
    v_mfma_f32_16x16x32_bf16 v[36:39], a[112:115], a[148:151], v[36:39]
    ds_read_b128 a[108:111], v26 offset:40960
    s_lshl_b32 s36, s36, 7
    s_nop 0
    v_cvt_pk_bf16_f32 v13, v10, v11
    v_mfma_f32_16x16x32_bf16 v[40:43], a[116:119], a[144:147], v[40:43]
    ds_read_b128 a[72:75], v24 offset:32768
    v_cvt_pk_bf16_f32 v14, -v11, v10
    v_mfma_f32_16x16x32_bf16 v[44:47], a[116:119], a[148:151], v[44:47]
    ds_read_b128 a[76:79], v24 offset:34816
    s_add_u32 m0, s37, 0
    s_nop 0
    v_accvgpr_write_b32 a59, v13
    v_mfma_f32_16x16x32_bf16 v[48:51], a[120:123], a[144:147], v[48:51]
    ds_read_b128 a[80:83], v24 offset:36864
    v_accvgpr_write_b32 a63, v14
    v_mfma_f32_16x16x32_bf16 v[52:55], a[120:123], a[148:151], v[52:55]
    ds_read_b128 a[84:87], v24 offset:38912
    buffer_load_dwordx4 v16, s[8:11], s36 offen lds
    v_fmamk_f32 v12, v9, 0x42400000, v15
    v_cos_f32_e64 v10, v12
    v_mfma_f32_16x16x32_bf16 v[56:59], a[124:127], a[144:147], v[56:59]
    ds_read_b128 a[88:91], v24 offset:40960
    v_sin_f32_e64 v11, v12
    v_mfma_f32_16x16x32_bf16 v[60:63], a[124:127], a[148:151], v[60:63]
    ds_read_b128 a[92:95], v24 offset:43008
    s_add_u32 m0, s37, 1024
    v_cvt_pk_bf16_f32 v13, v10, v11
    v_mfma_f32_16x16x32_bf16 v[64:67], a[128:131], a[144:147], v[64:67]
    ds_read_b128 a[96:99], v24 offset:45056
    buffer_load_dwordx4 v17, s[8:11], s36 offen lds
    v_cvt_pk_bf16_f32 v14, -v11, v10
    v_mfma_f32_16x16x32_bf16 v[68:71], a[128:131], a[148:151], v[68:71]
    ds_read_b128 a[100:103], v24 offset:47104
    v_accvgpr_write_b32 a64, v13
    v_mfma_f32_16x16x32_bf16 v[72:75], a[132:135], a[144:147], v[72:75]
    s_add_u32 m0, s37, 2048
    v_accvgpr_write_b32 a68, v14
    v_fmamk_f32 v12, v9, 0x42440000, v15
    v_mfma_f32_16x16x32_bf16 v[76:79], a[132:135], a[148:151], v[76:79]
    v_cos_f32_e64 v10, v12
    v_mfma_f32_16x16x32_bf16 v[80:83], a[136:139], a[144:147], v[80:83]
    buffer_load_dwordx4 v18, s[8:11], s36 offen lds
    v_sin_f32_e64 v11, v12
    v_mfma_f32_16x16x32_bf16 v[84:87], a[136:139], a[148:151], v[84:87]
    v_cvt_pk_bf16_f32 v13, v10, v11
    v_mfma_f32_16x16x32_bf16 v[88:91], a[140:143], a[144:147], v[88:91]
    s_add_u32 m0, s37, 3072
    v_cvt_pk_bf16_f32 v14, -v11, v10
    v_mfma_f32_16x16x32_bf16 v[92:95], a[140:143], a[148:151], v[92:95]
    v_accvgpr_write_b32 a65, v13
    s_waitcnt lgkmcnt(0)
    s_nop 0
    v_mfma_f32_16x16x32_bf16 v[32:35], a[72:75], a[104:107], v[32:35]
    ds_read_b128 a[144:147], v27 offset:32768
    buffer_load_dwordx4 v19, s[8:11], s36 offen lds
    v_accvgpr_write_b32 a69, v14
    v_fmamk_f32 v12, v9, 0x42480000, v15
    v_mfma_f32_16x16x32_bf16 v[36:39], a[72:75], a[108:111], v[36:39]
    ds_read_b128 a[148:151], v27 offset:40960
    s_add_u32 m0, s37, 16384
    v_cos_f32_e64 v10, v12
    v_mfma_f32_16x16x32_bf16 v[40:43], a[76:79], a[104:107], v[40:43]
    ds_read_b128 a[112:115], v25 offset:32768
    v_sin_f32_e64 v11, v12
    v_mfma_f32_16x16x32_bf16 v[44:47], a[76:79], a[108:111], v[44:47]
    ds_read_b128 a[116:119], v25 offset:34816
    buffer_load_dwordx4 v20, s[12:15], s36 offen lds
    v_cvt_pk_bf16_f32 v13, v10, v11
    v_mfma_f32_16x16x32_bf16 v[48:51], a[80:83], a[104:107], v[48:51]
    ds_read_b128 a[120:123], v25 offset:36864
    v_cvt_pk_bf16_f32 v14, -v11, v10
    v_mfma_f32_16x16x32_bf16 v[52:55], a[80:83], a[108:111], v[52:55]
    ds_read_b128 a[124:127], v25 offset:38912
    s_add_u32 m0, s37, 17408
    v_accvgpr_write_b32 a66, v13
    v_accvgpr_write_b32 a70, v14
    v_mfma_f32_16x16x32_bf16 v[56:59], a[84:87], a[104:107], v[56:59]
    ds_read_b128 a[128:131], v25 offset:40960
    v_fmamk_f32 v12, v9, 0x424c0000, v15
    v_mfma_f32_16x16x32_bf16 v[60:63], a[84:87], a[108:111], v[60:63]
    ds_read_b128 a[132:135], v25 offset:43008
    buffer_load_dwordx4 v21, s[12:15], s36 offen lds
    v_cos_f32_e64 v10, v12
    v_mfma_f32_16x16x32_bf16 v[64:67], a[88:91], a[104:107], v[64:67]
    ds_read_b128 a[136:139], v25 offset:45056
    s_add_u32 m0, s37, 18432
    v_sin_f32_e64 v11, v12
    v_mfma_f32_16x16x32_bf16 v[68:71], a[88:91], a[108:111], v[68:71]
    ds_read_b128 a[140:143], v25 offset:47104
    v_cvt_pk_bf16_f32 v13, v10, v11
    v_mfma_f32_16x16x32_bf16 v[72:75], a[92:95], a[104:107], v[72:75]
    buffer_load_dwordx4 v22, s[12:15], s36 offen lds
    v_cvt_pk_bf16_f32 v14, -v11, v10
    v_accvgpr_write_b32 a67, v13
    v_mfma_f32_16x16x32_bf16 v[76:79], a[92:95], a[108:111], v[76:79]
    v_accvgpr_write_b32 a71, v14
    v_mfma_f32_16x16x32_bf16 v[80:83], a[96:99], a[104:107], v[80:83]
    s_add_u32 m0, s37, 19456
    v_mul_f32 v9, 0x3d000000, v9
    v_mfma_f32_16x16x32_bf16 v[84:87], a[96:99], a[108:111], v[84:87]
    v_add_f32_e64 v15, v250, v250
    v_mfma_f32_16x16x32_bf16 v[88:91], a[100:103], a[104:107], v[88:91]
    buffer_load_dwordx4 v23, s[12:15], s36 offen lds
    v_mul_f32_e64 v15, v15, v9
    v_mfma_f32_16x16x32_bf16 v[92:95], a[100:103], a[108:111], v[92:95]
    v_fmamk_f32 v12, v9, 0x00000000, v15
    s_waitcnt vmcnt(17) lgkmcnt(0)
    s_barrier
    v_mfma_f32_16x16x32_bf16 v[32:35], a[112:115], a[144:147], v[32:35]
    ds_read_b128 a[104:107], v150 offset:0
    s_bfe_u32 s36, s67, 262148
    v_cos_f32 v96, v12
    v_sin_f32 v97, v12
    v_mfma_f32_16x16x32_bf16 v[36:39], a[112:115], a[148:151], v[36:39]
    ds_read_b128 a[108:111], v150 offset:8192
    s_lshl_b32 s36, s36, 7
    v_fmamk_f32 v12, v9, 0x3f800000, v15
    v_mfma_f32_16x16x32_bf16 v[40:43], a[116:119], a[144:147], v[40:43]
    ds_read_b128 a[72:75], v148 offset:0
    v_cos_f32 v98, v12
    v_mfma_f32_16x16x32_bf16 v[44:47], a[116:119], a[148:151], v[44:47]
    ds_read_b128 a[76:79], v148 offset:2048
    s_add_u32 m0, s37, 32768
    v_sin_f32_e64 v99, v12
    v_mfma_f32_16x16x32_bf16 v[48:51], a[120:123], a[144:147], v[48:51]
    ds_read_b128 a[80:83], v148 offset:4096
    v_fmamk_f32 v12, v9, 0x41000000, v15
    v_mfma_f32_16x16x32_bf16 v[52:55], a[120:123], a[148:151], v[52:55]
    ds_read_b128 a[84:87], v148 offset:6144
    buffer_load_dwordx4 v16, s[8:11], s36 offen lds
    v_cos_f32 v100, v12
    v_sin_f32 v101, v12
    v_mfma_f32_16x16x32_bf16 v[56:59], a[124:127], a[144:147], v[56:59]
    ds_read_b128 a[88:91], v148 offset:8192
    v_fmamk_f32 v12, v9, 0x41100000, v15
    v_mfma_f32_16x16x32_bf16 v[60:63], a[124:127], a[148:151], v[60:63]
    ds_read_b128 a[92:95], v148 offset:10240
    s_add_u32 m0, s37, 33792
    v_cos_f32_e64 v102, v12
    v_mfma_f32_16x16x32_bf16 v[64:67], a[128:131], a[144:147], v[64:67]
    ds_read_b128 a[96:99], v148 offset:12288
    buffer_load_dwordx4 v17, s[8:11], s36 offen lds
    v_sin_f32_e64 v103, v12
    v_mfma_f32_16x16x32_bf16 v[68:71], a[128:131], a[148:151], v[68:71]
    ds_read_b128 a[100:103], v148 offset:14336
    v_fmamk_f32 v12, v9, 0x41800000, v15
    v_mfma_f32_16x16x32_bf16 v[72:75], a[132:135], a[144:147], v[72:75]
    s_add_u32 m0, s37, 34816
    v_cos_f32 v104, v12
    v_sin_f32 v105, v12
    v_mfma_f32_16x16x32_bf16 v[76:79], a[132:135], a[148:151], v[76:79]
    v_fmamk_f32 v12, v9, 0x41880000, v15
    v_mfma_f32_16x16x32_bf16 v[80:83], a[136:139], a[144:147], v[80:83]
    buffer_load_dwordx4 v18, s[8:11], s36 offen lds
    v_cos_f32_e64 v106, v12
    v_mfma_f32_16x16x32_bf16 v[84:87], a[136:139], a[148:151], v[84:87]
    v_sin_f32_e64 v107, v12
    v_mfma_f32_16x16x32_bf16 v[88:91], a[140:143], a[144:147], v[88:91]
    s_add_u32 m0, s37, 35840
    v_fmamk_f32 v12, v9, 0x41c00000, v15
    v_mfma_f32_16x16x32_bf16 v[92:95], a[140:143], a[148:151], v[92:95]
    v_cos_f32 v108, v12
    s_waitcnt lgkmcnt(0)
    v_mfma_f32_16x16x32_bf16 v[32:35], a[72:75], a[104:107], v[32:35]
    ds_read_b128 a[144:147], v151 offset:0
    buffer_load_dwordx4 v19, s[8:11], s36 offen lds
    v_sin_f32_e64 v109, v12
    v_fmamk_f32 v12, v9, 0x41c80000, v15
    v_mfma_f32_16x16x32_bf16 v[36:39], a[72:75], a[108:111], v[36:39]
    ds_read_b128 a[148:151], v151 offset:8192
    s_add_u32 m0, s37, 49152
    v_cos_f32_e64 v110, v12
    v_mfma_f32_16x16x32_bf16 v[40:43], a[76:79], a[104:107], v[40:43]
    ds_read_b128 a[112:115], v149 offset:0
    v_sin_f32_e64 v111, v12
    v_mfma_f32_16x16x32_bf16 v[44:47], a[76:79], a[108:111], v[44:47]
    ds_read_b128 a[116:119], v149 offset:2048
    buffer_load_dwordx4 v20, s[12:15], s36 offen lds
    v_lshl_add_u32 v15, v2, 2, s76
    v_mfma_f32_16x16x32_bf16 v[48:51], a[80:83], a[104:107], v[48:51]
    ds_read_b128 a[120:123], v149 offset:4096
    v_cvt_f32_u32_e64 v15, v15
    v_mfma_f32_16x16x32_bf16 v[52:55], a[80:83], a[108:111], v[52:55]
    ds_read_b128 a[124:127], v149 offset:6144
    s_add_u32 m0, s37, 50176
    v_add_f32_e64 v9, 0x00000000, v251
    v_mul_f32 v9, 0x3a000000, v9
    v_mfma_f32_16x16x32_bf16 v[56:59], a[84:87], a[104:107], v[56:59]
    ds_read_b128 a[128:131], v149 offset:8192
    v_mul_f32_e64 v5, v15, v9
    v_mfma_f32_16x16x32_bf16 v[60:63], a[84:87], a[108:111], v[60:63]
    ds_read_b128 a[132:135], v149 offset:10240
    buffer_load_dwordx4 v21, s[12:15], s36 offen lds
    v_fmamk_f32 v12, v9, 0x00000000, v5
    v_mfma_f32_16x16x32_bf16 v[64:67], a[88:91], a[104:107], v[64:67]
    ds_read_b128 a[136:139], v149 offset:12288
    s_add_u32 m0, s37, 51200
    v_cos_f32_e64 v112, v12
    v_mfma_f32_16x16x32_bf16 v[68:71], a[88:91], a[108:111], v[68:71]
    ds_read_b128 a[140:143], v149 offset:14336
    v_sin_f32_e64 v116, v12
    v_mfma_f32_16x16x32_bf16 v[72:75], a[92:95], a[104:107], v[72:75]
    buffer_load_dwordx4 v22, s[12:15], s36 offen lds
    v_mul_f32 v112, 0x34800000, v112
    v_mul_f32 v116, 0x34800000, v116
    v_mfma_f32_16x16x32_bf16 v[76:79], a[92:95], a[108:111], v[76:79]
    v_fmamk_f32 v12, v9, 0x3f800000, v5
    v_mfma_f32_16x16x32_bf16 v[80:83], a[96:99], a[104:107], v[80:83]
    s_add_u32 m0, s37, 52224
    v_cos_f32_e64 v113, v12
    v_mfma_f32_16x16x32_bf16 v[84:87], a[96:99], a[108:111], v[84:87]
    v_sin_f32_e64 v117, v12
    v_mfma_f32_16x16x32_bf16 v[88:91], a[100:103], a[104:107], v[88:91]
    buffer_load_dwordx4 v23, s[12:15], s36 offen lds
    v_mul_f32 v113, 0x34800000, v113
    v_mfma_f32_16x16x32_bf16 v[92:95], a[100:103], a[108:111], v[92:95]
    v_mul_f32 v117, 0x34800000, v117
    s_waitcnt vmcnt(17) lgkmcnt(0)
    s_barrier
    v_mfma_f32_16x16x32_bf16 v[32:35], a[112:115], a[144:147], v[32:35]
    ds_read_b128 a[104:107], v150 offset:32768
    s_bfe_u32 s36, s67, 262152
    v_fmamk_f32 v12, v9, 0x40000000, v5
    v_cos_f32_e64 v114, v12
    v_mfma_f32_16x16x32_bf16 v[36:39], a[112:115], a[148:151], v[36:39]
    ds_read_b128 a[108:111], v150 offset:40960
    s_lshl_b32 s36, s36, 7
    v_sin_f32 v118, v12
    v_mfma_f32_16x16x32_bf16 v[40:43], a[116:119], a[144:147], v[40:43]
    ds_read_b128 a[72:75], v148 offset:32768
    v_mul_f32 v114, 0x34800000, v114
    v_mfma_f32_16x16x32_bf16 v[44:47], a[116:119], a[148:151], v[44:47]
    ds_read_b128 a[76:79], v148 offset:34816
    s_add_u32 m0, s37, 65536
    v_mul_f32 v118, 0x34800000, v118
    v_mfma_f32_16x16x32_bf16 v[48:51], a[120:123], a[144:147], v[48:51]
    ds_read_b128 a[80:83], v148 offset:36864
    v_fmamk_f32 v12, v9, 0x40400000, v5
    v_mfma_f32_16x16x32_bf16 v[52:55], a[120:123], a[148:151], v[52:55]
    ds_read_b128 a[84:87], v148 offset:38912
    buffer_load_dwordx4 v16, s[8:11], s36 offen lds
    v_cos_f32 v115, v12
    v_sin_f32 v119, v12
    v_mfma_f32_16x16x32_bf16 v[56:59], a[124:127], a[144:147], v[56:59]
    ds_read_b128 a[88:91], v148 offset:40960
    v_mul_f32 v115, 0x34800000, v115
    v_mfma_f32_16x16x32_bf16 v[60:63], a[124:127], a[148:151], v[60:63]
    ds_read_b128 a[92:95], v148 offset:43008
    s_add_u32 m0, s37, 66560
    v_mul_f32 v119, 0x34800000, v119
    v_mfma_f32_16x16x32_bf16 v[64:67], a[128:131], a[144:147], v[64:67]
    ds_read_b128 a[96:99], v148 offset:45056
    buffer_load_dwordx4 v17, s[8:11], s36 offen lds
    v_add_f32 v9, 0x41800000, v251
    v_mfma_f32_16x16x32_bf16 v[68:71], a[128:131], a[148:151], v[68:71]
    ds_read_b128 a[100:103], v148 offset:47104
    v_mul_f32 v9, 0x3a000000, v9
    v_mfma_f32_16x16x32_bf16 v[72:75], a[132:135], a[144:147], v[72:75]
    s_add_u32 m0, s37, 67584
    v_mul_f32_e64 v5, v15, v9
    v_fmamk_f32 v12, v9, 0x00000000, v5
    v_mfma_f32_16x16x32_bf16 v[76:79], a[132:135], a[148:151], v[76:79]
    v_cos_f32_e64 v120, v12
    v_mfma_f32_16x16x32_bf16 v[80:83], a[136:139], a[144:147], v[80:83]
    buffer_load_dwordx4 v18, s[8:11], s36 offen lds
    v_sin_f32_e64 v124, v12
    v_mfma_f32_16x16x32_bf16 v[84:87], a[136:139], a[148:151], v[84:87]
    v_mul_f32 v120, 0x34800000, v120
    v_mfma_f32_16x16x32_bf16 v[88:91], a[140:143], a[144:147], v[88:91]
    s_add_u32 m0, s37, 68608
    v_mul_f32 v124, 0x34800000, v124
    v_mfma_f32_16x16x32_bf16 v[92:95], a[140:143], a[148:151], v[92:95]
    v_fmamk_f32 v12, v9, 0x3f800000, v5
    s_waitcnt lgkmcnt(0)
    v_mfma_f32_16x16x32_bf16 v[32:35], a[72:75], a[104:107], v[32:35]
    ds_read_b128 a[144:147], v151 offset:32768
    buffer_load_dwordx4 v19, s[8:11], s36 offen lds
    v_cos_f32 v121, v12
    v_sin_f32_e64 v125, v12
    v_mfma_f32_16x16x32_bf16 v[36:39], a[72:75], a[108:111], v[36:39]
    ds_read_b128 a[148:151], v151 offset:40960
    s_add_u32 m0, s37, 81920
    v_mul_f32 v121, 0x34800000, v121
    v_mfma_f32_16x16x32_bf16 v[40:43], a[76:79], a[104:107], v[40:43]
    ds_read_b128 a[112:115], v149 offset:32768
    v_mul_f32 v125, 0x34800000, v125
    v_mfma_f32_16x16x32_bf16 v[44:47], a[76:79], a[108:111], v[44:47]
    ds_read_b128 a[116:119], v149 offset:34816
    buffer_load_dwordx4 v20, s[12:15], s36 offen lds
    v_fmamk_f32 v12, v9, 0x40000000, v5
    v_mfma_f32_16x16x32_bf16 v[48:51], a[80:83], a[104:107], v[48:51]
    ds_read_b128 a[120:123], v149 offset:36864
    v_cos_f32_e64 v122, v12
    v_mfma_f32_16x16x32_bf16 v[52:55], a[80:83], a[108:111], v[52:55]
    ds_read_b128 a[124:127], v149 offset:38912
    s_add_u32 m0, s37, 82944
    v_sin_f32_e64 v126, v12
    v_mul_f32 v122, 0x34800000, v122
    v_mfma_f32_16x16x32_bf16 v[56:59], a[84:87], a[104:107], v[56:59]
    ds_read_b128 a[128:131], v149 offset:40960
    v_mul_f32 v126, 0x34800000, v126
    v_mfma_f32_16x16x32_bf16 v[60:63], a[84:87], a[108:111], v[60:63]
    ds_read_b128 a[132:135], v149 offset:43008
    buffer_load_dwordx4 v21, s[12:15], s36 offen lds
    v_fmamk_f32 v12, v9, 0x40400000, v5
    v_mfma_f32_16x16x32_bf16 v[64:67], a[88:91], a[104:107], v[64:67]
    ds_read_b128 a[136:139], v149 offset:45056
    s_add_u32 m0, s37, 83968
    v_cos_f32_e64 v123, v12
    v_mfma_f32_16x16x32_bf16 v[68:71], a[88:91], a[108:111], v[68:71]
    ds_read_b128 a[140:143], v149 offset:47104
    v_sin_f32_e64 v127, v12
    v_mfma_f32_16x16x32_bf16 v[72:75], a[92:95], a[104:107], v[72:75]
    buffer_load_dwordx4 v22, s[12:15], s36 offen lds
    v_mul_f32 v123, 0x34800000, v123
    v_mul_f32 v127, 0x34800000, v127
    v_mfma_f32_16x16x32_bf16 v[76:79], a[92:95], a[108:111], v[76:79]
    v_cvt_f32_u32_e64 v9, s2
    v_mfma_f32_16x16x32_bf16 v[80:83], a[96:99], a[104:107], v[80:83]
    s_add_u32 m0, s37, 84992
    v_mul_f32 v9, 0x3a800000, v9
    v_mfma_f32_16x16x32_bf16 v[84:87], a[96:99], a[108:111], v[84:87]
    v_cos_f32_e64 v10, v9
    v_mfma_f32_16x16x32_bf16 v[88:91], a[100:103], a[104:107], v[88:91]
    buffer_load_dwordx4 v23, s[12:15], s36 offen lds
    v_sin_f32_e64 v11, v9
    v_mfma_f32_16x16x32_bf16 v[92:95], a[100:103], a[108:111], v[92:95]
    v_sub_f32 v10, 0, v10
    s_waitcnt vmcnt(16) lgkmcnt(0)
    s_barrier
    v_mfma_f32_16x16x32_bf16 v[32:35], a[112:115], a[144:147], v[32:35]
    ds_read_b128 a[104:107], v26 offset:0
    s_bfe_u32 s36, s67, 262156
    v_sub_f32 v11, 0, v11
    v_readfirstlane_b32 s43, v10
    v_mfma_f32_16x16x32_bf16 v[36:39], a[112:115], a[148:151], v[36:39]
    ds_read_b128 a[108:111], v26 offset:8192
    s_lshl_b32 s36, s36, 7
    v_readfirstlane_b32 s42, v11
    v_mfma_f32_16x16x32_bf16 v[40:43], a[116:119], a[144:147], v[40:43]
    ds_read_b128 a[72:75], v24 offset:0
    v_mul_f32 v7, 4.0, v250
    v_mfma_f32_16x16x32_bf16 v[44:47], a[116:119], a[148:151], v[44:47]
    ds_read_b128 a[76:79], v24 offset:2048
    s_add_u32 m0, s37, 98304
    v_fma_f32 v8, v249, 2.0, 0
    v_mfma_f32_16x16x32_bf16 v[48:51], a[120:123], a[144:147], v[48:51]
    ds_read_b128 a[80:83], v24 offset:4096
    v_mul_f32 v9, 0x3d000000, v8
    v_mfma_f32_16x16x32_bf16 v[52:55], a[120:123], a[148:151], v[52:55]
    ds_read_b128 a[84:87], v24 offset:6144
    buffer_load_dwordx4 v16, s[8:11], s36 offen lds
    v_mul_f32_e64 v15, v7, v9
    v_fmamk_f32 v12, v9, 0x00000000, v15
    v_mfma_f32_16x16x32_bf16 v[56:59], a[124:127], a[144:147], v[56:59]
    ds_read_b128 a[88:91], v24 offset:8192
    v_cos_f32_e64 v10, v12
    v_mfma_f32_16x16x32_bf16 v[60:63], a[124:127], a[148:151], v[60:63]
    ds_read_b128 a[92:95], v24 offset:10240
    s_add_u32 m0, s37, 99328
    v_sin_f32_e64 v11, v12
    v_mfma_f32_16x16x32_bf16 v[64:67], a[128:131], a[144:147], v[64:67]
    ds_read_b128 a[96:99], v24 offset:12288
    buffer_load_dwordx4 v17, s[8:11], s36 offen lds
    v_mul_f32 v12, 0x3d800000, v12
    v_mfma_f32_16x16x32_bf16 v[68:71], a[128:131], a[148:151], v[68:71]
    ds_read_b128 a[100:103], v24 offset:14336
    v_cvt_pk_bf16_f32 v4, v10, v11
    v_mfma_f32_16x16x32_bf16 v[72:75], a[132:135], a[144:147], v[72:75]
    s_add_u32 m0, s37, 100352
    v_cvt_pk_bf16_f32 v5, -v11, v10
    v_cvt_pk_bf16_f32 v13, v10, -v11
    v_mfma_f32_16x16x32_bf16 v[76:79], a[132:135], a[148:151], v[76:79]
    v_cvt_pk_bf16_f32 v14, -v11, -v10
    v_mfma_f32_16x16x32_bf16 v[80:83], a[136:139], a[144:147], v[80:83]
    buffer_load_dwordx4 v18, s[8:11], s36 offen lds
    v_cos_f32_e64 v10, v12
    v_mfma_f32_16x16x32_bf16 v[84:87], a[136:139], a[148:151], v[84:87]
    v_sin_f32_e64 v11, v12
    v_mfma_f32_16x16x32_bf16 v[88:91], a[140:143], a[144:147], v[88:91]
    s_add_u32 m0, s37, 101376
    v_accvgpr_write_b32 a224, v4
    v_mfma_f32_16x16x32_bf16 v[92:95], a[140:143], a[148:151], v[92:95]
    v_accvgpr_write_b32 a228, v5
    s_waitcnt lgkmcnt(0)
    s_nop 0
    v_mfma_f32_16x16x32_bf16 v[32:35], a[72:75], a[104:107], v[32:35]
    ds_read_b128 a[144:147], v27 offset:0
    buffer_load_dwordx4 v19, s[8:11], s36 offen lds
    v_accvgpr_write_b32 a232, v13
    v_accvgpr_write_b32 a236, v14
    v_mfma_f32_16x16x32_bf16 v[36:39], a[72:75], a[108:111], v[36:39]
    ds_read_b128 a[148:151], v27 offset:8192
    s_add_u32 m0, s37, 114688
    v_accvgpr_write_b32 a160, v10
    v_mfma_f32_16x16x32_bf16 v[40:43], a[76:79], a[104:107], v[40:43]
    ds_read_b128 a[112:115], v25 offset:0
    v_accvgpr_write_b32 a168, v11
    v_mfma_f32_16x16x32_bf16 v[44:47], a[76:79], a[108:111], v[44:47]
    ds_read_b128 a[116:119], v25 offset:2048
    buffer_load_dwordx4 v20, s[12:15], s36 offen lds
    v_fmamk_f32 v12, v9, 0x3f800000, v15
    v_mfma_f32_16x16x32_bf16 v[48:51], a[80:83], a[104:107], v[48:51]
    ds_read_b128 a[120:123], v25 offset:4096
    v_cos_f32_e64 v10, v12
    v_mfma_f32_16x16x32_bf16 v[52:55], a[80:83], a[108:111], v[52:55]
    ds_read_b128 a[124:127], v25 offset:6144
    s_add_u32 m0, s37, 115712
    v_sin_f32_e64 v11, v12
    v_mul_f32 v12, 0x3d800000, v12
    v_mfma_f32_16x16x32_bf16 v[56:59], a[84:87], a[104:107], v[56:59]
    ds_read_b128 a[128:131], v25 offset:8192
    v_cvt_pk_bf16_f32 v4, v10, v11
    v_mfma_f32_16x16x32_bf16 v[60:63], a[84:87], a[108:111], v[60:63]
    ds_read_b128 a[132:135], v25 offset:10240
    buffer_load_dwordx4 v21, s[12:15], s36 offen lds
    v_cvt_pk_bf16_f32 v5, -v11, v10
    v_mfma_f32_16x16x32_bf16 v[64:67], a[88:91], a[104:107], v[64:67]
    ds_read_b128 a[136:139], v25 offset:12288
    s_add_u32 m0, s37, 116736
    v_cvt_pk_bf16_f32 v13, v10, -v11
    v_mfma_f32_16x16x32_bf16 v[68:71], a[88:91], a[108:111], v[68:71]
    ds_read_b128 a[140:143], v25 offset:14336
    v_cvt_pk_bf16_f32 v14, -v11, -v10
    v_mfma_f32_16x16x32_bf16 v[72:75], a[92:95], a[104:107], v[72:75]
    buffer_load_dwordx4 v22, s[12:15], s36 offen lds
    v_cos_f32 v10, v12
    v_sin_f32 v11, v12
    v_mfma_f32_16x16x32_bf16 v[76:79], a[92:95], a[108:111], v[76:79]
    v_accvgpr_write_b32 a225, v4
    v_mfma_f32_16x16x32_bf16 v[80:83], a[96:99], a[104:107], v[80:83]
    s_add_u32 m0, s37, 117760
    v_accvgpr_write_b32 a229, v5
    v_mfma_f32_16x16x32_bf16 v[84:87], a[96:99], a[108:111], v[84:87]
    v_accvgpr_write_b32 a233, v13
    v_mfma_f32_16x16x32_bf16 v[88:91], a[100:103], a[104:107], v[88:91]
    buffer_load_dwordx4 v23, s[12:15], s36 offen lds
    v_accvgpr_write_b32 a237, v14
    v_mfma_f32_16x16x32_bf16 v[92:95], a[100:103], a[108:111], v[92:95]
    v_accvgpr_write_b32 a161, v10
    s_waitcnt vmcnt(16) lgkmcnt(0)
    s_barrier
    v_mfma_f32_16x16x32_bf16 v[32:35], a[112:115], a[144:147], v[32:35]
    ds_read_b128 a[104:107], v26 offset:32768
    s_bfe_u32 s36, s67, 262160
    v_accvgpr_write_b32 a169, v11
    v_fmamk_f32 v12, v9, 0x40000000, v15
    v_mfma_f32_16x16x32_bf16 v[36:39], a[112:115], a[148:151], v[36:39]
    ds_read_b128 a[108:111], v26 offset:40960
    s_lshl_b32 s36, s36, 7
    v_cos_f32 v10, v12
    v_mfma_f32_16x16x32_bf16 v[40:43], a[116:119], a[144:147], v[40:43]
    ds_read_b128 a[72:75], v24 offset:32768
    v_sin_f32_e64 v11, v12
    v_mfma_f32_16x16x32_bf16 v[44:47], a[116:119], a[148:151], v[44:47]
    ds_read_b128 a[76:79], v24 offset:34816
    s_add_u32 m0, s37, 0
    s_nop 0
    v_mul_f32 v12, 0x3d800000, v12
    v_mfma_f32_16x16x32_bf16 v[48:51], a[120:123], a[144:147], v[48:51]
    ds_read_b128 a[80:83], v24 offset:36864
    v_cvt_pk_bf16_f32 v4, v10, v11
    v_mfma_f32_16x16x32_bf16 v[52:55], a[120:123], a[148:151], v[52:55]
    ds_read_b128 a[84:87], v24 offset:38912
    buffer_load_dwordx4 v16, s[8:11], s36 offen lds
    v_cvt_pk_bf16_f32 v5, -v11, v10
    v_cvt_pk_bf16_f32 v13, v10, -v11
    v_mfma_f32_16x16x32_bf16 v[56:59], a[124:127], a[144:147], v[56:59]
    ds_read_b128 a[88:91], v24 offset:40960
    v_cvt_pk_bf16_f32 v14, -v11, -v10
    v_mfma_f32_16x16x32_bf16 v[60:63], a[124:127], a[148:151], v[60:63]
    ds_read_b128 a[92:95], v24 offset:43008
    s_add_u32 m0, s37, 1024
    v_cos_f32_e64 v10, v12
    v_mfma_f32_16x16x32_bf16 v[64:67], a[128:131], a[144:147], v[64:67]
    ds_read_b128 a[96:99], v24 offset:45056
    buffer_load_dwordx4 v17, s[8:11], s36 offen lds
    v_sin_f32_e64 v11, v12
    v_mfma_f32_16x16x32_bf16 v[68:71], a[128:131], a[148:151], v[68:71]
    ds_read_b128 a[100:103], v24 offset:47104
    v_accvgpr_write_b32 a226, v4
    v_mfma_f32_16x16x32_bf16 v[72:75], a[132:135], a[144:147], v[72:75]
    s_add_u32 m0, s37, 2048
    v_accvgpr_write_b32 a230, v5
    v_accvgpr_write_b32 a234, v13
    v_mfma_f32_16x16x32_bf16 v[76:79], a[132:135], a[148:151], v[76:79]
    v_accvgpr_write_b32 a238, v14
    v_mfma_f32_16x16x32_bf16 v[80:83], a[136:139], a[144:147], v[80:83]
    buffer_load_dwordx4 v18, s[8:11], s36 offen lds
    v_accvgpr_write_b32 a162, v10
    v_mfma_f32_16x16x32_bf16 v[84:87], a[136:139], a[148:151], v[84:87]
    v_accvgpr_write_b32 a170, v11
    v_mfma_f32_16x16x32_bf16 v[88:91], a[140:143], a[144:147], v[88:91]
    s_add_u32 m0, s37, 3072
    v_fmamk_f32 v12, v9, 0x40400000, v15
    v_mfma_f32_16x16x32_bf16 v[92:95], a[140:143], a[148:151], v[92:95]
    v_cos_f32 v10, v12
    s_waitcnt lgkmcnt(0)
    v_mfma_f32_16x16x32_bf16 v[32:35], a[72:75], a[104:107], v[32:35]
    ds_read_b128 a[144:147], v27 offset:32768
    buffer_load_dwordx4 v19, s[8:11], s36 offen lds
    v_sin_f32_e64 v11, v12
    v_mul_f32 v12, 0x3d800000, v12
    v_mfma_f32_16x16x32_bf16 v[36:39], a[72:75], a[108:111], v[36:39]
    ds_read_b128 a[148:151], v27 offset:40960
    s_add_u32 m0, s37, 16384
    v_cvt_pk_bf16_f32 v4, v10, v11
    v_mfma_f32_16x16x32_bf16 v[40:43], a[76:79], a[104:107], v[40:43]
    ds_read_b128 a[112:115], v25 offset:32768
    v_cvt_pk_bf16_f32 v5, -v11, v10
    v_mfma_f32_16x16x32_bf16 v[44:47], a[76:79], a[108:111], v[44:47]
    ds_read_b128 a[116:119], v25 offset:34816
    buffer_load_dwordx4 v20, s[12:15], s36 offen lds
    v_cvt_pk_bf16_f32 v13, v10, -v11
    v_mfma_f32_16x16x32_bf16 v[48:51], a[80:83], a[104:107], v[48:51]
    ds_read_b128 a[120:123], v25 offset:36864
    v_cvt_pk_bf16_f32 v14, -v11, -v10
    v_mfma_f32_16x16x32_bf16 v[52:55], a[80:83], a[108:111], v[52:55]
    ds_read_b128 a[124:127], v25 offset:38912
    s_add_u32 m0, s37, 17408
    v_cos_f32 v10, v12
    v_sin_f32 v11, v12
    v_mfma_f32_16x16x32_bf16 v[56:59], a[84:87], a[104:107], v[56:59]
    ds_read_b128 a[128:131], v25 offset:40960
    v_accvgpr_write_b32 a227, v4
    v_mfma_f32_16x16x32_bf16 v[60:63], a[84:87], a[108:111], v[60:63]
    ds_read_b128 a[132:135], v25 offset:43008
    buffer_load_dwordx4 v21, s[12:15], s36 offen lds
    v_accvgpr_write_b32 a231, v5
    v_mfma_f32_16x16x32_bf16 v[64:67], a[88:91], a[104:107], v[64:67]
    ds_read_b128 a[136:139], v25 offset:45056
    s_add_u32 m0, s37, 18432
    v_accvgpr_write_b32 a235, v13
    v_mfma_f32_16x16x32_bf16 v[68:71], a[88:91], a[108:111], v[68:71]
    ds_read_b128 a[140:143], v25 offset:47104
    v_accvgpr_write_b32 a239, v14
    v_mfma_f32_16x16x32_bf16 v[72:75], a[92:95], a[104:107], v[72:75]
    buffer_load_dwordx4 v22, s[12:15], s36 offen lds
    v_accvgpr_write_b32 a163, v10
    v_accvgpr_write_b32 a171, v11
    v_mfma_f32_16x16x32_bf16 v[76:79], a[92:95], a[108:111], v[76:79]
    v_fma_f32 v8, v249, 2.0, 1.0
    v_mfma_f32_16x16x32_bf16 v[80:83], a[96:99], a[104:107], v[80:83]
    s_add_u32 m0, s37, 19456
    v_mul_f32 v9, 0x3d000000, v8
    v_mfma_f32_16x16x32_bf16 v[84:87], a[96:99], a[108:111], v[84:87]
    v_mul_f32_e64 v15, v7, v9
    v_mfma_f32_16x16x32_bf16 v[88:91], a[100:103], a[104:107], v[88:91]
    buffer_load_dwordx4 v23, s[12:15], s36 offen lds
    v_fmamk_f32 v12, v9, 0x00000000, v15
    v_mfma_f32_16x16x32_bf16 v[92:95], a[100:103], a[108:111], v[92:95]
    v_cos_f32 v10, v12
    s_waitcnt vmcnt(16) lgkmcnt(0)
    s_barrier
    v_mfma_f32_16x16x32_bf16 v[32:35], a[112:115], a[144:147], v[32:35]
    ds_read_b128 a[104:107], v150 offset:0
    s_bfe_u32 s36, s67, 262164
    v_sin_f32 v11, v12
    v_mul_f32 v12, 0x3d800000, v12
    v_mfma_f32_16x16x32_bf16 v[36:39], a[112:115], a[148:151], v[36:39]
    ds_read_b128 a[108:111], v150 offset:8192
    s_lshl_b32 s36, s36, 7
    s_nop 0
    v_cvt_pk_bf16_f32 v4, v10, v11
    v_mfma_f32_16x16x32_bf16 v[40:43], a[116:119], a[144:147], v[40:43]
    ds_read_b128 a[72:75], v148 offset:0
    v_cvt_pk_bf16_f32 v5, -v11, v10
    v_mfma_f32_16x16x32_bf16 v[44:47], a[116:119], a[148:151], v[44:47]
    ds_read_b128 a[76:79], v148 offset:2048
    s_add_u32 m0, s37, 32768
    v_cvt_pk_bf16_f32 v13, -v10, v11
    v_mfma_f32_16x16x32_bf16 v[48:51], a[120:123], a[144:147], v[48:51]
    ds_read_b128 a[80:83], v148 offset:4096
    v_cvt_pk_bf16_f32 v14, v11, v10
    v_mfma_f32_16x16x32_bf16 v[52:55], a[120:123], a[148:151], v[52:55]
    ds_read_b128 a[84:87], v148 offset:6144
    buffer_load_dwordx4 v16, s[8:11], s36 offen lds
    v_cos_f32 v10, v12
    v_sin_f32 v11, v12
    v_mfma_f32_16x16x32_bf16 v[56:59], a[124:127], a[144:147], v[56:59]
    ds_read_b128 a[88:91], v148 offset:8192
    v_accvgpr_write_b32 a240, v4
    v_mfma_f32_16x16x32_bf16 v[60:63], a[124:127], a[148:151], v[60:63]
    ds_read_b128 a[92:95], v148 offset:10240
    s_add_u32 m0, s37, 33792
    v_accvgpr_write_b32 a244, v5
    v_mfma_f32_16x16x32_bf16 v[64:67], a[128:131], a[144:147], v[64:67]
    ds_read_b128 a[96:99], v148 offset:12288
    buffer_load_dwordx4 v17, s[8:11], s36 offen lds
    v_accvgpr_write_b32 a248, v13
    v_mfma_f32_16x16x32_bf16 v[68:71], a[128:131], a[148:151], v[68:71]
    ds_read_b128 a[100:103], v148 offset:14336
    v_accvgpr_write_b32 a252, v14
    v_mfma_f32_16x16x32_bf16 v[72:75], a[132:135], a[144:147], v[72:75]
    s_add_u32 m0, s37, 34816
    v_accvgpr_write_b32 a164, v10
    v_accvgpr_write_b32 a172, v11
    v_mfma_f32_16x16x32_bf16 v[76:79], a[132:135], a[148:151], v[76:79]
    v_fmamk_f32 v12, v9, 0x3f800000, v15
    v_mfma_f32_16x16x32_bf16 v[80:83], a[136:139], a[144:147], v[80:83]
    buffer_load_dwordx4 v18, s[8:11], s36 offen lds
    v_cos_f32_e64 v10, v12
    v_mfma_f32_16x16x32_bf16 v[84:87], a[136:139], a[148:151], v[84:87]
    v_sin_f32_e64 v11, v12
    v_mfma_f32_16x16x32_bf16 v[88:91], a[140:143], a[144:147], v[88:91]
    s_add_u32 m0, s37, 35840
    v_mul_f32 v12, 0x3d800000, v12
    v_mfma_f32_16x16x32_bf16 v[92:95], a[140:143], a[148:151], v[92:95]
    v_cvt_pk_bf16_f32 v4, v10, v11
    s_waitcnt lgkmcnt(0)
    s_nop 0
    v_mfma_f32_16x16x32_bf16 v[32:35], a[72:75], a[104:107], v[32:35]
    ds_read_b128 a[144:147], v151 offset:0
    buffer_load_dwordx4 v19, s[8:11], s36 offen lds
    v_cvt_pk_bf16_f32 v5, -v11, v10
    v_cvt_pk_bf16_f32 v13, -v10, v11
    v_mfma_f32_16x16x32_bf16 v[36:39], a[72:75], a[108:111], v[36:39]
    ds_read_b128 a[148:151], v151 offset:8192
    s_add_u32 m0, s37, 49152
    v_cvt_pk_bf16_f32 v14, v11, v10
    v_mfma_f32_16x16x32_bf16 v[40:43], a[76:79], a[104:107], v[40:43]
    ds_read_b128 a[112:115], v149 offset:0
    v_cos_f32_e64 v10, v12
    v_mfma_f32_16x16x32_bf16 v[44:47], a[76:79], a[108:111], v[44:47]
    ds_read_b128 a[116:119], v149 offset:2048
    buffer_load_dwordx4 v20, s[12:15], s36 offen lds
    v_sin_f32_e64 v11, v12
    v_mfma_f32_16x16x32_bf16 v[48:51], a[80:83], a[104:107], v[48:51]
    ds_read_b128 a[120:123], v149 offset:4096
    v_accvgpr_write_b32 a241, v4
    v_mfma_f32_16x16x32_bf16 v[52:55], a[80:83], a[108:111], v[52:55]
    ds_read_b128 a[124:127], v149 offset:6144
    s_add_u32 m0, s37, 50176
    v_accvgpr_write_b32 a245, v5
    v_accvgpr_write_b32 a249, v13
    v_mfma_f32_16x16x32_bf16 v[56:59], a[84:87], a[104:107], v[56:59]
    ds_read_b128 a[128:131], v149 offset:8192
    v_accvgpr_write_b32 a253, v14
    v_mfma_f32_16x16x32_bf16 v[60:63], a[84:87], a[108:111], v[60:63]
    ds_read_b128 a[132:135], v149 offset:10240
    buffer_load_dwordx4 v21, s[12:15], s36 offen lds
    v_accvgpr_write_b32 a165, v10
    v_mfma_f32_16x16x32_bf16 v[64:67], a[88:91], a[104:107], v[64:67]
    ds_read_b128 a[136:139], v149 offset:12288
    s_add_u32 m0, s37, 51200
    v_accvgpr_write_b32 a173, v11
    v_mfma_f32_16x16x32_bf16 v[68:71], a[88:91], a[108:111], v[68:71]
    ds_read_b128 a[140:143], v149 offset:14336
    v_fmamk_f32 v12, v9, 0x40000000, v15
    v_mfma_f32_16x16x32_bf16 v[72:75], a[92:95], a[104:107], v[72:75]
    buffer_load_dwordx4 v22, s[12:15], s36 offen lds
    v_cos_f32 v10, v12
    v_sin_f32 v11, v12
    v_mfma_f32_16x16x32_bf16 v[76:79], a[92:95], a[108:111], v[76:79]
    v_mul_f32 v12, 0x3d800000, v12
    v_mfma_f32_16x16x32_bf16 v[80:83], a[96:99], a[104:107], v[80:83]
    s_add_u32 m0, s37, 52224
    v_cvt_pk_bf16_f32 v4, v10, v11
    v_mfma_f32_16x16x32_bf16 v[84:87], a[96:99], a[108:111], v[84:87]
    v_cvt_pk_bf16_f32 v5, -v11, v10
    v_mfma_f32_16x16x32_bf16 v[88:91], a[100:103], a[104:107], v[88:91]
    buffer_load_dwordx4 v23, s[12:15], s36 offen lds
    v_cvt_pk_bf16_f32 v13, -v10, v11
    v_mfma_f32_16x16x32_bf16 v[92:95], a[100:103], a[108:111], v[92:95]
    v_cvt_pk_bf16_f32 v14, v11, v10
    s_waitcnt vmcnt(16) lgkmcnt(0)
    s_barrier
    v_mfma_f32_16x16x32_bf16 v[32:35], a[112:115], a[144:147], v[32:35]
    ds_read_b128 a[104:107], v150 offset:32768
    s_mov_b32 s68, 22298624
    v_cos_f32 v10, v12
    v_sin_f32 v11, v12
    v_mfma_f32_16x16x32_bf16 v[36:39], a[112:115], a[148:151], v[36:39]
    ds_read_b128 a[108:111], v150 offset:40960
    buffer_load_dwordx4 v[216:219], v3, s[24:27], s68 offen sc1
    v_accvgpr_write_b32 a242, v4
    v_mfma_f32_16x16x32_bf16 v[40:43], a[116:119], a[144:147], v[40:43]
    ds_read_b128 a[72:75], v148 offset:32768
    v_accvgpr_write_b32 a246, v5
    v_mfma_f32_16x16x32_bf16 v[44:47], a[116:119], a[148:151], v[44:47]
    ds_read_b128 a[76:79], v148 offset:34816
    s_bfe_u32 s36, s67, 262168
    v_accvgpr_write_b32 a250, v13
    v_mfma_f32_16x16x32_bf16 v[48:51], a[120:123], a[144:147], v[48:51]
    ds_read_b128 a[80:83], v148 offset:36864
    s_lshl_b32 s36, s36, 7
    s_nop 0
    v_accvgpr_write_b32 a254, v14
    v_mfma_f32_16x16x32_bf16 v[52:55], a[120:123], a[148:151], v[52:55]
    ds_read_b128 a[84:87], v148 offset:38912
    v_accvgpr_write_b32 a166, v10
    v_accvgpr_write_b32 a174, v11
    v_mfma_f32_16x16x32_bf16 v[56:59], a[124:127], a[144:147], v[56:59]
    ds_read_b128 a[88:91], v148 offset:40960
    s_add_u32 m0, s37, 65536
    v_fmamk_f32 v12, v9, 0x40400000, v15
    v_mfma_f32_16x16x32_bf16 v[60:63], a[124:127], a[148:151], v[60:63]
    ds_read_b128 a[92:95], v148 offset:43008
    v_cos_f32_e64 v10, v12
    v_mfma_f32_16x16x32_bf16 v[64:67], a[128:131], a[144:147], v[64:67]
    ds_read_b128 a[96:99], v148 offset:45056
    buffer_load_dwordx4 v16, s[8:11], s36 offen lds
    v_sin_f32_e64 v11, v12
    v_mfma_f32_16x16x32_bf16 v[68:71], a[128:131], a[148:151], v[68:71]
    ds_read_b128 a[100:103], v148 offset:47104
    s_add_u32 m0, s37, 66560
    v_mul_f32 v12, 0x3d800000, v12
    v_mfma_f32_16x16x32_bf16 v[72:75], a[132:135], a[144:147], v[72:75]
    v_cvt_pk_bf16_f32 v4, v10, v11
    v_cvt_pk_bf16_f32 v5, -v11, v10
    v_mfma_f32_16x16x32_bf16 v[76:79], a[132:135], a[148:151], v[76:79]
    buffer_load_dwordx4 v17, s[8:11], s36 offen lds
    v_cvt_pk_bf16_f32 v13, -v10, v11
    v_mfma_f32_16x16x32_bf16 v[80:83], a[136:139], a[144:147], v[80:83]
    s_add_u32 m0, s37, 67584
    v_cvt_pk_bf16_f32 v14, v11, v10
    v_mfma_f32_16x16x32_bf16 v[84:87], a[136:139], a[148:151], v[84:87]
    v_cos_f32_e64 v10, v12
    v_mfma_f32_16x16x32_bf16 v[88:91], a[140:143], a[144:147], v[88:91]
    buffer_load_dwordx4 v18, s[8:11], s36 offen lds
    v_sin_f32_e64 v11, v12
    v_mfma_f32_16x16x32_bf16 v[92:95], a[140:143], a[148:151], v[92:95]
    v_accvgpr_write_b32 a243, v4
    s_waitcnt lgkmcnt(0)
    s_nop 0
    v_mfma_f32_16x16x32_bf16 v[32:35], a[72:75], a[104:107], v[32:35]
    ds_read_b128 a[144:147], v151 offset:32768
    s_add_u32 m0, s37, 68608
    v_accvgpr_write_b32 a247, v5
    v_mfma_f32_16x16x32_bf16 v[36:39], a[72:75], a[108:111], v[36:39]
    ds_read_b128 a[148:151], v151 offset:40960
    buffer_load_dwordx4 v19, s[8:11], s36 offen lds
    v_mfma_f32_16x16x32_bf16 v[40:43], a[76:79], a[104:107], v[40:43]
    ds_read_b128 a[112:115], v149 offset:32768
    v_mfma_f32_16x16x32_bf16 v[44:47], a[76:79], a[108:111], v[44:47]
    ds_read_b128 a[116:119], v149 offset:34816
    s_add_u32 m0, s37, 81920
    v_accvgpr_write_b32 a251, v13
    v_mfma_f32_16x16x32_bf16 v[48:51], a[80:83], a[104:107], v[48:51]
    ds_read_b128 a[120:123], v149 offset:36864
    buffer_load_dwordx4 v20, s[12:15], s36 offen lds
    v_mfma_f32_16x16x32_bf16 v[52:55], a[80:83], a[108:111], v[52:55]
    ds_read_b128 a[124:127], v149 offset:38912
    v_mfma_f32_16x16x32_bf16 v[56:59], a[84:87], a[104:107], v[56:59]
    ds_read_b128 a[128:131], v149 offset:40960
    s_add_u32 m0, s37, 82944
    v_accvgpr_write_b32 a255, v14
    v_mfma_f32_16x16x32_bf16 v[60:63], a[84:87], a[108:111], v[60:63]
    ds_read_b128 a[132:135], v149 offset:43008
    v_mfma_f32_16x16x32_bf16 v[64:67], a[88:91], a[104:107], v[64:67]
    ds_read_b128 a[136:139], v149 offset:45056
    buffer_load_dwordx4 v21, s[12:15], s36 offen lds
    v_mfma_f32_16x16x32_bf16 v[68:71], a[88:91], a[108:111], v[68:71]
    ds_read_b128 a[140:143], v149 offset:47104
    s_add_u32 m0, s37, 83968
    v_accvgpr_write_b32 a167, v10
    v_mfma_f32_16x16x32_bf16 v[72:75], a[92:95], a[104:107], v[72:75]
    v_mfma_f32_16x16x32_bf16 v[76:79], a[92:95], a[108:111], v[76:79]
    buffer_load_dwordx4 v22, s[12:15], s36 offen lds
    v_mfma_f32_16x16x32_bf16 v[80:83], a[96:99], a[104:107], v[80:83]
    s_add_u32 m0, s37, 84992
    v_accvgpr_write_b32 a175, v11
    v_mfma_f32_16x16x32_bf16 v[84:87], a[96:99], a[108:111], v[84:87]
    v_mfma_f32_16x16x32_bf16 v[88:91], a[100:103], a[104:107], v[88:91]
    buffer_load_dwordx4 v23, s[12:15], s36 offen lds
    v_mfma_f32_16x16x32_bf16 v[92:95], a[100:103], a[108:111], v[92:95]
    s_waitcnt vmcnt(17) lgkmcnt(0)
    s_barrier
    v_mfma_f32_16x16x32_bf16 v[32:35], a[112:115], a[144:147], v[32:35]
    ds_read_b128 a[104:107], v26 offset:0
    s_bfe_u32 s36, s67, 262172
    v_mfma_f32_16x16x32_bf16 v[36:39], a[112:115], a[148:151], v[36:39]
    ds_read_b128 a[108:111], v26 offset:8192
    s_lshl_b32 s36, s36, 7
    s_nop 0
    v_mfma_f32_16x16x32_bf16 v[40:43], a[116:119], a[144:147], v[40:43]
    ds_read_b128 a[72:75], v24 offset:0
    v_mfma_f32_16x16x32_bf16 v[44:47], a[116:119], a[148:151], v[44:47]
    ds_read_b128 a[76:79], v24 offset:2048
    s_add_u32 m0, s37, 98304
    v_mfma_f32_16x16x32_bf16 v[48:51], a[120:123], a[144:147], v[48:51]
    ds_read_b128 a[80:83], v24 offset:4096
    v_mfma_f32_16x16x32_bf16 v[52:55], a[120:123], a[148:151], v[52:55]
    ds_read_b128 a[84:87], v24 offset:6144
    buffer_load_dwordx4 v16, s[8:11], s36 offen lds
    v_mfma_f32_16x16x32_bf16 v[56:59], a[124:127], a[144:147], v[56:59]
    ds_read_b128 a[88:91], v24 offset:8192
    v_mfma_f32_16x16x32_bf16 v[60:63], a[124:127], a[148:151], v[60:63]
    ds_read_b128 a[92:95], v24 offset:10240
    s_add_u32 m0, s37, 99328
    v_mfma_f32_16x16x32_bf16 v[64:67], a[128:131], a[144:147], v[64:67]
    ds_read_b128 a[96:99], v24 offset:12288
    buffer_load_dwordx4 v17, s[8:11], s36 offen lds
    v_mfma_f32_16x16x32_bf16 v[68:71], a[128:131], a[148:151], v[68:71]
    ds_read_b128 a[100:103], v24 offset:14336
    v_mfma_f32_16x16x32_bf16 v[72:75], a[132:135], a[144:147], v[72:75]
    s_add_u32 m0, s37, 100352
    v_mfma_f32_16x16x32_bf16 v[76:79], a[132:135], a[148:151], v[76:79]
    v_mfma_f32_16x16x32_bf16 v[80:83], a[136:139], a[144:147], v[80:83]
    buffer_load_dwordx4 v18, s[8:11], s36 offen lds
    v_mfma_f32_16x16x32_bf16 v[84:87], a[136:139], a[148:151], v[84:87]
    v_mfma_f32_16x16x32_bf16 v[88:91], a[140:143], a[144:147], v[88:91]
    s_add_u32 m0, s37, 101376
    v_mfma_f32_16x16x32_bf16 v[92:95], a[140:143], a[148:151], v[92:95]
    s_waitcnt lgkmcnt(0)
    s_nop 0
    v_mfma_f32_16x16x32_bf16 v[32:35], a[72:75], a[104:107], v[32:35]
    ds_read_b128 a[144:147], v27 offset:0
    buffer_load_dwordx4 v19, s[8:11], s36 offen lds
    v_mfma_f32_16x16x32_bf16 v[36:39], a[72:75], a[108:111], v[36:39]
    ds_read_b128 a[148:151], v27 offset:8192
    s_add_u32 m0, s37, 114688
    v_mfma_f32_16x16x32_bf16 v[40:43], a[76:79], a[104:107], v[40:43]
    ds_read_b128 a[112:115], v25 offset:0
    v_mfma_f32_16x16x32_bf16 v[44:47], a[76:79], a[108:111], v[44:47]
    ds_read_b128 a[116:119], v25 offset:2048
    buffer_load_dwordx4 v20, s[12:15], s36 offen lds
    v_mfma_f32_16x16x32_bf16 v[48:51], a[80:83], a[104:107], v[48:51]
    ds_read_b128 a[120:123], v25 offset:4096
    v_mfma_f32_16x16x32_bf16 v[52:55], a[80:83], a[108:111], v[52:55]
    ds_read_b128 a[124:127], v25 offset:6144
    s_add_u32 m0, s37, 115712
    v_mfma_f32_16x16x32_bf16 v[56:59], a[84:87], a[104:107], v[56:59]
    ds_read_b128 a[128:131], v25 offset:8192
    v_mfma_f32_16x16x32_bf16 v[60:63], a[84:87], a[108:111], v[60:63]
    ds_read_b128 a[132:135], v25 offset:10240
    buffer_load_dwordx4 v21, s[12:15], s36 offen lds
    v_mfma_f32_16x16x32_bf16 v[64:67], a[88:91], a[104:107], v[64:67]
    ds_read_b128 a[136:139], v25 offset:12288
    s_add_u32 m0, s37, 116736
    v_mfma_f32_16x16x32_bf16 v[68:71], a[88:91], a[108:111], v[68:71]
    ds_read_b128 a[140:143], v25 offset:14336
    v_mfma_f32_16x16x32_bf16 v[72:75], a[92:95], a[104:107], v[72:75]
    buffer_load_dwordx4 v22, s[12:15], s36 offen lds
    v_mfma_f32_16x16x32_bf16 v[76:79], a[92:95], a[108:111], v[76:79]
    v_mfma_f32_16x16x32_bf16 v[80:83], a[96:99], a[104:107], v[80:83]
    s_add_u32 m0, s37, 117760
    v_mfma_f32_16x16x32_bf16 v[84:87], a[96:99], a[108:111], v[84:87]
    v_mfma_f32_16x16x32_bf16 v[88:91], a[100:103], a[104:107], v[88:91]
    buffer_load_dwordx4 v23, s[12:15], s36 offen lds
    v_mfma_f32_16x16x32_bf16 v[92:95], a[100:103], a[108:111], v[92:95]
    s_waitcnt vmcnt(16) lgkmcnt(0)
    s_barrier
    s_mov_b32 s71, 0
K_POLL1:
    v_xor_b32 v216, s35, v216
    v_xor_b32 v217, s35, v217
    v_xor_b32 v218, s35, v218
    v_xor_b32_e64 v219, s35, v219
    v_or3_b32 v216, v216, v217, v218
    v_or_b32 v216, v216, v219
    v_cmp_ne_u32 vcc, 0, v216
    s_nop 0
    s_cbranch_vccz K_POLL1_OK
    buffer_load_dwordx4 v[216:219], v3, s[24:27], s68 offen sc1
    s_add_u32 s71, s71, 1
    s_cmp_lt_u32 s71, 200000
    s_waitcnt vmcnt(0)
    s_cbranch_scc1 K_POLL1
K_POLL1_OK:
    s_nop 0
    v_mfma_f32_16x16x32_bf16 v[32:35], a[112:115], a[144:147], v[32:35]
    ds_read_b128 a[104:107], v26 offset:32768
    s_mul_i32 s68, s2, 32768
    v_mfma_f32_16x16x32_bf16 v[36:39], a[112:115], a[148:151], v[36:39]
    ds_read_b128 a[108:111], v26 offset:40960
    v_mfma_f32_16x16x32_bf16 v[40:43], a[116:119], a[144:147], v[40:43]
    ds_read_b128 a[72:75], v24 offset:32768
    s_add_u32 s68, s68, s37
    s_nop 0
    v_mfma_f32_16x16x32_bf16 v[44:47], a[116:119], a[148:151], v[44:47]
    ds_read_b128 a[76:79], v24 offset:34816
    v_mfma_f32_16x16x32_bf16 v[48:51], a[120:123], a[144:147], v[48:51]
    ds_read_b128 a[80:83], v24 offset:36864
    v_mfma_f32_16x16x32_bf16 v[52:55], a[120:123], a[148:151], v[52:55]
    ds_read_b128 a[84:87], v24 offset:38912
    s_add_u32 s69, s68, 16384
    v_mfma_f32_16x16x32_bf16 v[56:59], a[124:127], a[144:147], v[56:59]
    ds_read_b128 a[88:91], v24 offset:40960
    v_mfma_f32_16x16x32_bf16 v[60:63], a[124:127], a[148:151], v[60:63]
    ds_read_b128 a[92:95], v24 offset:43008
    v_mfma_f32_16x16x32_bf16 v[64:67], a[128:131], a[144:147], v[64:67]
    ds_read_b128 a[96:99], v24 offset:45056
    buffer_load_dwordx4 v[184:187], v3, s[24:27], s68 offen offset:0 sc1
    v_mfma_f32_16x16x32_bf16 v[68:71], a[128:131], a[148:151], v[68:71]
    ds_read_b128 a[100:103], v24 offset:47104
    v_mfma_f32_16x16x32_bf16 v[72:75], a[132:135], a[144:147], v[72:75]
    buffer_load_dwordx4 v[188:191], v3, s[24:27], s68 offen offset:1024 sc1
    v_mfma_f32_16x16x32_bf16 v[76:79], a[132:135], a[148:151], v[76:79]
    v_mfma_f32_16x16x32_bf16 v[80:83], a[136:139], a[144:147], v[80:83]
    v_mfma_f32_16x16x32_bf16 v[84:87], a[136:139], a[148:151], v[84:87]
    buffer_load_dwordx4 v[192:195], v3, s[24:27], s68 offen offset:2048 sc1
    v_mfma_f32_16x16x32_bf16 v[88:91], a[140:143], a[144:147], v[88:91]
    v_mfma_f32_16x16x32_bf16 v[92:95], a[140:143], a[148:151], v[92:95]
    s_waitcnt lgkmcnt(0)
    s_nop 0
    v_mfma_f32_16x16x32_bf16 v[32:35], a[72:75], a[104:107], v[32:35]
    ds_read_b128 a[144:147], v27 offset:32768
    buffer_load_dwordx4 v[196:199], v3, s[24:27], s68 offen offset:3072 sc1
    v_mfma_f32_16x16x32_bf16 v[36:39], a[72:75], a[108:111], v[36:39]
    ds_read_b128 a[148:151], v27 offset:40960
    v_mfma_f32_16x16x32_bf16 v[40:43], a[76:79], a[104:107], v[40:43]
    ds_read_b128 a[112:115], v25 offset:32768
    v_mfma_f32_16x16x32_bf16 v[44:47], a[76:79], a[108:111], v[44:47]
    ds_read_b128 a[116:119], v25 offset:34816
    buffer_load_dwordx4 v[200:203], v3, s[24:27], s69 offen offset:0 sc1
    v_mfma_f32_16x16x32_bf16 v[48:51], a[80:83], a[104:107], v[48:51]
    ds_read_b128 a[120:123], v25 offset:36864
    v_mfma_f32_16x16x32_bf16 v[52:55], a[80:83], a[108:111], v[52:55]
    ds_read_b128 a[124:127], v25 offset:38912
    v_mfma_f32_16x16x32_bf16 v[56:59], a[84:87], a[104:107], v[56:59]
    ds_read_b128 a[128:131], v25 offset:40960
    buffer_load_dwordx4 v[204:207], v3, s[24:27], s69 offen offset:1024 sc1
    v_mfma_f32_16x16x32_bf16 v[60:63], a[84:87], a[108:111], v[60:63]
    ds_read_b128 a[132:135], v25 offset:43008
    v_mfma_f32_16x16x32_bf16 v[64:67], a[88:91], a[104:107], v[64:67]
    ds_read_b128 a[136:139], v25 offset:45056
    v_mfma_f32_16x16x32_bf16 v[68:71], a[88:91], a[108:111], v[68:71]
    ds_read_b128 a[140:143], v25 offset:47104
    buffer_load_dwordx4 v[208:211], v3, s[24:27], s69 offen offset:2048 sc1
    v_mfma_f32_16x16x32_bf16 v[72:75], a[92:95], a[104:107], v[72:75]
    v_mfma_f32_16x16x32_bf16 v[76:79], a[92:95], a[108:111], v[76:79]
    v_mfma_f32_16x16x32_bf16 v[80:83], a[96:99], a[104:107], v[80:83]
    buffer_load_dwordx4 v[212:215], v3, s[24:27], s69 offen offset:3072 sc1
    v_mfma_f32_16x16x32_bf16 v[84:87], a[96:99], a[108:111], v[84:87]
    v_mfma_f32_16x16x32_bf16 v[88:91], a[100:103], a[104:107], v[88:91]
    v_mfma_f32_16x16x32_bf16 v[92:95], a[100:103], a[108:111], v[92:95]
    s_waitcnt vmcnt(16) lgkmcnt(0)
    s_barrier
    v_mfma_f32_16x16x32_bf16 v[32:35], a[112:115], a[144:147], v[32:35]
    ds_read_b128 a[104:107], v150 offset:0
    s_cmp_lt_u32 s34, 2
    s_cselect_b32 s16, s80, s82
    v_mfma_f32_16x16x32_bf16 v[36:39], a[112:115], a[148:151], v[36:39]
    ds_read_b128 a[108:111], v150 offset:8192
    s_cselect_b32 s17, s81, s83
    s_nop 0
    v_mfma_f32_16x16x32_bf16 v[40:43], a[116:119], a[144:147], v[40:43]
    ds_read_b128 a[72:75], v148 offset:0
    s_mov_b32 s18, 0x200000
    v_mfma_f32_16x16x32_bf16 v[44:47], a[116:119], a[148:151], v[44:47]
    ds_read_b128 a[76:79], v148 offset:2048
    s_mov_b32 s19, 0x00020000
    v_mfma_f32_16x16x32_bf16 v[48:51], a[120:123], a[144:147], v[48:51]
    ds_read_b128 a[80:83], v148 offset:4096
    v_and_b32_e64 v6, 7, v0
    v_mfma_f32_16x16x32_bf16 v[52:55], a[120:123], a[148:151], v[52:55]
    ds_read_b128 a[84:87], v148 offset:6144
    v_xor_b32 v6, v6, v2
    v_lshlrev_b32 v6, 4, v6
    v_mfma_f32_16x16x32_bf16 v[56:59], a[124:127], a[144:147], v[56:59]
    ds_read_b128 a[88:91], v148 offset:8192
    s_and_b32 s38, s33, 8
    v_mfma_f32_16x16x32_bf16 v[60:63], a[124:127], a[148:151], v[60:63]
    ds_read_b128 a[92:95], v148 offset:10240
    s_lshl_b32 s38, s38, 7
    v_mfma_f32_16x16x32_bf16 v[64:67], a[128:131], a[144:147], v[64:67]
    ds_read_b128 a[96:99], v148 offset:12288
    v_add_u32_e64 v6, s38, v6
    v_mfma_f32_16x16x32_bf16 v[68:71], a[128:131], a[148:151], v[68:71]
    ds_read_b128 a[100:103], v148 offset:14336
    v_xor_b32_e64 v7, 64, v6
    v_mfma_f32_16x16x32_bf16 v[72:75], a[132:135], a[144:147], v[72:75]
    v_lshrrev_b32 v8, 3, v0
    v_lshlrev_b32 v8, 2, v8
    v_mfma_f32_16x16x32_bf16 v[76:79], a[132:135], a[148:151], v[76:79]
    s_and_b32 s38, s33, 7
    v_mfma_f32_16x16x32_bf16 v[80:83], a[136:139], a[144:147], v[80:83]
    s_lshl_b32 s38, s38, 1
    v_mfma_f32_16x16x32_bf16 v[84:87], a[136:139], a[148:151], v[84:87]
    s_lshr_b32 s39, s33, 3
    v_mfma_f32_16x16x32_bf16 v[88:91], a[140:143], a[144:147], v[88:91]
    s_add_u32 s38, s38, s39
    v_mfma_f32_16x16x32_bf16 v[92:95], a[140:143], a[148:151], v[92:95]
    s_mov_b32 s92, s38
    s_waitcnt lgkmcnt(0)
    v_mfma_f32_16x16x32_bf16 v[32:35], a[72:75], a[104:107], v[32:35]
    ds_read_b128 a[144:147], v151 offset:0
    s_xor_b32 s38, s38, 1
    s_lshl_b32 s38, s38, 6
    v_mfma_f32_16x16x32_bf16 v[36:39], a[72:75], a[108:111], v[36:39]
    ds_read_b128 a[148:151], v151 offset:8192
    s_and_b32 s39, s34, 1
    v_mfma_f32_16x16x32_bf16 v[40:43], a[76:79], a[104:107], v[40:43]
    ds_read_b128 a[112:115], v149 offset:0
    s_lshl_b32 s39, s39, 1
    v_mfma_f32_16x16x32_bf16 v[44:47], a[76:79], a[108:111], v[44:47]
    ds_read_b128 a[116:119], v149 offset:2048
    s_add_u32 s38, s38, s39
    v_mfma_f32_16x16x32_bf16 v[48:51], a[80:83], a[104:107], v[48:51]
    ds_read_b128 a[120:123], v149 offset:4096
    v_add_u32 v8, s38, v8
    v_mfma_f32_16x16x32_bf16 v[52:55], a[80:83], a[108:111], v[52:55]
    ds_read_b128 a[124:127], v149 offset:6144
    v_add_u32_e64 v9, 0, v8
    v_mfma_f32_16x16x32_bf16 v[56:59], a[84:87], a[104:107], v[56:59]
    ds_read_b128 a[128:131], v149 offset:8192
    v_lshl_add_u32 v16, v9, 11, v6
    v_mfma_f32_16x16x32_bf16 v[60:63], a[84:87], a[108:111], v[60:63]
    ds_read_b128 a[132:135], v149 offset:10240
    v_add_u32_e64 v9, 32, v8
    v_mfma_f32_16x16x32_bf16 v[64:67], a[88:91], a[104:107], v[64:67]
    ds_read_b128 a[136:139], v149 offset:12288
    v_lshl_add_u32 v17, v9, 11, v7
    v_add_u32_e64 v9, 1, v8
    v_mfma_f32_16x16x32_bf16 v[68:71], a[88:91], a[108:111], v[68:71]
    ds_read_b128 a[140:143], v149 offset:14336
    v_lshl_add_u32 v18, v9, 11, v6
    v_mfma_f32_16x16x32_bf16 v[72:75], a[92:95], a[104:107], v[72:75]
    v_add_u32_e64 v9, 33, v8
    v_mfma_f32_16x16x32_bf16 v[76:79], a[92:95], a[108:111], v[76:79]
    v_lshl_add_u32 v19, v9, 11, v7
    v_mfma_f32_16x16x32_bf16 v[80:83], a[96:99], a[104:107], v[80:83]
    s_mov_b32 s20, s90
    v_mfma_f32_16x16x32_bf16 v[84:87], a[96:99], a[108:111], v[84:87]
    s_mov_b32 s21, s91
    v_mfma_f32_16x16x32_bf16 v[88:91], a[100:103], a[104:107], v[88:91]
    s_mov_b32 s22, 8388608
    v_mfma_f32_16x16x32_bf16 v[92:95], a[100:103], a[108:111], v[92:95]
    s_mov_b32 s23, 0x00020000
    s_waitcnt vmcnt(8) lgkmcnt(0)
    s_barrier
    v_mfma_f32_16x16x32_bf16 v[32:35], a[112:115], a[144:147], v[32:35]
    ds_read_b128 a[104:107], v150 offset:32768
    v_mfma_f32_16x16x32_bf16 v[36:39], a[112:115], a[148:151], v[36:39]
    ds_read_b128 a[108:111], v150 offset:40960
    v_mfma_f32_16x16x32_bf16 v[40:43], a[116:119], a[144:147], v[40:43]
    ds_read_b128 a[72:75], v148 offset:32768
    v_mfma_f32_16x16x32_bf16 v[44:47], a[116:119], a[148:151], v[44:47]
    ds_read_b128 a[76:79], v148 offset:34816
    v_mfma_f32_16x16x32_bf16 v[48:51], a[120:123], a[144:147], v[48:51]
    ds_read_b128 a[80:83], v148 offset:36864
    v_mfma_f32_16x16x32_bf16 v[52:55], a[120:123], a[148:151], v[52:55]
    ds_read_b128 a[84:87], v148 offset:38912
    v_mfma_f32_16x16x32_bf16 v[56:59], a[124:127], a[144:147], v[56:59]
    ds_read_b128 a[88:91], v148 offset:40960
    v_mfma_f32_16x16x32_bf16 v[60:63], a[124:127], a[148:151], v[60:63]
    ds_read_b128 a[92:95], v148 offset:43008
    v_mfma_f32_16x16x32_bf16 v[64:67], a[128:131], a[144:147], v[64:67]
    ds_read_b128 a[96:99], v148 offset:45056
    v_mfma_f32_16x16x32_bf16 v[68:71], a[128:131], a[148:151], v[68:71]
    ds_read_b128 a[100:103], v148 offset:47104
    v_mfma_f32_16x16x32_bf16 v[72:75], a[132:135], a[144:147], v[72:75]
    v_mfma_f32_16x16x32_bf16 v[76:79], a[132:135], a[148:151], v[76:79]
    v_mfma_f32_16x16x32_bf16 v[80:83], a[136:139], a[144:147], v[80:83]
    v_mfma_f32_16x16x32_bf16 v[84:87], a[136:139], a[148:151], v[84:87]
    v_mfma_f32_16x16x32_bf16 v[88:91], a[140:143], a[144:147], v[88:91]
    v_mfma_f32_16x16x32_bf16 v[92:95], a[140:143], a[148:151], v[92:95]
    s_waitcnt lgkmcnt(0)
    s_nop 0
    v_mfma_f32_16x16x32_bf16 v[32:35], a[72:75], a[104:107], v[32:35]
    ds_read_b128 a[144:147], v151 offset:32768
    v_mfma_f32_16x16x32_bf16 v[36:39], a[72:75], a[108:111], v[36:39]
    ds_read_b128 a[148:151], v151 offset:40960
    v_mfma_f32_16x16x32_bf16 v[40:43], a[76:79], a[104:107], v[40:43]
    ds_read_b128 a[112:115], v149 offset:32768
    v_mfma_f32_16x16x32_bf16 v[44:47], a[76:79], a[108:111], v[44:47]
    ds_read_b128 a[116:119], v149 offset:34816
    v_mfma_f32_16x16x32_bf16 v[48:51], a[80:83], a[104:107], v[48:51]
    ds_read_b128 a[120:123], v149 offset:36864
    v_mfma_f32_16x16x32_bf16 v[52:55], a[80:83], a[108:111], v[52:55]
    ds_read_b128 a[124:127], v149 offset:38912
    v_mfma_f32_16x16x32_bf16 v[56:59], a[84:87], a[104:107], v[56:59]
    ds_read_b128 a[128:131], v149 offset:40960
    v_mfma_f32_16x16x32_bf16 v[60:63], a[84:87], a[108:111], v[60:63]
    ds_read_b128 a[132:135], v149 offset:43008
    v_mfma_f32_16x16x32_bf16 v[64:67], a[88:91], a[104:107], v[64:67]
    ds_read_b128 a[136:139], v149 offset:45056
    v_mfma_f32_16x16x32_bf16 v[68:71], a[88:91], a[108:111], v[68:71]
    ds_read_b128 a[140:143], v149 offset:47104
    v_mfma_f32_16x16x32_bf16 v[72:75], a[92:95], a[104:107], v[72:75]
    v_mfma_f32_16x16x32_bf16 v[76:79], a[92:95], a[108:111], v[76:79]
    v_mfma_f32_16x16x32_bf16 v[80:83], a[96:99], a[104:107], v[80:83]
    v_mfma_f32_16x16x32_bf16 v[84:87], a[96:99], a[108:111], v[84:87]
    v_mfma_f32_16x16x32_bf16 v[88:91], a[100:103], a[104:107], v[88:91]
    v_mfma_f32_16x16x32_bf16 v[92:95], a[100:103], a[108:111], v[92:95]
    s_waitcnt lgkmcnt(0)
    v_mfma_f32_16x16x32_bf16 v[32:35], a[112:115], a[144:147], v[32:35]
    s_add_u32 s38, s37, 131072
    v_add_u32 v4, s38, v3
    v_mfma_f32_16x16x32_bf16 v[36:39], a[112:115], a[148:151], v[36:39]
    s_waitcnt vmcnt(4)
    s_nop 0
    v_mfma_f32_16x16x32_bf16 v[40:43], a[116:119], a[144:147], v[40:43]
    ds_write_b128 v4, v[184:187] offset:0
    ds_write_b128 v4, v[188:191] offset:1024
    v_mfma_f32_16x16x32_bf16 v[44:47], a[116:119], a[148:151], v[44:47]
    ds_write_b128 v4, v[192:195] offset:2048
    v_mfma_f32_16x16x32_bf16 v[48:51], a[120:123], a[144:147], v[48:51]
    ds_write_b128 v4, v[196:199] offset:3072
    v_mfma_f32_16x16x32_bf16 v[52:55], a[120:123], a[148:151], v[52:55]
    v_and_b32 v8, 1, v2
    v_lshrrev_b32 v9, 1, v1
    v_mfma_f32_16x16x32_bf16 v[56:59], a[124:127], a[144:147], v[56:59]
    v_xor_b32_e64 v8, v8, v9
    v_mfma_f32_16x16x32_bf16 v[60:63], a[124:127], a[148:151], v[60:63]
    v_lshlrev_b32_e64 v8, 4, v8
    v_mfma_f32_16x16x32_bf16 v[64:67], a[128:131], a[144:147], v[64:67]
    v_lshl_add_u32 v8, v1, 7, v8
    v_lshrrev_b32_e64 v9, 1, v2
    v_mfma_f32_16x16x32_bf16 v[68:71], a[128:131], a[148:151], v[68:71]
    v_lshl_add_u32 v8, v9, 13, v8
    v_mfma_f32_16x16x32_bf16 v[72:75], a[132:135], a[144:147], v[72:75]
    v_xor_b32_e64 v20, 0, v8
    v_add_u32 v24, 0x10000, v20
    v_mfma_f32_16x16x32_bf16 v[76:79], a[132:135], a[148:151], v[76:79]
    v_xor_b32_e64 v21, 32, v8
    v_mfma_f32_16x16x32_bf16 v[80:83], a[136:139], a[144:147], v[80:83]
    v_add_u32 v25, 0x10000, v21
    v_mfma_f32_16x16x32_bf16 v[84:87], a[136:139], a[148:151], v[84:87]
    v_xor_b32_e64 v22, 64, v8
    v_add_u32 v26, 0x10000, v22
    v_mfma_f32_16x16x32_bf16 v[88:91], a[140:143], a[144:147], v[88:91]
    v_xor_b32 v23, 96, v8
    v_mfma_f32_16x16x32_bf16 v[92:95], a[140:143], a[148:151], v[92:95]
    v_add_u32 v27, 0x10000, v23
    s_waitcnt lgkmcnt(0)
    s_barrier
    v_add_u32 v28, 131072, v3
    ds_read_b128 a[72:75], v28 offset:0
    ds_read_b128 a[76:79], v28 offset:1024
    ds_read_b128 a[80:83], v28 offset:2048
    ds_read_b128 a[84:87], v28 offset:3072
    ds_read_b128 a[88:91], v28 offset:4096
    ds_read_b128 a[92:95], v28 offset:5120
    ds_read_b128 a[96:99], v28 offset:6144
    ds_read_b128 a[100:103], v28 offset:7168
    ds_read_b128 a[104:107], v28 offset:8192
    ds_read_b128 a[108:111], v28 offset:9216
    ds_read_b128 a[112:115], v28 offset:10240
    ds_read_b128 a[116:119], v28 offset:11264
    ds_read_b128 a[120:123], v28 offset:12288
    ds_read_b128 a[124:127], v28 offset:13312
    ds_read_b128 a[128:131], v28 offset:14336
    ds_read_b128 a[132:135], v28 offset:15360
    v_pk_fma_f32 v[4:5], v[32:33], v[128:129], v[34:35] op_sel_hi:[1,0,1]
    v_pk_fma_f32 v[6:7], v[36:37], v[128:129], v[38:39] op_sel_hi:[1,0,1]
    v_pk_fma_f32 v[4:5], v[36:37], v[128:129], v[4:5] op_sel:[0,1,0] neg_lo:[1,0,0] neg_hi:[1,0,0]
    v_pk_fma_f32 v[6:7], v[32:33], v[128:129], v[6:7] op_sel:[0,1,0]
    v_pk_fma_f32 v[8:9], v[4:5], v[128:129], v[40:41] op_sel_hi:[1,0,1]
    v_pk_fma_f32 v[10:11], v[6:7], v[128:129], v[44:45] op_sel_hi:[1,0,1]
    v_pk_fma_f32 v[8:9], v[6:7], v[128:129], v[8:9] op_sel:[0,1,0] neg_lo:[1,0,0] neg_hi:[1,0,0]
    v_pk_fma_f32 v[10:11], v[4:5], v[128:129], v[10:11] op_sel:[0,1,0]
    v_pk_fma_f32 v[4:5], v[8:9], v[128:129], v[42:43] op_sel_hi:[1,0,1]
    v_pk_fma_f32 v[6:7], v[10:11], v[128:129], v[46:47] op_sel_hi:[1,0,1]
    v_pk_fma_f32 v[4:5], v[10:11], v[128:129], v[4:5] op_sel:[0,1,0] neg_lo:[1,0,0] neg_hi:[1,0,0]
    v_pk_fma_f32 v[6:7], v[8:9], v[128:129], v[6:7] op_sel:[0,1,0]
    v_pk_fma_f32 v[8:9], v[4:5], v[128:129], v[48:49] op_sel_hi:[1,0,1]
    v_pk_fma_f32 v[10:11], v[6:7], v[128:129], v[52:53] op_sel_hi:[1,0,1]
    v_pk_fma_f32 v[8:9], v[6:7], v[128:129], v[8:9] op_sel:[0,1,0] neg_lo:[1,0,0] neg_hi:[1,0,0]
    v_pk_fma_f32 v[10:11], v[4:5], v[128:129], v[10:11] op_sel:[0,1,0]
    v_pk_fma_f32 v[4:5], v[8:9], v[128:129], v[50:51] op_sel_hi:[1,0,1]
    v_pk_fma_f32 v[6:7], v[10:11], v[128:129], v[54:55] op_sel_hi:[1,0,1]
    v_pk_fma_f32 v[4:5], v[10:11], v[128:129], v[4:5] op_sel:[0,1,0] neg_lo:[1,0,0] neg_hi:[1,0,0]
    v_pk_fma_f32 v[6:7], v[8:9], v[128:129], v[6:7] op_sel:[0,1,0]
    v_pk_fma_f32 v[8:9], v[4:5], v[128:129], v[56:57] op_sel_hi:[1,0,1]
    v_pk_fma_f32 v[10:11], v[6:7], v[128:129], v[60:61] op_sel_hi:[1,0,1]
    v_pk_fma_f32 v[8:9], v[6:7], v[128:129], v[8:9] op_sel:[0,1,0] neg_lo:[1,0,0] neg_hi:[1,0,0]
    v_pk_fma_f32 v[10:11], v[4:5], v[128:129], v[10:11] op_sel:[0,1,0]
    v_pk_fma_f32 v[4:5], v[8:9], v[128:129], v[58:59] op_sel_hi:[1,0,1]
    v_pk_fma_f32 v[6:7], v[10:11], v[128:129], v[62:63] op_sel_hi:[1,0,1]
    v_pk_fma_f32 v[4:5], v[10:11], v[128:129], v[4:5] op_sel:[0,1,0] neg_lo:[1,0,0] neg_hi:[1,0,0]
    v_pk_fma_f32 v[6:7], v[8:9], v[128:129], v[6:7] op_sel:[0,1,0]
    v_pk_fma_f32 v[8:9], v[4:5], v[128:129], v[64:65] op_sel_hi:[1,0,1]
    v_pk_fma_f32 v[10:11], v[6:7], v[128:129], v[68:69] op_sel_hi:[1,0,1]
    v_pk_fma_f32 v[8:9], v[6:7], v[128:129], v[8:9] op_sel:[0,1,0] neg_lo:[1,0,0] neg_hi:[1,0,0]
    v_pk_fma_f32 v[10:11], v[4:5], v[128:129], v[10:11] op_sel:[0,1,0]
    v_pk_fma_f32 v[4:5], v[8:9], v[128:129], v[66:67] op_sel_hi:[1,0,1]
    v_pk_fma_f32 v[6:7], v[10:11], v[128:129], v[70:71] op_sel_hi:[1,0,1]
    v_pk_fma_f32 v[4:5], v[10:11], v[128:129], v[4:5] op_sel:[0,1,0] neg_lo:[1,0,0] neg_hi:[1,0,0]
    v_pk_fma_f32 v[6:7], v[8:9], v[128:129], v[6:7] op_sel:[0,1,0]
    v_pk_fma_f32 v[8:9], v[4:5], v[128:129], v[72:73] op_sel_hi:[1,0,1]
    v_pk_fma_f32 v[10:11], v[6:7], v[128:129], v[76:77] op_sel_hi:[1,0,1]
    v_pk_fma_f32 v[8:9], v[6:7], v[128:129], v[8:9] op_sel:[0,1,0] neg_lo:[1,0,0] neg_hi:[1,0,0]
    v_pk_fma_f32 v[10:11], v[4:5], v[128:129], v[10:11] op_sel:[0,1,0]
    v_pk_fma_f32 v[4:5], v[8:9], v[128:129], v[74:75] op_sel_hi:[1,0,1]
    v_pk_fma_f32 v[6:7], v[10:11], v[128:129], v[78:79] op_sel_hi:[1,0,1]
    v_pk_fma_f32 v[4:5], v[10:11], v[128:129], v[4:5] op_sel:[0,1,0] neg_lo:[1,0,0] neg_hi:[1,0,0]
    v_pk_fma_f32 v[6:7], v[8:9], v[128:129], v[6:7] op_sel:[0,1,0]
    v_pk_fma_f32 v[8:9], v[4:5], v[128:129], v[80:81] op_sel_hi:[1,0,1]
    v_pk_fma_f32 v[10:11], v[6:7], v[128:129], v[84:85] op_sel_hi:[1,0,1]
    v_pk_fma_f32 v[8:9], v[6:7], v[128:129], v[8:9] op_sel:[0,1,0] neg_lo:[1,0,0] neg_hi:[1,0,0]
    v_pk_fma_f32 v[10:11], v[4:5], v[128:129], v[10:11] op_sel:[0,1,0]
    v_pk_fma_f32 v[4:5], v[8:9], v[128:129], v[82:83] op_sel_hi:[1,0,1]
    v_pk_fma_f32 v[6:7], v[10:11], v[128:129], v[86:87] op_sel_hi:[1,0,1]
    v_pk_fma_f32 v[4:5], v[10:11], v[128:129], v[4:5] op_sel:[0,1,0] neg_lo:[1,0,0] neg_hi:[1,0,0]
    v_pk_fma_f32 v[6:7], v[8:9], v[128:129], v[6:7] op_sel:[0,1,0]
    v_pk_fma_f32 v[8:9], v[4:5], v[128:129], v[88:89] op_sel_hi:[1,0,1]
    v_pk_fma_f32 v[10:11], v[6:7], v[128:129], v[92:93] op_sel_hi:[1,0,1]
    v_pk_fma_f32 v[8:9], v[6:7], v[128:129], v[8:9] op_sel:[0,1,0] neg_lo:[1,0,0] neg_hi:[1,0,0]
    v_pk_fma_f32 v[10:11], v[4:5], v[128:129], v[10:11] op_sel:[0,1,0]
    v_pk_fma_f32 v[142:143], v[8:9], v[128:129], v[90:91] op_sel_hi:[1,0,1]
    v_pk_fma_f32 v[144:145], v[10:11], v[128:129], v[94:95] op_sel_hi:[1,0,1]
    v_pk_fma_f32 v[142:143], v[10:11], v[128:129], v[142:143] op_sel:[0,1,0] neg_lo:[1,0,0] neg_hi:[1,0,0]
    v_pk_fma_f32 v[144:145], v[8:9], v[128:129], v[144:145] op_sel:[0,1,0]
    v_pk_mul_f32 v[4:5], v[142:143], v[130:131] op_sel_hi:[1,0]
    v_pk_mul_f32 v[6:7], v[144:145], v[130:131] op_sel_hi:[1,0]
    v_pk_fma_f32 v[4:5], v[144:145], v[130:131], v[4:5] op_sel:[0,1,0] neg_lo:[1,0,0] neg_hi:[1,0,0]
    v_pk_fma_f32 v[144:145], v[142:143], v[130:131], v[6:7] op_sel:[0,1,0]
    s_waitcnt lgkmcnt(12)
    v_mov_b32 v142, v4
    v_mov_b32_e64 v143, v5
    v_mfma_f32_16x16x32_bf16 v[224:227], a[72:75], a[40:43], 0
    v_fma_f32 v4, v142, v132, v143
    v_mfma_f32_16x16x32_bf16 v[228:231], a[72:75], a[44:47], 0
    v_fma_f32 v8, v142, v133, v145
    v_fma_f32 v4, -v144, v133, v4
    v_mfma_f32_16x16x32_bf16 v[224:227], a[76:79], a[48:51], v[224:227]
    v_fma_f32 v8, v144, v132, v8
    v_mfma_f32_16x16x32_bf16 v[228:231], a[76:79], a[52:55], v[228:231]
    v_mov_b32_e64 v6, v4
    v_mfma_f32_16x16x32_bf16 v[224:227], a[80:83], a[56:59], v[224:227]
    v_mov_b32 v10, v8
    v_permlane32_swap_b32 v4, v6
    v_mfma_f32_16x16x32_bf16 v[228:231], a[80:83], a[60:63], v[228:231]
    v_permlane32_swap_b32 v8, v10
    v_mfma_f32_16x16x32_bf16 v[224:227], a[84:87], a[64:67], v[224:227]
    v_mov_b32 v5, v4
    v_mfma_f32_16x16x32_bf16 v[228:231], a[84:87], a[68:71], v[228:231]
    v_mov_b32 v7, v6
    v_mov_b32 v9, v8
    s_waitcnt lgkmcnt(8)
    v_mov_b32 v11, v10
    v_mfma_f32_16x16x32_bf16 v[232:235], a[88:91], a[40:43], 0
    v_permlane16_swap_b32 v4, v5
    v_mfma_f32_16x16x32_bf16 v[236:239], a[88:91], a[44:47], 0
    v_permlane16_swap_b32 v6, v7
    v_permlane16_swap_b32 v8, v9
    v_mfma_f32_16x16x32_bf16 v[232:235], a[92:95], a[48:51], v[232:235]
    v_permlane16_swap_b32 v10, v11
    v_mfma_f32_16x16x32_bf16 v[236:239], a[92:95], a[52:55], v[236:239]
    v_fma_f32 v12, v4, v134, v5
    v_fma_f32 v13, v4, v135, v9
    v_mfma_f32_16x16x32_bf16 v[232:235], a[96:99], a[56:59], v[232:235]
    v_fma_f32 v12, -v8, v135, v12
    v_mfma_f32_16x16x32_bf16 v[236:239], a[96:99], a[60:63], v[236:239]
    v_fma_f32 v13, v8, v134, v13
    v_mfma_f32_16x16x32_bf16 v[232:235], a[100:103], a[64:67], v[232:235]
    v_fma_f32 v14, v12, v134, v6
    v_fma_f32 v15, v12, v135, v10
    v_mfma_f32_16x16x32_bf16 v[236:239], a[100:103], a[68:71], v[236:239]
    v_fma_f32 v14, -v13, v135, v14
    s_waitcnt lgkmcnt(4)
    s_nop 0
    v_fma_f32 v15, v13, v134, v15
    v_mfma_f32_16x16x32_bf16 v[240:243], a[104:107], a[40:43], 0
    v_fma_f32 v220, v14, v134, v7
    v_fma_f32 v221, v14, v135, v11
    v_mfma_f32_16x16x32_bf16 v[244:247], a[104:107], a[44:47], 0
    v_fma_f32 v220, -v15, v135, v220
    v_mfma_f32_16x16x32_bf16 v[240:243], a[108:111], a[48:51], v[240:243]
    v_fma_f32 v221, v15, v134, v221
    v_mfma_f32_16x16x32_bf16 v[244:247], a[108:111], a[52:55], v[244:247]
    v_mov_b32 v222, s35
    v_mov_b32 v223, s35
    v_mfma_f32_16x16x32_bf16 v[240:243], a[112:115], a[56:59], v[240:243]
    s_lshl_b32 s38, s33, 4
    v_mfma_f32_16x16x32_bf16 v[244:247], a[112:115], a[60:63], v[244:247]
    s_add_u32 s38, s38, s32
    s_lshl_b32 s38, s38, 2
    v_mfma_f32_16x16x32_bf16 v[240:243], a[116:119], a[64:67], v[240:243]
    s_add_u32 s38, s38, s34
    v_mfma_f32_16x16x32_bf16 v[244:247], a[116:119], a[68:71], v[244:247]
    s_lshl_b32 s38, s38, 8
    s_waitcnt lgkmcnt(0)
    s_add_u32 s38, s38, 22020096
    v_cmp_gt_u32_e64 vcc, 16, v0
    v_mfma_f32_16x16x32_bf16 v[248:251], a[120:123], a[40:43], 0
    s_nop 0
    v_cndmask_b32 v5, 2.0, v3, vcc
    v_mfma_f32_16x16x32_bf16 v[252:255], a[120:123], a[44:47], 0
    buffer_store_dwordx4 v[220:223], v5, s[24:27], s38 offen sc1
    v_mfma_f32_16x16x32_bf16 v[248:251], a[124:127], a[48:51], v[248:251]
    v_cndmask_b32 v146, v4, 0, vcc
    v_cndmask_b32 v147, v8, 0, vcc
    v_mfma_f32_16x16x32_bf16 v[252:255], a[124:127], a[52:55], v[252:255]
    v_cmp_eq_u32_e64 vcc, 2, v2
    v_mfma_f32_16x16x32_bf16 v[248:251], a[128:131], a[56:59], v[248:251]
    s_nop 0
    v_cndmask_b32 v146, v146, v12, vcc
    v_mfma_f32_16x16x32_bf16 v[252:255], a[128:131], a[60:63], v[252:255]
    v_cndmask_b32 v147, v147, v13, vcc
    v_cmp_eq_u32 vcc, 3, v2
    v_mfma_f32_16x16x32_bf16 v[248:251], a[132:135], a[64:67], v[248:251]
    s_nop 0
    v_cndmask_b32 v146, v146, v14, vcc
    v_mfma_f32_16x16x32_bf16 v[252:255], a[132:135], a[68:71], v[252:255]
    v_cndmask_b32_e64 v147, v147, v15, vcc
    v_pk_mul_f32 v[4:5], v[224:225], v[96:97] op_sel_hi:[1,0]
    s_and_b32 s73, s32, 3
    v_pk_mul_f32 v[6:7], v[228:229], v[96:97] op_sel_hi:[1,0]
    s_lshl_b32 s73, s73, 1
    v_pk_fma_f32 v[4:5], v[228:229], v[96:97], v[4:5] op_sel:[0,1,0]
    s_add_u32 s73, s73, 0
    v_pk_fma_f32 v[6:7], v[224:225], v[96:97], v[6:7] op_sel:[0,1,0] neg_lo:[1,0,0] neg_hi:[1,0,0]
    v_pk_mul_f32 v[8:9], v[226:227], v[98:99] op_sel_hi:[1,0]
    s_and_b32 s73, s73, 7
    v_pk_mul_f32 v[10:11], v[230:231], v[98:99] op_sel_hi:[1,0]
    s_add_u32 s72, s73, s33
    v_pk_fma_f32 v[8:9], v[230:231], v[98:99], v[8:9] op_sel:[0,1,0]
    v_pk_fma_f32 v[10:11], v[226:227], v[98:99], v[10:11] op_sel:[0,1,0] neg_lo:[1,0,0] neg_hi:[1,0,0]
    s_lshl_b32 s73, s73, 14
    v_cvt_pk_bf16_f32 v184, v4, v6
    s_add_u32 s73, s73, s37
    v_cvt_pk_bf16_f32 v192, v5, v7
    s_and_b32 s72, s72, 7
    v_cvt_pk_bf16_f32 v185, v8, v10
    v_cvt_pk_bf16_f32 v193, v9, v11
    s_lshl_b32 s72, s72, 7
    v_pk_mul_f32 v[4:5], v[232:233], v[100:101] op_sel_hi:[1,0]
    s_add_u32 m0, s73, 0
    v_pk_mul_f32 v[6:7], v[236:237], v[100:101] op_sel_hi:[1,0]
    v_pk_fma_f32 v[4:5], v[236:237], v[100:101], v[4:5] op_sel:[0,1,0]
    buffer_load_dwordx4 v16, s[16:19], s72 offen lds
    v_pk_fma_f32 v[6:7], v[232:233], v[100:101], v[6:7] op_sel:[0,1,0] neg_lo:[1,0,0] neg_hi:[1,0,0]
    s_add_u32 m0, s73, 1024
    v_pk_mul_f32 v[8:9], v[234:235], v[102:103] op_sel_hi:[1,0]
    buffer_load_dwordx4 v17, s[16:19], s72 offen lds
    v_pk_mul_f32 v[10:11], v[238:239], v[102:103] op_sel_hi:[1,0]
    v_pk_fma_f32 v[8:9], v[238:239], v[102:103], v[8:9] op_sel:[0,1,0]
    s_add_u32 m0, s73, 2048
    v_pk_fma_f32 v[10:11], v[234:235], v[102:103], v[10:11] op_sel:[0,1,0] neg_lo:[1,0,0] neg_hi:[1,0,0]
    buffer_load_dwordx4 v18, s[16:19], s72 offen lds
    v_cvt_pk_bf16_f32 v186, v4, v6
    v_cvt_pk_bf16_f32 v194, v5, v7
    s_add_u32 m0, s73, 3072
    v_cvt_pk_bf16_f32 v187, v8, v10
    buffer_load_dwordx4 v19, s[16:19], s72 offen lds
    v_cvt_pk_bf16_f32 v195, v9, v11
    v_pk_mul_f32 v[4:5], v[240:241], v[104:105] op_sel_hi:[1,0]
    s_and_b32 s73, s32, 3
    v_pk_mul_f32 v[6:7], v[244:245], v[104:105] op_sel_hi:[1,0]
    s_lshl_b32 s73, s73, 1
    v_pk_fma_f32 v[4:5], v[244:245], v[104:105], v[4:5] op_sel:[0,1,0]
    s_add_u32 s73, s73, 1
    v_pk_fma_f32 v[6:7], v[240:241], v[104:105], v[6:7] op_sel:[0,1,0] neg_lo:[1,0,0] neg_hi:[1,0,0]
    v_pk_mul_f32 v[8:9], v[242:243], v[106:107] op_sel_hi:[1,0]
    s_and_b32 s73, s73, 7
    v_pk_mul_f32 v[10:11], v[246:247], v[106:107] op_sel_hi:[1,0]
    s_add_u32 s72, s73, s33
    v_pk_fma_f32 v[8:9], v[246:247], v[106:107], v[8:9] op_sel:[0,1,0]
    v_pk_fma_f32 v[10:11], v[242:243], v[106:107], v[10:11] op_sel:[0,1,0] neg_lo:[1,0,0] neg_hi:[1,0,0]
    s_lshl_b32 s73, s73, 14
    v_cvt_pk_bf16_f32 v188, v4, v6
    s_add_u32 s73, s73, s37
    v_cvt_pk_bf16_f32 v196, v5, v7
    s_and_b32 s72, s72, 7
    v_cvt_pk_bf16_f32 v189, v8, v10
    v_cvt_pk_bf16_f32 v197, v9, v11
    s_lshl_b32 s72, s72, 7
    v_pk_mul_f32 v[4:5], v[248:249], v[108:109] op_sel_hi:[1,0]
    s_add_u32 m0, s73, 0
    v_pk_mul_f32 v[6:7], v[252:253], v[108:109] op_sel_hi:[1,0]
    v_pk_fma_f32 v[4:5], v[252:253], v[108:109], v[4:5] op_sel:[0,1,0]
    buffer_load_dwordx4 v16, s[16:19], s72 offen lds
    v_pk_fma_f32 v[6:7], v[248:249], v[108:109], v[6:7] op_sel:[0,1,0] neg_lo:[1,0,0] neg_hi:[1,0,0]
    s_add_u32 m0, s73, 1024
    v_pk_mul_f32 v[8:9], v[250:251], v[110:111] op_sel_hi:[1,0]
    buffer_load_dwordx4 v17, s[16:19], s72 offen lds
    v_pk_mul_f32 v[10:11], v[254:255], v[110:111] op_sel_hi:[1,0]
    v_pk_fma_f32 v[8:9], v[254:255], v[110:111], v[8:9] op_sel:[0,1,0]
    s_add_u32 m0, s73, 2048
    v_pk_fma_f32 v[10:11], v[250:251], v[110:111], v[10:11] op_sel:[0,1,0] neg_lo:[1,0,0] neg_hi:[1,0,0]
    buffer_load_dwordx4 v18, s[16:19], s72 offen lds
    v_cvt_pk_bf16_f32 v190, v4, v6
    v_cvt_pk_bf16_f32 v198, v5, v7
    s_add_u32 m0, s73, 3072
    v_cvt_pk_bf16_f32 v191, v8, v10
    buffer_load_dwordx4 v19, s[16:19], s72 offen lds
    v_cvt_pk_bf16_f32 v199, v9, v11
    v_mfma_f32_16x16x32_bf16 v[224:227], a[0:3], v[184:187], 0
    s_waitcnt vmcnt(9)
    v_lshlrev_b32 v152, 16, v200
    v_and_b32 v160, 0xffff0000, v200
    v_mfma_f32_16x16x32_bf16 v[228:231], a[4:7], v[184:187], 0
    v_lshlrev_b32_e64 v168, 16, v201
    v_and_b32 v176, 0xffff0000, v201
    v_mfma_f32_16x16x32_bf16 v[240:243], a[0:3], v[192:195], 0
    v_lshlrev_b32_e64 v153, 16, v202
    v_and_b32 v161, 0xffff0000, v202
    v_mfma_f32_16x16x32_bf16 v[244:247], a[4:7], v[192:195], 0
    v_lshlrev_b32_e64 v169, 16, v203
    v_and_b32 v177, 0xffff0000, v203
    v_mfma_f32_16x16x32_bf16 v[232:235], a[16:19], v[184:187], 0
    v_lshlrev_b32_e64 v154, 16, v204
    v_and_b32 v162, 0xffff0000, v204
    v_mfma_f32_16x16x32_bf16 v[236:239], a[20:23], v[184:187], 0
    v_lshlrev_b32_e64 v170, 16, v205
    v_and_b32 v178, 0xffff0000, v205
    v_mfma_f32_16x16x32_bf16 v[248:251], a[16:19], v[192:195], 0
    v_lshlrev_b32_e64 v155, 16, v206
    v_and_b32 v163, 0xffff0000, v206
    v_mfma_f32_16x16x32_bf16 v[252:255], a[20:23], v[192:195], 0
    v_lshlrev_b32_e64 v171, 16, v207
    v_and_b32 v179, 0xffff0000, v207
    v_mfma_f32_16x16x32_bf16 v[224:227], a[8:11], v[188:191], v[224:227]
    v_lshlrev_b32_e64 v156, 16, v208
    v_and_b32 v164, 0xffff0000, v208
    v_mfma_f32_16x16x32_bf16 v[228:231], a[12:15], v[188:191], v[228:231]
    v_lshlrev_b32_e64 v172, 16, v209
    v_and_b32 v180, 0xffff0000, v209
    v_mfma_f32_16x16x32_bf16 v[240:243], a[8:11], v[196:199], v[240:243]
    v_lshlrev_b32_e64 v157, 16, v210
    v_and_b32 v165, 0xffff0000, v210
    v_mfma_f32_16x16x32_bf16 v[244:247], a[12:15], v[196:199], v[244:247]
    v_lshlrev_b32_e64 v173, 16, v211
    v_and_b32 v181, 0xffff0000, v211
    v_mfma_f32_16x16x32_bf16 v[232:235], a[24:27], v[188:191], v[232:235]
    v_lshlrev_b32_e64 v158, 16, v212
    v_and_b32 v166, 0xffff0000, v212
    v_mfma_f32_16x16x32_bf16 v[236:239], a[28:31], v[188:191], v[236:239]
    v_lshlrev_b32_e64 v174, 16, v213
    v_and_b32 v182, 0xffff0000, v213
    v_mfma_f32_16x16x32_bf16 v[248:251], a[24:27], v[196:199], v[248:251]
    v_lshlrev_b32_e64 v159, 16, v214
    v_and_b32 v167, 0xffff0000, v214
    v_mfma_f32_16x16x32_bf16 v[252:255], a[28:31], v[196:199], v[252:255]
    v_lshlrev_b32_e64 v175, 16, v215
    v_and_b32 v183, 0xffff0000, v215
    s_lshl_b32 s93, s33, 14
    s_lshl_b32 s39, s34, 8
    s_add_u32 s93, s93, s39
    s_add_u32 s93, s93, 22020096
    v_lshlrev_b32 v28, 2, v2
    v_sub_u32 v28, s32, v28
    v_subrev_u32 v29, 1, v28
    v_cmp_le_i32 vcc, 0, v29
    v_lshlrev_b32 v29, 10, v29
    v_lshl_add_u32 v29, v1, 4, v29
    v_cndmask_b32 v148, 2.0, v29, vcc
    v_subrev_u32 v29, 2, v28
    v_cmp_le_i32 vcc, 0, v29
    v_lshlrev_b32 v29, 10, v29
    v_lshl_add_u32 v29, v1, 4, v29
    v_cndmask_b32 v149, 2.0, v29, vcc
    v_subrev_u32 v29, 3, v28
    v_cmp_le_i32 vcc, 0, v29
    v_lshlrev_b32 v29, 10, v29
    v_lshl_add_u32 v29, v1, 4, v29
    v_cndmask_b32 v150, 2.0, v29, vcc
    v_subrev_u32 v29, 4, v28
    v_cmp_le_i32 vcc, 0, v29
    v_lshlrev_b32 v29, 10, v29
    v_lshl_add_u32 v29, v1, 4, v29
    v_cndmask_b32_e64 v151, 2.0, v29, vcc
    buffer_load_dwordx4 v[96:99], v148, s[24:27], s93 offen sc1
    buffer_load_dwordx4 v[100:103], v149, s[24:27], s93 offen sc1
    buffer_load_dwordx4 v[104:107], v150, s[24:27], s93 offen sc1
    buffer_load_dwordx4 v[108:111], v151, s[24:27], s93 offen sc1
    s_cmp_lg_u32 s2, 0
    s_cbranch_scc1 K_NOSPECIAL
    s_mov_b32 s38, 8404992
    s_add_u32 s38, s38, s37
    s_nop 0
    buffer_load_dwordx4 v[184:187], v3, s[24:27], s38 offen offset:0 sc1
    buffer_load_dwordx4 v[188:191], v3, s[24:27], s38 offen offset:1024 sc1
    buffer_load_dwordx4 v[192:195], v3, s[24:27], s38 offen offset:2048 sc1
    buffer_load_dwordx4 v[196:199], v3, s[24:27], s38 offen offset:3072 sc1
    s_lshl_b32 s38, s34, 4
    v_lshl_add_u32 v4, v2, 7, v1
    v_add_u32 v4, s38, v4
    v_sub_u32 v5, 448, v4
    v_lshlrev_b32 v4, 2, v4
    v_lshlrev_b32 v5, 2, v5
    v_add_u32 v4, 81920, v4
    v_add_u32 v5, 81920, v5
    v_pk_mul_f32 v[224:225], v[224:225], 0.5 op_sel_hi:[1,0]
    v_pk_mul_f32 v[228:229], v[228:229], 0.5 op_sel_hi:[1,0]
    v_pk_mul_f32 v[226:227], v[226:227], 0.5 op_sel_hi:[1,0]
    v_pk_mul_f32 v[230:231], v[230:231], 0.5 op_sel_hi:[1,0]
    v_pk_mul_f32 v[232:233], v[232:233], 0.5 op_sel_hi:[1,0]
    v_pk_mul_f32 v[236:237], v[236:237], 0.5 op_sel_hi:[1,0]
    v_pk_mul_f32 v[234:235], v[234:235], 0.5 op_sel_hi:[1,0]
    v_pk_mul_f32 v[238:239], v[238:239], 0.5 op_sel_hi:[1,0]
    ds_write2st64_b32 v4, v224, v228 offset0:0 offset1:40
    ds_write2st64_b32 v4, v200, v201 offset0:80 offset1:120
    ds_write2st64_b32 v4, v225, v229 offset0:1 offset1:41
    ds_write2st64_b32 v4, v202, v203 offset0:81 offset1:121
    ds_write2st64_b32 v4, v226, v230 offset0:8 offset1:48
    ds_write2st64_b32 v4, v204, v205 offset0:88 offset1:128
    ds_write2st64_b32 v4, v227, v231 offset0:9 offset1:49
    ds_write2st64_b32 v4, v206, v207 offset0:89 offset1:129
    ds_write2st64_b32 v4, v232, v236 offset0:16 offset1:56
    ds_write2st64_b32 v4, v208, v209 offset0:96 offset1:136
    ds_write2st64_b32 v4, v233, v237 offset0:17 offset1:57
    ds_write2st64_b32 v4, v210, v211 offset0:97 offset1:137
    ds_write2st64_b32 v4, v234, v238 offset0:24 offset1:64
    ds_write2st64_b32 v4, v212, v213 offset0:104 offset1:144
    ds_write2st64_b32 v4, v235, v239 offset0:25 offset1:65
    ds_write2st64_b32 v4, v214, v215 offset0:105 offset1:145
    ds_write2st64_b32 v4, v224, v228 offset0:32 offset1:72
    ds_write2st64_b32 v4, v200, v201 offset0:112 offset1:152
    s_waitcnt vmcnt(0)
    v_lshlrev_b32 v6, 16, v184
    v_and_b32 v7, 0xffff0000, v184
    v_mul_f32 v6, 4.0, v6
    v_mul_f32 v7, 4.0, v7
    v_mul_f32 v8, v6, v240
    v_mul_f32 v9, v6, v244
    v_fma_f32 v8, -v7, v244, v8
    v_fma_f32 v9, v7, v240, v9
    v_cvt_pk_bf16_f32 v8, v8, -v9
    v_accvgpr_write_b32 a152, v8
    v_lshlrev_b32_e64 v6, 16, v186
    v_and_b32 v7, 0xffff0000, v186
    v_mul_f32 v6, 4.0, v6
    v_mul_f32 v7, 4.0, v7
    v_mul_f32 v8, v6, v241
    v_mul_f32 v9, v6, v245
    v_fma_f32 v8, -v7, v245, v8
    v_fma_f32 v9, v7, v241, v9
    v_cvt_pk_bf16_f32 v8, v8, -v9
    v_accvgpr_write_b32 a153, v8
    v_lshlrev_b32_e64 v6, 16, v188
    v_and_b32 v7, 0xffff0000, v188
    v_mul_f32 v6, 4.0, v6
    v_mul_f32 v7, 4.0, v7
    v_mul_f32 v8, v6, v242
    v_mul_f32 v9, v6, v246
    v_fma_f32 v8, -v7, v246, v8
    v_fma_f32 v9, v7, v242, v9
    v_cvt_pk_bf16_f32 v8, v8, -v9
    v_accvgpr_write_b32 a154, v8
    v_lshlrev_b32_e64 v6, 16, v190
    v_and_b32 v7, 0xffff0000, v190
    v_mul_f32 v6, 4.0, v6
    v_mul_f32 v7, 4.0, v7
    v_mul_f32 v8, v6, v243
    v_mul_f32 v9, v6, v247
    v_fma_f32 v8, -v7, v247, v8
    v_fma_f32 v9, v7, v243, v9
    v_cvt_pk_bf16_f32 v8, v8, -v9
    v_accvgpr_write_b32 a155, v8
    v_lshlrev_b32_e64 v6, 16, v192
    v_and_b32 v7, 0xffff0000, v192
    v_mul_f32 v6, 4.0, v6
    v_mul_f32 v7, 4.0, v7
    v_mul_f32 v8, v6, v248
    v_mul_f32 v9, v6, v252
    v_fma_f32 v8, -v7, v252, v8
    v_fma_f32 v9, v7, v248, v9
    v_cvt_pk_bf16_f32 v8, v8, -v9
    v_accvgpr_write_b32 a156, v8
    v_lshlrev_b32_e64 v6, 16, v194
    v_and_b32 v7, 0xffff0000, v194
    v_mul_f32 v6, 4.0, v6
    v_mul_f32 v7, 4.0, v7
    v_mul_f32 v8, v6, v249
    v_mul_f32 v9, v6, v253
    v_fma_f32 v8, -v7, v253, v8
    v_fma_f32 v9, v7, v249, v9
    v_cvt_pk_bf16_f32 v8, v8, -v9
    v_accvgpr_write_b32 a157, v8
    v_lshlrev_b32_e64 v6, 16, v196
    v_and_b32 v7, 0xffff0000, v196
    v_mul_f32 v6, 4.0, v6
    v_mul_f32 v7, 4.0, v7
    v_mul_f32 v8, v6, v250
    v_mul_f32 v9, v6, v254
    v_fma_f32 v8, -v7, v254, v8
    v_fma_f32 v9, v7, v250, v9
    v_cvt_pk_bf16_f32 v8, v8, -v9
    v_accvgpr_write_b32 a158, v8
    v_lshlrev_b32_e64 v6, 16, v198
    v_and_b32 v7, 0xffff0000, v198
    v_mul_f32 v6, 4.0, v6
    v_mul_f32 v7, 4.0, v7
    v_mul_f32 v8, v6, v251
    v_mul_f32 v9, v6, v255
    v_fma_f32 v8, -v7, v255, v8
    v_fma_f32 v9, v7, v251, v9
    v_cvt_pk_bf16_f32 v8, v8, -v9
    v_accvgpr_write_b32 a159, v8
    s_waitcnt lgkmcnt(0)
    s_barrier
    ds_read2st64_b32 v[240:241], v5 offset0:25 offset1:24
    ds_read2st64_b32 v[244:245], v5 offset0:65 offset1:64
    ds_read2st64_b32 v[184:185], v5 offset0:105 offset1:104
    ds_read2st64_b32 v[186:187], v5 offset0:145 offset1:144
    ds_read2st64_b32 v[242:243], v5 offset0:17 offset1:16
    ds_read2st64_b32 v[246:247], v5 offset0:57 offset1:56
    ds_read2st64_b32 v[188:189], v5 offset0:97 offset1:96
    ds_read2st64_b32 v[190:191], v5 offset0:137 offset1:136
    ds_read2st64_b32 v[248:249], v5 offset0:9 offset1:8
    ds_read2st64_b32 v[252:253], v5 offset0:49 offset1:48
    ds_read2st64_b32 v[192:193], v5 offset0:89 offset1:88
    ds_read2st64_b32 v[194:195], v5 offset0:129 offset1:128
    ds_read2st64_b32 v[250:251], v5 offset0:1 offset1:0
    ds_read2st64_b32 v[254:255], v5 offset0:41 offset1:40
    ds_read2st64_b32 v[196:197], v5 offset0:81 offset1:80
    ds_read2st64_b32 v[198:199], v5 offset0:121 offset1:120
    s_waitcnt lgkmcnt(0)
    s_barrier
    v_xor_b32 v244, 0x80000000, v244
    v_lshlrev_b32_e64 v6, 16, v184
    v_and_b32 v7, 0xffff0000, v184
    v_add_f32 v152, v152, v6
    v_sub_f32 v160, v160, v7
    v_lshlrev_b32_e64 v6, 16, v186
    v_and_b32 v7, 0xffff0000, v186
    v_add_f32 v168, v168, v6
    v_sub_f32 v176, v176, v7
    v_xor_b32 v245, 0x80000000, v245
    v_lshlrev_b32_e64 v6, 16, v185
    v_and_b32 v7, 0xffff0000, v185
    v_add_f32 v153, v153, v6
    v_sub_f32 v161, v161, v7
    v_lshlrev_b32_e64 v6, 16, v187
    v_and_b32 v7, 0xffff0000, v187
    v_add_f32 v169, v169, v6
    v_sub_f32 v177, v177, v7
    v_xor_b32 v246, 0x80000000, v246
    v_lshlrev_b32_e64 v6, 16, v188
    v_and_b32 v7, 0xffff0000, v188
    v_add_f32 v154, v154, v6
    v_sub_f32 v162, v162, v7
    v_lshlrev_b32_e64 v6, 16, v190
    v_and_b32 v7, 0xffff0000, v190
    v_add_f32 v170, v170, v6
    v_sub_f32 v178, v178, v7
    v_xor_b32 v247, 0x80000000, v247
    v_lshlrev_b32_e64 v6, 16, v189
    v_and_b32 v7, 0xffff0000, v189
    v_add_f32 v155, v155, v6
    v_sub_f32 v163, v163, v7
    v_lshlrev_b32_e64 v6, 16, v191
    v_and_b32 v7, 0xffff0000, v191
    v_add_f32 v171, v171, v6
    v_sub_f32 v179, v179, v7
    v_xor_b32 v252, 0x80000000, v252
    v_lshlrev_b32_e64 v6, 16, v192
    v_and_b32 v7, 0xffff0000, v192
    v_add_f32 v156, v156, v6
    v_sub_f32 v164, v164, v7
    v_lshlrev_b32_e64 v6, 16, v194
    v_and_b32 v7, 0xffff0000, v194
    v_add_f32 v172, v172, v6
    v_sub_f32 v180, v180, v7
    v_xor_b32 v253, 0x80000000, v253
    v_lshlrev_b32_e64 v6, 16, v193
    v_and_b32 v7, 0xffff0000, v193
    v_add_f32 v157, v157, v6
    v_sub_f32 v165, v165, v7
    v_lshlrev_b32_e64 v6, 16, v195
    v_and_b32 v7, 0xffff0000, v195
    v_add_f32 v173, v173, v6
    v_sub_f32 v181, v181, v7
    v_xor_b32 v254, 0x80000000, v254
    v_lshlrev_b32_e64 v6, 16, v196
    v_and_b32 v7, 0xffff0000, v196
    v_add_f32 v158, v158, v6
    v_sub_f32 v166, v166, v7
    v_lshlrev_b32_e64 v6, 16, v198
    v_and_b32 v7, 0xffff0000, v198
    v_add_f32 v174, v174, v6
    v_sub_f32 v182, v182, v7
    v_xor_b32 v255, 0x80000000, v255
    v_lshlrev_b32_e64 v6, 16, v197
    v_and_b32 v7, 0xffff0000, v197
    v_add_f32 v159, v159, v6
    v_sub_f32 v167, v167, v7
    v_lshlrev_b32_e64 v6, 16, v199
    v_and_b32 v7, 0xffff0000, v199
    v_add_f32 v175, v175, v6
    v_sub_f32 v183, v183, v7
    s_add_u32 s38, s62, 1
    v_mov_b32 v6, s38
    v_mov_b32 v7, 22315008
    buffer_store_dword v6, v7, s[24:27], 0 offen sc1
K_NOSPECIAL:
    v_pk_add_f32 v[4:5], v[224:225], v[240:241] neg_lo:[0,1] neg_hi:[0,1]
    s_lshl_b32 s68, s92, 6
    s_nop 0
    v_pk_add_f32 v[6:7], v[228:229], v[244:245] neg_lo:[0,1] neg_hi:[0,1]
    v_pk_add_f32 v[224:225], v[224:225], v[240:241]
    v_pk_add_f32 v[228:229], v[228:229], v[244:245]
    v_pk_mul_f32 v[8:9], v[4:5], s[42:43] op_sel_hi:[1,0]
    v_pk_mul_f32 v[10:11], v[6:7], s[42:43] op_sel_hi:[1,0]
    v_pk_fma_f32 v[8:9], v[6:7], s[42:43], v[8:9] op_sel:[0,1,0] neg_lo:[1,0,0] neg_hi:[1,0,0]
    v_pk_fma_f32 v[10:11], v[4:5], s[42:43], v[10:11] op_sel:[0,1,0]
    v_pk_add_f32 v[240:241], v[224:225], v[8:9] neg_lo:[0,1] neg_hi:[0,1]
    v_pk_add_f32 v[244:245], v[228:229], v[10:11] neg_lo:[0,1] neg_hi:[0,1]
    s_and_b32 s69, s34, 1
    s_nop 0
    v_pk_add_f32 v[224:225], v[224:225], v[8:9]
    v_pk_add_f32 v[228:229], v[228:229], v[10:11]
    v_pk_mul_f32 v[4:5], v[224:225], v[152:153]
    v_pk_mul_f32 v[6:7], v[228:229], v[152:153]
    v_pk_mul_f32 v[8:9], v[240:241], v[168:169]
    v_pk_mul_f32 v[10:11], v[244:245], v[168:169]
    v_pk_fma_f32 v[4:5], v[228:229], v[160:161], v[4:5] neg_lo:[1,0,0] neg_hi:[1,0,0]
    v_pk_fma_f32 v[6:7], v[224:225], v[160:161], v[6:7]
    v_pk_fma_f32 v[8:9], v[244:245], v[176:177], v[8:9]
    s_lshl_b32 s69, s69, 5
    s_nop 0
    v_pk_fma_f32 v[10:11], v[240:241], v[176:177], v[10:11] neg_lo:[1,0,0] neg_hi:[1,0,0]
    v_pk_add_f32 v[240:241], v[4:5], v[8:9] neg_lo:[0,1] neg_hi:[0,1]
    v_pk_add_f32 v[244:245], v[6:7], v[10:11] neg_lo:[0,1] neg_hi:[0,1]
    v_pk_add_f32 v[224:225], v[4:5], v[8:9]
    v_pk_add_f32 v[228:229], v[6:7], v[10:11]
    v_pk_mul_f32 v[4:5], v[240:241], s[42:43] op_sel_hi:[1,0]
    v_pk_mul_f32 v[6:7], v[244:245], s[42:43] op_sel_hi:[1,0]
    v_pk_fma_f32 v[4:5], v[244:245], s[42:43], v[4:5] op_sel:[0,1,0]
    v_pk_fma_f32 v[6:7], v[240:241], s[42:43], v[6:7] op_sel:[0,1,0] neg_lo:[1,0,0] neg_hi:[1,0,0]
    s_add_u32 s68, s68, s69
    s_nop 0
    v_pk_add_f32 v[240:241], v[224:225], v[4:5] neg_lo:[0,1] neg_hi:[0,1]
    v_pk_add_f32 v[244:245], v[228:229], v[6:7] neg_lo:[0,1] neg_hi:[0,1]
    v_pk_add_f32 v[224:225], v[224:225], v[4:5]
    v_pk_add_f32 v[228:229], v[228:229], v[6:7]
    v_cvt_pk_bf16_f32 v184, v224, -v228
    v_cvt_pk_bf16_f32 v185, v225, -v229
    v_cvt_pk_bf16_f32 v192, v240, -v244
    v_cvt_pk_bf16_f32 v193, v241, -v245
    v_pk_add_f32 v[4:5], v[226:227], v[242:243] neg_lo:[0,1] neg_hi:[0,1]
    s_lshl_b32 s68, s68, 11
    s_nop 0
    v_pk_add_f32 v[6:7], v[230:231], v[246:247] neg_lo:[0,1] neg_hi:[0,1]
    v_pk_add_f32 v[226:227], v[226:227], v[242:243]
    v_pk_add_f32 v[230:231], v[230:231], v[246:247]
    v_pk_mul_f32 v[8:9], v[4:5], s[42:43] op_sel_hi:[1,0]
    v_pk_mul_f32 v[10:11], v[6:7], s[42:43] op_sel_hi:[1,0]
    v_pk_fma_f32 v[8:9], v[6:7], s[42:43], v[8:9] op_sel:[0,1,0] neg_lo:[1,0,0] neg_hi:[1,0,0]
    v_pk_fma_f32 v[10:11], v[4:5], s[42:43], v[10:11] op_sel:[0,1,0]
    v_pk_add_f32 v[242:243], v[226:227], v[8:9] neg_lo:[0,1] neg_hi:[0,1]
    v_pk_add_f32 v[246:247], v[230:231], v[10:11] neg_lo:[0,1] neg_hi:[0,1]
    s_and_b32 s69, s33, 8
    s_nop 0
    v_pk_add_f32 v[226:227], v[226:227], v[8:9]
    v_pk_add_f32 v[230:231], v[230:231], v[10:11]
    v_pk_mul_f32 v[4:5], v[226:227], v[154:155]
    v_pk_mul_f32 v[6:7], v[230:231], v[154:155]
    v_pk_mul_f32 v[8:9], v[242:243], v[170:171]
    v_pk_mul_f32 v[10:11], v[246:247], v[170:171]
    v_pk_fma_f32 v[4:5], v[230:231], v[162:163], v[4:5] neg_lo:[1,0,0] neg_hi:[1,0,0]
    v_pk_fma_f32 v[6:7], v[226:227], v[162:163], v[6:7]
    v_pk_fma_f32 v[8:9], v[246:247], v[178:179], v[8:9]
    s_lshl_b32 s69, s69, 7
    s_nop 0
    v_pk_fma_f32 v[10:11], v[242:243], v[178:179], v[10:11] neg_lo:[1,0,0] neg_hi:[1,0,0]
    v_pk_add_f32 v[242:243], v[4:5], v[8:9] neg_lo:[0,1] neg_hi:[0,1]
    v_pk_add_f32 v[246:247], v[6:7], v[10:11] neg_lo:[0,1] neg_hi:[0,1]
    v_pk_add_f32 v[226:227], v[4:5], v[8:9]
    v_pk_add_f32 v[230:231], v[6:7], v[10:11]
    v_pk_mul_f32 v[4:5], v[242:243], s[42:43] op_sel_hi:[1,0]
    v_pk_mul_f32 v[6:7], v[246:247], s[42:43] op_sel_hi:[1,0]
    v_pk_fma_f32 v[4:5], v[246:247], s[42:43], v[4:5] op_sel:[0,1,0]
    v_pk_fma_f32 v[6:7], v[242:243], s[42:43], v[6:7] op_sel:[0,1,0] neg_lo:[1,0,0] neg_hi:[1,0,0]
    s_add_u32 s68, s68, s69
    s_nop 0
    v_pk_add_f32 v[242:243], v[226:227], v[4:5] neg_lo:[0,1] neg_hi:[0,1]
    v_pk_add_f32 v[246:247], v[230:231], v[6:7] neg_lo:[0,1] neg_hi:[0,1]
    v_pk_add_f32 v[226:227], v[226:227], v[4:5]
    v_pk_add_f32 v[230:231], v[230:231], v[6:7]
    v_cvt_pk_bf16_f32 v186, v226, -v230
    v_cvt_pk_bf16_f32 v187, v227, -v231
    v_cvt_pk_bf16_f32 v194, v242, -v246
    v_cvt_pk_bf16_f32 v195, v243, -v247
    v_pk_add_f32 v[4:5], v[232:233], v[248:249] neg_lo:[0,1] neg_hi:[0,1]
    s_and_b32 s69, s32, 3
    s_nop 0
    v_pk_add_f32 v[6:7], v[236:237], v[252:253] neg_lo:[0,1] neg_hi:[0,1]
    v_pk_add_f32 v[232:233], v[232:233], v[248:249]
    v_pk_add_f32 v[236:237], v[236:237], v[252:253]
    v_pk_mul_f32 v[8:9], v[4:5], s[42:43] op_sel_hi:[1,0]
    v_pk_mul_f32 v[10:11], v[6:7], s[42:43] op_sel_hi:[1,0]
    v_pk_fma_f32 v[8:9], v[6:7], s[42:43], v[8:9] op_sel:[0,1,0] neg_lo:[1,0,0] neg_hi:[1,0,0]
    v_pk_fma_f32 v[10:11], v[4:5], s[42:43], v[10:11] op_sel:[0,1,0]
    v_pk_add_f32 v[248:249], v[232:233], v[8:9] neg_lo:[0,1] neg_hi:[0,1]
    v_pk_add_f32 v[252:253], v[236:237], v[10:11] neg_lo:[0,1] neg_hi:[0,1]
    s_lshl_b32 s69, s69, 8
    s_nop 0
    v_pk_add_f32 v[232:233], v[232:233], v[8:9]
    v_pk_add_f32 v[236:237], v[236:237], v[10:11]
    v_pk_mul_f32 v[4:5], v[232:233], v[156:157]
    v_pk_mul_f32 v[6:7], v[236:237], v[156:157]
    v_pk_mul_f32 v[8:9], v[248:249], v[172:173]
    v_pk_mul_f32 v[10:11], v[252:253], v[172:173]
    v_pk_fma_f32 v[4:5], v[236:237], v[164:165], v[4:5] neg_lo:[1,0,0] neg_hi:[1,0,0]
    v_pk_fma_f32 v[6:7], v[232:233], v[164:165], v[6:7]
    v_pk_fma_f32 v[8:9], v[252:253], v[180:181], v[8:9]
    s_add_u32 s68, s68, s69
    s_nop 0
    v_pk_fma_f32 v[10:11], v[248:249], v[180:181], v[10:11] neg_lo:[1,0,0] neg_hi:[1,0,0]
    v_pk_add_f32 v[248:249], v[4:5], v[8:9] neg_lo:[0,1] neg_hi:[0,1]
    v_pk_add_f32 v[252:253], v[6:7], v[10:11] neg_lo:[0,1] neg_hi:[0,1]
    v_pk_add_f32 v[232:233], v[4:5], v[8:9]
    v_pk_add_f32 v[236:237], v[6:7], v[10:11]
    v_pk_mul_f32 v[4:5], v[248:249], s[42:43] op_sel_hi:[1,0]
    v_pk_mul_f32 v[6:7], v[252:253], s[42:43] op_sel_hi:[1,0]
    v_pk_fma_f32 v[4:5], v[252:253], s[42:43], v[4:5] op_sel:[0,1,0]
    v_pk_fma_f32 v[6:7], v[248:249], s[42:43], v[6:7] op_sel:[0,1,0] neg_lo:[1,0,0] neg_hi:[1,0,0]
    v_lshrrev_b32_e64 v28, 1, v0
    v_pk_add_f32 v[248:249], v[232:233], v[4:5] neg_lo:[0,1] neg_hi:[0,1]
    v_pk_add_f32 v[252:253], v[236:237], v[6:7] neg_lo:[0,1] neg_hi:[0,1]
    v_pk_add_f32 v[232:233], v[232:233], v[4:5]
    v_pk_add_f32 v[236:237], v[236:237], v[6:7]
    v_cvt_pk_bf16_f32 v188, v232, -v236
    v_cvt_pk_bf16_f32 v189, v233, -v237
    v_cvt_pk_bf16_f32 v196, v248, -v252
    v_cvt_pk_bf16_f32 v197, v249, -v253
    v_pk_add_f32 v[4:5], v[234:235], v[250:251] neg_lo:[0,1] neg_hi:[0,1]
    v_lshlrev_b32_e64 v28, 11, v28
    v_pk_add_f32 v[6:7], v[238:239], v[254:255] neg_lo:[0,1] neg_hi:[0,1]
    v_pk_add_f32 v[234:235], v[234:235], v[250:251]
    v_pk_add_f32 v[238:239], v[238:239], v[254:255]
    v_pk_mul_f32 v[8:9], v[4:5], s[42:43] op_sel_hi:[1,0]
    v_pk_mul_f32 v[10:11], v[6:7], s[42:43] op_sel_hi:[1,0]
    v_pk_fma_f32 v[8:9], v[6:7], s[42:43], v[8:9] op_sel:[0,1,0] neg_lo:[1,0,0] neg_hi:[1,0,0]
    v_pk_fma_f32 v[10:11], v[4:5], s[42:43], v[10:11] op_sel:[0,1,0]
    v_pk_add_f32 v[250:251], v[234:235], v[8:9] neg_lo:[0,1] neg_hi:[0,1]
    v_pk_add_f32 v[254:255], v[238:239], v[10:11] neg_lo:[0,1] neg_hi:[0,1]
    v_and_b32_e64 v29, 1, v0
    v_pk_add_f32 v[234:235], v[234:235], v[8:9]
    v_pk_add_f32 v[238:239], v[238:239], v[10:11]
    v_pk_mul_f32 v[4:5], v[234:235], v[158:159]
    v_pk_mul_f32 v[6:7], v[238:239], v[158:159]
    v_pk_mul_f32 v[8:9], v[250:251], v[174:175]
    v_pk_mul_f32 v[10:11], v[254:255], v[174:175]
    v_pk_fma_f32 v[4:5], v[238:239], v[166:167], v[4:5] neg_lo:[1,0,0] neg_hi:[1,0,0]
    v_pk_fma_f32 v[6:7], v[234:235], v[166:167], v[6:7]
    v_pk_fma_f32 v[8:9], v[254:255], v[182:183], v[8:9]
    v_lshl_add_u32 v28, v29, 7, v28
    v_pk_fma_f32 v[10:11], v[250:251], v[182:183], v[10:11] neg_lo:[1,0,0] neg_hi:[1,0,0]
    v_pk_add_f32 v[250:251], v[4:5], v[8:9] neg_lo:[0,1] neg_hi:[0,1]
    v_pk_add_f32 v[254:255], v[6:7], v[10:11] neg_lo:[0,1] neg_hi:[0,1]
    v_pk_add_f32 v[234:235], v[4:5], v[8:9]
    v_pk_add_f32 v[238:239], v[6:7], v[10:11]
    v_pk_mul_f32 v[4:5], v[250:251], s[42:43] op_sel_hi:[1,0]
    v_pk_mul_f32 v[6:7], v[254:255], s[42:43] op_sel_hi:[1,0]
    v_pk_fma_f32 v[4:5], v[254:255], s[42:43], v[4:5] op_sel:[0,1,0]
    v_pk_fma_f32 v[6:7], v[250:251], s[42:43], v[6:7] op_sel:[0,1,0] neg_lo:[1,0,0] neg_hi:[1,0,0]
    buffer_load_dword v30, v28, s[16:19], s68 offen
    v_pk_add_f32 v[250:251], v[234:235], v[4:5] neg_lo:[0,1] neg_hi:[0,1]
    v_pk_add_f32 v[254:255], v[238:239], v[6:7] neg_lo:[0,1] neg_hi:[0,1]
    v_pk_add_f32 v[234:235], v[234:235], v[4:5]
    v_pk_add_f32 v[238:239], v[238:239], v[6:7]
    v_cvt_pk_bf16_f32 v190, v234, -v238
    v_cvt_pk_bf16_f32 v191, v235, -v239
    v_cvt_pk_bf16_f32 v198, v250, -v254
    v_cvt_pk_bf16_f32 v199, v251, -v255
    s_cmp_lg_u32 s2, 0
    s_cbranch_scc1 K_NOSPECIAL2
    v_accvgpr_read_b32 v192, a152
    v_accvgpr_read_b32 v193, a153
    v_accvgpr_read_b32 v194, a154
    v_accvgpr_read_b32 v195, a155
    v_accvgpr_read_b32 v196, a156
    v_accvgpr_read_b32 v197, a157
    v_accvgpr_read_b32 v198, a158
    v_accvgpr_read_b32 v199, a159
K_NOSPECIAL2:
    v_pk_mul_f32 v[4:5], v[36:37], v[130:131] op_sel:[0,1]
    v_pk_mul_f32 v[6:7], v[32:33], v[130:131] op_sel:[0,1]
    v_pk_fma_f32 v[32:33], v[32:33], v[130:131], v[4:5] op_sel_hi:[1,0,1] neg_lo:[0,0,1] neg_hi:[0,0,1]
    v_pk_fma_f32 v[36:37], v[36:37], v[130:131], v[6:7] op_sel_hi:[1,0,1]
    v_pk_mul_f32 v[8:9], v[38:39], v[130:131] op_sel:[0,1]
    v_pk_mul_f32 v[10:11], v[34:35], v[130:131] op_sel:[0,1]
    v_pk_fma_f32 v[34:35], v[34:35], v[130:131], v[8:9] op_sel_hi:[1,0,1] neg_lo:[0,0,1] neg_hi:[0,0,1]
    v_pk_fma_f32 v[38:39], v[38:39], v[130:131], v[10:11] op_sel_hi:[1,0,1]
    v_pk_mul_f32 v[4:5], v[44:45], v[130:131] op_sel:[0,1]
    v_pk_mul_f32 v[6:7], v[40:41], v[130:131] op_sel:[0,1]
    v_pk_fma_f32 v[40:41], v[40:41], v[130:131], v[4:5] op_sel_hi:[1,0,1] neg_lo:[0,0,1] neg_hi:[0,0,1]
    v_pk_fma_f32 v[44:45], v[44:45], v[130:131], v[6:7] op_sel_hi:[1,0,1]
    v_pk_mul_f32 v[8:9], v[46:47], v[130:131] op_sel:[0,1]
    v_pk_mul_f32 v[10:11], v[42:43], v[130:131] op_sel:[0,1]
    v_pk_fma_f32 v[42:43], v[42:43], v[130:131], v[8:9] op_sel_hi:[1,0,1] neg_lo:[0,0,1] neg_hi:[0,0,1]
    v_pk_fma_f32 v[46:47], v[46:47], v[130:131], v[10:11] op_sel_hi:[1,0,1]
    v_pk_mul_f32 v[4:5], v[52:53], v[130:131] op_sel:[0,1]
    v_pk_mul_f32 v[6:7], v[48:49], v[130:131] op_sel:[0,1]
    v_pk_fma_f32 v[48:49], v[48:49], v[130:131], v[4:5] op_sel_hi:[1,0,1] neg_lo:[0,0,1] neg_hi:[0,0,1]
    v_pk_fma_f32 v[52:53], v[52:53], v[130:131], v[6:7] op_sel_hi:[1,0,1]
    v_pk_mul_f32 v[8:9], v[54:55], v[130:131] op_sel:[0,1]
    v_pk_mul_f32 v[10:11], v[50:51], v[130:131] op_sel:[0,1]
    v_pk_fma_f32 v[50:51], v[50:51], v[130:131], v[8:9] op_sel_hi:[1,0,1] neg_lo:[0,0,1] neg_hi:[0,0,1]
    v_pk_fma_f32 v[54:55], v[54:55], v[130:131], v[10:11] op_sel_hi:[1,0,1]
    v_pk_mul_f32 v[4:5], v[60:61], v[130:131] op_sel:[0,1]
    v_pk_mul_f32 v[6:7], v[56:57], v[130:131] op_sel:[0,1]
    v_pk_fma_f32 v[56:57], v[56:57], v[130:131], v[4:5] op_sel_hi:[1,0,1] neg_lo:[0,0,1] neg_hi:[0,0,1]
    v_pk_fma_f32 v[60:61], v[60:61], v[130:131], v[6:7] op_sel_hi:[1,0,1]
    v_pk_mul_f32 v[8:9], v[62:63], v[130:131] op_sel:[0,1]
    v_pk_mul_f32 v[10:11], v[58:59], v[130:131] op_sel:[0,1]
    v_pk_fma_f32 v[58:59], v[58:59], v[130:131], v[8:9] op_sel_hi:[1,0,1] neg_lo:[0,0,1] neg_hi:[0,0,1]
    v_pk_fma_f32 v[62:63], v[62:63], v[130:131], v[10:11] op_sel_hi:[1,0,1]
    v_pk_mul_f32 v[4:5], v[68:69], v[130:131] op_sel:[0,1]
    v_pk_mul_f32 v[6:7], v[64:65], v[130:131] op_sel:[0,1]
    v_pk_fma_f32 v[64:65], v[64:65], v[130:131], v[4:5] op_sel_hi:[1,0,1] neg_lo:[0,0,1] neg_hi:[0,0,1]
    v_pk_fma_f32 v[68:69], v[68:69], v[130:131], v[6:7] op_sel_hi:[1,0,1]
    v_pk_mul_f32 v[8:9], v[70:71], v[130:131] op_sel:[0,1]
    v_pk_mul_f32 v[10:11], v[66:67], v[130:131] op_sel:[0,1]
    v_pk_fma_f32 v[66:67], v[66:67], v[130:131], v[8:9] op_sel_hi:[1,0,1] neg_lo:[0,0,1] neg_hi:[0,0,1]
    v_pk_fma_f32 v[70:71], v[70:71], v[130:131], v[10:11] op_sel_hi:[1,0,1]
    v_pk_mul_f32 v[4:5], v[76:77], v[130:131] op_sel:[0,1]
    v_pk_mul_f32 v[6:7], v[72:73], v[130:131] op_sel:[0,1]
    v_pk_fma_f32 v[72:73], v[72:73], v[130:131], v[4:5] op_sel_hi:[1,0,1] neg_lo:[0,0,1] neg_hi:[0,0,1]
    v_pk_fma_f32 v[76:77], v[76:77], v[130:131], v[6:7] op_sel_hi:[1,0,1]
    v_pk_mul_f32 v[8:9], v[78:79], v[130:131] op_sel:[0,1]
    v_pk_mul_f32 v[10:11], v[74:75], v[130:131] op_sel:[0,1]
    v_pk_fma_f32 v[74:75], v[74:75], v[130:131], v[8:9] op_sel_hi:[1,0,1] neg_lo:[0,0,1] neg_hi:[0,0,1]
    v_pk_fma_f32 v[78:79], v[78:79], v[130:131], v[10:11] op_sel_hi:[1,0,1]
    v_pk_mul_f32 v[4:5], v[84:85], v[130:131] op_sel:[0,1]
    v_pk_mul_f32 v[6:7], v[80:81], v[130:131] op_sel:[0,1]
    v_pk_fma_f32 v[80:81], v[80:81], v[130:131], v[4:5] op_sel_hi:[1,0,1] neg_lo:[0,0,1] neg_hi:[0,0,1]
    v_pk_fma_f32 v[84:85], v[84:85], v[130:131], v[6:7] op_sel_hi:[1,0,1]
    v_pk_mul_f32 v[8:9], v[86:87], v[130:131] op_sel:[0,1]
    v_pk_mul_f32 v[10:11], v[82:83], v[130:131] op_sel:[0,1]
    v_pk_fma_f32 v[82:83], v[82:83], v[130:131], v[8:9] op_sel_hi:[1,0,1] neg_lo:[0,0,1] neg_hi:[0,0,1]
    v_pk_fma_f32 v[86:87], v[86:87], v[130:131], v[10:11] op_sel_hi:[1,0,1]
    v_pk_mul_f32 v[4:5], v[92:93], v[130:131] op_sel:[0,1]
    v_pk_mul_f32 v[6:7], v[88:89], v[130:131] op_sel:[0,1]
    v_pk_fma_f32 v[88:89], v[88:89], v[130:131], v[4:5] op_sel_hi:[1,0,1] neg_lo:[0,0,1] neg_hi:[0,0,1]
    v_pk_fma_f32 v[92:93], v[92:93], v[130:131], v[6:7] op_sel_hi:[1,0,1]
    v_pk_mul_f32 v[8:9], v[94:95], v[130:131] op_sel:[0,1]
    v_pk_mul_f32 v[10:11], v[90:91], v[130:131] op_sel:[0,1]
    v_pk_fma_f32 v[90:91], v[90:91], v[130:131], v[8:9] op_sel_hi:[1,0,1] neg_lo:[0,0,1] neg_hi:[0,0,1]
    v_pk_fma_f32 v[94:95], v[94:95], v[130:131], v[10:11] op_sel_hi:[1,0,1]
    v_and_b32 v14, 8, v1
    v_and_b32 v15, 3, v1
    v_lshl_or_b32 v14, v15, 1, v14
    v_bfe_u32 v15, v1, 2, 1
    v_or_b32 v14, v14, v15
    v_lshlrev_b32 v15, 2, v2
    v_xor_b32 v14, v14, v15
    v_lshlrev_b32 v14, 4, v14
    v_lshl_add_u32 v14, v1, 8, v14
    s_lshl_b32 s38, s34, 13
    s_add_u32 s38, s38, 131072
    v_add_u32 v152, s38, v14
    v_xor_b32 v153, 16, v152
    v_xor_b32 v154, 32, v152
    v_xor_b32 v155, 48, v152
    v_and_b32 v14, 1, v2
    v_lshrrev_b32_e64 v15, 2, v1
    v_lshl_add_u32 v12, v14, 3, v15
    v_lshlrev_b32 v12, 8, v12
    v_lshrrev_b32 v13, 1, v2
    v_lshl_add_u32 v12, v13, 12, v12
    v_lshlrev_b32_e64 v14, 3, v14
    v_lshl_or_b32 v14, v15, 1, v14
    v_bfe_u32 v15, v1, 1, 1
    v_xor_b32_e64 v14, v14, v15
    v_lshl_add_u32 v12, v14, 4, v12
    v_and_b32_e64 v15, 1, v1
    v_lshl_add_u32 v12, v15, 3, v12
    v_add_u32 v12, 131072, v12
    s_and_b32 s38, s34, 1
    s_lshl_b32 s38, s38, 2
    s_lshr_b32 s39, s34, 1
    s_add_u32 s94, s38, s39
    s_lshl_b32 s38, s94, 5
    v_xor_b32 v156, s38, v12
    v_xor_b32 v157, 16, v156
    v_xor_b32 v158, 64, v156
    v_xor_b32 v159, 80, v156
    s_lshl_b32 s94, s94, 12
    s_waitcnt vmcnt(1)
    s_mov_b32 s71, 0
K_POLL2:
    v_cmp_ne_u32 vcc, 2.0, v148
    v_xor_b32 v4, s35, v98
    s_nop 0
    v_cndmask_b32 v4, 0, v4, vcc
    v_cmp_ne_u32 vcc, 2.0, v149
    v_xor_b32 v5, s35, v102
    s_nop 0
    v_cndmask_b32 v5, 0, v5, vcc
    v_cmp_ne_u32 vcc, 2.0, v150
    v_xor_b32 v6, s35, v106
    s_nop 0
    v_cndmask_b32 v6, 0, v6, vcc
    v_cmp_ne_u32 vcc, 2.0, v151
    v_xor_b32 v7, s35, v110
    s_nop 0
    v_cndmask_b32_e64 v7, 0, v7, vcc
    v_or3_b32 v4, v4, v5, v6
    v_or_b32 v4, v4, v7
    v_cmp_ne_u32 vcc, 0, v4
    s_nop 0
    s_cbranch_vccz K_POLL2_OK
    buffer_load_dwordx4 v[96:99], v148, s[24:27], s93 offen sc1
    buffer_load_dwordx4 v[100:103], v149, s[24:27], s93 offen sc1
    buffer_load_dwordx4 v[104:107], v150, s[24:27], s93 offen sc1
    buffer_load_dwordx4 v[108:111], v151, s[24:27], s93 offen sc1
    s_add_u32 s71, s71, 1
    s_cmp_lt_u32 s71, 200000
    s_waitcnt vmcnt(0)
    s_cbranch_scc1 K_POLL2
K_POLL2_OK:
    v_fma_f32 v4, v108, v136, v104
    s_and_b32 s73, s32, 3
    v_fma_f32 v5, v108, v137, v105
    s_lshl_b32 s73, s73, 1
    v_fma_f32 v4, -v109, v137, v4
    s_add_u32 s73, s73, 2
    v_fma_f32 v5, v109, v136, v5
    v_fma_f32 v6, v4, v136, v100
    s_and_b32 s73, s73, 7
    v_fma_f32 v7, v4, v137, v101
    s_add_u32 s72, s73, s33
    v_fma_f32 v6, -v5, v137, v6
    s_lshl_b32 s73, s73, 14
    v_fma_f32 v7, v5, v136, v7
    v_fma_f32 v4, v6, v136, v96
    s_add_u32 s73, s73, s37
    v_fma_f32 v5, v6, v137, v97
    s_and_b32 s72, s72, 7
    v_fma_f32 v4, -v7, v137, v4
    v_fma_f32 v5, v7, v136, v5
    s_lshl_b32 s72, s72, 7
    v_mul_f32 v6, v4, v140
    s_add_u32 m0, s73, 0
    v_mul_f32_e64 v8, v4, v141
    buffer_load_dwordx4 v16, s[16:19], s72 offen lds
    v_fma_f32 v6, -v5, v141, v6
    v_fma_f32 v8, v5, v140, v8
    s_add_u32 m0, s73, 1024
    v_mov_b32_e64 v7, v6
    buffer_load_dwordx4 v17, s[16:19], s72 offen lds
    v_mov_b32_e64 v9, v8
    s_add_u32 m0, s73, 2048
    v_permlane32_swap_b32 v6, v7
    v_permlane32_swap_b32 v8, v9
    buffer_load_dwordx4 v18, s[16:19], s72 offen lds
    v_add_f32_e64 v6, v6, v7
    s_add_u32 m0, s73, 3072
    v_add_f32 v8, v8, v9
    v_mov_b32 v7, v6
    buffer_load_dwordx4 v19, s[16:19], s72 offen lds
    v_mov_b32 v9, v8
    s_and_b32 s73, s32, 3
    v_permlane16_swap_b32 v6, v7
    s_lshl_b32 s73, s73, 1
    v_permlane16_swap_b32 v8, v9
    v_add_f32 v6, v6, v7
    s_add_u32 s73, s73, 3
    v_add_f32 v8, v8, v9
    s_and_b32 s73, s73, 7
    v_fma_f32 v10, v6, v138, v146
    v_fma_f32 v12, v6, v139, v147
    s_add_u32 s72, s73, s33
    v_fma_f32 v10, -v8, v139, v10
    s_lshl_b32 s73, s73, 14
    v_fma_f32 v12, v8, v138, v12
    s_add_u32 s73, s73, s37
    v_fma_f32 v11, v10, v132, v142
    v_fma_f32 v13, v10, v133, v144
    s_and_b32 s72, s72, 7
    v_fma_f32 v11, -v12, v133, v11
    s_lshl_b32 s72, s72, 7
    v_fma_f32 v13, v12, v132, v13
    s_add_u32 m0, s73, 0
    s_nop 0
    v_pk_fma_f32 v[32:33], v[10:11], v[128:129], v[32:33] op_sel_hi:[1,0,1]
    v_pk_fma_f32 v[36:37], v[12:13], v[128:129], v[36:37] op_sel_hi:[1,0,1]
    buffer_load_dwordx4 v16, s[16:19], s72 offen lds
    v_pk_fma_f32 v[32:33], v[12:13], v[128:129], v[32:33] op_sel:[0,1,0] neg_lo:[1,0,0] neg_hi:[1,0,0]
    s_add_u32 m0, s73, 1024
    v_pk_fma_f32 v[36:37], v[10:11], v[128:129], v[36:37] op_sel:[0,1,0]
    v_pk_fma_f32 v[34:35], v[32:33], v[128:129], v[34:35] op_sel_hi:[1,0,1]
    buffer_load_dwordx4 v17, s[16:19], s72 offen lds
    v_pk_fma_f32 v[38:39], v[36:37], v[128:129], v[38:39] op_sel_hi:[1,0,1]
    s_add_u32 m0, s73, 2048
    v_pk_fma_f32 v[34:35], v[36:37], v[128:129], v[34:35] op_sel:[0,1,0] neg_lo:[1,0,0] neg_hi:[1,0,0]
    buffer_load_dwordx4 v18, s[16:19], s72 offen lds
    v_pk_fma_f32 v[38:39], v[32:33], v[128:129], v[38:39] op_sel:[0,1,0]
    v_cvt_pk_bf16_f32 v224, v32, v34
    s_add_u32 m0, s73, 3072
    v_cvt_pk_bf16_f32 v232, v33, v35
    buffer_load_dwordx4 v19, s[16:19], s72 offen lds
    v_cvt_pk_bf16_f32 v240, -v36, -v38
    v_cvt_pk_bf16_f32 v248, -v37, -v39
    s_and_b32 s73, s32, 3
    v_pk_fma_f32 v[40:41], v[34:35], v[128:129], v[40:41] op_sel_hi:[1,0,1]
    s_lshl_b32 s73, s73, 1
    v_pk_fma_f32 v[44:45], v[38:39], v[128:129], v[44:45] op_sel_hi:[1,0,1]
    s_add_u32 s73, s73, 4
    v_pk_fma_f32 v[40:41], v[38:39], v[128:129], v[40:41] op_sel:[0,1,0] neg_lo:[1,0,0] neg_hi:[1,0,0]
    v_pk_fma_f32 v[44:45], v[34:35], v[128:129], v[44:45] op_sel:[0,1,0]
    s_and_b32 s73, s73, 7
    v_pk_fma_f32 v[42:43], v[40:41], v[128:129], v[42:43] op_sel_hi:[1,0,1]
    s_add_u32 s72, s73, s33
    v_pk_fma_f32 v[46:47], v[44:45], v[128:129], v[46:47] op_sel_hi:[1,0,1]
    s_lshl_b32 s73, s73, 14
    v_pk_fma_f32 v[42:43], v[44:45], v[128:129], v[42:43] op_sel:[0,1,0] neg_lo:[1,0,0] neg_hi:[1,0,0]
    v_pk_fma_f32 v[46:47], v[40:41], v[128:129], v[46:47] op_sel:[0,1,0]
    s_add_u32 s73, s73, s37
    v_cvt_pk_bf16_f32 v225, v40, v42
    s_and_b32 s72, s72, 7
    v_cvt_pk_bf16_f32 v233, v41, v43
    v_cvt_pk_bf16_f32 v241, -v44, -v46
    s_lshl_b32 s72, s72, 7
    v_cvt_pk_bf16_f32 v249, -v45, -v47
    s_add_u32 m0, s73, 0
    v_pk_fma_f32 v[48:49], v[42:43], v[128:129], v[48:49] op_sel_hi:[1,0,1]
    buffer_load_dwordx4 v16, s[16:19], s72 offen lds
    v_pk_fma_f32 v[52:53], v[46:47], v[128:129], v[52:53] op_sel_hi:[1,0,1]
    v_pk_fma_f32 v[48:49], v[46:47], v[128:129], v[48:49] op_sel:[0,1,0] neg_lo:[1,0,0] neg_hi:[1,0,0]
    s_add_u32 m0, s73, 1024
    v_pk_fma_f32 v[52:53], v[42:43], v[128:129], v[52:53] op_sel:[0,1,0]
    buffer_load_dwordx4 v17, s[16:19], s72 offen lds
    v_pk_fma_f32 v[50:51], v[48:49], v[128:129], v[50:51] op_sel_hi:[1,0,1]
    s_add_u32 m0, s73, 2048
    v_pk_fma_f32 v[54:55], v[52:53], v[128:129], v[54:55] op_sel_hi:[1,0,1]
    v_pk_fma_f32 v[50:51], v[52:53], v[128:129], v[50:51] op_sel:[0,1,0] neg_lo:[1,0,0] neg_hi:[1,0,0]
    buffer_load_dwordx4 v18, s[16:19], s72 offen lds
    v_pk_fma_f32 v[54:55], v[48:49], v[128:129], v[54:55] op_sel:[0,1,0]
    s_add_u32 m0, s73, 3072
    v_cvt_pk_bf16_f32 v226, v48, v50
    v_cvt_pk_bf16_f32 v234, v49, v51
    buffer_load_dwordx4 v19, s[16:19], s72 offen lds
    v_cvt_pk_bf16_f32 v242, -v52, -v54
    s_and_b32 s73, s32, 3
    v_cvt_pk_bf16_f32 v250, -v53, -v55
    s_lshl_b32 s73, s73, 1
    v_pk_fma_f32 v[56:57], v[50:51], v[128:129], v[56:57] op_sel_hi:[1,0,1]
    v_pk_fma_f32 v[60:61], v[54:55], v[128:129], v[60:61] op_sel_hi:[1,0,1]
    s_add_u32 s73, s73, 5
    v_pk_fma_f32 v[56:57], v[54:55], v[128:129], v[56:57] op_sel:[0,1,0] neg_lo:[1,0,0] neg_hi:[1,0,0]
    s_and_b32 s73, s73, 7
    v_pk_fma_f32 v[60:61], v[50:51], v[128:129], v[60:61] op_sel:[0,1,0]
    v_pk_fma_f32 v[58:59], v[56:57], v[128:129], v[58:59] op_sel_hi:[1,0,1]
    s_add_u32 s72, s73, s33
    v_pk_fma_f32 v[62:63], v[60:61], v[128:129], v[62:63] op_sel_hi:[1,0,1]
    s_lshl_b32 s73, s73, 14
    v_pk_fma_f32 v[58:59], v[60:61], v[128:129], v[58:59] op_sel:[0,1,0] neg_lo:[1,0,0] neg_hi:[1,0,0]
    s_add_u32 s73, s73, s37
    v_pk_fma_f32 v[62:63], v[56:57], v[128:129], v[62:63] op_sel:[0,1,0]
    v_cvt_pk_bf16_f32 v227, v56, v58
    s_and_b32 s72, s72, 7
    v_cvt_pk_bf16_f32 v235, v57, v59
    s_lshl_b32 s72, s72, 7
    v_cvt_pk_bf16_f32 v243, -v60, -v62
    s_add_u32 m0, s73, 0
    v_cvt_pk_bf16_f32 v251, -v61, -v63
    s_barrier
    s_nop 0
    buffer_load_dwordx4 v16, s[16:19], s72 offen lds
    ds_write_b128 v152, v[224:227] offset:0
    s_add_u32 m0, s73, 1024
    ds_write_b128 v154, v[232:235] offset:0
    ds_write_b128 v152, v[240:243] offset:4096
    buffer_load_dwordx4 v17, s[16:19], s72 offen lds
    ds_write_b128 v154, v[248:251] offset:4096
    s_add_u32 m0, s73, 2048
    v_pk_fma_f32 v[64:65], v[58:59], v[128:129], v[64:65] op_sel_hi:[1,0,1]
    buffer_load_dwordx4 v18, s[16:19], s72 offen lds
    v_pk_fma_f32 v[68:69], v[62:63], v[128:129], v[68:69] op_sel_hi:[1,0,1]
    v_pk_fma_f32 v[64:65], v[62:63], v[128:129], v[64:65] op_sel:[0,1,0] neg_lo:[1,0,0] neg_hi:[1,0,0]
    s_add_u32 m0, s73, 3072
    v_pk_fma_f32 v[68:69], v[58:59], v[128:129], v[68:69] op_sel:[0,1,0]
    buffer_load_dwordx4 v19, s[16:19], s72 offen lds
    v_pk_fma_f32 v[66:67], v[64:65], v[128:129], v[66:67] op_sel_hi:[1,0,1]
    v_pk_fma_f32 v[70:71], v[68:69], v[128:129], v[70:71] op_sel_hi:[1,0,1]
    s_and_b32 s73, s32, 3
    v_pk_fma_f32 v[66:67], v[68:69], v[128:129], v[66:67] op_sel:[0,1,0] neg_lo:[1,0,0] neg_hi:[1,0,0]
    s_lshl_b32 s73, s73, 1
    v_pk_fma_f32 v[70:71], v[64:65], v[128:129], v[70:71] op_sel:[0,1,0]
    s_add_u32 s73, s73, 6
    v_cvt_pk_bf16_f32 v228, v64, v66
    v_cvt_pk_bf16_f32 v236, v65, v67
    s_and_b32 s73, s73, 7
    v_cvt_pk_bf16_f32 v244, -v68, -v70
    s_add_u32 s72, s73, s33
    v_cvt_pk_bf16_f32 v252, -v69, -v71
    s_lshl_b32 s73, s73, 14
    v_pk_fma_f32 v[72:73], v[66:67], v[128:129], v[72:73] op_sel_hi:[1,0,1]
    v_pk_fma_f32 v[76:77], v[70:71], v[128:129], v[76:77] op_sel_hi:[1,0,1]
    s_add_u32 s73, s73, s37
    v_pk_fma_f32 v[72:73], v[70:71], v[128:129], v[72:73] op_sel:[0,1,0] neg_lo:[1,0,0] neg_hi:[1,0,0]
    s_and_b32 s72, s72, 7
    v_pk_fma_f32 v[76:77], v[66:67], v[128:129], v[76:77] op_sel:[0,1,0]
    v_pk_fma_f32 v[74:75], v[72:73], v[128:129], v[74:75] op_sel_hi:[1,0,1]
    s_lshl_b32 s72, s72, 7
    v_pk_fma_f32 v[78:79], v[76:77], v[128:129], v[78:79] op_sel_hi:[1,0,1]
    s_add_u32 m0, s73, 0
    v_pk_fma_f32 v[74:75], v[76:77], v[128:129], v[74:75] op_sel:[0,1,0] neg_lo:[1,0,0] neg_hi:[1,0,0]
    buffer_load_dwordx4 v16, s[16:19], s72 offen lds
    v_pk_fma_f32 v[78:79], v[72:73], v[128:129], v[78:79] op_sel:[0,1,0]
    v_cvt_pk_bf16_f32 v229, v72, v74
    s_add_u32 m0, s73, 1024
    v_cvt_pk_bf16_f32 v237, v73, v75
    buffer_load_dwordx4 v17, s[16:19], s72 offen lds
    v_cvt_pk_bf16_f32 v245, -v76, -v78
    s_add_u32 m0, s73, 2048
    v_cvt_pk_bf16_f32 v253, -v77, -v79
    v_pk_fma_f32 v[80:81], v[74:75], v[128:129], v[80:81] op_sel_hi:[1,0,1]
    buffer_load_dwordx4 v18, s[16:19], s72 offen lds
    v_pk_fma_f32 v[84:85], v[78:79], v[128:129], v[84:85] op_sel_hi:[1,0,1]
    s_add_u32 m0, s73, 3072
    v_pk_fma_f32 v[80:81], v[78:79], v[128:129], v[80:81] op_sel:[0,1,0] neg_lo:[1,0,0] neg_hi:[1,0,0]
    v_pk_fma_f32 v[84:85], v[74:75], v[128:129], v[84:85] op_sel:[0,1,0]
    buffer_load_dwordx4 v19, s[16:19], s72 offen lds
    v_pk_fma_f32 v[82:83], v[80:81], v[128:129], v[82:83] op_sel_hi:[1,0,1]
    s_and_b32 s73, s32, 3
    v_pk_fma_f32 v[86:87], v[84:85], v[128:129], v[86:87] op_sel_hi:[1,0,1]
    s_lshl_b32 s73, s73, 1
    v_pk_fma_f32 v[82:83], v[84:85], v[128:129], v[82:83] op_sel:[0,1,0] neg_lo:[1,0,0] neg_hi:[1,0,0]
    v_pk_fma_f32 v[86:87], v[80:81], v[128:129], v[86:87] op_sel:[0,1,0]
    s_add_u32 s73, s73, 7
    v_cvt_pk_bf16_f32 v230, v80, v82
    s_and_b32 s73, s73, 7
    v_cvt_pk_bf16_f32 v238, v81, v83
    v_cvt_pk_bf16_f32 v246, -v84, -v86
    s_add_u32 s72, s73, s33
    v_cvt_pk_bf16_f32 v254, -v85, -v87
    s_lshl_b32 s73, s73, 14
    v_pk_fma_f32 v[88:89], v[82:83], v[128:129], v[88:89] op_sel_hi:[1,0,1]
    s_add_u32 s73, s73, s37
    v_pk_fma_f32 v[92:93], v[86:87], v[128:129], v[92:93] op_sel_hi:[1,0,1]
    v_pk_fma_f32 v[88:89], v[86:87], v[128:129], v[88:89] op_sel:[0,1,0] neg_lo:[1,0,0] neg_hi:[1,0,0]
    s_and_b32 s72, s72, 7
    v_pk_fma_f32 v[92:93], v[82:83], v[128:129], v[92:93] op_sel:[0,1,0]
    s_lshl_b32 s72, s72, 7
    v_pk_fma_f32 v[90:91], v[88:89], v[128:129], v[90:91] op_sel_hi:[1,0,1]
    s_add_u32 m0, s73, 0
    v_pk_fma_f32 v[94:95], v[92:93], v[128:129], v[94:95] op_sel_hi:[1,0,1]
    v_pk_fma_f32 v[90:91], v[92:93], v[128:129], v[90:91] op_sel:[0,1,0] neg_lo:[1,0,0] neg_hi:[1,0,0]
    buffer_load_dwordx4 v16, s[16:19], s72 offen lds
    v_pk_fma_f32 v[94:95], v[88:89], v[128:129], v[94:95] op_sel:[0,1,0]
    s_add_u32 m0, s73, 1024
    v_cvt_pk_bf16_f32 v231, v88, v90
    v_cvt_pk_bf16_f32 v239, v89, v91
    buffer_load_dwordx4 v17, s[16:19], s72 offen lds
    v_cvt_pk_bf16_f32 v247, -v92, -v94
    s_add_u32 m0, s73, 2048
    v_cvt_pk_bf16_f32 v255, -v93, -v95
    buffer_load_dwordx4 v18, s[16:19], s72 offen lds
    ds_write_b128 v153, v[228:231] offset:0
    ds_write_b128 v155, v[236:239] offset:0
    s_add_u32 m0, s73, 3072
    ds_write_b128 v153, v[244:247] offset:4096
    buffer_load_dwordx4 v19, s[16:19], s72 offen lds
    ds_write_b128 v155, v[252:255] offset:4096
    s_waitcnt lgkmcnt(0)
    s_barrier
    ds_read_b64_tr_b16 v[64:65], v156 offset:0
    ds_read_b64_tr_b16 v[66:67], v157 offset:1024
    ds_read_b64_tr_b16 v[68:69], v156 offset:8192
    ds_read_b64_tr_b16 v[70:71], v157 offset:9216
    ds_read_b64_tr_b16 v[72:73], v156 offset:16384
    ds_read_b64_tr_b16 v[74:75], v157 offset:17408
    ds_read_b64_tr_b16 v[76:77], v156 offset:24576
    ds_read_b64_tr_b16 v[78:79], v157 offset:25600
    ds_read_b64_tr_b16 v[80:81], v158 offset:0
    ds_read_b64_tr_b16 v[82:83], v159 offset:1024
    ds_read_b64_tr_b16 v[84:85], v158 offset:8192
    ds_read_b64_tr_b16 v[86:87], v159 offset:9216
    ds_read_b64_tr_b16 v[88:89], v158 offset:16384
    ds_read_b64_tr_b16 v[90:91], v159 offset:17408
    ds_read_b64_tr_b16 v[92:93], v158 offset:24576
    ds_read_b64_tr_b16 v[94:95], v159 offset:25600
    v_mfma_f32_16x16x32_bf16 v[224:227], v[184:187], a[0:3], 0
    s_mul_i32 s68, s2, 32768
    s_add_u32 s68, s68, s94
    v_bfe_u32 v12, v1, 1, 1
    v_mfma_f32_16x16x32_bf16 v[228:231], v[184:187], a[4:7], 0
    s_add_u32 s68, s68, 0
    v_mul_u32_u24 v12, 4112, v12
    v_mfma_f32_16x16x32_bf16 v[232:235], v[184:187], a[16:19], 0
    s_add_u32 s69, s68, 8192
    v_mfma_f32_16x16x32_bf16 v[236:239], v[184:187], a[20:23], 0
    s_waitcnt lgkmcnt(14)
    v_and_b32 v13, 1, v1
    v_mfma_f32_16x16x32_bf16 v[240:243], v[192:195], a[0:3], 0
    buffer_store_dwordx4 v[64:67], v3, s[24:27], s68 offen offset:0 sc1
    s_waitcnt lgkmcnt(12)
    s_nop 0
    v_lshl_add_u32 v12, v13, 5, v12
    v_mfma_f32_16x16x32_bf16 v[244:247], v[192:195], a[4:7], 0
    buffer_store_dwordx4 v[68:71], v3, s[24:27], s68 offen offset:1024 sc1
    v_mfma_f32_16x16x32_bf16 v[248:251], v[192:195], a[16:19], 0
    s_waitcnt lgkmcnt(10)
    v_and_b32 v13, 60, v0
    v_mfma_f32_16x16x32_bf16 v[252:255], v[192:195], a[20:23], 0
    buffer_store_dwordx4 v[72:75], v3, s[24:27], s68 offen offset:2048 sc1
    v_mfma_f32_16x16x32_bf16 v[224:227], v[188:191], a[8:11], v[224:227]
    s_waitcnt lgkmcnt(8)
    buffer_store_dwordx4 v[76:79], v3, s[24:27], s68 offen offset:3072 sc1
    v_lshl_add_u32 v12, v13, 4, v12
    v_mfma_f32_16x16x32_bf16 v[228:231], v[188:191], a[12:15], v[228:231]
    s_waitcnt lgkmcnt(6)
    s_lshl_b32 s38, s34, 10
    v_mfma_f32_16x16x32_bf16 v[232:235], v[188:191], a[24:27], v[232:235]
    buffer_store_dwordx4 v[80:83], v3, s[24:27], s69 offen offset:0 sc1
    v_mfma_f32_16x16x32_bf16 v[236:239], v[188:191], a[28:31], v[236:239]
    s_waitcnt lgkmcnt(4)
    s_add_u32 s38, s38, 131072
    v_mfma_f32_16x16x32_bf16 v[240:243], v[196:199], a[8:11], v[240:243]
    buffer_store_dwordx4 v[84:87], v3, s[24:27], s69 offen offset:1024 sc1
    s_waitcnt lgkmcnt(2)
    v_add_u32 v12, s38, v12
    v_mfma_f32_16x16x32_bf16 v[244:247], v[196:199], a[12:15], v[244:247]
    buffer_store_dwordx4 v[88:91], v3, s[24:27], s69 offen offset:2048 sc1
    v_mfma_f32_16x16x32_bf16 v[248:251], v[196:199], a[24:27], v[248:251]
    s_waitcnt lgkmcnt(0)
    v_add_u32 v13, 131072, v3
    v_mfma_f32_16x16x32_bf16 v[252:255], v[196:199], a[28:31], v[252:255]
    buffer_store_dwordx4 v[92:95], v3, s[24:27], s69 offen offset:3072 sc1
    s_barrier
    v_pk_mul_f32 v[4:5], v[224:225], v[112:113]
    v_pk_mul_f32 v[6:7], v[228:229], v[112:113]
    v_pk_fma_f32 v[4:5], v[228:229], v[116:117], v[4:5]
    v_pk_fma_f32 v[6:7], v[224:225], v[116:117], v[6:7] neg_lo:[1,0,0] neg_hi:[1,0,0]
    v_pk_mul_f32 v[8:9], v[226:227], v[114:115]
    v_pk_mul_f32 v[10:11], v[230:231], v[114:115]
    v_pk_fma_f32 v[8:9], v[230:231], v[118:119], v[8:9]
    v_pk_fma_f32 v[10:11], v[226:227], v[118:119], v[10:11] neg_lo:[1,0,0] neg_hi:[1,0,0]
    v_cvt_pk_bf16_f32 v184, v4, v6
    v_cvt_pk_bf16_f32 v185, v5, v7
    v_cvt_pk_bf16_f32 v186, v8, v10
    v_cvt_pk_bf16_f32 v187, v9, v11
    ds_write_b128 v12, v[184:187] offset:0
    v_pk_mul_f32 v[4:5], v[232:233], v[120:121]
    v_pk_mul_f32 v[6:7], v[236:237], v[120:121]
    v_pk_fma_f32 v[4:5], v[236:237], v[124:125], v[4:5]
    v_pk_fma_f32 v[6:7], v[232:233], v[124:125], v[6:7] neg_lo:[1,0,0] neg_hi:[1,0,0]
    v_pk_mul_f32 v[8:9], v[234:235], v[122:123]
    v_pk_mul_f32 v[10:11], v[238:239], v[122:123]
    v_pk_fma_f32 v[8:9], v[238:239], v[126:127], v[8:9]
    v_pk_fma_f32 v[10:11], v[234:235], v[126:127], v[10:11] neg_lo:[1,0,0] neg_hi:[1,0,0]
    v_cvt_pk_bf16_f32 v188, v4, v6
    v_cvt_pk_bf16_f32 v189, v5, v7
    v_cvt_pk_bf16_f32 v190, v8, v10
    v_cvt_pk_bf16_f32 v191, v9, v11
    ds_write_b128 v12, v[188:191] offset:8224
    v_pk_mul_f32 v[4:5], v[240:241], v[112:113]
    v_pk_mul_f32 v[6:7], v[244:245], v[112:113]
    v_pk_fma_f32 v[4:5], v[244:245], v[116:117], v[4:5]
    v_pk_fma_f32 v[6:7], v[240:241], v[116:117], v[6:7] neg_lo:[1,0,0] neg_hi:[1,0,0]
    v_pk_mul_f32 v[8:9], v[242:243], v[114:115]
    v_pk_mul_f32 v[10:11], v[246:247], v[114:115]
    v_pk_fma_f32 v[8:9], v[246:247], v[118:119], v[8:9]
    v_pk_fma_f32 v[10:11], v[242:243], v[118:119], v[10:11] neg_lo:[1,0,0] neg_hi:[1,0,0]
    v_cvt_pk_bf16_f32 v192, v4, v6
    v_cvt_pk_bf16_f32 v193, v5, v7
    v_cvt_pk_bf16_f32 v194, v8, v10
    v_cvt_pk_bf16_f32 v195, v9, v11
    ds_write_b128 v12, v[192:195] offset:16
    v_pk_mul_f32 v[4:5], v[248:249], v[120:121]
    v_pk_mul_f32 v[6:7], v[252:253], v[120:121]
    v_pk_fma_f32 v[4:5], v[252:253], v[124:125], v[4:5]
    v_pk_fma_f32 v[6:7], v[248:249], v[124:125], v[6:7] neg_lo:[1,0,0] neg_hi:[1,0,0]
    v_pk_mul_f32 v[8:9], v[250:251], v[122:123]
    v_pk_mul_f32 v[10:11], v[254:255], v[122:123]
    v_pk_fma_f32 v[8:9], v[254:255], v[126:127], v[8:9]
    v_pk_fma_f32 v[10:11], v[250:251], v[126:127], v[10:11] neg_lo:[1,0,0] neg_hi:[1,0,0]
    v_cvt_pk_bf16_f32 v196, v4, v6
    v_cvt_pk_bf16_f32 v197, v5, v7
    v_cvt_pk_bf16_f32 v198, v8, v10
    v_cvt_pk_bf16_f32 v199, v9, v11
    ds_write_b128 v12, v[196:199] offset:8240
    s_waitcnt lgkmcnt(0)
    s_barrier
    ds_read_b128 a[72:75], v13 offset:0
    ds_read_b128 a[76:79], v13 offset:1024
    ds_read_b128 a[80:83], v13 offset:2048
    ds_read_b128 a[84:87], v13 offset:3072
    ds_read_b128 a[88:91], v13 offset:4112
    ds_read_b128 a[92:95], v13 offset:5136
    ds_read_b128 a[96:99], v13 offset:6160
    ds_read_b128 a[100:103], v13 offset:7184
    ds_read_b128 a[104:107], v13 offset:8224
    ds_read_b128 a[108:111], v13 offset:9248
    ds_read_b128 a[112:115], v13 offset:10272
    ds_read_b128 a[116:119], v13 offset:11296
    ds_read_b128 a[120:123], v13 offset:12336
    ds_read_b128 a[124:127], v13 offset:13360
    ds_read_b128 a[128:131], v13 offset:14384
    ds_read_b128 a[132:135], v13 offset:15408
    v_lshlrev_b32 v12, 4, v2
    v_lshrrev_b32 v14, 2, v1
    v_add_u32 v12, v12, v14
    v_and_b32 v14, 3, v1
    v_lshlrev_b32_e64 v14, 4, v14
    v_lshl_add_u32 v12, v12, 14, v14
    s_lshl_b32 s38, s34, 20
    s_lshl_b32 s39, s2, 6
    s_add_u32 s38, s38, s39
    s_nop 0
    s_add_u32 s38, s38, 9437184
    v_accvgpr_read_b32 v96, a32
    v_accvgpr_read_b32 v97, a33
    v_accvgpr_read_b32 v98, a34
    v_accvgpr_read_b32 v99, a35
    v_accvgpr_read_b32 v100, a36
    v_accvgpr_read_b32 v101, a37
    v_accvgpr_read_b32 v102, a38
    v_accvgpr_read_b32 v103, a39
    s_waitcnt lgkmcnt(12)
    s_nop 0
    v_mfma_f32_16x16x32_bf16 v[224:227], a[40:43], a[72:75], 0
    v_accvgpr_read_b32 v104, a160
    v_accvgpr_read_b32 v105, a161
    v_mfma_f32_16x16x32_bf16 v[228:231], a[44:47], a[72:75], 0
    v_accvgpr_read_b32 v106, a162
    v_accvgpr_read_b32 v107, a163
    v_mfma_f32_16x16x32_bf16 v[224:227], a[48:51], a[76:79], v[224:227]
    v_accvgpr_read_b32 v108, a164
    v_accvgpr_read_b32 v109, a165
    v_mfma_f32_16x16x32_bf16 v[228:231], a[52:55], a[76:79], v[228:231]
    v_accvgpr_read_b32 v110, a166
    v_accvgpr_read_b32 v111, a167
    v_mfma_f32_16x16x32_bf16 v[224:227], a[56:59], a[80:83], v[224:227]
    v_accvgpr_read_b32 v112, a168
    v_mfma_f32_16x16x32_bf16 v[228:231], a[60:63], a[80:83], v[228:231]
    v_mfma_f32_16x16x32_bf16 v[224:227], a[64:67], a[84:87], v[224:227]
    v_mfma_f32_16x16x32_bf16 v[228:231], a[68:71], a[84:87], v[228:231]
    s_waitcnt lgkmcnt(8)
    s_nop 0
    v_mfma_f32_16x16x32_bf16 v[232:235], a[40:43], a[88:91], 0
    v_accvgpr_read_b32 v113, a169
    v_accvgpr_read_b32 v114, a170
    v_mfma_f32_16x16x32_bf16 v[236:239], a[44:47], a[88:91], 0
    v_accvgpr_read_b32 v115, a171
    v_accvgpr_read_b32 v116, a172
    v_mfma_f32_16x16x32_bf16 v[232:235], a[48:51], a[92:95], v[232:235]
    v_accvgpr_read_b32 v117, a173
    v_accvgpr_read_b32 v118, a174
    v_mfma_f32_16x16x32_bf16 v[236:239], a[52:55], a[92:95], v[236:239]
    v_accvgpr_read_b32 v119, a175
    v_accvgpr_read_b32 v120, a176
    v_mfma_f32_16x16x32_bf16 v[232:235], a[56:59], a[96:99], v[232:235]
    v_accvgpr_read_b32 v121, a177
    v_cvt_pk_bf16_f32 v184, v224, v228
    v_cvt_pk_bf16_f32 v185, v225, v229
    v_mfma_f32_16x16x32_bf16 v[236:239], a[60:63], a[96:99], v[236:239]
    v_cvt_pk_bf16_f32 v186, v226, v230
    v_mfma_f32_16x16x32_bf16 v[232:235], a[64:67], a[100:103], v[232:235]
    v_cvt_pk_bf16_f32 v187, v227, v231
    buffer_store_dwordx4 v[184:187], v12, s[24:27], s38 offen sc1
    v_mfma_f32_16x16x32_bf16 v[236:239], a[68:71], a[100:103], v[236:239]
    s_add_u32 s38, s38, 65536
    s_waitcnt lgkmcnt(4)
    s_nop 0
    v_mfma_f32_16x16x32_bf16 v[240:243], a[40:43], a[104:107], 0
    v_accvgpr_read_b32 v122, a178
    v_accvgpr_read_b32 v123, a179
    v_mfma_f32_16x16x32_bf16 v[244:247], a[44:47], a[104:107], 0
    v_accvgpr_read_b32 v124, a180
    v_accvgpr_read_b32 v125, a181
    v_mfma_f32_16x16x32_bf16 v[240:243], a[48:51], a[108:111], v[240:243]
    v_accvgpr_read_b32 v126, a182
    v_accvgpr_read_b32 v127, a183
    v_mfma_f32_16x16x32_bf16 v[244:247], a[52:55], a[108:111], v[244:247]
    v_accvgpr_read_b32 v128, a184
    v_accvgpr_read_b32 v129, a185
    v_mfma_f32_16x16x32_bf16 v[240:243], a[56:59], a[112:115], v[240:243]
    v_accvgpr_read_b32 v130, a186
    v_cvt_pk_bf16_f32 v188, v232, v236
    v_cvt_pk_bf16_f32 v189, v233, v237
    v_mfma_f32_16x16x32_bf16 v[244:247], a[60:63], a[112:115], v[244:247]
    v_cvt_pk_bf16_f32 v190, v234, v238
    v_mfma_f32_16x16x32_bf16 v[240:243], a[64:67], a[116:119], v[240:243]
    v_cvt_pk_bf16_f32 v191, v235, v239
    buffer_store_dwordx4 v[188:191], v12, s[24:27], s38 offen sc1
    v_mfma_f32_16x16x32_bf16 v[244:247], a[68:71], a[116:119], v[244:247]
    s_add_u32 s38, s38, 65536
    s_waitcnt lgkmcnt(0)
    s_nop 0
    v_mfma_f32_16x16x32_bf16 v[248:251], a[40:43], a[120:123], 0
    v_accvgpr_read_b32 v131, a187
    v_accvgpr_read_b32 v132, a188
    v_mfma_f32_16x16x32_bf16 v[252:255], a[44:47], a[120:123], 0
    v_accvgpr_read_b32 v133, a189
    v_mfma_f32_16x16x32_bf16 v[248:251], a[48:51], a[124:127], v[248:251]
    v_accvgpr_read_b32 v134, a190
    v_accvgpr_read_b32 v135, a191
    v_mfma_f32_16x16x32_bf16 v[252:255], a[52:55], a[124:127], v[252:255]
    v_accvgpr_read_b32 v136, a192
    v_mfma_f32_16x16x32_bf16 v[248:251], a[56:59], a[128:131], v[248:251]
    v_accvgpr_read_b32 v137, a193
    v_cvt_pk_bf16_f32 v192, v240, v244
    v_cvt_pk_bf16_f32 v193, v241, v245
    v_mfma_f32_16x16x32_bf16 v[252:255], a[60:63], a[128:131], v[252:255]
    v_cvt_pk_bf16_f32 v194, v242, v246
    v_mfma_f32_16x16x32_bf16 v[248:251], a[64:67], a[132:135], v[248:251]
    v_cvt_pk_bf16_f32 v195, v243, v247
    buffer_store_dwordx4 v[192:195], v12, s[24:27], s38 offen sc1
    v_mfma_f32_16x16x32_bf16 v[252:255], a[68:71], a[132:135], v[252:255]
    s_add_u32 s38, s38, 65536
    s_nop 6
    s_nop 0
    v_cvt_pk_bf16_f32 v196, v248, v252
    v_cvt_pk_bf16_f32 v197, v249, v253
    v_cvt_pk_bf16_f32 v198, v250, v254
    v_cvt_pk_bf16_f32 v199, v251, v255
    buffer_store_dwordx4 v[196:199], v12, s[24:27], s38 offen sc1
    s_add_u32 s95, s94, 0
    s_and_b32 s68, s2, 31
    s_lshl_b32 s68, s68, 7
    s_add_u32 s68, s68, 22302720
    s_lshr_b32 s69, s2, 5
    s_lshl_b32 s69, s69, 2
    s_add_u32 s69, s69, s68
    v_and_b32 v5, 7, v0
    v_lshlrev_b32 v5, 2, v5
    s_waitcnt vmcnt(4)
    s_barrier
    s_cmp_eq_u32 s34, 0
    s_cselect_b32 s71, 1, 0
    v_mov_b32 v28, s35
    v_cmp_gt_u32 vcc, s71, v0
    s_nop 1
    v_cndmask_b32 v29, 2.0, v0, vcc
    buffer_store_dword v28, v29, s[24:27], s69 offen sc1
    ds_read_b128 v[152:155], v20 offset:0
    ds_read_b128 v[156:159], v20 offset:2048
    ds_read_b128 v[160:163], v20 offset:4096
    ds_read_b128 v[164:167], v20 offset:6144
    s_nop 0
    s_waitcnt lgkmcnt(0)
    v_mfma_f32_16x16x32_bf16 v[32:35], v[64:67], v[152:155], 0
    ds_read_b128 v[168:171], v21 offset:0
    s_nop 0
    s_nop 0
    v_mfma_f32_16x16x32_bf16 v[48:51], v[80:83], v[152:155], 0
    ds_read_b128 v[172:175], v21 offset:2048
    v_mfma_f32_16x16x32_bf16 v[36:39], v[64:67], v[156:159], 0
    ds_read_b128 v[176:179], v21 offset:4096
    v_mfma_f32_16x16x32_bf16 v[52:55], v[80:83], v[156:159], 0
    ds_read_b128 v[180:183], v21 offset:6144
    v_mfma_f32_16x16x32_bf16 v[40:43], v[64:67], v[160:163], 0
    v_mfma_f32_16x16x32_bf16 v[56:59], v[80:83], v[160:163], 0
    v_mfma_f32_16x16x32_bf16 v[44:47], v[64:67], v[164:167], 0
    v_mfma_f32_16x16x32_bf16 v[60:63], v[80:83], v[164:167], 0
    s_waitcnt lgkmcnt(0)
    s_nop 0
    v_mfma_f32_16x16x32_bf16 v[32:35], v[68:71], v[168:171], v[32:35]
    ds_read_b128 v[152:155], v22 offset:0
    buffer_load_dword v4, v5, s[24:27], s68 offen sc1
    v_mfma_f32_16x16x32_bf16 v[48:51], v[84:87], v[168:171], v[48:51]
    ds_read_b128 v[156:159], v22 offset:2048
    v_mfma_f32_16x16x32_bf16 v[36:39], v[68:71], v[172:175], v[36:39]
    ds_read_b128 v[160:163], v22 offset:4096
    v_mfma_f32_16x16x32_bf16 v[52:55], v[84:87], v[172:175], v[52:55]
    ds_read_b128 v[164:167], v22 offset:6144
    v_mfma_f32_16x16x32_bf16 v[40:43], v[68:71], v[176:179], v[40:43]
    v_mfma_f32_16x16x32_bf16 v[56:59], v[84:87], v[176:179], v[56:59]
    v_mfma_f32_16x16x32_bf16 v[44:47], v[68:71], v[180:183], v[44:47]
    v_mfma_f32_16x16x32_bf16 v[60:63], v[84:87], v[180:183], v[60:63]
    s_waitcnt lgkmcnt(0)
    v_mfma_f32_16x16x32_bf16 v[32:35], v[72:75], v[152:155], v[32:35]
    ds_read_b128 v[168:171], v23 offset:0
    s_nop 0
    v_mfma_f32_16x16x32_bf16 v[48:51], v[88:91], v[152:155], v[48:51]
    ds_read_b128 v[172:175], v23 offset:2048
    v_mfma_f32_16x16x32_bf16 v[36:39], v[72:75], v[156:159], v[36:39]
    ds_read_b128 v[176:179], v23 offset:4096
    v_mfma_f32_16x16x32_bf16 v[52:55], v[88:91], v[156:159], v[52:55]
    ds_read_b128 v[180:183], v23 offset:6144
    v_mfma_f32_16x16x32_bf16 v[40:43], v[72:75], v[160:163], v[40:43]
    v_mfma_f32_16x16x32_bf16 v[56:59], v[88:91], v[160:163], v[56:59]
    v_mfma_f32_16x16x32_bf16 v[44:47], v[72:75], v[164:167], v[44:47]
    v_mfma_f32_16x16x32_bf16 v[60:63], v[88:91], v[164:167], v[60:63]
    s_waitcnt lgkmcnt(0) vmcnt(0)
    s_mov_b32 s71, 0
K_POLL3:
    v_cmp_ne_u32 vcc, s35, v4
    s_nop 0
    s_cbranch_vccz K_POLL3_OK
    buffer_load_dword v4, v5, s[24:27], s68 offen sc1
    s_add_u32 s71, s71, 1
    s_cmp_lt_u32 s71, 200000
    s_waitcnt vmcnt(0)
    s_cbranch_scc1 K_POLL3
K_POLL3_OK:
    s_add_u32 s74, s2, 32
    s_and_b32 s74, s74, 255
    s_mul_i32 s74, s74, 32768
    s_add_u32 s74, s74, s95
    s_add_u32 s96, s74, 8192
    buffer_load_dwordx4 a[0:3], v3, s[24:27], s74 offen offset:0 sc1
    buffer_load_dwordx4 a[16:19], v3, s[24:27], s96 offen offset:0 sc1
    buffer_load_dwordx4 a[4:7], v3, s[24:27], s74 offen offset:1024 sc1
    buffer_load_dwordx4 a[20:23], v3, s[24:27], s96 offen offset:1024 sc1
    buffer_load_dwordx4 a[8:11], v3, s[24:27], s74 offen offset:2048 sc1
    buffer_load_dwordx4 a[24:27], v3, s[24:27], s96 offen offset:2048 sc1
    buffer_load_dwordx4 a[12:15], v3, s[24:27], s74 offen offset:3072 sc1
    buffer_load_dwordx4 a[28:31], v3, s[24:27], s96 offen offset:3072 sc1
    s_add_u32 s74, s2, 64
    s_and_b32 s74, s74, 255
    s_mul_i32 s74, s74, 32768
    s_add_u32 s74, s74, s95
    s_add_u32 s96, s74, 8192
    buffer_load_dwordx4 a[32:35], v3, s[24:27], s74 offen offset:0 sc1
    buffer_load_dwordx4 a[48:51], v3, s[24:27], s96 offen offset:0 sc1
    buffer_load_dwordx4 a[36:39], v3, s[24:27], s74 offen offset:1024 sc1
    buffer_load_dwordx4 a[52:55], v3, s[24:27], s96 offen offset:1024 sc1
    buffer_load_dwordx4 a[40:43], v3, s[24:27], s74 offen offset:2048 sc1
    buffer_load_dwordx4 a[56:59], v3, s[24:27], s96 offen offset:2048 sc1
    buffer_load_dwordx4 a[44:47], v3, s[24:27], s74 offen offset:3072 sc1
    buffer_load_dwordx4 a[60:63], v3, s[24:27], s96 offen offset:3072 sc1
    v_mfma_f32_16x16x32_bf16 v[32:35], v[76:79], v[168:171], v[32:35]
    ds_read_b128 v[152:155], v20 offset:16384
    s_add_u32 s74, s2, 96
    v_mfma_f32_16x16x32_bf16 v[48:51], v[92:95], v[168:171], v[48:51]
    ds_read_b128 v[156:159], v20 offset:18432
    v_mfma_f32_16x16x32_bf16 v[36:39], v[76:79], v[172:175], v[36:39]
    ds_read_b128 v[160:163], v20 offset:20480
    s_and_b32 s74, s74, 255
    v_mfma_f32_16x16x32_bf16 v[52:55], v[92:95], v[172:175], v[52:55]
    ds_read_b128 v[164:167], v20 offset:22528
    v_mfma_f32_16x16x32_bf16 v[40:43], v[76:79], v[176:179], v[40:43]
    v_mfma_f32_16x16x32_bf16 v[56:59], v[92:95], v[176:179], v[56:59]
    s_mul_i32 s74, s74, 32768
    v_mfma_f32_16x16x32_bf16 v[44:47], v[76:79], v[180:183], v[44:47]
    v_mfma_f32_16x16x32_bf16 v[60:63], v[92:95], v[180:183], v[60:63]
    s_waitcnt lgkmcnt(0) vmcnt(8)
    v_mfma_f32_16x16x32_bf16 v[32:35], a[0:3], v[152:155], v[32:35]
    ds_read_b128 v[168:171], v21 offset:16384
    s_add_u32 s74, s74, s95
    v_mfma_f32_16x16x32_bf16 v[48:51], a[16:19], v[152:155], v[48:51]
    ds_read_b128 v[172:175], v21 offset:18432
    v_mfma_f32_16x16x32_bf16 v[36:39], a[0:3], v[156:159], v[36:39]
    ds_read_b128 v[176:179], v21 offset:20480
    s_add_u32 s96, s74, 8192
    v_mfma_f32_16x16x32_bf16 v[52:55], a[16:19], v[156:159], v[52:55]
    ds_read_b128 v[180:183], v21 offset:22528
    v_mfma_f32_16x16x32_bf16 v[40:43], a[0:3], v[160:163], v[40:43]
    v_mfma_f32_16x16x32_bf16 v[56:59], a[16:19], v[160:163], v[56:59]
    buffer_load_dwordx4 a[64:67], v3, s[24:27], s74 offen offset:0 sc1
    v_mfma_f32_16x16x32_bf16 v[44:47], a[0:3], v[164:167], v[44:47]
    v_mfma_f32_16x16x32_bf16 v[60:63], a[16:19], v[164:167], v[60:63]
    s_waitcnt lgkmcnt(0)
    s_nop 0
    v_mfma_f32_16x16x32_bf16 v[32:35], a[4:7], v[168:171], v[32:35]
    ds_read_b128 v[152:155], v22 offset:16384
    buffer_load_dwordx4 a[80:83], v3, s[24:27], s96 offen offset:0 sc1
    v_mfma_f32_16x16x32_bf16 v[48:51], a[20:23], v[168:171], v[48:51]
    ds_read_b128 v[156:159], v22 offset:18432
    v_mfma_f32_16x16x32_bf16 v[36:39], a[4:7], v[172:175], v[36:39]
    ds_read_b128 v[160:163], v22 offset:20480
    buffer_load_dwordx4 a[68:71], v3, s[24:27], s74 offen offset:1024 sc1
    v_mfma_f32_16x16x32_bf16 v[52:55], a[20:23], v[172:175], v[52:55]
    ds_read_b128 v[164:167], v22 offset:22528
    v_mfma_f32_16x16x32_bf16 v[40:43], a[4:7], v[176:179], v[40:43]
    v_mfma_f32_16x16x32_bf16 v[56:59], a[20:23], v[176:179], v[56:59]
    buffer_load_dwordx4 a[84:87], v3, s[24:27], s96 offen offset:1024 sc1
    v_mfma_f32_16x16x32_bf16 v[44:47], a[4:7], v[180:183], v[44:47]
    v_mfma_f32_16x16x32_bf16 v[60:63], a[20:23], v[180:183], v[60:63]
    s_waitcnt lgkmcnt(0)
    s_nop 0
    v_mfma_f32_16x16x32_bf16 v[32:35], a[8:11], v[152:155], v[32:35]
    ds_read_b128 v[168:171], v23 offset:16384
    buffer_load_dwordx4 a[72:75], v3, s[24:27], s74 offen offset:2048 sc1
    v_mfma_f32_16x16x32_bf16 v[48:51], a[24:27], v[152:155], v[48:51]
    ds_read_b128 v[172:175], v23 offset:18432
    v_mfma_f32_16x16x32_bf16 v[36:39], a[8:11], v[156:159], v[36:39]
    ds_read_b128 v[176:179], v23 offset:20480
    buffer_load_dwordx4 a[88:91], v3, s[24:27], s96 offen offset:2048 sc1
    v_mfma_f32_16x16x32_bf16 v[52:55], a[24:27], v[156:159], v[52:55]
    ds_read_b128 v[180:183], v23 offset:22528
    v_mfma_f32_16x16x32_bf16 v[40:43], a[8:11], v[160:163], v[40:43]
    buffer_load_dwordx4 a[76:79], v3, s[24:27], s74 offen offset:3072 sc1
    v_mfma_f32_16x16x32_bf16 v[56:59], a[24:27], v[160:163], v[56:59]
    v_mfma_f32_16x16x32_bf16 v[44:47], a[8:11], v[164:167], v[44:47]
    buffer_load_dwordx4 a[92:95], v3, s[24:27], s96 offen offset:3072 sc1
    v_mfma_f32_16x16x32_bf16 v[60:63], a[24:27], v[164:167], v[60:63]
    s_waitcnt lgkmcnt(0)
    s_barrier
    v_mfma_f32_16x16x32_bf16 v[32:35], a[12:15], v[168:171], v[32:35]
    ds_read_b128 v[152:155], v20 offset:32768
    s_lshl_b32 s69, s2, 2
    s_nop 0
    v_mfma_f32_16x16x32_bf16 v[48:51], a[28:31], v[168:171], v[48:51]
    ds_read_b128 v[156:159], v20 offset:34816
    s_add_u32 s69, s69, 22306816
    v_mfma_f32_16x16x32_bf16 v[36:39], a[12:15], v[172:175], v[36:39]
    ds_read_b128 v[160:163], v20 offset:36864
    v_mfma_f32_16x16x32_bf16 v[52:55], a[28:31], v[172:175], v[52:55]
    ds_read_b128 v[164:167], v20 offset:38912
    s_cmp_eq_u32 s34, 0
    v_mfma_f32_16x16x32_bf16 v[40:43], a[12:15], v[176:179], v[40:43]
    s_cselect_b32 s71, 1, 0
    v_mfma_f32_16x16x32_bf16 v[56:59], a[28:31], v[176:179], v[56:59]
    v_mfma_f32_16x16x32_bf16 v[44:47], a[12:15], v[180:183], v[44:47]
    v_mov_b32_e64 v28, s35
    v_mfma_f32_16x16x32_bf16 v[60:63], a[28:31], v[180:183], v[60:63]
    s_waitcnt lgkmcnt(0) vmcnt(8)
    v_mfma_f32_16x16x32_bf16 v[32:35], a[32:35], v[152:155], v[32:35]
    ds_read_b128 v[168:171], v21 offset:32768
    v_cmp_gt_u32 vcc, s71, v0
    v_mfma_f32_16x16x32_bf16 v[48:51], a[48:51], v[152:155], v[48:51]
    ds_read_b128 v[172:175], v21 offset:34816
    v_cndmask_b32_e64 v29, 2.0, v0, vcc
    v_mfma_f32_16x16x32_bf16 v[36:39], a[32:35], v[156:159], v[36:39]
    ds_read_b128 v[176:179], v21 offset:36864
    v_mfma_f32_16x16x32_bf16 v[52:55], a[48:51], v[156:159], v[52:55]
    ds_read_b128 v[180:183], v21 offset:38912
    buffer_store_dword v28, v29, s[24:27], s69 offen sc1
    v_mfma_f32_16x16x32_bf16 v[40:43], a[32:35], v[160:163], v[40:43]
    s_add_u32 s74, s2, 128
    v_mfma_f32_16x16x32_bf16 v[56:59], a[48:51], v[160:163], v[56:59]
    v_mfma_f32_16x16x32_bf16 v[44:47], a[32:35], v[164:167], v[44:47]
    s_and_b32 s74, s74, 255
    v_mfma_f32_16x16x32_bf16 v[60:63], a[48:51], v[164:167], v[60:63]
    s_waitcnt lgkmcnt(0)
    s_nop 0
    v_mfma_f32_16x16x32_bf16 v[32:35], a[36:39], v[168:171], v[32:35]
    ds_read_b128 v[152:155], v22 offset:32768
    s_mul_i32 s74, s74, 32768
    v_mfma_f32_16x16x32_bf16 v[48:51], a[52:55], v[168:171], v[48:51]
    ds_read_b128 v[156:159], v22 offset:34816
    s_add_u32 s74, s74, s95
    s_nop 0
    v_mfma_f32_16x16x32_bf16 v[36:39], a[36:39], v[172:175], v[36:39]
    ds_read_b128 v[160:163], v22 offset:36864
    v_mfma_f32_16x16x32_bf16 v[52:55], a[52:55], v[172:175], v[52:55]
    ds_read_b128 v[164:167], v22 offset:38912
    s_add_u32 s96, s74, 8192
    v_mfma_f32_16x16x32_bf16 v[40:43], a[36:39], v[176:179], v[40:43]
    buffer_load_dwordx4 a[96:99], v3, s[24:27], s74 offen offset:0 sc1
    v_mfma_f32_16x16x32_bf16 v[56:59], a[52:55], v[176:179], v[56:59]
    v_mfma_f32_16x16x32_bf16 v[44:47], a[36:39], v[180:183], v[44:47]
    buffer_load_dwordx4 a[112:115], v3, s[24:27], s96 offen offset:0 sc1
    v_mfma_f32_16x16x32_bf16 v[60:63], a[52:55], v[180:183], v[60:63]
    s_waitcnt lgkmcnt(0)
    s_nop 0
    v_mfma_f32_16x16x32_bf16 v[32:35], a[40:43], v[152:155], v[32:35]
    ds_read_b128 v[168:171], v23 offset:32768
    buffer_load_dwordx4 a[100:103], v3, s[24:27], s74 offen offset:1024 sc1
    v_mfma_f32_16x16x32_bf16 v[48:51], a[56:59], v[152:155], v[48:51]
    ds_read_b128 v[172:175], v23 offset:34816
    buffer_load_dwordx4 a[116:119], v3, s[24:27], s96 offen offset:1024 sc1
    v_mfma_f32_16x16x32_bf16 v[36:39], a[40:43], v[156:159], v[36:39]
    ds_read_b128 v[176:179], v23 offset:36864
    buffer_load_dwordx4 a[104:107], v3, s[24:27], s74 offen offset:2048 sc1
    v_mfma_f32_16x16x32_bf16 v[52:55], a[56:59], v[156:159], v[52:55]
    ds_read_b128 v[180:183], v23 offset:38912
    v_mfma_f32_16x16x32_bf16 v[40:43], a[40:43], v[160:163], v[40:43]
    buffer_load_dwordx4 a[120:123], v3, s[24:27], s96 offen offset:2048 sc1
    v_mfma_f32_16x16x32_bf16 v[56:59], a[56:59], v[160:163], v[56:59]
    buffer_load_dwordx4 a[108:111], v3, s[24:27], s74 offen offset:3072 sc1
    v_mfma_f32_16x16x32_bf16 v[44:47], a[40:43], v[164:167], v[44:47]
    buffer_load_dwordx4 a[124:127], v3, s[24:27], s96 offen offset:3072 sc1
    v_mfma_f32_16x16x32_bf16 v[60:63], a[56:59], v[164:167], v[60:63]
    s_waitcnt lgkmcnt(0)
    s_nop 0
    v_mfma_f32_16x16x32_bf16 v[32:35], a[44:47], v[168:171], v[32:35]
    ds_read_b128 v[152:155], v20 offset:49152
    s_add_u32 s74, s2, 160
    v_mfma_f32_16x16x32_bf16 v[48:51], a[60:63], v[168:171], v[48:51]
    ds_read_b128 v[156:159], v20 offset:51200
    v_mfma_f32_16x16x32_bf16 v[36:39], a[44:47], v[172:175], v[36:39]
    ds_read_b128 v[160:163], v20 offset:53248
    s_and_b32 s74, s74, 255
    v_mfma_f32_16x16x32_bf16 v[52:55], a[60:63], v[172:175], v[52:55]
    ds_read_b128 v[164:167], v20 offset:55296
    v_mfma_f32_16x16x32_bf16 v[40:43], a[44:47], v[176:179], v[40:43]
    v_mfma_f32_16x16x32_bf16 v[56:59], a[60:63], v[176:179], v[56:59]
    s_mul_i32 s74, s74, 32768
    v_mfma_f32_16x16x32_bf16 v[44:47], a[44:47], v[180:183], v[44:47]
    v_mfma_f32_16x16x32_bf16 v[60:63], a[60:63], v[180:183], v[60:63]
    s_waitcnt lgkmcnt(0) vmcnt(9)
    v_mfma_f32_16x16x32_bf16 v[32:35], a[64:67], v[152:155], v[32:35]
    ds_read_b128 v[168:171], v21 offset:49152
    s_add_u32 s74, s74, s95
    v_mfma_f32_16x16x32_bf16 v[48:51], a[80:83], v[152:155], v[48:51]
    ds_read_b128 v[172:175], v21 offset:51200
    v_mfma_f32_16x16x32_bf16 v[36:39], a[64:67], v[156:159], v[36:39]
    ds_read_b128 v[176:179], v21 offset:53248
    s_add_u32 s96, s74, 8192
    v_mfma_f32_16x16x32_bf16 v[52:55], a[80:83], v[156:159], v[52:55]
    ds_read_b128 v[180:183], v21 offset:55296
    v_mfma_f32_16x16x32_bf16 v[40:43], a[64:67], v[160:163], v[40:43]
    v_mfma_f32_16x16x32_bf16 v[56:59], a[80:83], v[160:163], v[56:59]
    buffer_load_dwordx4 a[128:131], v3, s[24:27], s74 offen offset:0 sc1
    v_mfma_f32_16x16x32_bf16 v[44:47], a[64:67], v[164:167], v[44:47]
    v_mfma_f32_16x16x32_bf16 v[60:63], a[80:83], v[164:167], v[60:63]
    s_waitcnt lgkmcnt(0)
    s_nop 0
    v_mfma_f32_16x16x32_bf16 v[32:35], a[68:71], v[168:171], v[32:35]
    ds_read_b128 v[152:155], v22 offset:49152
    buffer_load_dwordx4 a[144:147], v3, s[24:27], s96 offen offset:0 sc1
    v_mfma_f32_16x16x32_bf16 v[48:51], a[84:87], v[168:171], v[48:51]
    ds_read_b128 v[156:159], v22 offset:51200
    v_mfma_f32_16x16x32_bf16 v[36:39], a[68:71], v[172:175], v[36:39]
    ds_read_b128 v[160:163], v22 offset:53248
    buffer_load_dwordx4 a[132:135], v3, s[24:27], s74 offen offset:1024 sc1
    v_mfma_f32_16x16x32_bf16 v[52:55], a[84:87], v[172:175], v[52:55]
    ds_read_b128 v[164:167], v22 offset:55296
    v_mfma_f32_16x16x32_bf16 v[40:43], a[68:71], v[176:179], v[40:43]
    v_mfma_f32_16x16x32_bf16 v[56:59], a[84:87], v[176:179], v[56:59]
    buffer_load_dwordx4 a[148:151], v3, s[24:27], s96 offen offset:1024 sc1
    v_mfma_f32_16x16x32_bf16 v[44:47], a[68:71], v[180:183], v[44:47]
    v_mfma_f32_16x16x32_bf16 v[60:63], a[84:87], v[180:183], v[60:63]
    s_waitcnt lgkmcnt(0)
    s_nop 0
    v_mfma_f32_16x16x32_bf16 v[32:35], a[72:75], v[152:155], v[32:35]
    ds_read_b128 v[168:171], v23 offset:49152
    buffer_load_dwordx4 a[136:139], v3, s[24:27], s74 offen offset:2048 sc1
    v_mfma_f32_16x16x32_bf16 v[48:51], a[88:91], v[152:155], v[48:51]
    ds_read_b128 v[172:175], v23 offset:51200
    v_mfma_f32_16x16x32_bf16 v[36:39], a[72:75], v[156:159], v[36:39]
    ds_read_b128 v[176:179], v23 offset:53248
    buffer_load_dwordx4 a[152:155], v3, s[24:27], s96 offen offset:2048 sc1
    v_mfma_f32_16x16x32_bf16 v[52:55], a[88:91], v[156:159], v[52:55]
    ds_read_b128 v[180:183], v23 offset:55296
    v_mfma_f32_16x16x32_bf16 v[40:43], a[72:75], v[160:163], v[40:43]
    buffer_load_dwordx4 a[140:143], v3, s[24:27], s74 offen offset:3072 sc1
    v_mfma_f32_16x16x32_bf16 v[56:59], a[88:91], v[160:163], v[56:59]
    v_mfma_f32_16x16x32_bf16 v[44:47], a[72:75], v[164:167], v[44:47]
    buffer_load_dwordx4 a[156:159], v3, s[24:27], s96 offen offset:3072 sc1
    v_mfma_f32_16x16x32_bf16 v[60:63], a[88:91], v[164:167], v[60:63]
    s_waitcnt lgkmcnt(0)
    s_nop 0
    v_mfma_f32_16x16x32_bf16 v[32:35], a[76:79], v[168:171], v[32:35]
    ds_read_b128 v[152:155], v24 offset:0
    s_add_u32 s74, s2, 192
    v_mfma_f32_16x16x32_bf16 v[48:51], a[92:95], v[168:171], v[48:51]
    ds_read_b128 v[156:159], v24 offset:2048
    v_mfma_f32_16x16x32_bf16 v[36:39], a[76:79], v[172:175], v[36:39]
    ds_read_b128 v[160:163], v24 offset:4096
    s_and_b32 s74, s74, 255
    v_mfma_f32_16x16x32_bf16 v[52:55], a[92:95], v[172:175], v[52:55]
    ds_read_b128 v[164:167], v24 offset:6144
    v_mfma_f32_16x16x32_bf16 v[40:43], a[76:79], v[176:179], v[40:43]
    v_mfma_f32_16x16x32_bf16 v[56:59], a[92:95], v[176:179], v[56:59]
    s_mul_i32 s74, s74, 32768
    v_mfma_f32_16x16x32_bf16 v[44:47], a[76:79], v[180:183], v[44:47]
    v_mfma_f32_16x16x32_bf16 v[60:63], a[92:95], v[180:183], v[60:63]
    s_waitcnt lgkmcnt(0) vmcnt(8)
    v_mfma_f32_16x16x32_bf16 v[32:35], a[96:99], v[152:155], v[32:35]
    ds_read_b128 v[168:171], v25 offset:0
    s_add_u32 s74, s74, s95
    v_mfma_f32_16x16x32_bf16 v[48:51], a[112:115], v[152:155], v[48:51]
    ds_read_b128 v[172:175], v25 offset:2048
    v_mfma_f32_16x16x32_bf16 v[36:39], a[96:99], v[156:159], v[36:39]
    ds_read_b128 v[176:179], v25 offset:4096
    s_add_u32 s96, s74, 8192
    v_mfma_f32_16x16x32_bf16 v[52:55], a[112:115], v[156:159], v[52:55]
    ds_read_b128 v[180:183], v25 offset:6144
    v_mfma_f32_16x16x32_bf16 v[40:43], a[96:99], v[160:163], v[40:43]
    v_mfma_f32_16x16x32_bf16 v[56:59], a[112:115], v[160:163], v[56:59]
    buffer_load_dwordx4 a[160:163], v3, s[24:27], s74 offen offset:0 sc1
    v_mfma_f32_16x16x32_bf16 v[44:47], a[96:99], v[164:167], v[44:47]
    v_mfma_f32_16x16x32_bf16 v[60:63], a[112:115], v[164:167], v[60:63]
    s_waitcnt lgkmcnt(0)
    s_nop 0
    v_mfma_f32_16x16x32_bf16 v[32:35], a[100:103], v[168:171], v[32:35]
    ds_read_b128 v[152:155], v26 offset:0
    buffer_load_dwordx4 a[176:179], v3, s[24:27], s96 offen offset:0 sc1
    v_mfma_f32_16x16x32_bf16 v[48:51], a[116:119], v[168:171], v[48:51]
    ds_read_b128 v[156:159], v26 offset:2048
    v_mfma_f32_16x16x32_bf16 v[36:39], a[100:103], v[172:175], v[36:39]
    ds_read_b128 v[160:163], v26 offset:4096
    buffer_load_dwordx4 a[164:167], v3, s[24:27], s74 offen offset:1024 sc1
    v_mfma_f32_16x16x32_bf16 v[52:55], a[116:119], v[172:175], v[52:55]
    ds_read_b128 v[164:167], v26 offset:6144
    v_mfma_f32_16x16x32_bf16 v[40:43], a[100:103], v[176:179], v[40:43]
    v_mfma_f32_16x16x32_bf16 v[56:59], a[116:119], v[176:179], v[56:59]
    buffer_load_dwordx4 a[180:183], v3, s[24:27], s96 offen offset:1024 sc1
    v_mfma_f32_16x16x32_bf16 v[44:47], a[100:103], v[180:183], v[44:47]
    v_mfma_f32_16x16x32_bf16 v[60:63], a[116:119], v[180:183], v[60:63]
    s_waitcnt lgkmcnt(0)
    s_nop 0
    v_mfma_f32_16x16x32_bf16 v[32:35], a[104:107], v[152:155], v[32:35]
    ds_read_b128 v[168:171], v27 offset:0
    buffer_load_dwordx4 a[168:171], v3, s[24:27], s74 offen offset:2048 sc1
    v_mfma_f32_16x16x32_bf16 v[48:51], a[120:123], v[152:155], v[48:51]
    ds_read_b128 v[172:175], v27 offset:2048
    v_mfma_f32_16x16x32_bf16 v[36:39], a[104:107], v[156:159], v[36:39]
    ds_read_b128 v[176:179], v27 offset:4096
    buffer_load_dwordx4 a[184:187], v3, s[24:27], s96 offen offset:2048 sc1
    v_mfma_f32_16x16x32_bf16 v[52:55], a[120:123], v[156:159], v[52:55]
    ds_read_b128 v[180:183], v27 offset:6144
    v_mfma_f32_16x16x32_bf16 v[40:43], a[104:107], v[160:163], v[40:43]
    buffer_load_dwordx4 a[172:175], v3, s[24:27], s74 offen offset:3072 sc1
    v_mfma_f32_16x16x32_bf16 v[56:59], a[120:123], v[160:163], v[56:59]
    v_mfma_f32_16x16x32_bf16 v[44:47], a[104:107], v[164:167], v[44:47]
    buffer_load_dwordx4 a[188:191], v3, s[24:27], s96 offen offset:3072 sc1
    v_mfma_f32_16x16x32_bf16 v[60:63], a[120:123], v[164:167], v[60:63]
    s_waitcnt lgkmcnt(0)
    s_nop 0
    v_mfma_f32_16x16x32_bf16 v[32:35], a[108:111], v[168:171], v[32:35]
    ds_read_b128 v[152:155], v24 offset:16384
    s_add_u32 s74, s2, 224
    v_mfma_f32_16x16x32_bf16 v[48:51], a[124:127], v[168:171], v[48:51]
    ds_read_b128 v[156:159], v24 offset:18432
    v_mfma_f32_16x16x32_bf16 v[36:39], a[108:111], v[172:175], v[36:39]
    ds_read_b128 v[160:163], v24 offset:20480
    s_and_b32 s74, s74, 255
    v_mfma_f32_16x16x32_bf16 v[52:55], a[124:127], v[172:175], v[52:55]
    ds_read_b128 v[164:167], v24 offset:22528
    v_mfma_f32_16x16x32_bf16 v[40:43], a[108:111], v[176:179], v[40:43]
    v_mfma_f32_16x16x32_bf16 v[56:59], a[124:127], v[176:179], v[56:59]
    s_mul_i32 s74, s74, 32768
    v_mfma_f32_16x16x32_bf16 v[44:47], a[108:111], v[180:183], v[44:47]
    v_mfma_f32_16x16x32_bf16 v[60:63], a[124:127], v[180:183], v[60:63]
    s_waitcnt lgkmcnt(0) vmcnt(8)
    v_mfma_f32_16x16x32_bf16 v[32:35], a[128:131], v[152:155], v[32:35]
    ds_read_b128 v[168:171], v25 offset:16384
    s_add_u32 s74, s74, s95
    v_mfma_f32_16x16x32_bf16 v[48:51], a[144:147], v[152:155], v[48:51]
    ds_read_b128 v[172:175], v25 offset:18432
    v_mfma_f32_16x16x32_bf16 v[36:39], a[128:131], v[156:159], v[36:39]
    ds_read_b128 v[176:179], v25 offset:20480
    s_add_u32 s96, s74, 8192
    v_mfma_f32_16x16x32_bf16 v[52:55], a[144:147], v[156:159], v[52:55]
    ds_read_b128 v[180:183], v25 offset:22528
    v_mfma_f32_16x16x32_bf16 v[40:43], a[128:131], v[160:163], v[40:43]
    buffer_load_dwordx4 a[192:195], v3, s[24:27], s74 offen offset:0 sc1
    v_mfma_f32_16x16x32_bf16 v[56:59], a[144:147], v[160:163], v[56:59]
    v_mfma_f32_16x16x32_bf16 v[44:47], a[128:131], v[164:167], v[44:47]
    buffer_load_dwordx4 a[208:211], v3, s[24:27], s96 offen offset:0 sc1
    v_mfma_f32_16x16x32_bf16 v[60:63], a[144:147], v[164:167], v[60:63]
    s_waitcnt lgkmcnt(0)
    s_nop 0
    v_mfma_f32_16x16x32_bf16 v[32:35], a[132:135], v[168:171], v[32:35]
    ds_read_b128 v[152:155], v26 offset:16384
    buffer_load_dwordx4 a[196:199], v3, s[24:27], s74 offen offset:1024 sc1
    v_mfma_f32_16x16x32_bf16 v[48:51], a[148:151], v[168:171], v[48:51]
    ds_read_b128 v[156:159], v26 offset:18432
    v_mfma_f32_16x16x32_bf16 v[36:39], a[132:135], v[172:175], v[36:39]
    ds_read_b128 v[160:163], v26 offset:20480
    buffer_load_dwordx4 a[212:215], v3, s[24:27], s96 offen offset:1024 sc1
    v_mfma_f32_16x16x32_bf16 v[52:55], a[148:151], v[172:175], v[52:55]
    ds_read_b128 v[164:167], v26 offset:22528
    v_mfma_f32_16x16x32_bf16 v[40:43], a[132:135], v[176:179], v[40:43]
    buffer_load_dwordx4 a[200:203], v3, s[24:27], s74 offen offset:2048 sc1
    v_mfma_f32_16x16x32_bf16 v[56:59], a[148:151], v[176:179], v[56:59]
    v_mfma_f32_16x16x32_bf16 v[44:47], a[132:135], v[180:183], v[44:47]
    buffer_load_dwordx4 a[216:219], v3, s[24:27], s96 offen offset:2048 sc1
    v_mfma_f32_16x16x32_bf16 v[60:63], a[148:151], v[180:183], v[60:63]
    s_waitcnt lgkmcnt(0)
    s_nop 0
    v_mfma_f32_16x16x32_bf16 v[32:35], a[136:139], v[152:155], v[32:35]
    ds_read_b128 v[168:171], v27 offset:16384
    buffer_load_dwordx4 a[204:207], v3, s[24:27], s74 offen offset:3072 sc1
    v_mfma_f32_16x16x32_bf16 v[48:51], a[152:155], v[152:155], v[48:51]
    ds_read_b128 v[172:175], v27 offset:18432
    v_mfma_f32_16x16x32_bf16 v[36:39], a[136:139], v[156:159], v[36:39]
    ds_read_b128 v[176:179], v27 offset:20480
    buffer_load_dwordx4 a[220:223], v3, s[24:27], s96 offen offset:3072 sc1
    v_mfma_f32_16x16x32_bf16 v[52:55], a[152:155], v[156:159], v[52:55]
    ds_read_b128 v[180:183], v27 offset:22528
    v_mfma_f32_16x16x32_bf16 v[40:43], a[136:139], v[160:163], v[40:43]
    s_mov_b32 s68, 22306816
    v_mfma_f32_16x16x32_bf16 v[56:59], a[152:155], v[160:163], v[56:59]
    v_mfma_f32_16x16x32_bf16 v[44:47], a[136:139], v[164:167], v[44:47]
    buffer_load_dwordx4 v[8:11], v3, s[24:27], s68 offen sc1
    v_mfma_f32_16x16x32_bf16 v[60:63], a[152:155], v[164:167], v[60:63]
    s_waitcnt lgkmcnt(0)
    s_barrier
    v_mfma_f32_16x16x32_bf16 v[32:35], a[140:143], v[168:171], v[32:35]
    ds_read_b128 v[152:155], v24 offset:32768
    v_xor_b32 v16, 0x20000, v16
    v_mfma_f32_16x16x32_bf16 v[48:51], a[156:159], v[168:171], v[48:51]
    ds_read_b128 v[156:159], v24 offset:34816
    v_xor_b32 v17, 0x20000, v17
    v_mfma_f32_16x16x32_bf16 v[36:39], a[140:143], v[172:175], v[36:39]
    ds_read_b128 v[160:163], v24 offset:36864
    v_xor_b32 v18, 0x20000, v18
    v_mfma_f32_16x16x32_bf16 v[52:55], a[156:159], v[172:175], v[52:55]
    ds_read_b128 v[164:167], v24 offset:38912
    v_xor_b32 v19, 0x20000, v19
    v_mfma_f32_16x16x32_bf16 v[40:43], a[140:143], v[176:179], v[40:43]
    s_add_u32 s72, s33, 0
    v_mfma_f32_16x16x32_bf16 v[56:59], a[156:159], v[176:179], v[56:59]
    s_add_u32 s73, s37, 0
    v_mfma_f32_16x16x32_bf16 v[44:47], a[140:143], v[180:183], v[44:47]
    s_and_b32 s72, s72, 7
    v_mfma_f32_16x16x32_bf16 v[60:63], a[156:159], v[180:183], v[60:63]
    s_waitcnt lgkmcnt(0) vmcnt(9)
    v_mfma_f32_16x16x32_bf16 v[32:35], a[160:163], v[152:155], v[32:35]
    ds_read_b128 v[168:171], v25 offset:32768
    s_lshl_b32 s72, s72, 7
    v_mfma_f32_16x16x32_bf16 v[48:51], a[176:179], v[152:155], v[48:51]
    ds_read_b128 v[172:175], v25 offset:34816
    s_add_u32 m0, s73, 0
    v_mfma_f32_16x16x32_bf16 v[36:39], a[160:163], v[156:159], v[36:39]
    ds_read_b128 v[176:179], v25 offset:36864
    buffer_load_dwordx4 v16, s[16:19], s72 offen lds
    v_mfma_f32_16x16x32_bf16 v[52:55], a[176:179], v[156:159], v[52:55]
    ds_read_b128 v[180:183], v25 offset:38912
    s_add_u32 m0, s73, 1024
    v_mfma_f32_16x16x32_bf16 v[40:43], a[160:163], v[160:163], v[40:43]
    buffer_load_dwordx4 v17, s[16:19], s72 offen lds
    v_mfma_f32_16x16x32_bf16 v[56:59], a[176:179], v[160:163], v[56:59]
    s_add_u32 m0, s73, 2048
    v_mfma_f32_16x16x32_bf16 v[44:47], a[160:163], v[164:167], v[44:47]
    buffer_load_dwordx4 v18, s[16:19], s72 offen lds
    v_mfma_f32_16x16x32_bf16 v[60:63], a[176:179], v[164:167], v[60:63]
    s_waitcnt lgkmcnt(0)
    s_nop 0
    v_mfma_f32_16x16x32_bf16 v[32:35], a[164:167], v[168:171], v[32:35]
    ds_read_b128 v[152:155], v26 offset:32768
    s_add_u32 m0, s73, 3072
    v_mfma_f32_16x16x32_bf16 v[48:51], a[180:183], v[168:171], v[48:51]
    ds_read_b128 v[156:159], v26 offset:34816
    buffer_load_dwordx4 v19, s[16:19], s72 offen lds
    v_mfma_f32_16x16x32_bf16 v[36:39], a[164:167], v[172:175], v[36:39]
    ds_read_b128 v[160:163], v26 offset:36864
    s_add_u32 s72, s33, 1
    s_nop 0
    v_mfma_f32_16x16x32_bf16 v[52:55], a[180:183], v[172:175], v[52:55]
    ds_read_b128 v[164:167], v26 offset:38912
    s_add_u32 s73, s37, 16384
    v_mfma_f32_16x16x32_bf16 v[40:43], a[164:167], v[176:179], v[40:43]
    s_and_b32 s72, s72, 7
    v_mfma_f32_16x16x32_bf16 v[56:59], a[180:183], v[176:179], v[56:59]
    s_lshl_b32 s72, s72, 7
    v_mfma_f32_16x16x32_bf16 v[44:47], a[164:167], v[180:183], v[44:47]
    s_add_u32 m0, s73, 0
    v_mfma_f32_16x16x32_bf16 v[60:63], a[180:183], v[180:183], v[60:63]
    s_waitcnt lgkmcnt(0)
    v_mfma_f32_16x16x32_bf16 v[32:35], a[168:171], v[152:155], v[32:35]
    ds_read_b128 v[168:171], v27 offset:32768
    buffer_load_dwordx4 v16, s[16:19], s72 offen lds
    v_mfma_f32_16x16x32_bf16 v[48:51], a[184:187], v[152:155], v[48:51]
    ds_read_b128 v[172:175], v27 offset:34816
    s_add_u32 m0, s73, 1024
    v_mfma_f32_16x16x32_bf16 v[36:39], a[168:171], v[156:159], v[36:39]
    ds_read_b128 v[176:179], v27 offset:36864
    buffer_load_dwordx4 v17, s[16:19], s72 offen lds
    v_mfma_f32_16x16x32_bf16 v[52:55], a[184:187], v[156:159], v[52:55]
    ds_read_b128 v[180:183], v27 offset:38912
    s_add_u32 m0, s73, 2048
    v_mfma_f32_16x16x32_bf16 v[40:43], a[168:171], v[160:163], v[40:43]
    buffer_load_dwordx4 v18, s[16:19], s72 offen lds
    v_mfma_f32_16x16x32_bf16 v[56:59], a[184:187], v[160:163], v[56:59]
    s_add_u32 m0, s73, 3072
    v_mfma_f32_16x16x32_bf16 v[44:47], a[168:171], v[164:167], v[44:47]
    buffer_load_dwordx4 v19, s[16:19], s72 offen lds
    v_mfma_f32_16x16x32_bf16 v[60:63], a[184:187], v[164:167], v[60:63]
    s_waitcnt lgkmcnt(0) vmcnt(8)
    s_mov_b32 s71, 0
K_POLL4:
    v_xor_b32 v8, s35, v8
    v_xor_b32 v9, s35, v9
    v_xor_b32 v10, s35, v10
    v_xor_b32 v11, s35, v11
    v_or3_b32 v8, v8, v9, v10
    v_or_b32 v8, v8, v11
    v_cmp_ne_u32 vcc, 0, v8
    s_nop 0
    s_cbranch_vccz K_POLL4_OK
    buffer_load_dwordx4 v[8:11], v3, s[24:27], s68 offen sc1
    s_add_u32 s71, s71, 1
    s_cmp_lt_u32 s71, 200000
    s_waitcnt vmcnt(0)
    s_cbranch_scc1 K_POLL4
K_POLL4_OK:
    v_mfma_f32_16x16x32_bf16 v[32:35], a[172:175], v[168:171], v[32:35]
    ds_read_b128 v[152:155], v24 offset:49152
    s_lshl_b32 s68, s32, 4
    v_mfma_f32_16x16x32_bf16 v[48:51], a[188:191], v[168:171], v[48:51]
    ds_read_b128 v[156:159], v24 offset:51200
    s_add_u32 s68, s68, s33
    v_mfma_f32_16x16x32_bf16 v[36:39], a[172:175], v[172:175], v[36:39]
    ds_read_b128 v[160:163], v24 offset:53248
    s_lshl_b32 s68, s68, 14
    v_mfma_f32_16x16x32_bf16 v[52:55], a[188:191], v[172:175], v[52:55]
    ds_read_b128 v[164:167], v24 offset:55296
    v_mfma_f32_16x16x32_bf16 v[40:43], a[172:175], v[176:179], v[40:43]
    s_lshl_b32 s69, s34, 10
    v_mfma_f32_16x16x32_bf16 v[56:59], a[188:191], v[176:179], v[56:59]
    s_add_u32 s68, s68, s69
    v_mfma_f32_16x16x32_bf16 v[44:47], a[172:175], v[180:183], v[44:47]
    s_add_u32 s68, s68, 9437184
    v_mfma_f32_16x16x32_bf16 v[60:63], a[188:191], v[180:183], v[60:63]
    s_waitcnt lgkmcnt(0)
    s_nop 0
    v_mfma_f32_16x16x32_bf16 v[32:35], a[192:195], v[152:155], v[32:35]
    ds_read_b128 v[168:171], v25 offset:49152
    buffer_load_dwordx4 v[184:187], v3, s[24:27], s68 offen sc1
    v_mfma_f32_16x16x32_bf16 v[48:51], a[208:211], v[152:155], v[48:51]
    ds_read_b128 v[172:175], v25 offset:51200
    s_add_u32 s68, s68, 4096
    v_mfma_f32_16x16x32_bf16 v[36:39], a[192:195], v[156:159], v[36:39]
    ds_read_b128 v[176:179], v25 offset:53248
    buffer_load_dwordx4 v[188:191], v3, s[24:27], s68 offen sc1
    v_mfma_f32_16x16x32_bf16 v[52:55], a[208:211], v[156:159], v[52:55]
    ds_read_b128 v[180:183], v25 offset:55296
    v_mfma_f32_16x16x32_bf16 v[40:43], a[192:195], v[160:163], v[40:43]
    s_add_u32 s68, s68, 4096
    v_mfma_f32_16x16x32_bf16 v[56:59], a[208:211], v[160:163], v[56:59]
    buffer_load_dwordx4 v[192:195], v3, s[24:27], s68 offen sc1
    v_mfma_f32_16x16x32_bf16 v[44:47], a[192:195], v[164:167], v[44:47]
    s_add_u32 s68, s68, 4096
    v_mfma_f32_16x16x32_bf16 v[60:63], a[208:211], v[164:167], v[60:63]
    s_waitcnt lgkmcnt(0)
    s_nop 0
    v_mfma_f32_16x16x32_bf16 v[32:35], a[196:199], v[168:171], v[32:35]
    ds_read_b128 v[152:155], v26 offset:49152
    buffer_load_dwordx4 v[196:199], v3, s[24:27], s68 offen sc1
    v_mfma_f32_16x16x32_bf16 v[48:51], a[212:215], v[168:171], v[48:51]
    ds_read_b128 v[156:159], v26 offset:51200
    s_add_u32 s72, s33, 2
    s_nop 0
    v_mfma_f32_16x16x32_bf16 v[36:39], a[196:199], v[172:175], v[36:39]
    ds_read_b128 v[160:163], v26 offset:53248
    s_add_u32 s73, s37, 32768
    v_mfma_f32_16x16x32_bf16 v[52:55], a[212:215], v[172:175], v[52:55]
    ds_read_b128 v[164:167], v26 offset:55296
    v_mfma_f32_16x16x32_bf16 v[40:43], a[196:199], v[176:179], v[40:43]
    s_and_b32 s72, s72, 7
    v_mfma_f32_16x16x32_bf16 v[56:59], a[212:215], v[176:179], v[56:59]
    s_lshl_b32 s72, s72, 7
    v_mfma_f32_16x16x32_bf16 v[44:47], a[196:199], v[180:183], v[44:47]
    s_add_u32 m0, s73, 0
    v_mfma_f32_16x16x32_bf16 v[60:63], a[212:215], v[180:183], v[60:63]
    s_waitcnt lgkmcnt(0)
    v_mfma_f32_16x16x32_bf16 v[32:35], a[200:203], v[152:155], v[32:35]
    ds_read_b128 v[168:171], v27 offset:49152
    buffer_load_dwordx4 v16, s[16:19], s72 offen lds
    v_mfma_f32_16x16x32_bf16 v[48:51], a[216:219], v[152:155], v[48:51]
    ds_read_b128 v[172:175], v27 offset:51200
    s_add_u32 m0, s73, 1024
    v_mfma_f32_16x16x32_bf16 v[36:39], a[200:203], v[156:159], v[36:39]
    ds_read_b128 v[176:179], v27 offset:53248
    buffer_load_dwordx4 v17, s[16:19], s72 offen lds
    v_mfma_f32_16x16x32_bf16 v[52:55], a[216:219], v[156:159], v[52:55]
    ds_read_b128 v[180:183], v27 offset:55296
    s_add_u32 m0, s73, 2048
    v_mfma_f32_16x16x32_bf16 v[40:43], a[200:203], v[160:163], v[40:43]
    buffer_load_dwordx4 v18, s[16:19], s72 offen lds
    v_mfma_f32_16x16x32_bf16 v[56:59], a[216:219], v[160:163], v[56:59]
    s_add_u32 m0, s73, 3072
    v_mfma_f32_16x16x32_bf16 v[44:47], a[200:203], v[164:167], v[44:47]
    buffer_load_dwordx4 v19, s[16:19], s72 offen lds
    v_mfma_f32_16x16x32_bf16 v[60:63], a[216:219], v[164:167], v[60:63]
    s_waitcnt lgkmcnt(0)
    v_mfma_f32_16x16x32_bf16 v[32:35], a[204:207], v[168:171], v[32:35]
    s_lshr_b32 s38, s34, 1
    s_lshl_b32 s38, s38, 2
    s_and_b32 s39, s34, 1
    s_add_u32 s38, s38, s39
    s_nop 0
    v_mfma_f32_16x16x32_bf16 v[48:51], a[220:223], v[168:171], v[48:51]
    s_mul_i32 s38, s38, 2080
    s_add_u32 s38, s38, 131072
    v_lshl_add_u32 v4, v2, 6, v1
    v_mfma_f32_16x16x32_bf16 v[36:39], a[204:207], v[172:175], v[36:39]
    v_lshl_add_u32 v6, v4, 3, s38
    v_sub_u32 v4, 208, v4
    s_add_u32 s38, s38, 4160
    v_mfma_f32_16x16x32_bf16 v[52:55], a[220:223], v[172:175], v[52:55]
    v_lshl_add_u32 v7, v4, 3, s38
    v_and_b32 v4, 3, v0
    v_lshrrev_b32 v5, 2, v0
    v_mfma_f32_16x16x32_bf16 v[40:43], a[204:207], v[176:179], v[40:43]
    s_lshl_b32 s39, s34, 4
    v_add_u32 v5, s39, v5
    v_mul_u32_u24 v9, 4160, v4
    v_lshl_add_u32 v9, v5, 3, v9
    v_mfma_f32_16x16x32_bf16 v[56:59], a[220:223], v[176:179], v[56:59]
    v_add_u32 v9, 131072, v9
    v_and_b32 v4, 1, v4
    v_lshlrev_b32 v4, 11, v4
    v_mfma_f32_16x16x32_bf16 v[44:47], a[204:207], v[180:183], v[44:47]
    v_cmp_eq_u32 vcc, 0, v5
    s_nop 1
    v_cndmask_b32 v4, 0, v4, vcc
    v_add_u32 v8, v9, v4
    v_mfma_f32_16x16x32_bf16 v[60:63], a[220:223], v[180:183], v[60:63]
    s_lshl_b32 s38, s2, 14
    s_add_u32 s38, s38, s37
    s_add_u32 s38, s38, 17825792
    v_cvt_pk_bf16_f32 v200, v32, v36
    v_cvt_pk_bf16_f32 v201, v40, v44
    v_cvt_pk_bf16_f32 v202, v48, v52
    s_nop 1
    s_nop 0
    v_cvt_pk_bf16_f32 v203, v56, v60
    buffer_store_dwordx4 v[200:203], v3, s[24:27], s38 offen offset:0 sc1
    v_cvt_pk_bf16_f32 v204, v33, v37
    v_cvt_pk_bf16_f32 v205, v41, v45
    v_cvt_pk_bf16_f32 v206, v49, v53
    v_cvt_pk_bf16_f32 v207, v57, v61
    buffer_store_dwordx4 v[204:207], v3, s[24:27], s38 offen offset:1024 sc1
    v_cvt_pk_bf16_f32 v208, v34, v38
    v_cvt_pk_bf16_f32 v209, v42, v46
    v_cvt_pk_bf16_f32 v210, v50, v54
    v_cvt_pk_bf16_f32 v211, v58, v62
    buffer_store_dwordx4 v[208:211], v3, s[24:27], s38 offen offset:2048 sc1
    v_cvt_pk_bf16_f32 v212, v35, v39
    v_cvt_pk_bf16_f32 v213, v43, v47
    v_cvt_pk_bf16_f32 v214, v51, v55
    v_cvt_pk_bf16_f32 v215, v59, v63
    buffer_store_dwordx4 v[212:215], v3, s[24:27], s38 offen offset:3072 sc1
    s_waitcnt vmcnt(8)
    s_nop 0
    ds_write_b64 v8, v[184:185] offset:0
    ds_write_b64 v8, v[186:187] offset:2080
    ds_write_b64 v9, v[188:189] offset:512
    ds_write_b64 v9, v[190:191] offset:2592
    ds_write_b64 v9, v[192:193] offset:1024
    ds_write_b64 v9, v[194:195] offset:3104
    ds_write_b64 v9, v[196:197] offset:1536
    ds_write_b64 v9, v[198:199] offset:3616
    s_waitcnt lgkmcnt(0)
    s_barrier
    ds_read2_b32 v[184:185], v6 offset0:0 offset1:32
    ds_read2_b32 v[186:187], v6 offset0:64 offset1:96
    ds_read2_b32 v[188:189], v7 offset0:96 offset1:64
    ds_read2_b32 v[190:191], v7 offset0:32 offset1:0
    ds_read2_b32 v[192:193], v6 offset0:1 offset1:33
    ds_read2_b32 v[194:195], v6 offset0:65 offset1:97
    ds_read2_b32 v[196:197], v7 offset0:97 offset1:65
    ds_read2_b32 v[198:199], v7 offset0:33 offset1:1
    s_add_u32 s72, s33, 3
    s_add_u32 s73, s37, 49152
    s_and_b32 s72, s72, 7
    s_lshl_b32 s72, s72, 7
    s_add_u32 m0, s73, 0
    s_nop 0
    buffer_load_dwordx4 v16, s[16:19], s72 offen lds
    s_add_u32 m0, s73, 1024
    s_nop 0
    buffer_load_dwordx4 v17, s[16:19], s72 offen lds
    s_add_u32 m0, s73, 2048
    s_nop 0
    buffer_load_dwordx4 v18, s[16:19], s72 offen lds
    s_add_u32 m0, s73, 3072
    s_nop 0
    buffer_load_dwordx4 v19, s[16:19], s72 offen lds
    s_waitcnt lgkmcnt(4)
    v_mfma_f32_16x16x32_bf16 v[32:35], v[184:187], a[224:227], 0
    v_lshlrev_b32 v216, 16, v120
    v_and_b32 v220, 0xffff0000, v120
    v_mfma_f32_16x16x32_bf16 v[36:39], v[184:187], a[228:231], 0
    v_lshlrev_b32_e64 v217, 16, v121
    v_and_b32 v221, 0xffff0000, v121
    v_mfma_f32_16x16x32_bf16 v[40:43], v[184:187], a[240:243], 0
    v_lshlrev_b32_e64 v218, 16, v122
    v_and_b32 v222, 0xffff0000, v122
    v_mfma_f32_16x16x32_bf16 v[44:47], v[184:187], a[244:247], 0
    v_lshlrev_b32_e64 v219, 16, v123
    v_and_b32 v223, 0xffff0000, v123
    v_mfma_f32_16x16x32_bf16 v[32:35], v[188:191], a[232:235], v[32:35]
    v_lshlrev_b32_e64 v224, 16, v124
    v_and_b32 v228, 0xffff0000, v124
    v_mfma_f32_16x16x32_bf16 v[36:39], v[188:191], a[236:239], v[36:39]
    v_lshlrev_b32_e64 v225, 16, v125
    v_and_b32 v229, 0xffff0000, v125
    v_mfma_f32_16x16x32_bf16 v[40:43], v[188:191], a[248:251], v[40:43]
    v_lshlrev_b32_e64 v226, 16, v126
    v_and_b32 v230, 0xffff0000, v126
    v_mfma_f32_16x16x32_bf16 v[44:47], v[188:191], a[252:255], v[44:47]
    v_lshlrev_b32_e64 v227, 16, v127
    v_and_b32 v231, 0xffff0000, v127
    s_waitcnt lgkmcnt(0)
    v_lshlrev_b32 v232, 16, v128
    v_mfma_f32_16x16x32_bf16 v[48:51], v[192:195], a[224:227], 0
    v_and_b32 v236, 0xffff0000, v128
    v_lshlrev_b32_e64 v233, 16, v129
    v_mfma_f32_16x16x32_bf16 v[52:55], v[192:195], a[228:231], 0
    v_and_b32 v237, 0xffff0000, v129
    v_lshlrev_b32_e64 v234, 16, v130
    v_mfma_f32_16x16x32_bf16 v[56:59], v[192:195], a[240:243], 0
    v_and_b32 v238, 0xffff0000, v130
    v_lshlrev_b32_e64 v235, 16, v131
    v_mfma_f32_16x16x32_bf16 v[60:63], v[192:195], a[244:247], 0
    v_and_b32 v239, 0xffff0000, v131
    v_lshlrev_b32_e64 v240, 16, v132
    v_mfma_f32_16x16x32_bf16 v[48:51], v[196:199], a[232:235], v[48:51]
    v_and_b32 v244, 0xffff0000, v132
    v_lshlrev_b32_e64 v241, 16, v133
    v_mfma_f32_16x16x32_bf16 v[52:55], v[196:199], a[236:239], v[52:55]
    v_and_b32 v245, 0xffff0000, v133
    v_lshlrev_b32_e64 v242, 16, v134
    v_mfma_f32_16x16x32_bf16 v[56:59], v[196:199], a[248:251], v[56:59]
    v_and_b32 v246, 0xffff0000, v134
    v_lshlrev_b32_e64 v243, 16, v135
    v_mfma_f32_16x16x32_bf16 v[60:63], v[196:199], a[252:255], v[60:63]
    v_and_b32 v247, 0xffff0000, v135
    v_pk_mul_f32 v[168:169], v[32:33], v[104:105]
    v_pk_mul_f32 v[170:171], v[36:37], v[104:105]
    v_pk_fma_f32 v[168:169], v[36:37], v[112:113], v[168:169]
    v_pk_fma_f32 v[170:171], v[32:33], v[112:113], v[170:171] neg_lo:[1,0,0] neg_hi:[1,0,0]
    v_pk_mul_f32 v[172:173], v[34:35], v[106:107]
    v_pk_mul_f32 v[174:175], v[38:39], v[106:107]
    v_pk_fma_f32 v[172:173], v[38:39], v[114:115], v[172:173]
    v_pk_fma_f32 v[174:175], v[34:35], v[114:115], v[174:175] neg_lo:[1,0,0] neg_hi:[1,0,0]
    v_cvt_pk_bf16_f32 v152, v168, v170
    v_cvt_pk_bf16_f32 v153, v169, v171
    v_cvt_pk_bf16_f32 v154, v172, v174
    v_cvt_pk_bf16_f32 v155, v173, v175
    v_pk_mul_f32 v[168:169], v[40:41], v[108:109]
    v_pk_mul_f32 v[170:171], v[44:45], v[108:109]
    v_pk_fma_f32 v[168:169], v[44:45], v[116:117], v[168:169]
    v_pk_fma_f32 v[170:171], v[40:41], v[116:117], v[170:171] neg_lo:[1,0,0] neg_hi:[1,0,0]
    v_pk_mul_f32 v[172:173], v[42:43], v[110:111]
    v_pk_mul_f32 v[174:175], v[46:47], v[110:111]
    v_pk_fma_f32 v[172:173], v[46:47], v[118:119], v[172:173]
    v_pk_fma_f32 v[174:175], v[42:43], v[118:119], v[174:175] neg_lo:[1,0,0] neg_hi:[1,0,0]
    v_cvt_pk_bf16_f32 v156, v168, v170
    v_cvt_pk_bf16_f32 v157, v169, v171
    v_cvt_pk_bf16_f32 v158, v172, v174
    v_cvt_pk_bf16_f32 v159, v173, v175
    v_pk_mul_f32 v[168:169], v[48:49], v[104:105]
    v_pk_mul_f32 v[170:171], v[52:53], v[104:105]
    v_pk_fma_f32 v[168:169], v[52:53], v[112:113], v[168:169]
    v_pk_fma_f32 v[170:171], v[48:49], v[112:113], v[170:171] neg_lo:[1,0,0] neg_hi:[1,0,0]
    v_pk_mul_f32 v[172:173], v[50:51], v[106:107]
    v_pk_mul_f32 v[174:175], v[54:55], v[106:107]
    v_pk_fma_f32 v[172:173], v[54:55], v[114:115], v[172:173]
    v_pk_fma_f32 v[174:175], v[50:51], v[114:115], v[174:175] neg_lo:[1,0,0] neg_hi:[1,0,0]
    v_cvt_pk_bf16_f32 v160, v168, v170
    v_cvt_pk_bf16_f32 v161, v169, v171
    v_cvt_pk_bf16_f32 v162, v172, v174
    v_cvt_pk_bf16_f32 v163, v173, v175
    v_pk_mul_f32 v[168:169], v[56:57], v[108:109]
    v_pk_mul_f32 v[170:171], v[60:61], v[108:109]
    v_pk_fma_f32 v[168:169], v[60:61], v[116:117], v[168:169]
    v_pk_fma_f32 v[170:171], v[56:57], v[116:117], v[170:171] neg_lo:[1,0,0] neg_hi:[1,0,0]
    v_pk_mul_f32 v[172:173], v[58:59], v[110:111]
    v_pk_mul_f32 v[174:175], v[62:63], v[110:111]
    v_pk_fma_f32 v[172:173], v[62:63], v[118:119], v[172:173]
    v_pk_fma_f32 v[174:175], v[58:59], v[118:119], v[174:175] neg_lo:[1,0,0] neg_hi:[1,0,0]
    v_cvt_pk_bf16_f32 v164, v168, v170
    v_cvt_pk_bf16_f32 v165, v169, v171
    v_cvt_pk_bf16_f32 v166, v172, v174
    v_cvt_pk_bf16_f32 v167, v173, v175
    v_mfma_f32_16x16x32_bf16 v[32:35], v[96:99], v[152:155], 0
    v_lshlrev_b32_e64 v4, 16, v2
    v_lshl_add_u32 v4, v1, 4, v4
    v_mfma_f32_16x16x32_bf16 v[36:39], v[100:103], v[152:155], 0
    s_add_u32 s72, s33, 4
    s_add_u32 s73, s37, 65536
    v_mfma_f32_16x16x32_bf16 v[40:43], v[96:99], v[156:159], 0
    s_and_b32 s72, s72, 7
    s_lshl_b32 s72, s72, 7
    v_mfma_f32_16x16x32_bf16 v[44:47], v[100:103], v[156:159], 0
    s_add_u32 m0, s73, 0
    v_mfma_f32_16x16x32_bf16 v[48:51], v[96:99], v[160:163], 0
    buffer_load_dwordx4 v16, s[16:19], s72 offen lds
    s_add_u32 m0, s73, 1024
    v_mfma_f32_16x16x32_bf16 v[52:55], v[100:103], v[160:163], 0
    buffer_load_dwordx4 v17, s[16:19], s72 offen lds
    s_add_u32 m0, s73, 2048
    v_mfma_f32_16x16x32_bf16 v[56:59], v[96:99], v[164:167], 0
    buffer_load_dwordx4 v18, s[16:19], s72 offen lds
    s_add_u32 m0, s73, 3072
    v_mfma_f32_16x16x32_bf16 v[60:63], v[100:103], v[164:167], 0
    buffer_load_dwordx4 v19, s[16:19], s72 offen lds
    v_pk_fma_f32 v[216:217], v[32:33], v[136:137], v[216:217] op_sel_hi:[1,0,1]
    v_pk_fma_f32 v[220:221], v[36:37], v[136:137], v[220:221] op_sel_hi:[1,0,1] neg_lo:[1,0,0] neg_hi:[1,0,0]
    v_pk_fma_f32 v[224:225], v[40:41], v[136:137], v[224:225] op_sel_hi:[1,0,1]
    v_pk_fma_f32 v[228:229], v[44:45], v[136:137], v[228:229] op_sel_hi:[1,0,1] neg_lo:[1,0,0] neg_hi:[1,0,0]
    v_pk_fma_f32 v[232:233], v[48:49], v[136:137], v[232:233] op_sel:[0,1,0]
    v_pk_fma_f32 v[236:237], v[52:53], v[136:137], v[236:237] op_sel:[0,1,0] neg_lo:[1,0,0] neg_hi:[1,0,0]
    v_pk_fma_f32 v[240:241], v[56:57], v[136:137], v[240:241] op_sel:[0,1,0]
    v_pk_fma_f32 v[244:245], v[60:61], v[136:137], v[244:245] op_sel:[0,1,0] neg_lo:[1,0,0] neg_hi:[1,0,0]
    v_cvt_pk_bf16_f32 v184, v216, v220
    v_cvt_pk_bf16_f32 v185, v224, v228
    v_cvt_pk_bf16_f32 v186, v232, v236
    v_cvt_pk_bf16_f32 v187, v240, v244
    buffer_store_dwordx4 v[184:187], v4, s[24:27], s75 offen sc1
    s_add_u32 s75, s75, 16384
    v_cvt_pk_bf16_f32 v188, v217, v221
    v_cvt_pk_bf16_f32 v189, v225, v229
    v_cvt_pk_bf16_f32 v190, v233, v237
    v_cvt_pk_bf16_f32 v191, v241, v245
    buffer_store_dwordx4 v[188:191], v4, s[24:27], s75 offen sc1
    s_add_u32 s75, s75, 16384
    v_pk_fma_f32 v[218:219], v[34:35], v[136:137], v[218:219] op_sel_hi:[1,0,1]
    v_pk_fma_f32 v[222:223], v[38:39], v[136:137], v[222:223] op_sel_hi:[1,0,1] neg_lo:[1,0,0] neg_hi:[1,0,0]
    v_pk_fma_f32 v[226:227], v[42:43], v[136:137], v[226:227] op_sel_hi:[1,0,1]
    v_pk_fma_f32 v[230:231], v[46:47], v[136:137], v[230:231] op_sel_hi:[1,0,1] neg_lo:[1,0,0] neg_hi:[1,0,0]
    v_pk_fma_f32 v[234:235], v[50:51], v[136:137], v[234:235] op_sel:[0,1,0]
    v_pk_fma_f32 v[238:239], v[54:55], v[136:137], v[238:239] op_sel:[0,1,0] neg_lo:[1,0,0] neg_hi:[1,0,0]
    v_pk_fma_f32 v[242:243], v[58:59], v[136:137], v[242:243] op_sel:[0,1,0]
    v_pk_fma_f32 v[246:247], v[62:63], v[136:137], v[246:247] op_sel:[0,1,0] neg_lo:[1,0,0] neg_hi:[1,0,0]
    v_cvt_pk_bf16_f32 v192, v218, v222
    v_cvt_pk_bf16_f32 v193, v226, v230
    v_cvt_pk_bf16_f32 v194, v234, v238
    v_cvt_pk_bf16_f32 v195, v242, v246
    buffer_store_dwordx4 v[192:195], v4, s[24:27], s75 offen sc1
    s_add_u32 s75, s75, 16384
    v_cvt_pk_bf16_f32 v196, v219, v223
    v_cvt_pk_bf16_f32 v197, v227, v231
    v_cvt_pk_bf16_f32 v198, v235, v239
    v_cvt_pk_bf16_f32 v199, v243, v247
    buffer_store_dwordx4 v[196:199], v4, s[24:27], s75 offen sc1
    s_waitcnt vmcnt(16)
    s_barrier
    ds_read_b128 v[152:155], v20 offset:0
    ds_read_b128 v[156:159], v20 offset:2048
    ds_read_b128 v[160:163], v20 offset:4096
    ds_read_b128 v[164:167], v20 offset:6144
    s_add_u32 s72, s33, 5
    s_add_u32 s73, s37, 81920
    s_and_b32 s72, s72, 7
    s_waitcnt lgkmcnt(0)
    v_mfma_f32_16x16x32_bf16 v[32:35], v[64:67], v[152:155], 0
    ds_read_b128 v[168:171], v21 offset:0
    s_lshl_b32 s72, s72, 7
    v_mfma_f32_16x16x32_bf16 v[48:51], v[80:83], v[152:155], 0
    ds_read_b128 v[172:175], v21 offset:2048
    v_mfma_f32_16x16x32_bf16 v[36:39], v[64:67], v[156:159], 0
    ds_read_b128 v[176:179], v21 offset:4096
    s_add_u32 m0, s73, 0
    s_nop 0
    v_mfma_f32_16x16x32_bf16 v[52:55], v[80:83], v[156:159], 0
    ds_read_b128 v[180:183], v21 offset:6144
    v_mfma_f32_16x16x32_bf16 v[40:43], v[64:67], v[160:163], 0
    v_mfma_f32_16x16x32_bf16 v[56:59], v[80:83], v[160:163], 0
    buffer_load_dwordx4 v16, s[16:19], s72 offen lds
    v_mfma_f32_16x16x32_bf16 v[44:47], v[64:67], v[164:167], 0
    v_mfma_f32_16x16x32_bf16 v[60:63], v[80:83], v[164:167], 0
    s_waitcnt lgkmcnt(0)
    s_nop 0
    v_mfma_f32_16x16x32_bf16 v[32:35], v[68:71], v[168:171], v[32:35]
    ds_read_b128 v[152:155], v22 offset:0
    s_add_u32 m0, s73, 1024
    v_mfma_f32_16x16x32_bf16 v[48:51], v[84:87], v[168:171], v[48:51]
    ds_read_b128 v[156:159], v22 offset:2048
    v_mfma_f32_16x16x32_bf16 v[36:39], v[68:71], v[172:175], v[36:39]
    ds_read_b128 v[160:163], v22 offset:4096
    buffer_load_dwordx4 v17, s[16:19], s72 offen lds
    v_mfma_f32_16x16x32_bf16 v[52:55], v[84:87], v[172:175], v[52:55]
    ds_read_b128 v[164:167], v22 offset:6144
    v_mfma_f32_16x16x32_bf16 v[40:43], v[68:71], v[176:179], v[40:43]
    v_mfma_f32_16x16x32_bf16 v[56:59], v[84:87], v[176:179], v[56:59]
    s_add_u32 m0, s73, 2048
    v_mfma_f32_16x16x32_bf16 v[44:47], v[68:71], v[180:183], v[44:47]
    v_mfma_f32_16x16x32_bf16 v[60:63], v[84:87], v[180:183], v[60:63]
    s_waitcnt lgkmcnt(0)
    s_nop 0
    v_mfma_f32_16x16x32_bf16 v[32:35], v[72:75], v[152:155], v[32:35]
    ds_read_b128 v[168:171], v23 offset:0
    buffer_load_dwordx4 v18, s[16:19], s72 offen lds
    v_mfma_f32_16x16x32_bf16 v[48:51], v[88:91], v[152:155], v[48:51]
    ds_read_b128 v[172:175], v23 offset:2048
    v_mfma_f32_16x16x32_bf16 v[36:39], v[72:75], v[156:159], v[36:39]
    ds_read_b128 v[176:179], v23 offset:4096
    s_add_u32 m0, s73, 3072
    v_mfma_f32_16x16x32_bf16 v[52:55], v[88:91], v[156:159], v[52:55]
    ds_read_b128 v[180:183], v23 offset:6144
    v_mfma_f32_16x16x32_bf16 v[40:43], v[72:75], v[160:163], v[40:43]
    v_mfma_f32_16x16x32_bf16 v[56:59], v[88:91], v[160:163], v[56:59]
    buffer_load_dwordx4 v19, s[16:19], s72 offen lds
    v_mfma_f32_16x16x32_bf16 v[44:47], v[72:75], v[164:167], v[44:47]
    v_mfma_f32_16x16x32_bf16 v[60:63], v[88:91], v[164:167], v[60:63]
    s_waitcnt lgkmcnt(0)
    v_mfma_f32_16x16x32_bf16 v[32:35], v[76:79], v[168:171], v[32:35]
    ds_read_b128 v[152:155], v20 offset:16384
    s_add_u32 s72, s33, 6
    v_mfma_f32_16x16x32_bf16 v[48:51], v[92:95], v[168:171], v[48:51]
    ds_read_b128 v[156:159], v20 offset:18432
    v_mfma_f32_16x16x32_bf16 v[36:39], v[76:79], v[172:175], v[36:39]
    ds_read_b128 v[160:163], v20 offset:20480
    s_add_u32 s73, s37, 98304
    v_mfma_f32_16x16x32_bf16 v[52:55], v[92:95], v[172:175], v[52:55]
    ds_read_b128 v[164:167], v20 offset:22528
    v_mfma_f32_16x16x32_bf16 v[40:43], v[76:79], v[176:179], v[40:43]
    v_mfma_f32_16x16x32_bf16 v[56:59], v[92:95], v[176:179], v[56:59]
    s_and_b32 s72, s72, 7
    v_mfma_f32_16x16x32_bf16 v[44:47], v[76:79], v[180:183], v[44:47]
    v_mfma_f32_16x16x32_bf16 v[60:63], v[92:95], v[180:183], v[60:63]
    s_waitcnt lgkmcnt(0)
    v_mfma_f32_16x16x32_bf16 v[32:35], a[0:3], v[152:155], v[32:35]
    ds_read_b128 v[168:171], v21 offset:16384
    s_lshl_b32 s72, s72, 7
    s_nop 0
    v_mfma_f32_16x16x32_bf16 v[48:51], a[16:19], v[152:155], v[48:51]
    ds_read_b128 v[172:175], v21 offset:18432
    v_mfma_f32_16x16x32_bf16 v[36:39], a[0:3], v[156:159], v[36:39]
    ds_read_b128 v[176:179], v21 offset:20480
    s_add_u32 m0, s73, 0
    s_nop 0
    v_mfma_f32_16x16x32_bf16 v[52:55], a[16:19], v[156:159], v[52:55]
    ds_read_b128 v[180:183], v21 offset:22528
    v_mfma_f32_16x16x32_bf16 v[40:43], a[0:3], v[160:163], v[40:43]
    v_mfma_f32_16x16x32_bf16 v[56:59], a[16:19], v[160:163], v[56:59]
    buffer_load_dwordx4 v16, s[16:19], s72 offen lds
    v_mfma_f32_16x16x32_bf16 v[44:47], a[0:3], v[164:167], v[44:47]
    v_mfma_f32_16x16x32_bf16 v[60:63], a[16:19], v[164:167], v[60:63]
    s_waitcnt lgkmcnt(0)
    s_nop 0
    v_mfma_f32_16x16x32_bf16 v[32:35], a[4:7], v[168:171], v[32:35]
    ds_read_b128 v[152:155], v22 offset:16384
    s_add_u32 m0, s73, 1024
    v_mfma_f32_16x16x32_bf16 v[48:51], a[20:23], v[168:171], v[48:51]
    ds_read_b128 v[156:159], v22 offset:18432
    v_mfma_f32_16x16x32_bf16 v[36:39], a[4:7], v[172:175], v[36:39]
    ds_read_b128 v[160:163], v22 offset:20480
    buffer_load_dwordx4 v17, s[16:19], s72 offen lds
    v_mfma_f32_16x16x32_bf16 v[52:55], a[20:23], v[172:175], v[52:55]
    ds_read_b128 v[164:167], v22 offset:22528
    v_mfma_f32_16x16x32_bf16 v[40:43], a[4:7], v[176:179], v[40:43]
    v_mfma_f32_16x16x32_bf16 v[56:59], a[20:23], v[176:179], v[56:59]
    s_add_u32 m0, s73, 2048
    v_mfma_f32_16x16x32_bf16 v[44:47], a[4:7], v[180:183], v[44:47]
    v_mfma_f32_16x16x32_bf16 v[60:63], a[20:23], v[180:183], v[60:63]
    s_waitcnt lgkmcnt(0)
    s_nop 0
    v_mfma_f32_16x16x32_bf16 v[32:35], a[8:11], v[152:155], v[32:35]
    ds_read_b128 v[168:171], v23 offset:16384
    buffer_load_dwordx4 v18, s[16:19], s72 offen lds
    v_mfma_f32_16x16x32_bf16 v[48:51], a[24:27], v[152:155], v[48:51]
    ds_read_b128 v[172:175], v23 offset:18432
    v_mfma_f32_16x16x32_bf16 v[36:39], a[8:11], v[156:159], v[36:39]
    ds_read_b128 v[176:179], v23 offset:20480
    s_add_u32 m0, s73, 3072
    v_mfma_f32_16x16x32_bf16 v[52:55], a[24:27], v[156:159], v[52:55]
    ds_read_b128 v[180:183], v23 offset:22528
    v_mfma_f32_16x16x32_bf16 v[40:43], a[8:11], v[160:163], v[40:43]
    v_mfma_f32_16x16x32_bf16 v[56:59], a[24:27], v[160:163], v[56:59]
    buffer_load_dwordx4 v19, s[16:19], s72 offen lds
    v_mfma_f32_16x16x32_bf16 v[44:47], a[8:11], v[164:167], v[44:47]
    v_mfma_f32_16x16x32_bf16 v[60:63], a[24:27], v[164:167], v[60:63]
    s_waitcnt lgkmcnt(0)
    v_mfma_f32_16x16x32_bf16 v[32:35], a[12:15], v[168:171], v[32:35]
    ds_read_b128 v[152:155], v20 offset:32768
    s_add_u32 s72, s33, 7
    v_mfma_f32_16x16x32_bf16 v[48:51], a[28:31], v[168:171], v[48:51]
    ds_read_b128 v[156:159], v20 offset:34816
    v_mfma_f32_16x16x32_bf16 v[36:39], a[12:15], v[172:175], v[36:39]
    ds_read_b128 v[160:163], v20 offset:36864
    s_add_u32 s73, s37, 114688
    v_mfma_f32_16x16x32_bf16 v[52:55], a[28:31], v[172:175], v[52:55]
    ds_read_b128 v[164:167], v20 offset:38912
    v_mfma_f32_16x16x32_bf16 v[40:43], a[12:15], v[176:179], v[40:43]
    v_mfma_f32_16x16x32_bf16 v[56:59], a[28:31], v[176:179], v[56:59]
    s_and_b32 s72, s72, 7
    v_mfma_f32_16x16x32_bf16 v[44:47], a[12:15], v[180:183], v[44:47]
    v_mfma_f32_16x16x32_bf16 v[60:63], a[28:31], v[180:183], v[60:63]
    s_waitcnt lgkmcnt(0)
    v_mfma_f32_16x16x32_bf16 v[32:35], a[32:35], v[152:155], v[32:35]
    ds_read_b128 v[168:171], v21 offset:32768
    s_lshl_b32 s72, s72, 7
    s_nop 0
    v_mfma_f32_16x16x32_bf16 v[48:51], a[48:51], v[152:155], v[48:51]
    ds_read_b128 v[172:175], v21 offset:34816
    v_mfma_f32_16x16x32_bf16 v[36:39], a[32:35], v[156:159], v[36:39]
    ds_read_b128 v[176:179], v21 offset:36864
    s_add_u32 m0, s73, 0
    s_nop 0
    v_mfma_f32_16x16x32_bf16 v[52:55], a[48:51], v[156:159], v[52:55]
    ds_read_b128 v[180:183], v21 offset:38912
    v_mfma_f32_16x16x32_bf16 v[40:43], a[32:35], v[160:163], v[40:43]
    v_mfma_f32_16x16x32_bf16 v[56:59], a[48:51], v[160:163], v[56:59]
    buffer_load_dwordx4 v16, s[16:19], s72 offen lds
    v_mfma_f32_16x16x32_bf16 v[44:47], a[32:35], v[164:167], v[44:47]
    v_mfma_f32_16x16x32_bf16 v[60:63], a[48:51], v[164:167], v[60:63]
    s_waitcnt lgkmcnt(0)
    s_nop 0
    v_mfma_f32_16x16x32_bf16 v[32:35], a[36:39], v[168:171], v[32:35]
    ds_read_b128 v[152:155], v22 offset:32768
    s_add_u32 m0, s73, 1024
    v_mfma_f32_16x16x32_bf16 v[48:51], a[52:55], v[168:171], v[48:51]
    ds_read_b128 v[156:159], v22 offset:34816
    v_mfma_f32_16x16x32_bf16 v[36:39], a[36:39], v[172:175], v[36:39]
    ds_read_b128 v[160:163], v22 offset:36864
    buffer_load_dwordx4 v17, s[16:19], s72 offen lds
    v_mfma_f32_16x16x32_bf16 v[52:55], a[52:55], v[172:175], v[52:55]
    ds_read_b128 v[164:167], v22 offset:38912
    v_mfma_f32_16x16x32_bf16 v[40:43], a[36:39], v[176:179], v[40:43]
    v_mfma_f32_16x16x32_bf16 v[56:59], a[52:55], v[176:179], v[56:59]
    s_add_u32 m0, s73, 2048
    v_mfma_f32_16x16x32_bf16 v[44:47], a[36:39], v[180:183], v[44:47]
    v_mfma_f32_16x16x32_bf16 v[60:63], a[52:55], v[180:183], v[60:63]
    s_waitcnt lgkmcnt(0)
    s_nop 0
    v_mfma_f32_16x16x32_bf16 v[32:35], a[40:43], v[152:155], v[32:35]
    ds_read_b128 v[168:171], v23 offset:32768
    buffer_load_dwordx4 v18, s[16:19], s72 offen lds
    v_mfma_f32_16x16x32_bf16 v[48:51], a[56:59], v[152:155], v[48:51]
    ds_read_b128 v[172:175], v23 offset:34816
    v_mfma_f32_16x16x32_bf16 v[36:39], a[40:43], v[156:159], v[36:39]
    ds_read_b128 v[176:179], v23 offset:36864
    s_add_u32 m0, s73, 3072
    v_mfma_f32_16x16x32_bf16 v[52:55], a[56:59], v[156:159], v[52:55]
    ds_read_b128 v[180:183], v23 offset:38912
    v_mfma_f32_16x16x32_bf16 v[40:43], a[40:43], v[160:163], v[40:43]
    v_mfma_f32_16x16x32_bf16 v[56:59], a[56:59], v[160:163], v[56:59]
    buffer_load_dwordx4 v19, s[16:19], s72 offen lds
    v_mfma_f32_16x16x32_bf16 v[44:47], a[40:43], v[164:167], v[44:47]
    v_mfma_f32_16x16x32_bf16 v[60:63], a[56:59], v[164:167], v[60:63]
    s_waitcnt lgkmcnt(0) vmcnt(12)
    s_barrier
    v_mfma_f32_16x16x32_bf16 v[32:35], a[44:47], v[168:171], v[32:35]
    ds_read_b128 v[152:155], v20 offset:49152
    s_lshl_b32 s68, s32, 7
    s_nop 0
    v_mfma_f32_16x16x32_bf16 v[48:51], a[60:63], v[168:171], v[48:51]
    ds_read_b128 v[156:159], v20 offset:51200
    v_mfma_f32_16x16x32_bf16 v[36:39], a[44:47], v[172:175], v[36:39]
    ds_read_b128 v[160:163], v20 offset:53248
    v_mfma_f32_16x16x32_bf16 v[52:55], a[60:63], v[172:175], v[52:55]
    ds_read_b128 v[164:167], v20 offset:55296
    v_mfma_f32_16x16x32_bf16 v[40:43], a[44:47], v[176:179], v[40:43]
    s_add_u32 s68, s68, 22310912
    v_mfma_f32_16x16x32_bf16 v[56:59], a[60:63], v[176:179], v[56:59]
    v_mfma_f32_16x16x32_bf16 v[44:47], a[44:47], v[180:183], v[44:47]
    v_mfma_f32_16x16x32_bf16 v[60:63], a[60:63], v[180:183], v[60:63]
    s_waitcnt lgkmcnt(0)
    v_mfma_f32_16x16x32_bf16 v[32:35], a[64:67], v[152:155], v[32:35]
    ds_read_b128 v[168:171], v21 offset:49152
    s_lshl_b32 s69, s33, 2
    v_mfma_f32_16x16x32_bf16 v[48:51], a[80:83], v[152:155], v[48:51]
    ds_read_b128 v[172:175], v21 offset:51200
    v_mfma_f32_16x16x32_bf16 v[36:39], a[64:67], v[156:159], v[36:39]
    ds_read_b128 v[176:179], v21 offset:53248
    s_add_u32 s69, s69, s68
    s_nop 0
    v_mfma_f32_16x16x32_bf16 v[52:55], a[80:83], v[156:159], v[52:55]
    ds_read_b128 v[180:183], v21 offset:55296
    v_mfma_f32_16x16x32_bf16 v[40:43], a[64:67], v[160:163], v[40:43]
    v_mfma_f32_16x16x32_bf16 v[56:59], a[80:83], v[160:163], v[56:59]
    s_cmp_eq_u32 s34, 0
    v_mfma_f32_16x16x32_bf16 v[44:47], a[64:67], v[164:167], v[44:47]
    v_mfma_f32_16x16x32_bf16 v[60:63], a[80:83], v[164:167], v[60:63]
    s_waitcnt lgkmcnt(0)
    v_mfma_f32_16x16x32_bf16 v[32:35], a[68:71], v[168:171], v[32:35]
    ds_read_b128 v[152:155], v22 offset:49152
    s_cselect_b32 s71, 1, 0
    s_nop 0
    v_mfma_f32_16x16x32_bf16 v[48:51], a[84:87], v[168:171], v[48:51]
    ds_read_b128 v[156:159], v22 offset:51200
    v_mfma_f32_16x16x32_bf16 v[36:39], a[68:71], v[172:175], v[36:39]
    ds_read_b128 v[160:163], v22 offset:53248
    v_mov_b32_e64 v28, s35
    v_mfma_f32_16x16x32_bf16 v[52:55], a[84:87], v[172:175], v[52:55]
    ds_read_b128 v[164:167], v22 offset:55296
    v_mfma_f32_16x16x32_bf16 v[40:43], a[68:71], v[176:179], v[40:43]
    v_mfma_f32_16x16x32_bf16 v[56:59], a[84:87], v[176:179], v[56:59]
    v_cmp_gt_u32_e64 vcc, s71, v0
    v_mfma_f32_16x16x32_bf16 v[44:47], a[68:71], v[180:183], v[44:47]
    v_mfma_f32_16x16x32_bf16 v[60:63], a[84:87], v[180:183], v[60:63]
    s_waitcnt lgkmcnt(0)
    v_mfma_f32_16x16x32_bf16 v[32:35], a[72:75], v[152:155], v[32:35]
    ds_read_b128 v[168:171], v23 offset:49152
    v_cndmask_b32 v29, 2.0, v0, vcc
    v_mfma_f32_16x16x32_bf16 v[48:51], a[88:91], v[152:155], v[48:51]
    ds_read_b128 v[172:175], v23 offset:51200
    v_mfma_f32_16x16x32_bf16 v[36:39], a[72:75], v[156:159], v[36:39]
    ds_read_b128 v[176:179], v23 offset:53248
    buffer_store_dword v28, v29, s[24:27], s69 offen sc1
    v_mfma_f32_16x16x32_bf16 v[52:55], a[88:91], v[156:159], v[52:55]
    ds_read_b128 v[180:183], v23 offset:55296
    v_mfma_f32_16x16x32_bf16 v[40:43], a[72:75], v[160:163], v[40:43]
    v_mfma_f32_16x16x32_bf16 v[56:59], a[88:91], v[160:163], v[56:59]
    v_lshlrev_b32_e64 v5, 2, v1
    v_mfma_f32_16x16x32_bf16 v[44:47], a[72:75], v[164:167], v[44:47]
    v_mfma_f32_16x16x32_bf16 v[60:63], a[88:91], v[164:167], v[60:63]
    s_waitcnt lgkmcnt(0)
    v_mfma_f32_16x16x32_bf16 v[32:35], a[76:79], v[168:171], v[32:35]
    ds_read_b128 v[152:155], v24 offset:0
    s_lshl_b32 s69, s32, 2
    v_mfma_f32_16x16x32_bf16 v[48:51], a[92:95], v[168:171], v[48:51]
    ds_read_b128 v[156:159], v24 offset:2048
    v_mfma_f32_16x16x32_bf16 v[36:39], a[76:79], v[172:175], v[36:39]
    ds_read_b128 v[160:163], v24 offset:4096
    v_mfma_f32_16x16x32_bf16 v[52:55], a[92:95], v[172:175], v[52:55]
    ds_read_b128 v[164:167], v24 offset:6144
    v_mfma_f32_16x16x32_bf16 v[40:43], a[76:79], v[176:179], v[40:43]
    v_mfma_f32_16x16x32_bf16 v[56:59], a[92:95], v[176:179], v[56:59]
    v_mfma_f32_16x16x32_bf16 v[44:47], a[76:79], v[180:183], v[44:47]
    v_mfma_f32_16x16x32_bf16 v[60:63], a[92:95], v[180:183], v[60:63]
    s_waitcnt lgkmcnt(0)
    v_mfma_f32_16x16x32_bf16 v[32:35], a[96:99], v[152:155], v[32:35]
    ds_read_b128 v[168:171], v25 offset:0
    s_add_u32 s69, s69, s34
    v_mfma_f32_16x16x32_bf16 v[48:51], a[112:115], v[152:155], v[48:51]
    ds_read_b128 v[172:175], v25 offset:2048
    v_mfma_f32_16x16x32_bf16 v[36:39], a[96:99], v[156:159], v[36:39]
    ds_read_b128 v[176:179], v25 offset:4096
    v_mfma_f32_16x16x32_bf16 v[52:55], a[112:115], v[156:159], v[52:55]
    ds_read_b128 v[180:183], v25 offset:6144
    v_mfma_f32_16x16x32_bf16 v[40:43], a[96:99], v[160:163], v[40:43]
    s_lshl_b32 s69, s69, 7
    v_mfma_f32_16x16x32_bf16 v[56:59], a[112:115], v[160:163], v[56:59]
    v_mfma_f32_16x16x32_bf16 v[44:47], a[96:99], v[164:167], v[44:47]
    v_mfma_f32_16x16x32_bf16 v[60:63], a[112:115], v[164:167], v[60:63]
    s_waitcnt lgkmcnt(0)
    v_mfma_f32_16x16x32_bf16 v[32:35], a[100:103], v[168:171], v[32:35]
    ds_read_b128 v[152:155], v26 offset:0
    s_add_u32 s69, s69, 22282240
    v_mfma_f32_16x16x32_bf16 v[48:51], a[116:119], v[168:171], v[48:51]
    ds_read_b128 v[156:159], v26 offset:2048
    v_mfma_f32_16x16x32_bf16 v[36:39], a[100:103], v[172:175], v[36:39]
    ds_read_b128 v[160:163], v26 offset:4096
    v_mfma_f32_16x16x32_bf16 v[52:55], a[116:119], v[172:175], v[52:55]
    ds_read_b128 v[164:167], v26 offset:6144
    v_mfma_f32_16x16x32_bf16 v[40:43], a[100:103], v[176:179], v[40:43]
    v_lshlrev_b32_e64 v7, 5, v2
    v_mfma_f32_16x16x32_bf16 v[56:59], a[116:119], v[176:179], v[56:59]
    v_mfma_f32_16x16x32_bf16 v[44:47], a[100:103], v[180:183], v[44:47]
    v_mfma_f32_16x16x32_bf16 v[60:63], a[116:119], v[180:183], v[60:63]
    s_waitcnt lgkmcnt(0)
    s_nop 0
    v_mfma_f32_16x16x32_bf16 v[32:35], a[104:107], v[152:155], v[32:35]
    ds_read_b128 v[168:171], v27 offset:0
    buffer_load_dwordx4 v[128:131], v7, s[24:27], s69 offen offset:0 sc1
    v_mfma_f32_16x16x32_bf16 v[48:51], a[120:123], v[152:155], v[48:51]
    ds_read_b128 v[172:175], v27 offset:2048
    v_mfma_f32_16x16x32_bf16 v[36:39], a[104:107], v[156:159], v[36:39]
    ds_read_b128 v[176:179], v27 offset:4096
    v_mfma_f32_16x16x32_bf16 v[52:55], a[120:123], v[156:159], v[52:55]
    ds_read_b128 v[180:183], v27 offset:6144
    v_mfma_f32_16x16x32_bf16 v[40:43], a[104:107], v[160:163], v[40:43]
    buffer_load_dwordx4 v[132:135], v7, s[24:27], s69 offen offset:16 sc1
    v_mfma_f32_16x16x32_bf16 v[56:59], a[120:123], v[160:163], v[56:59]
    v_mfma_f32_16x16x32_bf16 v[44:47], a[104:107], v[164:167], v[44:47]
    v_mfma_f32_16x16x32_bf16 v[60:63], a[120:123], v[164:167], v[60:63]
    s_waitcnt lgkmcnt(0) vmcnt(3)
    s_barrier
    v_mfma_f32_16x16x32_bf16 v[32:35], a[108:111], v[168:171], v[32:35]
    ds_read_b128 v[152:155], v24 offset:16384
    v_mfma_f32_16x16x32_bf16 v[48:51], a[124:127], v[168:171], v[48:51]
    ds_read_b128 v[156:159], v24 offset:18432
    v_mfma_f32_16x16x32_bf16 v[36:39], a[108:111], v[172:175], v[36:39]
    ds_read_b128 v[160:163], v24 offset:20480
    v_mfma_f32_16x16x32_bf16 v[52:55], a[124:127], v[172:175], v[52:55]
    ds_read_b128 v[164:167], v24 offset:22528
    v_mfma_f32_16x16x32_bf16 v[40:43], a[108:111], v[176:179], v[40:43]
    v_mfma_f32_16x16x32_bf16 v[56:59], a[124:127], v[176:179], v[56:59]
    v_mfma_f32_16x16x32_bf16 v[44:47], a[108:111], v[180:183], v[44:47]
    v_mfma_f32_16x16x32_bf16 v[60:63], a[124:127], v[180:183], v[60:63]
    s_waitcnt lgkmcnt(0)
    s_nop 0
    v_mfma_f32_16x16x32_bf16 v[32:35], a[128:131], v[152:155], v[32:35]
    ds_read_b128 v[168:171], v25 offset:16384
    v_mfma_f32_16x16x32_bf16 v[48:51], a[144:147], v[152:155], v[48:51]
    ds_read_b128 v[172:175], v25 offset:18432
    v_mfma_f32_16x16x32_bf16 v[36:39], a[128:131], v[156:159], v[36:39]
    ds_read_b128 v[176:179], v25 offset:20480
    v_mfma_f32_16x16x32_bf16 v[52:55], a[144:147], v[156:159], v[52:55]
    ds_read_b128 v[180:183], v25 offset:22528
    v_mfma_f32_16x16x32_bf16 v[40:43], a[128:131], v[160:163], v[40:43]
    v_mfma_f32_16x16x32_bf16 v[56:59], a[144:147], v[160:163], v[56:59]
    v_mfma_f32_16x16x32_bf16 v[44:47], a[128:131], v[164:167], v[44:47]
    v_mfma_f32_16x16x32_bf16 v[60:63], a[144:147], v[164:167], v[60:63]
    s_waitcnt lgkmcnt(0)
    s_nop 0
    v_mfma_f32_16x16x32_bf16 v[32:35], a[132:135], v[168:171], v[32:35]
    ds_read_b128 v[152:155], v26 offset:16384
    v_mfma_f32_16x16x32_bf16 v[48:51], a[148:151], v[168:171], v[48:51]
    ds_read_b128 v[156:159], v26 offset:18432
    v_mfma_f32_16x16x32_bf16 v[36:39], a[132:135], v[172:175], v[36:39]
    ds_read_b128 v[160:163], v26 offset:20480
    v_mfma_f32_16x16x32_bf16 v[52:55], a[148:151], v[172:175], v[52:55]
    ds_read_b128 v[164:167], v26 offset:22528
    v_mfma_f32_16x16x32_bf16 v[40:43], a[132:135], v[176:179], v[40:43]
    v_mfma_f32_16x16x32_bf16 v[56:59], a[148:151], v[176:179], v[56:59]
    v_mfma_f32_16x16x32_bf16 v[44:47], a[132:135], v[180:183], v[44:47]
    v_mfma_f32_16x16x32_bf16 v[60:63], a[148:151], v[180:183], v[60:63]
    s_waitcnt lgkmcnt(0)
    s_nop 0
    v_mfma_f32_16x16x32_bf16 v[32:35], a[136:139], v[152:155], v[32:35]
    ds_read_b128 v[168:171], v27 offset:16384
    buffer_load_dword v4, v5, s[24:27], s68 offen sc1
    v_mfma_f32_16x16x32_bf16 v[48:51], a[152:155], v[152:155], v[48:51]
    ds_read_b128 v[172:175], v27 offset:18432
    v_mfma_f32_16x16x32_bf16 v[36:39], a[136:139], v[156:159], v[36:39]
    ds_read_b128 v[176:179], v27 offset:20480
    v_mfma_f32_16x16x32_bf16 v[52:55], a[152:155], v[156:159], v[52:55]
    ds_read_b128 v[180:183], v27 offset:22528
    v_mfma_f32_16x16x32_bf16 v[40:43], a[136:139], v[160:163], v[40:43]
    v_mfma_f32_16x16x32_bf16 v[56:59], a[152:155], v[160:163], v[56:59]
    v_mfma_f32_16x16x32_bf16 v[44:47], a[136:139], v[164:167], v[44:47]
    v_mfma_f32_16x16x32_bf16 v[60:63], a[152:155], v[164:167], v[60:63]
    s_waitcnt lgkmcnt(0)
    s_nop 0
    v_mfma_f32_16x16x32_bf16 v[32:35], a[140:143], v[168:171], v[32:35]
    ds_read_b128 v[152:155], v24 offset:32768
    v_mfma_f32_16x16x32_bf16 v[48:51], a[156:159], v[168:171], v[48:51]
    ds_read_b128 v[156:159], v24 offset:34816
    v_mfma_f32_16x16x32_bf16 v[36:39], a[140:143], v[172:175], v[36:39]
    ds_read_b128 v[160:163], v24 offset:36864
    v_mfma_f32_16x16x32_bf16 v[52:55], a[156:159], v[172:175], v[52:55]
    ds_read_b128 v[164:167], v24 offset:38912
    v_mfma_f32_16x16x32_bf16 v[40:43], a[140:143], v[176:179], v[40:43]
    v_mfma_f32_16x16x32_bf16 v[56:59], a[156:159], v[176:179], v[56:59]
    v_mfma_f32_16x16x32_bf16 v[44:47], a[140:143], v[180:183], v[44:47]
    v_mfma_f32_16x16x32_bf16 v[60:63], a[156:159], v[180:183], v[60:63]
    s_waitcnt lgkmcnt(0)
    s_nop 0
    v_mfma_f32_16x16x32_bf16 v[32:35], a[160:163], v[152:155], v[32:35]
    ds_read_b128 v[168:171], v25 offset:32768
    v_mfma_f32_16x16x32_bf16 v[48:51], a[176:179], v[152:155], v[48:51]
    ds_read_b128 v[172:175], v25 offset:34816
    v_mfma_f32_16x16x32_bf16 v[36:39], a[160:163], v[156:159], v[36:39]
    ds_read_b128 v[176:179], v25 offset:36864
    v_mfma_f32_16x16x32_bf16 v[52:55], a[176:179], v[156:159], v[52:55]
    ds_read_b128 v[180:183], v25 offset:38912
    v_mfma_f32_16x16x32_bf16 v[40:43], a[160:163], v[160:163], v[40:43]
    v_mfma_f32_16x16x32_bf16 v[56:59], a[176:179], v[160:163], v[56:59]
    v_mfma_f32_16x16x32_bf16 v[44:47], a[160:163], v[164:167], v[44:47]
    v_mfma_f32_16x16x32_bf16 v[60:63], a[176:179], v[164:167], v[60:63]
    s_waitcnt lgkmcnt(0)
    s_nop 0
    v_mfma_f32_16x16x32_bf16 v[32:35], a[164:167], v[168:171], v[32:35]
    ds_read_b128 v[152:155], v26 offset:32768
    v_mfma_f32_16x16x32_bf16 v[48:51], a[180:183], v[168:171], v[48:51]
    ds_read_b128 v[156:159], v26 offset:34816
    v_mfma_f32_16x16x32_bf16 v[36:39], a[164:167], v[172:175], v[36:39]
    ds_read_b128 v[160:163], v26 offset:36864
    v_mfma_f32_16x16x32_bf16 v[52:55], a[180:183], v[172:175], v[52:55]
    ds_read_b128 v[164:167], v26 offset:38912
    v_mfma_f32_16x16x32_bf16 v[40:43], a[164:167], v[176:179], v[40:43]
    v_mfma_f32_16x16x32_bf16 v[56:59], a[180:183], v[176:179], v[56:59]
    v_mfma_f32_16x16x32_bf16 v[44:47], a[164:167], v[180:183], v[44:47]
    v_mfma_f32_16x16x32_bf16 v[60:63], a[180:183], v[180:183], v[60:63]
    s_waitcnt lgkmcnt(0)
    s_nop 0
    v_mfma_f32_16x16x32_bf16 v[32:35], a[168:171], v[152:155], v[32:35]
    ds_read_b128 v[168:171], v27 offset:32768
    v_mfma_f32_16x16x32_bf16 v[48:51], a[184:187], v[152:155], v[48:51]
    ds_read_b128 v[172:175], v27 offset:34816
    v_mfma_f32_16x16x32_bf16 v[36:39], a[168:171], v[156:159], v[36:39]
    ds_read_b128 v[176:179], v27 offset:36864
    v_mfma_f32_16x16x32_bf16 v[52:55], a[184:187], v[156:159], v[52:55]
    ds_read_b128 v[180:183], v27 offset:38912
    v_mfma_f32_16x16x32_bf16 v[40:43], a[168:171], v[160:163], v[40:43]
    v_mfma_f32_16x16x32_bf16 v[56:59], a[184:187], v[160:163], v[56:59]
    v_mfma_f32_16x16x32_bf16 v[44:47], a[168:171], v[164:167], v[44:47]
    v_mfma_f32_16x16x32_bf16 v[60:63], a[184:187], v[164:167], v[60:63]
    s_waitcnt lgkmcnt(0) vmcnt(0)
    s_mov_b32 s71, 0
K_POLL5:
    v_cmp_ne_u32 vcc, s35, v4
    s_nop 0
    s_cbranch_vccz K_POLL5_OK
    buffer_load_dword v4, v5, s[24:27], s68 offen sc1
    s_add_u32 s71, s71, 1
    s_cmp_lt_u32 s71, 200000
    s_waitcnt vmcnt(0)
    s_cbranch_scc1 K_POLL5
K_POLL5_OK:
    v_mfma_f32_16x16x32_bf16 v[32:35], a[172:175], v[168:171], v[32:35]
    ds_read_b128 v[152:155], v24 offset:49152
    s_lshl_b32 s68, s32, 4
    s_add_u32 s68, s68, s92
    v_mfma_f32_16x16x32_bf16 v[48:51], a[188:191], v[168:171], v[48:51]
    ds_read_b128 v[156:159], v24 offset:51200
    s_lshl_b32 s68, s68, 14
    v_mfma_f32_16x16x32_bf16 v[36:39], a[172:175], v[172:175], v[36:39]
    ds_read_b128 v[160:163], v24 offset:53248
    s_add_u32 s68, s68, s37
    v_mfma_f32_16x16x32_bf16 v[52:55], a[188:191], v[172:175], v[52:55]
    ds_read_b128 v[164:167], v24 offset:55296
    s_add_u32 s68, s68, 13631488
    v_mfma_f32_16x16x32_bf16 v[40:43], a[172:175], v[176:179], v[40:43]
    s_xor_b32 s70, s2, 4
    v_mfma_f32_16x16x32_bf16 v[56:59], a[188:191], v[176:179], v[56:59]
    s_lshl_b32 s70, s70, 14
    v_mfma_f32_16x16x32_bf16 v[44:47], a[172:175], v[180:183], v[44:47]
    s_add_u32 s70, s70, s37
    v_mfma_f32_16x16x32_bf16 v[60:63], a[188:191], v[180:183], v[60:63]
    s_add_u32 s70, s70, 17825792
    s_waitcnt lgkmcnt(0)
    v_mfma_f32_16x16x32_bf16 v[32:35], a[192:195], v[152:155], v[32:35]
    ds_read_b128 v[168:171], v25 offset:49152
    buffer_load_dwordx4 v[96:99], v3, s[24:27], s68 offen offset:0 sc1
    buffer_load_dwordx4 v[112:115], v3, s[24:27], s70 offen offset:0 sc1
    v_mfma_f32_16x16x32_bf16 v[48:51], a[208:211], v[152:155], v[48:51]
    ds_read_b128 v[172:175], v25 offset:51200
    buffer_load_dwordx4 v[100:103], v3, s[24:27], s68 offen offset:1024 sc1
    v_mfma_f32_16x16x32_bf16 v[36:39], a[192:195], v[156:159], v[36:39]
    ds_read_b128 v[176:179], v25 offset:53248
    buffer_load_dwordx4 v[116:119], v3, s[24:27], s70 offen offset:1024 sc1
    v_mfma_f32_16x16x32_bf16 v[52:55], a[208:211], v[156:159], v[52:55]
    ds_read_b128 v[180:183], v25 offset:55296
    buffer_load_dwordx4 v[104:107], v3, s[24:27], s68 offen offset:2048 sc1
    v_mfma_f32_16x16x32_bf16 v[40:43], a[192:195], v[160:163], v[40:43]
    buffer_load_dwordx4 v[120:123], v3, s[24:27], s70 offen offset:2048 sc1
    v_mfma_f32_16x16x32_bf16 v[56:59], a[208:211], v[160:163], v[56:59]
    buffer_load_dwordx4 v[108:111], v3, s[24:27], s68 offen offset:3072 sc1
    v_mfma_f32_16x16x32_bf16 v[44:47], a[192:195], v[164:167], v[44:47]
    buffer_load_dwordx4 v[124:127], v3, s[24:27], s70 offen offset:3072 sc1
    v_mfma_f32_16x16x32_bf16 v[60:63], a[208:211], v[164:167], v[60:63]
    s_waitcnt lgkmcnt(0)
    s_nop 0
    v_mfma_f32_16x16x32_bf16 v[32:35], a[196:199], v[168:171], v[32:35]
    ds_read_b128 v[152:155], v26 offset:49152
    v_mfma_f32_16x16x32_bf16 v[48:51], a[212:215], v[168:171], v[48:51]
    ds_read_b128 v[156:159], v26 offset:51200
    v_mfma_f32_16x16x32_bf16 v[36:39], a[196:199], v[172:175], v[36:39]
    ds_read_b128 v[160:163], v26 offset:53248
    v_mfma_f32_16x16x32_bf16 v[52:55], a[212:215], v[172:175], v[52:55]
    ds_read_b128 v[164:167], v26 offset:55296
    v_mfma_f32_16x16x32_bf16 v[40:43], a[196:199], v[176:179], v[40:43]
    v_mfma_f32_16x16x32_bf16 v[56:59], a[212:215], v[176:179], v[56:59]
    v_mfma_f32_16x16x32_bf16 v[44:47], a[196:199], v[180:183], v[44:47]
    v_mfma_f32_16x16x32_bf16 v[60:63], a[212:215], v[180:183], v[60:63]
    s_waitcnt lgkmcnt(0)
    s_nop 0
    v_mfma_f32_16x16x32_bf16 v[32:35], a[200:203], v[152:155], v[32:35]
    ds_read_b128 v[168:171], v27 offset:49152
    v_mfma_f32_16x16x32_bf16 v[48:51], a[216:219], v[152:155], v[48:51]
    ds_read_b128 v[172:175], v27 offset:51200
    v_mfma_f32_16x16x32_bf16 v[36:39], a[200:203], v[156:159], v[36:39]
    ds_read_b128 v[176:179], v27 offset:53248
    v_mfma_f32_16x16x32_bf16 v[52:55], a[216:219], v[156:159], v[52:55]
    ds_read_b128 v[180:183], v27 offset:55296
    v_mfma_f32_16x16x32_bf16 v[40:43], a[200:203], v[160:163], v[40:43]
    v_mfma_f32_16x16x32_bf16 v[56:59], a[216:219], v[160:163], v[56:59]
    v_mfma_f32_16x16x32_bf16 v[44:47], a[200:203], v[164:167], v[44:47]
    v_mfma_f32_16x16x32_bf16 v[60:63], a[216:219], v[164:167], v[60:63]
    s_waitcnt lgkmcnt(0)
    v_mfma_f32_16x16x32_bf16 v[32:35], a[204:207], v[168:171], v[32:35]
    s_lshl_b32 s38, s32, 7
    s_and_b32 s39, s34, 1
    v_mfma_f32_16x16x32_bf16 v[48:51], a[220:223], v[168:171], v[48:51]
    s_lshl_b32 s39, s39, 6
    v_mfma_f32_16x16x32_bf16 v[36:39], a[204:207], v[172:175], v[36:39]
    s_add_u32 s38, s38, s39
    s_lshr_b32 s39, s34, 1
    v_mfma_f32_16x16x32_bf16 v[52:55], a[220:223], v[172:175], v[52:55]
    s_lshl_b32 s39, s39, 4
    v_mfma_f32_16x16x32_bf16 v[40:43], a[204:207], v[176:179], v[40:43]
    s_add_u32 s38, s38, s39
    s_lshl_b32 s38, s38, 12
    v_mfma_f32_16x16x32_bf16 v[56:59], a[220:223], v[176:179], v[56:59]
    s_lshl_b32 s39, s92, 8
    v_mfma_f32_16x16x32_bf16 v[44:47], a[204:207], v[180:183], v[44:47]
    s_add_u32 s38, s38, s39
    v_lshlrev_b32 v4, 14, v2
    v_mfma_f32_16x16x32_bf16 v[60:63], a[220:223], v[180:183], v[60:63]
    v_lshl_add_u32 v4, v1, 4, v4
    s_waitcnt vmcnt(6)
    v_lshlrev_b32 v6, 16, v112
    v_and_b32 v7, 0xffff0000, v112
    v_lshlrev_b32_e64 v184, 16, v96
    v_and_b32 v185, 0xffff0000, v96
    v_add_f32 v6, v6, v32
    v_add_f32 v7, v7, v36
    v_fmac_f32 v184, v6, v128
    v_fmac_f32 v185, v7, v128
    v_lshlrev_b32_e64 v6, 16, v113
    v_and_b32 v7, 0xffff0000, v113
    v_lshlrev_b32_e64 v186, 16, v97
    v_and_b32 v187, 0xffff0000, v97
    v_add_f32 v6, v6, v40
    v_add_f32 v7, v7, v44
    v_fmac_f32 v186, v6, v128
    v_fmac_f32 v187, v7, v128
    s_mov_b32 s39, s38
    buffer_store_dwordx4 v[184:187], v4, s[20:23], s39 offen
    v_lshlrev_b32 v6, 16, v114
    v_and_b32 v7, 0xffff0000, v114
    v_lshlrev_b32_e64 v188, 16, v98
    v_and_b32 v189, 0xffff0000, v98
    v_add_f32 v6, v6, v48
    v_add_f32 v7, v7, v52
    v_fmac_f32 v188, v6, v129
    v_fmac_f32 v189, v7, v129
    v_lshlrev_b32_e64 v6, 16, v115
    v_and_b32 v7, 0xffff0000, v115
    v_lshlrev_b32_e64 v190, 16, v99
    v_and_b32 v191, 0xffff0000, v99
    v_add_f32 v6, v6, v56
    v_add_f32 v7, v7, v60
    v_fmac_f32 v190, v6, v129
    v_fmac_f32 v191, v7, v129
    s_add_u32 s39, s38, 131072
    buffer_store_dwordx4 v[188:191], v4, s[20:23], s39 offen
    s_waitcnt vmcnt(6)
    v_lshlrev_b32 v6, 16, v116
    v_and_b32 v7, 0xffff0000, v116
    v_lshlrev_b32_e64 v192, 16, v100
    v_and_b32 v193, 0xffff0000, v100
    v_add_f32 v6, v6, v33
    v_add_f32 v7, v7, v37
    v_fmac_f32 v192, v6, v130
    v_fmac_f32 v193, v7, v130
    v_lshlrev_b32_e64 v6, 16, v117
    v_and_b32 v7, 0xffff0000, v117
    v_lshlrev_b32_e64 v194, 16, v101
    v_and_b32 v195, 0xffff0000, v101
    v_add_f32 v6, v6, v41
    v_add_f32 v7, v7, v45
    v_fmac_f32 v194, v6, v130
    v_fmac_f32 v195, v7, v130
    s_add_u32 s39, s38, 4096
    buffer_store_dwordx4 v[192:195], v4, s[20:23], s39 offen
    v_lshlrev_b32_e64 v6, 16, v118
    v_and_b32 v7, 0xffff0000, v118
    v_lshlrev_b32_e64 v196, 16, v102
    v_and_b32 v197, 0xffff0000, v102
    v_add_f32 v6, v6, v49
    v_add_f32 v7, v7, v53
    v_fmac_f32 v196, v6, v131
    v_fmac_f32 v197, v7, v131
    v_lshlrev_b32_e64 v6, 16, v119
    v_and_b32 v7, 0xffff0000, v119
    v_lshlrev_b32_e64 v198, 16, v103
    v_and_b32 v199, 0xffff0000, v103
    v_add_f32 v6, v6, v57
    v_add_f32 v7, v7, v61
    v_fmac_f32 v198, v6, v131
    v_fmac_f32 v199, v7, v131
    s_add_u32 s39, s38, 135168
    buffer_store_dwordx4 v[196:199], v4, s[20:23], s39 offen
    s_waitcnt vmcnt(6)
    v_lshlrev_b32 v6, 16, v120
    v_and_b32 v7, 0xffff0000, v120
    v_lshlrev_b32_e64 v200, 16, v104
    v_and_b32 v201, 0xffff0000, v104
    v_add_f32 v6, v6, v34
    v_add_f32 v7, v7, v38
    v_fmac_f32 v200, v6, v132
    v_fmac_f32 v201, v7, v132
    v_lshlrev_b32_e64 v6, 16, v121
    v_and_b32 v7, 0xffff0000, v121
    v_lshlrev_b32_e64 v202, 16, v105
    v_and_b32 v203, 0xffff0000, v105
    v_add_f32 v6, v6, v42
    v_add_f32 v7, v7, v46
    v_fmac_f32 v202, v6, v132
    v_fmac_f32 v203, v7, v132
    s_add_u32 s39, s38, 8192
    buffer_store_dwordx4 v[200:203], v4, s[20:23], s39 offen
    v_lshlrev_b32_e64 v6, 16, v122
    v_and_b32 v7, 0xffff0000, v122
    v_lshlrev_b32_e64 v204, 16, v106
    v_and_b32 v205, 0xffff0000, v106
    v_add_f32 v6, v6, v50
    v_add_f32 v7, v7, v54
    v_fmac_f32 v204, v6, v133
    v_fmac_f32 v205, v7, v133
    v_lshlrev_b32_e64 v6, 16, v123
    v_and_b32 v7, 0xffff0000, v123
    v_lshlrev_b32_e64 v206, 16, v107
    v_and_b32 v207, 0xffff0000, v107
    v_add_f32 v6, v6, v58
    v_add_f32 v7, v7, v62
    v_fmac_f32 v206, v6, v133
    v_fmac_f32 v207, v7, v133
    s_add_u32 s39, s38, 139264
    buffer_store_dwordx4 v[204:207], v4, s[20:23], s39 offen
    s_waitcnt vmcnt(6)
    v_lshlrev_b32 v6, 16, v124
    v_and_b32 v7, 0xffff0000, v124
    v_lshlrev_b32_e64 v208, 16, v108
    v_and_b32 v209, 0xffff0000, v108
    v_add_f32 v6, v6, v35
    v_add_f32 v7, v7, v39
    v_fmac_f32 v208, v6, v134
    v_fmac_f32 v209, v7, v134
    v_lshlrev_b32_e64 v6, 16, v125
    v_and_b32 v7, 0xffff0000, v125
    v_lshlrev_b32_e64 v210, 16, v109
    v_and_b32 v211, 0xffff0000, v109
    v_add_f32 v6, v6, v43
    v_add_f32 v7, v7, v47
    v_fmac_f32 v210, v6, v134
    v_fmac_f32 v211, v7, v134
    s_add_u32 s39, s38, 12288
    buffer_store_dwordx4 v[208:211], v4, s[20:23], s39 offen
    v_lshlrev_b32_e64 v6, 16, v126
    v_and_b32 v7, 0xffff0000, v126
    v_lshlrev_b32_e64 v212, 16, v110
    v_and_b32 v213, 0xffff0000, v110
    v_add_f32 v6, v6, v51
    v_add_f32 v7, v7, v55
    v_fmac_f32 v212, v6, v135
    v_fmac_f32 v213, v7, v135
    v_lshlrev_b32_e64 v6, 16, v127
    v_and_b32 v7, 0xffff0000, v127
    v_lshlrev_b32_e64 v214, 16, v111
    v_and_b32 v215, 0xffff0000, v111
    v_add_f32 v6, v6, v59
    v_add_f32 v7, v7, v63
    v_fmac_f32 v214, v6, v135
    v_fmac_f32 v215, v7, v135
    s_add_u32 s39, s38, 143360
    buffer_store_dwordx4 v[212:215], v4, s[20:23], s39 offen
K_END:
    s_endpgm
K_CODE_END:
.section .rodata,"a"
.p2align 6
.amdhsa_kernel gated_mix__spectral_gfnet__ssm_conv_s5__prompt_kernel
  .amdhsa_next_free_vgpr 512
  .amdhsa_next_free_sgpr 100
  .amdhsa_accum_offset 256
  .amdhsa_group_segment_fixed_size 0
  .amdhsa_kernarg_size 128
  .amdhsa_user_sgpr_count 2
  .amdhsa_user_sgpr_kernarg_segment_ptr 1
  .amdhsa_system_sgpr_workgroup_id_x 1
.end_amdhsa_kernel
```

```asm
; @launch grid=(256,1,1) block=(256,1,1) lds=163840
.amdgcn_target "amdgcn-amd-amdhsa--gfx950"
.text
.globl gated_mix__spectral_gfnet__ssm_conv_s5__prompt_kernel
.p2align 8
.type gated_mix__spectral_gfnet__ssm_conv_s5__prompt_kernel,@function
gated_mix__spectral_gfnet__ssm_conv_s5__prompt_kernel:
    s_load_dwordx2 s[8:9], s[0:1], 0
    s_load_dwordx2 s[60:61], s[0:1], 120
    s_cmp_ge_u32 s2, 256
    s_cbranch_scc1 K_END
    s_getpc_b64 s[28:29]
K_PC:
    s_mov_b32 s30, K_CODE_END-K_PC
    s_mov_b32 s31, 0x00020000
    s_bfe_u32 s38, s2, 0x30003
    s_lshl_b32 s38, s38, 13
    v_lshl_add_u32 v4, v0, 5, s38
    v_lshrrev_b32 v3, 6, v0
    buffer_load_dword v255, v4, s[28:31], 0 offen
    s_load_dwordx8 s[52:59], s[0:1], 32
    s_load_dwordx4 s[44:47], s[0:1], 8
    s_load_dwordx8 s[80:87], s[0:1], 64
    s_load_dwordx4 s[88:91], s[0:1], 96
    v_readfirstlane_b32 s34, v3
    v_and_b32 v1, 15, v0
    v_bfe_u32 v2, v0, 4, 2
    s_and_b32 s38, s2, 3
    s_bfe_u32 s39, s2, 0x20003
    s_lshl2_add_u32 s32, s38, s39
    s_bfe_u32 s38, s2, 0x10002
    s_lshr_b32 s39, s2, 5
    s_lshl3_add_u32 s33, s38, s39
    s_and_b32 s6, s34, 1
    s_lshr_b32 s41, s34, 1
    s_lshl1_add_u32 s38, s32, s6
    s_lshl_b32 s38, s38, 5
    s_add_u32 s38, s38, s33
    s_lshl1_add_u32 s68, s38, s41
    s_lshl_b32 s68, s68, 11
    s_add_u32 s69, s68, 65536
    v_lshlrev_b32 v5, 9, v2
    v_lshl_add_u32 v29, v1, 3, v5
    s_mov_b32 s10, 0x400000
    s_mov_b32 s11, s31
    s_waitcnt lgkmcnt(0)
    buffer_load_dwordx2 v[96:97], v29, s[8:11], s68 offen offset:0
    buffer_load_dwordx2 v[98:99], v29, s[8:11], s68 offen offset:128
    v_cmp_eq_u32_e64 vcc, 0, v0
    buffer_load_dwordx2 v[100:101], v29, s[8:11], s68 offen offset:256
    s_lshl4_add_u32 s4, s32, s33
    s_lshl_b32 s37, s34, 12
    v_cndmask_b32 v30, 2.0, v0, vcc
    v_and_b32 v0, 63, v0
    v_lshlrev_b32 v3, 4, v0
    s_lshl_b32 s63, s34, 4
    buffer_load_dwordx2 v[102:103], v29, s[8:11], s68 offen offset:384
    s_lshl2_add_u32 s94, s6, s41
    v_and_b32 v6, 7, v0
    v_xor_b32 v6, v6, v2
    v_lshlrev_b32 v6, 4, v6
    v_and_b32_e64 v8, 32, v0
    v_bfe_u32 v9, v0, 3, 1
    v_lshl_add_u32 v8, v9, 4, v8
    buffer_load_dwordx2 v[104:105], v29, s[8:11], s69 offen offset:0
    v_bfe_u32 v9, v0, 4, 1
    s_lshl_b32 s38, s32, 5
    s_add_u32 s38, s38, s34
    s_lshl_b32 s38, s38, 2
    v_add3_u32 v8, v8, v9, s38
    v_lshl_add_u32 v16, v8, 11, v6
    v_lshrrev_b32 v9, 3, v0
    buffer_load_dwordx2 v[106:107], v29, s[8:11], s69 offen offset:128
    s_lshl1_add_u32 s38, s33, s6
    s_lshl_b32 s38, s38, 5
    v_add_u32_e64 v9, s38, v9
    v_lshl_add_u32 v20, v9, 11, v6
    v_xor_b32 v8, 64, v16
    v_xor_b32 v9, 64, v20
    v_add_u32 v17, 130048, v8
    buffer_load_dwordx2 v[108:109], v29, s[8:11], s69 offen offset:256
    v_add_u32 v18, 2048, v16
    v_add_u32 v19, 132096, v8
    v_add_u32 v21, 15360, v9
    v_add_u32 v22, 30720, v20
    v_add_u32 v23, 46080, v9
    s_add_u32 s38, s32, s33
    s_and_b32 s38, s38, 3
    buffer_load_dwordx2 v[110:111], v29, s[8:11], s69 offen offset:384
    s_mov_b32 s66, 1703092544
    s_mov_b32 s67, 4275808711
    s_cmp_eq_u32 s38, 1
    s_cselect_b32 s66, 2036348193, s66
    s_cselect_b32 s67, 3488136612, s67
    s_cmp_eq_u32 s38, 2
    s_cselect_b32 s66, 2758893618, s66
    s_cselect_b32 s67, 3707365557, s67
    s_cmp_eq_u32 s38, 3
    s_cselect_b32 s66, 1699160323, s66
    s_cselect_b32 s67, 3989809547, s67
    s_and_b32 s38, s2, 3
    s_mul_i32 s38, s38, 0x44444444
    s_xor_b32 s66, s66, s38
    s_xor_b32 s67, s67, s38
    s_mov_b32 s14, 0x200000
    s_mov_b32 s15, s31
    v_cvt_f32_u32 v249, v1
    s_add_u32 s40, s60, 22343680
    s_addc_u32 s41, s61, 0
    v_cvt_f32_u32 v250, v2
    v_mul_f32 v251, 0x3d800000, v249
    v_mul_f32 v250, 4.0, v250
    v_mul_f32 v248, v250, v251
    s_load_dword s62, s[40:41], 0
    v_fmamk_f32 v4, v251, 0x00000000, v248
    v_fmamk_f32 v5, v251, 0x3f800000, v248
    v_fmamk_f32 v6, v251, 0x40000000, v248
    v_fmamk_f32 v7, v251, 0x40400000, v248
    v_cos_f32 v8, v4
    s_cmp_lt_u32 s34, 2
    s_cselect_b64 s[12:13], s[56:57], s[58:59]
    s_cselect_b64 s[28:29], s[88:89], s[86:87]
    v_cos_f32 v9, v5
    v_cos_f32 v10, v6
    v_cos_f32 v11, v7
    v_sin_f32 v12, v4
    s_mov_b32 s30, 2048
    v_sin_f32 v13, v5
    v_sin_f32 v14, v6
    v_sin_f32_e64 v15, v7
    v_cvt_pk_bf16_f32 v4, v8, v12
    v_cvt_pk_bf16_f32 v5, -v12, v8
    s_lshl_b32 s38, s6, 10
    s_nop 0
    v_accvgpr_write_b32 a224, v4
    v_accvgpr_write_b32 a228, v5
    v_cvt_pk_bf16_f32 v4, v9, v13
    v_cvt_pk_bf16_f32 v5, -v13, v9
    v_accvgpr_write_b32 a225, v4
    s_lshl_b32 s39, s34, 10
    s_nop 0
    v_accvgpr_write_b32 a229, v5
    v_cvt_pk_bf16_f32 v4, v10, v14
    v_cvt_pk_bf16_f32 v5, -v14, v10
    v_accvgpr_write_b32 a226, v4
    s_add_u32 m0, s39, 147712
    v_accvgpr_write_b32 a230, v5
    v_cvt_pk_bf16_f32 v4, v11, v15
    v_cvt_pk_bf16_f32 v5, -v15, v11
    v_accvgpr_write_b32 a227, v4
    v_accvgpr_write_b32 a231, v5
    s_lshl2_add_u32 s39, s33, s34
    s_nop 0
    v_fmamk_f32 v4, v251, 0x3f000000, v248
    v_fmamk_f32 v5, v251, 0x3fc00000, v248
    v_fmamk_f32 v6, v251, 0x40200000, v248
    v_fmamk_f32 v7, v251, 0x40600000, v248
    v_cos_f32_e64 v8, v4
    buffer_load_dwordx4 v3, s[28:31], s38 offen lds
    v_cos_f32 v9, v5
    v_cos_f32 v10, v6
    v_cos_f32 v11, v7
    v_sin_f32 v12, v4
    s_lshl_b32 s39, s39, 4
    v_sin_f32 v13, v5
    v_sin_f32 v14, v6
    v_sin_f32 v15, v7
    v_cvt_pk_bf16_f32 v4, v8, v12
    v_cvt_pk_bf16_f32 v5, -v12, v8
    v_add_lshl_u32 v28, v1, s39, 1
    v_accvgpr_write_b32 a248, v4
    v_accvgpr_write_b32 a252, v5
    v_cvt_pk_bf16_f32 v4, v9, v13
    v_cvt_pk_bf16_f32 v5, -v13, v9
    global_load_ushort v142, v28, s[52:53]
    v_accvgpr_write_b32 a249, v4
    v_accvgpr_write_b32 a253, v5
    v_cvt_pk_bf16_f32 v4, v10, v14
    v_cvt_pk_bf16_f32 v5, -v14, v10
    v_accvgpr_write_b32 a250, v4
    global_load_ushort v143, v28, s[54:55]
    v_accvgpr_write_b32 a254, v5
    v_cvt_pk_bf16_f32 v4, v11, v15
    v_cvt_pk_bf16_f32 v5, -v15, v11
    v_accvgpr_write_b32 a251, v4
    v_accvgpr_write_b32 a255, v5
    global_load_ushort v144, v28, s[84:85]
    v_mul_f32 v251, 0x3d800000, v251
    v_mul_f32 v248, 0x3d800000, v248
    v_fmamk_f32 v4, v251, 0x00000000, v248
    v_fmamk_f32 v5, v251, 0x3f800000, v248
    s_bfe_u32 s36, s66, 262144
    v_fmamk_f32 v6, v251, 0x40000000, v248
    v_fmamk_f32 v7, v251, 0x40400000, v248
    v_cos_f32 v232, v4
    v_cos_f32 v233, v5
    v_cos_f32 v234, v6
    s_add_u32 m0, s37, 0
    v_cos_f32 v235, v7
    v_sin_f32 v240, v4
    v_sin_f32 v241, v5
    v_sin_f32 v242, v6
    v_sin_f32 v243, v7
    s_lshl_b32 s36, s36, 7
    v_fmamk_f32 v4, v251, 0x3f000000, v248
    v_fmamk_f32 v5, v251, 0x3fc00000, v248
    v_fmamk_f32 v6, v251, 0x40200000, v248
    v_fmamk_f32 v7, v251, 0x40600000, v248
    buffer_load_dwordx4 v16, s[8:11], s36 offen offset:0 lds
    v_cos_f32 v236, v4
    v_cos_f32 v237, v5
    v_cos_f32 v238, v6
    v_cos_f32 v239, v7
    v_sin_f32_e64 v244, v4
    buffer_load_dwordx4 v17, s[8:11], s36 offen offset:1024 lds
    v_sin_f32 v245, v5
    v_sin_f32 v246, v6
    v_sin_f32 v247, v7
    s_mov_b64 s[24:25], s[60:61]
    buffer_load_dwordx4 v18, s[8:11], s36 offen offset:2048 lds
    s_mov_b32 s26, 33554432
    s_mov_b32 s27, 0x00020000
    v_lshrrev_b32 v15, 1, v1
    v_xor_b32 v15, v15, v2
    v_lshlrev_b32_e64 v15, 4, v15
    buffer_load_dwordx4 v19, s[8:11], s36 offen offset:3072 lds
    v_lshl_add_u32 v24, v1, 7, v15
    v_xor_b32 v25, 64, v24
    s_lshl_b32 s76, s34, 11
    s_add_u32 s76, s76, 16384
    v_add_u32_e64 v26, s76, v24
    s_add_u32 m0, s37, 16384
    v_add_u32_e64 v27, s76, v25
    v_add_u32 v148, 0x10000, v24
    v_add_u32 v149, 0x10000, v25
    v_add_u32 v150, 0x10000, v26
    buffer_load_dwordx4 v20, s[12:15], s36 offen offset:0 lds
    v_add_u32 v151, 0x10000, v27
    s_and_b32 s76, s34, 2
    s_lshl1_add_u32 s76, s76, s6
    s_mul_i32 s76, s76, 2080
    s_add_u32 s76, s76, 131072
    buffer_load_dwordx4 v21, s[12:15], s36 offen offset:1024 lds
    v_lshl_add_u32 v15, v2, 6, v1
    v_lshl_add_u32 v252, v15, 3, s76
    v_sub_u32 v15, 728, v15
    v_lshl_add_u32 v253, v15, 3, s76
    v_lshrrev_b32 v7, 2, v0
    v_add_u32 v7, s63, v7
    v_and_b32 v15, 3, v0
    v_lshlrev_b32 v12, 4, v15
    v_mul_u32_u24 v229, 4160, v15
    v_lshl_add_u32 v229, v7, 3, v229
    v_add_u32 v229, 131072, v229
    v_lshrrev_b32_e64 v14, 2, v0
    v_lshl_add_u32 v230, v14, 8, v12
    v_and_b32_e64 v14, 3, v14
    v_lshl_add_u32 v231, v14, 10, v12
    v_lshl_add_u32 v231, v2, 19, v231
    v_and_b32 v15, 1, v15
    v_lshlrev_b32 v15, 11, v15
    v_cmp_eq_u32_e64 vcc, 0, v7
    v_add_u32 v254, 147712, v29
    s_nop 0
    v_cndmask_b32 v15, 0, v15, vcc
    v_add_u32_e64 v228, v229, v15
    v_accvgpr_write_b32 a136, v232
    v_accvgpr_write_b32 a144, v240
    v_accvgpr_write_b32 a137, v233
    v_accvgpr_write_b32 a145, v241
    v_accvgpr_write_b32 a138, v234
    v_accvgpr_write_b32 a146, v242
    v_accvgpr_write_b32 a139, v235
    v_accvgpr_write_b32 a147, v243
    v_accvgpr_write_b32 a170, v252
    v_accvgpr_write_b32 a171, v253
    v_accvgpr_write_b32 a172, v228
    v_accvgpr_write_b32 a173, v229
    v_fma_f32 v251, v249, 2.0, 1.0
    v_mul_f32 v251, 0x3d000000, v251
    v_mul_f32_e64 v248, v250, v251
    v_fmamk_f32 v4, v251, 0x00000000, v248
    v_fmamk_f32 v5, v251, 0x3f800000, v248
    v_fmamk_f32 v6, v251, 0x40000000, v248
    v_fmamk_f32 v7, v251, 0x40400000, v248
    v_cos_f32 v8, v4
    v_cos_f32 v9, v5
    v_cos_f32 v10, v6
    v_cos_f32 v11, v7
    v_sin_f32 v12, v4
    v_sin_f32 v13, v5
    v_sin_f32 v14, v6
    v_sin_f32 v15, v7
    v_cvt_pk_bf16_f32 v4, v8, v12
    v_cvt_pk_bf16_f32 v5, -v12, v8
    v_accvgpr_write_b32 a232, v4
    v_accvgpr_write_b32 a236, v5
    v_cvt_pk_bf16_f32 v4, v9, v13
    v_cvt_pk_bf16_f32 v5, -v13, v9
    v_accvgpr_write_b32 a233, v4
    v_accvgpr_write_b32 a237, v5
    v_cvt_pk_bf16_f32 v4, v10, v14
    v_cvt_pk_bf16_f32 v5, -v14, v10
    v_accvgpr_write_b32 a234, v4
    v_accvgpr_write_b32 a238, v5
    v_cvt_pk_bf16_f32 v4, v11, v15
    v_cvt_pk_bf16_f32 v5, -v15, v11
    v_accvgpr_write_b32 a235, v4
    v_accvgpr_write_b32 a239, v5
    v_cvt_pk_bf16_f32 v4, -v8, -v12
    v_cvt_pk_bf16_f32 v5, v12, -v8
    v_accvgpr_write_b32 a240, v4
    v_accvgpr_write_b32 a244, v5
    v_cvt_pk_bf16_f32 v4, -v9, -v13
    v_cvt_pk_bf16_f32 v5, v13, -v9
    v_accvgpr_write_b32 a241, v4
    v_accvgpr_write_b32 a245, v5
    v_cvt_pk_bf16_f32 v4, -v10, -v14
    v_cvt_pk_bf16_f32 v5, v14, -v10
    v_accvgpr_write_b32 a242, v4
    v_accvgpr_write_b32 a246, v5
    v_cvt_pk_bf16_f32 v4, -v11, -v15
    v_cvt_pk_bf16_f32 v5, v15, -v11
    v_accvgpr_write_b32 a243, v4
    v_accvgpr_write_b32 a247, v5
    v_mul_f32 v251, 0x3d800000, v251
    v_mul_f32 v248, 0x3d800000, v248
    v_fmamk_f32 v4, v251, 0x00000000, v248
    v_fmamk_f32 v5, v251, 0x3f800000, v248
    v_fmamk_f32 v6, v251, 0x40000000, v248
    v_fmamk_f32 v7, v251, 0x40400000, v248
    v_cos_f32 v8, v4
    v_cos_f32 v9, v5
    v_cos_f32 v10, v6
    v_cos_f32 v11, v7
    v_sin_f32 v12, v4
    v_sin_f32 v13, v5
    v_sin_f32 v14, v6
    v_sin_f32 v15, v7
    v_accvgpr_write_b32 a140, v8
    v_accvgpr_write_b32 a148, v12
    v_accvgpr_write_b32 a141, v9
    v_accvgpr_write_b32 a149, v13
    v_accvgpr_write_b32 a142, v10
    v_accvgpr_write_b32 a150, v14
    v_accvgpr_write_b32 a143, v11
    v_accvgpr_write_b32 a151, v15
    v_add_u32 v251, s63, v1
    v_cvt_f32_u32 v251, v251
    v_and_b32_e64 v147, 1, v1
    v_mul_f32 v251, 0x3c800000, v251
    v_mul_u32_u24 v147, 0x8000, v147
    v_mul_f32_e64 v248, v250, v251
    v_lshl_or_b32 v147, v147, 16, v147
    v_fmamk_f32 v4, v251, 0x00000000, v248
    v_fmamk_f32 v5, v251, 0x3f800000, v248
    v_fmamk_f32 v6, v251, 0x40000000, v248
    v_fmamk_f32 v7, v251, 0x40400000, v248
    v_cos_f32 v8, v4
    v_cos_f32 v9, v5
    v_cos_f32 v10, v6
    v_cos_f32 v11, v7
    v_sin_f32 v12, v4
    v_sin_f32 v13, v5
    v_sin_f32 v14, v6
    v_sin_f32 v15, v7
    v_cvt_pk_bf16_f32 v4, v8, v12
    v_cvt_pk_bf16_f32 v5, -v12, v8
    v_accvgpr_write_b32 a0, v4
    v_accvgpr_write_b32 a4, v5
    v_xor_b32 v4, v147, v4
    v_xor_b32 v5, v147, v5
    v_accvgpr_write_b32 a16, v4
    v_accvgpr_write_b32 a20, v5
    v_cvt_pk_bf16_f32 v4, v9, v13
    v_cvt_pk_bf16_f32 v5, -v13, v9
    v_accvgpr_write_b32 a1, v4
    v_accvgpr_write_b32 a5, v5
    v_xor_b32 v4, v147, v4
    v_xor_b32 v5, v147, v5
    v_accvgpr_write_b32 a17, v4
    v_accvgpr_write_b32 a21, v5
    v_cvt_pk_bf16_f32 v4, v10, v14
    v_cvt_pk_bf16_f32 v5, -v14, v10
    v_accvgpr_write_b32 a2, v4
    v_accvgpr_write_b32 a6, v5
    v_xor_b32 v4, v147, v4
    v_xor_b32 v5, v147, v5
    v_accvgpr_write_b32 a18, v4
    v_accvgpr_write_b32 a22, v5
    v_cvt_pk_bf16_f32 v4, v11, v15
    v_cvt_pk_bf16_f32 v5, -v15, v11
    v_accvgpr_write_b32 a3, v4
    v_accvgpr_write_b32 a7, v5
    v_xor_b32 v4, v147, v4
    v_xor_b32 v5, v147, v5
    v_accvgpr_write_b32 a19, v4
    v_accvgpr_write_b32 a23, v5
    v_fmamk_f32 v4, v251, 0x41800000, v248
    v_fmamk_f32 v5, v251, 0x41880000, v248
    v_fmamk_f32 v6, v251, 0x41900000, v248
    v_fmamk_f32 v7, v251, 0x41980000, v248
    v_cos_f32 v8, v4
    v_cos_f32 v9, v5
    v_cos_f32 v10, v6
    v_cos_f32 v11, v7
    v_sin_f32 v12, v4
    v_sin_f32 v13, v5
    v_sin_f32 v14, v6
    v_sin_f32 v15, v7
    v_cvt_pk_bf16_f32 v4, v8, v12
    v_cvt_pk_bf16_f32 v5, -v12, v8
    v_accvgpr_write_b32 a8, v4
    v_accvgpr_write_b32 a12, v5
    v_xor_b32 v4, v147, v4
    v_xor_b32 v5, v147, v5
    s_mov_b64 s[16:17], s[44:45]
    s_mov_b32 s18, 2101248
    s_mov_b32 s19, 0x00020000
    s_mov_b64 s[20:21], s[46:47]
    s_mov_b32 s22, 2101248
    s_mov_b32 s23, 0x00020000
    s_lshr_b32 s38, s2, 6
    s_and_b32 s39, s2, 3
    s_lshl2_add_u32 s38, s38, s39
    s_bfe_u32 s39, s2, 0x10005
    s_bfe_u32 s40, s2, 0x20002
    s_lshl2_add_u32 s39, s39, s40
    s_bfe_u32 s40, s2, 0x10004
    s_lshl1_add_u32 s39, s39, s40
    s_lshl_b32 s39, s39, 7
    s_lshl2_add_u32 s38, s38, s39
    v_add_u32 v184, s38, v2
    v_add_u32 v185, s63, v1
    s_movk_i32 s40, 1026
    v_mul_u32_u24_e64 v186, s40, v184
    v_lshl_add_u32 v200, v185, 3, v186
    v_sub_u32 v187, 2048, v184
    v_and_b32 v188, 2047, v187
    v_subrev_u32 v187, 64, v187
    v_lshlrev_b32 v189, 3, v185
    v_sub_u32 v189, 1018, v189
    v_mad_u32_u24 v201, v188, s40, v189
    v_mad_u32_u24 v202, v187, s40, v189
    s_mov_b32 s70, 65664
    v_cmp_eq_u32_e64 vcc, 0, v185
    v_add_u32 v186, 512, v186
    v_lshlrev_b32 v187, 4, v2
    v_cndmask_b32 v203, 2.0, v186, vcc
    v_cndmask_b32 v204, 2.0, v187, vcc
    v_lshrrev_b32 v185, 2, v0
    v_and_b32_e64 v189, 3, v0
    v_lshl_add_u32 v184, v189, 2, v185
    v_and_b32_e64 v184, 15, v184
    v_lshl_add_u32 v184, v189, 4, v184
    s_add_u32 s40, s37, 131072
    v_lshl_add_u32 v206, v184, 4, s40
    v_lshl_add_u32 v184, v2, 2, v1
    v_and_b32_e64 v184, 15, v184
    v_lshl_add_u32 v184, v2, 4, v184
    v_lshl_add_u32 v205, v184, 4, s40
    s_mov_b64 s[28:29], s[90:91]
    s_mov_b32 s30, 0x800000
    s_waitcnt vmcnt(14)
    v_swap_b32 v97, v98
    v_swap_b32 v101, v102
    v_swap_b32 v98, v100
    v_swap_b32 v99, v101
    s_waitcnt vmcnt(10)
    v_swap_b32 v105, v106
    v_swap_b32 v109, v110
    v_swap_b32 v106, v108
    v_swap_b32 v107, v109
    v_mfma_f32_16x16x32_bf16 v[32:35], v[96:99], a[224:227], 0
    buffer_load_dwordx4 v22, s[12:15], s36 offen offset:2048 lds
    s_and_b32 s38, s33, 3
    s_lshr_b32 s39, s32, 2
    v_mfma_f32_16x16x32_bf16 v[36:39], v[96:99], a[228:231], 0
    s_lshl2_add_u32 s38, s38, s39
    s_and_b32 s39, s32, 3
    v_mfma_f32_16x16x32_bf16 v[40:43], v[100:103], a[224:227], 0
    s_lshl2_add_u32 s38, s38, s39
    s_lshl_b32 s39, s34, 7
    v_mfma_f32_16x16x32_bf16 v[44:47], v[100:103], a[228:231], 0
    s_add_u32 s38, s38, s39
    v_mfma_f32_16x16x32_bf16 v[48:51], v[104:107], a[224:227], 0
    buffer_load_dwordx4 v23, s[12:15], s36 offen offset:3072 lds
    s_lshl_b32 s38, s38, 6
    s_lshr_b32 s39, s33, 2
    v_mfma_f32_16x16x32_bf16 v[52:55], v[104:107], a[228:231], 0
    s_add_u32 s38, s38, s39
    s_lshl_b32 s68, s38, 6
    v_mfma_f32_16x16x32_bf16 v[56:59], v[108:111], a[224:227], 0
    s_lshr_b32 s39, s34, 1
    s_lshl1_add_u32 s38, s33, s39
    v_mfma_f32_16x16x32_bf16 v[60:63], v[108:111], a[228:231], 0
    s_lshr_b32 s39, s38, 4
    s_lshl1_add_u32 s39, s39, s6
    s_lshl2_add_u32 s41, s32, s39
    s_and_b32 s40, s38, 15
    v_pk_mul_f32 v[184:185], v[32:33], v[232:233]
    v_pk_mul_f32 v[186:187], v[36:37], v[232:233]
    v_pk_fma_f32 v[184:185], v[36:37], v[240:241], v[184:185]
    v_pk_fma_f32 v[186:187], v[32:33], v[240:241], v[186:187] neg_lo:[1,0,0] neg_hi:[1,0,0]
    buffer_load_dwordx2 v[208:209], v200, s[16:19], 0 offen
    v_pk_mul_f32 v[188:189], v[34:35], v[234:235]
    v_pk_mul_f32 v[190:191], v[38:39], v[234:235]
    v_pk_fma_f32 v[188:189], v[38:39], v[242:243], v[188:189]
    v_pk_fma_f32 v[190:191], v[34:35], v[242:243], v[190:191] neg_lo:[1,0,0] neg_hi:[1,0,0]
    v_cvt_pk_bf16_f32 v152, v184, v186
    v_cvt_pk_bf16_f32 v153, v185, v187
    v_cvt_pk_bf16_f32 v154, v188, v190
    v_cvt_pk_bf16_f32 v155, v189, v191
    v_pk_mul_f32 v[184:185], v[40:41], v[236:237]
    v_pk_mul_f32 v[186:187], v[44:45], v[236:237]
    buffer_load_dwordx2 v[210:211], v200, s[20:23], 0 offen
    v_pk_fma_f32 v[184:185], v[44:45], v[244:245], v[184:185]
    v_pk_fma_f32 v[186:187], v[40:41], v[244:245], v[186:187] neg_lo:[1,0,0] neg_hi:[1,0,0]
    v_pk_mul_f32 v[188:189], v[42:43], v[238:239]
    v_pk_mul_f32 v[190:191], v[46:47], v[238:239]
    v_pk_fma_f32 v[188:189], v[46:47], v[246:247], v[188:189]
    v_pk_fma_f32 v[190:191], v[42:43], v[246:247], v[190:191] neg_lo:[1,0,0] neg_hi:[1,0,0]
    v_cvt_pk_bf16_f32 v156, v184, v186
    v_cvt_pk_bf16_f32 v157, v185, v187
    v_cvt_pk_bf16_f32 v158, v188, v190
    v_cvt_pk_bf16_f32 v159, v189, v191
    buffer_load_dwordx2 v[212:213], v201, s[16:19], 0 offen
    v_pk_mul_f32 v[184:185], v[48:49], v[232:233]
    v_pk_mul_f32 v[186:187], v[52:53], v[232:233]
    v_pk_fma_f32 v[184:185], v[52:53], v[240:241], v[184:185]
    v_pk_fma_f32 v[186:187], v[48:49], v[240:241], v[186:187] neg_lo:[1,0,0] neg_hi:[1,0,0]
    v_pk_mul_f32 v[188:189], v[50:51], v[234:235]
    v_pk_mul_f32 v[190:191], v[54:55], v[234:235]
    v_pk_fma_f32 v[188:189], v[54:55], v[242:243], v[188:189]
    v_pk_fma_f32 v[190:191], v[50:51], v[242:243], v[190:191] neg_lo:[1,0,0] neg_hi:[1,0,0]
    v_cvt_pk_bf16_f32 v160, v184, v186
    v_cvt_pk_bf16_f32 v161, v185, v187
    v_cvt_pk_bf16_f32 v162, v188, v190
    buffer_load_dwordx2 v[214:215], v201, s[20:23], 0 offen
    v_cvt_pk_bf16_f32 v163, v189, v191
    v_pk_mul_f32 v[184:185], v[56:57], v[236:237]
    v_pk_mul_f32 v[186:187], v[60:61], v[236:237]
    v_pk_fma_f32 v[184:185], v[60:61], v[244:245], v[184:185]
    v_pk_fma_f32 v[186:187], v[56:57], v[244:245], v[186:187] neg_lo:[1,0,0] neg_hi:[1,0,0]
    v_pk_mul_f32 v[188:189], v[58:59], v[238:239]
    v_pk_mul_f32 v[190:191], v[62:63], v[238:239]
    v_pk_fma_f32 v[188:189], v[62:63], v[246:247], v[188:189]
    v_pk_fma_f32 v[190:191], v[58:59], v[246:247], v[190:191] neg_lo:[1,0,0] neg_hi:[1,0,0]
    v_cvt_pk_bf16_f32 v164, v184, v186
    buffer_load_ushort v224, v203, s[16:19], 0 offen
    v_cvt_pk_bf16_f32 v165, v185, v187
    v_cvt_pk_bf16_f32 v166, v188, v190
    v_cvt_pk_bf16_f32 v167, v189, v191
    v_mfma_f32_16x16x32_bf16 v[64:67], a[224:227], v[152:155], 0
    s_lshl4_add_u32 s41, s41, s40
    s_lshl3_add_u32 s69, s41, 22282240
    v_mfma_f32_16x16x32_bf16 v[68:71], a[228:231], v[152:155], 0
    s_lshl_b32 s41, s32, 6
    s_add_u32 s39, s39, s41
    v_mfma_f32_16x16x32_bf16 v[72:75], a[248:251], v[156:159], 0
    buffer_load_ushort v225, v203, s[20:23], 0 offen
    s_and_b32 s40, s38, 3
    s_lshl2_add_u32 s39, s39, s40
    v_mfma_f32_16x16x32_bf16 v[76:79], a[252:255], v[156:159], 0
    s_bfe_u32 s40, s38, 0x20002
    s_lshl2_add_u32 s39, s39, s40
    v_mfma_f32_16x16x32_bf16 v[80:83], a[224:227], v[160:163], 0
    s_lshl_b32 s39, s39, 8
    s_add_u32 s75, s39, 13631488
    v_mfma_f32_16x16x32_bf16 v[84:87], a[228:231], v[160:163], 0
    s_getreg_b32 s96, hwreg(HW_REG_XCC_ID, 0, 4)
    s_and_b32 s38, s2, 31
    buffer_load_dwordx2 v[216:217], v200, s[16:19], s70 offen
    v_mfma_f32_16x16x32_bf16 v[88:91], a[248:251], v[164:167], 0
    s_lshl_b32 s38, s38, 7
    s_add_u32 s51, s38, 22302720
    v_mfma_f32_16x16x32_bf16 v[92:95], a[252:255], v[164:167], 0
    s_lshr_b32 s38, s2, 5
    s_lshl2_add_u32 s77, s38, s51
    v_pk_add_f32 v[32:33], v[64:65], v[72:73]
    v_pk_add_f32 v[40:41], v[64:65], v[72:73] neg_lo:[0,1] neg_hi:[0,1]
    v_pk_add_f32 v[34:35], v[66:67], v[74:75]
    v_pk_add_f32 v[42:43], v[66:67], v[74:75] neg_lo:[0,1] neg_hi:[0,1]
    buffer_load_dwordx2 v[218:219], v200, s[20:23], s70 offen
    v_pk_add_f32 v[36:37], v[68:69], v[76:77]
    v_pk_add_f32 v[44:45], v[68:69], v[76:77] neg_lo:[0,1] neg_hi:[0,1]
    v_pk_add_f32 v[38:39], v[70:71], v[78:79]
    v_pk_add_f32 v[46:47], v[70:71], v[78:79] neg_lo:[0,1] neg_hi:[0,1]
    v_pk_add_f32 v[48:49], v[80:81], v[88:89]
    v_pk_add_f32 v[56:57], v[80:81], v[88:89] neg_lo:[0,1] neg_hi:[0,1]
    v_pk_add_f32 v[50:51], v[82:83], v[90:91]
    v_pk_add_f32 v[58:59], v[82:83], v[90:91] neg_lo:[0,1] neg_hi:[0,1]
    v_pk_add_f32 v[52:53], v[84:85], v[92:93]
    v_pk_add_f32 v[60:61], v[84:85], v[92:93] neg_lo:[0,1] neg_hi:[0,1]
    buffer_load_dwordx2 v[220:221], v202, s[16:19], 0 offen
    v_pk_add_f32 v[54:55], v[86:87], v[94:95]
    v_pk_add_f32 v[62:63], v[86:87], v[94:95] neg_lo:[0,1] neg_hi:[0,1]
    v_cvt_pk_bf16_f32 v168, v32, v36
    v_cvt_pk_bf16_f32 v169, v48, v52
    ds_write_b64 v252, v[168:169] offset:0
    v_cvt_pk_bf16_f32 v170, v33, v37
    v_cvt_pk_bf16_f32 v171, v49, v53
    ds_write_b64 v252, v[170:171] offset:128
    v_cvt_pk_bf16_f32 v172, v34, v38
    v_cvt_pk_bf16_f32 v173, v50, v54
    ds_write_b64 v252, v[172:173] offset:256
    buffer_load_dwordx2 v[222:223], v202, s[20:23], 0 offen
    v_cvt_pk_bf16_f32 v174, v35, v39
    v_cvt_pk_bf16_f32 v175, v51, v55
    ds_write_b64 v252, v[174:175] offset:384
    v_cvt_pk_bf16_f32 v176, v40, -v44
    v_cvt_pk_bf16_f32 v177, v56, -v60
    ds_write_b64 v253, v[176:177] offset:384
    v_cvt_pk_bf16_f32 v178, v41, -v45
    v_cvt_pk_bf16_f32 v179, v57, -v61
    ds_write_b64 v253, v[178:179] offset:256
    v_cvt_pk_bf16_f32 v180, v42, -v46
    buffer_load_ushort v226, v203, s[16:19], s70 offen
    v_cvt_pk_bf16_f32 v181, v58, -v62
    ds_write_b64 v253, v[180:181] offset:128
    v_cvt_pk_bf16_f32 v182, v43, -v47
    v_cvt_pk_bf16_f32 v183, v59, -v63
    ds_write_b64 v253, v[182:183] offset:0
    v_lshlrev_b32_e64 v64, 16, v96
    v_and_b32 v68, 0xffff0000, v96
    v_lshlrev_b32_e64 v65, 16, v97
    v_and_b32 v69, 0xffff0000, v97
    v_lshlrev_b32_e64 v66, 16, v98
    buffer_load_ushort v227, v203, s[20:23], s70 offen
    v_and_b32 v70, 0xffff0000, v98
    v_lshlrev_b32_e64 v67, 16, v99
    v_and_b32 v71, 0xffff0000, v99
    v_lshlrev_b32_e64 v72, 16, v100
    v_and_b32 v76, 0xffff0000, v100
    v_lshlrev_b32_e64 v73, 16, v101
    v_and_b32 v77, 0xffff0000, v101
    v_lshlrev_b32_e64 v74, 16, v102
    v_and_b32 v78, 0xffff0000, v102
    v_lshlrev_b32_e64 v75, 16, v103
    v_and_b32 v79, 0xffff0000, v103
    v_lshlrev_b32_e64 v80, 16, v104
    v_and_b32 v84, 0xffff0000, v104
    v_lshlrev_b32_e64 v81, 16, v105
    v_and_b32 v85, 0xffff0000, v105
    v_lshlrev_b32_e64 v82, 16, v106
    v_and_b32 v86, 0xffff0000, v106
    v_lshlrev_b32_e64 v83, 16, v107
    v_and_b32 v87, 0xffff0000, v107
    v_lshlrev_b32_e64 v88, 16, v108
    v_and_b32 v92, 0xffff0000, v108
    v_lshlrev_b32_e64 v89, 16, v109
    v_and_b32 v93, 0xffff0000, v109
    v_lshlrev_b32_e64 v90, 16, v110
    v_and_b32 v94, 0xffff0000, v110
    v_lshlrev_b32_e64 v91, 16, v111
    v_and_b32 v95, 0xffff0000, v111
    s_waitcnt lgkmcnt(0) vmcnt(23)
    s_barrier
    ds_read_b64 v[112:113], v254 offset:0
    ds_read_b64 v[114:115], v254 offset:128
    ds_read_b64 v[116:117], v254 offset:256
    ds_read_b64 v[118:119], v254 offset:384
    ds_read_b64 v[120:121], v254 offset:2048
    ds_read_b64 v[122:123], v254 offset:2176
    ds_read_b64 v[124:125], v254 offset:2304
    ds_read_b64 v[126:127], v254 offset:2432
    ds_read_b64 v[232:233], v228 offset:0
    ds_read_b64 v[234:235], v228 offset:2080
    ds_read_b64 v[236:237], v229 offset:512
    ds_read_b64 v[238:239], v229 offset:2592
    ds_read_b64 v[240:241], v229 offset:1024
    ds_read_b64 v[242:243], v229 offset:3104
    ds_read_b64 v[244:245], v229 offset:1536
    ds_read_b64 v[246:247], v229 offset:3616
    s_mul_i32 s35, s62, 2654435761
    s_add_u32 s35, s35, 2135587861
    s_cmp_eq_u32 s34, 0
    s_cselect_b32 s98, s35, 0
    s_cselect_b32 s99, 0, 2.0
    s_waitcnt lgkmcnt(12)
    v_mov_b32_e64 v28, s96
    s_bfe_u32 s36, s66, 262148
    v_dot2_f32_bf16 v184, v96, v112, 0
    buffer_store_dword v28, v30, s[24:27], s77 offen sc1
    v_dot2_f32_bf16 v185, v104, v112, 0
    v_dot2_f32_bf16 v184, v100, v113, v184
    v_dot2_f32_bf16 v185, v108, v113, v185
    v_dot2_f32_bf16 v184, v97, v114, v184
    v_dot2_f32_bf16 v185, v105, v114, v185
    v_dot2_f32_bf16 v184, v101, v115, v184
    v_dot2_f32_bf16 v185, v109, v115, v185
    v_dot2_f32_bf16 v184, v98, v116, v184
    v_dot2_f32_bf16 v185, v106, v116, v185
    v_dot2_f32_bf16 v184, v102, v117, v184
    v_dot2_f32_bf16 v185, v110, v117, v185
    v_dot2_f32_bf16 v184, v99, v118, v184
    s_add_u32 m0, s37, 32768
    v_dot2_f32_bf16 v185, v107, v118, v185
    v_dot2_f32_bf16 v184, v103, v119, v184
    v_dot2_f32_bf16 v185, v111, v119, v185
    s_waitcnt lgkmcnt(8)
    v_lshlrev_b32 v32, 16, v120
    v_and_b32 v36, 0xffff0000, v120
    v_add_f32_dpp v184, v184, v184 row_ror:8 row_mask:0xf bank_mask:0xf
    v_add_f32_dpp v185, v185, v185 row_ror:8 row_mask:0xf bank_mask:0xf
    v_lshlrev_b32_e64 v40, 16, v121
    v_add_f32_dpp v184, v184, v184 row_ror:4 row_mask:0xf bank_mask:0xf
    v_and_b32 v44, 0xffff0000, v121
    v_add_f32_dpp v185, v185, v185 row_ror:4 row_mask:0xf bank_mask:0xf
    v_lshlrev_b32 v33, 16, v122
    s_lshl_b32 s36, s36, 7
    v_add_f32_dpp v184, v184, v184 row_ror:2 row_mask:0xf bank_mask:0xf
    v_and_b32 v37, 0xffff0000, v122
    v_add_f32_dpp v185, v185, v185 row_ror:2 row_mask:0xf bank_mask:0xf
    v_lshlrev_b32_e64 v41, 16, v123
    v_add_f32_dpp v184, v184, v184 row_ror:1 row_mask:0xf bank_mask:0xf
    v_and_b32 v45, 0xffff0000, v123
    v_add_f32_dpp v185, v185, v185 row_ror:1 row_mask:0xf bank_mask:0xf
    v_lshlrev_b32 v34, 16, v124
    s_nop 0
    v_permlane32_swap_b32 v184, v185
    v_and_b32 v38, 0xffff0000, v124
    v_add_f32 v184, v184, v185
    v_lshlrev_b32 v42, 16, v125
    v_mov_b32 v185, v184
    buffer_load_dwordx4 v16, s[8:11], s36 offen offset:0 lds
    v_and_b32 v46, 0xffff0000, v125
    v_permlane16_swap_b32 v184, v185
    v_lshlrev_b32 v35, 16, v126
    v_add_f32_e64 v184, v184, v185
    v_and_b32 v39, 0xffff0000, v126
    v_cvt_pk_bf16_f32 v184, v184, v184
    v_lshlrev_b32 v43, 16, v127
    v_lshlrev_b32 v184, 16, v184
    v_and_b32 v47, 0xffff0000, v127
    v_mul_f32 v184, 0xbfb8aa3b, v184
    v_pk_mul_f32 v[64:65], v[64:65], v[32:33]
    v_exp_f32_e64 v184, v184
    v_pk_mul_f32 v[66:67], v[66:67], v[34:35]
    buffer_load_dwordx4 v17, s[8:11], s36 offen offset:1024 lds
    v_add_f32_e64 v184, 1.0, v184
    v_pk_mul_f32 v[68:69], v[68:69], v[36:37]
    v_rcp_f32_e64 v184, v184
    v_pk_mul_f32 v[70:71], v[70:71], v[38:39]
    v_cvt_pk_bf16_f32 v184, v184, v184
    v_pk_mul_f32 v[72:73], v[72:73], v[40:41]
    v_lshlrev_b32_e64 v184, 16, v184
    v_pk_mul_f32 v[74:75], v[74:75], v[42:43]
    v_sub_f32_e64 v186, 1.0, v184
    v_pk_mul_f32 v[76:77], v[76:77], v[44:45]
    v_cvt_pk_bf16_f32 v186, v186, v186
    v_pk_mul_f32 v[78:79], v[78:79], v[46:47]
    v_lshlrev_b32_e64 v186, 16, v186
    buffer_load_dwordx4 v18, s[8:11], s36 offen offset:2048 lds
    v_pk_mul_f32 v[80:81], v[80:81], v[32:33]
    v_mov_b32_e64 v185, v184
    v_pk_mul_f32 v[82:83], v[82:83], v[34:35]
    v_mov_b32_e64 v187, v186
    v_pk_mul_f32 v[84:85], v[84:85], v[36:37]
    v_permlane32_swap_b32 v184, v185
    v_pk_mul_f32 v[86:87], v[86:87], v[38:39]
    v_permlane32_swap_b32 v186, v187
    v_pk_mul_f32 v[88:89], v[88:89], v[40:41]
    v_cmp_eq_u32_e64 vcc, 0, v0
    v_pk_mul_f32 v[90:91], v[90:91], v[42:43]
    v_accvgpr_write_b32 a168, v184
    v_pk_mul_f32 v[92:93], v[92:93], v[44:45]
    buffer_load_dwordx4 v19, s[8:11], s36 offen offset:3072 lds
    v_accvgpr_write_b32 a169, v185
    v_pk_mul_f32 v[94:95], v[94:95], v[46:47]
    v_cndmask_b32_e64 v188, 2.0, v0, vcc
    buffer_store_dwordx2 v[186:187], v188, s[24:27], s69 offen sc1
    v_pk_mul_f32 v[64:65], v[64:65], v[186:187] op_sel_hi:[1,0]
    v_pk_mul_f32 v[66:67], v[66:67], v[186:187] op_sel_hi:[1,0]
    v_pk_mul_f32 v[68:69], v[68:69], v[186:187] op_sel_hi:[1,0]
    v_pk_mul_f32 v[70:71], v[70:71], v[186:187] op_sel_hi:[1,0]
    v_cvt_pk_bf16_f32 v190, v64, v68
    v_accvgpr_write_b32 a152, v190
    v_cvt_pk_bf16_f32 v191, v65, v69
    v_accvgpr_write_b32 a153, v191
    v_cvt_pk_bf16_f32 v190, v66, v70
    s_add_u32 m0, s37, 49152
    v_accvgpr_write_b32 a154, v190
    v_cvt_pk_bf16_f32 v191, v67, v71
    v_accvgpr_write_b32 a155, v191
    v_pk_mul_f32 v[72:73], v[72:73], v[186:187] op_sel_hi:[1,0]
    v_pk_mul_f32 v[74:75], v[74:75], v[186:187] op_sel_hi:[1,0]
    v_pk_mul_f32 v[76:77], v[76:77], v[186:187] op_sel_hi:[1,0]
    v_pk_mul_f32 v[78:79], v[78:79], v[186:187] op_sel_hi:[1,0]
    v_cvt_pk_bf16_f32 v190, v72, v76
    v_accvgpr_write_b32 a156, v190
    v_cvt_pk_bf16_f32 v191, v73, v77
    v_accvgpr_write_b32 a157, v191
    v_cvt_pk_bf16_f32 v190, v74, v78
    v_accvgpr_write_b32 a158, v190
    buffer_load_dwordx4 v20, s[12:15], s36 offen offset:0 lds
    v_cvt_pk_bf16_f32 v191, v75, v79
    v_accvgpr_write_b32 a159, v191
    v_pk_mul_f32 v[80:81], v[80:81], v[186:187] op_sel:[0,1]
    v_pk_mul_f32 v[82:83], v[82:83], v[186:187] op_sel:[0,1]
    v_pk_mul_f32 v[84:85], v[84:85], v[186:187] op_sel:[0,1]
    v_pk_mul_f32 v[86:87], v[86:87], v[186:187] op_sel:[0,1]
    v_cvt_pk_bf16_f32 v190, v80, v84
    v_accvgpr_write_b32 a160, v190
    v_cvt_pk_bf16_f32 v191, v81, v85
    v_accvgpr_write_b32 a161, v191
    v_cvt_pk_bf16_f32 v190, v82, v86
    v_accvgpr_write_b32 a162, v190
    v_cvt_pk_bf16_f32 v191, v83, v87
    buffer_load_dwordx4 v21, s[12:15], s36 offen offset:1024 lds
    v_accvgpr_write_b32 a163, v191
    v_pk_mul_f32 v[88:89], v[88:89], v[186:187] op_sel:[0,1]
    v_pk_mul_f32 v[90:91], v[90:91], v[186:187] op_sel:[0,1]
    v_pk_mul_f32 v[92:93], v[92:93], v[186:187] op_sel:[0,1]
    v_pk_mul_f32 v[94:95], v[94:95], v[186:187] op_sel:[0,1]
    v_cvt_pk_bf16_f32 v190, v88, v92
    v_accvgpr_write_b32 a164, v190
    v_cvt_pk_bf16_f32 v191, v89, v93
    v_accvgpr_write_b32 a165, v191
    v_cvt_pk_bf16_f32 v190, v90, v94
    v_accvgpr_write_b32 a166, v190
    v_cvt_pk_bf16_f32 v191, v91, v95
    v_accvgpr_write_b32 a167, v191
    buffer_load_dwordx4 v22, s[12:15], s36 offen offset:2048 lds
    v_accvgpr_write_b32 a24, v4
    v_accvgpr_write_b32 a28, v5
    v_cvt_pk_bf16_f32 v4, v9, v13
    v_cvt_pk_bf16_f32 v5, -v13, v9
    v_accvgpr_write_b32 a9, v4
    v_accvgpr_write_b32 a13, v5
    v_xor_b32 v4, v147, v4
    v_xor_b32 v5, v147, v5
    v_accvgpr_write_b32 a25, v4
    v_accvgpr_write_b32 a29, v5
    v_cvt_pk_bf16_f32 v4, v10, v14
    v_cvt_pk_bf16_f32 v5, -v14, v10
    v_accvgpr_write_b32 a10, v4
    buffer_load_dwordx4 v23, s[12:15], s36 offen offset:3072 lds
    v_accvgpr_write_b32 a14, v5
    v_xor_b32 v4, v147, v4
    v_xor_b32 v5, v147, v5
    v_accvgpr_write_b32 a26, v4
    v_accvgpr_write_b32 a30, v5
    v_cvt_pk_bf16_f32 v4, v11, v15
    v_cvt_pk_bf16_f32 v5, -v15, v11
    v_accvgpr_write_b32 a11, v4
    v_accvgpr_write_b32 a15, v5
    v_xor_b32 v4, v147, v4
    v_xor_b32 v5, v147, v5
    v_accvgpr_write_b32 a27, v4
    v_accvgpr_write_b32 a31, v5
    s_waitcnt lgkmcnt(0) vmcnt(22)
    s_barrier
    ds_read_b128 a[64:67], v26 offset:0
    ds_read_b128 a[68:71], v26 offset:8192
    ds_read_b128 a[32:35], v24 offset:0
    ds_read_b128 a[36:39], v24 offset:2048
    ds_read_b128 a[40:43], v24 offset:4096
    ds_read_b128 a[44:47], v24 offset:6144
    ds_read_b128 a[48:51], v24 offset:8192
    ds_read_b128 a[52:55], v24 offset:10240
    ds_read_b128 a[56:59], v24 offset:12288
    ds_read_b128 a[60:63], v24 offset:14336
    s_bfe_u32 s36, s66, 262152
    s_add_u32 m0, s37, 65536
    s_lshl_b32 s36, s36, 7
    s_nop 0
    buffer_load_dwordx4 v16, s[8:11], s36 offen offset:0 lds
    buffer_load_dwordx4 v17, s[8:11], s36 offen offset:1024 lds
    buffer_load_dwordx4 v18, s[8:11], s36 offen offset:2048 lds
    buffer_load_dwordx4 v19, s[8:11], s36 offen offset:3072 lds
    s_add_u32 m0, s37, 81920
    s_nop 0
    s_nop 0
    buffer_load_dwordx4 v20, s[12:15], s36 offen offset:0 lds
    buffer_load_dwordx4 v21, s[12:15], s36 offen offset:1024 lds
    buffer_load_dwordx4 v22, s[12:15], s36 offen offset:2048 lds
    buffer_load_dwordx4 v23, s[12:15], s36 offen offset:3072 lds
    s_waitcnt lgkmcnt(0)
    s_nop 0
    v_mfma_f32_16x16x32_bf16 v[32:35], a[32:35], a[64:67], 0
    ds_read_b128 a[104:107], v27 offset:0
    s_bfe_u32 s36, s66, 262156
    v_mfma_f32_16x16x32_bf16 v[36:39], a[32:35], a[68:71], 0
    ds_read_b128 a[108:111], v27 offset:8192
    s_add_u32 m0, s37, 98304
    v_mfma_f32_16x16x32_bf16 v[40:43], a[36:39], a[64:67], 0
    ds_read_b128 a[72:75], v25 offset:0
    s_lshl_b32 s36, s36, 7
    s_nop 0
    v_mfma_f32_16x16x32_bf16 v[44:47], a[36:39], a[68:71], 0
    ds_read_b128 a[76:79], v25 offset:2048
    v_mfma_f32_16x16x32_bf16 v[48:51], a[40:43], a[64:67], 0
    ds_read_b128 a[80:83], v25 offset:4096
    buffer_load_dwordx4 v16, s[8:11], s36 offen offset:0 lds
    v_mfma_f32_16x16x32_bf16 v[52:55], a[40:43], a[68:71], 0
    ds_read_b128 a[84:87], v25 offset:6144
    buffer_load_dwordx4 v17, s[8:11], s36 offen offset:1024 lds
    v_mfma_f32_16x16x32_bf16 v[56:59], a[44:47], a[64:67], 0
    ds_read_b128 a[88:91], v25 offset:8192
    buffer_load_dwordx4 v18, s[8:11], s36 offen offset:2048 lds
    v_mfma_f32_16x16x32_bf16 v[60:63], a[44:47], a[68:71], 0
    ds_read_b128 a[92:95], v25 offset:10240
    v_mfma_f32_16x16x32_bf16 v[64:67], a[48:51], a[64:67], 0
    ds_read_b128 a[96:99], v25 offset:12288
    buffer_load_dwordx4 v19, s[8:11], s36 offen offset:3072 lds
    v_mfma_f32_16x16x32_bf16 v[68:71], a[48:51], a[68:71], 0
    ds_read_b128 a[100:103], v25 offset:14336
    s_add_u32 m0, s37, 114688
    v_mfma_f32_16x16x32_bf16 v[72:75], a[52:55], a[64:67], 0
    buffer_load_dwordx4 v20, s[12:15], s36 offen offset:0 lds
    v_mfma_f32_16x16x32_bf16 v[76:79], a[52:55], a[68:71], 0
    v_mfma_f32_16x16x32_bf16 v[80:83], a[56:59], a[64:67], 0
    buffer_load_dwordx4 v21, s[12:15], s36 offen offset:1024 lds
    v_mfma_f32_16x16x32_bf16 v[84:87], a[56:59], a[68:71], 0
    buffer_load_dwordx4 v22, s[12:15], s36 offen offset:2048 lds
    v_mfma_f32_16x16x32_bf16 v[88:91], a[60:63], a[64:67], 0
    buffer_load_dwordx4 v23, s[12:15], s36 offen offset:3072 lds
    v_mfma_f32_16x16x32_bf16 v[92:95], a[60:63], a[68:71], 0
    s_waitcnt lgkmcnt(0) vmcnt(16)
    s_barrier
    v_mfma_f32_16x16x32_bf16 v[32:35], a[72:75], a[104:107], v[32:35]
    ds_read_b128 a[64:67], v26 offset:32768
    s_bfe_u32 s36, s66, 262160
    s_mov_b32 s76, 0x05040100
    v_mfma_f32_16x16x32_bf16 v[36:39], a[72:75], a[108:111], v[36:39]
    ds_read_b128 a[68:71], v26 offset:40960
    s_mov_b32 s77, 0x07060302
    s_lshl_b32 s40, s2, 6
    v_mfma_f32_16x16x32_bf16 v[40:43], a[76:79], a[104:107], v[40:43]
    ds_read_b128 a[32:35], v24 offset:32768
    s_add_u32 m0, s37, 0
    v_lshl_or_b32 v224, v225, 16, v224
    v_lshl_or_b32 v226, v227, 16, v226
    v_mfma_f32_16x16x32_bf16 v[44:47], a[76:79], a[108:111], v[44:47]
    ds_read_b128 a[36:39], v24 offset:34816
    buffer_store_dwordx4 v[224:227], v204, s[24:27], s40 offen sc1
    v_mfma_f32_16x16x32_bf16 v[48:51], a[80:83], a[104:107], v[48:51]
    ds_read_b128 a[40:43], v24 offset:36864
    v_perm_b32 v152, v210, v208, s76
    v_perm_b32 v153, v215, v213, s77
    v_mfma_f32_16x16x32_bf16 v[52:55], a[80:83], a[108:111], v[52:55]
    ds_read_b128 a[44:47], v24 offset:38912
    s_lshl_b32 s36, s36, 7
    s_nop 0
    v_perm_b32 v154, v218, v216, s76
    v_perm_b32 v155, v223, v221, s77
    v_mfma_f32_16x16x32_bf16 v[56:59], a[84:87], a[104:107], v[56:59]
    ds_read_b128 a[48:51], v24 offset:40960
    ds_write_b128 v205, v[152:155] offset:0
    v_mfma_f32_16x16x32_bf16 v[60:63], a[84:87], a[108:111], v[60:63]
    ds_read_b128 a[52:55], v24 offset:43008
    v_perm_b32 v156, v210, v208, s77
    v_perm_b32 v157, v215, v213, s76
    v_mfma_f32_16x16x32_bf16 v[64:67], a[88:91], a[104:107], v[64:67]
    ds_read_b128 a[56:59], v24 offset:45056
    buffer_load_dwordx4 v16, s[8:11], s36 offen offset:0 lds
    v_perm_b32 v158, v218, v216, s77
    v_perm_b32 v159, v223, v221, s76
    v_mfma_f32_16x16x32_bf16 v[68:71], a[88:91], a[108:111], v[68:71]
    ds_read_b128 a[60:63], v24 offset:47104
    ds_write_b128 v205, v[156:159] offset:1024
    v_mfma_f32_16x16x32_bf16 v[72:75], a[92:95], a[104:107], v[72:75]
    buffer_load_dwordx4 v17, s[8:11], s36 offen offset:1024 lds
    v_perm_b32 v160, v211, v209, s76
    v_perm_b32 v161, v214, v212, s77
    v_mfma_f32_16x16x32_bf16 v[76:79], a[92:95], a[108:111], v[76:79]
    v_perm_b32 v162, v219, v217, s76
    v_perm_b32 v163, v222, v220, s77
    v_mfma_f32_16x16x32_bf16 v[80:83], a[96:99], a[104:107], v[80:83]
    ds_write_b128 v205, v[160:163] offset:2048
    v_mfma_f32_16x16x32_bf16 v[84:87], a[96:99], a[108:111], v[84:87]
    buffer_load_dwordx4 v18, s[8:11], s36 offen offset:2048 lds
    v_perm_b32 v164, v211, v209, s77
    v_perm_b32 v165, v214, v212, s76
    v_mfma_f32_16x16x32_bf16 v[88:91], a[100:103], a[104:107], v[88:91]
    v_perm_b32 v166, v219, v217, s77
    v_perm_b32 v167, v222, v220, s76
    v_mfma_f32_16x16x32_bf16 v[92:95], a[100:103], a[108:111], v[92:95]
    ds_write_b128 v205, v[164:167] offset:3072
    s_waitcnt lgkmcnt(3)
    v_mfma_f32_16x16x32_bf16 v[32:35], a[32:35], a[64:67], v[32:35]
    ds_read_b128 a[104:107], v27 offset:32768
    buffer_load_dwordx4 v19, s[8:11], s36 offen offset:3072 lds
    s_waitcnt lgkmcnt(1)
    v_mfma_f32_16x16x32_bf16 v[36:39], a[32:35], a[68:71], v[36:39]
    ds_read_b128 a[108:111], v27 offset:40960
    ds_read_b128 v[168:171], v206 offset:0
    v_mfma_f32_16x16x32_bf16 v[40:43], a[36:39], a[64:67], v[40:43]
    ds_read_b128 a[72:75], v25 offset:32768
    s_add_u32 m0, s37, 16384
    ds_read_b128 v[172:175], v206 offset:1024
    v_mfma_f32_16x16x32_bf16 v[44:47], a[36:39], a[68:71], v[44:47]
    ds_read_b128 a[76:79], v25 offset:34816
    ds_read_b128 v[176:179], v206 offset:2048
    v_mfma_f32_16x16x32_bf16 v[48:51], a[40:43], a[64:67], v[48:51]
    ds_read_b128 a[80:83], v25 offset:36864
    ds_read_b128 v[180:183], v206 offset:3072
    v_mfma_f32_16x16x32_bf16 v[52:55], a[40:43], a[68:71], v[52:55]
    ds_read_b128 a[84:87], v25 offset:38912
    buffer_load_dwordx4 v20, s[12:15], s36 offen offset:0 lds
    v_mfma_f32_16x16x32_bf16 v[56:59], a[44:47], a[64:67], v[56:59]
    ds_read_b128 a[88:91], v25 offset:40960
    s_lshr_b32 s40, s2, 2
    buffer_store_dwordx4 v[232:235], v230, s[28:31], s68 offen sc1
    v_mfma_f32_16x16x32_bf16 v[60:63], a[44:47], a[68:71], v[60:63]
    ds_read_b128 a[92:95], v25 offset:43008
    s_lshl_b32 s41, s34, 9
    v_mfma_f32_16x16x32_bf16 v[64:67], a[48:51], a[64:67], v[64:67]
    ds_read_b128 a[96:99], v25 offset:45056
    buffer_load_dwordx4 v21, s[12:15], s36 offen offset:1024 lds
    s_add_u32 s40, s40, s41
    s_add_u32 s68, s68, 2097152
    v_mfma_f32_16x16x32_bf16 v[68:71], a[48:51], a[68:71], v[68:71]
    ds_read_b128 a[100:103], v25 offset:47104
    s_add_u32 s40, s40, 64
    v_mfma_f32_16x16x32_bf16 v[72:75], a[52:55], a[64:67], v[72:75]
    buffer_load_dwordx4 v22, s[12:15], s36 offen offset:2048 lds
    v_mfma_f32_16x16x32_bf16 v[76:79], a[52:55], a[68:71], v[76:79]
    s_lshl_b32 s40, s40, 6
    v_mfma_f32_16x16x32_bf16 v[80:83], a[56:59], a[64:67], v[80:83]
    s_and_b32 s41, s2, 3
    v_mfma_f32_16x16x32_bf16 v[84:87], a[56:59], a[68:71], v[84:87]
    buffer_load_dwordx4 v23, s[12:15], s36 offen offset:3072 lds
    s_add_u32 s40, s40, s41
    v_mfma_f32_16x16x32_bf16 v[88:91], a[60:63], a[64:67], v[88:91]
    s_lshl_b32 s76, s40, 6
    v_mfma_f32_16x16x32_bf16 v[92:95], a[60:63], a[68:71], v[92:95]
    s_waitcnt lgkmcnt(0) vmcnt(18)
    s_barrier
    v_mfma_f32_16x16x32_bf16 v[32:35], a[72:75], a[104:107], v[32:35]
    ds_read_b128 a[64:67], v150 offset:0
    s_bfe_u32 s36, s66, 262164
    v_mfma_f32_16x16x32_bf16 v[36:39], a[72:75], a[108:111], v[36:39]
    ds_read_b128 a[68:71], v150 offset:8192
    v_lshlrev_b32_e64 v144, 16, v144
    v_mfma_f32_16x16x32_bf16 v[40:43], a[76:79], a[104:107], v[40:43]
    ds_read_b128 a[32:35], v148 offset:0
    s_add_u32 m0, s37, 32768
    v_mfma_f32_16x16x32_bf16 v[44:47], a[76:79], a[108:111], v[44:47]
    ds_read_b128 a[36:39], v148 offset:2048
    v_lshlrev_b32_e64 v142, 16, v142
    v_mfma_f32_16x16x32_bf16 v[48:51], a[80:83], a[104:107], v[48:51]
    ds_read_b128 a[40:43], v148 offset:4096
    v_mul_f32 v144, 0x3fb8aa3b, v144
    v_mfma_f32_16x16x32_bf16 v[52:55], a[80:83], a[108:111], v[52:55]
    ds_read_b128 a[44:47], v148 offset:6144
    s_lshl_b32 s36, s36, 7
    v_mfma_f32_16x16x32_bf16 v[56:59], a[84:87], a[104:107], v[56:59]
    ds_read_b128 a[48:51], v148 offset:8192
    v_exp_f32 v144, v144
    buffer_store_dwordx4 v[236:239], v230, s[28:31], s68 offen sc1
    v_mfma_f32_16x16x32_bf16 v[60:63], a[84:87], a[108:111], v[60:63]
    ds_read_b128 a[52:55], v148 offset:10240
    v_mfma_f32_16x16x32_bf16 v[64:67], a[88:91], a[104:107], v[64:67]
    ds_read_b128 a[56:59], v148 offset:12288
    buffer_load_dwordx4 v16, s[8:11], s36 offen offset:0 lds
    v_lshlrev_b32_e64 v143, 16, v143
    s_add_u32 s68, s68, 2097152
    v_mfma_f32_16x16x32_bf16 v[68:71], a[88:91], a[108:111], v[68:71]
    ds_read_b128 a[60:63], v148 offset:14336
    v_cvt_pk_bf16_f32 v144, v144, v144
    v_mfma_f32_16x16x32_bf16 v[72:75], a[92:95], a[104:107], v[72:75]
    buffer_load_dwordx4 v17, s[8:11], s36 offen offset:1024 lds
    v_mfma_f32_16x16x32_bf16 v[76:79], a[92:95], a[108:111], v[76:79]
    v_lshlrev_b32_e64 v144, 16, v144
    v_mfma_f32_16x16x32_bf16 v[80:83], a[96:99], a[104:107], v[80:83]
    v_mul_f32_e64 v14, v144, v142
    v_mfma_f32_16x16x32_bf16 v[84:87], a[96:99], a[108:111], v[84:87]
    buffer_load_dwordx4 v18, s[8:11], s36 offen offset:2048 lds
    v_mfma_f32_16x16x32_bf16 v[88:91], a[100:103], a[104:107], v[88:91]
    v_mul_f32_e64 v4, v144, v143
    v_mfma_f32_16x16x32_bf16 v[92:95], a[100:103], a[108:111], v[92:95]
    s_waitcnt lgkmcnt(0)
    s_nop 0
    v_mfma_f32_16x16x32_bf16 v[32:35], a[32:35], a[64:67], v[32:35]
    ds_read_b128 a[104:107], v151 offset:0
    buffer_load_dwordx4 v19, s[8:11], s36 offen offset:3072 lds
    v_mul_f32 v14, 0x3fb8aa3b, v14
    v_mfma_f32_16x16x32_bf16 v[36:39], a[32:35], a[68:71], v[36:39]
    ds_read_b128 a[108:111], v151 offset:8192
    v_mul_f32_e64 v4, 0x3e22f983, v4
    v_mfma_f32_16x16x32_bf16 v[40:43], a[36:39], a[64:67], v[40:43]
    ds_read_b128 a[72:75], v149 offset:0
    s_add_u32 m0, s37, 49152
    v_mfma_f32_16x16x32_bf16 v[44:47], a[36:39], a[68:71], v[44:47]
    ds_read_b128 a[76:79], v149 offset:2048
    v_exp_f32_e64 v14, v14
    v_mfma_f32_16x16x32_bf16 v[48:51], a[40:43], a[64:67], v[48:51]
    ds_read_b128 a[80:83], v149 offset:4096
    v_fract_f32_e64 v4, v4
    v_mfma_f32_16x16x32_bf16 v[52:55], a[40:43], a[68:71], v[52:55]
    ds_read_b128 a[84:87], v149 offset:6144
    buffer_load_dwordx4 v20, s[12:15], s36 offen offset:0 lds
    v_mfma_f32_16x16x32_bf16 v[56:59], a[44:47], a[64:67], v[56:59]
    ds_read_b128 a[88:91], v149 offset:8192
    v_cos_f32_e64 v5, v4
    buffer_store_dwordx4 v[240:243], v230, s[28:31], s68 offen sc1
    v_mfma_f32_16x16x32_bf16 v[60:63], a[44:47], a[68:71], v[60:63]
    ds_read_b128 a[92:95], v149 offset:10240
    v_mfma_f32_16x16x32_bf16 v[64:67], a[48:51], a[64:67], v[64:67]
    ds_read_b128 a[96:99], v149 offset:12288
    buffer_load_dwordx4 v21, s[12:15], s36 offen offset:1024 lds
    v_sin_f32_e64 v6, v4
    s_add_u32 s68, s68, 2097152
    v_mfma_f32_16x16x32_bf16 v[68:71], a[48:51], a[68:71], v[68:71]
    ds_read_b128 a[100:103], v149 offset:14336
    v_mul_f32_e64 v128, v14, v5
    v_mfma_f32_16x16x32_bf16 v[72:75], a[52:55], a[64:67], v[72:75]
    buffer_load_dwordx4 v22, s[12:15], s36 offen offset:2048 lds
    v_mfma_f32_16x16x32_bf16 v[76:79], a[52:55], a[68:71], v[76:79]
    v_mul_f32_e64 v129, v14, v6
    v_mfma_f32_16x16x32_bf16 v[80:83], a[56:59], a[64:67], v[80:83]
    v_mul_f32_e64 v14, v142, v142
    v_mfma_f32_16x16x32_bf16 v[84:87], a[56:59], a[68:71], v[84:87]
    buffer_load_dwordx4 v23, s[12:15], s36 offen offset:3072 lds
    v_mfma_f32_16x16x32_bf16 v[88:91], a[60:63], a[64:67], v[88:91]
    v_fma_f32 v14, v143, v143, v14
    v_mfma_f32_16x16x32_bf16 v[92:95], a[60:63], a[68:71], v[92:95]
    s_waitcnt lgkmcnt(0) vmcnt(20)
    s_barrier
    v_mfma_f32_16x16x32_bf16 v[32:35], a[72:75], a[104:107], v[32:35]
    ds_read_b128 a[64:67], v150 offset:32768
    s_bfe_u32 s36, s66, 262168
    v_rcp_f32_e64 v14, v14
    v_mfma_f32_16x16x32_bf16 v[36:39], a[72:75], a[108:111], v[36:39]
    ds_read_b128 a[68:71], v150 offset:40960
    v_add_f32_e64 v4, -1.0, v128
    v_mfma_f32_16x16x32_bf16 v[40:43], a[76:79], a[104:107], v[40:43]
    ds_read_b128 a[32:35], v148 offset:32768
    s_add_u32 m0, s37, 65536
    v_mfma_f32_16x16x32_bf16 v[44:47], a[76:79], a[108:111], v[44:47]
    ds_read_b128 a[36:39], v148 offset:34816
    v_add_f32_e64 v14, v14, v14
    v_mfma_f32_16x16x32_bf16 v[48:51], a[80:83], a[104:107], v[48:51]
    ds_read_b128 a[40:43], v148 offset:36864
    v_mul_f32_e64 v5, v4, v142
    v_mfma_f32_16x16x32_bf16 v[52:55], a[80:83], a[108:111], v[52:55]
    ds_read_b128 a[44:47], v148 offset:38912
    s_lshl_b32 s36, s36, 7
    s_nop 0
    v_mfma_f32_16x16x32_bf16 v[56:59], a[84:87], a[104:107], v[56:59]
    ds_read_b128 a[48:51], v148 offset:40960
    v_fma_f32 v5, v129, v143, v5
    buffer_store_dwordx4 v[244:247], v230, s[28:31], s68 offen sc1
    v_mfma_f32_16x16x32_bf16 v[60:63], a[84:87], a[108:111], v[60:63]
    ds_read_b128 a[52:55], v148 offset:43008
    v_mfma_f32_16x16x32_bf16 v[64:67], a[88:91], a[104:107], v[64:67]
    ds_read_b128 a[56:59], v148 offset:45056
    buffer_load_dwordx4 v16, s[8:11], s36 offen offset:0 lds
    v_mul_f32_e64 v6, v129, v142
    v_mfma_f32_16x16x32_bf16 v[68:71], a[88:91], a[108:111], v[68:71]
    ds_read_b128 a[60:63], v148 offset:47104
    v_fma_f32 v6, -v4, v143, v6
    v_mfma_f32_16x16x32_bf16 v[72:75], a[92:95], a[104:107], v[72:75]
    buffer_load_dwordx4 v17, s[8:11], s36 offen offset:1024 lds
    v_mfma_f32_16x16x32_bf16 v[76:79], a[92:95], a[108:111], v[76:79]
    v_mul_f32_e64 v130, v5, v14
    v_mfma_f32_16x16x32_bf16 v[80:83], a[96:99], a[104:107], v[80:83]
    v_mul_f32_e64 v131, v6, v14
    v_mfma_f32_16x16x32_bf16 v[84:87], a[96:99], a[108:111], v[84:87]
    buffer_load_dwordx4 v18, s[8:11], s36 offen offset:2048 lds
    v_mfma_f32_16x16x32_bf16 v[88:91], a[100:103], a[104:107], v[88:91]
    v_mul_f32_e64 v4, v128, v128
    v_mfma_f32_16x16x32_bf16 v[92:95], a[100:103], a[108:111], v[92:95]
    s_waitcnt lgkmcnt(0)
    v_mfma_f32_16x16x32_bf16 v[32:35], a[32:35], a[64:67], v[32:35]
    ds_read_b128 a[104:107], v151 offset:32768
    buffer_load_dwordx4 v19, s[8:11], s36 offen offset:3072 lds
    v_mul_f32 v5, v128, v129
    v_mfma_f32_16x16x32_bf16 v[36:39], a[32:35], a[68:71], v[36:39]
    ds_read_b128 a[108:111], v151 offset:40960
    v_fma_f32 v4, -v129, v129, v4
    v_mfma_f32_16x16x32_bf16 v[40:43], a[36:39], a[64:67], v[40:43]
    ds_read_b128 a[72:75], v149 offset:32768
    s_add_u32 m0, s37, 81920
    v_mfma_f32_16x16x32_bf16 v[44:47], a[36:39], a[68:71], v[44:47]
    ds_read_b128 a[76:79], v149 offset:34816
    v_add_f32_e64 v5, v5, v5
    v_mfma_f32_16x16x32_bf16 v[48:51], a[40:43], a[64:67], v[48:51]
    ds_read_b128 a[80:83], v149 offset:36864
    v_mul_f32_e64 v6, v4, v4
    v_mfma_f32_16x16x32_bf16 v[52:55], a[40:43], a[68:71], v[52:55]
    ds_read_b128 a[84:87], v149 offset:38912
    buffer_load_dwordx4 v20, s[12:15], s36 offen offset:0 lds
    v_mfma_f32_16x16x32_bf16 v[56:59], a[44:47], a[64:67], v[56:59]
    ds_read_b128 a[88:91], v149 offset:40960
    v_mul_f32_e64 v7, v4, v5
    buffer_store_dwordx4 v[168:171], v231, s[28:31], s76 offen offset:0 sc1
    v_mfma_f32_16x16x32_bf16 v[60:63], a[44:47], a[68:71], v[60:63]
    ds_read_b128 a[92:95], v149 offset:43008
    v_mfma_f32_16x16x32_bf16 v[64:67], a[48:51], a[64:67], v[64:67]
    ds_read_b128 a[96:99], v149 offset:45056
    buffer_load_dwordx4 v21, s[12:15], s36 offen offset:1024 lds
    v_fma_f32 v6, -v5, v5, v6
    v_mfma_f32_16x16x32_bf16 v[68:71], a[48:51], a[68:71], v[68:71]
    ds_read_b128 a[100:103], v149 offset:47104
    v_add_f32_e64 v7, v7, v7
    v_mfma_f32_16x16x32_bf16 v[72:75], a[52:55], a[64:67], v[72:75]
    buffer_load_dwordx4 v22, s[12:15], s36 offen offset:2048 lds
    v_mfma_f32_16x16x32_bf16 v[76:79], a[52:55], a[68:71], v[76:79]
    v_mul_f32_e64 v4, v6, v6
    v_mfma_f32_16x16x32_bf16 v[80:83], a[56:59], a[64:67], v[80:83]
    v_mul_f32_e64 v5, v6, v7
    v_mfma_f32_16x16x32_bf16 v[84:87], a[56:59], a[68:71], v[84:87]
    buffer_load_dwordx4 v23, s[12:15], s36 offen offset:3072 lds
    v_mfma_f32_16x16x32_bf16 v[88:91], a[60:63], a[64:67], v[88:91]
    v_fma_f32 v4, -v7, v7, v4
    v_mfma_f32_16x16x32_bf16 v[92:95], a[60:63], a[68:71], v[92:95]
    s_waitcnt lgkmcnt(0) vmcnt(20)
    s_barrier
    v_mfma_f32_16x16x32_bf16 v[32:35], a[72:75], a[104:107], v[32:35]
    ds_read_b128 a[64:67], v26 offset:0
    s_bfe_u32 s36, s66, 262172
    v_add_f32_e64 v5, v5, v5
    v_mfma_f32_16x16x32_bf16 v[36:39], a[72:75], a[108:111], v[36:39]
    ds_read_b128 a[68:71], v26 offset:8192
    v_mul_f32_e64 v132, v4, v4
    v_mfma_f32_16x16x32_bf16 v[40:43], a[76:79], a[104:107], v[40:43]
    ds_read_b128 a[32:35], v24 offset:0
    s_add_u32 m0, s37, 98304
    v_mfma_f32_16x16x32_bf16 v[44:47], a[76:79], a[108:111], v[44:47]
    ds_read_b128 a[36:39], v24 offset:2048
    v_mul_f32_e64 v133, v4, v5
    v_mfma_f32_16x16x32_bf16 v[48:51], a[80:83], a[104:107], v[48:51]
    ds_read_b128 a[40:43], v24 offset:4096
    v_fma_f32 v132, -v5, v5, v132
    v_mfma_f32_16x16x32_bf16 v[52:55], a[80:83], a[108:111], v[52:55]
    ds_read_b128 a[44:47], v24 offset:6144
    s_lshl_b32 s36, s36, 7
    v_mfma_f32_16x16x32_bf16 v[56:59], a[84:87], a[104:107], v[56:59]
    ds_read_b128 a[48:51], v24 offset:8192
    v_add_f32 v133, v133, v133
    buffer_store_dwordx4 v[172:175], v231, s[28:31], s76 offen offset:256 sc1
    v_mfma_f32_16x16x32_bf16 v[60:63], a[84:87], a[108:111], v[60:63]
    ds_read_b128 a[52:55], v24 offset:10240
    v_mfma_f32_16x16x32_bf16 v[64:67], a[88:91], a[104:107], v[64:67]
    ds_read_b128 a[56:59], v24 offset:12288
    buffer_load_dwordx4 v16, s[8:11], s36 offen offset:0 lds
    v_mul_f32_e64 v134, v132, v132
    v_mfma_f32_16x16x32_bf16 v[68:71], a[88:91], a[108:111], v[68:71]
    ds_read_b128 a[60:63], v24 offset:14336
    v_mul_f32_e64 v135, v132, v133
    v_mfma_f32_16x16x32_bf16 v[72:75], a[92:95], a[104:107], v[72:75]
    buffer_load_dwordx4 v17, s[8:11], s36 offen offset:1024 lds
    v_mfma_f32_16x16x32_bf16 v[76:79], a[92:95], a[108:111], v[76:79]
    v_fma_f32 v134, -v133, v133, v134
    v_mfma_f32_16x16x32_bf16 v[80:83], a[96:99], a[104:107], v[80:83]
    v_add_f32_e64 v135, v135, v135
    v_mfma_f32_16x16x32_bf16 v[84:87], a[96:99], a[108:111], v[84:87]
    buffer_load_dwordx4 v18, s[8:11], s36 offen offset:2048 lds
    v_mfma_f32_16x16x32_bf16 v[88:91], a[100:103], a[104:107], v[88:91]
    v_mul_f32_e64 v8, v134, v134
    v_mfma_f32_16x16x32_bf16 v[92:95], a[100:103], a[108:111], v[92:95]
    s_waitcnt lgkmcnt(0)
    v_mfma_f32_16x16x32_bf16 v[32:35], a[32:35], a[64:67], v[32:35]
    ds_read_b128 a[104:107], v27 offset:0
    buffer_load_dwordx4 v19, s[8:11], s36 offen offset:3072 lds
    v_mul_f32 v9, v134, v135
    v_mfma_f32_16x16x32_bf16 v[36:39], a[32:35], a[68:71], v[36:39]
    ds_read_b128 a[108:111], v27 offset:8192
    v_fma_f32 v8, -v135, v135, v8
    v_mfma_f32_16x16x32_bf16 v[40:43], a[36:39], a[64:67], v[40:43]
    ds_read_b128 a[72:75], v25 offset:0
    s_add_u32 m0, s37, 114688
    v_mfma_f32_16x16x32_bf16 v[44:47], a[36:39], a[68:71], v[44:47]
    ds_read_b128 a[76:79], v25 offset:2048
    v_add_f32_e64 v9, v9, v9
    v_mfma_f32_16x16x32_bf16 v[48:51], a[40:43], a[64:67], v[48:51]
    ds_read_b128 a[80:83], v25 offset:4096
    v_mul_f32_e64 v136, v8, v8
    v_mfma_f32_16x16x32_bf16 v[52:55], a[40:43], a[68:71], v[52:55]
    ds_read_b128 a[84:87], v25 offset:6144
    buffer_load_dwordx4 v20, s[12:15], s36 offen offset:0 lds
    v_mfma_f32_16x16x32_bf16 v[56:59], a[44:47], a[64:67], v[56:59]
    ds_read_b128 a[88:91], v25 offset:8192
    v_mul_f32_e64 v137, v8, v9
    buffer_store_dwordx4 v[176:179], v231, s[28:31], s76 offen offset:512 sc1
    v_mfma_f32_16x16x32_bf16 v[60:63], a[44:47], a[68:71], v[60:63]
    ds_read_b128 a[92:95], v25 offset:10240
    v_mfma_f32_16x16x32_bf16 v[64:67], a[48:51], a[64:67], v[64:67]
    ds_read_b128 a[96:99], v25 offset:12288
    buffer_load_dwordx4 v21, s[12:15], s36 offen offset:1024 lds
    v_fma_f32 v136, -v9, v9, v136
    v_mfma_f32_16x16x32_bf16 v[68:71], a[48:51], a[68:71], v[68:71]
    ds_read_b128 a[100:103], v25 offset:14336
    v_add_f32_e64 v137, v137, v137
    v_mfma_f32_16x16x32_bf16 v[72:75], a[52:55], a[64:67], v[72:75]
    buffer_load_dwordx4 v22, s[12:15], s36 offen offset:2048 lds
    v_mfma_f32_16x16x32_bf16 v[76:79], a[52:55], a[68:71], v[76:79]
    v_mul_f32_e64 v4, v136, v136
    v_mfma_f32_16x16x32_bf16 v[80:83], a[56:59], a[64:67], v[80:83]
    v_mul_f32_e64 v5, v136, v137
    v_mfma_f32_16x16x32_bf16 v[84:87], a[56:59], a[68:71], v[84:87]
    buffer_load_dwordx4 v23, s[12:15], s36 offen offset:3072 lds
    v_mfma_f32_16x16x32_bf16 v[88:91], a[60:63], a[64:67], v[88:91]
    v_fma_f32 v4, -v137, v137, v4
    v_mfma_f32_16x16x32_bf16 v[92:95], a[60:63], a[68:71], v[92:95]
    s_waitcnt lgkmcnt(0) vmcnt(20)
    s_barrier
    v_mfma_f32_16x16x32_bf16 v[32:35], a[72:75], a[104:107], v[32:35]
    ds_read_b128 a[64:67], v26 offset:32768
    s_bfe_u32 s36, s67, 262144
    v_add_f32_e64 v5, v5, v5
    v_mfma_f32_16x16x32_bf16 v[36:39], a[72:75], a[108:111], v[36:39]
    ds_read_b128 a[68:71], v26 offset:40960
    v_mul_f32_e64 v10, v4, v4
    v_mfma_f32_16x16x32_bf16 v[40:43], a[76:79], a[104:107], v[40:43]
    ds_read_b128 a[32:35], v24 offset:32768
    s_add_u32 m0, s37, 0
    v_mfma_f32_16x16x32_bf16 v[44:47], a[76:79], a[108:111], v[44:47]
    ds_read_b128 a[36:39], v24 offset:34816
    v_mul_f32 v11, v4, v5
    v_mfma_f32_16x16x32_bf16 v[48:51], a[80:83], a[104:107], v[48:51]
    ds_read_b128 a[40:43], v24 offset:36864
    v_fma_f32 v10, -v5, v5, v10
    v_mfma_f32_16x16x32_bf16 v[52:55], a[80:83], a[108:111], v[52:55]
    ds_read_b128 a[44:47], v24 offset:38912
    s_lshl_b32 s36, s36, 7
    v_mfma_f32_16x16x32_bf16 v[56:59], a[84:87], a[104:107], v[56:59]
    ds_read_b128 a[48:51], v24 offset:40960
    v_add_f32 v11, v11, v11
    buffer_store_dwordx4 v[180:183], v231, s[28:31], s76 offen offset:768 sc1
    v_mfma_f32_16x16x32_bf16 v[60:63], a[84:87], a[108:111], v[60:63]
    ds_read_b128 a[52:55], v24 offset:43008
    v_mfma_f32_16x16x32_bf16 v[64:67], a[88:91], a[104:107], v[64:67]
    ds_read_b128 a[56:59], v24 offset:45056
    buffer_load_dwordx4 v16, s[8:11], s36 offen offset:0 lds
    v_mul_f32_e64 v12, v10, v10
    v_mfma_f32_16x16x32_bf16 v[68:71], a[88:91], a[108:111], v[68:71]
    ds_read_b128 a[60:63], v24 offset:47104
    v_mul_f32_e64 v13, v10, v11
    v_mfma_f32_16x16x32_bf16 v[72:75], a[92:95], a[104:107], v[72:75]
    buffer_load_dwordx4 v17, s[8:11], s36 offen offset:1024 lds
    v_mfma_f32_16x16x32_bf16 v[76:79], a[92:95], a[108:111], v[76:79]
    v_fma_f32 v12, -v11, v11, v12
    v_mfma_f32_16x16x32_bf16 v[80:83], a[96:99], a[104:107], v[80:83]
    v_add_f32_e64 v13, v13, v13
    v_mfma_f32_16x16x32_bf16 v[84:87], a[96:99], a[108:111], v[84:87]
    buffer_load_dwordx4 v18, s[8:11], s36 offen offset:2048 lds
    v_mfma_f32_16x16x32_bf16 v[88:91], a[100:103], a[104:107], v[88:91]
    v_and_b32_e64 v14, 1, v2
    v_mfma_f32_16x16x32_bf16 v[92:95], a[100:103], a[108:111], v[92:95]
    s_waitcnt lgkmcnt(0)
    s_nop 0
    v_mfma_f32_16x16x32_bf16 v[32:35], a[32:35], a[64:67], v[32:35]
    ds_read_b128 a[104:107], v27 offset:32768
    buffer_load_dwordx4 v19, s[8:11], s36 offen offset:3072 lds
    v_cmp_eq_u32 s[78:79], 1, v14
    v_mfma_f32_16x16x32_bf16 v[36:39], a[32:35], a[68:71], v[36:39]
    ds_read_b128 a[108:111], v27 offset:40960
    v_cndmask_b32 v4, 1.0, v134, s[78:79]
    v_mfma_f32_16x16x32_bf16 v[40:43], a[36:39], a[64:67], v[40:43]
    ds_read_b128 a[72:75], v25 offset:32768
    s_add_u32 m0, s37, 16384
    v_mfma_f32_16x16x32_bf16 v[44:47], a[36:39], a[68:71], v[44:47]
    ds_read_b128 a[76:79], v25 offset:34816
    v_cndmask_b32 v5, 0, v135, s[78:79]
    v_mfma_f32_16x16x32_bf16 v[48:51], a[40:43], a[64:67], v[48:51]
    ds_read_b128 a[80:83], v25 offset:36864
    v_cndmask_b32 v10, 1.0, v10, s[78:79]
    v_mfma_f32_16x16x32_bf16 v[52:55], a[40:43], a[68:71], v[52:55]
    ds_read_b128 a[84:87], v25 offset:38912
    buffer_load_dwordx4 v20, s[12:15], s36 offen offset:0 lds
    v_mfma_f32_16x16x32_bf16 v[56:59], a[44:47], a[64:67], v[56:59]
    ds_read_b128 a[88:91], v25 offset:40960
    v_cndmask_b32 v11, 0, v11, s[78:79]
    v_mfma_f32_16x16x32_bf16 v[60:63], a[44:47], a[68:71], v[60:63]
    ds_read_b128 a[92:95], v25 offset:43008
    v_mfma_f32_16x16x32_bf16 v[64:67], a[48:51], a[64:67], v[64:67]
    ds_read_b128 a[96:99], v25 offset:45056
    buffer_load_dwordx4 v21, s[12:15], s36 offen offset:1024 lds
    v_cmp_lt_u32 s[78:79], 1, v2
    v_mfma_f32_16x16x32_bf16 v[68:71], a[48:51], a[68:71], v[68:71]
    ds_read_b128 a[100:103], v25 offset:47104
    v_cndmask_b32 v8, 1.0, v8, s[78:79]
    v_mfma_f32_16x16x32_bf16 v[72:75], a[52:55], a[64:67], v[72:75]
    buffer_load_dwordx4 v22, s[12:15], s36 offen offset:2048 lds
    v_mfma_f32_16x16x32_bf16 v[76:79], a[52:55], a[68:71], v[76:79]
    v_cndmask_b32 v9, 0, v9, s[78:79]
    v_mfma_f32_16x16x32_bf16 v[80:83], a[56:59], a[64:67], v[80:83]
    v_cndmask_b32 v12, 1.0, v12, s[78:79]
    v_mfma_f32_16x16x32_bf16 v[84:87], a[56:59], a[68:71], v[84:87]
    buffer_load_dwordx4 v23, s[12:15], s36 offen offset:3072 lds
    v_mfma_f32_16x16x32_bf16 v[88:91], a[60:63], a[64:67], v[88:91]
    v_cndmask_b32 v13, 0, v13, s[78:79]
    v_mfma_f32_16x16x32_bf16 v[92:95], a[60:63], a[68:71], v[92:95]
    s_waitcnt lgkmcnt(0) vmcnt(19)
    s_barrier
    v_mfma_f32_16x16x32_bf16 v[32:35], a[72:75], a[104:107], v[32:35]
    ds_read_b128 a[64:67], v150 offset:0
    s_bfe_u32 s36, s67, 262148
    v_mul_f32_e64 v138, v4, v8
    v_mfma_f32_16x16x32_bf16 v[36:39], a[72:75], a[108:111], v[36:39]
    ds_read_b128 a[68:71], v150 offset:8192
    v_mul_f32_e64 v139, v4, v9
    v_mfma_f32_16x16x32_bf16 v[40:43], a[76:79], a[104:107], v[40:43]
    ds_read_b128 a[32:35], v148 offset:0
    s_add_u32 m0, s37, 32768
    v_mfma_f32_16x16x32_bf16 v[44:47], a[76:79], a[108:111], v[44:47]
    ds_read_b128 a[36:39], v148 offset:2048
    v_fma_f32 v138, -v5, v9, v138
    v_mfma_f32_16x16x32_bf16 v[48:51], a[80:83], a[104:107], v[48:51]
    ds_read_b128 a[40:43], v148 offset:4096
    v_fma_f32 v139, v5, v8, v139
    v_mfma_f32_16x16x32_bf16 v[52:55], a[80:83], a[108:111], v[52:55]
    ds_read_b128 a[44:47], v148 offset:6144
    s_lshl_b32 s36, s36, 7
    v_mfma_f32_16x16x32_bf16 v[56:59], a[84:87], a[104:107], v[56:59]
    ds_read_b128 a[48:51], v148 offset:8192
    v_mul_f32 v140, v10, v12
    v_mfma_f32_16x16x32_bf16 v[60:63], a[84:87], a[108:111], v[60:63]
    ds_read_b128 a[52:55], v148 offset:10240
    v_mfma_f32_16x16x32_bf16 v[64:67], a[88:91], a[104:107], v[64:67]
    ds_read_b128 a[56:59], v148 offset:12288
    buffer_load_dwordx4 v16, s[8:11], s36 offen offset:0 lds
    v_mul_f32_e64 v141, v10, v13
    v_mfma_f32_16x16x32_bf16 v[68:71], a[88:91], a[108:111], v[68:71]
    ds_read_b128 a[60:63], v148 offset:14336
    v_fma_f32 v140, -v11, v13, v140
    v_mfma_f32_16x16x32_bf16 v[72:75], a[92:95], a[104:107], v[72:75]
    buffer_load_dwordx4 v17, s[8:11], s36 offen offset:1024 lds
    v_mfma_f32_16x16x32_bf16 v[76:79], a[92:95], a[108:111], v[76:79]
    v_fma_f32 v141, v11, v12, v141
    v_mfma_f32_16x16x32_bf16 v[80:83], a[96:99], a[104:107], v[80:83]
    v_add_u32_e64 v251, s63, v1
    v_mfma_f32_16x16x32_bf16 v[84:87], a[96:99], a[108:111], v[84:87]
    buffer_load_dwordx4 v18, s[8:11], s36 offen offset:2048 lds
    v_mfma_f32_16x16x32_bf16 v[88:91], a[100:103], a[104:107], v[88:91]
    v_cvt_f32_u32_e64 v251, v251
    v_mfma_f32_16x16x32_bf16 v[92:95], a[100:103], a[108:111], v[92:95]
    s_waitcnt lgkmcnt(0)
    s_nop 0
    v_mfma_f32_16x16x32_bf16 v[32:35], a[32:35], a[64:67], v[32:35]
    ds_read_b128 a[104:107], v151 offset:0
    buffer_load_dwordx4 v19, s[8:11], s36 offen offset:3072 lds
    v_mul_f32 v251, 0x3a800000, v251
    v_mfma_f32_16x16x32_bf16 v[36:39], a[32:35], a[68:71], v[36:39]
    ds_read_b128 a[108:111], v151 offset:8192
    v_mul_f32_e64 v248, v250, v251
    v_mfma_f32_16x16x32_bf16 v[40:43], a[36:39], a[64:67], v[40:43]
    ds_read_b128 a[72:75], v149 offset:0
    s_add_u32 m0, s37, 49152
    v_mfma_f32_16x16x32_bf16 v[44:47], a[36:39], a[68:71], v[44:47]
    ds_read_b128 a[76:79], v149 offset:2048
    v_fmamk_f32 v4, v251, 0x00000000, v248
    v_mfma_f32_16x16x32_bf16 v[48:51], a[40:43], a[64:67], v[48:51]
    ds_read_b128 a[80:83], v149 offset:4096
    v_fmamk_f32 v5, v251, 0x3f000000, v248
    v_mfma_f32_16x16x32_bf16 v[52:55], a[40:43], a[68:71], v[52:55]
    ds_read_b128 a[84:87], v149 offset:6144
    buffer_load_dwordx4 v20, s[12:15], s36 offen offset:0 lds
    v_mfma_f32_16x16x32_bf16 v[56:59], a[44:47], a[64:67], v[56:59]
    ds_read_b128 a[88:91], v149 offset:8192
    v_fmamk_f32 v6, v251, 0x3f800000, v248
    v_mfma_f32_16x16x32_bf16 v[60:63], a[44:47], a[68:71], v[60:63]
    ds_read_b128 a[92:95], v149 offset:10240
    v_mfma_f32_16x16x32_bf16 v[64:67], a[48:51], a[64:67], v[64:67]
    ds_read_b128 a[96:99], v149 offset:12288
    buffer_load_dwordx4 v21, s[12:15], s36 offen offset:1024 lds
    v_fmamk_f32 v7, v251, 0x3fc00000, v248
    v_mfma_f32_16x16x32_bf16 v[68:71], a[48:51], a[68:71], v[68:71]
    ds_read_b128 a[100:103], v149 offset:14336
    v_cos_f32_e64 v96, v4
    v_mfma_f32_16x16x32_bf16 v[72:75], a[52:55], a[64:67], v[72:75]
    buffer_load_dwordx4 v22, s[12:15], s36 offen offset:2048 lds
    v_mfma_f32_16x16x32_bf16 v[76:79], a[52:55], a[68:71], v[76:79]
    v_cos_f32_e64 v98, v5
    v_mfma_f32_16x16x32_bf16 v[80:83], a[56:59], a[64:67], v[80:83]
    v_cos_f32_e64 v100, v6
    v_mfma_f32_16x16x32_bf16 v[84:87], a[56:59], a[68:71], v[84:87]
    buffer_load_dwordx4 v23, s[12:15], s36 offen offset:3072 lds
    v_mfma_f32_16x16x32_bf16 v[88:91], a[60:63], a[64:67], v[88:91]
    v_cos_f32_e64 v102, v7
    v_mfma_f32_16x16x32_bf16 v[92:95], a[60:63], a[68:71], v[92:95]
    s_waitcnt lgkmcnt(0) vmcnt(16)
    s_barrier
    v_mfma_f32_16x16x32_bf16 v[32:35], a[72:75], a[104:107], v[32:35]
    ds_read_b128 a[64:67], v150 offset:32768
    s_lshl4_add_u32 s69, s2, 22298624
    v_sin_f32_e64 v97, v4
    v_mfma_f32_16x16x32_bf16 v[36:39], a[72:75], a[108:111], v[36:39]
    ds_read_b128 a[68:71], v150 offset:40960
    v_sin_f32_e64 v99, v5
    v_mfma_f32_16x16x32_bf16 v[40:43], a[76:79], a[104:107], v[40:43]
    ds_read_b128 a[32:35], v148 offset:32768
    v_mov_b32_e64 v28, s35
    v_mfma_f32_16x16x32_bf16 v[44:47], a[76:79], a[108:111], v[44:47]
    ds_read_b128 a[36:39], v148 offset:34816
    v_sin_f32_e64 v101, v6
    v_mfma_f32_16x16x32_bf16 v[48:51], a[80:83], a[104:107], v[48:51]
    ds_read_b128 a[40:43], v148 offset:36864
    buffer_store_dword v28, v30, s[24:27], s69 offen sc1
    v_sin_f32_e64 v103, v7
    v_mfma_f32_16x16x32_bf16 v[52:55], a[80:83], a[108:111], v[52:55]
    ds_read_b128 a[44:47], v148 offset:38912
    v_mfma_f32_16x16x32_bf16 v[56:59], a[84:87], a[104:107], v[56:59]
    ds_read_b128 a[48:51], v148 offset:40960
    s_bfe_u32 s36, s67, 262152
    v_fmamk_f32 v4, v251, 0x40000000, v248
    v_mfma_f32_16x16x32_bf16 v[60:63], a[84:87], a[108:111], v[60:63]
    ds_read_b128 a[52:55], v148 offset:43008
    v_mfma_f32_16x16x32_bf16 v[64:67], a[88:91], a[104:107], v[64:67]
    ds_read_b128 a[56:59], v148 offset:45056
    s_add_u32 m0, s37, 65536
    v_fmamk_f32 v5, v251, 0x40200000, v248
    v_mfma_f32_16x16x32_bf16 v[68:71], a[88:91], a[108:111], v[68:71]
    ds_read_b128 a[60:63], v148 offset:47104
    v_fmamk_f32 v6, v251, 0x40400000, v248
    v_mfma_f32_16x16x32_bf16 v[72:75], a[92:95], a[104:107], v[72:75]
    s_lshl_b32 s36, s36, 7
    s_nop 0
    v_mfma_f32_16x16x32_bf16 v[76:79], a[92:95], a[108:111], v[76:79]
    v_fmamk_f32 v7, v251, 0x40600000, v248
    v_mfma_f32_16x16x32_bf16 v[80:83], a[96:99], a[104:107], v[80:83]
    buffer_load_dwordx4 v16, s[8:11], s36 offen offset:0 lds
    v_cos_f32_e64 v104, v4
    v_mfma_f32_16x16x32_bf16 v[84:87], a[96:99], a[108:111], v[84:87]
    v_mfma_f32_16x16x32_bf16 v[88:91], a[100:103], a[104:107], v[88:91]
    buffer_load_dwordx4 v17, s[8:11], s36 offen offset:1024 lds
    v_cos_f32_e64 v106, v5
    v_mfma_f32_16x16x32_bf16 v[92:95], a[100:103], a[108:111], v[92:95]
    s_waitcnt lgkmcnt(0)
    v_mfma_f32_16x16x32_bf16 v[32:35], a[32:35], a[64:67], v[32:35]
    ds_read_b128 a[104:107], v151 offset:32768
    buffer_load_dwordx4 v18, s[8:11], s36 offen offset:2048 lds
    v_cos_f32 v108, v6
    v_mfma_f32_16x16x32_bf16 v[36:39], a[32:35], a[68:71], v[36:39]
    ds_read_b128 a[108:111], v151 offset:40960
    v_cos_f32_e64 v110, v7
    v_mfma_f32_16x16x32_bf16 v[40:43], a[36:39], a[64:67], v[40:43]
    ds_read_b128 a[72:75], v149 offset:32768
    buffer_load_dwordx4 v19, s[8:11], s36 offen offset:3072 lds
    v_mfma_f32_16x16x32_bf16 v[44:47], a[36:39], a[68:71], v[44:47]
    ds_read_b128 a[76:79], v149 offset:34816
    v_sin_f32_e64 v105, v4
    v_mfma_f32_16x16x32_bf16 v[48:51], a[40:43], a[64:67], v[48:51]
    ds_read_b128 a[80:83], v149 offset:36864
    s_add_u32 m0, s37, 81920
    v_sin_f32_e64 v107, v5
    v_mfma_f32_16x16x32_bf16 v[52:55], a[40:43], a[68:71], v[52:55]
    ds_read_b128 a[84:87], v149 offset:38912
    v_mfma_f32_16x16x32_bf16 v[56:59], a[44:47], a[64:67], v[56:59]
    ds_read_b128 a[88:91], v149 offset:40960
    buffer_load_dwordx4 v20, s[12:15], s36 offen offset:0 lds
    v_sin_f32_e64 v109, v6
    v_mfma_f32_16x16x32_bf16 v[60:63], a[44:47], a[68:71], v[60:63]
    ds_read_b128 a[92:95], v149 offset:43008
    v_mfma_f32_16x16x32_bf16 v[64:67], a[48:51], a[64:67], v[64:67]
    ds_read_b128 a[96:99], v149 offset:45056
    v_sin_f32_e64 v111, v7
    v_mfma_f32_16x16x32_bf16 v[68:71], a[48:51], a[68:71], v[68:71]
    ds_read_b128 a[100:103], v149 offset:47104
    buffer_load_dwordx4 v21, s[12:15], s36 offen offset:1024 lds
    v_cvt_f32_u32_e64 v9, s4
    v_mfma_f32_16x16x32_bf16 v[72:75], a[52:55], a[64:67], v[72:75]
    v_mfma_f32_16x16x32_bf16 v[76:79], a[52:55], a[68:71], v[76:79]
    buffer_load_dwordx4 v22, s[12:15], s36 offen offset:2048 lds
    v_mul_f32 v9, 0x3a800000, v9
    v_mfma_f32_16x16x32_bf16 v[80:83], a[56:59], a[64:67], v[80:83]
    v_sin_f32_e64 v11, v9
    v_mfma_f32_16x16x32_bf16 v[84:87], a[56:59], a[68:71], v[84:87]
    buffer_load_dwordx4 v23, s[12:15], s36 offen offset:3072 lds
    v_mfma_f32_16x16x32_bf16 v[88:91], a[60:63], a[64:67], v[88:91]
    v_cos_f32_e64 v10, v9
    v_mfma_f32_16x16x32_bf16 v[92:95], a[60:63], a[68:71], v[92:95]
    s_waitcnt lgkmcnt(0) vmcnt(17)
    s_barrier
    v_mfma_f32_16x16x32_bf16 v[32:35], a[72:75], a[104:107], v[32:35]
    ds_read_b128 a[64:67], v26 offset:0
    s_bfe_u32 s36, s67, 262156
    v_add_f32_e64 v11, 1.0, v11
    v_mfma_f32_16x16x32_bf16 v[36:39], a[72:75], a[108:111], v[36:39]
    ds_read_b128 a[68:71], v26 offset:8192
    v_rcp_f32_e64 v9, v11
    v_mfma_f32_16x16x32_bf16 v[40:43], a[76:79], a[104:107], v[40:43]
    ds_read_b128 a[32:35], v24 offset:0
    s_add_u32 m0, s37, 98304
    v_mfma_f32_16x16x32_bf16 v[44:47], a[76:79], a[108:111], v[44:47]
    ds_read_b128 a[36:39], v24 offset:2048
    v_mul_f32 v15, 0x35000000, v11
    v_mfma_f32_16x16x32_bf16 v[48:51], a[80:83], a[104:107], v[48:51]
    ds_read_b128 a[40:43], v24 offset:4096
    v_mul_f32_e64 v10, -v10, v9
    v_mfma_f32_16x16x32_bf16 v[52:55], a[80:83], a[108:111], v[52:55]
    ds_read_b128 a[44:47], v24 offset:6144
    s_lshl_b32 s36, s36, 7
    v_mfma_f32_16x16x32_bf16 v[56:59], a[84:87], a[104:107], v[56:59]
    ds_read_b128 a[48:51], v24 offset:8192
    v_cvt_f32_u32 v14, s63
    v_mfma_f32_16x16x32_bf16 v[60:63], a[84:87], a[108:111], v[60:63]
    ds_read_b128 a[52:55], v24 offset:10240
    v_mfma_f32_16x16x32_bf16 v[64:67], a[88:91], a[104:107], v[64:67]
    ds_read_b128 a[56:59], v24 offset:12288
    buffer_load_dwordx4 v16, s[8:11], s36 offen offset:0 lds
    v_readfirstlane_b32 s42, v10
    v_mfma_f32_16x16x32_bf16 v[68:71], a[88:91], a[108:111], v[68:71]
    ds_read_b128 a[60:63], v24 offset:14336
    v_add_f32 v14, v14, v250
    v_mfma_f32_16x16x32_bf16 v[72:75], a[92:95], a[104:107], v[72:75]
    buffer_load_dwordx4 v17, s[8:11], s36 offen offset:1024 lds
    v_mfma_f32_16x16x32_bf16 v[76:79], a[92:95], a[108:111], v[76:79]
    v_fma_f32 v251, v249, 2.0, 0
    v_mfma_f32_16x16x32_bf16 v[80:83], a[96:99], a[104:107], v[80:83]
    v_mul_f32 v251, 0x3a000000, v251
    v_mfma_f32_16x16x32_bf16 v[84:87], a[96:99], a[108:111], v[84:87]
    buffer_load_dwordx4 v18, s[8:11], s36 offen offset:2048 lds
    v_mfma_f32_16x16x32_bf16 v[88:91], a[100:103], a[104:107], v[88:91]
    v_mul_f32_e64 v248, v14, v251
    v_mfma_f32_16x16x32_bf16 v[92:95], a[100:103], a[108:111], v[92:95]
    s_waitcnt lgkmcnt(0)
    s_nop 0
    v_mfma_f32_16x16x32_bf16 v[32:35], a[32:35], a[64:67], v[32:35]
    ds_read_b128 a[104:107], v27 offset:0
    buffer_load_dwordx4 v19, s[8:11], s36 offen offset:3072 lds
    v_fmamk_f32 v4, v251, 0x00000000, v248
    v_mfma_f32_16x16x32_bf16 v[36:39], a[32:35], a[68:71], v[36:39]
    ds_read_b128 a[108:111], v27 offset:8192
    v_fmamk_f32 v5, v251, 0x3f800000, v248
    v_mfma_f32_16x16x32_bf16 v[40:43], a[36:39], a[64:67], v[40:43]
    ds_read_b128 a[72:75], v25 offset:0
    s_add_u32 m0, s37, 114688
    v_mfma_f32_16x16x32_bf16 v[44:47], a[36:39], a[68:71], v[44:47]
    ds_read_b128 a[76:79], v25 offset:2048
    v_fmamk_f32 v6, v251, 0x40000000, v248
    v_mfma_f32_16x16x32_bf16 v[48:51], a[40:43], a[64:67], v[48:51]
    ds_read_b128 a[80:83], v25 offset:4096
    v_fmamk_f32 v7, v251, 0x40400000, v248
    v_mfma_f32_16x16x32_bf16 v[52:55], a[40:43], a[68:71], v[52:55]
    ds_read_b128 a[84:87], v25 offset:6144
    buffer_load_dwordx4 v20, s[12:15], s36 offen offset:0 lds
    v_mfma_f32_16x16x32_bf16 v[56:59], a[44:47], a[64:67], v[56:59]
    ds_read_b128 a[88:91], v25 offset:8192
    v_cos_f32_e64 v112, v4
    v_mfma_f32_16x16x32_bf16 v[60:63], a[44:47], a[68:71], v[60:63]
    ds_read_b128 a[92:95], v25 offset:10240
    v_mfma_f32_16x16x32_bf16 v[64:67], a[48:51], a[64:67], v[64:67]
    ds_read_b128 a[96:99], v25 offset:12288
    buffer_load_dwordx4 v21, s[12:15], s36 offen offset:1024 lds
    v_cos_f32_e64 v113, v5
    v_mfma_f32_16x16x32_bf16 v[68:71], a[48:51], a[68:71], v[68:71]
    ds_read_b128 a[100:103], v25 offset:14336
    v_cos_f32_e64 v114, v6
    v_mfma_f32_16x16x32_bf16 v[72:75], a[52:55], a[64:67], v[72:75]
    buffer_load_dwordx4 v22, s[12:15], s36 offen offset:2048 lds
    v_mfma_f32_16x16x32_bf16 v[76:79], a[52:55], a[68:71], v[76:79]
    v_cos_f32_e64 v115, v7
    v_mfma_f32_16x16x32_bf16 v[80:83], a[56:59], a[64:67], v[80:83]
    v_sin_f32_e64 v116, v4
    v_mfma_f32_16x16x32_bf16 v[84:87], a[56:59], a[68:71], v[84:87]
    buffer_load_dwordx4 v23, s[12:15], s36 offen offset:3072 lds
    v_mfma_f32_16x16x32_bf16 v[88:91], a[60:63], a[64:67], v[88:91]
    v_sin_f32_e64 v117, v5
    v_mfma_f32_16x16x32_bf16 v[92:95], a[60:63], a[68:71], v[92:95]
    s_waitcnt lgkmcnt(0) vmcnt(17)
    s_barrier
    v_mfma_f32_16x16x32_bf16 v[32:35], a[72:75], a[104:107], v[32:35]
    ds_read_b128 a[64:67], v26 offset:32768
    s_bfe_u32 s36, s67, 262160
    v_sin_f32_e64 v118, v6
    v_mfma_f32_16x16x32_bf16 v[36:39], a[72:75], a[108:111], v[36:39]
    ds_read_b128 a[68:71], v26 offset:40960
    v_sin_f32_e64 v119, v7
    v_mfma_f32_16x16x32_bf16 v[40:43], a[76:79], a[104:107], v[40:43]
    ds_read_b128 a[32:35], v24 offset:32768
    s_add_u32 m0, s37, 0
    v_mfma_f32_16x16x32_bf16 v[44:47], a[76:79], a[108:111], v[44:47]
    ds_read_b128 a[36:39], v24 offset:34816
    v_mul_f32 v112, v15, v112
    v_mfma_f32_16x16x32_bf16 v[48:51], a[80:83], a[104:107], v[48:51]
    ds_read_b128 a[40:43], v24 offset:36864
    v_mul_f32_e64 v113, v15, v113
    v_mfma_f32_16x16x32_bf16 v[52:55], a[80:83], a[108:111], v[52:55]
    ds_read_b128 a[44:47], v24 offset:38912
    s_lshl_b32 s36, s36, 7
    v_mfma_f32_16x16x32_bf16 v[56:59], a[84:87], a[104:107], v[56:59]
    ds_read_b128 a[48:51], v24 offset:40960
    v_mul_f32 v114, v15, v114
    v_mfma_f32_16x16x32_bf16 v[60:63], a[84:87], a[108:111], v[60:63]
    ds_read_b128 a[52:55], v24 offset:43008
    v_mfma_f32_16x16x32_bf16 v[64:67], a[88:91], a[104:107], v[64:67]
    ds_read_b128 a[56:59], v24 offset:45056
    buffer_load_dwordx4 v16, s[8:11], s36 offen offset:0 lds
    v_mul_f32_e64 v115, v15, v115
    v_mfma_f32_16x16x32_bf16 v[68:71], a[88:91], a[108:111], v[68:71]
    ds_read_b128 a[60:63], v24 offset:47104
    v_mul_f32_e64 v116, v15, v116
    v_mfma_f32_16x16x32_bf16 v[72:75], a[92:95], a[104:107], v[72:75]
    buffer_load_dwordx4 v17, s[8:11], s36 offen offset:1024 lds
    v_mfma_f32_16x16x32_bf16 v[76:79], a[92:95], a[108:111], v[76:79]
    v_mul_f32_e64 v117, v15, v117
    v_mfma_f32_16x16x32_bf16 v[80:83], a[96:99], a[104:107], v[80:83]
    v_mul_f32_e64 v118, v15, v118
    v_mfma_f32_16x16x32_bf16 v[84:87], a[96:99], a[108:111], v[84:87]
    buffer_load_dwordx4 v18, s[8:11], s36 offen offset:2048 lds
    v_mfma_f32_16x16x32_bf16 v[88:91], a[100:103], a[104:107], v[88:91]
    v_mul_f32_e64 v119, v15, v119
    v_mfma_f32_16x16x32_bf16 v[92:95], a[100:103], a[108:111], v[92:95]
    s_waitcnt lgkmcnt(0)
    s_nop 0
    v_mfma_f32_16x16x32_bf16 v[32:35], a[32:35], a[64:67], v[32:35]
    ds_read_b128 a[104:107], v27 offset:32768
    buffer_load_dwordx4 v19, s[8:11], s36 offen offset:3072 lds
    v_fma_f32 v251, v249, 2.0, 1.0
    v_mfma_f32_16x16x32_bf16 v[36:39], a[32:35], a[68:71], v[36:39]
    ds_read_b128 a[108:111], v27 offset:40960
    v_mul_f32 v251, 0x3a000000, v251
    v_mfma_f32_16x16x32_bf16 v[40:43], a[36:39], a[64:67], v[40:43]
    ds_read_b128 a[72:75], v25 offset:32768
    s_add_u32 m0, s37, 16384
    v_mfma_f32_16x16x32_bf16 v[44:47], a[36:39], a[68:71], v[44:47]
    ds_read_b128 a[76:79], v25 offset:34816
    v_mul_f32_e64 v248, v14, v251
    v_mfma_f32_16x16x32_bf16 v[48:51], a[40:43], a[64:67], v[48:51]
    ds_read_b128 a[80:83], v25 offset:36864
    v_fmamk_f32 v4, v251, 0x00000000, v248
    v_mfma_f32_16x16x32_bf16 v[52:55], a[40:43], a[68:71], v[52:55]
    ds_read_b128 a[84:87], v25 offset:38912
    buffer_load_dwordx4 v20, s[12:15], s36 offen offset:0 lds
    v_mfma_f32_16x16x32_bf16 v[56:59], a[44:47], a[64:67], v[56:59]
    ds_read_b128 a[88:91], v25 offset:40960
    v_fmamk_f32 v5, v251, 0x3f800000, v248
    v_mfma_f32_16x16x32_bf16 v[60:63], a[44:47], a[68:71], v[60:63]
    ds_read_b128 a[92:95], v25 offset:43008
    v_mfma_f32_16x16x32_bf16 v[64:67], a[48:51], a[64:67], v[64:67]
    ds_read_b128 a[96:99], v25 offset:45056
    buffer_load_dwordx4 v21, s[12:15], s36 offen offset:1024 lds
    v_fmamk_f32 v6, v251, 0x40000000, v248
    v_mfma_f32_16x16x32_bf16 v[68:71], a[48:51], a[68:71], v[68:71]
    ds_read_b128 a[100:103], v25 offset:47104
    v_fmamk_f32 v7, v251, 0x40400000, v248
    v_mfma_f32_16x16x32_bf16 v[72:75], a[52:55], a[64:67], v[72:75]
    buffer_load_dwordx4 v22, s[12:15], s36 offen offset:2048 lds
    v_mfma_f32_16x16x32_bf16 v[76:79], a[52:55], a[68:71], v[76:79]
    v_cos_f32_e64 v120, v4
    v_mfma_f32_16x16x32_bf16 v[80:83], a[56:59], a[64:67], v[80:83]
    v_cos_f32_e64 v121, v5
    v_mfma_f32_16x16x32_bf16 v[84:87], a[56:59], a[68:71], v[84:87]
    buffer_load_dwordx4 v23, s[12:15], s36 offen offset:3072 lds
    v_mfma_f32_16x16x32_bf16 v[88:91], a[60:63], a[64:67], v[88:91]
    v_cos_f32_e64 v122, v6
    v_mfma_f32_16x16x32_bf16 v[92:95], a[60:63], a[68:71], v[92:95]
    s_waitcnt lgkmcnt(0) vmcnt(16)
    s_barrier
    v_mfma_f32_16x16x32_bf16 v[32:35], a[72:75], a[104:107], v[32:35]
    ds_read_b128 a[64:67], v150 offset:0
    s_bfe_u32 s36, s67, 262164
    v_cos_f32_e64 v123, v7
    v_mfma_f32_16x16x32_bf16 v[36:39], a[72:75], a[108:111], v[36:39]
    ds_read_b128 a[68:71], v150 offset:8192
    s_add_u32 m0, s37, 32768
    v_sin_f32_e64 v124, v4
    v_mfma_f32_16x16x32_bf16 v[40:43], a[76:79], a[104:107], v[40:43]
    ds_read_b128 a[32:35], v148 offset:0
    v_mfma_f32_16x16x32_bf16 v[44:47], a[76:79], a[108:111], v[44:47]
    ds_read_b128 a[36:39], v148 offset:2048
    s_lshl_b32 s36, s36, 7
    v_sin_f32 v125, v5
    v_mfma_f32_16x16x32_bf16 v[48:51], a[80:83], a[104:107], v[48:51]
    ds_read_b128 a[40:43], v148 offset:4096
    v_sin_f32_e64 v126, v6
    v_mfma_f32_16x16x32_bf16 v[52:55], a[80:83], a[108:111], v[52:55]
    ds_read_b128 a[44:47], v148 offset:6144
    buffer_load_dwordx4 v16, s[8:11], s36 offen offset:0 lds
    v_mfma_f32_16x16x32_bf16 v[56:59], a[84:87], a[104:107], v[56:59]
    ds_read_b128 a[48:51], v148 offset:8192
    v_sin_f32_e64 v127, v7
    v_mfma_f32_16x16x32_bf16 v[60:63], a[84:87], a[108:111], v[60:63]
    ds_read_b128 a[52:55], v148 offset:10240
    buffer_load_dwordx4 v17, s[8:11], s36 offen offset:1024 lds
    v_mfma_f32_16x16x32_bf16 v[64:67], a[88:91], a[104:107], v[64:67]
    ds_read_b128 a[56:59], v148 offset:12288
    buffer_load_dwordx4 v18, s[8:11], s36 offen offset:2048 lds
    v_mul_f32_e64 v120, v15, v120
    v_mfma_f32_16x16x32_bf16 v[68:71], a[88:91], a[108:111], v[68:71]
    ds_read_b128 a[60:63], v148 offset:14336
    v_mul_f32_e64 v121, v15, v121
    v_mfma_f32_16x16x32_bf16 v[72:75], a[92:95], a[104:107], v[72:75]
    buffer_load_dwordx4 v19, s[8:11], s36 offen offset:3072 lds
    v_mfma_f32_16x16x32_bf16 v[76:79], a[92:95], a[108:111], v[76:79]
    v_mul_f32_e64 v122, v15, v122
    v_mfma_f32_16x16x32_bf16 v[80:83], a[96:99], a[104:107], v[80:83]
    s_add_u32 m0, s37, 49152
    v_mul_f32_e64 v123, v15, v123
    v_mfma_f32_16x16x32_bf16 v[84:87], a[96:99], a[108:111], v[84:87]
    v_mfma_f32_16x16x32_bf16 v[88:91], a[100:103], a[104:107], v[88:91]
    buffer_load_dwordx4 v20, s[12:15], s36 offen offset:0 lds
    v_mul_f32_e64 v124, v15, v124
    v_mfma_f32_16x16x32_bf16 v[92:95], a[100:103], a[108:111], v[92:95]
    s_waitcnt lgkmcnt(0)
    v_mfma_f32_16x16x32_bf16 v[32:35], a[32:35], a[64:67], v[32:35]
    ds_read_b128 a[104:107], v151 offset:0
    buffer_load_dwordx4 v21, s[12:15], s36 offen offset:1024 lds
    v_mul_f32 v125, v15, v125
    v_mfma_f32_16x16x32_bf16 v[36:39], a[32:35], a[68:71], v[36:39]
    ds_read_b128 a[108:111], v151 offset:8192
    buffer_load_dwordx4 v22, s[12:15], s36 offen offset:2048 lds
    v_mul_f32_e64 v126, v15, v126
    v_mfma_f32_16x16x32_bf16 v[40:43], a[36:39], a[64:67], v[40:43]
    ds_read_b128 a[72:75], v149 offset:0
    v_mfma_f32_16x16x32_bf16 v[44:47], a[36:39], a[68:71], v[44:47]
    ds_read_b128 a[76:79], v149 offset:2048
    buffer_load_dwordx4 v23, s[12:15], s36 offen offset:3072 lds
    v_mul_f32_e64 v127, v15, v127
    v_mfma_f32_16x16x32_bf16 v[48:51], a[40:43], a[64:67], v[48:51]
    ds_read_b128 a[80:83], v149 offset:4096
    s_and_b32 s38, s32, 3
    v_mfma_f32_16x16x32_bf16 v[52:55], a[40:43], a[68:71], v[52:55]
    ds_read_b128 a[84:87], v149 offset:6144
    s_getpc_b64 s[20:21]
K_PC2:
    s_mov_b32 s22, K_CODE_END-K_PC2
    v_mfma_f32_16x16x32_bf16 v[56:59], a[44:47], a[64:67], v[56:59]
    ds_read_b128 a[88:91], v149 offset:8192
    s_mov_b32 s97, 1985229328
    v_mfma_f32_16x16x32_bf16 v[60:63], a[44:47], a[68:71], v[60:63]
    ds_read_b128 a[92:95], v149 offset:10240
    s_bfe_u32 s3, s2, 0x20003
    v_mfma_f32_16x16x32_bf16 v[64:67], a[48:51], a[64:67], v[64:67]
    ds_read_b128 a[96:99], v149 offset:12288
    s_lshl2_add_u32 s3, s3, s34
    s_cmp_eq_u32 s38, 1
    s_cselect_b32 s97, 561402928, s97
    v_mfma_f32_16x16x32_bf16 v[68:71], a[48:51], a[68:71], v[68:71]
    ds_read_b128 a[100:103], v149 offset:14336
    s_cmp_eq_u32 s38, 2
    s_cselect_b32 s97, 1126266448, s97
    v_mfma_f32_16x16x32_bf16 v[72:75], a[52:55], a[64:67], v[72:75]
    s_lshl_b32 s3, s3, 11
    v_mfma_f32_16x16x32_bf16 v[76:79], a[52:55], a[68:71], v[76:79]
    s_cmp_eq_u32 s38, 3
    s_cselect_b32 s97, 1698898288, s97
    v_mfma_f32_16x16x32_bf16 v[80:83], a[56:59], a[64:67], v[80:83]
    v_lshl_add_u32 v28, v0, 5, s3
    s_lshr_b32 s38, s2, 5
    v_mfma_f32_16x16x32_bf16 v[84:87], a[56:59], a[68:71], v[84:87]
    v_mfma_f32_16x16x32_bf16 v[88:91], a[60:63], a[64:67], v[88:91]
    buffer_load_dword a221, v28, s[20:23], 0 offen
    s_mul_i32 s38, s38, 0x11111111
    v_mfma_f32_16x16x32_bf16 v[92:95], a[60:63], a[68:71], v[92:95]
    s_waitcnt lgkmcnt(0) vmcnt(17)
    s_barrier
    v_mfma_f32_16x16x32_bf16 v[32:35], a[72:75], a[104:107], v[32:35]
    ds_read_b128 a[64:67], v150 offset:32768
    s_bfe_u32 s36, s67, 262168
    s_add_u32 s97, s97, s38
    s_nop 0
    v_mfma_f32_16x16x32_bf16 v[36:39], a[72:75], a[108:111], v[36:39]
    ds_read_b128 a[68:71], v150 offset:40960
    s_and_b32 s97, s97, 0x77777777
    v_mfma_f32_16x16x32_bf16 v[40:43], a[76:79], a[104:107], v[40:43]
    ds_read_b128 a[32:35], v148 offset:32768
    s_add_u32 m0, s37, 65536
    v_mfma_f32_16x16x32_bf16 v[44:47], a[76:79], a[108:111], v[44:47]
    ds_read_b128 a[36:39], v148 offset:34816
    s_lshl_b32 s38, s33, 6
    v_mfma_f32_16x16x32_bf16 v[48:51], a[80:83], a[104:107], v[48:51]
    ds_read_b128 a[40:43], v148 offset:36864
    s_add_u32 s38, s38, s34
    v_mfma_f32_16x16x32_bf16 v[52:55], a[80:83], a[108:111], v[52:55]
    ds_read_b128 a[44:47], v148 offset:38912
    s_lshl_b32 s36, s36, 7
    v_mfma_f32_16x16x32_bf16 v[56:59], a[84:87], a[104:107], v[56:59]
    ds_read_b128 a[48:51], v148 offset:40960
    s_lshl_b32 s38, s38, 8
    v_mfma_f32_16x16x32_bf16 v[60:63], a[84:87], a[108:111], v[60:63]
    ds_read_b128 a[52:55], v148 offset:43008
    v_mfma_f32_16x16x32_bf16 v[64:67], a[88:91], a[104:107], v[64:67]
    ds_read_b128 a[56:59], v148 offset:45056
    buffer_load_dwordx4 v16, s[8:11], s36 offen offset:0 lds
    s_add_u32 s93, s38, 22020096
    v_mfma_f32_16x16x32_bf16 v[68:71], a[88:91], a[108:111], v[68:71]
    ds_read_b128 a[60:63], v148 offset:47104
    s_lshl_b32 s38, s32, 11
    v_mfma_f32_16x16x32_bf16 v[72:75], a[92:95], a[104:107], v[72:75]
    buffer_load_dwordx4 v17, s[8:11], s36 offen offset:1024 lds
    v_mfma_f32_16x16x32_bf16 v[76:79], a[92:95], a[108:111], v[76:79]
    s_add_u32 s38, s38, s33
    v_mfma_f32_16x16x32_bf16 v[80:83], a[96:99], a[104:107], v[80:83]
    s_lshl_b32 s5, s38, 8
    v_mfma_f32_16x16x32_bf16 v[84:87], a[96:99], a[108:111], v[84:87]
    buffer_load_dwordx4 v18, s[8:11], s36 offen offset:2048 lds
    v_mfma_f32_16x16x32_bf16 v[88:91], a[100:103], a[104:107], v[88:91]
    s_lshl_b32 s38, s94, 16
    v_mfma_f32_16x16x32_bf16 v[92:95], a[100:103], a[108:111], v[92:95]
    s_waitcnt lgkmcnt(0)
    s_nop 0
    v_mfma_f32_16x16x32_bf16 v[32:35], a[32:35], a[64:67], v[32:35]
    ds_read_b128 a[104:107], v151 offset:32768
    buffer_load_dwordx4 v19, s[8:11], s36 offen offset:3072 lds
    s_andn2_b32 s95, s5, 0x700
    v_mfma_f32_16x16x32_bf16 v[36:39], a[32:35], a[68:71], v[36:39]
    ds_read_b128 a[108:111], v151 offset:40960
    v_mfma_f32_16x16x32_bf16 v[40:43], a[36:39], a[64:67], v[40:43]
    ds_read_b128 a[72:75], v149 offset:32768
    s_add_u32 m0, s37, 81920
    v_mfma_f32_16x16x32_bf16 v[44:47], a[36:39], a[68:71], v[44:47]
    ds_read_b128 a[76:79], v149 offset:34816
    v_mfma_f32_16x16x32_bf16 v[48:51], a[40:43], a[64:67], v[48:51]
    ds_read_b128 a[80:83], v149 offset:36864
    s_add_u32 s95, s95, s38
    s_nop 0
    v_mfma_f32_16x16x32_bf16 v[52:55], a[40:43], a[68:71], v[52:55]
    ds_read_b128 a[84:87], v149 offset:38912
    buffer_load_dwordx4 v20, s[12:15], s36 offen offset:0 lds
    v_mfma_f32_16x16x32_bf16 v[56:59], a[44:47], a[64:67], v[56:59]
    ds_read_b128 a[88:91], v149 offset:40960
    v_mfma_f32_16x16x32_bf16 v[60:63], a[44:47], a[68:71], v[60:63]
    ds_read_b128 a[92:95], v149 offset:43008
    v_mfma_f32_16x16x32_bf16 v[64:67], a[48:51], a[64:67], v[64:67]
    ds_read_b128 a[96:99], v149 offset:45056
    buffer_load_dwordx4 v21, s[12:15], s36 offen offset:1024 lds
    s_cmp_lt_u32 s34, 2
    s_cselect_b64 s[16:17], s[80:81], s[82:83]
    v_mfma_f32_16x16x32_bf16 v[68:71], a[48:51], a[68:71], v[68:71]
    ds_read_b128 a[100:103], v149 offset:47104
    v_mfma_f32_16x16x32_bf16 v[72:75], a[52:55], a[64:67], v[72:75]
    buffer_load_dwordx4 v22, s[12:15], s36 offen offset:2048 lds
    v_mfma_f32_16x16x32_bf16 v[76:79], a[52:55], a[68:71], v[76:79]
    v_mfma_f32_16x16x32_bf16 v[80:83], a[56:59], a[64:67], v[80:83]
    s_mov_b32 s18, 0x200000
    v_mfma_f32_16x16x32_bf16 v[84:87], a[56:59], a[68:71], v[84:87]
    buffer_load_dwordx4 v23, s[12:15], s36 offen offset:3072 lds
    v_mfma_f32_16x16x32_bf16 v[88:91], a[60:63], a[64:67], v[88:91]
    v_mfma_f32_16x16x32_bf16 v[92:95], a[60:63], a[68:71], v[92:95]
    s_waitcnt lgkmcnt(0) vmcnt(17)
    s_barrier
    v_mfma_f32_16x16x32_bf16 v[32:35], a[72:75], a[104:107], v[32:35]
    ds_read_b128 a[64:67], v26 offset:0
    s_lshl_b32 s68, s34, 10
    s_nop 0
    v_mfma_f32_16x16x32_bf16 v[36:39], a[72:75], a[108:111], v[36:39]
    ds_read_b128 a[68:71], v26 offset:8192
    s_add_u32 s68, s68, 22298624
    v_mfma_f32_16x16x32_bf16 v[40:43], a[76:79], a[104:107], v[40:43]
    ds_read_b128 a[32:35], v24 offset:0
    v_mfma_f32_16x16x32_bf16 v[44:47], a[76:79], a[108:111], v[44:47]
    ds_read_b128 a[36:39], v24 offset:2048
    buffer_load_dword v216, v3, s[24:27], s68 offen sc1
    v_mfma_f32_16x16x32_bf16 v[48:51], a[80:83], a[104:107], v[48:51]
    ds_read_b128 a[40:43], v24 offset:4096
    s_bfe_u32 s36, s67, 262172
    v_mfma_f32_16x16x32_bf16 v[52:55], a[80:83], a[108:111], v[52:55]
    ds_read_b128 a[44:47], v24 offset:6144
    v_mfma_f32_16x16x32_bf16 v[56:59], a[84:87], a[104:107], v[56:59]
    ds_read_b128 a[48:51], v24 offset:8192
    s_add_u32 m0, s37, 98304
    v_mfma_f32_16x16x32_bf16 v[60:63], a[84:87], a[108:111], v[60:63]
    ds_read_b128 a[52:55], v24 offset:10240
    v_mfma_f32_16x16x32_bf16 v[64:67], a[88:91], a[104:107], v[64:67]
    ds_read_b128 a[56:59], v24 offset:12288
    s_lshl_b32 s36, s36, 7
    s_nop 0
    v_mfma_f32_16x16x32_bf16 v[68:71], a[88:91], a[108:111], v[68:71]
    ds_read_b128 a[60:63], v24 offset:14336
    buffer_load_dwordx4 v16, s[8:11], s36 offen offset:0 lds
    v_mfma_f32_16x16x32_bf16 v[72:75], a[92:95], a[104:107], v[72:75]
    v_mfma_f32_16x16x32_bf16 v[76:79], a[92:95], a[108:111], v[76:79]
    buffer_load_dwordx4 v17, s[8:11], s36 offen offset:1024 lds
    v_mfma_f32_16x16x32_bf16 v[80:83], a[96:99], a[104:107], v[80:83]
    buffer_load_dwordx4 v18, s[8:11], s36 offen offset:2048 lds
    v_mfma_f32_16x16x32_bf16 v[84:87], a[96:99], a[108:111], v[84:87]
    v_mfma_f32_16x16x32_bf16 v[88:91], a[100:103], a[104:107], v[88:91]
    buffer_load_dwordx4 v19, s[8:11], s36 offen offset:3072 lds
    v_mfma_f32_16x16x32_bf16 v[92:95], a[100:103], a[108:111], v[92:95]
    s_waitcnt lgkmcnt(0)
    v_mfma_f32_16x16x32_bf16 v[32:35], a[32:35], a[64:67], v[32:35]
    ds_read_b128 a[104:107], v27 offset:0
    s_add_u32 m0, s37, 114688
    v_and_b32 v6, 7, v0
    v_xor_b32_e64 v6, v6, v2
    v_mfma_f32_16x16x32_bf16 v[36:39], a[32:35], a[68:71], v[36:39]
    ds_read_b128 a[108:111], v27 offset:8192
    s_and_b32 s38, s33, 8
    s_lshl_b32 s38, s38, 7
    v_mfma_f32_16x16x32_bf16 v[40:43], a[36:39], a[64:67], v[40:43]
    ds_read_b128 a[72:75], v25 offset:0
    v_lshl_add_u32 v6, v6, 4, s38
    v_lshrrev_b32_e64 v8, 3, v0
    v_mfma_f32_16x16x32_bf16 v[44:47], a[36:39], a[68:71], v[44:47]
    ds_read_b128 a[76:79], v25 offset:2048
    buffer_load_dwordx4 v20, s[12:15], s36 offen offset:0 lds
    s_xor_b32 s38, s33, 8
    v_mfma_f32_16x16x32_bf16 v[48:51], a[40:43], a[64:67], v[48:51]
    ds_read_b128 a[80:83], v25 offset:4096
    s_lshl_b32 s38, s38, 5
    s_add_u32 s38, s38, s6
    v_mfma_f32_16x16x32_bf16 v[52:55], a[40:43], a[68:71], v[52:55]
    ds_read_b128 a[84:87], v25 offset:6144
    s_lshl_b32 s38, s38, 1
    v_lshl_add_u32 v8, v8, 2, s38
    v_mfma_f32_16x16x32_bf16 v[56:59], a[44:47], a[64:67], v[56:59]
    ds_read_b128 a[88:91], v25 offset:8192
    buffer_load_dwordx4 v21, s[12:15], s36 offen offset:1024 lds
    v_lshl_add_u32 v16, v8, 11, v6
    v_mfma_f32_16x16x32_bf16 v[60:63], a[44:47], a[68:71], v[60:63]
    ds_read_b128 a[92:95], v25 offset:10240
    v_xor_b32_e64 v8, 64, v16
    v_add_u32 v17, 64512, v8
    v_mfma_f32_16x16x32_bf16 v[64:67], a[48:51], a[64:67], v[64:67]
    ds_read_b128 a[96:99], v25 offset:12288
    v_mov_b32_e64 v18, v16
    v_add_u32 v19, 64512, v8
    v_mfma_f32_16x16x32_bf16 v[68:71], a[48:51], a[68:71], v[68:71]
    ds_read_b128 a[100:103], v25 offset:14336
    buffer_load_dwordx4 v22, s[12:15], s36 offen offset:2048 lds
    s_lshl1_add_u32 s40, s33, s6
    v_mfma_f32_16x16x32_bf16 v[72:75], a[52:55], a[64:67], v[72:75]
    s_lshl_b32 s40, s40, 6
    s_lshr_b32 s41, s33, 3
    v_mfma_f32_16x16x32_bf16 v[76:79], a[52:55], a[68:71], v[76:79]
    s_add_u32 s40, s40, s41
    s_and_b32 s41, s32, 3
    v_mfma_f32_16x16x32_bf16 v[80:83], a[56:59], a[64:67], v[80:83]
    buffer_load_dwordx4 v23, s[12:15], s36 offen offset:3072 lds
    s_lshl2_add_u32 s40, s40, s41
    v_mfma_f32_16x16x32_bf16 v[84:87], a[56:59], a[68:71], v[84:87]
    s_lshl_b32 s92, s40, 8
    v_lshrrev_b32 v29, 1, v0
    v_mfma_f32_16x16x32_bf16 v[88:91], a[60:63], a[64:67], v[88:91]
    v_lshlrev_b32_e64 v29, 4, v29
    v_and_or_b32 v29, v0, 1, v29
    v_mfma_f32_16x16x32_bf16 v[92:95], a[60:63], a[68:71], v[92:95]
    v_lshlrev_b32 v29, 7, v29
    s_waitcnt lgkmcnt(0) vmcnt(8)
    v_cmp_ne_u32 vcc, s35, v216
    s_nop 0
    s_cbranch_vccnz K_POLL1
K_POLL1_OK:
    s_barrier
    v_mfma_f32_16x16x32_bf16 v[32:35], a[72:75], a[104:107], v[32:35]
    ds_read_b128 a[64:67], v26 offset:32768
    v_lshlrev_b32_e64 v28, 12, v2
    v_mfma_f32_16x16x32_bf16 v[36:39], a[72:75], a[108:111], v[36:39]
    ds_read_b128 a[68:71], v26 offset:40960
    v_lshl_add_u32 v28, v1, 4, v28
    v_mfma_f32_16x16x32_bf16 v[40:43], a[76:79], a[104:107], v[40:43]
    ds_read_b128 a[32:35], v24 offset:32768
    s_lshl4_add_u32 s68, s37, s5
    s_nop 0
    v_mfma_f32_16x16x32_bf16 v[44:47], a[76:79], a[108:111], v[44:47]
    ds_read_b128 a[36:39], v24 offset:34816
    s_add_u32 m0, s37, 131072
    v_mfma_f32_16x16x32_bf16 v[48:51], a[80:83], a[104:107], v[48:51]
    ds_read_b128 a[40:43], v24 offset:36864
    s_add_u32 s69, s68, 0
    s_nop 0
    v_mfma_f32_16x16x32_bf16 v[52:55], a[80:83], a[108:111], v[52:55]
    ds_read_b128 a[44:47], v24 offset:38912
    buffer_load_dwordx4 v28, s[28:31], s69 offen sc1 lds
    v_mfma_f32_16x16x32_bf16 v[56:59], a[84:87], a[104:107], v[56:59]
    ds_read_b128 a[48:51], v24 offset:40960
    s_add_u32 m0, s37, 132096
    v_mfma_f32_16x16x32_bf16 v[60:63], a[84:87], a[108:111], v[60:63]
    ds_read_b128 a[52:55], v24 offset:43008
    v_mfma_f32_16x16x32_bf16 v[64:67], a[88:91], a[104:107], v[64:67]
    ds_read_b128 a[56:59], v24 offset:45056
    s_add_u32 s69, s68, 16384
    v_mfma_f32_16x16x32_bf16 v[68:71], a[88:91], a[108:111], v[68:71]
    ds_read_b128 a[60:63], v24 offset:47104
    buffer_load_dwordx4 v28, s[28:31], s69 offen sc1 lds
    v_mfma_f32_16x16x32_bf16 v[72:75], a[92:95], a[104:107], v[72:75]
    s_add_u32 m0, s37, 133120
    v_mfma_f32_16x16x32_bf16 v[76:79], a[92:95], a[108:111], v[76:79]
    s_add_u32 s69, s68, 32768
    v_mfma_f32_16x16x32_bf16 v[80:83], a[96:99], a[104:107], v[80:83]
    buffer_load_dwordx4 v28, s[28:31], s69 offen sc1 lds
    v_mfma_f32_16x16x32_bf16 v[84:87], a[96:99], a[108:111], v[84:87]
    s_add_u32 m0, s37, 134144
    v_mfma_f32_16x16x32_bf16 v[88:91], a[100:103], a[104:107], v[88:91]
    s_add_u32 s69, s68, 49152
    v_mfma_f32_16x16x32_bf16 v[92:95], a[100:103], a[108:111], v[92:95]
    s_waitcnt lgkmcnt(0)
    s_nop 0
    v_mfma_f32_16x16x32_bf16 v[32:35], a[32:35], a[64:67], v[32:35]
    ds_read_b128 a[104:107], v27 offset:32768
    buffer_load_dwordx4 v28, s[28:31], s69 offen sc1 lds
    v_mfma_f32_16x16x32_bf16 v[36:39], a[32:35], a[68:71], v[36:39]
    ds_read_b128 a[108:111], v27 offset:40960
    s_add_u32 s69, s68, 262144
    v_mfma_f32_16x16x32_bf16 v[40:43], a[36:39], a[64:67], v[40:43]
    ds_read_b128 a[72:75], v25 offset:32768
    buffer_load_dwordx4 v[200:203], v28, s[28:31], s69 offen sc1
    v_mfma_f32_16x16x32_bf16 v[44:47], a[36:39], a[68:71], v[44:47]
    ds_read_b128 a[76:79], v25 offset:34816
    s_add_u32 s69, s68, 278528
    v_mfma_f32_16x16x32_bf16 v[48:51], a[40:43], a[64:67], v[48:51]
    ds_read_b128 a[80:83], v25 offset:36864
    buffer_load_dwordx4 v[204:207], v28, s[28:31], s69 offen sc1
    v_mfma_f32_16x16x32_bf16 v[52:55], a[40:43], a[68:71], v[52:55]
    ds_read_b128 a[84:87], v25 offset:38912
    v_mfma_f32_16x16x32_bf16 v[56:59], a[44:47], a[64:67], v[56:59]
    ds_read_b128 a[88:91], v25 offset:40960
    s_add_u32 s69, s68, 294912
    v_mfma_f32_16x16x32_bf16 v[60:63], a[44:47], a[68:71], v[60:63]
    ds_read_b128 a[92:95], v25 offset:43008
    buffer_load_dwordx4 v[208:211], v28, s[28:31], s69 offen sc1
    v_mfma_f32_16x16x32_bf16 v[64:67], a[48:51], a[64:67], v[64:67]
    ds_read_b128 a[96:99], v25 offset:45056
    s_add_u32 s69, s68, 311296
    v_mfma_f32_16x16x32_bf16 v[68:71], a[48:51], a[68:71], v[68:71]
    ds_read_b128 a[100:103], v25 offset:47104
    buffer_load_dwordx4 v[212:215], v28, s[28:31], s69 offen sc1
    v_mfma_f32_16x16x32_bf16 v[72:75], a[52:55], a[64:67], v[72:75]
    v_mfma_f32_16x16x32_bf16 v[76:79], a[52:55], a[68:71], v[76:79]
    s_cmp_eq_u32 s2, 0
    s_cbranch_scc1 K_W256
K_W256_RET:
    v_mfma_f32_16x16x32_bf16 v[80:83], a[56:59], a[64:67], v[80:83]
    v_and_b32_e64 v28, 7, v0
    v_mfma_f32_16x16x32_bf16 v[84:87], a[56:59], a[68:71], v[84:87]
    v_lshlrev_b32_e64 v28, 2, v28
    v_mfma_f32_16x16x32_bf16 v[88:91], a[60:63], a[64:67], v[88:91]
    buffer_load_dword a222, v28, s[24:27], s51 offen sc1
    v_mfma_f32_16x16x32_bf16 v[92:95], a[60:63], a[68:71], v[92:95]
    s_waitcnt lgkmcnt(0)
    s_barrier
    v_mfma_f32_16x16x32_bf16 v[32:35], a[72:75], a[104:107], v[32:35]
    ds_read_b128 a[64:67], v150 offset:0
    s_bfe_u32 s72, s97, 262148
    v_mfma_f32_16x16x32_bf16 v[36:39], a[72:75], a[108:111], v[36:39]
    ds_read_b128 a[68:71], v150 offset:8192
    v_mfma_f32_16x16x32_bf16 v[40:43], a[76:79], a[104:107], v[40:43]
    ds_read_b128 a[32:35], v148 offset:0
    v_mfma_f32_16x16x32_bf16 v[44:47], a[76:79], a[108:111], v[44:47]
    ds_read_b128 a[36:39], v148 offset:2048
    v_mfma_f32_16x16x32_bf16 v[48:51], a[80:83], a[104:107], v[48:51]
    ds_read_b128 a[40:43], v148 offset:4096
    s_add_u32 m0, s37, 16384
    v_mfma_f32_16x16x32_bf16 v[52:55], a[80:83], a[108:111], v[52:55]
    ds_read_b128 a[44:47], v148 offset:6144
    v_mfma_f32_16x16x32_bf16 v[56:59], a[84:87], a[104:107], v[56:59]
    ds_read_b128 a[48:51], v148 offset:8192
    v_mfma_f32_16x16x32_bf16 v[60:63], a[84:87], a[108:111], v[60:63]
    ds_read_b128 a[52:55], v148 offset:10240
    v_mfma_f32_16x16x32_bf16 v[64:67], a[88:91], a[104:107], v[64:67]
    ds_read_b128 a[56:59], v148 offset:12288
    s_lshl_b32 s72, s72, 7
    s_nop 0
    v_mfma_f32_16x16x32_bf16 v[68:71], a[88:91], a[108:111], v[68:71]
    ds_read_b128 a[60:63], v148 offset:14336
    v_mfma_f32_16x16x32_bf16 v[72:75], a[92:95], a[104:107], v[72:75]
    v_mfma_f32_16x16x32_bf16 v[76:79], a[92:95], a[108:111], v[76:79]
    v_mfma_f32_16x16x32_bf16 v[80:83], a[96:99], a[104:107], v[80:83]
    buffer_load_dwordx4 v16, s[16:19], s72 offen offset:0  lds
    v_mfma_f32_16x16x32_bf16 v[84:87], a[96:99], a[108:111], v[84:87]
    v_mfma_f32_16x16x32_bf16 v[88:91], a[100:103], a[104:107], v[88:91]
    v_mfma_f32_16x16x32_bf16 v[92:95], a[100:103], a[108:111], v[92:95]
    s_waitcnt lgkmcnt(0)
    s_nop 0
    v_mfma_f32_16x16x32_bf16 v[32:35], a[32:35], a[64:67], v[32:35]
    ds_read_b128 a[104:107], v151 offset:0
    buffer_load_dwordx4 v17, s[16:19], s72 offen offset:1024  lds
    v_mfma_f32_16x16x32_bf16 v[36:39], a[32:35], a[68:71], v[36:39]
    ds_read_b128 a[108:111], v151 offset:8192
    v_mfma_f32_16x16x32_bf16 v[40:43], a[36:39], a[64:67], v[40:43]
    ds_read_b128 a[72:75], v149 offset:0
    v_mfma_f32_16x16x32_bf16 v[44:47], a[36:39], a[68:71], v[44:47]
    ds_read_b128 a[76:79], v149 offset:2048
    v_mfma_f32_16x16x32_bf16 v[48:51], a[40:43], a[64:67], v[48:51]
    ds_read_b128 a[80:83], v149 offset:4096
    v_mfma_f32_16x16x32_bf16 v[52:55], a[40:43], a[68:71], v[52:55]
    ds_read_b128 a[84:87], v149 offset:6144
    buffer_load_dwordx4 v18, s[16:19], s72 offen offset:2048  lds
    v_mfma_f32_16x16x32_bf16 v[56:59], a[44:47], a[64:67], v[56:59]
    ds_read_b128 a[88:91], v149 offset:8192
    v_mfma_f32_16x16x32_bf16 v[60:63], a[44:47], a[68:71], v[60:63]
    ds_read_b128 a[92:95], v149 offset:10240
    v_mfma_f32_16x16x32_bf16 v[64:67], a[48:51], a[64:67], v[64:67]
    ds_read_b128 a[96:99], v149 offset:12288
    v_mfma_f32_16x16x32_bf16 v[68:71], a[48:51], a[68:71], v[68:71]
    ds_read_b128 a[100:103], v149 offset:14336
    v_mfma_f32_16x16x32_bf16 v[72:75], a[52:55], a[64:67], v[72:75]
    buffer_load_dwordx4 v19, s[16:19], s72 offen offset:3072  lds
    v_mfma_f32_16x16x32_bf16 v[76:79], a[52:55], a[68:71], v[76:79]
    v_mfma_f32_16x16x32_bf16 v[80:83], a[56:59], a[64:67], v[80:83]
    v_mfma_f32_16x16x32_bf16 v[84:87], a[56:59], a[68:71], v[84:87]
    v_mfma_f32_16x16x32_bf16 v[88:91], a[60:63], a[64:67], v[88:91]
    v_mfma_f32_16x16x32_bf16 v[92:95], a[60:63], a[68:71], v[92:95]
    s_waitcnt lgkmcnt(0) vmcnt(13)
    s_barrier
    v_mfma_f32_16x16x32_bf16 v[32:35], a[72:75], a[104:107], v[32:35]
    ds_read_b128 a[64:67], v150 offset:32768
    s_bfe_u32 s72, s97, 262152
    v_mfma_f32_16x16x32_bf16 v[36:39], a[72:75], a[108:111], v[36:39]
    ds_read_b128 a[68:71], v150 offset:40960
    v_mfma_f32_16x16x32_bf16 v[40:43], a[76:79], a[104:107], v[40:43]
    ds_read_b128 a[32:35], v148 offset:32768
    v_mfma_f32_16x16x32_bf16 v[44:47], a[76:79], a[108:111], v[44:47]
    ds_read_b128 a[36:39], v148 offset:34816
    v_mfma_f32_16x16x32_bf16 v[48:51], a[80:83], a[104:107], v[48:51]
    ds_read_b128 a[40:43], v148 offset:36864
    s_add_u32 m0, s37, 32768
    v_mfma_f32_16x16x32_bf16 v[52:55], a[80:83], a[108:111], v[52:55]
    ds_read_b128 a[44:47], v148 offset:38912
    v_mfma_f32_16x16x32_bf16 v[56:59], a[84:87], a[104:107], v[56:59]
    ds_read_b128 a[48:51], v148 offset:40960
    v_mfma_f32_16x16x32_bf16 v[60:63], a[84:87], a[108:111], v[60:63]
    ds_read_b128 a[52:55], v148 offset:43008
    v_mfma_f32_16x16x32_bf16 v[64:67], a[88:91], a[104:107], v[64:67]
    ds_read_b128 a[56:59], v148 offset:45056
    s_lshl_b32 s72, s72, 7
    s_nop 0
    v_mfma_f32_16x16x32_bf16 v[68:71], a[88:91], a[108:111], v[68:71]
    ds_read_b128 a[60:63], v148 offset:47104
    v_mfma_f32_16x16x32_bf16 v[72:75], a[92:95], a[104:107], v[72:75]
    v_mfma_f32_16x16x32_bf16 v[76:79], a[92:95], a[108:111], v[76:79]
    v_mfma_f32_16x16x32_bf16 v[80:83], a[96:99], a[104:107], v[80:83]
    buffer_load_dwordx4 v16, s[16:19], s72 offen offset:0  lds
    v_mfma_f32_16x16x32_bf16 v[84:87], a[96:99], a[108:111], v[84:87]
    v_mfma_f32_16x16x32_bf16 v[88:91], a[100:103], a[104:107], v[88:91]
    v_mfma_f32_16x16x32_bf16 v[92:95], a[100:103], a[108:111], v[92:95]
    s_waitcnt lgkmcnt(0)
    s_nop 0
    v_mfma_f32_16x16x32_bf16 v[32:35], a[32:35], a[64:67], v[32:35]
    ds_read_b128 a[104:107], v151 offset:32768
    buffer_load_dwordx4 v17, s[16:19], s72 offen offset:1024  lds
    v_mfma_f32_16x16x32_bf16 v[36:39], a[32:35], a[68:71], v[36:39]
    ds_read_b128 a[108:111], v151 offset:40960
    v_mfma_f32_16x16x32_bf16 v[40:43], a[36:39], a[64:67], v[40:43]
    ds_read_b128 a[72:75], v149 offset:32768
    v_mfma_f32_16x16x32_bf16 v[44:47], a[36:39], a[68:71], v[44:47]
    ds_read_b128 a[76:79], v149 offset:34816
    v_mfma_f32_16x16x32_bf16 v[48:51], a[40:43], a[64:67], v[48:51]
    ds_read_b128 a[80:83], v149 offset:36864
    v_mfma_f32_16x16x32_bf16 v[52:55], a[40:43], a[68:71], v[52:55]
    ds_read_b128 a[84:87], v149 offset:38912
    buffer_load_dwordx4 v18, s[16:19], s72 offen offset:2048  lds
    v_mfma_f32_16x16x32_bf16 v[56:59], a[44:47], a[64:67], v[56:59]
    ds_read_b128 a[88:91], v149 offset:40960
    v_mfma_f32_16x16x32_bf16 v[60:63], a[44:47], a[68:71], v[60:63]
    ds_read_b128 a[92:95], v149 offset:43008
    v_mfma_f32_16x16x32_bf16 v[64:67], a[48:51], a[64:67], v[64:67]
    ds_read_b128 a[96:99], v149 offset:45056
    v_mfma_f32_16x16x32_bf16 v[68:71], a[48:51], a[68:71], v[68:71]
    ds_read_b128 a[100:103], v149 offset:47104
    v_mfma_f32_16x16x32_bf16 v[72:75], a[52:55], a[64:67], v[72:75]
    buffer_load_dwordx4 v19, s[16:19], s72 offen offset:3072  lds
    v_mfma_f32_16x16x32_bf16 v[76:79], a[52:55], a[68:71], v[76:79]
    v_mfma_f32_16x16x32_bf16 v[80:83], a[56:59], a[64:67], v[80:83]
    v_mfma_f32_16x16x32_bf16 v[84:87], a[56:59], a[68:71], v[84:87]
    v_mfma_f32_16x16x32_bf16 v[88:91], a[60:63], a[64:67], v[88:91]
    v_mfma_f32_16x16x32_bf16 v[92:95], a[60:63], a[68:71], v[92:95]
    s_waitcnt lgkmcnt(0)
    v_mfma_f32_16x16x32_bf16 v[32:35], a[72:75], a[104:107], v[32:35]
    v_add_u32 v28, 131072, v3
    v_mfma_f32_16x16x32_bf16 v[36:39], a[72:75], a[108:111], v[36:39]
    v_and_b32 v8, 1, v2
    v_mfma_f32_16x16x32_bf16 v[40:43], a[76:79], a[104:107], v[40:43]
    v_lshrrev_b32_e64 v9, 1, v1
    v_mfma_f32_16x16x32_bf16 v[44:47], a[76:79], a[108:111], v[44:47]
    v_xor_b32_e64 v8, v8, v9
    v_mfma_f32_16x16x32_bf16 v[48:51], a[80:83], a[104:107], v[48:51]
    v_lshlrev_b32_e64 v8, 4, v8
    v_mfma_f32_16x16x32_bf16 v[52:55], a[80:83], a[108:111], v[52:55]
    v_lshl_add_u32 v8, v1, 7, v8
    v_mfma_f32_16x16x32_bf16 v[56:59], a[84:87], a[104:107], v[56:59]
    v_lshrrev_b32_e64 v9, 1, v2
    v_mfma_f32_16x16x32_bf16 v[60:63], a[84:87], a[108:111], v[60:63]
    v_lshl_add_u32 v20, v9, 13, v8
    v_mfma_f32_16x16x32_bf16 v[64:67], a[88:91], a[104:107], v[64:67]
    v_lshlrev_b32_e64 v9, 12, v2
    v_mfma_f32_16x16x32_bf16 v[68:71], a[88:91], a[108:111], v[68:71]
    v_lshl_add_u32 v24, v1, 4, v9
    v_mfma_f32_16x16x32_bf16 v[72:75], a[92:95], a[104:107], v[72:75]
    v_xor_b32_e64 v21, 32, v20
    v_mfma_f32_16x16x32_bf16 v[76:79], a[92:95], a[108:111], v[76:79]
    v_add_u32 v25, 16384, v24
    v_mfma_f32_16x16x32_bf16 v[80:83], a[96:99], a[104:107], v[80:83]
    v_xor_b32_e64 v22, 64, v20
    v_mfma_f32_16x16x32_bf16 v[84:87], a[96:99], a[108:111], v[84:87]
    v_add_u32 v26, 32768, v24
    v_mfma_f32_16x16x32_bf16 v[88:91], a[100:103], a[104:107], v[88:91]
    v_xor_b32 v23, 96, v20
    v_mfma_f32_16x16x32_bf16 v[92:95], a[100:103], a[108:111], v[92:95]
    v_add_u32 v27, 49152, v24
    s_waitcnt vmcnt(13)
    s_barrier
    ds_read_b128 a[32:35], v28 offset:0
    ds_read_b128 a[36:39], v28 offset:1024
    ds_read_b128 a[40:43], v28 offset:2048
    ds_read_b128 a[44:47], v28 offset:3072
    ds_read_b128 a[48:51], v28 offset:4096
    ds_read_b128 a[52:55], v28 offset:5120
    ds_read_b128 a[56:59], v28 offset:6144
    ds_read_b128 a[60:63], v28 offset:7168
    ds_read_b128 a[64:67], v28 offset:8192
    ds_read_b128 a[68:71], v28 offset:9216
    ds_read_b128 a[72:75], v28 offset:10240
    ds_read_b128 a[76:79], v28 offset:11264
    ds_read_b128 a[80:83], v28 offset:12288
    ds_read_b128 a[84:87], v28 offset:13312
    ds_read_b128 a[88:91], v28 offset:14336
    ds_read_b128 a[92:95], v28 offset:15360
    v_pk_fma_f32 v[4:5], v[32:33], v[128:129], v[34:35] op_sel_hi:[1,0,1]
    v_pk_fma_f32 v[6:7], v[36:37], v[128:129], v[38:39] op_sel_hi:[1,0,1]
    v_pk_fma_f32 v[4:5], v[36:37], v[128:129], v[4:5] op_sel:[0,1,0] neg_lo:[1,0,0] neg_hi:[1,0,0]
    v_pk_fma_f32 v[6:7], v[32:33], v[128:129], v[6:7] op_sel:[0,1,0]
    v_pk_fma_f32 v[8:9], v[4:5], v[128:129], v[40:41] op_sel_hi:[1,0,1]
    v_pk_fma_f32 v[10:11], v[6:7], v[128:129], v[44:45] op_sel_hi:[1,0,1]
    v_pk_fma_f32 v[8:9], v[6:7], v[128:129], v[8:9] op_sel:[0,1,0] neg_lo:[1,0,0] neg_hi:[1,0,0]
    v_pk_fma_f32 v[10:11], v[4:5], v[128:129], v[10:11] op_sel:[0,1,0]
    v_pk_fma_f32 v[4:5], v[8:9], v[128:129], v[42:43] op_sel_hi:[1,0,1]
    v_pk_fma_f32 v[6:7], v[10:11], v[128:129], v[46:47] op_sel_hi:[1,0,1]
    v_pk_fma_f32 v[4:5], v[10:11], v[128:129], v[4:5] op_sel:[0,1,0] neg_lo:[1,0,0] neg_hi:[1,0,0]
    v_pk_fma_f32 v[6:7], v[8:9], v[128:129], v[6:7] op_sel:[0,1,0]
    v_pk_fma_f32 v[8:9], v[4:5], v[128:129], v[48:49] op_sel_hi:[1,0,1]
    v_pk_fma_f32 v[10:11], v[6:7], v[128:129], v[52:53] op_sel_hi:[1,0,1]
    v_pk_fma_f32 v[8:9], v[6:7], v[128:129], v[8:9] op_sel:[0,1,0] neg_lo:[1,0,0] neg_hi:[1,0,0]
    v_pk_fma_f32 v[10:11], v[4:5], v[128:129], v[10:11] op_sel:[0,1,0]
    v_pk_fma_f32 v[4:5], v[8:9], v[128:129], v[50:51] op_sel_hi:[1,0,1]
    v_pk_fma_f32 v[6:7], v[10:11], v[128:129], v[54:55] op_sel_hi:[1,0,1]
    v_pk_fma_f32 v[4:5], v[10:11], v[128:129], v[4:5] op_sel:[0,1,0] neg_lo:[1,0,0] neg_hi:[1,0,0]
    v_pk_fma_f32 v[6:7], v[8:9], v[128:129], v[6:7] op_sel:[0,1,0]
    v_pk_fma_f32 v[8:9], v[4:5], v[128:129], v[56:57] op_sel_hi:[1,0,1]
    v_pk_fma_f32 v[10:11], v[6:7], v[128:129], v[60:61] op_sel_hi:[1,0,1]
    v_pk_fma_f32 v[8:9], v[6:7], v[128:129], v[8:9] op_sel:[0,1,0] neg_lo:[1,0,0] neg_hi:[1,0,0]
    v_pk_fma_f32 v[10:11], v[4:5], v[128:129], v[10:11] op_sel:[0,1,0]
    v_pk_fma_f32 v[4:5], v[8:9], v[128:129], v[58:59] op_sel_hi:[1,0,1]
    v_pk_fma_f32 v[6:7], v[10:11], v[128:129], v[62:63] op_sel_hi:[1,0,1]
    v_pk_fma_f32 v[4:5], v[10:11], v[128:129], v[4:5] op_sel:[0,1,0] neg_lo:[1,0,0] neg_hi:[1,0,0]
    v_pk_fma_f32 v[6:7], v[8:9], v[128:129], v[6:7] op_sel:[0,1,0]
    v_pk_fma_f32 v[8:9], v[4:5], v[128:129], v[64:65] op_sel_hi:[1,0,1]
    v_pk_fma_f32 v[10:11], v[6:7], v[128:129], v[68:69] op_sel_hi:[1,0,1]
    v_pk_fma_f32 v[8:9], v[6:7], v[128:129], v[8:9] op_sel:[0,1,0] neg_lo:[1,0,0] neg_hi:[1,0,0]
    v_pk_fma_f32 v[10:11], v[4:5], v[128:129], v[10:11] op_sel:[0,1,0]
    v_pk_fma_f32 v[4:5], v[8:9], v[128:129], v[66:67] op_sel_hi:[1,0,1]
    v_pk_fma_f32 v[6:7], v[10:11], v[128:129], v[70:71] op_sel_hi:[1,0,1]
    v_pk_fma_f32 v[4:5], v[10:11], v[128:129], v[4:5] op_sel:[0,1,0] neg_lo:[1,0,0] neg_hi:[1,0,0]
    v_pk_fma_f32 v[6:7], v[8:9], v[128:129], v[6:7] op_sel:[0,1,0]
    v_pk_fma_f32 v[8:9], v[4:5], v[128:129], v[72:73] op_sel_hi:[1,0,1]
    v_pk_fma_f32 v[10:11], v[6:7], v[128:129], v[76:77] op_sel_hi:[1,0,1]
    v_pk_fma_f32 v[8:9], v[6:7], v[128:129], v[8:9] op_sel:[0,1,0] neg_lo:[1,0,0] neg_hi:[1,0,0]
    v_pk_fma_f32 v[10:11], v[4:5], v[128:129], v[10:11] op_sel:[0,1,0]
    v_pk_fma_f32 v[4:5], v[8:9], v[128:129], v[74:75] op_sel_hi:[1,0,1]
    v_pk_fma_f32 v[6:7], v[10:11], v[128:129], v[78:79] op_sel_hi:[1,0,1]
    v_pk_fma_f32 v[4:5], v[10:11], v[128:129], v[4:5] op_sel:[0,1,0] neg_lo:[1,0,0] neg_hi:[1,0,0]
    v_pk_fma_f32 v[6:7], v[8:9], v[128:129], v[6:7] op_sel:[0,1,0]
    v_pk_fma_f32 v[8:9], v[4:5], v[128:129], v[80:81] op_sel_hi:[1,0,1]
    v_pk_fma_f32 v[10:11], v[6:7], v[128:129], v[84:85] op_sel_hi:[1,0,1]
    v_pk_fma_f32 v[8:9], v[6:7], v[128:129], v[8:9] op_sel:[0,1,0] neg_lo:[1,0,0] neg_hi:[1,0,0]
    v_pk_fma_f32 v[10:11], v[4:5], v[128:129], v[10:11] op_sel:[0,1,0]
    v_pk_fma_f32 v[4:5], v[8:9], v[128:129], v[82:83] op_sel_hi:[1,0,1]
    v_pk_fma_f32 v[6:7], v[10:11], v[128:129], v[86:87] op_sel_hi:[1,0,1]
    v_pk_fma_f32 v[4:5], v[10:11], v[128:129], v[4:5] op_sel:[0,1,0] neg_lo:[1,0,0] neg_hi:[1,0,0]
    v_pk_fma_f32 v[6:7], v[8:9], v[128:129], v[6:7] op_sel:[0,1,0]
    v_pk_fma_f32 v[8:9], v[4:5], v[128:129], v[88:89] op_sel_hi:[1,0,1]
    v_pk_fma_f32 v[10:11], v[6:7], v[128:129], v[92:93] op_sel_hi:[1,0,1]
    v_pk_fma_f32 v[8:9], v[6:7], v[128:129], v[8:9] op_sel:[0,1,0] neg_lo:[1,0,0] neg_hi:[1,0,0]
    v_pk_fma_f32 v[10:11], v[4:5], v[128:129], v[10:11] op_sel:[0,1,0]
    v_pk_fma_f32 v[4:5], v[8:9], v[128:129], v[90:91] op_sel_hi:[1,0,1]
    v_pk_fma_f32 v[6:7], v[10:11], v[128:129], v[94:95] op_sel_hi:[1,0,1]
    v_pk_fma_f32 v[4:5], v[10:11], v[128:129], v[4:5] op_sel:[0,1,0] neg_lo:[1,0,0] neg_hi:[1,0,0]
    v_pk_fma_f32 v[6:7], v[8:9], v[128:129], v[6:7] op_sel:[0,1,0]
    v_pk_mul_f32 v[142:143], v[4:5], v[130:131] op_sel_hi:[1,0]
    v_pk_mul_f32 v[144:145], v[6:7], v[130:131] op_sel_hi:[1,0]
    v_pk_fma_f32 v[142:143], v[6:7], v[130:131], v[142:143] op_sel:[0,1,0] neg_lo:[1,0,0] neg_hi:[1,0,0]
    v_pk_fma_f32 v[144:145], v[4:5], v[130:131], v[144:145] op_sel:[0,1,0]
    s_waitcnt lgkmcnt(12)
    s_nop 0
    v_fma_f32 v4, v142, v132, v143
    v_fma_f32 v8, v142, v133, v145
    v_mfma_f32_16x16x32_bf16 v[224:227], a[32:35], a[0:3], 0
    v_fma_f32 v4, -v144, v133, v4
    v_fma_f32 v8, v144, v132, v8
    v_mfma_f32_16x16x32_bf16 v[228:231], a[32:35], a[4:7], 0
    v_mov_b32_e64 v6, v4
    v_mfma_f32_16x16x32_bf16 v[224:227], a[36:39], a[8:11], v[224:227]
    v_mov_b32 v10, v8
    v_permlane32_swap_b32 v4, v6
    v_mfma_f32_16x16x32_bf16 v[228:231], a[36:39], a[12:15], v[228:231]
    v_permlane32_swap_b32 v8, v10
    v_mfma_f32_16x16x32_bf16 v[224:227], a[40:43], a[16:19], v[224:227]
    v_mov_b32 v5, v4
    v_mov_b32_e64 v7, v6
    v_mfma_f32_16x16x32_bf16 v[228:231], a[40:43], a[20:23], v[228:231]
    v_mov_b32_e64 v9, v8
    v_mfma_f32_16x16x32_bf16 v[224:227], a[44:47], a[24:27], v[224:227]
    v_mov_b32 v11, v10
    v_permlane16_swap_b32 v4, v5
    v_mfma_f32_16x16x32_bf16 v[228:231], a[44:47], a[28:31], v[228:231]
    v_permlane16_swap_b32 v6, v7
    s_waitcnt lgkmcnt(8)
    v_permlane16_swap_b32 v8, v9
    v_permlane16_swap_b32 v10, v11
    v_mfma_f32_16x16x32_bf16 v[232:235], a[48:51], a[0:3], 0
    v_fma_f32 v12, v4, v134, v5
    v_mfma_f32_16x16x32_bf16 v[236:239], a[48:51], a[4:7], 0
    v_fma_f32 v13, v4, v135, v9
    v_fma_f32 v12, -v8, v135, v12
    v_mfma_f32_16x16x32_bf16 v[232:235], a[52:55], a[8:11], v[232:235]
    v_fma_f32 v13, v8, v134, v13
    v_mfma_f32_16x16x32_bf16 v[236:239], a[52:55], a[12:15], v[236:239]
    v_fma_f32 v14, v12, v134, v6
    v_fma_f32 v15, v12, v135, v10
    v_mfma_f32_16x16x32_bf16 v[232:235], a[56:59], a[16:19], v[232:235]
    v_fma_f32 v14, -v13, v135, v14
    v_mfma_f32_16x16x32_bf16 v[236:239], a[56:59], a[20:23], v[236:239]
    v_fma_f32 v15, v13, v134, v15
    v_fma_f32 v220, v14, v134, v7
    v_mfma_f32_16x16x32_bf16 v[232:235], a[60:63], a[24:27], v[232:235]
    v_fma_f32 v221, v14, v135, v11
    v_mfma_f32_16x16x32_bf16 v[236:239], a[60:63], a[28:31], v[236:239]
    v_fma_f32 v220, -v15, v135, v220
    v_fma_f32 v221, v15, v134, v221
    s_waitcnt lgkmcnt(4)
    v_mov_b32 v222, s35
    v_mov_b32_e64 v223, s35
    v_mfma_f32_16x16x32_bf16 v[240:243], a[64:67], a[0:3], 0
    s_lshl_b32 s38, s32, 10
    v_mfma_f32_16x16x32_bf16 v[244:247], a[64:67], a[4:7], 0
    s_add_u32 s38, s38, s93
    v_cmp_gt_u32_e64 vcc, 16, v0
    v_mfma_f32_16x16x32_bf16 v[240:243], a[68:71], a[8:11], v[240:243]
    s_nop 0
    v_cndmask_b32 v5, 2.0, v3, vcc
    v_mfma_f32_16x16x32_bf16 v[244:247], a[68:71], a[12:15], v[244:247]
    buffer_store_dwordx4 v[220:223], v5, s[24:27], s38 offen sc1
    v_cndmask_b32 v146, v4, 0, vcc
    v_mfma_f32_16x16x32_bf16 v[240:243], a[72:75], a[16:19], v[240:243]
    v_cndmask_b32 v147, v8, 0, vcc
    v_mfma_f32_16x16x32_bf16 v[244:247], a[72:75], a[20:23], v[244:247]
    v_cmp_eq_u32 vcc, 2, v2
    s_nop 1
    v_cndmask_b32_e64 v146, v146, v12, vcc
    v_mfma_f32_16x16x32_bf16 v[240:243], a[76:79], a[24:27], v[240:243]
    v_cndmask_b32_e64 v147, v147, v13, vcc
    v_mfma_f32_16x16x32_bf16 v[244:247], a[76:79], a[28:31], v[244:247]
    v_cmp_eq_u32 vcc, 3, v2
    s_nop 1
    v_cndmask_b32 v146, v146, v14, vcc
    s_waitcnt lgkmcnt(0)
    v_cndmask_b32_e64 v147, v147, v15, vcc
    v_mfma_f32_16x16x32_bf16 v[248:251], a[80:83], a[0:3], 0
    v_lshlrev_b32 v12, 2, v2
    v_sub_u32 v12, s32, v12
    v_mfma_f32_16x16x32_bf16 v[252:255], a[80:83], a[4:7], 0
    v_lshlrev_b32_e64 v12, 10, v12
    v_mfma_f32_16x16x32_bf16 v[248:251], a[84:87], a[8:11], v[248:251]
    v_lshl_add_u32 v12, v1, 4, v12
    v_subrev_u32 v148, 1024, v12
    v_mfma_f32_16x16x32_bf16 v[252:255], a[84:87], a[12:15], v[252:255]
    v_min_u32_e64 v148, 2.0, v148
    v_mfma_f32_16x16x32_bf16 v[248:251], a[88:91], a[16:19], v[248:251]
    v_subrev_u32 v149, 2048, v12
    v_min_u32_e64 v149, 2.0, v149
    v_mfma_f32_16x16x32_bf16 v[252:255], a[88:91], a[20:23], v[252:255]
    v_subrev_u32 v150, 3072, v12
    v_mfma_f32_16x16x32_bf16 v[248:251], a[92:95], a[24:27], v[248:251]
    v_min_u32_e64 v150, 2.0, v150
    v_subrev_u32 v151, 4096, v12
    v_mfma_f32_16x16x32_bf16 v[252:255], a[92:95], a[28:31], v[252:255]
    v_min_u32_e64 v151, 2.0, v151
    v_pk_mul_f32 v[4:5], v[224:225], v[96:97] op_sel_hi:[1,0]
    s_bfe_u32 s72, s97, 262144
    v_pk_mul_f32 v[6:7], v[228:229], v[96:97] op_sel_hi:[1,0]
    v_pk_fma_f32 v[4:5], v[228:229], v[96:97], v[4:5] op_sel:[0,1,0]
    v_pk_fma_f32 v[6:7], v[224:225], v[96:97], v[6:7] op_sel:[0,1,0] neg_lo:[1,0,0] neg_hi:[1,0,0]
    v_pk_mul_f32 v[8:9], v[226:227], v[98:99] op_sel_hi:[1,0]
    v_pk_mul_f32 v[10:11], v[230:231], v[98:99] op_sel_hi:[1,0]
    v_pk_fma_f32 v[8:9], v[230:231], v[98:99], v[8:9] op_sel:[0,1,0]
    s_add_u32 m0, s37, 0
    s_nop 0
    v_pk_fma_f32 v[10:11], v[226:227], v[98:99], v[10:11] op_sel:[0,1,0] neg_lo:[1,0,0] neg_hi:[1,0,0]
    v_cvt_pk_bf16_f32 v184, v4, v6
    v_cvt_pk_bf16_f32 v192, v5, v7
    v_cvt_pk_bf16_f32 v188, v8, v10
    v_cvt_pk_bf16_f32 v196, v9, v11
    v_pk_mul_f32 v[4:5], v[232:233], v[100:101] op_sel_hi:[1,0]
    v_pk_mul_f32 v[6:7], v[236:237], v[100:101] op_sel_hi:[1,0]
    s_lshl_b32 s72, s72, 7
    s_nop 0
    v_pk_fma_f32 v[4:5], v[236:237], v[100:101], v[4:5] op_sel:[0,1,0]
    v_pk_fma_f32 v[6:7], v[232:233], v[100:101], v[6:7] op_sel:[0,1,0] neg_lo:[1,0,0] neg_hi:[1,0,0]
    v_pk_mul_f32 v[8:9], v[234:235], v[102:103] op_sel_hi:[1,0]
    v_pk_mul_f32 v[10:11], v[238:239], v[102:103] op_sel_hi:[1,0]
    v_pk_fma_f32 v[8:9], v[238:239], v[102:103], v[8:9] op_sel:[0,1,0]
    v_pk_fma_f32 v[10:11], v[234:235], v[102:103], v[10:11] op_sel:[0,1,0] neg_lo:[1,0,0] neg_hi:[1,0,0]
    v_cvt_pk_bf16_f32 v185, v4, v6
    buffer_load_dwordx4 v16, s[16:19], s72 offen offset:0  lds
    v_cvt_pk_bf16_f32 v193, v5, v7
    v_cvt_pk_bf16_f32 v189, v8, v10
    v_cvt_pk_bf16_f32 v197, v9, v11
    v_pk_mul_f32 v[4:5], v[240:241], v[104:105] op_sel_hi:[1,0]
    v_pk_mul_f32 v[6:7], v[244:245], v[104:105] op_sel_hi:[1,0]
    v_pk_fma_f32 v[4:5], v[244:245], v[104:105], v[4:5] op_sel:[0,1,0]
    v_pk_fma_f32 v[6:7], v[240:241], v[104:105], v[6:7] op_sel:[0,1,0] neg_lo:[1,0,0] neg_hi:[1,0,0]
    buffer_load_dwordx4 v17, s[16:19], s72 offen offset:1024  lds
    v_pk_mul_f32 v[8:9], v[242:243], v[106:107] op_sel_hi:[1,0]
    v_pk_mul_f32 v[10:11], v[246:247], v[106:107] op_sel_hi:[1,0]
    v_pk_fma_f32 v[8:9], v[246:247], v[106:107], v[8:9] op_sel:[0,1,0]
    v_pk_fma_f32 v[10:11], v[242:243], v[106:107], v[10:11] op_sel:[0,1,0] neg_lo:[1,0,0] neg_hi:[1,0,0]
    v_cvt_pk_bf16_f32 v186, v4, v6
    v_cvt_pk_bf16_f32 v194, v5, v7
    v_cvt_pk_bf16_f32 v190, v8, v10
    buffer_load_dwordx4 v18, s[16:19], s72 offen offset:2048  lds
    v_cvt_pk_bf16_f32 v198, v9, v11
    v_pk_mul_f32 v[4:5], v[248:249], v[108:109] op_sel_hi:[1,0]
    v_pk_mul_f32 v[6:7], v[252:253], v[108:109] op_sel_hi:[1,0]
    v_pk_fma_f32 v[4:5], v[252:253], v[108:109], v[4:5] op_sel:[0,1,0]
    v_pk_fma_f32 v[6:7], v[248:249], v[108:109], v[6:7] op_sel:[0,1,0] neg_lo:[1,0,0] neg_hi:[1,0,0]
    v_pk_mul_f32 v[8:9], v[250:251], v[110:111] op_sel_hi:[1,0]
    v_pk_mul_f32 v[10:11], v[254:255], v[110:111] op_sel_hi:[1,0]
    buffer_load_dwordx4 v19, s[16:19], s72 offen offset:3072  lds
    v_pk_fma_f32 v[8:9], v[254:255], v[110:111], v[8:9] op_sel:[0,1,0]
    v_pk_fma_f32 v[10:11], v[250:251], v[110:111], v[10:11] op_sel:[0,1,0] neg_lo:[1,0,0] neg_hi:[1,0,0]
    v_cvt_pk_bf16_f32 v187, v4, v6
    v_cvt_pk_bf16_f32 v195, v5, v7
    v_cvt_pk_bf16_f32 v191, v8, v10
    v_cvt_pk_bf16_f32 v199, v9, v11
    v_mfma_f32_16x16x32_bf16 v[224:227], a[224:227], v[184:187], 0
    s_waitcnt vmcnt(13)
    v_lshlrev_b32 v152, 16, v200
    v_and_b32 v160, 0xffff0000, v200
    v_mfma_f32_16x16x32_bf16 v[228:231], a[228:231], v[184:187], 0
    v_lshlrev_b32_e64 v168, 16, v201
    v_and_b32 v176, 0xffff0000, v201
    v_mfma_f32_16x16x32_bf16 v[232:235], a[248:251], v[188:191], 0
    v_lshlrev_b32_e64 v153, 16, v202
    v_and_b32 v161, 0xffff0000, v202
    v_mfma_f32_16x16x32_bf16 v[236:239], a[252:255], v[188:191], 0
    v_lshlrev_b32_e64 v169, 16, v203
    v_and_b32 v177, 0xffff0000, v203
    v_mfma_f32_16x16x32_bf16 v[240:243], a[224:227], v[192:195], 0
    v_lshlrev_b32_e64 v154, 16, v204
    v_and_b32 v162, 0xffff0000, v204
    v_mfma_f32_16x16x32_bf16 v[244:247], a[228:231], v[192:195], 0
    v_lshlrev_b32_e64 v170, 16, v205
    v_and_b32 v178, 0xffff0000, v205
    v_mfma_f32_16x16x32_bf16 v[248:251], a[248:251], v[196:199], 0
    v_lshlrev_b32_e64 v155, 16, v206
    v_and_b32 v163, 0xffff0000, v206
    v_mfma_f32_16x16x32_bf16 v[252:255], a[252:255], v[196:199], 0
    v_lshlrev_b32_e64 v171, 16, v207
    v_and_b32 v179, 0xffff0000, v207
    v_lshlrev_b32_e64 v156, 16, v208
    v_and_b32 v164, 0xffff0000, v208
    v_lshlrev_b32_e64 v172, 16, v209
    v_and_b32 v180, 0xffff0000, v209
    v_lshlrev_b32_e64 v157, 16, v210
    v_and_b32 v165, 0xffff0000, v210
    v_lshlrev_b32_e64 v173, 16, v211
    v_and_b32 v181, 0xffff0000, v211
    v_lshlrev_b32_e64 v158, 16, v212
    v_and_b32 v166, 0xffff0000, v212
    v_lshlrev_b32_e64 v174, 16, v213
    v_and_b32 v182, 0xffff0000, v213
    v_lshlrev_b32_e64 v159, 16, v214
    v_and_b32 v167, 0xffff0000, v214
    v_lshlrev_b32_e64 v175, 16, v215
    v_and_b32 v183, 0xffff0000, v215
    v_accvgpr_read_b32 v28, a222
    v_cmp_ne_u32 s[78:79], s96, v28
    s_nop 0
    s_cmp_eq_u64 s[78:79], 0
    s_cselect_b32 s50, 0, 2.0
    s_cselect_b32 s7, 2.0, 0
    v_pk_add_f32 v[224:225], v[224:225], v[232:233]
    v_pk_add_f32 v[226:227], v[226:227], v[234:235]
    v_pk_add_f32 v[228:229], v[228:229], v[236:237]
    v_pk_add_f32 v[230:231], v[230:231], v[238:239]
    v_pk_fma_f32 v[232:233], v[232:233], -2.0, v[224:225] op_sel_hi:[1,0,1]
    v_pk_fma_f32 v[234:235], v[234:235], -2.0, v[226:227] op_sel_hi:[1,0,1]
    v_pk_fma_f32 v[236:237], v[236:237], -2.0, v[228:229] op_sel_hi:[1,0,1]
    v_pk_fma_f32 v[238:239], v[238:239], -2.0, v[230:231] op_sel_hi:[1,0,1]
    v_pk_add_f32 v[240:241], v[240:241], v[248:249]
    v_pk_add_f32 v[242:243], v[242:243], v[250:251]
    v_pk_add_f32 v[244:245], v[244:245], v[252:253]
    v_pk_add_f32 v[246:247], v[246:247], v[254:255]
    v_pk_fma_f32 v[248:249], v[248:249], -2.0, v[240:241] op_sel_hi:[1,0,1]
    v_pk_fma_f32 v[250:251], v[250:251], -2.0, v[242:243] op_sel_hi:[1,0,1]
    v_pk_fma_f32 v[252:253], v[252:253], -2.0, v[244:245] op_sel_hi:[1,0,1]
    v_pk_fma_f32 v[254:255], v[254:255], -2.0, v[246:247] op_sel_hi:[1,0,1]
    s_cmp_eq_u32 s2, 0
    s_cbranch_scc1 K_SPECIAL
K_SPECIAL_RET:
    v_pk_fma_f32 v[4:5], v[224:225], s[42:43], v[244:245] op_sel_hi:[1,0,1]
    v_pk_fma_f32 v[6:7], v[228:229], s[42:43], v[240:241] op_sel_hi:[1,0,1] neg_lo:[0,0,1] neg_hi:[0,0,1]
    v_pk_fma_f32 v[8:9], v[240:241], s[42:43], v[228:229] op_sel_hi:[1,0,1]
    v_pk_fma_f32 v[10:11], v[244:245], s[42:43], v[224:225] op_sel_hi:[1,0,1] neg_lo:[0,0,1] neg_hi:[0,0,1]
    v_pk_mul_f32 v[224:225], v[4:5], v[152:153]
    v_pk_mul_f32 v[228:229], v[6:7], v[152:153]
    v_pk_mul_f32 v[240:241], v[8:9], v[168:169]
    v_pk_mul_f32 v[244:245], v[10:11], v[168:169]
    v_pk_fma_f32 v[152:153], v[6:7], v[160:161], v[224:225] neg_lo:[1,0,0] neg_hi:[1,0,0]
    v_pk_fma_f32 v[160:161], v[4:5], v[160:161], v[228:229]
    v_pk_fma_f32 v[168:169], v[10:11], v[176:177], v[240:241]
    v_pk_fma_f32 v[176:177], v[8:9], v[176:177], v[244:245] neg_lo:[1,0,0] neg_hi:[1,0,0]
    v_pk_fma_f32 v[224:225], v[152:153], s[42:43], v[176:177] op_sel_hi:[1,0,1] neg_lo:[0,0,1] neg_hi:[0,0,1]
    v_pk_fma_f32 v[228:229], v[160:161], s[42:43], v[168:169] op_sel_hi:[1,0,1]
    v_pk_fma_f32 v[240:241], v[168:169], s[42:43], v[160:161] op_sel_hi:[1,0,1] neg_lo:[0,0,1] neg_hi:[0,0,1]
    v_pk_fma_f32 v[244:245], v[176:177], s[42:43], v[152:153] op_sel_hi:[1,0,1]
    v_pk_fma_f32 v[4:5], v[226:227], s[42:43], v[246:247] op_sel_hi:[1,0,1]
    v_pk_fma_f32 v[6:7], v[230:231], s[42:43], v[242:243] op_sel_hi:[1,0,1] neg_lo:[0,0,1] neg_hi:[0,0,1]
    v_pk_fma_f32 v[8:9], v[242:243], s[42:43], v[230:231] op_sel_hi:[1,0,1]
    v_pk_fma_f32 v[10:11], v[246:247], s[42:43], v[226:227] op_sel_hi:[1,0,1] neg_lo:[0,0,1] neg_hi:[0,0,1]
    v_pk_mul_f32 v[226:227], v[4:5], v[154:155]
    v_pk_mul_f32 v[230:231], v[6:7], v[154:155]
    v_pk_mul_f32 v[242:243], v[8:9], v[170:171]
    v_pk_mul_f32 v[246:247], v[10:11], v[170:171]
    v_pk_fma_f32 v[154:155], v[6:7], v[162:163], v[226:227] neg_lo:[1,0,0] neg_hi:[1,0,0]
    v_pk_fma_f32 v[162:163], v[4:5], v[162:163], v[230:231]
    v_pk_fma_f32 v[170:171], v[10:11], v[178:179], v[242:243]
    v_pk_fma_f32 v[178:179], v[8:9], v[178:179], v[246:247] neg_lo:[1,0,0] neg_hi:[1,0,0]
    v_pk_fma_f32 v[226:227], v[154:155], s[42:43], v[178:179] op_sel_hi:[1,0,1] neg_lo:[0,0,1] neg_hi:[0,0,1]
    v_pk_fma_f32 v[230:231], v[162:163], s[42:43], v[170:171] op_sel_hi:[1,0,1]
    v_pk_fma_f32 v[242:243], v[170:171], s[42:43], v[162:163] op_sel_hi:[1,0,1] neg_lo:[0,0,1] neg_hi:[0,0,1]
    buffer_load_dwordx4 v[96:99], v148, s[24:27], s93 offen sc1
    v_pk_fma_f32 v[246:247], v[178:179], s[42:43], v[154:155] op_sel_hi:[1,0,1]
    v_pk_fma_f32 v[4:5], v[232:233], s[42:43], v[252:253] op_sel_hi:[1,0,1]
    v_pk_fma_f32 v[6:7], v[236:237], s[42:43], v[248:249] op_sel_hi:[1,0,1] neg_lo:[0,0,1] neg_hi:[0,0,1]
    v_pk_fma_f32 v[8:9], v[248:249], s[42:43], v[236:237] op_sel_hi:[1,0,1]
    v_pk_fma_f32 v[10:11], v[252:253], s[42:43], v[232:233] op_sel_hi:[1,0,1] neg_lo:[0,0,1] neg_hi:[0,0,1]
    v_pk_mul_f32 v[232:233], v[4:5], v[156:157]
    v_pk_mul_f32 v[236:237], v[6:7], v[156:157]
    buffer_load_dwordx4 v[100:103], v149, s[24:27], s93 offen sc1
    v_pk_mul_f32 v[248:249], v[8:9], v[172:173]
    v_pk_mul_f32 v[252:253], v[10:11], v[172:173]
    v_pk_fma_f32 v[156:157], v[6:7], v[164:165], v[232:233] neg_lo:[1,0,0] neg_hi:[1,0,0]
    v_pk_fma_f32 v[164:165], v[4:5], v[164:165], v[236:237]
    v_pk_fma_f32 v[172:173], v[10:11], v[180:181], v[248:249]
    v_pk_fma_f32 v[180:181], v[8:9], v[180:181], v[252:253] neg_lo:[1,0,0] neg_hi:[1,0,0]
    v_pk_fma_f32 v[232:233], v[156:157], s[42:43], v[180:181] op_sel_hi:[1,0,1] neg_lo:[0,0,1] neg_hi:[0,0,1]
    v_pk_fma_f32 v[236:237], v[164:165], s[42:43], v[172:173] op_sel_hi:[1,0,1]
    buffer_load_dwordx4 v[104:107], v150, s[24:27], s93 offen sc1
    v_pk_fma_f32 v[248:249], v[172:173], s[42:43], v[164:165] op_sel_hi:[1,0,1] neg_lo:[0,0,1] neg_hi:[0,0,1]
    v_pk_fma_f32 v[252:253], v[180:181], s[42:43], v[156:157] op_sel_hi:[1,0,1]
    v_pk_fma_f32 v[4:5], v[234:235], s[42:43], v[254:255] op_sel_hi:[1,0,1]
    v_pk_fma_f32 v[6:7], v[238:239], s[42:43], v[250:251] op_sel_hi:[1,0,1] neg_lo:[0,0,1] neg_hi:[0,0,1]
    v_pk_fma_f32 v[8:9], v[250:251], s[42:43], v[238:239] op_sel_hi:[1,0,1]
    v_pk_fma_f32 v[10:11], v[254:255], s[42:43], v[234:235] op_sel_hi:[1,0,1] neg_lo:[0,0,1] neg_hi:[0,0,1]
    v_pk_mul_f32 v[234:235], v[4:5], v[158:159]
    v_pk_mul_f32 v[238:239], v[6:7], v[158:159]
    buffer_load_dwordx4 v[108:111], v151, s[24:27], s93 offen sc1
    v_pk_mul_f32 v[250:251], v[8:9], v[174:175]
    v_pk_mul_f32 v[254:255], v[10:11], v[174:175]
    v_pk_fma_f32 v[158:159], v[6:7], v[166:167], v[234:235] neg_lo:[1,0,0] neg_hi:[1,0,0]
    v_pk_fma_f32 v[166:167], v[4:5], v[166:167], v[238:239]
    v_pk_fma_f32 v[174:175], v[10:11], v[182:183], v[250:251]
    v_pk_fma_f32 v[182:183], v[8:9], v[182:183], v[254:255] neg_lo:[1,0,0] neg_hi:[1,0,0]
    v_pk_fma_f32 v[234:235], v[158:159], s[42:43], v[182:183] op_sel_hi:[1,0,1] neg_lo:[0,0,1] neg_hi:[0,0,1]
    v_pk_fma_f32 v[238:239], v[166:167], s[42:43], v[174:175] op_sel_hi:[1,0,1]
    v_pk_fma_f32 v[250:251], v[174:175], s[42:43], v[166:167] op_sel_hi:[1,0,1] neg_lo:[0,0,1] neg_hi:[0,0,1]
    v_pk_fma_f32 v[254:255], v[182:183], s[42:43], v[158:159] op_sel_hi:[1,0,1]
    s_cmp_eq_u32 s2, 0
    s_cbranch_scc1 K_SPECIAL2
K_SPECIAL2_RET:
    v_pk_add_f32 v[224:225], v[224:225], v[232:233]
    s_bfe_u32 s72, s97, 262156
    v_pk_add_f32 v[226:227], v[226:227], v[234:235]
    v_pk_add_f32 v[228:229], v[228:229], v[236:237]
    v_pk_add_f32 v[230:231], v[230:231], v[238:239]
    v_pk_fma_f32 v[232:233], v[232:233], -2.0, v[224:225] op_sel_hi:[1,0,1]
    s_add_u32 m0, s37, 49152
    v_pk_fma_f32 v[234:235], v[234:235], -2.0, v[226:227] op_sel_hi:[1,0,1]
    v_pk_fma_f32 v[236:237], v[236:237], -2.0, v[228:229] op_sel_hi:[1,0,1]
    v_pk_fma_f32 v[238:239], v[238:239], -2.0, v[230:231] op_sel_hi:[1,0,1]
    v_cvt_pk_bf16_f32 v184, v224, -v228
    v_cvt_pk_bf16_f32 v185, v225, -v229
    s_lshl_b32 s72, s72, 7
    s_nop 0
    v_cvt_pk_bf16_f32 v186, v226, -v230
    v_cvt_pk_bf16_f32 v187, v227, -v231
    v_cvt_pk_bf16_f32 v188, v232, -v236
    v_cvt_pk_bf16_f32 v189, v233, -v237
    buffer_load_dwordx4 v16, s[16:19], s72 offen offset:0  lds
    v_cvt_pk_bf16_f32 v190, v234, -v238
    v_cvt_pk_bf16_f32 v191, v235, -v239
    v_pk_add_f32 v[240:241], v[240:241], v[248:249]
    v_pk_add_f32 v[242:243], v[242:243], v[250:251]
    v_pk_add_f32 v[244:245], v[244:245], v[252:253]
    buffer_load_dwordx4 v17, s[16:19], s72 offen offset:1024  lds
    v_pk_add_f32 v[246:247], v[246:247], v[254:255]
    v_pk_fma_f32 v[248:249], v[248:249], -2.0, v[240:241] op_sel_hi:[1,0,1]
    v_pk_fma_f32 v[250:251], v[250:251], -2.0, v[242:243] op_sel_hi:[1,0,1]
    v_pk_fma_f32 v[252:253], v[252:253], -2.0, v[244:245] op_sel_hi:[1,0,1]
    buffer_load_dwordx4 v18, s[16:19], s72 offen offset:2048  lds
    v_pk_fma_f32 v[254:255], v[254:255], -2.0, v[246:247] op_sel_hi:[1,0,1]
    v_cvt_pk_bf16_f32 v192, v240, -v244
    v_cvt_pk_bf16_f32 v193, v241, -v245
    v_cvt_pk_bf16_f32 v194, v242, -v246
    v_cvt_pk_bf16_f32 v195, v243, -v247
    buffer_load_dwordx4 v19, s[16:19], s72 offen offset:3072  lds
    v_cvt_pk_bf16_f32 v196, v248, -v252
    v_cvt_pk_bf16_f32 v197, v249, -v253
    v_cvt_pk_bf16_f32 v198, v250, -v254
    v_cvt_pk_bf16_f32 v199, v251, -v255
    v_pk_mul_f32 v[4:5], v[36:37], v[130:131] op_sel:[0,1]
    s_bfe_u32 s72, s97, 262160
    v_pk_mul_f32 v[6:7], v[32:33], v[130:131] op_sel:[0,1]
    v_pk_fma_f32 v[32:33], v[32:33], v[130:131], v[4:5] op_sel_hi:[1,0,1] neg_lo:[0,0,1] neg_hi:[0,0,1]
    v_pk_fma_f32 v[36:37], v[36:37], v[130:131], v[6:7] op_sel_hi:[1,0,1]
    v_pk_mul_f32 v[8:9], v[38:39], v[130:131] op_sel:[0,1]
    s_add_u32 m0, s37, 65536
    v_pk_mul_f32 v[10:11], v[34:35], v[130:131] op_sel:[0,1]
    v_pk_fma_f32 v[34:35], v[34:35], v[130:131], v[8:9] op_sel_hi:[1,0,1] neg_lo:[0,0,1] neg_hi:[0,0,1]
    v_pk_fma_f32 v[38:39], v[38:39], v[130:131], v[10:11] op_sel_hi:[1,0,1]
    v_pk_mul_f32 v[4:5], v[44:45], v[130:131] op_sel:[0,1]
    v_pk_mul_f32 v[6:7], v[40:41], v[130:131] op_sel:[0,1]
    s_lshl_b32 s72, s72, 7
    s_nop 0
    v_pk_fma_f32 v[40:41], v[40:41], v[130:131], v[4:5] op_sel_hi:[1,0,1] neg_lo:[0,0,1] neg_hi:[0,0,1]
    v_pk_fma_f32 v[44:45], v[44:45], v[130:131], v[6:7] op_sel_hi:[1,0,1]
    v_pk_mul_f32 v[8:9], v[46:47], v[130:131] op_sel:[0,1]
    v_pk_mul_f32 v[10:11], v[42:43], v[130:131] op_sel:[0,1]
    buffer_load_dwordx4 v16, s[16:19], s72 offen offset:0  lds
    v_pk_fma_f32 v[42:43], v[42:43], v[130:131], v[8:9] op_sel_hi:[1,0,1] neg_lo:[0,0,1] neg_hi:[0,0,1]
    v_pk_fma_f32 v[46:47], v[46:47], v[130:131], v[10:11] op_sel_hi:[1,0,1]
    v_pk_mul_f32 v[4:5], v[52:53], v[130:131] op_sel:[0,1]
    v_pk_mul_f32 v[6:7], v[48:49], v[130:131] op_sel:[0,1]
    v_pk_fma_f32 v[48:49], v[48:49], v[130:131], v[4:5] op_sel_hi:[1,0,1] neg_lo:[0,0,1] neg_hi:[0,0,1]
    buffer_load_dwordx4 v17, s[16:19], s72 offen offset:1024  lds
    v_pk_fma_f32 v[52:53], v[52:53], v[130:131], v[6:7] op_sel_hi:[1,0,1]
    v_pk_mul_f32 v[8:9], v[54:55], v[130:131] op_sel:[0,1]
    v_pk_mul_f32 v[10:11], v[50:51], v[130:131] op_sel:[0,1]
    v_pk_fma_f32 v[50:51], v[50:51], v[130:131], v[8:9] op_sel_hi:[1,0,1] neg_lo:[0,0,1] neg_hi:[0,0,1]
    buffer_load_dwordx4 v18, s[16:19], s72 offen offset:2048  lds
    v_pk_fma_f32 v[54:55], v[54:55], v[130:131], v[10:11] op_sel_hi:[1,0,1]
    v_pk_mul_f32 v[4:5], v[60:61], v[130:131] op_sel:[0,1]
    v_pk_mul_f32 v[6:7], v[56:57], v[130:131] op_sel:[0,1]
    v_pk_fma_f32 v[56:57], v[56:57], v[130:131], v[4:5] op_sel_hi:[1,0,1] neg_lo:[0,0,1] neg_hi:[0,0,1]
    v_pk_fma_f32 v[60:61], v[60:61], v[130:131], v[6:7] op_sel_hi:[1,0,1]
    buffer_load_dwordx4 v19, s[16:19], s72 offen offset:3072  lds
    v_pk_mul_f32 v[8:9], v[62:63], v[130:131] op_sel:[0,1]
    v_pk_mul_f32 v[10:11], v[58:59], v[130:131] op_sel:[0,1]
    v_pk_fma_f32 v[58:59], v[58:59], v[130:131], v[8:9] op_sel_hi:[1,0,1] neg_lo:[0,0,1] neg_hi:[0,0,1]
    v_pk_fma_f32 v[62:63], v[62:63], v[130:131], v[10:11] op_sel_hi:[1,0,1]
    v_pk_mul_f32 v[4:5], v[68:69], v[130:131] op_sel:[0,1]
    s_bfe_u32 s72, s97, 262164
    v_pk_mul_f32 v[6:7], v[64:65], v[130:131] op_sel:[0,1]
    v_pk_fma_f32 v[64:65], v[64:65], v[130:131], v[4:5] op_sel_hi:[1,0,1] neg_lo:[0,0,1] neg_hi:[0,0,1]
    v_pk_fma_f32 v[68:69], v[68:69], v[130:131], v[6:7] op_sel_hi:[1,0,1]
    v_pk_mul_f32 v[8:9], v[70:71], v[130:131] op_sel:[0,1]
    s_add_u32 m0, s37, 81920
    v_pk_mul_f32 v[10:11], v[66:67], v[130:131] op_sel:[0,1]
    v_pk_fma_f32 v[66:67], v[66:67], v[130:131], v[8:9] op_sel_hi:[1,0,1] neg_lo:[0,0,1] neg_hi:[0,0,1]
    v_pk_fma_f32 v[70:71], v[70:71], v[130:131], v[10:11] op_sel_hi:[1,0,1]
    v_pk_mul_f32 v[4:5], v[76:77], v[130:131] op_sel:[0,1]
    v_pk_mul_f32 v[6:7], v[72:73], v[130:131] op_sel:[0,1]
    s_lshl_b32 s72, s72, 7
    s_nop 0
    v_pk_fma_f32 v[72:73], v[72:73], v[130:131], v[4:5] op_sel_hi:[1,0,1] neg_lo:[0,0,1] neg_hi:[0,0,1]
    v_pk_fma_f32 v[76:77], v[76:77], v[130:131], v[6:7] op_sel_hi:[1,0,1]
    v_pk_mul_f32 v[8:9], v[78:79], v[130:131] op_sel:[0,1]
    v_pk_mul_f32 v[10:11], v[74:75], v[130:131] op_sel:[0,1]
    buffer_load_dwordx4 v16, s[16:19], s72 offen offset:0  lds
    v_pk_fma_f32 v[74:75], v[74:75], v[130:131], v[8:9] op_sel_hi:[1,0,1] neg_lo:[0,0,1] neg_hi:[0,0,1]
    v_pk_fma_f32 v[78:79], v[78:79], v[130:131], v[10:11] op_sel_hi:[1,0,1]
    v_pk_mul_f32 v[4:5], v[84:85], v[130:131] op_sel:[0,1]
    v_pk_mul_f32 v[6:7], v[80:81], v[130:131] op_sel:[0,1]
    v_pk_fma_f32 v[80:81], v[80:81], v[130:131], v[4:5] op_sel_hi:[1,0,1] neg_lo:[0,0,1] neg_hi:[0,0,1]
    buffer_load_dwordx4 v17, s[16:19], s72 offen offset:1024  lds
    v_pk_fma_f32 v[84:85], v[84:85], v[130:131], v[6:7] op_sel_hi:[1,0,1]
    v_pk_mul_f32 v[8:9], v[86:87], v[130:131] op_sel:[0,1]
    v_pk_mul_f32 v[10:11], v[82:83], v[130:131] op_sel:[0,1]
    v_pk_fma_f32 v[82:83], v[82:83], v[130:131], v[8:9] op_sel_hi:[1,0,1] neg_lo:[0,0,1] neg_hi:[0,0,1]
    buffer_load_dwordx4 v18, s[16:19], s72 offen offset:2048  lds
    v_pk_fma_f32 v[86:87], v[86:87], v[130:131], v[10:11] op_sel_hi:[1,0,1]
    v_pk_mul_f32 v[4:5], v[92:93], v[130:131] op_sel:[0,1]
    v_pk_mul_f32 v[6:7], v[88:89], v[130:131] op_sel:[0,1]
    v_pk_fma_f32 v[88:89], v[88:89], v[130:131], v[4:5] op_sel_hi:[1,0,1] neg_lo:[0,0,1] neg_hi:[0,0,1]
    v_pk_fma_f32 v[92:93], v[92:93], v[130:131], v[6:7] op_sel_hi:[1,0,1]
    buffer_load_dwordx4 v19, s[16:19], s72 offen offset:3072  lds
    v_pk_mul_f32 v[8:9], v[94:95], v[130:131] op_sel:[0,1]
    v_pk_mul_f32 v[10:11], v[90:91], v[130:131] op_sel:[0,1]
    v_pk_fma_f32 v[90:91], v[90:91], v[130:131], v[8:9] op_sel_hi:[1,0,1] neg_lo:[0,0,1] neg_hi:[0,0,1]
    v_pk_fma_f32 v[94:95], v[94:95], v[130:131], v[10:11] op_sel_hi:[1,0,1]
    v_and_b32 v14, 8, v1
    v_and_b32 v15, 3, v1
    v_lshl_or_b32 v14, v15, 1, v14
    v_bfe_u32 v15, v1, 2, 1
    v_lshlrev_b32 v13, 2, v2
    v_or_b32 v14, v14, v15
    v_xor_b32_e64 v14, v14, v13
    v_lshl_add_u32 v14, v1, 4, v14
    s_lshl1_add_u32 s38, s37, 131072
    v_lshl_add_u32 v216, v14, 4, s38
    v_xor_b32 v217, 16, v216
    v_xor_b32 v218, 32, v216
    v_xor_b32 v219, 48, v216
    v_and_b32 v14, 1, v2
    v_lshrrev_b32_e64 v15, 2, v1
    v_lshl_add_u32 v12, v2, 3, v15
    v_lshlrev_b32_e64 v14, 3, v14
    v_lshl_or_b32 v14, v15, 1, v14
    v_bfe_u32 v15, v1, 1, 1
    v_xor_b32_e64 v14, v14, v15
    v_lshl_add_u32 v12, v12, 4, v14
    v_and_b32_e64 v15, 1, v1
    v_lshl_add_u32 v12, v12, 1, v15
    s_lshl_b32 s38, s94, 5
    s_add_u32 s38, s38, 131072
    v_lshlrev_b32 v12, 3, v12
    v_xor_b32 v220, s38, v12
    v_xor_b32 v221, 16, v220
    v_xor_b32_e64 v222, 64, v220
    v_xor_b32 v223, 80, v220
    s_waitcnt vmcnt(12)
    v_cmp_ne_u32 vcc, 2.0, v148
    v_xor_b32 v4, s35, v98
    s_nop 0
    v_cndmask_b32 v4, 0, v4, vcc
    v_cmp_ne_u32 vcc, 2.0, v149
    v_xor_b32 v5, s35, v102
    s_nop 0
    v_cndmask_b32 v5, 0, v5, vcc
    v_cmp_ne_u32 vcc, 2.0, v150
    v_xor_b32 v6, s35, v106
    s_nop 0
    v_cndmask_b32 v6, 0, v6, vcc
    v_cmp_ne_u32 vcc, 2.0, v151
    v_xor_b32 v7, s35, v110
    s_nop 0
    v_cndmask_b32_e64 v7, 0, v7, vcc
    v_or3_b32 v4, v4, v5, v6
    v_or_b32 v4, v4, v7
    v_cmp_ne_u32 vcc, 0, v4
    s_nop 0
    s_cbranch_vccnz K_POLL2
K_POLL2_OK:
    buffer_load_dword a223, v29, s[16:19], s92 offen
    v_fma_f32 v4, v108, v136, v104
    v_fma_f32 v5, v108, v137, v105
    v_fma_f32 v4, -v109, v137, v4
    v_fma_f32 v5, v109, v136, v5
    v_fma_f32 v6, v4, v136, v100
    v_fma_f32 v7, v4, v137, v101
    v_fma_f32 v6, -v5, v137, v6
    v_fma_f32 v7, v5, v136, v7
    v_fma_f32 v4, v6, v136, v96
    v_fma_f32 v5, v6, v137, v97
    v_fma_f32 v4, -v7, v137, v4
    v_fma_f32 v5, v7, v136, v5
    v_mul_f32 v6, v4, v140
    v_mul_f32 v8, v4, v141
    v_fma_f32 v6, -v5, v141, v6
    v_fma_f32 v8, v5, v140, v8
    s_nop 1
    v_permlane32_swap_b32 v6, v8
    v_add_f32 v6, v6, v8
    v_mov_b32 v8, v6
    s_nop 1
    v_permlane16_swap_b32 v6, v8
    v_add_f32 v6, v6, v8
    v_mov_b32 v8, v6
    s_nop 1
    v_permlane32_swap_b32 v6, v8
    v_fma_f32 v10, v6, v138, v146
    v_fma_f32 v12, v6, v139, v147
    v_fma_f32 v10, -v8, v139, v10
    v_fma_f32 v12, v8, v138, v12
    v_fma_f32 v11, v10, v132, v142
    v_fma_f32 v13, v10, v133, v144
    v_fma_f32 v11, -v12, v133, v11
    v_fma_f32 v13, v12, v132, v13
    v_pk_fma_f32 v[32:33], v[10:11], v[128:129], v[32:33] op_sel_hi:[1,0,1]
    v_pk_fma_f32 v[36:37], v[12:13], v[128:129], v[36:37] op_sel_hi:[1,0,1]
    v_pk_fma_f32 v[32:33], v[12:13], v[128:129], v[32:33] op_sel:[0,1,0] neg_lo:[1,0,0] neg_hi:[1,0,0]
    v_pk_fma_f32 v[36:37], v[10:11], v[128:129], v[36:37] op_sel:[0,1,0]
    v_pk_fma_f32 v[34:35], v[32:33], v[128:129], v[34:35] op_sel_hi:[1,0,1]
    v_pk_fma_f32 v[38:39], v[36:37], v[128:129], v[38:39] op_sel_hi:[1,0,1]
    v_pk_fma_f32 v[34:35], v[36:37], v[128:129], v[34:35] op_sel:[0,1,0] neg_lo:[1,0,0] neg_hi:[1,0,0]
    v_pk_fma_f32 v[38:39], v[32:33], v[128:129], v[38:39] op_sel:[0,1,0]
    v_cvt_pk_bf16_f32 v224, v32, v34
    v_cvt_pk_bf16_f32 v232, v33, v35
    v_cvt_pk_bf16_f32 v240, -v36, -v38
    v_cvt_pk_bf16_f32 v248, -v37, -v39
    v_pk_fma_f32 v[40:41], v[34:35], v[128:129], v[40:41] op_sel_hi:[1,0,1]
    v_pk_fma_f32 v[44:45], v[38:39], v[128:129], v[44:45] op_sel_hi:[1,0,1]
    v_pk_fma_f32 v[40:41], v[38:39], v[128:129], v[40:41] op_sel:[0,1,0] neg_lo:[1,0,0] neg_hi:[1,0,0]
    v_pk_fma_f32 v[44:45], v[34:35], v[128:129], v[44:45] op_sel:[0,1,0]
    v_pk_fma_f32 v[42:43], v[40:41], v[128:129], v[42:43] op_sel_hi:[1,0,1]
    v_pk_fma_f32 v[46:47], v[44:45], v[128:129], v[46:47] op_sel_hi:[1,0,1]
    v_pk_fma_f32 v[42:43], v[44:45], v[128:129], v[42:43] op_sel:[0,1,0] neg_lo:[1,0,0] neg_hi:[1,0,0]
    v_pk_fma_f32 v[46:47], v[40:41], v[128:129], v[46:47] op_sel:[0,1,0]
    v_cvt_pk_bf16_f32 v225, v40, v42
    v_cvt_pk_bf16_f32 v233, v41, v43
    v_cvt_pk_bf16_f32 v241, -v44, -v46
    v_cvt_pk_bf16_f32 v249, -v45, -v47
    v_pk_fma_f32 v[48:49], v[42:43], v[128:129], v[48:49] op_sel_hi:[1,0,1]
    v_pk_fma_f32 v[52:53], v[46:47], v[128:129], v[52:53] op_sel_hi:[1,0,1]
    v_pk_fma_f32 v[48:49], v[46:47], v[128:129], v[48:49] op_sel:[0,1,0] neg_lo:[1,0,0] neg_hi:[1,0,0]
    v_pk_fma_f32 v[52:53], v[42:43], v[128:129], v[52:53] op_sel:[0,1,0]
    v_pk_fma_f32 v[50:51], v[48:49], v[128:129], v[50:51] op_sel_hi:[1,0,1]
    v_pk_fma_f32 v[54:55], v[52:53], v[128:129], v[54:55] op_sel_hi:[1,0,1]
    v_pk_fma_f32 v[50:51], v[52:53], v[128:129], v[50:51] op_sel:[0,1,0] neg_lo:[1,0,0] neg_hi:[1,0,0]
    v_pk_fma_f32 v[54:55], v[48:49], v[128:129], v[54:55] op_sel:[0,1,0]
    v_cvt_pk_bf16_f32 v226, v48, v50
    v_cvt_pk_bf16_f32 v234, v49, v51
    v_cvt_pk_bf16_f32 v242, -v52, -v54
    v_cvt_pk_bf16_f32 v250, -v53, -v55
    v_pk_fma_f32 v[56:57], v[50:51], v[128:129], v[56:57] op_sel_hi:[1,0,1]
    v_pk_fma_f32 v[60:61], v[54:55], v[128:129], v[60:61] op_sel_hi:[1,0,1]
    v_pk_fma_f32 v[56:57], v[54:55], v[128:129], v[56:57] op_sel:[0,1,0] neg_lo:[1,0,0] neg_hi:[1,0,0]
    v_pk_fma_f32 v[60:61], v[50:51], v[128:129], v[60:61] op_sel:[0,1,0]
    v_pk_fma_f32 v[58:59], v[56:57], v[128:129], v[58:59] op_sel_hi:[1,0,1]
    v_pk_fma_f32 v[62:63], v[60:61], v[128:129], v[62:63] op_sel_hi:[1,0,1]
    v_pk_fma_f32 v[58:59], v[60:61], v[128:129], v[58:59] op_sel:[0,1,0] neg_lo:[1,0,0] neg_hi:[1,0,0]
    v_pk_fma_f32 v[62:63], v[56:57], v[128:129], v[62:63] op_sel:[0,1,0]
    v_cvt_pk_bf16_f32 v227, v56, v58
    v_cvt_pk_bf16_f32 v235, v57, v59
    v_cvt_pk_bf16_f32 v243, -v60, -v62
    v_cvt_pk_bf16_f32 v251, -v61, -v63
    s_barrier
    s_nop 0
    ds_write_b128 v216, v[224:227] offset:0
    ds_write_b128 v218, v[232:235] offset:0
    ds_write_b128 v216, v[240:243] offset:4096
    ds_write_b128 v218, v[248:251] offset:4096
    v_pk_fma_f32 v[64:65], v[58:59], v[128:129], v[64:65] op_sel_hi:[1,0,1]
    v_pk_fma_f32 v[68:69], v[62:63], v[128:129], v[68:69] op_sel_hi:[1,0,1]
    v_pk_fma_f32 v[64:65], v[62:63], v[128:129], v[64:65] op_sel:[0,1,0] neg_lo:[1,0,0] neg_hi:[1,0,0]
    v_pk_fma_f32 v[68:69], v[58:59], v[128:129], v[68:69] op_sel:[0,1,0]
    v_pk_fma_f32 v[66:67], v[64:65], v[128:129], v[66:67] op_sel_hi:[1,0,1]
    v_pk_fma_f32 v[70:71], v[68:69], v[128:129], v[70:71] op_sel_hi:[1,0,1]
    v_pk_fma_f32 v[66:67], v[68:69], v[128:129], v[66:67] op_sel:[0,1,0] neg_lo:[1,0,0] neg_hi:[1,0,0]
    v_pk_fma_f32 v[70:71], v[64:65], v[128:129], v[70:71] op_sel:[0,1,0]
    v_cvt_pk_bf16_f32 v228, v64, v66
    v_cvt_pk_bf16_f32 v236, v65, v67
    v_cvt_pk_bf16_f32 v244, -v68, -v70
    v_cvt_pk_bf16_f32 v252, -v69, -v71
    v_pk_fma_f32 v[72:73], v[66:67], v[128:129], v[72:73] op_sel_hi:[1,0,1]
    v_pk_fma_f32 v[76:77], v[70:71], v[128:129], v[76:77] op_sel_hi:[1,0,1]
    v_pk_fma_f32 v[72:73], v[70:71], v[128:129], v[72:73] op_sel:[0,1,0] neg_lo:[1,0,0] neg_hi:[1,0,0]
    v_pk_fma_f32 v[76:77], v[66:67], v[128:129], v[76:77] op_sel:[0,1,0]
    v_pk_fma_f32 v[74:75], v[72:73], v[128:129], v[74:75] op_sel_hi:[1,0,1]
    v_pk_fma_f32 v[78:79], v[76:77], v[128:129], v[78:79] op_sel_hi:[1,0,1]
    v_pk_fma_f32 v[74:75], v[76:77], v[128:129], v[74:75] op_sel:[0,1,0] neg_lo:[1,0,0] neg_hi:[1,0,0]
    v_pk_fma_f32 v[78:79], v[72:73], v[128:129], v[78:79] op_sel:[0,1,0]
    v_cvt_pk_bf16_f32 v229, v72, v74
    v_cvt_pk_bf16_f32 v237, v73, v75
    v_cvt_pk_bf16_f32 v245, -v76, -v78
    v_cvt_pk_bf16_f32 v253, -v77, -v79
    v_pk_fma_f32 v[80:81], v[74:75], v[128:129], v[80:81] op_sel_hi:[1,0,1]
    v_pk_fma_f32 v[84:85], v[78:79], v[128:129], v[84:85] op_sel_hi:[1,0,1]
    v_pk_fma_f32 v[80:81], v[78:79], v[128:129], v[80:81] op_sel:[0,1,0] neg_lo:[1,0,0] neg_hi:[1,0,0]
    v_pk_fma_f32 v[84:85], v[74:75], v[128:129], v[84:85] op_sel:[0,1,0]
    v_pk_fma_f32 v[82:83], v[80:81], v[128:129], v[82:83] op_sel_hi:[1,0,1]
    v_pk_fma_f32 v[86:87], v[84:85], v[128:129], v[86:87] op_sel_hi:[1,0,1]
    v_pk_fma_f32 v[82:83], v[84:85], v[128:129], v[82:83] op_sel:[0,1,0] neg_lo:[1,0,0] neg_hi:[1,0,0]
    v_pk_fma_f32 v[86:87], v[80:81], v[128:129], v[86:87] op_sel:[0,1,0]
    v_cvt_pk_bf16_f32 v230, v80, v82
    v_cvt_pk_bf16_f32 v238, v81, v83
    v_cvt_pk_bf16_f32 v246, -v84, -v86
    v_cvt_pk_bf16_f32 v254, -v85, -v87
    v_pk_fma_f32 v[88:89], v[82:83], v[128:129], v[88:89] op_sel_hi:[1,0,1]
    v_pk_fma_f32 v[92:93], v[86:87], v[128:129], v[92:93] op_sel_hi:[1,0,1]
    v_pk_fma_f32 v[88:89], v[86:87], v[128:129], v[88:89] op_sel:[0,1,0] neg_lo:[1,0,0] neg_hi:[1,0,0]
    v_pk_fma_f32 v[92:93], v[82:83], v[128:129], v[92:93] op_sel:[0,1,0]
    v_pk_fma_f32 v[90:91], v[88:89], v[128:129], v[90:91] op_sel_hi:[1,0,1]
    v_pk_fma_f32 v[94:95], v[92:93], v[128:129], v[94:95] op_sel_hi:[1,0,1]
    v_pk_fma_f32 v[90:91], v[92:93], v[128:129], v[90:91] op_sel:[0,1,0] neg_lo:[1,0,0] neg_hi:[1,0,0]
    v_pk_fma_f32 v[94:95], v[88:89], v[128:129], v[94:95] op_sel:[0,1,0]
    v_cvt_pk_bf16_f32 v231, v88, v90
    v_cvt_pk_bf16_f32 v239, v89, v91
    v_cvt_pk_bf16_f32 v247, -v92, -v94
    v_cvt_pk_bf16_f32 v255, -v93, -v95
    ds_write_b128 v217, v[228:231] offset:0
    ds_write_b128 v219, v[236:239] offset:0
    ds_write_b128 v217, v[244:247] offset:4096
    ds_write_b128 v219, v[252:255] offset:4096
    v_mfma_f32_16x16x32_bf16 v[32:35], v[184:187], a[224:227], 0
    v_and_b32_e64 v12, 3, v1
    v_mul_u32_u24 v12, 4112, v12
    v_mfma_f32_16x16x32_bf16 v[36:39], v[184:187], a[228:231], 0
    v_and_b32_e64 v13, 60, v0
    v_mfma_f32_16x16x32_bf16 v[40:43], v[188:191], a[232:235], 0
    v_lshl_add_u32 v12, v13, 4, v12
    s_lshl_b32 s38, s34, 10
    v_mfma_f32_16x16x32_bf16 v[44:47], v[188:191], a[236:239], 0
    s_add_u32 s38, s38, 131072
    v_mfma_f32_16x16x32_bf16 v[48:51], v[192:195], a[224:227], 0
    v_add_u32 v12, s38, v12
    v_mfma_f32_16x16x32_bf16 v[52:55], v[192:195], a[228:231], 0
    v_add_u32 v13, 131072, v3
    s_lshl_b32 s68, s94, 16
    v_mfma_f32_16x16x32_bf16 v[56:59], v[196:199], a[232:235], 0
    s_add_u32 s68, s68, s5
    v_mfma_f32_16x16x32_bf16 v[60:63], v[196:199], a[236:239], 0
    s_add_u32 s69, s68, 0x20000
    s_waitcnt lgkmcnt(0)
    s_barrier
    ds_read_b64_tr_b16 v[64:65], v220 offset:0
    ds_read_b64_tr_b16 v[66:67], v221 offset:1024
    ds_read_b64_tr_b16 v[68:69], v220 offset:8192
    ds_read_b64_tr_b16 v[70:71], v221 offset:9216
    ds_read_b64_tr_b16 v[72:73], v220 offset:16384
    ds_read_b64_tr_b16 v[74:75], v221 offset:17408
    ds_read_b64_tr_b16 v[76:77], v220 offset:24576
    ds_read_b64_tr_b16 v[78:79], v221 offset:25600
    ds_read_b64_tr_b16 v[80:81], v222 offset:0
    ds_read_b64_tr_b16 v[82:83], v223 offset:1024
    ds_read_b64_tr_b16 v[84:85], v222 offset:8192
    ds_read_b64_tr_b16 v[86:87], v223 offset:9216
    ds_read_b64_tr_b16 v[88:89], v222 offset:16384
    ds_read_b64_tr_b16 v[90:91], v223 offset:17408
    ds_read_b64_tr_b16 v[92:93], v222 offset:24576
    ds_read_b64_tr_b16 v[94:95], v223 offset:25600
    v_pk_mul_f32 v[4:5], v[32:33], v[112:113]
    v_pk_mul_f32 v[6:7], v[36:37], v[112:113]
    v_pk_fma_f32 v[4:5], v[36:37], v[116:117], v[4:5]
    v_pk_fma_f32 v[6:7], v[32:33], v[116:117], v[6:7] neg_lo:[1,0,0] neg_hi:[1,0,0]
    v_pk_mul_f32 v[8:9], v[34:35], v[114:115]
    v_pk_mul_f32 v[10:11], v[38:39], v[114:115]
    v_pk_fma_f32 v[8:9], v[38:39], v[118:119], v[8:9]
    v_pk_fma_f32 v[10:11], v[34:35], v[118:119], v[10:11] neg_lo:[1,0,0] neg_hi:[1,0,0]
    v_cvt_pk_bf16_f32 v184, v4, v6
    v_cvt_pk_bf16_f32 v185, v5, v7
    v_cvt_pk_bf16_f32 v186, v8, v10
    v_cvt_pk_bf16_f32 v187, v9, v11
    s_waitcnt lgkmcnt(0)
    s_barrier
    s_cmp_lg_u32 s50, 0
    s_cbranch_scc1 K_HFAR
    ds_write_b128 v12, v[184:187] offset:0
    buffer_store_dwordx4 v[64:67], v24, s[28:31], s68 offen
    v_pk_mul_f32 v[4:5], v[40:41], v[120:121]
    v_pk_mul_f32 v[6:7], v[44:45], v[120:121]
    v_pk_fma_f32 v[4:5], v[44:45], v[124:125], v[4:5]
    v_pk_fma_f32 v[6:7], v[40:41], v[124:125], v[6:7] neg_lo:[1,0,0] neg_hi:[1,0,0]
    v_pk_mul_f32 v[8:9], v[42:43], v[122:123]
    buffer_store_dwordx4 v[68:71], v25, s[28:31], s68 offen
    v_pk_mul_f32 v[10:11], v[46:47], v[122:123]
    v_pk_fma_f32 v[8:9], v[46:47], v[126:127], v[8:9]
    v_pk_fma_f32 v[10:11], v[42:43], v[126:127], v[10:11] neg_lo:[1,0,0] neg_hi:[1,0,0]
    v_cvt_pk_bf16_f32 v188, v4, v6
    v_cvt_pk_bf16_f32 v189, v5, v7
    buffer_store_dwordx4 v[72:75], v26, s[28:31], s68 offen
    v_cvt_pk_bf16_f32 v190, v8, v10
    v_cvt_pk_bf16_f32 v191, v9, v11
    ds_write_b128 v12, v[188:191] offset:32
    v_pk_mul_f32 v[4:5], v[48:49], v[112:113]
    v_pk_mul_f32 v[6:7], v[52:53], v[112:113]
    buffer_store_dwordx4 v[76:79], v27, s[28:31], s68 offen
    v_pk_fma_f32 v[4:5], v[52:53], v[116:117], v[4:5]
    v_pk_fma_f32 v[6:7], v[48:49], v[116:117], v[6:7] neg_lo:[1,0,0] neg_hi:[1,0,0]
    v_pk_mul_f32 v[8:9], v[50:51], v[114:115]
    v_pk_mul_f32 v[10:11], v[54:55], v[114:115]
    v_pk_fma_f32 v[8:9], v[54:55], v[118:119], v[8:9]
    buffer_store_dwordx4 v[80:83], v24, s[28:31], s69 offen
    v_pk_fma_f32 v[10:11], v[50:51], v[118:119], v[10:11] neg_lo:[1,0,0] neg_hi:[1,0,0]
    v_cvt_pk_bf16_f32 v192, v4, v6
    v_cvt_pk_bf16_f32 v193, v5, v7
    v_cvt_pk_bf16_f32 v194, v8, v10
    v_cvt_pk_bf16_f32 v195, v9, v11
    buffer_store_dwordx4 v[84:87], v25, s[28:31], s69 offen
    ds_write_b128 v12, v[192:195] offset:16
    v_pk_mul_f32 v[4:5], v[56:57], v[120:121]
    v_pk_mul_f32 v[6:7], v[60:61], v[120:121]
    v_pk_fma_f32 v[4:5], v[60:61], v[124:125], v[4:5]
    v_pk_fma_f32 v[6:7], v[56:57], v[124:125], v[6:7] neg_lo:[1,0,0] neg_hi:[1,0,0]
    buffer_store_dwordx4 v[88:91], v26, s[28:31], s69 offen
    v_pk_mul_f32 v[8:9], v[58:59], v[122:123]
    v_pk_mul_f32 v[10:11], v[62:63], v[122:123]
    v_pk_fma_f32 v[8:9], v[62:63], v[126:127], v[8:9]
    v_pk_fma_f32 v[10:11], v[58:59], v[126:127], v[10:11] neg_lo:[1,0,0] neg_hi:[1,0,0]
    v_cvt_pk_bf16_f32 v196, v4, v6
    buffer_store_dwordx4 v[92:95], v27, s[28:31], s69 offen
    v_cvt_pk_bf16_f32 v197, v5, v7
    v_cvt_pk_bf16_f32 v198, v8, v10
    v_cvt_pk_bf16_f32 v199, v9, v11
    ds_write_b128 v12, v[196:199] offset:48
K_HFAR_RET:
    s_bfe_u32 s72, s97, 262168
    s_add_u32 m0, s37, 98304
    s_lshl_b32 s72, s72, 7
    s_nop 0
    buffer_load_dwordx4 v16, s[16:19], s72 offen offset:0  lds
    buffer_load_dwordx4 v17, s[16:19], s72 offen offset:1024  lds
    buffer_load_dwordx4 v18, s[16:19], s72 offen offset:2048  lds
    buffer_load_dwordx4 v19, s[16:19], s72 offen offset:3072  lds
    s_waitcnt lgkmcnt(0)
    s_barrier
    ds_read_b128 a[32:35], v13 offset:0
    ds_read_b128 a[36:39], v13 offset:1024
    ds_read_b128 a[40:43], v13 offset:2048
    ds_read_b128 a[44:47], v13 offset:3072
    ds_read_b128 a[48:51], v13 offset:4112
    ds_read_b128 a[52:55], v13 offset:5136
    ds_read_b128 a[56:59], v13 offset:6160
    ds_read_b128 a[60:63], v13 offset:7184
    ds_read_b128 a[64:67], v13 offset:8224
    ds_read_b128 a[68:71], v13 offset:9248
    ds_read_b128 a[72:75], v13 offset:10272
    ds_read_b128 a[76:79], v13 offset:11296
    ds_read_b128 a[80:83], v13 offset:12336
    ds_read_b128 a[84:87], v13 offset:13360
    ds_read_b128 a[88:91], v13 offset:14384
    ds_read_b128 a[92:95], v13 offset:15408
    v_lshlrev_b32 v12, 4, v2
    v_and_b32 v14, 12, v1
    v_add_u32 v12, v12, v14
    v_and_b32 v14, 3, v1
    v_lshlrev_b32_e64 v14, 4, v14
    v_lshl_add_u32 v12, v12, 14, v14
    v_lshlrev_b32 v14, 31, v1
    s_lshl_b32 s38, s34, 14
    s_add_u32 s38, s38, s4
    s_lshl_b32 s38, s38, 6
    s_add_u32 s38, s38, 9437184
    s_lshr_b32 s70, s2, 5
    s_lshl2_add_u32 s70, s70, s51
    v_and_b32_e64 v5, 7, v0
    v_lshl_add_u32 v5, v5, 2, s99
    v_add_u32 v6, s50, v30
    v_add_u32 v7, s7, v30
    v_mov_b32 v28, s35
    s_waitcnt lgkmcnt(12)
    s_bfe_u32 s72, s97, 262172
    v_mfma_f32_16x16x32_bf16 v[224:227], a[0:3], a[32:35], 0
    v_accvgpr_read_b32 v96, a136
    v_accvgpr_read_b32 v97, a137
    s_add_u32 m0, s37, 114688
    v_mfma_f32_16x16x32_bf16 v[228:231], a[4:7], a[32:35], 0
    v_accvgpr_read_b32 v98, a138
    v_accvgpr_read_b32 v99, a139
    s_lshl_b32 s72, s72, 7
    s_nop 0
    v_mfma_f32_16x16x32_bf16 v[224:227], a[8:11], a[36:39], v[224:227]
    v_accvgpr_read_b32 v100, a140
    v_accvgpr_read_b32 v101, a141
    buffer_load_dwordx4 v16, s[16:19], s72 offen offset:0  lds
    v_mfma_f32_16x16x32_bf16 v[228:231], a[12:15], a[36:39], v[228:231]
    v_accvgpr_read_b32 v102, a142
    v_accvgpr_read_b32 v103, a143
    v_mfma_f32_16x16x32_bf16 v[224:227], a[16:19], a[40:43], v[224:227]
    v_accvgpr_read_b32 v104, a144
    v_accvgpr_read_b32 v105, a145
    buffer_load_dwordx4 v17, s[16:19], s72 offen offset:1024  lds
    v_mfma_f32_16x16x32_bf16 v[228:231], a[20:23], a[40:43], v[228:231]
    v_accvgpr_read_b32 v106, a146
    v_accvgpr_read_b32 v107, a147
    buffer_load_dwordx4 v18, s[16:19], s72 offen offset:2048  lds
    v_mfma_f32_16x16x32_bf16 v[224:227], a[24:27], a[44:47], v[224:227]
    v_accvgpr_read_b32 v108, a148
    v_accvgpr_read_b32 v109, a149
    buffer_load_dwordx4 v19, s[16:19], s72 offen offset:3072  lds
    v_mfma_f32_16x16x32_bf16 v[228:231], a[28:31], a[44:47], v[228:231]
    v_accvgpr_read_b32 v110, a150
    v_accvgpr_read_b32 v111, a151
    s_waitcnt lgkmcnt(8)
    s_nop 0
    v_mfma_f32_16x16x32_bf16 v[232:235], a[0:3], a[48:51], 0
    v_accvgpr_read_b32 v112, a152
    v_accvgpr_read_b32 v113, a153
    v_mfma_f32_16x16x32_bf16 v[236:239], a[4:7], a[48:51], 0
    v_accvgpr_read_b32 v114, a154
    v_accvgpr_read_b32 v115, a155
    v_mfma_f32_16x16x32_bf16 v[232:235], a[8:11], a[52:55], v[232:235]
    v_accvgpr_read_b32 v116, a156
    v_accvgpr_read_b32 v117, a157
    v_mfma_f32_16x16x32_bf16 v[236:239], a[12:15], a[52:55], v[236:239]
    v_cvt_pk_bf16_f32 v184, v224, v228
    v_cvt_pk_bf16_f32 v185, v225, v229
    v_mfma_f32_16x16x32_bf16 v[232:235], a[16:19], a[56:59], v[232:235]
    v_cvt_pk_bf16_f32 v186, v226, v230
    v_cvt_pk_bf16_f32 v187, v227, v231
    v_mfma_f32_16x16x32_bf16 v[236:239], a[20:23], a[56:59], v[236:239]
    v_xor_b32 v184, v14, v184
    v_xor_b32 v185, v14, v185
    v_mfma_f32_16x16x32_bf16 v[232:235], a[24:27], a[60:63], v[232:235]
    v_xor_b32 v186, v14, v186
    v_xor_b32 v187, v14, v187
    v_mfma_f32_16x16x32_bf16 v[236:239], a[28:31], a[60:63], v[236:239]
    buffer_store_dwordx4 v[184:187], v12, s[24:27], s38 offen sc1
    s_add_u32 s38, s38, 16384
    s_waitcnt lgkmcnt(4)
    s_nop 0
    v_mfma_f32_16x16x32_bf16 v[240:243], a[0:3], a[64:67], 0
    v_accvgpr_read_b32 v118, a158
    v_accvgpr_read_b32 v119, a159
    v_mfma_f32_16x16x32_bf16 v[244:247], a[4:7], a[64:67], 0
    v_accvgpr_read_b32 v120, a160
    v_accvgpr_read_b32 v121, a161
    v_mfma_f32_16x16x32_bf16 v[240:243], a[8:11], a[68:71], v[240:243]
    v_accvgpr_read_b32 v122, a162
    v_accvgpr_read_b32 v123, a163
    v_mfma_f32_16x16x32_bf16 v[244:247], a[12:15], a[68:71], v[244:247]
    v_cvt_pk_bf16_f32 v188, v232, v236
    v_cvt_pk_bf16_f32 v189, v233, v237
    v_mfma_f32_16x16x32_bf16 v[240:243], a[16:19], a[72:75], v[240:243]
    v_cvt_pk_bf16_f32 v190, v234, v238
    v_cvt_pk_bf16_f32 v191, v235, v239
    v_mfma_f32_16x16x32_bf16 v[244:247], a[20:23], a[72:75], v[244:247]
    v_xor_b32 v188, v14, v188
    v_xor_b32 v189, v14, v189
    v_mfma_f32_16x16x32_bf16 v[240:243], a[24:27], a[76:79], v[240:243]
    v_xor_b32 v190, v14, v190
    v_xor_b32 v191, v14, v191
    v_mfma_f32_16x16x32_bf16 v[244:247], a[28:31], a[76:79], v[244:247]
    buffer_store_dwordx4 v[188:191], v12, s[24:27], s38 offen sc1
    s_add_u32 s38, s38, 16384
    s_waitcnt lgkmcnt(0)
    s_nop 0
    v_mfma_f32_16x16x32_bf16 v[248:251], a[0:3], a[80:83], 0
    v_accvgpr_read_b32 v124, a164
    v_accvgpr_read_b32 v125, a165
    v_mfma_f32_16x16x32_bf16 v[252:255], a[4:7], a[80:83], 0
    v_accvgpr_read_b32 v126, a166
    v_accvgpr_read_b32 v127, a167
    v_mfma_f32_16x16x32_bf16 v[248:251], a[8:11], a[84:87], v[248:251]
    v_accvgpr_read_b32 v128, a168
    v_accvgpr_read_b32 v129, a169
    v_mfma_f32_16x16x32_bf16 v[252:255], a[12:15], a[84:87], v[252:255]
    v_cvt_pk_bf16_f32 v192, v240, v244
    v_cvt_pk_bf16_f32 v193, v241, v245
    v_mfma_f32_16x16x32_bf16 v[248:251], a[16:19], a[88:91], v[248:251]
    v_cvt_pk_bf16_f32 v194, v242, v246
    v_cvt_pk_bf16_f32 v195, v243, v247
    v_mfma_f32_16x16x32_bf16 v[252:255], a[20:23], a[88:91], v[252:255]
    v_xor_b32 v192, v14, v192
    v_xor_b32 v193, v14, v193
    v_mfma_f32_16x16x32_bf16 v[248:251], a[24:27], a[92:95], v[248:251]
    v_xor_b32 v194, v14, v194
    v_xor_b32 v195, v14, v195
    v_mfma_f32_16x16x32_bf16 v[252:255], a[28:31], a[92:95], v[252:255]
    buffer_store_dwordx4 v[192:195], v12, s[24:27], s38 offen sc1
    s_add_u32 s38, s38, 16384
    v_accvgpr_read_b32 v130, a170
    v_accvgpr_read_b32 v131, a171
    v_accvgpr_read_b32 v132, a172
    v_accvgpr_read_b32 v133, a173
    s_waitcnt vmcnt(11)
    s_barrier
    buffer_store_dword v28, v6, s[24:27], s70 offen offset:32
    buffer_store_dword v28, v7, s[24:27], s70 offen offset:32 sc1
    v_cvt_pk_bf16_f32 v196, v248, v252
    v_cvt_pk_bf16_f32 v197, v249, v253
    v_cvt_pk_bf16_f32 v198, v250, v254
    v_cvt_pk_bf16_f32 v199, v251, v255
    v_xor_b32 v196, v14, v196
    v_xor_b32 v197, v14, v197
    v_xor_b32 v198, v14, v198
    v_xor_b32 v199, v14, v199
    buffer_store_dwordx4 v[196:199], v12, s[24:27], s38 offen sc1
    ds_read_b128 v[152:155], v20 offset:0
    ds_read_b128 v[156:159], v20 offset:2048
    ds_read_b128 v[160:163], v20 offset:4096
    ds_read_b128 v[164:167], v20 offset:6144
    s_waitcnt lgkmcnt(0)
    s_nop 0
    v_mfma_f32_16x16x32_bf16 v[32:35], v[64:67], v[152:155], 0
    ds_read_b128 v[168:171], v21 offset:0
    buffer_load_dword v4, v5, s[24:27], s51 offen offset:32 sc1
    v_mfma_f32_16x16x32_bf16 v[48:51], v[80:83], v[152:155], 0
    ds_read_b128 v[172:175], v21 offset:2048
    v_mfma_f32_16x16x32_bf16 v[36:39], v[64:67], v[156:159], 0
    ds_read_b128 v[176:179], v21 offset:4096
    v_mfma_f32_16x16x32_bf16 v[52:55], v[80:83], v[156:159], 0
    ds_read_b128 v[180:183], v21 offset:6144
    v_mfma_f32_16x16x32_bf16 v[40:43], v[64:67], v[160:163], 0
    v_mfma_f32_16x16x32_bf16 v[56:59], v[80:83], v[160:163], 0
    v_mfma_f32_16x16x32_bf16 v[44:47], v[64:67], v[164:167], 0
    v_mfma_f32_16x16x32_bf16 v[60:63], v[80:83], v[164:167], 0
    s_waitcnt lgkmcnt(0)
    s_nop 0
    v_mfma_f32_16x16x32_bf16 v[32:35], v[68:71], v[168:171], v[32:35]
    ds_read_b128 v[152:155], v22 offset:0
    v_mfma_f32_16x16x32_bf16 v[48:51], v[84:87], v[168:171], v[48:51]
    ds_read_b128 v[156:159], v22 offset:2048
    v_mfma_f32_16x16x32_bf16 v[36:39], v[68:71], v[172:175], v[36:39]
    ds_read_b128 v[160:163], v22 offset:4096
    v_mfma_f32_16x16x32_bf16 v[52:55], v[84:87], v[172:175], v[52:55]
    ds_read_b128 v[164:167], v22 offset:6144
    v_mfma_f32_16x16x32_bf16 v[40:43], v[68:71], v[176:179], v[40:43]
    v_mfma_f32_16x16x32_bf16 v[56:59], v[84:87], v[176:179], v[56:59]
    v_mfma_f32_16x16x32_bf16 v[44:47], v[68:71], v[180:183], v[44:47]
    v_mfma_f32_16x16x32_bf16 v[60:63], v[84:87], v[180:183], v[60:63]
    s_waitcnt lgkmcnt(0) vmcnt(0)
    v_cmp_ne_u32 vcc, s98, v4
    s_nop 0
    s_cbranch_vccnz K_POLL3
K_POLL3_OK:
    s_barrier
    v_mfma_f32_16x16x32_bf16 v[32:35], v[72:75], v[152:155], v[32:35]
    ds_read_b128 v[168:171], v23 offset:0
    s_bfe_u32 s73, s97, 262148
    s_lshl_b32 s73, s73, 8
    v_mfma_f32_16x16x32_bf16 v[48:51], v[88:91], v[152:155], v[48:51]
    ds_read_b128 v[172:175], v23 offset:2048
    s_add_u32 s73, s73, s95
    s_nop 0
    v_mfma_f32_16x16x32_bf16 v[36:39], v[72:75], v[156:159], v[36:39]
    ds_read_b128 v[176:179], v23 offset:4096
    s_add_u32 s74, s73, 0x20000
    buffer_load_dwordx4 a[0:3], v24, s[28:31], s73 offen sc1
    v_mfma_f32_16x16x32_bf16 v[52:55], v[88:91], v[156:159], v[52:55]
    ds_read_b128 v[180:183], v23 offset:6144
    buffer_load_dwordx4 a[16:19], v24, s[28:31], s74 offen sc1
    v_mfma_f32_16x16x32_bf16 v[40:43], v[72:75], v[160:163], v[40:43]
    buffer_load_dwordx4 a[4:7], v25, s[28:31], s73 offen sc1
    buffer_load_dwordx4 a[20:23], v25, s[28:31], s74 offen sc1
    v_mfma_f32_16x16x32_bf16 v[56:59], v[88:91], v[160:163], v[56:59]
    buffer_load_dwordx4 a[8:11], v26, s[28:31], s73 offen sc1
    v_mfma_f32_16x16x32_bf16 v[44:47], v[72:75], v[164:167], v[44:47]
    buffer_load_dwordx4 a[24:27], v26, s[28:31], s74 offen sc1
    buffer_load_dwordx4 a[12:15], v27, s[28:31], s73 offen sc1
    v_mfma_f32_16x16x32_bf16 v[60:63], v[88:91], v[164:167], v[60:63]
    buffer_load_dwordx4 a[28:31], v27, s[28:31], s74 offen sc1
    s_waitcnt lgkmcnt(0)
    v_mfma_f32_16x16x32_bf16 v[32:35], v[76:79], v[168:171], v[32:35]
    ds_read_b128 v[152:155], v20 offset:16384
    s_bfe_u32 s73, s97, 262152
    s_lshl_b32 s73, s73, 8
    v_mfma_f32_16x16x32_bf16 v[48:51], v[92:95], v[168:171], v[48:51]
    ds_read_b128 v[156:159], v20 offset:18432
    s_add_u32 s73, s73, s95
    s_nop 0
    v_mfma_f32_16x16x32_bf16 v[36:39], v[76:79], v[172:175], v[36:39]
    ds_read_b128 v[160:163], v20 offset:20480
    s_add_u32 s74, s73, 0x20000
    buffer_load_dwordx4 a[32:35], v24, s[28:31], s73 offen sc1
    v_mfma_f32_16x16x32_bf16 v[52:55], v[92:95], v[172:175], v[52:55]
    ds_read_b128 v[164:167], v20 offset:22528
    buffer_load_dwordx4 a[48:51], v24, s[28:31], s74 offen sc1
    v_mfma_f32_16x16x32_bf16 v[40:43], v[76:79], v[176:179], v[40:43]
    buffer_load_dwordx4 a[36:39], v25, s[28:31], s73 offen sc1
    buffer_load_dwordx4 a[52:55], v25, s[28:31], s74 offen sc1
    v_mfma_f32_16x16x32_bf16 v[56:59], v[92:95], v[176:179], v[56:59]
    buffer_load_dwordx4 a[40:43], v26, s[28:31], s73 offen sc1
    v_mfma_f32_16x16x32_bf16 v[44:47], v[76:79], v[180:183], v[44:47]
    buffer_load_dwordx4 a[56:59], v26, s[28:31], s74 offen sc1
    buffer_load_dwordx4 a[44:47], v27, s[28:31], s73 offen sc1
    v_mfma_f32_16x16x32_bf16 v[60:63], v[92:95], v[180:183], v[60:63]
    buffer_load_dwordx4 a[60:63], v27, s[28:31], s74 offen sc1
    s_waitcnt lgkmcnt(0) vmcnt(14)
    s_nop 0
    v_mfma_f32_16x16x32_bf16 v[32:35], a[0:3], v[152:155], v[32:35]
    ds_read_b128 v[168:171], v21 offset:16384
    s_bfe_u32 s73, s97, 262156
    v_mfma_f32_16x16x32_bf16 v[48:51], a[16:19], v[152:155], v[48:51]
    ds_read_b128 v[172:175], v21 offset:18432
    v_mfma_f32_16x16x32_bf16 v[36:39], a[0:3], v[156:159], v[36:39]
    ds_read_b128 v[176:179], v21 offset:20480
    s_lshl_b32 s73, s73, 8
    v_mfma_f32_16x16x32_bf16 v[52:55], a[16:19], v[156:159], v[52:55]
    ds_read_b128 v[180:183], v21 offset:22528
    v_mfma_f32_16x16x32_bf16 v[40:43], a[0:3], v[160:163], v[40:43]
    s_add_u32 s73, s73, s95
    v_mfma_f32_16x16x32_bf16 v[56:59], a[16:19], v[160:163], v[56:59]
    v_mfma_f32_16x16x32_bf16 v[44:47], a[0:3], v[164:167], v[44:47]
    s_add_u32 s74, s73, 0x20000
    v_mfma_f32_16x16x32_bf16 v[60:63], a[16:19], v[164:167], v[60:63]
    s_waitcnt lgkmcnt(0) vmcnt(12)
    s_nop 0
    v_mfma_f32_16x16x32_bf16 v[32:35], a[4:7], v[168:171], v[32:35]
    ds_read_b128 v[152:155], v22 offset:16384
    buffer_load_dwordx4 a[64:67], v24, s[28:31], s73 offen sc1
    v_mfma_f32_16x16x32_bf16 v[48:51], a[20:23], v[168:171], v[48:51]
    ds_read_b128 v[156:159], v22 offset:18432
    v_mfma_f32_16x16x32_bf16 v[36:39], a[4:7], v[172:175], v[36:39]
    ds_read_b128 v[160:163], v22 offset:20480
    buffer_load_dwordx4 a[80:83], v24, s[28:31], s74 offen sc1
    v_mfma_f32_16x16x32_bf16 v[52:55], a[20:23], v[172:175], v[52:55]
    ds_read_b128 v[164:167], v22 offset:22528
    v_mfma_f32_16x16x32_bf16 v[40:43], a[4:7], v[176:179], v[40:43]
    buffer_load_dwordx4 a[68:71], v25, s[28:31], s73 offen sc1
    v_mfma_f32_16x16x32_bf16 v[56:59], a[20:23], v[176:179], v[56:59]
    v_mfma_f32_16x16x32_bf16 v[44:47], a[4:7], v[180:183], v[44:47]
    buffer_load_dwordx4 a[84:87], v25, s[28:31], s74 offen sc1
    v_mfma_f32_16x16x32_bf16 v[60:63], a[20:23], v[180:183], v[60:63]
    s_waitcnt lgkmcnt(0) vmcnt(14)
    s_nop 0
    v_mfma_f32_16x16x32_bf16 v[32:35], a[8:11], v[152:155], v[32:35]
    ds_read_b128 v[168:171], v23 offset:16384
    buffer_load_dwordx4 a[72:75], v26, s[28:31], s73 offen sc1
    v_mfma_f32_16x16x32_bf16 v[48:51], a[24:27], v[152:155], v[48:51]
    ds_read_b128 v[172:175], v23 offset:18432
    v_mfma_f32_16x16x32_bf16 v[36:39], a[8:11], v[156:159], v[36:39]
    ds_read_b128 v[176:179], v23 offset:20480
    buffer_load_dwordx4 a[88:91], v26, s[28:31], s74 offen sc1
    v_mfma_f32_16x16x32_bf16 v[52:55], a[24:27], v[156:159], v[52:55]
    ds_read_b128 v[180:183], v23 offset:22528
    v_mfma_f32_16x16x32_bf16 v[40:43], a[8:11], v[160:163], v[40:43]
    buffer_load_dwordx4 a[76:79], v27, s[28:31], s73 offen sc1
    v_mfma_f32_16x16x32_bf16 v[56:59], a[24:27], v[160:163], v[56:59]
    v_mfma_f32_16x16x32_bf16 v[44:47], a[8:11], v[164:167], v[44:47]
    buffer_load_dwordx4 a[92:95], v27, s[28:31], s74 offen sc1
    v_mfma_f32_16x16x32_bf16 v[60:63], a[24:27], v[164:167], v[60:63]
    s_waitcnt lgkmcnt(0)
    s_barrier
    s_waitcnt vmcnt(16)
    s_nop 0
    v_mfma_f32_16x16x32_bf16 v[32:35], a[12:15], v[168:171], v[32:35]
    ds_read_b128 v[152:155], v20 offset:32768
    s_lshl4_add_u32 s70, s2, 22306816
    v_mfma_f32_16x16x32_bf16 v[48:51], a[28:31], v[168:171], v[48:51]
    ds_read_b128 v[156:159], v20 offset:34816
    v_mfma_f32_16x16x32_bf16 v[36:39], a[12:15], v[172:175], v[36:39]
    ds_read_b128 v[160:163], v20 offset:36864
    v_mov_b32_e64 v28, s35
    v_mfma_f32_16x16x32_bf16 v[52:55], a[28:31], v[172:175], v[52:55]
    ds_read_b128 v[164:167], v20 offset:38912
    v_mfma_f32_16x16x32_bf16 v[40:43], a[12:15], v[176:179], v[40:43]
    v_mfma_f32_16x16x32_bf16 v[56:59], a[28:31], v[176:179], v[56:59]
    buffer_store_dword v28, v30, s[24:27], s70 offen sc1
    v_mfma_f32_16x16x32_bf16 v[44:47], a[12:15], v[180:183], v[44:47]
    v_mfma_f32_16x16x32_bf16 v[60:63], a[28:31], v[180:183], v[60:63]
    s_waitcnt lgkmcnt(0) vmcnt(15)
    s_nop 0
    v_mfma_f32_16x16x32_bf16 v[32:35], a[32:35], v[152:155], v[32:35]
    ds_read_b128 v[168:171], v21 offset:32768
    s_bfe_u32 s73, s97, 262160
    v_mfma_f32_16x16x32_bf16 v[48:51], a[48:51], v[152:155], v[48:51]
    ds_read_b128 v[172:175], v21 offset:34816
    v_mfma_f32_16x16x32_bf16 v[36:39], a[32:35], v[156:159], v[36:39]
    ds_read_b128 v[176:179], v21 offset:36864
    s_lshl_b32 s73, s73, 8
    v_mfma_f32_16x16x32_bf16 v[52:55], a[48:51], v[156:159], v[52:55]
    ds_read_b128 v[180:183], v21 offset:38912
    v_mfma_f32_16x16x32_bf16 v[40:43], a[32:35], v[160:163], v[40:43]
    s_add_u32 s73, s73, s95
    v_mfma_f32_16x16x32_bf16 v[56:59], a[48:51], v[160:163], v[56:59]
    v_mfma_f32_16x16x32_bf16 v[44:47], a[32:35], v[164:167], v[44:47]
    s_add_u32 s74, s73, 0x20000
    v_mfma_f32_16x16x32_bf16 v[60:63], a[48:51], v[164:167], v[60:63]
    s_waitcnt lgkmcnt(0) vmcnt(13)
    s_nop 0
    v_mfma_f32_16x16x32_bf16 v[32:35], a[36:39], v[168:171], v[32:35]
    ds_read_b128 v[152:155], v22 offset:32768
    buffer_load_dwordx4 a[96:99], v24, s[28:31], s73 offen sc1
    v_mfma_f32_16x16x32_bf16 v[48:51], a[52:55], v[168:171], v[48:51]
    ds_read_b128 v[156:159], v22 offset:34816
    v_mfma_f32_16x16x32_bf16 v[36:39], a[36:39], v[172:175], v[36:39]
    ds_read_b128 v[160:163], v22 offset:36864
    buffer_load_dwordx4 a[112:115], v24, s[28:31], s74 offen sc1
    v_mfma_f32_16x16x32_bf16 v[52:55], a[52:55], v[172:175], v[52:55]
    ds_read_b128 v[164:167], v22 offset:38912
    v_mfma_f32_16x16x32_bf16 v[40:43], a[36:39], v[176:179], v[40:43]
    buffer_load_dwordx4 a[100:103], v25, s[28:31], s73 offen sc1
    v_mfma_f32_16x16x32_bf16 v[56:59], a[52:55], v[176:179], v[56:59]
    v_mfma_f32_16x16x32_bf16 v[44:47], a[36:39], v[180:183], v[44:47]
    buffer_load_dwordx4 a[116:119], v25, s[28:31], s74 offen sc1
    v_mfma_f32_16x16x32_bf16 v[60:63], a[52:55], v[180:183], v[60:63]
    s_waitcnt lgkmcnt(0) vmcnt(15)
    s_nop 0
    v_mfma_f32_16x16x32_bf16 v[32:35], a[40:43], v[152:155], v[32:35]
    ds_read_b128 v[168:171], v23 offset:32768
    buffer_load_dwordx4 a[104:107], v26, s[28:31], s73 offen sc1
    v_mfma_f32_16x16x32_bf16 v[48:51], a[56:59], v[152:155], v[48:51]
    ds_read_b128 v[172:175], v23 offset:34816
    v_mfma_f32_16x16x32_bf16 v[36:39], a[40:43], v[156:159], v[36:39]
    ds_read_b128 v[176:179], v23 offset:36864
    buffer_load_dwordx4 a[120:123], v26, s[28:31], s74 offen sc1
    v_mfma_f32_16x16x32_bf16 v[52:55], a[56:59], v[156:159], v[52:55]
    ds_read_b128 v[180:183], v23 offset:38912
    v_mfma_f32_16x16x32_bf16 v[40:43], a[40:43], v[160:163], v[40:43]
    buffer_load_dwordx4 a[108:111], v27, s[28:31], s73 offen sc1
    v_mfma_f32_16x16x32_bf16 v[56:59], a[56:59], v[160:163], v[56:59]
    v_mfma_f32_16x16x32_bf16 v[44:47], a[40:43], v[164:167], v[44:47]
    buffer_load_dwordx4 a[124:127], v27, s[28:31], s74 offen sc1
    v_mfma_f32_16x16x32_bf16 v[60:63], a[56:59], v[164:167], v[60:63]
    s_waitcnt lgkmcnt(0) vmcnt(17)
    s_nop 0
    v_mfma_f32_16x16x32_bf16 v[32:35], a[44:47], v[168:171], v[32:35]
    ds_read_b128 v[152:155], v20 offset:49152
    ds_read_b128 v[156:159], v20 offset:51200
    s_bfe_u32 s73, s97, 262164
    v_mfma_f32_16x16x32_bf16 v[48:51], a[60:63], v[168:171], v[48:51]
    ds_read_b128 v[160:163], v20 offset:53248
    v_mfma_f32_16x16x32_bf16 v[36:39], a[44:47], v[172:175], v[36:39]
    ds_read_b128 v[164:167], v20 offset:55296
    s_lshl_b32 s73, s73, 8
    s_nop 0
    v_mfma_f32_16x16x32_bf16 v[52:55], a[60:63], v[172:175], v[52:55]
    v_xor_b32 v20, 0x10000, v20
    v_mfma_f32_16x16x32_bf16 v[40:43], a[44:47], v[176:179], v[40:43]
    v_mfma_f32_16x16x32_bf16 v[56:59], a[60:63], v[176:179], v[56:59]
    s_add_u32 s73, s73, s95
    v_mfma_f32_16x16x32_bf16 v[44:47], a[44:47], v[180:183], v[44:47]
    v_mfma_f32_16x16x32_bf16 v[60:63], a[60:63], v[180:183], v[60:63]
    s_waitcnt lgkmcnt(0) vmcnt(15)
    v_mfma_f32_16x16x32_bf16 v[32:35], a[64:67], v[152:155], v[32:35]
    ds_read_b128 v[168:171], v21 offset:49152
    ds_read_b128 v[172:175], v21 offset:51200
    s_add_u32 s74, s73, 0x20000
    v_mfma_f32_16x16x32_bf16 v[48:51], a[80:83], v[152:155], v[48:51]
    ds_read_b128 v[176:179], v21 offset:53248
    v_mfma_f32_16x16x32_bf16 v[36:39], a[64:67], v[156:159], v[36:39]
    ds_read_b128 v[180:183], v21 offset:55296
    buffer_load_dwordx4 a[128:131], v24, s[28:31], s73 offen sc1
    v_mfma_f32_16x16x32_bf16 v[52:55], a[80:83], v[156:159], v[52:55]
    v_xor_b32 v21, 0x10000, v21
    v_mfma_f32_16x16x32_bf16 v[40:43], a[64:67], v[160:163], v[40:43]
    v_mfma_f32_16x16x32_bf16 v[56:59], a[80:83], v[160:163], v[56:59]
    buffer_load_dwordx4 a[144:147], v24, s[28:31], s74 offen sc1
    v_mfma_f32_16x16x32_bf16 v[44:47], a[64:67], v[164:167], v[44:47]
    v_mfma_f32_16x16x32_bf16 v[60:63], a[80:83], v[164:167], v[60:63]
    s_waitcnt lgkmcnt(0) vmcnt(15)
    s_nop 0
    v_mfma_f32_16x16x32_bf16 v[32:35], a[68:71], v[168:171], v[32:35]
    ds_read_b128 v[152:155], v22 offset:49152
    ds_read_b128 v[156:159], v22 offset:51200
    buffer_load_dwordx4 a[132:135], v25, s[28:31], s73 offen sc1
    v_mfma_f32_16x16x32_bf16 v[48:51], a[84:87], v[168:171], v[48:51]
    ds_read_b128 v[160:163], v22 offset:53248
    v_mfma_f32_16x16x32_bf16 v[36:39], a[68:71], v[172:175], v[36:39]
    ds_read_b128 v[164:167], v22 offset:55296
    buffer_load_dwordx4 a[148:151], v25, s[28:31], s74 offen sc1
    v_mfma_f32_16x16x32_bf16 v[52:55], a[84:87], v[172:175], v[52:55]
    v_xor_b32 v22, 0x10000, v22
    v_mfma_f32_16x16x32_bf16 v[40:43], a[68:71], v[176:179], v[40:43]
    v_mfma_f32_16x16x32_bf16 v[56:59], a[84:87], v[176:179], v[56:59]
    buffer_load_dwordx4 a[136:139], v26, s[28:31], s73 offen sc1
    v_mfma_f32_16x16x32_bf16 v[44:47], a[68:71], v[180:183], v[44:47]
    v_mfma_f32_16x16x32_bf16 v[60:63], a[84:87], v[180:183], v[60:63]
    s_waitcnt lgkmcnt(0) vmcnt(16)
    s_nop 0
    v_mfma_f32_16x16x32_bf16 v[32:35], a[72:75], v[152:155], v[32:35]
    ds_read_b128 v[168:171], v23 offset:49152
    ds_read_b128 v[172:175], v23 offset:51200
    buffer_load_dwordx4 a[152:155], v26, s[28:31], s74 offen sc1
    v_mfma_f32_16x16x32_bf16 v[48:51], a[88:91], v[152:155], v[48:51]
    ds_read_b128 v[176:179], v23 offset:53248
    v_mfma_f32_16x16x32_bf16 v[36:39], a[72:75], v[156:159], v[36:39]
    ds_read_b128 v[180:183], v23 offset:55296
    buffer_load_dwordx4 a[140:143], v27, s[28:31], s73 offen sc1
    v_mfma_f32_16x16x32_bf16 v[52:55], a[88:91], v[156:159], v[52:55]
    v_xor_b32 v23, 0x10000, v23
    v_mfma_f32_16x16x32_bf16 v[40:43], a[72:75], v[160:163], v[40:43]
    v_mfma_f32_16x16x32_bf16 v[56:59], a[88:91], v[160:163], v[56:59]
    buffer_load_dwordx4 a[156:159], v27, s[28:31], s74 offen sc1
    v_mfma_f32_16x16x32_bf16 v[44:47], a[72:75], v[164:167], v[44:47]
    v_mfma_f32_16x16x32_bf16 v[60:63], a[88:91], v[164:167], v[60:63]
    s_waitcnt lgkmcnt(0) vmcnt(17)
    s_nop 0
    v_mfma_f32_16x16x32_bf16 v[32:35], a[76:79], v[168:171], v[32:35]
    ds_read_b128 v[152:155], v20 offset:0
    s_bfe_u32 s73, s97, 262168
    v_mfma_f32_16x16x32_bf16 v[48:51], a[92:95], v[168:171], v[48:51]
    ds_read_b128 v[156:159], v20 offset:2048
    v_mfma_f32_16x16x32_bf16 v[36:39], a[76:79], v[172:175], v[36:39]
    ds_read_b128 v[160:163], v20 offset:4096
    s_lshl_b32 s73, s73, 8
    v_mfma_f32_16x16x32_bf16 v[52:55], a[92:95], v[172:175], v[52:55]
    ds_read_b128 v[164:167], v20 offset:6144
    v_mfma_f32_16x16x32_bf16 v[40:43], a[76:79], v[176:179], v[40:43]
    s_add_u32 s73, s73, s95
    v_mfma_f32_16x16x32_bf16 v[56:59], a[92:95], v[176:179], v[56:59]
    v_mfma_f32_16x16x32_bf16 v[44:47], a[76:79], v[180:183], v[44:47]
    s_add_u32 s74, s73, 0x20000
    v_mfma_f32_16x16x32_bf16 v[60:63], a[92:95], v[180:183], v[60:63]
    s_waitcnt lgkmcnt(0) vmcnt(14)
    s_nop 0
    v_mfma_f32_16x16x32_bf16 v[32:35], a[96:99], v[152:155], v[32:35]
    ds_read_b128 v[168:171], v21 offset:0
    buffer_load_dwordx4 a[160:163], v24, s[28:31], s73 offen sc1
    v_mfma_f32_16x16x32_bf16 v[48:51], a[112:115], v[152:155], v[48:51]
    ds_read_b128 v[172:175], v21 offset:2048
    buffer_load_dwordx4 a[176:179], v24, s[28:31], s74 offen sc1
    v_mfma_f32_16x16x32_bf16 v[36:39], a[96:99], v[156:159], v[36:39]
    ds_read_b128 v[176:179], v21 offset:4096
    v_mfma_f32_16x16x32_bf16 v[52:55], a[112:115], v[156:159], v[52:55]
    ds_read_b128 v[180:183], v21 offset:6144
    buffer_load_dwordx4 a[164:167], v25, s[28:31], s73 offen sc1
    v_mfma_f32_16x16x32_bf16 v[40:43], a[96:99], v[160:163], v[40:43]
    buffer_load_dwordx4 a[180:183], v25, s[28:31], s74 offen sc1
    v_mfma_f32_16x16x32_bf16 v[56:59], a[112:115], v[160:163], v[56:59]
    v_mfma_f32_16x16x32_bf16 v[44:47], a[96:99], v[164:167], v[44:47]
    buffer_load_dwordx4 a[168:171], v26, s[28:31], s73 offen sc1
    v_mfma_f32_16x16x32_bf16 v[60:63], a[112:115], v[164:167], v[60:63]
    s_waitcnt lgkmcnt(0) vmcnt(17)
    s_nop 0
    v_mfma_f32_16x16x32_bf16 v[32:35], a[100:103], v[168:171], v[32:35]
    ds_read_b128 v[152:155], v22 offset:0
    buffer_load_dwordx4 a[184:187], v26, s[28:31], s74 offen sc1
    v_mfma_f32_16x16x32_bf16 v[48:51], a[116:119], v[168:171], v[48:51]
    ds_read_b128 v[156:159], v22 offset:2048
    v_mfma_f32_16x16x32_bf16 v[36:39], a[100:103], v[172:175], v[36:39]
    ds_read_b128 v[160:163], v22 offset:4096
    buffer_load_dwordx4 a[172:175], v27, s[28:31], s73 offen sc1
    v_mfma_f32_16x16x32_bf16 v[52:55], a[116:119], v[172:175], v[52:55]
    ds_read_b128 v[164:167], v22 offset:6144
    v_mfma_f32_16x16x32_bf16 v[40:43], a[100:103], v[176:179], v[40:43]
    buffer_load_dwordx4 a[188:191], v27, s[28:31], s74 offen sc1
    v_mfma_f32_16x16x32_bf16 v[56:59], a[116:119], v[176:179], v[56:59]
    v_mfma_f32_16x16x32_bf16 v[44:47], a[100:103], v[180:183], v[44:47]
    s_getpc_b64 s[20:21]
K_PC3:
    s_mov_b32 s22, K_CODE_END-K_PC3
    v_mfma_f32_16x16x32_bf16 v[60:63], a[116:119], v[180:183], v[60:63]
    s_waitcnt lgkmcnt(0) vmcnt(18)
    v_mfma_f32_16x16x32_bf16 v[32:35], a[104:107], v[152:155], v[32:35]
    ds_read_b128 v[168:171], v23 offset:0
    s_bfe_u32 s3, s2, 0x20003
    v_mfma_f32_16x16x32_bf16 v[48:51], a[120:123], v[152:155], v[48:51]
    ds_read_b128 v[172:175], v23 offset:2048
    s_lshl2_add_u32 s3, s3, s34
    s_nop 0
    v_mfma_f32_16x16x32_bf16 v[36:39], a[104:107], v[156:159], v[36:39]
    ds_read_b128 v[176:179], v23 offset:4096
    v_mfma_f32_16x16x32_bf16 v[52:55], a[120:123], v[156:159], v[52:55]
    ds_read_b128 v[180:183], v23 offset:6144
    s_lshl_b32 s3, s3, 11
    s_nop 0
    v_mfma_f32_16x16x32_bf16 v[40:43], a[104:107], v[160:163], v[40:43]
    v_lshl_add_u32 v28, v0, 5, s3
    v_mfma_f32_16x16x32_bf16 v[56:59], a[120:123], v[160:163], v[56:59]
    v_mfma_f32_16x16x32_bf16 v[44:47], a[104:107], v[164:167], v[44:47]
    buffer_load_dword v29, v28, s[20:23], 0 offen
    v_mfma_f32_16x16x32_bf16 v[60:63], a[120:123], v[164:167], v[60:63]
    s_waitcnt lgkmcnt(0) vmcnt(17)
    s_nop 0
    v_mfma_f32_16x16x32_bf16 v[32:35], a[108:111], v[168:171], v[32:35]
    ds_read_b128 v[152:155], v20 offset:16384
    s_bfe_u32 s73, s97, 262172
    v_mfma_f32_16x16x32_bf16 v[48:51], a[124:127], v[168:171], v[48:51]
    ds_read_b128 v[156:159], v20 offset:18432
    v_mfma_f32_16x16x32_bf16 v[36:39], a[108:111], v[172:175], v[36:39]
    ds_read_b128 v[160:163], v20 offset:20480
    s_lshl_b32 s73, s73, 8
    s_nop 0
    v_mfma_f32_16x16x32_bf16 v[52:55], a[124:127], v[172:175], v[52:55]
    ds_read_b128 v[164:167], v20 offset:22528
    v_mfma_f32_16x16x32_bf16 v[40:43], a[108:111], v[176:179], v[40:43]
    v_mfma_f32_16x16x32_bf16 v[56:59], a[124:127], v[176:179], v[56:59]
    s_add_u32 s73, s73, s95
    v_mfma_f32_16x16x32_bf16 v[44:47], a[108:111], v[180:183], v[44:47]
    v_mfma_f32_16x16x32_bf16 v[60:63], a[124:127], v[180:183], v[60:63]
    s_waitcnt lgkmcnt(0) vmcnt(15)
    v_mfma_f32_16x16x32_bf16 v[32:35], a[128:131], v[152:155], v[32:35]
    ds_read_b128 v[168:171], v21 offset:16384
    s_add_u32 s74, s73, 0x20000
    v_mfma_f32_16x16x32_bf16 v[48:51], a[144:147], v[152:155], v[48:51]
    ds_read_b128 v[172:175], v21 offset:18432
    v_mfma_f32_16x16x32_bf16 v[36:39], a[128:131], v[156:159], v[36:39]
    ds_read_b128 v[176:179], v21 offset:20480
    buffer_load_dwordx4 a[192:195], v24, s[28:31], s73 offen sc1
    v_mfma_f32_16x16x32_bf16 v[52:55], a[144:147], v[156:159], v[52:55]
    ds_read_b128 v[180:183], v21 offset:22528
    v_mfma_f32_16x16x32_bf16 v[40:43], a[128:131], v[160:163], v[40:43]
    v_mfma_f32_16x16x32_bf16 v[56:59], a[144:147], v[160:163], v[56:59]
    buffer_load_dwordx4 a[208:211], v24, s[28:31], s74 offen sc1
    v_mfma_f32_16x16x32_bf16 v[44:47], a[128:131], v[164:167], v[44:47]
    v_mfma_f32_16x16x32_bf16 v[60:63], a[144:147], v[164:167], v[60:63]
    s_waitcnt lgkmcnt(0) vmcnt(15)
    s_nop 0
    v_mfma_f32_16x16x32_bf16 v[32:35], a[132:135], v[168:171], v[32:35]
    ds_read_b128 v[152:155], v22 offset:16384
    buffer_load_dwordx4 a[196:199], v25, s[28:31], s73 offen sc1
    v_mfma_f32_16x16x32_bf16 v[48:51], a[148:151], v[168:171], v[48:51]
    ds_read_b128 v[156:159], v22 offset:18432
    v_mfma_f32_16x16x32_bf16 v[36:39], a[132:135], v[172:175], v[36:39]
    ds_read_b128 v[160:163], v22 offset:20480
    buffer_load_dwordx4 a[212:215], v25, s[28:31], s74 offen sc1
    v_mfma_f32_16x16x32_bf16 v[52:55], a[148:151], v[172:175], v[52:55]
    ds_read_b128 v[164:167], v22 offset:22528
    v_mfma_f32_16x16x32_bf16 v[40:43], a[132:135], v[176:179], v[40:43]
    v_mfma_f32_16x16x32_bf16 v[56:59], a[148:151], v[176:179], v[56:59]
    buffer_load_dwordx4 a[200:203], v26, s[28:31], s73 offen sc1
    v_mfma_f32_16x16x32_bf16 v[44:47], a[132:135], v[180:183], v[44:47]
    v_mfma_f32_16x16x32_bf16 v[60:63], a[148:151], v[180:183], v[60:63]
    s_waitcnt lgkmcnt(0) vmcnt(16)
    s_nop 0
    v_mfma_f32_16x16x32_bf16 v[32:35], a[136:139], v[152:155], v[32:35]
    ds_read_b128 v[168:171], v23 offset:16384
    buffer_load_dwordx4 a[216:219], v26, s[28:31], s74 offen sc1
    v_mfma_f32_16x16x32_bf16 v[48:51], a[152:155], v[152:155], v[48:51]
    ds_read_b128 v[172:175], v23 offset:18432
    v_mfma_f32_16x16x32_bf16 v[36:39], a[136:139], v[156:159], v[36:39]
    ds_read_b128 v[176:179], v23 offset:20480
    buffer_load_dwordx4 a[204:207], v27, s[28:31], s73 offen sc1
    v_mfma_f32_16x16x32_bf16 v[52:55], a[152:155], v[156:159], v[52:55]
    ds_read_b128 v[180:183], v23 offset:22528
    v_mfma_f32_16x16x32_bf16 v[40:43], a[136:139], v[160:163], v[40:43]
    v_mfma_f32_16x16x32_bf16 v[56:59], a[152:155], v[160:163], v[56:59]
    buffer_load_dwordx4 a[220:223], v27, s[28:31], s74 offen sc1
    v_mfma_f32_16x16x32_bf16 v[44:47], a[136:139], v[164:167], v[44:47]
    v_mfma_f32_16x16x32_bf16 v[60:63], a[152:155], v[164:167], v[60:63]
    s_waitcnt lgkmcnt(0) vmcnt(17)
    s_nop 0
    v_mfma_f32_16x16x32_bf16 v[32:35], a[140:143], v[168:171], v[32:35]
    ds_read_b128 v[152:155], v20 offset:32768
    v_mfma_f32_16x16x32_bf16 v[48:51], a[156:159], v[168:171], v[48:51]
    ds_read_b128 v[156:159], v20 offset:34816
    v_mfma_f32_16x16x32_bf16 v[36:39], a[140:143], v[172:175], v[36:39]
    ds_read_b128 v[160:163], v20 offset:36864
    v_mfma_f32_16x16x32_bf16 v[52:55], a[156:159], v[172:175], v[52:55]
    ds_read_b128 v[164:167], v20 offset:38912
    v_mfma_f32_16x16x32_bf16 v[40:43], a[140:143], v[176:179], v[40:43]
    v_mfma_f32_16x16x32_bf16 v[56:59], a[156:159], v[176:179], v[56:59]
    v_mfma_f32_16x16x32_bf16 v[44:47], a[140:143], v[180:183], v[44:47]
    v_mfma_f32_16x16x32_bf16 v[60:63], a[156:159], v[180:183], v[60:63]
    s_waitcnt lgkmcnt(0) vmcnt(15)
    v_mfma_f32_16x16x32_bf16 v[32:35], a[160:163], v[152:155], v[32:35]
    ds_read_b128 v[168:171], v21 offset:32768
    s_lshl_b32 s70, s34, 10
    v_mfma_f32_16x16x32_bf16 v[48:51], a[176:179], v[152:155], v[48:51]
    ds_read_b128 v[172:175], v21 offset:34816
    v_mfma_f32_16x16x32_bf16 v[36:39], a[160:163], v[156:159], v[36:39]
    ds_read_b128 v[176:179], v21 offset:36864
    v_mfma_f32_16x16x32_bf16 v[52:55], a[176:179], v[156:159], v[52:55]
    ds_read_b128 v[180:183], v21 offset:38912
    v_mfma_f32_16x16x32_bf16 v[40:43], a[160:163], v[160:163], v[40:43]
    v_mfma_f32_16x16x32_bf16 v[56:59], a[176:179], v[160:163], v[56:59]
    v_mfma_f32_16x16x32_bf16 v[44:47], a[160:163], v[164:167], v[44:47]
    v_mfma_f32_16x16x32_bf16 v[60:63], a[176:179], v[164:167], v[60:63]
    s_waitcnt lgkmcnt(0) vmcnt(13)
    s_nop 0
    v_mfma_f32_16x16x32_bf16 v[32:35], a[164:167], v[168:171], v[32:35]
    ds_read_b128 v[152:155], v22 offset:32768
    s_add_u32 s70, s70, 22306816
    v_mfma_f32_16x16x32_bf16 v[48:51], a[180:183], v[168:171], v[48:51]
    ds_read_b128 v[156:159], v22 offset:34816
    v_mfma_f32_16x16x32_bf16 v[36:39], a[164:167], v[172:175], v[36:39]
    ds_read_b128 v[160:163], v22 offset:36864
    v_mfma_f32_16x16x32_bf16 v[52:55], a[180:183], v[172:175], v[52:55]
    ds_read_b128 v[164:167], v22 offset:38912
    v_mfma_f32_16x16x32_bf16 v[40:43], a[164:167], v[176:179], v[40:43]
    v_mfma_f32_16x16x32_bf16 v[56:59], a[180:183], v[176:179], v[56:59]
    v_mfma_f32_16x16x32_bf16 v[44:47], a[164:167], v[180:183], v[44:47]
    v_mfma_f32_16x16x32_bf16 v[60:63], a[180:183], v[180:183], v[60:63]
    s_waitcnt lgkmcnt(0) vmcnt(11)
    s_nop 0
    v_mfma_f32_16x16x32_bf16 v[32:35], a[168:171], v[152:155], v[32:35]
    ds_read_b128 v[168:171], v23 offset:32768
    buffer_load_dword v8, v3, s[24:27], s70 offen sc1
    v_mfma_f32_16x16x32_bf16 v[48:51], a[184:187], v[152:155], v[48:51]
    ds_read_b128 v[172:175], v23 offset:34816
    v_mfma_f32_16x16x32_bf16 v[36:39], a[168:171], v[156:159], v[36:39]
    ds_read_b128 v[176:179], v23 offset:36864
    v_mfma_f32_16x16x32_bf16 v[52:55], a[184:187], v[156:159], v[52:55]
    ds_read_b128 v[180:183], v23 offset:38912
    v_mfma_f32_16x16x32_bf16 v[40:43], a[168:171], v[160:163], v[40:43]
    v_mfma_f32_16x16x32_bf16 v[56:59], a[184:187], v[160:163], v[56:59]
    v_mfma_f32_16x16x32_bf16 v[44:47], a[168:171], v[164:167], v[44:47]
    v_mfma_f32_16x16x32_bf16 v[60:63], a[184:187], v[164:167], v[60:63]
    s_waitcnt lgkmcnt(0) vmcnt(0)
    v_cmp_ne_u32 vcc, s35, v8
    s_nop 0
    s_cbranch_vccnz K_POLL4
K_POLL4_OK:
    s_barrier
    v_mfma_f32_16x16x32_bf16 v[32:35], a[172:175], v[168:171], v[32:35]
    ds_read_b128 v[152:155], v20 offset:49152
    ds_read_b128 v[156:159], v20 offset:51200
    s_lshl4_add_u32 s70, s32, s33
    v_mfma_f32_16x16x32_bf16 v[48:51], a[188:191], v[168:171], v[48:51]
    ds_read_b128 v[160:163], v20 offset:53248
    s_lshl4_add_u32 s70, s70, s34
    v_mfma_f32_16x16x32_bf16 v[36:39], a[172:175], v[172:175], v[36:39]
    ds_read_b128 v[164:167], v20 offset:55296
    s_lshl_b32 s70, s70, 10
    v_mfma_f32_16x16x32_bf16 v[52:55], a[188:191], v[172:175], v[52:55]
    v_xor_b32 v20, 0x10000, v20
    s_add_u32 s70, s70, 9437184
    v_mfma_f32_16x16x32_bf16 v[40:43], a[172:175], v[176:179], v[40:43]
    buffer_load_dwordx4 v[184:187], v3, s[24:27], s70 offen sc1 nt
    v_mfma_f32_16x16x32_bf16 v[56:59], a[188:191], v[176:179], v[56:59]
    s_add_u32 s70, s70, 4096
    v_mfma_f32_16x16x32_bf16 v[44:47], a[172:175], v[180:183], v[44:47]
    buffer_load_dwordx4 v[188:191], v3, s[24:27], s70 offen sc1 nt
    v_mfma_f32_16x16x32_bf16 v[60:63], a[188:191], v[180:183], v[60:63]
    s_waitcnt lgkmcnt(0)
    s_nop 0
    v_mfma_f32_16x16x32_bf16 v[32:35], a[192:195], v[152:155], v[32:35]
    ds_read_b128 v[168:171], v21 offset:49152
    ds_read_b128 v[172:175], v21 offset:51200
    s_add_u32 s70, s70, 4096
    v_mfma_f32_16x16x32_bf16 v[48:51], a[208:211], v[152:155], v[48:51]
    ds_read_b128 v[176:179], v21 offset:53248
    buffer_load_dwordx4 v[192:195], v3, s[24:27], s70 offen sc1 nt
    v_mfma_f32_16x16x32_bf16 v[36:39], a[192:195], v[156:159], v[36:39]
    ds_read_b128 v[180:183], v21 offset:55296
    s_add_u32 s70, s70, 4096
    v_mfma_f32_16x16x32_bf16 v[52:55], a[208:211], v[156:159], v[52:55]
    v_xor_b32 v21, 0x10000, v21
    buffer_load_dwordx4 v[196:199], v3, s[24:27], s70 offen sc1 nt
    v_mfma_f32_16x16x32_bf16 v[40:43], a[192:195], v[160:163], v[40:43]
    v_xor_b32 v16, 0x100000, v16
    v_mfma_f32_16x16x32_bf16 v[56:59], a[208:211], v[160:163], v[56:59]
    v_xor_b32 v17, 0x100000, v17
    v_mfma_f32_16x16x32_bf16 v[44:47], a[192:195], v[164:167], v[44:47]
    v_xor_b32 v18, 0x100000, v18
    v_mfma_f32_16x16x32_bf16 v[60:63], a[208:211], v[164:167], v[60:63]
    s_waitcnt lgkmcnt(0)
    s_nop 0
    v_mfma_f32_16x16x32_bf16 v[32:35], a[196:199], v[168:171], v[32:35]
    ds_read_b128 v[152:155], v22 offset:49152
    ds_read_b128 v[156:159], v22 offset:51200
    v_xor_b32 v19, 0x100000, v19
    v_mfma_f32_16x16x32_bf16 v[48:51], a[212:215], v[168:171], v[48:51]
    ds_read_b128 v[160:163], v22 offset:53248
    s_bfe_u32 s72, s97, 262144
    v_mfma_f32_16x16x32_bf16 v[36:39], a[196:199], v[172:175], v[36:39]
    ds_read_b128 v[164:167], v22 offset:55296
    s_add_u32 m0, s37, 0
    v_mfma_f32_16x16x32_bf16 v[52:55], a[212:215], v[172:175], v[52:55]
    v_xor_b32 v22, 0x10000, v22
    s_lshl_b32 s72, s72, 7
    v_mfma_f32_16x16x32_bf16 v[40:43], a[196:199], v[176:179], v[40:43]
    buffer_load_dwordx4 v16, s[16:19], s72 offen offset:0 nt lds
    v_mfma_f32_16x16x32_bf16 v[56:59], a[212:215], v[176:179], v[56:59]
    buffer_load_dwordx4 v17, s[16:19], s72 offen offset:1024 nt lds
    v_mfma_f32_16x16x32_bf16 v[44:47], a[196:199], v[180:183], v[44:47]
    buffer_load_dwordx4 v18, s[16:19], s72 offen offset:2048 nt lds
    v_mfma_f32_16x16x32_bf16 v[60:63], a[212:215], v[180:183], v[60:63]
    s_waitcnt lgkmcnt(0)
    s_nop 0
    v_mfma_f32_16x16x32_bf16 v[32:35], a[200:203], v[152:155], v[32:35]
    ds_read_b128 v[168:171], v23 offset:49152
    ds_read_b128 v[172:175], v23 offset:51200
    buffer_load_dwordx4 v19, s[16:19], s72 offen offset:3072 nt lds
    v_mfma_f32_16x16x32_bf16 v[48:51], a[216:219], v[152:155], v[48:51]
    ds_read_b128 v[176:179], v23 offset:53248
    s_bfe_u32 s72, s97, 262148
    v_mfma_f32_16x16x32_bf16 v[36:39], a[200:203], v[156:159], v[36:39]
    ds_read_b128 v[180:183], v23 offset:55296
    s_add_u32 m0, s37, 16384
    v_mfma_f32_16x16x32_bf16 v[52:55], a[216:219], v[156:159], v[52:55]
    v_xor_b32 v23, 0x10000, v23
    s_lshl_b32 s72, s72, 7
    s_nop 0
    v_mfma_f32_16x16x32_bf16 v[40:43], a[200:203], v[160:163], v[40:43]
    buffer_load_dwordx4 v16, s[16:19], s72 offen offset:0 nt lds
    v_mfma_f32_16x16x32_bf16 v[56:59], a[216:219], v[160:163], v[56:59]
    buffer_load_dwordx4 v17, s[16:19], s72 offen offset:1024 nt lds
    v_mfma_f32_16x16x32_bf16 v[44:47], a[200:203], v[164:167], v[44:47]
    buffer_load_dwordx4 v18, s[16:19], s72 offen offset:2048 nt lds
    v_mfma_f32_16x16x32_bf16 v[60:63], a[216:219], v[164:167], v[60:63]
    buffer_load_dwordx4 v19, s[16:19], s72 offen offset:3072 nt lds
    s_waitcnt lgkmcnt(0)
    v_mfma_f32_16x16x32_bf16 v[32:35], a[204:207], v[168:171], v[32:35]
    s_lshl_b32 s38, s2, 14
    s_add_u32 s38, s38, s37
    v_mfma_f32_16x16x32_bf16 v[48:51], a[220:223], v[168:171], v[48:51]
    s_add_u32 s38, s38, 17825792
    v_lshlrev_b32 v4, 16, v2
    v_mfma_f32_16x16x32_bf16 v[36:39], a[204:207], v[172:175], v[36:39]
    v_lshl_add_u32 v4, v1, 4, v4
    v_lshlrev_b32_e64 v216, 16, v112
    v_mfma_f32_16x16x32_bf16 v[52:55], a[220:223], v[172:175], v[52:55]
    v_and_b32 v220, 0xffff0000, v112
    v_lshlrev_b32_e64 v217, 16, v113
    v_mfma_f32_16x16x32_bf16 v[40:43], a[204:207], v[176:179], v[40:43]
    v_and_b32 v221, 0xffff0000, v113
    v_lshlrev_b32_e64 v218, 16, v114
    v_mfma_f32_16x16x32_bf16 v[56:59], a[220:223], v[176:179], v[56:59]
    v_and_b32 v222, 0xffff0000, v114
    v_lshlrev_b32_e64 v219, 16, v115
    v_mfma_f32_16x16x32_bf16 v[44:47], a[204:207], v[180:183], v[44:47]
    v_and_b32 v223, 0xffff0000, v115
    v_lshlrev_b32_e64 v224, 16, v116
    v_mfma_f32_16x16x32_bf16 v[60:63], a[220:223], v[180:183], v[60:63]
    v_and_b32 v228, 0xffff0000, v116
    v_lshlrev_b32_e64 v225, 16, v117
    v_and_b32 v229, 0xffff0000, v117
    v_lshlrev_b32_e64 v226, 16, v118
    v_and_b32 v230, 0xffff0000, v118
    v_lshlrev_b32_e64 v227, 16, v119
    v_and_b32 v231, 0xffff0000, v119
    v_cvt_pk_bf16_f32 v200, v32, v36
    v_cvt_pk_bf16_f32 v201, v40, v44
    v_cvt_pk_bf16_f32 v202, v48, v52
    v_cvt_pk_bf16_f32 v203, v56, v60
    buffer_store_dwordx4 v[200:203], v3, s[24:27], s38 offen offset:0 sc1
    v_cvt_pk_bf16_f32 v204, v33, v37
    v_cvt_pk_bf16_f32 v205, v41, v45
    v_cvt_pk_bf16_f32 v206, v49, v53
    v_cvt_pk_bf16_f32 v207, v57, v61
    buffer_store_dwordx4 v[204:207], v3, s[24:27], s38 offen offset:1024 sc1
    v_cvt_pk_bf16_f32 v208, v34, v38
    v_cvt_pk_bf16_f32 v209, v42, v46
    v_cvt_pk_bf16_f32 v210, v50, v54
    v_cvt_pk_bf16_f32 v211, v58, v62
    buffer_store_dwordx4 v[208:211], v3, s[24:27], s38 offen offset:2048 sc1
    v_cvt_pk_bf16_f32 v212, v35, v39
    v_cvt_pk_bf16_f32 v213, v43, v47
    v_cvt_pk_bf16_f32 v214, v51, v55
    v_cvt_pk_bf16_f32 v215, v59, v63
    buffer_store_dwordx4 v[212:215], v3, s[24:27], s38 offen offset:3072 sc1
    s_waitcnt vmcnt(12)
    s_nop 0
    ds_write_b64 v132, v[184:185] offset:0
    ds_write_b64 v132, v[186:187] offset:2080
    ds_write_b64 v133, v[188:189] offset:512
    ds_write_b64 v133, v[190:191] offset:2592
    ds_write_b64 v133, v[192:193] offset:1024
    ds_write_b64 v133, v[194:195] offset:3104
    ds_write_b64 v133, v[196:197] offset:1536
    ds_write_b64 v133, v[198:199] offset:3616
    v_lshlrev_b32_e64 v232, 16, v120
    v_and_b32 v236, 0xffff0000, v120
    v_lshlrev_b32_e64 v233, 16, v121
    v_and_b32 v237, 0xffff0000, v121
    v_lshlrev_b32_e64 v234, 16, v122
    v_and_b32 v238, 0xffff0000, v122
    v_lshlrev_b32_e64 v235, 16, v123
    v_and_b32 v239, 0xffff0000, v123
    v_lshlrev_b32_e64 v240, 16, v124
    v_and_b32 v244, 0xffff0000, v124
    v_lshlrev_b32_e64 v241, 16, v125
    v_and_b32 v245, 0xffff0000, v125
    v_lshlrev_b32_e64 v242, 16, v126
    v_and_b32 v246, 0xffff0000, v126
    v_lshlrev_b32_e64 v243, 16, v127
    v_and_b32 v247, 0xffff0000, v127
    s_waitcnt lgkmcnt(0)
    s_barrier
    ds_read2_b32 v[184:185], v130 offset0:0 offset1:32
    ds_read2_b32 v[186:187], v130 offset0:64 offset1:96
    ds_read2_b32 v[188:189], v131 offset0:96 offset1:64
    ds_read2_b32 v[190:191], v131 offset0:32 offset1:0
    ds_read2_b32 v[192:193], v130 offset0:1 offset1:33
    ds_read2_b32 v[194:195], v130 offset0:65 offset1:97
    ds_read2_b32 v[196:197], v131 offset0:97 offset1:65
    ds_read2_b32 v[198:199], v131 offset0:33 offset1:1
    s_waitcnt lgkmcnt(4)
    s_nop 0
    s_bfe_u32 s72, s97, 262152
    v_mfma_f32_16x16x32_bf16 v[32:35], v[184:187], a[224:227], 0
    v_mfma_f32_16x16x32_bf16 v[36:39], v[184:187], a[228:231], 0
    s_add_u32 m0, s37, 32768
    v_mfma_f32_16x16x32_bf16 v[40:43], v[184:187], a[232:235], 0
    v_mfma_f32_16x16x32_bf16 v[44:47], v[184:187], a[236:239], 0
    v_mfma_f32_16x16x32_bf16 v[32:35], v[188:191], a[224:227], v[32:35]
    s_lshl_b32 s72, s72, 7
    s_nop 0
    v_mfma_f32_16x16x32_bf16 v[36:39], v[188:191], a[228:231], v[36:39]
    v_mfma_f32_16x16x32_bf16 v[40:43], v[188:191], a[240:243], v[40:43]
    buffer_load_dwordx4 v16, s[16:19], s72 offen offset:0 nt lds
    v_mfma_f32_16x16x32_bf16 v[44:47], v[188:191], a[244:247], v[44:47]
    s_waitcnt lgkmcnt(0)
    s_nop 0
    v_mfma_f32_16x16x32_bf16 v[48:51], v[192:195], a[224:227], 0
    buffer_load_dwordx4 v17, s[16:19], s72 offen offset:1024 nt lds
    v_mfma_f32_16x16x32_bf16 v[52:55], v[192:195], a[228:231], 0
    v_mfma_f32_16x16x32_bf16 v[56:59], v[192:195], a[232:235], 0
    buffer_load_dwordx4 v18, s[16:19], s72 offen offset:2048 nt lds
    v_mfma_f32_16x16x32_bf16 v[60:63], v[192:195], a[236:239], 0
    v_mfma_f32_16x16x32_bf16 v[48:51], v[196:199], a[224:227], v[48:51]
    v_mfma_f32_16x16x32_bf16 v[52:55], v[196:199], a[228:231], v[52:55]
    buffer_load_dwordx4 v19, s[16:19], s72 offen offset:3072 nt lds
    v_mfma_f32_16x16x32_bf16 v[56:59], v[196:199], a[240:243], v[56:59]
    v_mfma_f32_16x16x32_bf16 v[60:63], v[196:199], a[244:247], v[60:63]
    v_pk_mul_f32 v[168:169], v[32:33], v[96:97]
    v_pk_mul_f32 v[170:171], v[36:37], v[96:97]
    v_pk_fma_f32 v[168:169], v[36:37], v[104:105], v[168:169]
    v_pk_fma_f32 v[170:171], v[32:33], v[104:105], v[170:171] neg_lo:[1,0,0] neg_hi:[1,0,0]
    v_pk_mul_f32 v[172:173], v[34:35], v[98:99]
    v_pk_mul_f32 v[174:175], v[38:39], v[98:99]
    v_pk_fma_f32 v[172:173], v[38:39], v[106:107], v[172:173]
    v_pk_fma_f32 v[174:175], v[34:35], v[106:107], v[174:175] neg_lo:[1,0,0] neg_hi:[1,0,0]
    v_cvt_pk_bf16_f32 v152, v168, v170
    v_cvt_pk_bf16_f32 v153, v169, v171
    v_cvt_pk_bf16_f32 v154, v172, v174
    v_cvt_pk_bf16_f32 v155, v173, v175
    v_pk_mul_f32 v[168:169], v[40:41], v[100:101]
    v_pk_mul_f32 v[170:171], v[44:45], v[100:101]
    v_pk_fma_f32 v[168:169], v[44:45], v[108:109], v[168:169]
    v_pk_fma_f32 v[170:171], v[40:41], v[108:109], v[170:171] neg_lo:[1,0,0] neg_hi:[1,0,0]
    v_pk_mul_f32 v[172:173], v[42:43], v[102:103]
    v_pk_mul_f32 v[174:175], v[46:47], v[102:103]
    v_pk_fma_f32 v[172:173], v[46:47], v[110:111], v[172:173]
    v_pk_fma_f32 v[174:175], v[42:43], v[110:111], v[174:175] neg_lo:[1,0,0] neg_hi:[1,0,0]
    v_cvt_pk_bf16_f32 v156, v168, v170
    v_cvt_pk_bf16_f32 v157, v169, v171
    v_cvt_pk_bf16_f32 v158, v172, v174
    v_cvt_pk_bf16_f32 v159, v173, v175
    v_pk_mul_f32 v[168:169], v[48:49], v[96:97]
    v_pk_mul_f32 v[170:171], v[52:53], v[96:97]
    v_pk_fma_f32 v[168:169], v[52:53], v[104:105], v[168:169]
    v_pk_fma_f32 v[170:171], v[48:49], v[104:105], v[170:171] neg_lo:[1,0,0] neg_hi:[1,0,0]
    v_pk_mul_f32 v[172:173], v[50:51], v[98:99]
    v_pk_mul_f32 v[174:175], v[54:55], v[98:99]
    v_pk_fma_f32 v[172:173], v[54:55], v[106:107], v[172:173]
    v_pk_fma_f32 v[174:175], v[50:51], v[106:107], v[174:175] neg_lo:[1,0,0] neg_hi:[1,0,0]
    v_cvt_pk_bf16_f32 v160, v168, v170
    v_cvt_pk_bf16_f32 v161, v169, v171
    v_cvt_pk_bf16_f32 v162, v172, v174
    v_cvt_pk_bf16_f32 v163, v173, v175
    v_pk_mul_f32 v[168:169], v[56:57], v[100:101]
    v_pk_mul_f32 v[170:171], v[60:61], v[100:101]
    v_pk_fma_f32 v[168:169], v[60:61], v[108:109], v[168:169]
    v_pk_fma_f32 v[170:171], v[56:57], v[108:109], v[170:171] neg_lo:[1,0,0] neg_hi:[1,0,0]
    v_pk_mul_f32 v[172:173], v[58:59], v[102:103]
    v_pk_mul_f32 v[174:175], v[62:63], v[102:103]
    v_pk_fma_f32 v[172:173], v[62:63], v[110:111], v[172:173]
    v_pk_fma_f32 v[174:175], v[58:59], v[110:111], v[174:175] neg_lo:[1,0,0] neg_hi:[1,0,0]
    v_cvt_pk_bf16_f32 v164, v168, v170
    v_cvt_pk_bf16_f32 v165, v169, v171
    v_cvt_pk_bf16_f32 v166, v172, v174
    v_cvt_pk_bf16_f32 v167, v173, v175
    v_mfma_f32_16x16x32_bf16 v[32:35], a[224:227], v[152:155], 0
    v_mfma_f32_16x16x32_bf16 v[36:39], a[228:231], v[152:155], 0
    v_mfma_f32_16x16x32_bf16 v[40:43], a[224:227], v[156:159], 0
    v_mfma_f32_16x16x32_bf16 v[44:47], a[228:231], v[156:159], 0
    v_mfma_f32_16x16x32_bf16 v[48:51], a[224:227], v[160:163], 0
    v_mfma_f32_16x16x32_bf16 v[52:55], a[228:231], v[160:163], 0
    v_mfma_f32_16x16x32_bf16 v[56:59], a[224:227], v[164:167], 0
    v_mfma_f32_16x16x32_bf16 v[60:63], a[228:231], v[164:167], 0
    s_nop 0
    s_nop 0
    v_pk_fma_f32 v[216:217], v[32:33], v[128:129], v[216:217] op_sel_hi:[1,0,1]
    v_pk_fma_f32 v[220:221], v[36:37], v[128:129], v[220:221] op_sel_hi:[1,0,1] neg_lo:[1,0,0] neg_hi:[1,0,0]
    v_pk_fma_f32 v[224:225], v[40:41], v[128:129], v[224:225] op_sel_hi:[1,0,1]
    v_pk_fma_f32 v[228:229], v[44:45], v[128:129], v[228:229] op_sel_hi:[1,0,1] neg_lo:[1,0,0] neg_hi:[1,0,0]
    v_pk_fma_f32 v[232:233], v[48:49], v[128:129], v[232:233] op_sel:[0,1,0]
    v_pk_fma_f32 v[236:237], v[52:53], v[128:129], v[236:237] op_sel:[0,1,0] neg_lo:[1,0,0] neg_hi:[1,0,0]
    v_pk_fma_f32 v[240:241], v[56:57], v[128:129], v[240:241] op_sel:[0,1,0]
    v_pk_fma_f32 v[244:245], v[60:61], v[128:129], v[244:245] op_sel:[0,1,0] neg_lo:[1,0,0] neg_hi:[1,0,0]
    v_cvt_pk_bf16_f32 v184, v216, v220
    v_cvt_pk_bf16_f32 v185, v224, v228
    v_cvt_pk_bf16_f32 v186, v232, v236
    v_cvt_pk_bf16_f32 v187, v240, v244
    buffer_store_dwordx4 v[184:187], v4, s[24:27], s75 offen sc1
    s_add_u32 s75, s75, 16384
    v_cvt_pk_bf16_f32 v188, v217, v221
    v_cvt_pk_bf16_f32 v189, v225, v229
    v_cvt_pk_bf16_f32 v190, v233, v237
    v_cvt_pk_bf16_f32 v191, v241, v245
    buffer_store_dwordx4 v[188:191], v4, s[24:27], s75 offen sc1
    s_add_u32 s75, s75, 16384
    v_pk_fma_f32 v[218:219], v[34:35], v[128:129], v[218:219] op_sel_hi:[1,0,1]
    v_pk_fma_f32 v[222:223], v[38:39], v[128:129], v[222:223] op_sel_hi:[1,0,1] neg_lo:[1,0,0] neg_hi:[1,0,0]
    v_pk_fma_f32 v[226:227], v[42:43], v[128:129], v[226:227] op_sel_hi:[1,0,1]
    v_pk_fma_f32 v[230:231], v[46:47], v[128:129], v[230:231] op_sel_hi:[1,0,1] neg_lo:[1,0,0] neg_hi:[1,0,0]
    v_pk_fma_f32 v[234:235], v[50:51], v[128:129], v[234:235] op_sel:[0,1,0]
    v_pk_fma_f32 v[238:239], v[54:55], v[128:129], v[238:239] op_sel:[0,1,0] neg_lo:[1,0,0] neg_hi:[1,0,0]
    v_pk_fma_f32 v[242:243], v[58:59], v[128:129], v[242:243] op_sel:[0,1,0]
    v_pk_fma_f32 v[246:247], v[62:63], v[128:129], v[246:247] op_sel:[0,1,0] neg_lo:[1,0,0] neg_hi:[1,0,0]
    v_cvt_pk_bf16_f32 v192, v218, v222
    v_cvt_pk_bf16_f32 v193, v226, v230
    v_cvt_pk_bf16_f32 v194, v234, v238
    v_cvt_pk_bf16_f32 v195, v242, v246
    buffer_store_dwordx4 v[192:195], v4, s[24:27], s75 offen sc1
    s_add_u32 s75, s75, 16384
    v_cvt_pk_bf16_f32 v196, v219, v223
    v_cvt_pk_bf16_f32 v197, v227, v231
    v_cvt_pk_bf16_f32 v198, v235, v239
    v_cvt_pk_bf16_f32 v199, v243, v247
    buffer_store_dwordx4 v[196:199], v4, s[24:27], s75 offen sc1
    s_waitcnt vmcnt(8)
    s_barrier
    ds_read_b128 v[152:155], v20 offset:0
    ds_read_b128 v[156:159], v20 offset:2048
    ds_read_b128 v[160:163], v20 offset:4096
    ds_read_b128 v[164:167], v20 offset:6144
    s_lshl_b32 s69, s4, 6
    s_add_u32 s68, s69, 22327296
    v_mov_b32 v28, s35
    buffer_store_dword v28, v30, s[24:27], s68 offen sc1
    s_add_u32 s69, s69, 22310912
    s_lshl_b32 s70, s32, 10
    s_waitcnt lgkmcnt(0)
    v_mfma_f32_16x16x32_bf16 v[32:35], v[64:67], v[152:155], 0
    ds_read_b128 v[168:171], v21 offset:0
    s_add_u32 s70, s70, 22310912
    v_mfma_f32_16x16x32_bf16 v[48:51], v[80:83], v[152:155], 0
    ds_read_b128 v[172:175], v21 offset:2048
    v_lshl_add_u32 v5, v1, 6, s99
    v_mfma_f32_16x16x32_bf16 v[36:39], v[64:67], v[156:159], 0
    ds_read_b128 v[176:179], v21 offset:4096
    s_xor_b32 s38, s33, 264
    v_mfma_f32_16x16x32_bf16 v[52:55], v[80:83], v[156:159], 0
    ds_read_b128 v[180:183], v21 offset:6144
    s_lshl_b32 s38, s38, 6
    v_mfma_f32_16x16x32_bf16 v[40:43], v[64:67], v[160:163], 0
    s_add_u32 s38, s38, s99
    v_mfma_f32_16x16x32_bf16 v[56:59], v[80:83], v[160:163], 0
    v_mov_b32_e64 v9, s38
    v_mfma_f32_16x16x32_bf16 v[44:47], v[64:67], v[164:167], 0
    s_bfe_u32 s72, s97, 262156
    v_mfma_f32_16x16x32_bf16 v[60:63], v[80:83], v[164:167], 0
    s_waitcnt lgkmcnt(0)
    s_nop 0
    v_mfma_f32_16x16x32_bf16 v[32:35], v[68:71], v[168:171], v[32:35]
    ds_read_b128 v[152:155], v22 offset:0
    s_add_u32 m0, s37, 49152
    v_mfma_f32_16x16x32_bf16 v[48:51], v[84:87], v[168:171], v[48:51]
    ds_read_b128 v[156:159], v22 offset:2048
    s_lshl_b32 s72, s72, 7
    s_nop 0
    v_mfma_f32_16x16x32_bf16 v[36:39], v[68:71], v[172:175], v[36:39]
    ds_read_b128 v[160:163], v22 offset:4096
    buffer_load_dwordx4 v16, s[16:19], s72 offen offset:0 nt lds
    v_mfma_f32_16x16x32_bf16 v[52:55], v[84:87], v[172:175], v[52:55]
    ds_read_b128 v[164:167], v22 offset:6144
    v_mfma_f32_16x16x32_bf16 v[40:43], v[68:71], v[176:179], v[40:43]
    buffer_load_dwordx4 v17, s[16:19], s72 offen offset:1024 nt lds
    v_mfma_f32_16x16x32_bf16 v[56:59], v[84:87], v[176:179], v[56:59]
    buffer_load_dwordx4 v18, s[16:19], s72 offen offset:2048 nt lds
    v_mfma_f32_16x16x32_bf16 v[44:47], v[68:71], v[180:183], v[44:47]
    buffer_load_dwordx4 v19, s[16:19], s72 offen offset:3072 nt lds
    v_mfma_f32_16x16x32_bf16 v[60:63], v[84:87], v[180:183], v[60:63]
    s_waitcnt lgkmcnt(0)
    s_nop 0
    v_mfma_f32_16x16x32_bf16 v[32:35], v[72:75], v[152:155], v[32:35]
    ds_read_b128 v[168:171], v23 offset:0
    s_bfe_u32 s72, s97, 262160
    v_mfma_f32_16x16x32_bf16 v[48:51], v[88:91], v[152:155], v[48:51]
    ds_read_b128 v[172:175], v23 offset:2048
    s_add_u32 m0, s37, 65536
    v_mfma_f32_16x16x32_bf16 v[36:39], v[72:75], v[156:159], v[36:39]
    ds_read_b128 v[176:179], v23 offset:4096
    s_lshl_b32 s72, s72, 7
    s_nop 0
    v_mfma_f32_16x16x32_bf16 v[52:55], v[88:91], v[156:159], v[52:55]
    ds_read_b128 v[180:183], v23 offset:6144
    buffer_load_dwordx4 v16, s[16:19], s72 offen offset:0 nt lds
    v_mfma_f32_16x16x32_bf16 v[40:43], v[72:75], v[160:163], v[40:43]
    buffer_load_dwordx4 v17, s[16:19], s72 offen offset:1024 nt lds
    v_mfma_f32_16x16x32_bf16 v[56:59], v[88:91], v[160:163], v[56:59]
    buffer_load_dwordx4 v18, s[16:19], s72 offen offset:2048 nt lds
    v_mfma_f32_16x16x32_bf16 v[44:47], v[72:75], v[164:167], v[44:47]
    buffer_load_dwordx4 v19, s[16:19], s72 offen offset:3072 nt lds
    v_mfma_f32_16x16x32_bf16 v[60:63], v[88:91], v[164:167], v[60:63]
    s_waitcnt lgkmcnt(0)
    s_nop 0
    v_mfma_f32_16x16x32_bf16 v[32:35], v[76:79], v[168:171], v[32:35]
    ds_read_b128 v[152:155], v20 offset:16384
    s_bfe_u32 s72, s97, 262164
    v_mfma_f32_16x16x32_bf16 v[48:51], v[92:95], v[168:171], v[48:51]
    ds_read_b128 v[156:159], v20 offset:18432
    v_mfma_f32_16x16x32_bf16 v[36:39], v[76:79], v[172:175], v[36:39]
    ds_read_b128 v[160:163], v20 offset:20480
    s_add_u32 m0, s37, 81920
    v_mfma_f32_16x16x32_bf16 v[52:55], v[92:95], v[172:175], v[52:55]
    ds_read_b128 v[164:167], v20 offset:22528
    v_mfma_f32_16x16x32_bf16 v[40:43], v[76:79], v[176:179], v[40:43]
    v_mfma_f32_16x16x32_bf16 v[56:59], v[92:95], v[176:179], v[56:59]
    s_lshl_b32 s72, s72, 7
    v_mfma_f32_16x16x32_bf16 v[44:47], v[76:79], v[180:183], v[44:47]
    v_mfma_f32_16x16x32_bf16 v[60:63], v[92:95], v[180:183], v[60:63]
    s_waitcnt lgkmcnt(0)
    v_mfma_f32_16x16x32_bf16 v[32:35], a[0:3], v[152:155], v[32:35]
    ds_read_b128 v[168:171], v21 offset:16384
    buffer_load_dwordx4 v16, s[16:19], s72 offen offset:0 nt lds
    v_mfma_f32_16x16x32_bf16 v[48:51], a[16:19], v[152:155], v[48:51]
    ds_read_b128 v[172:175], v21 offset:18432
    v_mfma_f32_16x16x32_bf16 v[36:39], a[0:3], v[156:159], v[36:39]
    ds_read_b128 v[176:179], v21 offset:20480
    buffer_load_dwordx4 v17, s[16:19], s72 offen offset:1024 nt lds
    v_mfma_f32_16x16x32_bf16 v[52:55], a[16:19], v[156:159], v[52:55]
    ds_read_b128 v[180:183], v21 offset:22528
    v_mfma_f32_16x16x32_bf16 v[40:43], a[0:3], v[160:163], v[40:43]
    buffer_load_dwordx4 v18, s[16:19], s72 offen offset:2048 nt lds
    v_mfma_f32_16x16x32_bf16 v[56:59], a[16:19], v[160:163], v[56:59]
    v_mfma_f32_16x16x32_bf16 v[44:47], a[0:3], v[164:167], v[44:47]
    buffer_load_dwordx4 v19, s[16:19], s72 offen offset:3072 nt lds
    v_mfma_f32_16x16x32_bf16 v[60:63], a[16:19], v[164:167], v[60:63]
    s_waitcnt lgkmcnt(0)
    s_nop 0
    v_mfma_f32_16x16x32_bf16 v[32:35], a[4:7], v[168:171], v[32:35]
    ds_read_b128 v[152:155], v22 offset:16384
    s_bfe_u32 s72, s97, 262168
    v_mfma_f32_16x16x32_bf16 v[48:51], a[20:23], v[168:171], v[48:51]
    ds_read_b128 v[156:159], v22 offset:18432
    v_mfma_f32_16x16x32_bf16 v[36:39], a[4:7], v[172:175], v[36:39]
    ds_read_b128 v[160:163], v22 offset:20480
    s_add_u32 m0, s37, 98304
    v_mfma_f32_16x16x32_bf16 v[52:55], a[20:23], v[172:175], v[52:55]
    ds_read_b128 v[164:167], v22 offset:22528
    v_mfma_f32_16x16x32_bf16 v[40:43], a[4:7], v[176:179], v[40:43]
    v_mfma_f32_16x16x32_bf16 v[56:59], a[20:23], v[176:179], v[56:59]
    s_lshl_b32 s72, s72, 7
    v_mfma_f32_16x16x32_bf16 v[44:47], a[4:7], v[180:183], v[44:47]
    v_mfma_f32_16x16x32_bf16 v[60:63], a[20:23], v[180:183], v[60:63]
    s_waitcnt lgkmcnt(0)
    v_mfma_f32_16x16x32_bf16 v[32:35], a[8:11], v[152:155], v[32:35]
    ds_read_b128 v[168:171], v23 offset:16384
    buffer_load_dwordx4 v16, s[16:19], s72 offen offset:0 nt lds
    v_mfma_f32_16x16x32_bf16 v[48:51], a[24:27], v[152:155], v[48:51]
    ds_read_b128 v[172:175], v23 offset:18432
    v_mfma_f32_16x16x32_bf16 v[36:39], a[8:11], v[156:159], v[36:39]
    ds_read_b128 v[176:179], v23 offset:20480
    buffer_load_dwordx4 v17, s[16:19], s72 offen offset:1024 nt lds
    v_mfma_f32_16x16x32_bf16 v[52:55], a[24:27], v[156:159], v[52:55]
    ds_read_b128 v[180:183], v23 offset:22528
    v_mfma_f32_16x16x32_bf16 v[40:43], a[8:11], v[160:163], v[40:43]
    buffer_load_dwordx4 v18, s[16:19], s72 offen offset:2048 nt lds
    v_mfma_f32_16x16x32_bf16 v[56:59], a[24:27], v[160:163], v[56:59]
    v_mfma_f32_16x16x32_bf16 v[44:47], a[8:11], v[164:167], v[44:47]
    buffer_load_dwordx4 v19, s[16:19], s72 offen offset:3072 nt lds
    v_mfma_f32_16x16x32_bf16 v[60:63], a[24:27], v[164:167], v[60:63]
    s_waitcnt lgkmcnt(0) vmcnt(12)
    s_barrier
    v_mfma_f32_16x16x32_bf16 v[32:35], a[12:15], v[168:171], v[32:35]
    ds_read_b128 v[152:155], v20 offset:32768
    s_bfe_u32 s72, s97, 262172
    v_mfma_f32_16x16x32_bf16 v[48:51], a[28:31], v[168:171], v[48:51]
    ds_read_b128 v[156:159], v20 offset:34816
    s_add_u32 m0, s37, 114688
    v_mfma_f32_16x16x32_bf16 v[36:39], a[12:15], v[172:175], v[36:39]
    ds_read_b128 v[160:163], v20 offset:36864
    s_lshl_b32 s72, s72, 7
    s_nop 0
    v_mfma_f32_16x16x32_bf16 v[52:55], a[28:31], v[172:175], v[52:55]
    ds_read_b128 v[164:167], v20 offset:38912
    v_mfma_f32_16x16x32_bf16 v[40:43], a[12:15], v[176:179], v[40:43]
    buffer_load_dwordx4 v16, s[16:19], s72 offen offset:0 nt lds
    v_mfma_f32_16x16x32_bf16 v[56:59], a[28:31], v[176:179], v[56:59]
    buffer_load_dwordx4 v17, s[16:19], s72 offen offset:1024 nt lds
    v_mfma_f32_16x16x32_bf16 v[44:47], a[12:15], v[180:183], v[44:47]
    buffer_load_dwordx4 v18, s[16:19], s72 offen offset:2048 nt lds
    v_mfma_f32_16x16x32_bf16 v[60:63], a[28:31], v[180:183], v[60:63]
    s_waitcnt lgkmcnt(0)
    s_nop 0
    v_mfma_f32_16x16x32_bf16 v[32:35], a[32:35], v[152:155], v[32:35]
    ds_read_b128 v[168:171], v21 offset:32768
    buffer_load_dwordx4 v19, s[16:19], s72 offen offset:3072 nt lds
    v_mfma_f32_16x16x32_bf16 v[48:51], a[48:51], v[152:155], v[48:51]
    ds_read_b128 v[172:175], v21 offset:34816
    s_lshl4_add_u32 s38, s32, s33
    v_mfma_f32_16x16x32_bf16 v[36:39], a[32:35], v[156:159], v[36:39]
    ds_read_b128 v[176:179], v21 offset:36864
    s_lshl_b32 s38, s38, 14
    v_mfma_f32_16x16x32_bf16 v[52:55], a[48:51], v[156:159], v[52:55]
    ds_read_b128 v[180:183], v21 offset:38912
    v_mfma_f32_16x16x32_bf16 v[40:43], a[32:35], v[160:163], v[40:43]
    s_add_u32 s38, s38, s37
    v_mfma_f32_16x16x32_bf16 v[56:59], a[48:51], v[160:163], v[56:59]
    s_add_u32 s38, s38, 13631488
    v_mfma_f32_16x16x32_bf16 v[44:47], a[32:35], v[164:167], v[44:47]
    s_xor_b32 s39, s2, 4
    v_mfma_f32_16x16x32_bf16 v[60:63], a[48:51], v[164:167], v[60:63]
    s_waitcnt lgkmcnt(0)
    v_mfma_f32_16x16x32_bf16 v[32:35], a[36:39], v[168:171], v[32:35]
    ds_read_b128 v[152:155], v22 offset:32768
    s_lshl_b32 s39, s39, 14
    v_mfma_f32_16x16x32_bf16 v[48:51], a[52:55], v[168:171], v[48:51]
    ds_read_b128 v[156:159], v22 offset:34816
    s_add_u32 s39, s39, s37
    s_nop 0
    v_mfma_f32_16x16x32_bf16 v[36:39], a[36:39], v[172:175], v[36:39]
    ds_read_b128 v[160:163], v22 offset:36864
    s_add_u32 s39, s39, 17825792
    v_mfma_f32_16x16x32_bf16 v[52:55], a[52:55], v[172:175], v[52:55]
    ds_read_b128 v[164:167], v22 offset:38912
    v_mfma_f32_16x16x32_bf16 v[40:43], a[36:39], v[176:179], v[40:43]
    s_lshl2_add_u32 s40, s32, s34
    v_mfma_f32_16x16x32_bf16 v[56:59], a[52:55], v[176:179], v[56:59]
    s_lshl_b32 s40, s40, 7
    v_mfma_f32_16x16x32_bf16 v[44:47], a[36:39], v[180:183], v[44:47]
    s_add_u32 s40, s40, 22282240
    v_mfma_f32_16x16x32_bf16 v[60:63], a[52:55], v[180:183], v[60:63]
    s_waitcnt lgkmcnt(0)
    v_mfma_f32_16x16x32_bf16 v[32:35], a[40:43], v[152:155], v[32:35]
    ds_read_b128 v[168:171], v23 offset:32768
    v_lshlrev_b32 v7, 5, v2
    v_mfma_f32_16x16x32_bf16 v[48:51], a[56:59], v[152:155], v[48:51]
    ds_read_b128 v[172:175], v23 offset:34816
    s_lshl3_add_u32 s41, s32, s94
    v_mfma_f32_16x16x32_bf16 v[36:39], a[40:43], v[156:159], v[36:39]
    ds_read_b128 v[176:179], v23 offset:36864
    s_lshl_b32 s41, s41, 8
    v_mfma_f32_16x16x32_bf16 v[52:55], a[56:59], v[156:159], v[52:55]
    ds_read_b128 v[180:183], v23 offset:38912
    s_add_u32 s41, s41, s33
    v_mfma_f32_16x16x32_bf16 v[40:43], a[40:43], v[160:163], v[40:43]
    s_lshl_b32 s41, s41, 8
    v_mfma_f32_16x16x32_bf16 v[56:59], a[56:59], v[160:163], v[56:59]
    v_lshlrev_b32_e64 v8, 14, v2
    v_mfma_f32_16x16x32_bf16 v[44:47], a[40:43], v[164:167], v[44:47]
    v_lshl_add_u32 v8, v1, 4, v8
    v_mfma_f32_16x16x32_bf16 v[60:63], a[56:59], v[164:167], v[60:63]
    s_waitcnt lgkmcnt(0)
    s_barrier
    v_mfma_f32_16x16x32_bf16 v[32:35], a[44:47], v[168:171], v[32:35]
    ds_read_b128 v[152:155], v20 offset:49152
    ds_read_b128 v[156:159], v20 offset:51200
    v_mfma_f32_16x16x32_bf16 v[48:51], a[60:63], v[168:171], v[48:51]
    ds_read_b128 v[160:163], v20 offset:53248
    v_mfma_f32_16x16x32_bf16 v[36:39], a[44:47], v[172:175], v[36:39]
    ds_read_b128 v[164:167], v20 offset:55296
    v_mfma_f32_16x16x32_bf16 v[52:55], a[60:63], v[172:175], v[52:55]
    v_xor_b32 v20, 0x10000, v20
    v_mfma_f32_16x16x32_bf16 v[40:43], a[44:47], v[176:179], v[40:43]
    v_mfma_f32_16x16x32_bf16 v[56:59], a[60:63], v[176:179], v[56:59]
    v_mfma_f32_16x16x32_bf16 v[44:47], a[44:47], v[180:183], v[44:47]
    v_mfma_f32_16x16x32_bf16 v[60:63], a[60:63], v[180:183], v[60:63]
    s_waitcnt lgkmcnt(0)
    v_mfma_f32_16x16x32_bf16 v[32:35], a[64:67], v[152:155], v[32:35]
    ds_read_b128 v[168:171], v21 offset:49152
    ds_read_b128 v[172:175], v21 offset:51200
    v_mov_b32 v28, s35
    v_mfma_f32_16x16x32_bf16 v[48:51], a[80:83], v[152:155], v[48:51]
    ds_read_b128 v[176:179], v21 offset:53248
    v_mfma_f32_16x16x32_bf16 v[36:39], a[64:67], v[156:159], v[36:39]
    ds_read_b128 v[180:183], v21 offset:55296
    v_mfma_f32_16x16x32_bf16 v[52:55], a[80:83], v[156:159], v[52:55]
    v_xor_b32 v21, 0x10000, v21
    v_mfma_f32_16x16x32_bf16 v[40:43], a[64:67], v[160:163], v[40:43]
    v_mfma_f32_16x16x32_bf16 v[56:59], a[80:83], v[160:163], v[56:59]
    v_mfma_f32_16x16x32_bf16 v[44:47], a[64:67], v[164:167], v[44:47]
    v_mfma_f32_16x16x32_bf16 v[60:63], a[80:83], v[164:167], v[60:63]
    s_waitcnt lgkmcnt(0)
    s_nop 0
    v_mfma_f32_16x16x32_bf16 v[32:35], a[68:71], v[168:171], v[32:35]
    ds_read_b128 v[152:155], v22 offset:49152
    ds_read_b128 v[156:159], v22 offset:51200
    v_mfma_f32_16x16x32_bf16 v[48:51], a[84:87], v[168:171], v[48:51]
    ds_read_b128 v[160:163], v22 offset:53248
    v_mfma_f32_16x16x32_bf16 v[36:39], a[68:71], v[172:175], v[36:39]
    ds_read_b128 v[164:167], v22 offset:55296
    v_mfma_f32_16x16x32_bf16 v[52:55], a[84:87], v[172:175], v[52:55]
    v_xor_b32 v22, 0x10000, v22
    v_mfma_f32_16x16x32_bf16 v[40:43], a[68:71], v[176:179], v[40:43]
    v_mfma_f32_16x16x32_bf16 v[56:59], a[84:87], v[176:179], v[56:59]
    v_mfma_f32_16x16x32_bf16 v[44:47], a[68:71], v[180:183], v[44:47]
    v_mfma_f32_16x16x32_bf16 v[60:63], a[84:87], v[180:183], v[60:63]
    s_waitcnt lgkmcnt(0)
    s_nop 0
    v_mfma_f32_16x16x32_bf16 v[32:35], a[72:75], v[152:155], v[32:35]
    ds_read_b128 v[168:171], v23 offset:49152
    ds_read_b128 v[172:175], v23 offset:51200
    buffer_store_dword v28, v30, s[24:27], s69 offen sc1
    v_mfma_f32_16x16x32_bf16 v[48:51], a[88:91], v[152:155], v[48:51]
    ds_read_b128 v[176:179], v23 offset:53248
    v_mfma_f32_16x16x32_bf16 v[36:39], a[72:75], v[156:159], v[36:39]
    ds_read_b128 v[180:183], v23 offset:55296
    v_mfma_f32_16x16x32_bf16 v[52:55], a[88:91], v[156:159], v[52:55]
    v_xor_b32 v23, 0x10000, v23
    v_mfma_f32_16x16x32_bf16 v[40:43], a[72:75], v[160:163], v[40:43]
    buffer_load_dword v6, v9, s[24:27], s70 offen sc1
    v_mfma_f32_16x16x32_bf16 v[56:59], a[88:91], v[160:163], v[56:59]
    v_mfma_f32_16x16x32_bf16 v[44:47], a[72:75], v[164:167], v[44:47]
    v_mfma_f32_16x16x32_bf16 v[60:63], a[88:91], v[164:167], v[60:63]
    s_waitcnt lgkmcnt(0) vmcnt(2)
    s_barrier
    v_mfma_f32_16x16x32_bf16 v[32:35], a[76:79], v[168:171], v[32:35]
    ds_read_b128 v[152:155], v20 offset:0
    v_mfma_f32_16x16x32_bf16 v[48:51], a[92:95], v[168:171], v[48:51]
    ds_read_b128 v[156:159], v20 offset:2048
    v_mfma_f32_16x16x32_bf16 v[36:39], a[76:79], v[172:175], v[36:39]
    ds_read_b128 v[160:163], v20 offset:4096
    v_mfma_f32_16x16x32_bf16 v[52:55], a[92:95], v[172:175], v[52:55]
    ds_read_b128 v[164:167], v20 offset:6144
    v_mfma_f32_16x16x32_bf16 v[40:43], a[76:79], v[176:179], v[40:43]
    v_mfma_f32_16x16x32_bf16 v[56:59], a[92:95], v[176:179], v[56:59]
    v_mfma_f32_16x16x32_bf16 v[44:47], a[76:79], v[180:183], v[44:47]
    v_mfma_f32_16x16x32_bf16 v[60:63], a[92:95], v[180:183], v[60:63]
    s_waitcnt lgkmcnt(0)
    s_nop 0
    v_mfma_f32_16x16x32_bf16 v[32:35], a[96:99], v[152:155], v[32:35]
    ds_read_b128 v[168:171], v21 offset:0
    v_mfma_f32_16x16x32_bf16 v[48:51], a[112:115], v[152:155], v[48:51]
    ds_read_b128 v[172:175], v21 offset:2048
    v_mfma_f32_16x16x32_bf16 v[36:39], a[96:99], v[156:159], v[36:39]
    ds_read_b128 v[176:179], v21 offset:4096
    v_mfma_f32_16x16x32_bf16 v[52:55], a[112:115], v[156:159], v[52:55]
    ds_read_b128 v[180:183], v21 offset:6144
    v_mfma_f32_16x16x32_bf16 v[40:43], a[96:99], v[160:163], v[40:43]
    v_mfma_f32_16x16x32_bf16 v[56:59], a[112:115], v[160:163], v[56:59]
    v_mfma_f32_16x16x32_bf16 v[44:47], a[96:99], v[164:167], v[44:47]
    v_mfma_f32_16x16x32_bf16 v[60:63], a[112:115], v[164:167], v[60:63]
    s_waitcnt lgkmcnt(0)
    s_nop 0
    v_mfma_f32_16x16x32_bf16 v[32:35], a[100:103], v[168:171], v[32:35]
    ds_read_b128 v[152:155], v22 offset:0
    v_mfma_f32_16x16x32_bf16 v[48:51], a[116:119], v[168:171], v[48:51]
    ds_read_b128 v[156:159], v22 offset:2048
    v_mfma_f32_16x16x32_bf16 v[36:39], a[100:103], v[172:175], v[36:39]
    ds_read_b128 v[160:163], v22 offset:4096
    v_mfma_f32_16x16x32_bf16 v[52:55], a[116:119], v[172:175], v[52:55]
    ds_read_b128 v[164:167], v22 offset:6144
    v_mfma_f32_16x16x32_bf16 v[40:43], a[100:103], v[176:179], v[40:43]
    v_mfma_f32_16x16x32_bf16 v[56:59], a[116:119], v[176:179], v[56:59]
    v_mfma_f32_16x16x32_bf16 v[44:47], a[100:103], v[180:183], v[44:47]
    v_mfma_f32_16x16x32_bf16 v[60:63], a[116:119], v[180:183], v[60:63]
    s_waitcnt lgkmcnt(0)
    s_nop 0
    v_mfma_f32_16x16x32_bf16 v[32:35], a[104:107], v[152:155], v[32:35]
    ds_read_b128 v[168:171], v23 offset:0
    v_mfma_f32_16x16x32_bf16 v[48:51], a[120:123], v[152:155], v[48:51]
    ds_read_b128 v[172:175], v23 offset:2048
    v_mfma_f32_16x16x32_bf16 v[36:39], a[104:107], v[156:159], v[36:39]
    ds_read_b128 v[176:179], v23 offset:4096
    v_mfma_f32_16x16x32_bf16 v[52:55], a[120:123], v[156:159], v[52:55]
    ds_read_b128 v[180:183], v23 offset:6144
    v_mfma_f32_16x16x32_bf16 v[40:43], a[104:107], v[160:163], v[40:43]
    v_mfma_f32_16x16x32_bf16 v[56:59], a[120:123], v[160:163], v[56:59]
    v_mfma_f32_16x16x32_bf16 v[44:47], a[104:107], v[164:167], v[44:47]
    v_mfma_f32_16x16x32_bf16 v[60:63], a[120:123], v[164:167], v[60:63]
    s_waitcnt lgkmcnt(0) vmcnt(0)
    v_cmp_ne_u32 vcc, s98, v6
    s_nop 0
    s_cbranch_vccnz K_POLL6
K_POLL6_OK:
    s_barrier
    s_nop 0
    v_mfma_f32_16x16x32_bf16 v[32:35], a[108:111], v[168:171], v[32:35]
    ds_read_b128 v[152:155], v20 offset:16384
    buffer_load_dwordx4 v[112:115], v3, s[24:27], s39 offen offset:0 sc1 nt
    v_mfma_f32_16x16x32_bf16 v[48:51], a[124:127], v[168:171], v[48:51]
    ds_read_b128 v[156:159], v20 offset:18432
    v_mfma_f32_16x16x32_bf16 v[36:39], a[108:111], v[172:175], v[36:39]
    ds_read_b128 v[160:163], v20 offset:20480
    buffer_load_dwordx4 v[116:119], v3, s[24:27], s39 offen offset:1024 sc1 nt
    v_mfma_f32_16x16x32_bf16 v[52:55], a[124:127], v[172:175], v[52:55]
    ds_read_b128 v[164:167], v20 offset:22528
    v_mfma_f32_16x16x32_bf16 v[40:43], a[108:111], v[176:179], v[40:43]
    buffer_load_dwordx4 v[120:123], v3, s[24:27], s39 offen offset:2048 sc1 nt
    v_mfma_f32_16x16x32_bf16 v[56:59], a[124:127], v[176:179], v[56:59]
    v_mfma_f32_16x16x32_bf16 v[44:47], a[108:111], v[180:183], v[44:47]
    buffer_load_dwordx4 v[124:127], v3, s[24:27], s39 offen offset:3072 sc1 nt
    v_mfma_f32_16x16x32_bf16 v[60:63], a[124:127], v[180:183], v[60:63]
    s_waitcnt lgkmcnt(0)
    s_nop 0
    v_mfma_f32_16x16x32_bf16 v[32:35], a[128:131], v[152:155], v[32:35]
    ds_read_b128 v[168:171], v21 offset:16384
    v_mfma_f32_16x16x32_bf16 v[48:51], a[144:147], v[152:155], v[48:51]
    ds_read_b128 v[172:175], v21 offset:18432
    v_mfma_f32_16x16x32_bf16 v[36:39], a[128:131], v[156:159], v[36:39]
    ds_read_b128 v[176:179], v21 offset:20480
    v_mfma_f32_16x16x32_bf16 v[52:55], a[144:147], v[156:159], v[52:55]
    ds_read_b128 v[180:183], v21 offset:22528
    v_mfma_f32_16x16x32_bf16 v[40:43], a[128:131], v[160:163], v[40:43]
    v_mfma_f32_16x16x32_bf16 v[56:59], a[144:147], v[160:163], v[56:59]
    v_mfma_f32_16x16x32_bf16 v[44:47], a[128:131], v[164:167], v[44:47]
    v_mfma_f32_16x16x32_bf16 v[60:63], a[144:147], v[164:167], v[60:63]
    s_waitcnt lgkmcnt(0)
    s_nop 0
    v_mfma_f32_16x16x32_bf16 v[32:35], a[132:135], v[168:171], v[32:35]
    ds_read_b128 v[152:155], v22 offset:16384
    v_mfma_f32_16x16x32_bf16 v[48:51], a[148:151], v[168:171], v[48:51]
    ds_read_b128 v[156:159], v22 offset:18432
    v_mfma_f32_16x16x32_bf16 v[36:39], a[132:135], v[172:175], v[36:39]
    ds_read_b128 v[160:163], v22 offset:20480
    v_mfma_f32_16x16x32_bf16 v[52:55], a[148:151], v[172:175], v[52:55]
    ds_read_b128 v[164:167], v22 offset:22528
    v_mfma_f32_16x16x32_bf16 v[40:43], a[132:135], v[176:179], v[40:43]
    v_mfma_f32_16x16x32_bf16 v[56:59], a[148:151], v[176:179], v[56:59]
    v_mfma_f32_16x16x32_bf16 v[44:47], a[132:135], v[180:183], v[44:47]
    v_mfma_f32_16x16x32_bf16 v[60:63], a[148:151], v[180:183], v[60:63]
    s_waitcnt lgkmcnt(0)
    s_nop 0
    v_mfma_f32_16x16x32_bf16 v[32:35], a[136:139], v[152:155], v[32:35]
    ds_read_b128 v[168:171], v23 offset:16384
    buffer_load_dword v4, v5, s[24:27], s70 offen sc1
    v_mfma_f32_16x16x32_bf16 v[48:51], a[152:155], v[152:155], v[48:51]
    ds_read_b128 v[172:175], v23 offset:18432
    v_mfma_f32_16x16x32_bf16 v[36:39], a[136:139], v[156:159], v[36:39]
    ds_read_b128 v[176:179], v23 offset:20480
    v_mfma_f32_16x16x32_bf16 v[52:55], a[152:155], v[156:159], v[52:55]
    ds_read_b128 v[180:183], v23 offset:22528
    v_mfma_f32_16x16x32_bf16 v[40:43], a[136:139], v[160:163], v[40:43]
    v_mfma_f32_16x16x32_bf16 v[56:59], a[152:155], v[160:163], v[56:59]
    v_mfma_f32_16x16x32_bf16 v[44:47], a[136:139], v[164:167], v[44:47]
    v_mfma_f32_16x16x32_bf16 v[60:63], a[152:155], v[164:167], v[60:63]
    s_waitcnt lgkmcnt(0)
    s_nop 0
    v_mfma_f32_16x16x32_bf16 v[32:35], a[140:143], v[168:171], v[32:35]
    ds_read_b128 v[152:155], v20 offset:32768
    v_mfma_f32_16x16x32_bf16 v[48:51], a[156:159], v[168:171], v[48:51]
    ds_read_b128 v[156:159], v20 offset:34816
    v_mfma_f32_16x16x32_bf16 v[36:39], a[140:143], v[172:175], v[36:39]
    ds_read_b128 v[160:163], v20 offset:36864
    v_mfma_f32_16x16x32_bf16 v[52:55], a[156:159], v[172:175], v[52:55]
    ds_read_b128 v[164:167], v20 offset:38912
    v_mfma_f32_16x16x32_bf16 v[40:43], a[140:143], v[176:179], v[40:43]
    v_mfma_f32_16x16x32_bf16 v[56:59], a[156:159], v[176:179], v[56:59]
    v_mfma_f32_16x16x32_bf16 v[44:47], a[140:143], v[180:183], v[44:47]
    v_mfma_f32_16x16x32_bf16 v[60:63], a[156:159], v[180:183], v[60:63]
    s_waitcnt lgkmcnt(0)
    s_nop 0
    v_mfma_f32_16x16x32_bf16 v[32:35], a[160:163], v[152:155], v[32:35]
    ds_read_b128 v[168:171], v21 offset:32768
    v_mfma_f32_16x16x32_bf16 v[48:51], a[176:179], v[152:155], v[48:51]
    ds_read_b128 v[172:175], v21 offset:34816
    v_mfma_f32_16x16x32_bf16 v[36:39], a[160:163], v[156:159], v[36:39]
    ds_read_b128 v[176:179], v21 offset:36864
    v_mfma_f32_16x16x32_bf16 v[52:55], a[176:179], v[156:159], v[52:55]
    ds_read_b128 v[180:183], v21 offset:38912
    v_mfma_f32_16x16x32_bf16 v[40:43], a[160:163], v[160:163], v[40:43]
    v_mfma_f32_16x16x32_bf16 v[56:59], a[176:179], v[160:163], v[56:59]
    v_mfma_f32_16x16x32_bf16 v[44:47], a[160:163], v[164:167], v[44:47]
    v_mfma_f32_16x16x32_bf16 v[60:63], a[176:179], v[164:167], v[60:63]
    s_waitcnt lgkmcnt(0)
    s_nop 0
    v_mfma_f32_16x16x32_bf16 v[32:35], a[164:167], v[168:171], v[32:35]
    ds_read_b128 v[152:155], v22 offset:32768
    v_mfma_f32_16x16x32_bf16 v[48:51], a[180:183], v[168:171], v[48:51]
    ds_read_b128 v[156:159], v22 offset:34816
    v_mfma_f32_16x16x32_bf16 v[36:39], a[164:167], v[172:175], v[36:39]
    ds_read_b128 v[160:163], v22 offset:36864
    v_mfma_f32_16x16x32_bf16 v[52:55], a[180:183], v[172:175], v[52:55]
    ds_read_b128 v[164:167], v22 offset:38912
    v_mfma_f32_16x16x32_bf16 v[40:43], a[164:167], v[176:179], v[40:43]
    v_mfma_f32_16x16x32_bf16 v[56:59], a[180:183], v[176:179], v[56:59]
    v_mfma_f32_16x16x32_bf16 v[44:47], a[164:167], v[180:183], v[44:47]
    v_mfma_f32_16x16x32_bf16 v[60:63], a[180:183], v[180:183], v[60:63]
    s_waitcnt lgkmcnt(0)
    s_nop 0
    v_mfma_f32_16x16x32_bf16 v[32:35], a[168:171], v[152:155], v[32:35]
    ds_read_b128 v[168:171], v23 offset:32768
    v_mfma_f32_16x16x32_bf16 v[48:51], a[184:187], v[152:155], v[48:51]
    ds_read_b128 v[172:175], v23 offset:34816
    v_mfma_f32_16x16x32_bf16 v[36:39], a[168:171], v[156:159], v[36:39]
    ds_read_b128 v[176:179], v23 offset:36864
    v_mfma_f32_16x16x32_bf16 v[52:55], a[184:187], v[156:159], v[52:55]
    ds_read_b128 v[180:183], v23 offset:38912
    v_mfma_f32_16x16x32_bf16 v[40:43], a[168:171], v[160:163], v[40:43]
    v_mfma_f32_16x16x32_bf16 v[56:59], a[184:187], v[160:163], v[56:59]
    v_mfma_f32_16x16x32_bf16 v[44:47], a[168:171], v[164:167], v[44:47]
    v_mfma_f32_16x16x32_bf16 v[60:63], a[184:187], v[164:167], v[60:63]
    s_waitcnt lgkmcnt(0) vmcnt(0)
    v_cmp_ne_u32 vcc, s98, v4
    s_nop 0
    s_cbranch_vccnz K_POLL5
K_POLL5_OK:
    s_barrier
    s_nop 0
    v_mfma_f32_16x16x32_bf16 v[32:35], a[172:175], v[168:171], v[32:35]
    ds_read_b128 v[152:155], v20 offset:49152
    ds_read_b128 v[156:159], v20 offset:51200
    buffer_load_dwordx4 v[128:131], v7, s[24:27], s40 offen offset:0 sc1
    v_mfma_f32_16x16x32_bf16 v[48:51], a[188:191], v[168:171], v[48:51]
    ds_read_b128 v[160:163], v20 offset:53248
    buffer_load_dwordx4 v[132:135], v7, s[24:27], s40 offen offset:16 sc1
    v_mfma_f32_16x16x32_bf16 v[36:39], a[172:175], v[172:175], v[36:39]
    ds_read_b128 v[164:167], v20 offset:55296
    buffer_load_dwordx4 v[96:99], v3, s[24:27], s38 offen offset:0 sc1 nt
    v_mfma_f32_16x16x32_bf16 v[52:55], a[188:191], v[172:175], v[52:55]
    v_xor_b32 v20, 0x10000, v20
    v_mfma_f32_16x16x32_bf16 v[40:43], a[172:175], v[176:179], v[40:43]
    buffer_load_dwordx4 v[100:103], v3, s[24:27], s38 offen offset:1024 sc1 nt
    v_mfma_f32_16x16x32_bf16 v[56:59], a[188:191], v[176:179], v[56:59]
    buffer_load_dwordx4 v[104:107], v3, s[24:27], s38 offen offset:2048 sc1 nt
    v_mfma_f32_16x16x32_bf16 v[44:47], a[172:175], v[180:183], v[44:47]
    buffer_load_dwordx4 v[108:111], v3, s[24:27], s38 offen offset:3072 sc1 nt
    v_mfma_f32_16x16x32_bf16 v[60:63], a[188:191], v[180:183], v[60:63]
    s_waitcnt lgkmcnt(0)
    v_mfma_f32_16x16x32_bf16 v[32:35], a[192:195], v[152:155], v[32:35]
    ds_read_b128 v[168:171], v21 offset:49152
    ds_read_b128 v[172:175], v21 offset:51200
    v_lshlrev_b32 v216, 16, v112
    v_mfma_f32_16x16x32_bf16 v[48:51], a[208:211], v[152:155], v[48:51]
    ds_read_b128 v[176:179], v21 offset:53248
    v_and_b32 v217, 0xffff0000, v112
    v_mfma_f32_16x16x32_bf16 v[36:39], a[192:195], v[156:159], v[36:39]
    ds_read_b128 v[180:183], v21 offset:55296
    v_lshlrev_b32_e64 v218, 16, v113
    v_and_b32 v219, 0xffff0000, v113
    v_mfma_f32_16x16x32_bf16 v[52:55], a[208:211], v[156:159], v[52:55]
    v_xor_b32 v21, 0x10000, v21
    v_lshlrev_b32_e64 v220, 16, v114
    v_mfma_f32_16x16x32_bf16 v[40:43], a[192:195], v[160:163], v[40:43]
    v_and_b32 v221, 0xffff0000, v114
    v_mfma_f32_16x16x32_bf16 v[56:59], a[208:211], v[160:163], v[56:59]
    v_lshlrev_b32_e64 v222, 16, v115
    v_and_b32 v223, 0xffff0000, v115
    v_mfma_f32_16x16x32_bf16 v[44:47], a[192:195], v[164:167], v[44:47]
    v_lshlrev_b32_e64 v224, 16, v116
    v_mfma_f32_16x16x32_bf16 v[60:63], a[208:211], v[164:167], v[60:63]
    v_and_b32 v225, 0xffff0000, v116
    s_waitcnt lgkmcnt(0)
    v_mfma_f32_16x16x32_bf16 v[32:35], a[196:199], v[168:171], v[32:35]
    ds_read_b128 v[152:155], v22 offset:49152
    ds_read_b128 v[156:159], v22 offset:51200
    v_lshlrev_b32 v226, 16, v117
    v_and_b32 v227, 0xffff0000, v117
    v_mfma_f32_16x16x32_bf16 v[48:51], a[212:215], v[168:171], v[48:51]
    ds_read_b128 v[160:163], v22 offset:53248
    v_lshlrev_b32_e64 v228, 16, v118
    v_mfma_f32_16x16x32_bf16 v[36:39], a[196:199], v[172:175], v[36:39]
    ds_read_b128 v[164:167], v22 offset:55296
    v_and_b32 v229, 0xffff0000, v118
    v_lshlrev_b32_e64 v230, 16, v119
    v_mfma_f32_16x16x32_bf16 v[52:55], a[212:215], v[172:175], v[52:55]
    v_xor_b32 v22, 0x10000, v22
    v_and_b32 v231, 0xffff0000, v119
    v_mfma_f32_16x16x32_bf16 v[40:43], a[196:199], v[176:179], v[40:43]
    v_lshlrev_b32_e64 v232, 16, v120
    v_mfma_f32_16x16x32_bf16 v[56:59], a[212:215], v[176:179], v[56:59]
    v_and_b32 v233, 0xffff0000, v120
    v_lshlrev_b32_e64 v234, 16, v121
    v_mfma_f32_16x16x32_bf16 v[44:47], a[196:199], v[180:183], v[44:47]
    v_and_b32 v235, 0xffff0000, v121
    v_mfma_f32_16x16x32_bf16 v[60:63], a[212:215], v[180:183], v[60:63]
    v_lshlrev_b32 v236, 16, v122
    s_waitcnt lgkmcnt(0)
    v_mfma_f32_16x16x32_bf16 v[32:35], a[200:203], v[152:155], v[32:35]
    ds_read_b128 v[168:171], v23 offset:49152
    ds_read_b128 v[172:175], v23 offset:51200
    v_and_b32 v237, 0xffff0000, v122
    v_lshlrev_b32_e64 v238, 16, v123
    v_mfma_f32_16x16x32_bf16 v[48:51], a[216:219], v[152:155], v[48:51]
    ds_read_b128 v[176:179], v23 offset:53248
    v_and_b32 v239, 0xffff0000, v123
    v_mfma_f32_16x16x32_bf16 v[36:39], a[200:203], v[156:159], v[36:39]
    ds_read_b128 v[180:183], v23 offset:55296
    v_lshlrev_b32_e64 v240, 16, v124
    v_and_b32 v241, 0xffff0000, v124
    v_mfma_f32_16x16x32_bf16 v[52:55], a[216:219], v[156:159], v[52:55]
    v_xor_b32 v23, 0x10000, v23
    v_lshlrev_b32_e64 v242, 16, v125
    v_mfma_f32_16x16x32_bf16 v[40:43], a[200:203], v[160:163], v[40:43]
    v_and_b32 v243, 0xffff0000, v125
    v_mfma_f32_16x16x32_bf16 v[56:59], a[216:219], v[160:163], v[56:59]
    v_lshlrev_b32_e64 v244, 16, v126
    v_and_b32 v245, 0xffff0000, v126
    v_mfma_f32_16x16x32_bf16 v[44:47], a[200:203], v[164:167], v[44:47]
    v_lshlrev_b32_e64 v246, 16, v127
    v_mfma_f32_16x16x32_bf16 v[60:63], a[216:219], v[164:167], v[60:63]
    v_and_b32 v247, 0xffff0000, v127
    s_waitcnt lgkmcnt(0)
    s_nop 0
    v_mfma_f32_16x16x32_bf16 v[32:35], a[204:207], v[168:171], v[32:35]
    v_mfma_f32_16x16x32_bf16 v[48:51], a[220:223], v[168:171], v[48:51]
    v_mfma_f32_16x16x32_bf16 v[36:39], a[204:207], v[172:175], v[36:39]
    v_mfma_f32_16x16x32_bf16 v[52:55], a[220:223], v[172:175], v[52:55]
    v_mfma_f32_16x16x32_bf16 v[40:43], a[204:207], v[176:179], v[40:43]
    v_mfma_f32_16x16x32_bf16 v[56:59], a[220:223], v[176:179], v[56:59]
    v_mfma_f32_16x16x32_bf16 v[44:47], a[204:207], v[180:183], v[44:47]
    v_mfma_f32_16x16x32_bf16 v[60:63], a[220:223], v[180:183], v[60:63]
    s_waitcnt vmcnt(3)
    v_add_f32 v216, v216, v32
    s_nop 0
    v_add_f32 v217, v217, v36
    v_lshlrev_b32_e64 v184, 16, v96
    v_and_b32 v185, 0xffff0000, v96
    v_pk_fma_f32 v[184:185], v[216:217], v[128:129], v[184:185] op_sel_hi:[1,0,1]
    v_add_f32 v218, v218, v40
    v_add_f32 v219, v219, v44
    v_lshlrev_b32_e64 v186, 16, v97
    v_and_b32 v187, 0xffff0000, v97
    v_pk_fma_f32 v[186:187], v[218:219], v[128:129], v[186:187] op_sel_hi:[1,0,1]
    s_mov_b32 s39, s41
    buffer_store_dwordx4 v[184:187], v8, s[28:31], s39 offen
    v_add_f32 v220, v220, v48
    v_add_f32 v221, v221, v52
    v_lshlrev_b32 v188, 16, v98
    v_and_b32 v189, 0xffff0000, v98
    v_pk_fma_f32 v[188:189], v[220:221], v[128:129], v[188:189] op_sel:[0,1,0]
    v_add_f32 v222, v222, v56
    v_add_f32 v223, v223, v60
    v_lshlrev_b32_e64 v190, 16, v99
    v_and_b32 v191, 0xffff0000, v99
    v_pk_fma_f32 v[190:191], v[222:223], v[128:129], v[190:191] op_sel:[0,1,0]
    s_add_u32 s39, s41, 131072
    buffer_store_dwordx4 v[188:191], v8, s[28:31], s39 offen
    s_waitcnt vmcnt(4)
    v_add_f32 v224, v224, v33
    v_add_f32 v225, v225, v37
    v_lshlrev_b32 v192, 16, v100
    v_and_b32 v193, 0xffff0000, v100
    v_pk_fma_f32 v[192:193], v[224:225], v[130:131], v[192:193] op_sel_hi:[1,0,1]
    v_add_f32 v226, v226, v41
    v_add_f32 v227, v227, v45
    v_lshlrev_b32_e64 v194, 16, v101
    v_and_b32 v195, 0xffff0000, v101
    v_pk_fma_f32 v[194:195], v[226:227], v[130:131], v[194:195] op_sel_hi:[1,0,1]
    s_add_u32 s39, s41, 4096
    buffer_store_dwordx4 v[192:195], v8, s[28:31], s39 offen
    v_add_f32 v228, v228, v49
    v_add_f32 v229, v229, v53
    v_lshlrev_b32_e64 v196, 16, v102
    v_and_b32 v197, 0xffff0000, v102
    v_pk_fma_f32 v[196:197], v[228:229], v[130:131], v[196:197] op_sel:[0,1,0]
    v_add_f32 v230, v230, v57
    v_add_f32 v231, v231, v61
    v_lshlrev_b32_e64 v198, 16, v103
    v_and_b32 v199, 0xffff0000, v103
    v_pk_fma_f32 v[198:199], v[230:231], v[130:131], v[198:199] op_sel:[0,1,0]
    s_add_u32 s39, s41, 135168
    buffer_store_dwordx4 v[196:199], v8, s[28:31], s39 offen
    s_waitcnt vmcnt(5)
    v_add_f32 v232, v232, v34
    v_add_f32 v233, v233, v38
    v_lshlrev_b32 v200, 16, v104
    v_and_b32 v201, 0xffff0000, v104
    v_pk_fma_f32 v[200:201], v[232:233], v[132:133], v[200:201] op_sel_hi:[1,0,1]
    v_add_f32 v234, v234, v42
    v_add_f32 v235, v235, v46
    v_lshlrev_b32_e64 v202, 16, v105
    v_and_b32 v203, 0xffff0000, v105
    v_pk_fma_f32 v[202:203], v[234:235], v[132:133], v[202:203] op_sel_hi:[1,0,1]
    s_add_u32 s39, s41, 8192
    buffer_store_dwordx4 v[200:203], v8, s[28:31], s39 offen
    v_add_f32 v236, v236, v50
    v_add_f32 v237, v237, v54
    v_lshlrev_b32_e64 v204, 16, v106
    v_and_b32 v205, 0xffff0000, v106
    v_pk_fma_f32 v[204:205], v[236:237], v[132:133], v[204:205] op_sel:[0,1,0]
    v_add_f32 v238, v238, v58
    v_add_f32 v239, v239, v62
    v_lshlrev_b32_e64 v206, 16, v107
    v_and_b32 v207, 0xffff0000, v107
    v_pk_fma_f32 v[206:207], v[238:239], v[132:133], v[206:207] op_sel:[0,1,0]
    s_add_u32 s39, s41, 139264
    buffer_store_dwordx4 v[204:207], v8, s[28:31], s39 offen
    s_waitcnt vmcnt(6)
    v_add_f32 v240, v240, v35
    v_add_f32 v241, v241, v39
    v_lshlrev_b32 v208, 16, v108
    v_and_b32 v209, 0xffff0000, v108
    v_pk_fma_f32 v[208:209], v[240:241], v[134:135], v[208:209] op_sel_hi:[1,0,1]
    v_add_f32 v242, v242, v43
    v_add_f32 v243, v243, v47
    v_lshlrev_b32_e64 v210, 16, v109
    v_and_b32 v211, 0xffff0000, v109
    v_pk_fma_f32 v[210:211], v[242:243], v[134:135], v[210:211] op_sel_hi:[1,0,1]
    s_add_u32 s39, s41, 12288
    buffer_store_dwordx4 v[208:211], v8, s[28:31], s39 offen
    v_add_f32 v244, v244, v51
    v_add_f32 v245, v245, v55
    v_lshlrev_b32_e64 v212, 16, v110
    v_and_b32 v213, 0xffff0000, v110
    v_pk_fma_f32 v[212:213], v[244:245], v[134:135], v[212:213] op_sel:[0,1,0]
    v_add_f32 v246, v246, v59
    v_add_f32 v247, v247, v63
    v_lshlrev_b32_e64 v214, 16, v111
    v_and_b32 v215, 0xffff0000, v111
    v_pk_fma_f32 v[214:215], v[246:247], v[134:135], v[214:215] op_sel:[0,1,0]
    s_add_u32 s39, s41, 143360
    buffer_store_dwordx4 v[212:215], v8, s[28:31], s39 offen
K_END:
    s_endpgm
K_W256:
    s_nop 0
    buffer_load_dwordx4 a[120:123], v3, s[24:27], s37 offen offset:0 sc1
    buffer_load_dwordx4 a[124:127], v3, s[24:27], s37 offen offset:1024 sc1
    buffer_load_dwordx4 a[128:131], v3, s[24:27], s37 offen offset:2048 sc1
    buffer_load_dwordx4 a[132:135], v3, s[24:27], s37 offen offset:3072 sc1
    s_branch K_W256_RET
K_POLL1:
    s_mov_b32 s71, 0
K_POLL1_L:
    s_sleep 2
    buffer_load_dword v216, v3, s[24:27], s68 offen sc1
    s_add_u32 s71, s71, 1
    s_waitcnt vmcnt(0)
    v_cmp_ne_u32 vcc, s35, v216
    s_nop 0
    s_cbranch_vccz K_POLL1_OK
    s_cmp_lt_u32 s71, 200000
    s_cbranch_scc1 K_POLL1_L
    s_branch K_POLL1_OK
K_SPECIAL:
    v_lshl_add_u32 v12, v2, 8, v1
    v_add_u32_e64 v12, s63, v12
    v_sub_u32 v13, 21312, v12
    v_add_u32 v12, 20480, v12
    v_lshlrev_b32 v13, 2, v13
    v_lshlrev_b32 v12, 2, v12
    v_pk_mul_f32 v[224:225], v[224:225], 0.5 op_sel_hi:[1,0]
    v_pk_mul_f32 v[226:227], v[226:227], 0.5 op_sel_hi:[1,0]
    v_pk_mul_f32 v[228:229], v[228:229], 0.5 op_sel_hi:[1,0]
    v_pk_mul_f32 v[230:231], v[230:231], 0.5 op_sel_hi:[1,0]
    v_pk_mul_f32 v[232:233], v[232:233], 0.5 op_sel_hi:[1,0]
    v_pk_mul_f32 v[234:235], v[234:235], 0.5 op_sel_hi:[1,0]
    v_pk_mul_f32 v[236:237], v[236:237], 0.5 op_sel_hi:[1,0]
    v_pk_mul_f32 v[238:239], v[238:239], 0.5 op_sel_hi:[1,0]
    ds_write2st64_b32 v12, v224, v228 offset0:0 offset1:46
    ds_write2st64_b32 v12, v225, v229 offset0:1 offset1:47
    ds_write2st64_b32 v12, v226, v230 offset0:2 offset1:48
    ds_write2st64_b32 v12, v227, v231 offset0:3 offset1:49
    ds_write2st64_b32 v12, v232, v236 offset0:16 offset1:62
    ds_write2st64_b32 v12, v233, v237 offset0:17 offset1:63
    ds_write2st64_b32 v12, v234, v238 offset0:18 offset1:64
    ds_write2st64_b32 v12, v235, v239 offset0:19 offset1:65
    ds_write2st64_b32 v12, v224, v228 offset0:32 offset1:78
    v_accvgpr_read_b32 v8, a120
    v_accvgpr_read_b32 v9, a122
    v_lshlrev_b32 v4, 16, v8
    v_lshlrev_b32 v5, 16, v9
    v_and_b32 v6, 0xffff0000, v8
    v_and_b32 v7, 0xffff0000, v9
    v_pk_mul_f32 v[184:185], v[240:241], v[4:5]
    v_pk_mul_f32 v[188:189], v[244:245], v[4:5]
    v_pk_fma_f32 v[184:185], v[244:245], v[6:7], v[184:185] neg_lo:[1,0,0] neg_hi:[1,0,0]
    v_pk_fma_f32 v[188:189], v[240:241], v[6:7], v[188:189]
    v_accvgpr_read_b32 v8, a124
    v_accvgpr_read_b32 v9, a126
    v_lshlrev_b32 v4, 16, v8
    v_lshlrev_b32 v5, 16, v9
    v_and_b32 v6, 0xffff0000, v8
    v_and_b32 v7, 0xffff0000, v9
    v_pk_mul_f32 v[186:187], v[242:243], v[4:5]
    v_pk_mul_f32 v[190:191], v[246:247], v[4:5]
    v_pk_fma_f32 v[186:187], v[246:247], v[6:7], v[186:187] neg_lo:[1,0,0] neg_hi:[1,0,0]
    v_pk_fma_f32 v[190:191], v[242:243], v[6:7], v[190:191]
    v_accvgpr_read_b32 v8, a128
    v_accvgpr_read_b32 v9, a130
    v_lshlrev_b32 v4, 16, v8
    v_lshlrev_b32 v5, 16, v9
    v_and_b32 v6, 0xffff0000, v8
    v_and_b32 v7, 0xffff0000, v9
    v_pk_mul_f32 v[192:193], v[248:249], v[4:5]
    v_pk_mul_f32 v[196:197], v[252:253], v[4:5]
    v_pk_fma_f32 v[192:193], v[252:253], v[6:7], v[192:193] neg_lo:[1,0,0] neg_hi:[1,0,0]
    v_pk_fma_f32 v[196:197], v[248:249], v[6:7], v[196:197]
    v_accvgpr_read_b32 v8, a132
    v_accvgpr_read_b32 v9, a134
    v_lshlrev_b32 v4, 16, v8
    v_lshlrev_b32 v5, 16, v9
    v_and_b32 v6, 0xffff0000, v8
    v_and_b32 v7, 0xffff0000, v9
    v_pk_mul_f32 v[194:195], v[250:251], v[4:5]
    v_pk_mul_f32 v[198:199], v[254:255], v[4:5]
    v_pk_fma_f32 v[194:195], v[254:255], v[6:7], v[194:195] neg_lo:[1,0,0] neg_hi:[1,0,0]
    v_pk_fma_f32 v[198:199], v[250:251], v[6:7], v[198:199]
    s_add_u32 s39, s62, 1
    v_mov_b32 v6, s39
    s_mov_b32 s39, 22343680
    buffer_store_dword v6, v30, s[24:27], s39 offen sc1
    s_waitcnt lgkmcnt(0)
    s_barrier
    ds_read2st64_b32 v[240:241], v13 offset0:19 offset1:18
    ds_read2st64_b32 v[244:245], v13 offset0:65 offset1:64
    ds_read2st64_b32 v[242:243], v13 offset0:17 offset1:16
    ds_read2st64_b32 v[246:247], v13 offset0:63 offset1:62
    ds_read2st64_b32 v[248:249], v13 offset0:3 offset1:2
    ds_read2st64_b32 v[252:253], v13 offset0:49 offset1:48
    ds_read2st64_b32 v[250:251], v13 offset0:1 offset1:0
    ds_read2st64_b32 v[254:255], v13 offset0:47 offset1:46
    s_waitcnt lgkmcnt(0)
    s_nop 0
    v_pk_mul_f32 v[244:245], v[244:245], -1.0 op_sel_hi:[1,0]
    v_pk_mul_f32 v[246:247], v[246:247], -1.0 op_sel_hi:[1,0]
    v_pk_mul_f32 v[252:253], v[252:253], -1.0 op_sel_hi:[1,0]
    v_pk_mul_f32 v[254:255], v[254:255], -1.0 op_sel_hi:[1,0]
    s_branch K_SPECIAL_RET
K_SPECIAL2:
    s_nop 0
    ds_write2st64_b32 v12, v240, v244 offset0:92 offset1:138
    ds_write2st64_b32 v12, v241, v245 offset0:93 offset1:139
    ds_write2st64_b32 v12, v242, v246 offset0:94 offset1:140
    ds_write2st64_b32 v12, v243, v247 offset0:95 offset1:141
    ds_write2st64_b32 v12, v248, v252 offset0:108 offset1:154
    ds_write2st64_b32 v12, v249, v253 offset0:109 offset1:155
    ds_write2st64_b32 v12, v250, v254 offset0:110 offset1:156
    ds_write2st64_b32 v12, v251, v255 offset0:111 offset1:157
    ds_write2st64_b32 v12, v240, v244 offset0:124 offset1:170
    s_waitcnt lgkmcnt(0)
    s_barrier
    ds_read2st64_b32 v[240:241], v13 offset0:111 offset1:110
    ds_read2st64_b32 v[244:245], v13 offset0:157 offset1:156
    ds_read2st64_b32 v[242:243], v13 offset0:109 offset1:108
    ds_read2st64_b32 v[246:247], v13 offset0:155 offset1:154
    ds_read2st64_b32 v[248:249], v13 offset0:95 offset1:94
    ds_read2st64_b32 v[252:253], v13 offset0:141 offset1:140
    ds_read2st64_b32 v[250:251], v13 offset0:93 offset1:92
    ds_read2st64_b32 v[254:255], v13 offset0:139 offset1:138
    s_waitcnt lgkmcnt(0)
    s_nop 0
    v_pk_add_f32 v[224:225], v[224:225], v[240:241]
    v_pk_add_f32 v[240:241], v[184:185], v[184:185]
    v_pk_add_f32 v[226:227], v[226:227], v[242:243]
    v_pk_add_f32 v[242:243], v[186:187], v[186:187]
    v_pk_add_f32 v[228:229], v[228:229], v[244:245] neg_lo:[0,1] neg_hi:[0,1]
    v_pk_add_f32 v[244:245], v[188:189], v[188:189]
    v_pk_add_f32 v[230:231], v[230:231], v[246:247] neg_lo:[0,1] neg_hi:[0,1]
    v_pk_add_f32 v[246:247], v[190:191], v[190:191]
    v_pk_add_f32 v[232:233], v[232:233], v[248:249]
    v_pk_add_f32 v[248:249], v[192:193], v[192:193]
    v_pk_add_f32 v[234:235], v[234:235], v[250:251]
    v_pk_add_f32 v[250:251], v[194:195], v[194:195]
    v_pk_add_f32 v[236:237], v[236:237], v[252:253] neg_lo:[0,1] neg_hi:[0,1]
    v_pk_add_f32 v[252:253], v[196:197], v[196:197]
    v_pk_add_f32 v[238:239], v[238:239], v[254:255] neg_lo:[0,1] neg_hi:[0,1]
    v_pk_add_f32 v[254:255], v[198:199], v[198:199]
    s_barrier
    s_branch K_SPECIAL2_RET
K_POLL2:
    s_mov_b32 s71, 0
K_POLL2_L:
    s_nop 0
    buffer_load_dwordx4 v[96:99], v148, s[24:27], s93 offen sc1
    buffer_load_dwordx4 v[100:103], v149, s[24:27], s93 offen sc1
    buffer_load_dwordx4 v[104:107], v150, s[24:27], s93 offen sc1
    buffer_load_dwordx4 v[108:111], v151, s[24:27], s93 offen sc1
    s_add_u32 s71, s71, 1
    s_waitcnt vmcnt(0)
    v_cmp_ne_u32 vcc, 2.0, v148
    v_xor_b32 v4, s35, v98
    s_nop 0
    v_cndmask_b32 v4, 0, v4, vcc
    v_cmp_ne_u32 vcc, 2.0, v149
    v_xor_b32 v5, s35, v102
    s_nop 0
    v_cndmask_b32 v5, 0, v5, vcc
    v_cmp_ne_u32 vcc, 2.0, v150
    v_xor_b32 v6, s35, v106
    s_nop 0
    v_cndmask_b32 v6, 0, v6, vcc
    v_cmp_ne_u32 vcc, 2.0, v151
    v_xor_b32 v7, s35, v110
    s_nop 0
    v_cndmask_b32 v7, 0, v7, vcc
    v_or3_b32 v4, v4, v5, v6
    v_or_b32 v4, v4, v7
    v_cmp_ne_u32 vcc, 0, v4
    s_nop 0
    s_cbranch_vccz K_POLL2_OK
    s_cmp_lt_u32 s71, 200000
    s_cbranch_scc1 K_POLL2_L
    s_branch K_POLL2_OK
K_HFAR:
    ds_write_b128 v12, v[184:187] offset:0
    buffer_store_dwordx4 v[64:67], v24, s[28:31], s68 offen sc1
    v_pk_mul_f32 v[4:5], v[40:41], v[120:121]
    v_pk_mul_f32 v[6:7], v[44:45], v[120:121]
    v_pk_fma_f32 v[4:5], v[44:45], v[124:125], v[4:5]
    v_pk_fma_f32 v[6:7], v[40:41], v[124:125], v[6:7] neg_lo:[1,0,0] neg_hi:[1,0,0]
    v_pk_mul_f32 v[8:9], v[42:43], v[122:123]
    buffer_store_dwordx4 v[68:71], v25, s[28:31], s68 offen sc1
    v_pk_mul_f32 v[10:11], v[46:47], v[122:123]
    v_pk_fma_f32 v[8:9], v[46:47], v[126:127], v[8:9]
    v_pk_fma_f32 v[10:11], v[42:43], v[126:127], v[10:11] neg_lo:[1,0,0] neg_hi:[1,0,0]
    v_cvt_pk_bf16_f32 v188, v4, v6
    v_cvt_pk_bf16_f32 v189, v5, v7
    buffer_store_dwordx4 v[72:75], v26, s[28:31], s68 offen sc1
    v_cvt_pk_bf16_f32 v190, v8, v10
    v_cvt_pk_bf16_f32 v191, v9, v11
    ds_write_b128 v12, v[188:191] offset:32
    v_pk_mul_f32 v[4:5], v[48:49], v[112:113]
    v_pk_mul_f32 v[6:7], v[52:53], v[112:113]
    buffer_store_dwordx4 v[76:79], v27, s[28:31], s68 offen sc1
    v_pk_fma_f32 v[4:5], v[52:53], v[116:117], v[4:5]
    v_pk_fma_f32 v[6:7], v[48:49], v[116:117], v[6:7] neg_lo:[1,0,0] neg_hi:[1,0,0]
    v_pk_mul_f32 v[8:9], v[50:51], v[114:115]
    v_pk_mul_f32 v[10:11], v[54:55], v[114:115]
    v_pk_fma_f32 v[8:9], v[54:55], v[118:119], v[8:9]
    buffer_store_dwordx4 v[80:83], v24, s[28:31], s69 offen sc1
    v_pk_fma_f32 v[10:11], v[50:51], v[118:119], v[10:11] neg_lo:[1,0,0] neg_hi:[1,0,0]
    v_cvt_pk_bf16_f32 v192, v4, v6
    v_cvt_pk_bf16_f32 v193, v5, v7
    v_cvt_pk_bf16_f32 v194, v8, v10
    v_cvt_pk_bf16_f32 v195, v9, v11
    buffer_store_dwordx4 v[84:87], v25, s[28:31], s69 offen sc1
    ds_write_b128 v12, v[192:195] offset:16
    v_pk_mul_f32 v[4:5], v[56:57], v[120:121]
    v_pk_mul_f32 v[6:7], v[60:61], v[120:121]
    v_pk_fma_f32 v[4:5], v[60:61], v[124:125], v[4:5]
    v_pk_fma_f32 v[6:7], v[56:57], v[124:125], v[6:7] neg_lo:[1,0,0] neg_hi:[1,0,0]
    buffer_store_dwordx4 v[88:91], v26, s[28:31], s69 offen sc1
    v_pk_mul_f32 v[8:9], v[58:59], v[122:123]
    v_pk_mul_f32 v[10:11], v[62:63], v[122:123]
    v_pk_fma_f32 v[8:9], v[62:63], v[126:127], v[8:9]
    v_pk_fma_f32 v[10:11], v[58:59], v[126:127], v[10:11] neg_lo:[1,0,0] neg_hi:[1,0,0]
    v_cvt_pk_bf16_f32 v196, v4, v6
    buffer_store_dwordx4 v[92:95], v27, s[28:31], s69 offen sc1
    v_cvt_pk_bf16_f32 v197, v5, v7
    v_cvt_pk_bf16_f32 v198, v8, v10
    v_cvt_pk_bf16_f32 v199, v9, v11
    ds_write_b128 v12, v[196:199] offset:48
    s_branch K_HFAR_RET
K_POLL3:
    s_mov_b32 s71, 0
K_POLL3_L:
    s_sleep 2
    buffer_load_dword v4, v5, s[24:27], s51 offen offset:32 sc1
    s_add_u32 s71, s71, 1
    s_waitcnt vmcnt(0)
    v_cmp_ne_u32 vcc, s98, v4
    s_nop 0
    s_cbranch_vccz K_POLL3_OK
    s_cmp_lt_u32 s71, 200000
    s_cbranch_scc1 K_POLL3_L
    s_branch K_POLL3_OK
K_POLL4:
    s_mov_b32 s71, 0
K_POLL4_L:
    s_sleep 2
    buffer_load_dword v8, v3, s[24:27], s70 offen sc1
    s_add_u32 s71, s71, 1
    s_waitcnt vmcnt(0)
    v_cmp_ne_u32 vcc, s35, v8
    s_nop 0
    s_cbranch_vccz K_POLL4_OK
    s_cmp_lt_u32 s71, 200000
    s_cbranch_scc1 K_POLL4_L
    s_branch K_POLL4_OK
K_POLL6:
    s_mov_b32 s71, 0
K_POLL6_L:
    s_sleep 2
    buffer_load_dword v6, v9, s[24:27], s70 offen sc1
    s_add_u32 s71, s71, 1
    s_waitcnt vmcnt(0)
    v_cmp_ne_u32 vcc, s98, v6
    s_nop 0
    s_cbranch_vccz K_POLL6_OK
    s_cmp_lt_u32 s71, 200000
    s_cbranch_scc1 K_POLL6_L
    s_branch K_POLL6_OK
K_POLL5:
    s_mov_b32 s71, 0
K_POLL5_L:
    s_sleep 2
    buffer_load_dword v4, v5, s[24:27], s70 offen sc1
    s_add_u32 s71, s71, 1
    s_waitcnt vmcnt(0)
    v_cmp_ne_u32 vcc, s98, v4
    s_nop 0
    s_cbranch_vccz K_POLL5_OK
    s_cmp_lt_u32 s71, 200000
    s_cbranch_scc1 K_POLL5_L
    s_branch K_POLL5_OK
K_CODE_END:
.section .rodata,"a"
.p2align 6
.amdhsa_kernel gated_mix__spectral_gfnet__ssm_conv_s5__prompt_kernel
  .amdhsa_next_free_vgpr 512
  .amdhsa_next_free_sgpr 102
  .amdhsa_accum_offset 256
  .amdhsa_group_segment_fixed_size 0
  .amdhsa_kernarg_size 128
  .amdhsa_user_sgpr_count 2
  .amdhsa_user_sgpr_kernarg_segment_ptr 1
  .amdhsa_system_sgpr_workgroup_id_x 1
.end_amdhsa_kernel
```

```asm
; @launch grid=(256,1,1) block=(256,1,1) lds=163840
.amdgcn_target "amdgcn-amd-amdhsa--gfx950"
.text
.globl gated_mix__spectral_gfnet__ssm_conv_s5__prompt_kernel
.p2align 8
.type gated_mix__spectral_gfnet__ssm_conv_s5__prompt_kernel,@function
gated_mix__spectral_gfnet__ssm_conv_s5__prompt_kernel:
    s_load_dwordx2 s[8:9], s[0:1], 0
    s_load_dwordx2 s[60:61], s[0:1], 120
    s_cmp_ge_u32 s2, 256
    s_cbranch_scc1 K_END
    s_getpc_b64 s[28:29]
K_PC:
    s_mov_b32 s30, K_CODE_END-K_PC
    s_mov_b32 s31, 0x00020000
    s_lshr_b32 s38, s2, 3
    s_mul_i32 s38, s38, 1280
    v_lshl_add_u32 v4, v0, 3, s38
    v_lshrrev_b32 v3, 6, v0
    buffer_load_dword v255, v4, s[28:31], 0 offen
    s_load_dwordx8 s[52:59], s[0:1], 32
    s_load_dwordx4 s[44:47], s[0:1], 8
    s_load_dwordx8 s[80:87], s[0:1], 64
    s_load_dwordx4 s[88:91], s[0:1], 96
    v_readfirstlane_b32 s34, v3
    v_and_b32 v1, 15, v0
    v_bfe_u32 v2, v0, 4, 2
    s_and_b32 s38, s2, 3
    s_bfe_u32 s39, s2, 0x20003
    s_lshl2_add_u32 s32, s38, s39
    s_bfe_u32 s38, s2, 0x10002
    s_lshr_b32 s39, s2, 5
    s_lshl3_add_u32 s33, s38, s39
    s_and_b32 s6, s34, 1
    s_lshr_b32 s41, s34, 1
    s_lshl1_add_u32 s38, s32, s6
    s_lshl_b32 s38, s38, 5
    s_add_u32 s38, s38, s33
    s_lshl1_add_u32 s68, s38, s41
    s_lshl_b32 s68, s68, 11
    s_add_u32 s69, s68, 65536
    v_lshlrev_b32 v5, 9, v2
    v_lshl_add_u32 v29, v1, 3, v5
    s_mov_b32 s10, 0x400000
    s_mov_b32 s11, s31
    s_waitcnt lgkmcnt(0)
    buffer_load_dwordx2 v[96:97], v29, s[8:11], s68 offen offset:0
    buffer_load_dwordx2 v[98:99], v29, s[8:11], s68 offen offset:128
    v_cmp_gt_u32_e64 vcc, 16, v0
    buffer_load_dwordx2 v[100:101], v29, s[8:11], s68 offen offset:256
    v_lshlrev_b32 v30, 2, v0
    s_lshl4_add_u32 s4, s32, s33
    s_lshl_b32 s37, s34, 12
    v_cndmask_b32 v30, 2.0, v30, vcc
    v_and_b32 v0, 63, v0
    v_lshlrev_b32 v3, 4, v0
    buffer_load_dwordx2 v[102:103], v29, s[8:11], s68 offen offset:384
    s_lshl_b32 s63, s34, 4
    s_lshl2_add_u32 s94, s6, s41
    v_and_b32 v6, 7, v0
    v_xor_b32 v6, v6, v2
    v_lshlrev_b32 v6, 4, v6
    v_and_b32 v8, 32, v0
    v_bfe_u32 v9, v0, 3, 1
    buffer_load_dwordx2 v[104:105], v29, s[8:11], s69 offen offset:0
    v_lshl_add_u32 v8, v9, 4, v8
    v_bfe_u32 v9, v0, 4, 1
    s_lshl_b32 s38, s32, 5
    s_add_u32 s38, s38, s34
    s_lshl_b32 s38, s38, 2
    v_add3_u32 v8, v8, v9, s38
    v_lshl_add_u32 v16, v8, 11, v6
    buffer_load_dwordx2 v[106:107], v29, s[8:11], s69 offen offset:128
    v_lshrrev_b32 v9, 3, v0
    s_lshl1_add_u32 s38, s33, s6
    s_lshl_b32 s38, s38, 5
    v_add_u32_e64 v9, s38, v9
    v_lshl_add_u32 v20, v9, 11, v6
    v_xor_b32 v8, 64, v16
    v_xor_b32 v9, 64, v20
    buffer_load_dwordx2 v[108:109], v29, s[8:11], s69 offen offset:256
    v_add_u32 v17, 130048, v8
    v_add_u32 v18, 2048, v16
    v_add_u32 v19, 132096, v8
    v_add_u32 v21, 15360, v9
    v_add_u32 v22, 30720, v20
    v_add_u32 v23, 46080, v9
    s_add_u32 s38, s32, s33
    buffer_load_dwordx2 v[110:111], v29, s[8:11], s69 offen offset:384
    s_and_b32 s38, s38, 3
    s_mov_b32 s66, 1703092544
    s_mov_b32 s67, 4275808711
    s_cmp_eq_u32 s38, 1
    s_cselect_b32 s66, 2036348193, s66
    s_cselect_b32 s67, 3488136612, s67
    s_cmp_eq_u32 s38, 2
    s_cselect_b32 s66, 2758893618, s66
    s_cselect_b32 s67, 3707365557, s67
    s_cmp_eq_u32 s38, 3
    s_cselect_b32 s66, 1699160323, s66
    s_cselect_b32 s67, 3989809547, s67
    s_and_b32 s38, s2, 3
    s_mul_i32 s38, s38, 0x44444444
    s_xor_b32 s66, s66, s38
    s_xor_b32 s67, s67, s38
    s_mov_b32 s14, 0x200000
    s_mov_b32 s15, s31
    s_nop 0
    s_cmp_lt_u32 s34, 2
    s_cselect_b64 s[12:13], s[56:57], s[58:59]
    s_cselect_b64 s[28:29], s[88:89], s[86:87]
    s_mov_b32 s30, 2048
    s_lshl_b32 s39, s34, 10
    s_add_u32 m0, s39, 147712
    s_lshl_b32 s38, s6, 10
    buffer_load_dwordx4 v3, s[28:31], s38 offen lds
    v_cvt_f32_u32 v249, v1
    v_cvt_f32_u32_e64 v250, v2
    v_mul_f32 v251, 0x3d800000, v249
    v_mul_f32 v250, 4.0, v250
    v_mul_f32 v248, v250, v251
    v_fmamk_f32 v4, v251, 0x00000000, v248
    v_fmamk_f32 v5, v251, 0x3f800000, v248
    v_fmamk_f32 v6, v251, 0x40000000, v248
    s_bfe_u32 s36, s66, 262144
    s_add_u32 m0, s37, 16384
    s_lshl_b32 s36, s36, 7
    buffer_load_dwordx4 v20, s[12:15], s36 offen offset:0 lds
    buffer_load_dwordx4 v21, s[12:15], s36 offen offset:1024 lds
    buffer_load_dwordx4 v22, s[12:15], s36 offen offset:2048 lds
    buffer_load_dwordx4 v23, s[12:15], s36 offen offset:3072 lds
    v_fmamk_f32 v7, v251, 0x40400000, v248
    v_cos_f32 v8, v4
    v_cos_f32 v9, v5
    v_cos_f32 v10, v6
    v_cos_f32 v11, v7
    v_sin_f32 v12, v4
    v_sin_f32 v13, v5
    v_sin_f32 v14, v6
    v_sin_f32_e64 v15, v7
    v_cvt_pk_bf16_f32 v4, v8, v12
    v_cvt_pk_bf16_f32 v5, -v12, v8
    v_accvgpr_write_b32 a224, v4
    v_accvgpr_write_b32 a228, v5
    v_cvt_pk_bf16_f32 v4, v9, v13
    v_cvt_pk_bf16_f32 v5, -v13, v9
    v_accvgpr_write_b32 a225, v4
    v_accvgpr_write_b32 a229, v5
    v_cvt_pk_bf16_f32 v4, v10, v14
    v_cvt_pk_bf16_f32 v5, -v14, v10
    v_accvgpr_write_b32 a226, v4
    v_accvgpr_write_b32 a230, v5
    v_cvt_pk_bf16_f32 v4, v11, v15
    v_cvt_pk_bf16_f32 v5, -v15, v11
    v_accvgpr_write_b32 a227, v4
    v_accvgpr_write_b32 a231, v5
    v_fmamk_f32 v4, v251, 0x3f000000, v248
    v_fmamk_f32 v5, v251, 0x3fc00000, v248
    v_fmamk_f32 v6, v251, 0x40200000, v248
    v_fmamk_f32 v7, v251, 0x40600000, v248
    v_cos_f32 v8, v4
    v_cos_f32 v9, v5
    v_cos_f32_e64 v10, v6
    s_add_u32 s40, s60, 22446080
    s_addc_u32 s41, s61, 0
    s_load_dword s62, s[40:41], 0
    v_cos_f32 v11, v7
    v_sin_f32 v12, v4
    v_sin_f32 v13, v5
    v_sin_f32 v14, v6
    v_sin_f32 v15, v7
    v_cvt_pk_bf16_f32 v4, v8, v12
    v_cvt_pk_bf16_f32 v5, -v12, v8
    v_accvgpr_write_b32 a248, v4
    v_accvgpr_write_b32 a252, v5
    v_cvt_pk_bf16_f32 v4, v9, v13
    v_cvt_pk_bf16_f32 v5, -v13, v9
    v_accvgpr_write_b32 a249, v4
    v_accvgpr_write_b32 a253, v5
    v_cvt_pk_bf16_f32 v4, v10, v14
    v_cvt_pk_bf16_f32 v5, -v14, v10
    v_accvgpr_write_b32 a250, v4
    v_accvgpr_write_b32 a254, v5
    v_cvt_pk_bf16_f32 v4, v11, v15
    v_cvt_pk_bf16_f32 v5, -v15, v11
    v_accvgpr_write_b32 a251, v4
    v_accvgpr_write_b32 a255, v5
    v_mul_f32 v251, 0x3d800000, v251
    v_mul_f32 v248, 0x3d800000, v248
    v_fmamk_f32 v4, v251, 0x00000000, v248
    v_fmamk_f32 v5, v251, 0x3f800000, v248
    v_fmamk_f32 v6, v251, 0x40000000, v248
    v_fmamk_f32 v7, v251, 0x40400000, v248
    v_cos_f32 v232, v4
    v_cos_f32 v233, v5
    v_cos_f32 v234, v6
    v_cos_f32 v235, v7
    v_sin_f32 v240, v4
    v_sin_f32 v241, v5
    v_sin_f32 v242, v6
    v_sin_f32 v243, v7
    v_fmamk_f32 v4, v251, 0x3f000000, v248
    v_fmamk_f32 v5, v251, 0x3fc00000, v248
    v_fmamk_f32 v6, v251, 0x40200000, v248
    v_fmamk_f32 v7, v251, 0x40600000, v248
    v_cos_f32 v236, v4
    v_cos_f32 v237, v5
    v_cos_f32 v238, v6
    v_cos_f32 v239, v7
    v_sin_f32 v244, v4
    v_sin_f32 v245, v5
    v_sin_f32 v246, v6
    v_sin_f32 v247, v7
    s_mov_b64 s[24:25], s[60:61]
    s_mov_b32 s26, 33554432
    s_mov_b32 s27, 0x00020000
    v_lshrrev_b32 v15, 1, v1
    v_xor_b32 v15, v15, v2
    v_lshlrev_b32 v15, 4, v15
    v_lshl_add_u32 v24, v1, 7, v15
    v_xor_b32 v25, 64, v24
    s_lshl_b32 s76, s34, 11
    s_add_u32 s76, s76, 16384
    v_add_u32 v26, s76, v24
    v_add_u32 v27, s76, v25
    v_add_u32 v148, 0x10000, v24
    v_add_u32 v149, 0x10000, v25
    v_add_u32 v150, 0x10000, v26
    v_add_u32 v151, 0x10000, v27
    s_and_b32 s76, s34, 2
    s_lshl1_add_u32 s76, s76, s6
    s_mul_i32 s76, s76, 2080
    s_add_u32 s76, s76, 131072
    v_lshl_add_u32 v15, v2, 6, v1
    v_lshl_add_u32 v252, v15, 3, s76
    v_sub_u32 v15, 728, v15
    v_lshl_add_u32 v253, v15, 3, s76
    v_lshrrev_b32 v7, 2, v0
    v_add_u32 v7, s63, v7
    v_and_b32 v15, 3, v0
    v_lshlrev_b32 v12, 4, v15
    v_mul_u32_u24 v229, 4160, v15
    v_lshl_add_u32 v229, v7, 3, v229
    v_add_u32 v229, 131072, v229
    v_lshrrev_b32_e64 v14, 2, v0
    v_lshl_add_u32 v230, v14, 8, v12
    v_and_b32_e64 v14, 3, v14
    v_lshl_add_u32 v231, v14, 10, v12
    v_lshl_add_u32 v231, v2, 19, v231
    v_and_b32 v15, 1, v15
    v_lshlrev_b32 v15, 11, v15
    v_cmp_eq_u32_e64 vcc, 0, v7
    v_add_u32 v254, 147712, v29
    s_nop 0
    v_cndmask_b32 v15, 0, v15, vcc
    v_add_u32_e64 v228, v229, v15
    v_accvgpr_write_b32 a136, v232
    v_accvgpr_write_b32 a144, v240
    v_accvgpr_write_b32 a137, v233
    v_accvgpr_write_b32 a145, v241
    v_accvgpr_write_b32 a138, v234
    v_accvgpr_write_b32 a146, v242
    v_accvgpr_write_b32 a139, v235
    v_accvgpr_write_b32 a147, v243
    v_accvgpr_write_b32 a170, v252
    v_accvgpr_write_b32 a171, v253
    v_accvgpr_write_b32 a172, v228
    v_accvgpr_write_b32 a173, v229
    v_fma_f32 v251, v249, 2.0, 1.0
    v_mul_f32 v251, 0x3d000000, v251
    v_mul_f32_e64 v248, v250, v251
    v_fmamk_f32 v4, v251, 0x00000000, v248
    v_fmamk_f32 v5, v251, 0x3f800000, v248
    v_fmamk_f32 v6, v251, 0x40000000, v248
    v_fmamk_f32 v7, v251, 0x40400000, v248
    v_cos_f32 v8, v4
    v_cos_f32 v9, v5
    v_cos_f32 v10, v6
    v_cos_f32 v11, v7
    v_sin_f32 v12, v4
    v_sin_f32 v13, v5
    v_sin_f32 v14, v6
    v_sin_f32 v15, v7
    v_cvt_pk_bf16_f32 v4, v8, v12
    v_cvt_pk_bf16_f32 v5, -v12, v8
    v_accvgpr_write_b32 a232, v4
    v_accvgpr_write_b32 a236, v5
    v_cvt_pk_bf16_f32 v4, v9, v13
    v_cvt_pk_bf16_f32 v5, -v13, v9
    v_accvgpr_write_b32 a233, v4
    v_accvgpr_write_b32 a237, v5
    v_cvt_pk_bf16_f32 v4, v10, v14
    v_cvt_pk_bf16_f32 v5, -v14, v10
    v_accvgpr_write_b32 a234, v4
    v_accvgpr_write_b32 a238, v5
    v_cvt_pk_bf16_f32 v4, v11, v15
    v_cvt_pk_bf16_f32 v5, -v15, v11
    v_accvgpr_write_b32 a235, v4
    v_accvgpr_write_b32 a239, v5
    v_cvt_pk_bf16_f32 v4, -v8, -v12
    v_cvt_pk_bf16_f32 v5, v12, -v8
    v_accvgpr_write_b32 a240, v4
    v_accvgpr_write_b32 a244, v5
    v_cvt_pk_bf16_f32 v4, -v9, -v13
    v_cvt_pk_bf16_f32 v5, v13, -v9
    v_accvgpr_write_b32 a241, v4
    v_accvgpr_write_b32 a245, v5
    v_cvt_pk_bf16_f32 v4, -v10, -v14
    v_cvt_pk_bf16_f32 v5, v14, -v10
    v_accvgpr_write_b32 a242, v4
    v_accvgpr_write_b32 a246, v5
    v_cvt_pk_bf16_f32 v4, -v11, -v15
    v_cvt_pk_bf16_f32 v5, v15, -v11
    v_accvgpr_write_b32 a243, v4
    v_accvgpr_write_b32 a247, v5
    v_mul_f32 v251, 0x3d800000, v251
    v_mul_f32 v248, 0x3d800000, v248
    v_fmamk_f32 v4, v251, 0x00000000, v248
    v_fmamk_f32 v5, v251, 0x3f800000, v248
    v_fmamk_f32 v6, v251, 0x40000000, v248
    v_fmamk_f32 v7, v251, 0x40400000, v248
    v_cos_f32 v8, v4
    v_cos_f32 v9, v5
    v_cos_f32 v10, v6
    v_cos_f32 v11, v7
    v_sin_f32 v12, v4
    v_sin_f32 v13, v5
    v_sin_f32 v14, v6
    v_sin_f32 v15, v7
    v_accvgpr_write_b32 a140, v8
    v_accvgpr_write_b32 a148, v12
    v_accvgpr_write_b32 a141, v9
    v_accvgpr_write_b32 a149, v13
    v_accvgpr_write_b32 a142, v10
    v_accvgpr_write_b32 a150, v14
    v_accvgpr_write_b32 a143, v11
    v_accvgpr_write_b32 a151, v15
    v_add_u32 v251, s63, v1
    v_cvt_f32_u32 v251, v251
    v_and_b32_e64 v147, 1, v1
    v_mul_f32 v251, 0x3c800000, v251
    v_mul_u32_u24 v147, 0x8000, v147
    v_mul_f32_e64 v248, v250, v251
    v_lshl_or_b32 v147, v147, 16, v147
    v_fmamk_f32 v4, v251, 0x00000000, v248
    v_fmamk_f32 v5, v251, 0x3f800000, v248
    v_fmamk_f32 v6, v251, 0x40000000, v248
    v_fmamk_f32 v7, v251, 0x40400000, v248
    v_cos_f32 v8, v4
    v_cos_f32 v9, v5
    v_cos_f32 v10, v6
    v_cos_f32 v11, v7
    v_sin_f32 v12, v4
    v_sin_f32 v13, v5
    v_sin_f32 v14, v6
    v_sin_f32 v15, v7
    v_cvt_pk_bf16_f32 v4, v8, v12
    v_cvt_pk_bf16_f32 v5, -v12, v8
    v_accvgpr_write_b32 a0, v4
    v_accvgpr_write_b32 a4, v5
    v_xor_b32 v4, v147, v4
    v_xor_b32 v5, v147, v5
    v_accvgpr_write_b32 a16, v4
    v_accvgpr_write_b32 a20, v5
    v_cvt_pk_bf16_f32 v4, v9, v13
    v_cvt_pk_bf16_f32 v5, -v13, v9
    v_accvgpr_write_b32 a1, v4
    v_accvgpr_write_b32 a5, v5
    v_xor_b32 v4, v147, v4
    v_xor_b32 v5, v147, v5
    v_accvgpr_write_b32 a17, v4
    v_accvgpr_write_b32 a21, v5
    v_cvt_pk_bf16_f32 v4, v10, v14
    v_cvt_pk_bf16_f32 v5, -v14, v10
    v_accvgpr_write_b32 a2, v4
    v_accvgpr_write_b32 a6, v5
    v_xor_b32 v4, v147, v4
    v_xor_b32 v5, v147, v5
    v_accvgpr_write_b32 a18, v4
    v_accvgpr_write_b32 a22, v5
    v_cvt_pk_bf16_f32 v4, v11, v15
    v_cvt_pk_bf16_f32 v5, -v15, v11
    v_accvgpr_write_b32 a3, v4
    v_accvgpr_write_b32 a7, v5
    v_xor_b32 v4, v147, v4
    v_xor_b32 v5, v147, v5
    v_accvgpr_write_b32 a19, v4
    v_accvgpr_write_b32 a23, v5
    v_fmamk_f32 v4, v251, 0x41800000, v248
    v_fmamk_f32 v5, v251, 0x41880000, v248
    v_fmamk_f32 v6, v251, 0x41900000, v248
    v_fmamk_f32 v7, v251, 0x41980000, v248
    v_cos_f32 v8, v4
    v_cos_f32 v9, v5
    v_cos_f32 v10, v6
    v_cos_f32 v11, v7
    v_sin_f32 v12, v4
    v_sin_f32 v13, v5
    v_sin_f32 v14, v6
    v_sin_f32 v15, v7
    v_cvt_pk_bf16_f32 v4, v8, v12
    v_cvt_pk_bf16_f32 v5, -v12, v8
    v_accvgpr_write_b32 a8, v4
    v_accvgpr_write_b32 a12, v5
    v_xor_b32 v4, v147, v4
    v_xor_b32 v5, v147, v5
    s_mov_b64 s[16:17], s[44:45]
    s_mov_b32 s18, 2101248
    s_mov_b32 s19, 0x00020000
    s_mov_b64 s[20:21], s[46:47]
    s_mov_b32 s22, 2101248
    s_mov_b32 s23, 0x00020000
    s_lshr_b32 s38, s2, 6
    s_and_b32 s39, s2, 3
    s_lshl2_add_u32 s38, s38, s39
    s_lshl2_add_u32 s38, s38, s34
    s_bfe_u32 s39, s2, 0x10005
    s_bfe_u32 s40, s2, 0x20002
    s_lshl2_add_u32 s39, s39, s40
    s_bfe_u32 s40, s2, 0x10004
    s_lshl1_add_u32 s39, s39, s40
    s_lshl_b32 s39, s39, 7
    s_add_u32 s38, s38, s39
    s_mul_i32 s44, s38, 1026
    s_andn2_b32 s44, s44, 3
    s_add_u32 s45, s44, 65664
    s_sub_u32 s38, 2048, s38
    s_and_b32 s39, s38, 2047
    s_mul_i32 s39, s39, 1026
    s_add_u32 s39, s39, 514
    s_andn2_b32 s46, s39, 3
    s_mul_i32 s39, s38, 1026
    s_sub_u32 s39, s39, 65150
    s_andn2_b32 s47, s39, 3
    v_lshlrev_b32 v192, 3, v0
    v_sub_u32 v193, 504, v192
    s_lshl_b32 s38, s34, 2
    v_add_u32 v184, s38, v1
    v_and_b32_e64 v184, 15, v184
    v_and_or_b32 v184, v0, 48, v184
    s_lshl_b32 s38, s34, 10
    s_add_u32 s38, s38, 131072
    v_lshl_add_u32 v194, v184, 4, s38
    v_lshrrev_b32 v185, 2, v0
    v_and_b32_e64 v186, 3, v0
    v_lshl_add_u32 v184, v186, 2, v185
    v_and_b32_e64 v184, 15, v184
    v_lshl_add_u32 v184, v186, 6, v184
    s_lshl_b32 s38, s34, 8
    s_add_u32 s38, s38, 131072
    v_lshl_add_u32 v195, v184, 4, s38
    s_mov_b64 s[28:29], s[90:91]
    s_mov_b32 s30, 0x800000
    s_waitcnt vmcnt(9)
    v_swap_b32 v97, v98
    v_swap_b32 v101, v102
    v_swap_b32 v98, v100
    v_swap_b32 v99, v101
    s_waitcnt vmcnt(5)
    v_swap_b32 v105, v106
    v_swap_b32 v109, v110
    v_swap_b32 v106, v108
    v_swap_b32 v107, v109
    v_mfma_f32_16x16x32_bf16 v[32:35], v[96:99], a[224:227], 0
    buffer_load_dwordx3 v[196:198], v192, s[16:19], s44 offen
    buffer_load_dwordx3 v[200:202], v192, s[20:23], s44 offen
    s_and_b32 s38, s33, 3
    s_lshr_b32 s39, s32, 2
    v_mfma_f32_16x16x32_bf16 v[36:39], v[96:99], a[228:231], 0
    s_lshl2_add_u32 s38, s38, s39
    s_and_b32 s39, s32, 3
    v_mfma_f32_16x16x32_bf16 v[40:43], v[100:103], a[224:227], 0
    s_lshl2_add_u32 s38, s38, s39
    s_lshl_b32 s39, s34, 7
    v_mfma_f32_16x16x32_bf16 v[44:47], v[100:103], a[228:231], 0
    s_add_u32 s38, s38, s39
    s_lshl_b32 s38, s38, 6
    v_mfma_f32_16x16x32_bf16 v[48:51], v[104:107], a[224:227], 0
    s_lshr_b32 s39, s33, 2
    s_add_u32 s38, s38, s39
    v_mfma_f32_16x16x32_bf16 v[52:55], v[104:107], a[228:231], 0
    s_lshl_b32 s68, s38, 6
    s_lshr_b32 s39, s34, 1
    v_mfma_f32_16x16x32_bf16 v[56:59], v[108:111], a[224:227], 0
    s_lshl1_add_u32 s38, s33, s39
    s_lshr_b32 s39, s38, 4
    v_mfma_f32_16x16x32_bf16 v[60:63], v[108:111], a[228:231], 0
    s_lshl1_add_u32 s39, s39, s6
    s_lshl2_add_u32 s41, s32, s39
    buffer_load_dwordx3 v[204:206], v193, s[16:19], s46 offen
    buffer_load_dwordx3 v[208:210], v193, s[20:23], s46 offen
    s_and_b32 s40, s38, 15
    s_lshl4_add_u32 s41, s41, s40
    s_lshl_b32 s41, s41, 6
    s_nop 0
    v_pk_mul_f32 v[184:185], v[32:33], v[232:233]
    v_pk_mul_f32 v[186:187], v[36:37], v[232:233]
    v_pk_fma_f32 v[184:185], v[36:37], v[240:241], v[184:185]
    v_pk_fma_f32 v[186:187], v[32:33], v[240:241], v[186:187] neg_lo:[1,0,0] neg_hi:[1,0,0]
    v_pk_mul_f32 v[188:189], v[34:35], v[234:235]
    v_pk_mul_f32 v[190:191], v[38:39], v[234:235]
    v_pk_fma_f32 v[188:189], v[38:39], v[242:243], v[188:189]
    v_pk_fma_f32 v[190:191], v[34:35], v[242:243], v[190:191] neg_lo:[1,0,0] neg_hi:[1,0,0]
    v_cvt_pk_bf16_f32 v152, v184, v186
    v_cvt_pk_bf16_f32 v153, v185, v187
    v_cvt_pk_bf16_f32 v154, v188, v190
    v_cvt_pk_bf16_f32 v155, v189, v191
    v_pk_mul_f32 v[184:185], v[40:41], v[236:237]
    v_pk_mul_f32 v[186:187], v[44:45], v[236:237]
    v_pk_fma_f32 v[184:185], v[44:45], v[244:245], v[184:185]
    v_pk_fma_f32 v[186:187], v[40:41], v[244:245], v[186:187] neg_lo:[1,0,0] neg_hi:[1,0,0]
    v_pk_mul_f32 v[188:189], v[42:43], v[238:239]
    v_pk_mul_f32 v[190:191], v[46:47], v[238:239]
    v_pk_fma_f32 v[188:189], v[46:47], v[246:247], v[188:189]
    v_pk_fma_f32 v[190:191], v[42:43], v[246:247], v[190:191] neg_lo:[1,0,0] neg_hi:[1,0,0]
    v_cvt_pk_bf16_f32 v156, v184, v186
    v_cvt_pk_bf16_f32 v157, v185, v187
    v_cvt_pk_bf16_f32 v158, v188, v190
    v_cvt_pk_bf16_f32 v159, v189, v191
    v_pk_mul_f32 v[184:185], v[48:49], v[232:233]
    v_pk_mul_f32 v[186:187], v[52:53], v[232:233]
    v_pk_fma_f32 v[184:185], v[52:53], v[240:241], v[184:185]
    buffer_load_dwordx3 v[212:214], v192, s[16:19], s45 offen
    buffer_load_dwordx3 v[216:218], v192, s[20:23], s45 offen
    v_pk_fma_f32 v[186:187], v[48:49], v[240:241], v[186:187] neg_lo:[1,0,0] neg_hi:[1,0,0]
    v_pk_mul_f32 v[188:189], v[50:51], v[234:235]
    v_pk_mul_f32 v[190:191], v[54:55], v[234:235]
    v_pk_fma_f32 v[188:189], v[54:55], v[242:243], v[188:189]
    v_pk_fma_f32 v[190:191], v[50:51], v[242:243], v[190:191] neg_lo:[1,0,0] neg_hi:[1,0,0]
    v_cvt_pk_bf16_f32 v160, v184, v186
    v_cvt_pk_bf16_f32 v161, v185, v187
    v_cvt_pk_bf16_f32 v162, v188, v190
    v_cvt_pk_bf16_f32 v163, v189, v191
    v_pk_mul_f32 v[184:185], v[56:57], v[236:237]
    v_pk_mul_f32 v[186:187], v[60:61], v[236:237]
    v_pk_fma_f32 v[184:185], v[60:61], v[244:245], v[184:185]
    v_pk_fma_f32 v[186:187], v[56:57], v[244:245], v[186:187] neg_lo:[1,0,0] neg_hi:[1,0,0]
    v_pk_mul_f32 v[188:189], v[58:59], v[238:239]
    v_pk_mul_f32 v[190:191], v[62:63], v[238:239]
    v_pk_fma_f32 v[188:189], v[62:63], v[246:247], v[188:189]
    v_pk_fma_f32 v[190:191], v[58:59], v[246:247], v[190:191] neg_lo:[1,0,0] neg_hi:[1,0,0]
    v_cvt_pk_bf16_f32 v164, v184, v186
    v_cvt_pk_bf16_f32 v165, v185, v187
    v_cvt_pk_bf16_f32 v166, v188, v190
    v_cvt_pk_bf16_f32 v167, v189, v191
    v_mfma_f32_16x16x32_bf16 v[64:67], a[224:227], v[152:155], 0
    s_add_u32 s69, s41, 22282240
    s_lshl_b32 s41, s32, 6
    v_mfma_f32_16x16x32_bf16 v[68:71], a[228:231], v[152:155], 0
    s_add_u32 s39, s39, s41
    buffer_load_dwordx3 v[220:222], v193, s[16:19], s47 offen
    buffer_load_dwordx3 v[224:226], v193, s[20:23], s47 offen
    s_and_b32 s40, s38, 3
    v_mfma_f32_16x16x32_bf16 v[72:75], a[248:251], v[156:159], 0
    s_lshl2_add_u32 s39, s39, s40
    s_bfe_u32 s40, s38, 0x20002
    v_mfma_f32_16x16x32_bf16 v[76:79], a[252:255], v[156:159], 0
    s_lshl2_add_u32 s39, s39, s40
    s_lshl_b32 s39, s39, 8
    v_mfma_f32_16x16x32_bf16 v[80:83], a[224:227], v[160:163], 0
    s_add_u32 s75, s39, 13631488
    s_getreg_b32 s96, hwreg(HW_REG_XCC_ID, 0, 4)
    v_mfma_f32_16x16x32_bf16 v[84:87], a[228:231], v[160:163], 0
    s_and_b32 s38, s2, 31
    s_lshl_b32 s38, s38, 10
    v_mfma_f32_16x16x32_bf16 v[88:91], a[248:251], v[164:167], 0
    s_add_u32 s51, s38, 22364160
    s_and_b32 s38, s2, 0xe0
    v_mfma_f32_16x16x32_bf16 v[92:95], a[252:255], v[164:167], 0
    s_lshl2_add_u32 s70, s38, s51
    v_pk_add_f32 v[32:33], v[64:65], v[72:73]
    v_pk_add_f32 v[40:41], v[64:65], v[72:73] neg_lo:[0,1] neg_hi:[0,1]
    v_pk_add_f32 v[34:35], v[66:67], v[74:75]
    v_pk_add_f32 v[42:43], v[66:67], v[74:75] neg_lo:[0,1] neg_hi:[0,1]
    v_pk_add_f32 v[36:37], v[68:69], v[76:77]
    v_pk_add_f32 v[44:45], v[68:69], v[76:77] neg_lo:[0,1] neg_hi:[0,1]
    v_pk_add_f32 v[38:39], v[70:71], v[78:79]
    v_pk_add_f32 v[46:47], v[70:71], v[78:79] neg_lo:[0,1] neg_hi:[0,1]
    v_pk_add_f32 v[48:49], v[80:81], v[88:89]
    v_pk_add_f32 v[56:57], v[80:81], v[88:89] neg_lo:[0,1] neg_hi:[0,1]
    v_pk_add_f32 v[50:51], v[82:83], v[90:91]
    v_pk_add_f32 v[58:59], v[82:83], v[90:91] neg_lo:[0,1] neg_hi:[0,1]
    v_pk_add_f32 v[52:53], v[84:85], v[92:93]
    v_pk_add_f32 v[60:61], v[84:85], v[92:93] neg_lo:[0,1] neg_hi:[0,1]
    v_pk_add_f32 v[54:55], v[86:87], v[94:95]
    v_pk_add_f32 v[62:63], v[86:87], v[94:95] neg_lo:[0,1] neg_hi:[0,1]
    v_cvt_pk_bf16_f32 v168, v32, v36
    v_cvt_pk_bf16_f32 v169, v48, v52
    ds_write_b64 v252, v[168:169] offset:0
    v_cvt_pk_bf16_f32 v170, v33, v37
    v_cvt_pk_bf16_f32 v171, v49, v53
    ds_write_b64 v252, v[170:171] offset:128
    v_cvt_pk_bf16_f32 v172, v34, v38
    v_cvt_pk_bf16_f32 v173, v50, v54
    ds_write_b64 v252, v[172:173] offset:256
    v_cvt_pk_bf16_f32 v174, v35, v39
    v_cvt_pk_bf16_f32 v175, v51, v55
    ds_write_b64 v252, v[174:175] offset:384
    v_cvt_pk_bf16_f32 v176, v40, -v44
    v_cvt_pk_bf16_f32 v177, v56, -v60
    ds_write_b64 v253, v[176:177] offset:384
    v_cvt_pk_bf16_f32 v178, v41, -v45
    v_cvt_pk_bf16_f32 v179, v57, -v61
    ds_write_b64 v253, v[178:179] offset:256
    v_cvt_pk_bf16_f32 v180, v42, -v46
    v_cvt_pk_bf16_f32 v181, v58, -v62
    ds_write_b64 v253, v[180:181] offset:128
    v_cvt_pk_bf16_f32 v182, v43, -v47
    v_cvt_pk_bf16_f32 v183, v59, -v63
    ds_write_b64 v253, v[182:183] offset:0
    v_lshlrev_b32_e64 v64, 16, v96
    v_and_b32 v68, 0xffff0000, v96
    v_lshlrev_b32_e64 v65, 16, v97
    v_and_b32 v69, 0xffff0000, v97
    v_lshlrev_b32_e64 v66, 16, v98
    v_and_b32 v70, 0xffff0000, v98
    v_lshlrev_b32_e64 v67, 16, v99
    v_and_b32 v71, 0xffff0000, v99
    v_lshlrev_b32_e64 v72, 16, v100
    v_and_b32 v76, 0xffff0000, v100
    v_lshlrev_b32_e64 v73, 16, v101
    v_and_b32 v77, 0xffff0000, v101
    v_lshlrev_b32_e64 v74, 16, v102
    v_and_b32 v78, 0xffff0000, v102
    v_lshlrev_b32_e64 v75, 16, v103
    v_and_b32 v79, 0xffff0000, v103
    v_lshlrev_b32_e64 v80, 16, v104
    v_and_b32 v84, 0xffff0000, v104
    v_lshlrev_b32_e64 v81, 16, v105
    v_and_b32 v85, 0xffff0000, v105
    v_lshlrev_b32_e64 v82, 16, v106
    v_and_b32 v86, 0xffff0000, v106
    v_lshlrev_b32_e64 v83, 16, v107
    v_and_b32 v87, 0xffff0000, v107
    v_lshlrev_b32_e64 v88, 16, v108
    v_and_b32 v92, 0xffff0000, v108
    v_lshlrev_b32_e64 v89, 16, v109
    v_and_b32 v93, 0xffff0000, v109
    v_lshlrev_b32_e64 v90, 16, v110
    v_and_b32 v94, 0xffff0000, v110
    v_lshlrev_b32_e64 v91, 16, v111
    v_and_b32 v95, 0xffff0000, v111
    s_waitcnt lgkmcnt(0) vmcnt(12)
    s_barrier
    ds_read_b64 v[112:113], v254 offset:0
    ds_read_b64 v[114:115], v254 offset:128
    ds_read_b64 v[116:117], v254 offset:256
    ds_read_b64 v[118:119], v254 offset:384
    ds_read_b64 v[120:121], v254 offset:2048
    ds_read_b64 v[122:123], v254 offset:2176
    ds_read_b64 v[124:125], v254 offset:2304
    ds_read_b64 v[126:127], v254 offset:2432
    ds_read_b64 v[232:233], v228 offset:0
    ds_read_b64 v[234:235], v228 offset:2080
    ds_read_b64 v[236:237], v229 offset:512
    ds_read_b64 v[238:239], v229 offset:2592
    ds_read_b64 v[240:241], v229 offset:1024
    ds_read_b64 v[242:243], v229 offset:3104
    ds_read_b64 v[244:245], v229 offset:1536
    ds_read_b64 v[246:247], v229 offset:3616
    s_mul_i32 s35, s62, 2654435761
    s_add_u32 s35, s35, 2135587861
    s_cmp_eq_u32 s34, 0
    s_cselect_b32 s98, s35, 0
    s_cselect_b32 s99, 0, 2.0
    s_waitcnt lgkmcnt(12)
    s_add_u32 m0, s37, 0
    s_nop 0
    buffer_load_dwordx4 v16, s[8:11], s36 offen offset:0 lds
    buffer_load_dwordx4 v17, s[8:11], s36 offen offset:1024 lds
    buffer_load_dwordx4 v18, s[8:11], s36 offen offset:2048 lds
    buffer_load_dwordx4 v19, s[8:11], s36 offen offset:3072 lds
    v_dot2_f32_bf16 v184, v96, v112, 0
    v_dot2_f32_bf16 v185, v104, v112, 0
    v_dot2_f32_bf16 v184, v100, v113, v184
    v_dot2_f32_bf16 v185, v108, v113, v185
    v_dot2_f32_bf16 v184, v97, v114, v184
    v_dot2_f32_bf16 v185, v105, v114, v185
    v_dot2_f32_bf16 v184, v101, v115, v184
    v_dot2_f32_bf16 v185, v109, v115, v185
    v_dot2_f32_bf16 v184, v98, v116, v184
    v_dot2_f32_bf16 v185, v106, v116, v185
    v_dot2_f32_bf16 v184, v102, v117, v184
    v_dot2_f32_bf16 v185, v110, v117, v185
    v_dot2_f32_bf16 v184, v99, v118, v184
    v_dot2_f32_bf16 v185, v107, v118, v185
    v_dot2_f32_bf16 v184, v103, v119, v184
    v_dot2_f32_bf16 v185, v111, v119, v185
    s_waitcnt lgkmcnt(8)
    v_lshlrev_b32 v32, 16, v120
    v_and_b32 v36, 0xffff0000, v120
    v_add_f32_dpp v184, v184, v184 row_ror:8 row_mask:0xf bank_mask:0xf
    v_add_f32_dpp v185, v185, v185 row_ror:8 row_mask:0xf bank_mask:0xf
    v_lshlrev_b32_e64 v40, 16, v121
    v_add_f32_dpp v184, v184, v184 row_ror:4 row_mask:0xf bank_mask:0xf
    v_and_b32 v44, 0xffff0000, v121
    v_add_f32_dpp v185, v185, v185 row_ror:4 row_mask:0xf bank_mask:0xf
    v_lshlrev_b32_e64 v33, 16, v122
    v_add_f32_dpp v184, v184, v184 row_ror:2 row_mask:0xf bank_mask:0xf
    v_and_b32 v37, 0xffff0000, v122
    v_add_f32_dpp v185, v185, v185 row_ror:2 row_mask:0xf bank_mask:0xf
    v_lshlrev_b32_e64 v41, 16, v123
    v_add_f32_dpp v184, v184, v184 row_ror:1 row_mask:0xf bank_mask:0xf
    v_and_b32 v45, 0xffff0000, v123
    v_add_f32_dpp v185, v185, v185 row_ror:1 row_mask:0xf bank_mask:0xf
    v_lshlrev_b32 v34, 16, v124
    s_nop 0
    v_permlane32_swap_b32 v184, v185
    v_and_b32 v38, 0xffff0000, v124
    v_add_f32 v184, v184, v185
    v_lshlrev_b32 v42, 16, v125
    v_mov_b32 v185, v184
    v_and_b32 v46, 0xffff0000, v125
    s_nop 0
    v_permlane16_swap_b32 v184, v185
    v_lshlrev_b32 v35, 16, v126
    v_add_f32 v184, v184, v185
    v_and_b32 v39, 0xffff0000, v126
    v_cvt_pk_bf16_f32 v184, v184, v184
    v_lshlrev_b32 v43, 16, v127
    v_lshlrev_b32 v184, 16, v184
    v_and_b32 v47, 0xffff0000, v127
    v_mul_f32 v184, 0xbfb8aa3b, v184
    v_pk_mul_f32 v[64:65], v[64:65], v[32:33]
    v_exp_f32 v184, v184
    s_nop 0
    v_add_f32_e64 v184, 1.0, v184
    v_pk_mul_f32 v[66:67], v[66:67], v[34:35]
    v_rcp_f32 v184, v184
    s_lshl2_add_u32 s3, s33, s34
    s_lshl_b32 s3, s3, 4
    v_add_lshl_u32 v145, v1, s3, 1
    s_nop 0
    global_load_ushort v142, v145, s[52:53]
    global_load_ushort v143, v145, s[54:55]
    global_load_ushort v144, v145, s[84:85]
    v_pk_mul_f32 v[68:69], v[68:69], v[36:37]
    v_cvt_pk_bf16_f32 v184, v184, v184
    v_pk_mul_f32 v[70:71], v[70:71], v[38:39]
    v_lshlrev_b32_e64 v184, 16, v184
    v_pk_mul_f32 v[72:73], v[72:73], v[40:41]
    v_sub_f32_e64 v252, 1.0, v184
    v_pk_mul_f32 v[74:75], v[74:75], v[42:43]
    v_cvt_pk_bf16_f32 v252, v252, v252
    v_pk_mul_f32 v[76:77], v[76:77], v[44:45]
    v_lshlrev_b32_e64 v252, 16, v252
    v_pk_mul_f32 v[78:79], v[78:79], v[46:47]
    v_mov_b32_e64 v185, v184
    v_pk_mul_f32 v[80:81], v[80:81], v[32:33]
    v_mov_b32_e64 v253, v252
    v_pk_mul_f32 v[82:83], v[82:83], v[34:35]
    v_permlane32_swap_b32 v184, v185
    v_pk_mul_f32 v[84:85], v[84:85], v[36:37]
    v_permlane32_swap_b32 v252, v253
    v_pk_mul_f32 v[86:87], v[86:87], v[38:39]
    v_cmp_gt_u32_e64 vcc, 8, v0
    v_pk_mul_f32 v[88:89], v[88:89], v[40:41]
    v_lshlrev_b32_e64 v254, 3, v0
    v_pk_mul_f32 v[90:91], v[90:91], v[42:43]
    v_accvgpr_write_b32 a168, v184
    v_pk_mul_f32 v[92:93], v[92:93], v[44:45]
    v_accvgpr_write_b32 a169, v185
    v_pk_mul_f32 v[94:95], v[94:95], v[46:47]
    v_cndmask_b32_e64 v254, 2.0, v254, vcc
    v_pk_mul_f32 v[64:65], v[64:65], v[252:253] op_sel_hi:[1,0]
    v_pk_mul_f32 v[66:67], v[66:67], v[252:253] op_sel_hi:[1,0]
    v_pk_mul_f32 v[68:69], v[68:69], v[252:253] op_sel_hi:[1,0]
    v_pk_mul_f32 v[70:71], v[70:71], v[252:253] op_sel_hi:[1,0]
    v_cvt_pk_bf16_f32 v190, v64, v68
    v_accvgpr_write_b32 a152, v190
    v_cvt_pk_bf16_f32 v191, v65, v69
    v_accvgpr_write_b32 a153, v191
    v_cvt_pk_bf16_f32 v190, v66, v70
    v_accvgpr_write_b32 a154, v190
    s_bfe_u32 s36, s66, 262148
    s_add_u32 m0, s37, 32768
    s_lshl_b32 s36, s36, 7
    s_nop 0
    buffer_load_dwordx4 v16, s[8:11], s36 offen offset:0 lds
    buffer_load_dwordx4 v17, s[8:11], s36 offen offset:1024 lds
    buffer_load_dwordx4 v18, s[8:11], s36 offen offset:2048 lds
    buffer_load_dwordx4 v19, s[8:11], s36 offen offset:3072 lds
    v_cvt_pk_bf16_f32 v191, v67, v71
    v_accvgpr_write_b32 a155, v191
    v_pk_mul_f32 v[72:73], v[72:73], v[252:253] op_sel_hi:[1,0]
    v_pk_mul_f32 v[74:75], v[74:75], v[252:253] op_sel_hi:[1,0]
    v_pk_mul_f32 v[76:77], v[76:77], v[252:253] op_sel_hi:[1,0]
    v_pk_mul_f32 v[78:79], v[78:79], v[252:253] op_sel_hi:[1,0]
    v_cvt_pk_bf16_f32 v190, v72, v76
    v_accvgpr_write_b32 a156, v190
    v_cvt_pk_bf16_f32 v191, v73, v77
    v_accvgpr_write_b32 a157, v191
    v_cvt_pk_bf16_f32 v190, v74, v78
    v_accvgpr_write_b32 a158, v190
    v_cvt_pk_bf16_f32 v191, v75, v79
    v_accvgpr_write_b32 a159, v191
    v_pk_mul_f32 v[80:81], v[80:81], v[252:253] op_sel:[0,1]
    v_pk_mul_f32 v[82:83], v[82:83], v[252:253] op_sel:[0,1]
    v_pk_mul_f32 v[84:85], v[84:85], v[252:253] op_sel:[0,1]
    v_pk_mul_f32 v[86:87], v[86:87], v[252:253] op_sel:[0,1]
    v_cvt_pk_bf16_f32 v190, v80, v84
    v_accvgpr_write_b32 a160, v190
    v_cvt_pk_bf16_f32 v191, v81, v85
    v_accvgpr_write_b32 a161, v191
    v_cvt_pk_bf16_f32 v190, v82, v86
    v_accvgpr_write_b32 a162, v190
    v_cvt_pk_bf16_f32 v191, v83, v87
    v_accvgpr_write_b32 a163, v191
    v_pk_mul_f32 v[88:89], v[88:89], v[252:253] op_sel:[0,1]
    v_pk_mul_f32 v[90:91], v[90:91], v[252:253] op_sel:[0,1]
    v_pk_mul_f32 v[92:93], v[92:93], v[252:253] op_sel:[0,1]
    v_pk_mul_f32 v[94:95], v[94:95], v[252:253] op_sel:[0,1]
    v_cvt_pk_bf16_f32 v190, v88, v92
    v_accvgpr_write_b32 a164, v190
    v_cvt_pk_bf16_f32 v191, v89, v93
    v_accvgpr_write_b32 a165, v191
    v_cvt_pk_bf16_f32 v190, v90, v94
    v_accvgpr_write_b32 a166, v190
    v_cvt_pk_bf16_f32 v191, v91, v95
    v_accvgpr_write_b32 a167, v191
    v_accvgpr_write_b32 a24, v4
    v_accvgpr_write_b32 a28, v5
    v_cvt_pk_bf16_f32 v4, v9, v13
    v_cvt_pk_bf16_f32 v5, -v13, v9
    v_accvgpr_write_b32 a9, v4
    v_accvgpr_write_b32 a13, v5
    v_xor_b32 v4, v147, v4
    v_xor_b32 v5, v147, v5
    v_accvgpr_write_b32 a25, v4
    v_accvgpr_write_b32 a29, v5
    v_cvt_pk_bf16_f32 v4, v10, v14
    v_cvt_pk_bf16_f32 v5, -v14, v10
    v_accvgpr_write_b32 a10, v4
    v_accvgpr_write_b32 a14, v5
    v_xor_b32 v4, v147, v4
    v_xor_b32 v5, v147, v5
    v_accvgpr_write_b32 a26, v4
    v_accvgpr_write_b32 a30, v5
    v_cvt_pk_bf16_f32 v4, v11, v15
    s_add_u32 m0, s37, 49152
    s_nop 0
    s_nop 0
    buffer_load_dwordx4 v20, s[12:15], s36 offen offset:0 lds
    buffer_load_dwordx4 v21, s[12:15], s36 offen offset:1024 lds
    buffer_load_dwordx4 v22, s[12:15], s36 offen offset:2048 lds
    buffer_load_dwordx4 v23, s[12:15], s36 offen offset:3072 lds
    v_cvt_pk_bf16_f32 v5, -v15, v11
    v_accvgpr_write_b32 a11, v4
    v_accvgpr_write_b32 a15, v5
    v_xor_b32 v4, v147, v4
    v_xor_b32 v5, v147, v5
    v_accvgpr_write_b32 a27, v4
    v_accvgpr_write_b32 a31, v5
    s_waitcnt lgkmcnt(0) vmcnt(11)
    s_barrier
    ds_read_b128 a[64:67], v26 offset:0
    ds_read_b128 a[68:71], v26 offset:8192
    ds_read_b128 a[32:35], v24 offset:0
    ds_read_b128 a[36:39], v24 offset:2048
    ds_read_b128 a[40:43], v24 offset:4096
    ds_read_b128 a[44:47], v24 offset:6144
    ds_read_b128 a[48:51], v24 offset:8192
    ds_read_b128 a[52:55], v24 offset:10240
    ds_read_b128 a[56:59], v24 offset:12288
    ds_read_b128 a[60:63], v24 offset:14336
    s_bfe_u32 s36, s66, 262152
    s_add_u32 m0, s37, 65536
    s_lshl_b32 s36, s36, 7
    buffer_load_dwordx4 v16, s[8:11], s36 offen offset:0 lds
    buffer_load_dwordx4 v17, s[8:11], s36 offen offset:1024 lds
    buffer_load_dwordx4 v18, s[8:11], s36 offen offset:2048 lds
    buffer_load_dwordx4 v19, s[8:11], s36 offen offset:3072 lds
    s_add_u32 m0, s37, 81920
    s_nop 0
    buffer_load_dwordx4 v20, s[12:15], s36 offen offset:0 lds
    buffer_load_dwordx4 v21, s[12:15], s36 offen offset:1024 lds
    buffer_load_dwordx4 v22, s[12:15], s36 offen offset:2048 lds
    buffer_load_dwordx4 v23, s[12:15], s36 offen offset:3072 lds
    s_waitcnt lgkmcnt(0)
    v_mfma_f32_16x16x32_bf16 v[32:35], a[32:35], a[64:67], 0
    ds_read_b128 a[104:107], v27 offset:0
    s_bfe_u32 s36, s66, 262156
    v_mfma_f32_16x16x32_bf16 v[36:39], a[32:35], a[68:71], 0
    ds_read_b128 a[108:111], v27 offset:8192
    s_add_u32 m0, s37, 98304
    v_mfma_f32_16x16x32_bf16 v[40:43], a[36:39], a[64:67], 0
    ds_read_b128 a[72:75], v25 offset:0
    s_lshl_b32 s36, s36, 7
    v_mfma_f32_16x16x32_bf16 v[44:47], a[36:39], a[68:71], 0
    ds_read_b128 a[76:79], v25 offset:2048
    v_mfma_f32_16x16x32_bf16 v[48:51], a[40:43], a[64:67], 0
    ds_read_b128 a[80:83], v25 offset:4096
    buffer_load_dwordx4 v16, s[8:11], s36 offen offset:0 lds
    v_mfma_f32_16x16x32_bf16 v[52:55], a[40:43], a[68:71], 0
    ds_read_b128 a[84:87], v25 offset:6144
    buffer_load_dwordx4 v17, s[8:11], s36 offen offset:1024 lds
    v_mfma_f32_16x16x32_bf16 v[56:59], a[44:47], a[64:67], 0
    ds_read_b128 a[88:91], v25 offset:8192
    buffer_load_dwordx4 v18, s[8:11], s36 offen offset:2048 lds
    v_mov_b32_e64 v28, s96
    v_mfma_f32_16x16x32_bf16 v[60:63], a[44:47], a[68:71], 0
    ds_read_b128 a[92:95], v25 offset:10240
    buffer_store_dword v28, v30, s[24:27], s70 offen sc1
    v_mfma_f32_16x16x32_bf16 v[64:67], a[48:51], a[64:67], 0
    ds_read_b128 a[96:99], v25 offset:12288
    buffer_load_dwordx4 v19, s[8:11], s36 offen offset:3072 lds
    buffer_store_dwordx2 v[252:253], v254, s[24:27], s69 offen sc1
    v_mfma_f32_16x16x32_bf16 v[68:71], a[48:51], a[68:71], 0
    ds_read_b128 a[100:103], v25 offset:14336
    s_add_u32 m0, s37, 114688
    v_mfma_f32_16x16x32_bf16 v[72:75], a[52:55], a[64:67], 0
    buffer_load_dwordx4 v20, s[12:15], s36 offen offset:0 lds
    v_mfma_f32_16x16x32_bf16 v[76:79], a[52:55], a[68:71], 0
    v_mfma_f32_16x16x32_bf16 v[80:83], a[56:59], a[64:67], 0
    buffer_load_dwordx4 v21, s[12:15], s36 offen offset:1024 lds
    v_mfma_f32_16x16x32_bf16 v[84:87], a[56:59], a[68:71], 0
    buffer_load_dwordx4 v22, s[12:15], s36 offen offset:2048 lds
    v_mfma_f32_16x16x32_bf16 v[88:91], a[60:63], a[64:67], 0
    buffer_load_dwordx4 v23, s[12:15], s36 offen offset:3072 lds
    v_mfma_f32_16x16x32_bf16 v[92:95], a[60:63], a[68:71], 0
    s_waitcnt lgkmcnt(0) vmcnt(18)
    s_barrier
    v_mfma_f32_16x16x32_bf16 v[32:35], a[72:75], a[104:107], v[32:35]
    ds_read_b128 a[64:67], v26 offset:32768
    s_bfe_u32 s36, s66, 262160
    s_mov_b32 s76, 0x05040100
    v_mfma_f32_16x16x32_bf16 v[36:39], a[72:75], a[108:111], v[36:39]
    ds_read_b128 a[68:71], v26 offset:40960
    s_mov_b32 s77, 0x07060302
    s_lshl_b32 s38, s6, 4
    v_mfma_f32_16x16x32_bf16 v[40:43], a[76:79], a[104:107], v[40:43]
    ds_read_b128 a[32:35], v24 offset:32768
    s_add_u32 m0, s37, 0
    s_xor_b32 s39, s38, 16
    v_alignbit_b32 v196, v197, v196, s38
    v_mfma_f32_16x16x32_bf16 v[44:47], a[76:79], a[108:111], v[44:47]
    ds_read_b128 a[36:39], v24 offset:34816
    v_alignbit_b32 v197, v198, v197, s38
    v_mfma_f32_16x16x32_bf16 v[48:51], a[80:83], a[104:107], v[48:51]
    ds_read_b128 a[40:43], v24 offset:36864
    v_lshrrev_b32 v198, s38, v198
    v_alignbit_b32 v200, v201, v200, s38
    v_mfma_f32_16x16x32_bf16 v[52:55], a[80:83], a[108:111], v[52:55]
    ds_read_b128 a[44:47], v24 offset:38912
    s_lshl_b32 s36, s36, 7
    v_alignbit_b32 v201, v202, v201, s38
    v_lshrrev_b32 v202, s38, v202
    v_mfma_f32_16x16x32_bf16 v[56:59], a[84:87], a[104:107], v[56:59]
    ds_read_b128 a[48:51], v24 offset:40960
    v_alignbit_b32 v204, v205, v204, s39
    v_alignbit_b32 v205, v206, v205, s39
    buffer_store_dwordx4 v[232:235], v230, s[28:31], s68 offen sc1
    v_mfma_f32_16x16x32_bf16 v[60:63], a[84:87], a[108:111], v[60:63]
    ds_read_b128 a[52:55], v24 offset:43008
    v_alignbit_b32 v208, v209, v208, s39
    v_mfma_f32_16x16x32_bf16 v[64:67], a[88:91], a[104:107], v[64:67]
    ds_read_b128 a[56:59], v24 offset:45056
    buffer_load_dwordx4 v16, s[8:11], s36 offen offset:0 lds
    v_alignbit_b32 v209, v210, v209, s39
    v_alignbit_b32 v212, v213, v212, s38
    s_add_u32 s68, s68, 2097152
    v_mfma_f32_16x16x32_bf16 v[68:71], a[88:91], a[108:111], v[68:71]
    ds_read_b128 a[60:63], v24 offset:47104
    v_alignbit_b32 v213, v214, v213, s38
    v_lshrrev_b32_e64 v214, s38, v214
    v_mfma_f32_16x16x32_bf16 v[72:75], a[92:95], a[104:107], v[72:75]
    buffer_load_dwordx4 v17, s[8:11], s36 offen offset:1024 lds
    v_alignbit_b32 v216, v217, v216, s38
    v_alignbit_b32 v217, v218, v217, s38
    v_mfma_f32_16x16x32_bf16 v[76:79], a[92:95], a[108:111], v[76:79]
    v_lshrrev_b32_e64 v218, s38, v218
    v_mfma_f32_16x16x32_bf16 v[80:83], a[96:99], a[104:107], v[80:83]
    v_alignbit_b32 v220, v221, v220, s39
    v_alignbit_b32 v221, v222, v221, s39
    v_mfma_f32_16x16x32_bf16 v[84:87], a[96:99], a[108:111], v[84:87]
    buffer_load_dwordx4 v18, s[8:11], s36 offen offset:2048 lds
    v_alignbit_b32 v224, v225, v224, s39
    v_alignbit_b32 v225, v226, v225, s39
    v_mfma_f32_16x16x32_bf16 v[88:91], a[100:103], a[104:107], v[88:91]
    v_perm_b32 v184, v202, v198, s76
    v_perm_b32 v186, v218, v214, s76
    v_mfma_f32_16x16x32_bf16 v[92:95], a[100:103], a[108:111], v[92:95]
    ds_write_b128 v194, v[184:187] offset:16384
    s_waitcnt lgkmcnt(1)
    v_mfma_f32_16x16x32_bf16 v[32:35], a[32:35], a[64:67], v[32:35]
    ds_read_b128 a[104:107], v27 offset:32768
    buffer_load_dwordx4 v19, s[8:11], s36 offen offset:3072 lds
    v_perm_b32 v152, v200, v196, s76
    v_perm_b32 v153, v209, v205, s77
    v_mfma_f32_16x16x32_bf16 v[36:39], a[32:35], a[68:71], v[36:39]
    ds_read_b128 a[108:111], v27 offset:40960
    v_perm_b32 v154, v216, v212, s76
    v_perm_b32 v155, v225, v221, s77
    v_mfma_f32_16x16x32_bf16 v[40:43], a[36:39], a[64:67], v[40:43]
    ds_read_b128 a[72:75], v25 offset:32768
    s_add_u32 m0, s37, 16384
    ds_write_b128 v194, v[152:155] offset:0
    v_perm_b32 v156, v200, v196, s77
    v_mfma_f32_16x16x32_bf16 v[44:47], a[36:39], a[68:71], v[44:47]
    ds_read_b128 a[76:79], v25 offset:34816
    v_perm_b32 v157, v209, v205, s76
    v_perm_b32 v158, v216, v212, s77
    v_mfma_f32_16x16x32_bf16 v[48:51], a[40:43], a[64:67], v[48:51]
    ds_read_b128 a[80:83], v25 offset:36864
    v_perm_b32 v159, v225, v221, s76
    ds_write_b128 v194, v[156:159] offset:4096
    v_mfma_f32_16x16x32_bf16 v[52:55], a[40:43], a[68:71], v[52:55]
    ds_read_b128 a[84:87], v25 offset:38912
    buffer_load_dwordx4 v20, s[12:15], s36 offen offset:0 lds
    v_perm_b32 v160, v201, v197, s76
    v_mfma_f32_16x16x32_bf16 v[56:59], a[44:47], a[64:67], v[56:59]
    ds_read_b128 a[88:91], v25 offset:40960
    v_perm_b32 v161, v208, v204, s77
    v_perm_b32 v162, v217, v213, s76
    buffer_store_dwordx4 v[236:239], v230, s[28:31], s68 offen sc1
    v_mfma_f32_16x16x32_bf16 v[60:63], a[44:47], a[68:71], v[60:63]
    ds_read_b128 a[92:95], v25 offset:43008
    v_perm_b32 v163, v224, v220, s77
    ds_write_b128 v194, v[160:163] offset:8192
    v_mfma_f32_16x16x32_bf16 v[64:67], a[48:51], a[64:67], v[64:67]
    ds_read_b128 a[96:99], v25 offset:45056
    buffer_load_dwordx4 v21, s[12:15], s36 offen offset:1024 lds
    v_perm_b32 v164, v201, v197, s77
    v_perm_b32 v165, v208, v204, s76
    s_add_u32 s68, s68, 2097152
    v_mfma_f32_16x16x32_bf16 v[68:71], a[48:51], a[68:71], v[68:71]
    ds_read_b128 a[100:103], v25 offset:47104
    v_perm_b32 v166, v217, v213, s77
    v_perm_b32 v167, v224, v220, s76
    v_mfma_f32_16x16x32_bf16 v[72:75], a[52:55], a[64:67], v[72:75]
    buffer_load_dwordx4 v22, s[12:15], s36 offen offset:2048 lds
    ds_write_b128 v194, v[164:167] offset:12288
    v_mfma_f32_16x16x32_bf16 v[76:79], a[52:55], a[68:71], v[76:79]
    v_bfe_u32 v189, v0, 2, 2
    v_lshl_add_u32 v228, v189, 8, v231
    v_mfma_f32_16x16x32_bf16 v[80:83], a[56:59], a[64:67], v[80:83]
    v_lshl_add_u32 v189, v189, 12, v195
    v_xor_b32 v190, 0x1000, v189
    v_mfma_f32_16x16x32_bf16 v[84:87], a[56:59], a[68:71], v[84:87]
    buffer_load_dwordx4 v23, s[12:15], s36 offen offset:3072 lds
    v_xor_b32 v191, 0x2000, v189
    v_xor_b32 v192, 0x3000, v189
    v_mfma_f32_16x16x32_bf16 v[88:91], a[60:63], a[64:67], v[88:91]
    v_xor_b32 v229, 0x100, v228
    v_xor_b32 v231, 0x200, v228
    v_mfma_f32_16x16x32_bf16 v[92:95], a[60:63], a[68:71], v[92:95]
    v_xor_b32 v193, 0x300, v228
    s_waitcnt lgkmcnt(0) vmcnt(20)
    s_barrier
    v_mfma_f32_16x16x32_bf16 v[32:35], a[72:75], a[104:107], v[32:35]
    ds_read_b128 a[64:67], v150 offset:0
    s_bfe_u32 s36, s66, 262164
    ds_read_b128 v[184:187], v195 offset:16384
    ds_read_b128 v[168:171], v189
    v_mfma_f32_16x16x32_bf16 v[36:39], a[72:75], a[108:111], v[36:39]
    ds_read_b128 a[68:71], v150 offset:8192
    ds_read_b128 v[172:175], v190
    v_mfma_f32_16x16x32_bf16 v[40:43], a[76:79], a[104:107], v[40:43]
    ds_read_b128 a[32:35], v148 offset:0
    s_add_u32 m0, s37, 32768
    ds_read_b128 v[176:179], v191
    v_mfma_f32_16x16x32_bf16 v[44:47], a[76:79], a[108:111], v[44:47]
    ds_read_b128 a[36:39], v148 offset:2048
    ds_read_b128 v[180:183], v192
    v_mfma_f32_16x16x32_bf16 v[48:51], a[80:83], a[104:107], v[48:51]
    ds_read_b128 a[40:43], v148 offset:4096
    s_lshr_b32 s40, s2, 2
    v_mfma_f32_16x16x32_bf16 v[52:55], a[80:83], a[108:111], v[52:55]
    ds_read_b128 a[44:47], v148 offset:6144
    s_lshl_b32 s36, s36, 7
    s_lshl_b32 s41, s34, 9
    v_mfma_f32_16x16x32_bf16 v[56:59], a[84:87], a[104:107], v[56:59]
    ds_read_b128 a[48:51], v148 offset:8192
    s_add_u32 s40, s40, s41
    buffer_store_dwordx4 v[240:243], v230, s[28:31], s68 offen sc1
    v_mfma_f32_16x16x32_bf16 v[60:63], a[84:87], a[108:111], v[60:63]
    ds_read_b128 a[52:55], v148 offset:10240
    s_add_u32 s40, s40, 64
    v_mfma_f32_16x16x32_bf16 v[64:67], a[88:91], a[104:107], v[64:67]
    ds_read_b128 a[56:59], v148 offset:12288
    buffer_load_dwordx4 v16, s[8:11], s36 offen offset:0 lds
    s_lshl_b32 s40, s40, 6
    s_and_b32 s41, s2, 3
    s_add_u32 s68, s68, 2097152
    v_mfma_f32_16x16x32_bf16 v[68:71], a[88:91], a[108:111], v[68:71]
    ds_read_b128 a[60:63], v148 offset:14336
    s_add_u32 s40, s40, s41
    v_mfma_f32_16x16x32_bf16 v[72:75], a[92:95], a[104:107], v[72:75]
    buffer_load_dwordx4 v17, s[8:11], s36 offen offset:1024 lds
    s_lshl_b32 s76, s40, 6
    v_mfma_f32_16x16x32_bf16 v[76:79], a[92:95], a[108:111], v[76:79]
    s_lshl_b32 s40, s34, 10
    v_mfma_f32_16x16x32_bf16 v[80:83], a[96:99], a[104:107], v[80:83]
    v_add_u32 v188, s40, v3
    v_mfma_f32_16x16x32_bf16 v[84:87], a[96:99], a[108:111], v[84:87]
    buffer_load_dwordx4 v18, s[8:11], s36 offen offset:2048 lds
    v_subrev_u32 v188, 4032, v188
    v_mfma_f32_16x16x32_bf16 v[88:91], a[100:103], a[104:107], v[88:91]
    v_min_u32_e64 v188, 2.0, v188
    v_mfma_f32_16x16x32_bf16 v[92:95], a[100:103], a[108:111], v[92:95]
    s_lshl_b32 s77, s2, 6
    s_waitcnt lgkmcnt(0)
    v_mfma_f32_16x16x32_bf16 v[32:35], a[32:35], a[64:67], v[32:35]
    ds_read_b128 a[104:107], v151 offset:0
    buffer_load_dwordx4 v19, s[8:11], s36 offen offset:3072 lds
    s_and_b32 s38, s32, 3
    v_mfma_f32_16x16x32_bf16 v[36:39], a[32:35], a[68:71], v[36:39]
    ds_read_b128 a[108:111], v151 offset:8192
    s_mov_b32 s97, 1985229328
    v_mfma_f32_16x16x32_bf16 v[40:43], a[36:39], a[64:67], v[40:43]
    ds_read_b128 a[72:75], v149 offset:0
    s_add_u32 m0, s37, 49152
    s_cmp_eq_u32 s38, 1
    s_cselect_b32 s97, 561402928, s97
    v_mfma_f32_16x16x32_bf16 v[44:47], a[36:39], a[68:71], v[44:47]
    ds_read_b128 a[76:79], v149 offset:2048
    v_mfma_f32_16x16x32_bf16 v[48:51], a[40:43], a[64:67], v[48:51]
    ds_read_b128 a[80:83], v149 offset:4096
    s_cmp_eq_u32 s38, 2
    s_cselect_b32 s97, 1126266448, s97
    v_mfma_f32_16x16x32_bf16 v[52:55], a[40:43], a[68:71], v[52:55]
    ds_read_b128 a[84:87], v149 offset:6144
    buffer_load_dwordx4 v20, s[12:15], s36 offen offset:0 lds
    s_cmp_eq_u32 s38, 3
    s_cselect_b32 s97, 1698898288, s97
    v_mfma_f32_16x16x32_bf16 v[56:59], a[44:47], a[64:67], v[56:59]
    ds_read_b128 a[88:91], v149 offset:8192
    buffer_store_dwordx4 v[244:247], v230, s[28:31], s68 offen sc1
    v_mfma_f32_16x16x32_bf16 v[60:63], a[44:47], a[68:71], v[60:63]
    ds_read_b128 a[92:95], v149 offset:10240
    s_lshr_b32 s38, s2, 5
    v_mfma_f32_16x16x32_bf16 v[64:67], a[48:51], a[64:67], v[64:67]
    ds_read_b128 a[96:99], v149 offset:12288
    buffer_load_dwordx4 v21, s[12:15], s36 offen offset:1024 lds
    s_mul_i32 s38, s38, 0x11111111
    v_mfma_f32_16x16x32_bf16 v[68:71], a[48:51], a[68:71], v[68:71]
    ds_read_b128 a[100:103], v149 offset:14336
    v_mfma_f32_16x16x32_bf16 v[72:75], a[52:55], a[64:67], v[72:75]
    buffer_load_dwordx4 v22, s[12:15], s36 offen offset:2048 lds
    s_add_u32 s97, s97, s38
    v_mfma_f32_16x16x32_bf16 v[76:79], a[52:55], a[68:71], v[76:79]
    s_and_b32 s97, s97, 0x77777777
    v_mfma_f32_16x16x32_bf16 v[80:83], a[56:59], a[64:67], v[80:83]
    v_mfma_f32_16x16x32_bf16 v[84:87], a[56:59], a[68:71], v[84:87]
    buffer_load_dwordx4 v23, s[12:15], s36 offen offset:3072 lds
    s_lshl_b32 s38, s33, 6
    v_mfma_f32_16x16x32_bf16 v[88:91], a[60:63], a[64:67], v[88:91]
    s_add_u32 s38, s38, s34
    v_mfma_f32_16x16x32_bf16 v[92:95], a[60:63], a[68:71], v[92:95]
    s_waitcnt lgkmcnt(0) vmcnt(20)
    s_barrier
    v_mfma_f32_16x16x32_bf16 v[32:35], a[72:75], a[104:107], v[32:35]
    ds_read_b128 a[64:67], v150 offset:32768
    s_bfe_u32 s36, s66, 262168
    s_lshl_b32 s38, s38, 8
    v_mfma_f32_16x16x32_bf16 v[36:39], a[72:75], a[108:111], v[36:39]
    ds_read_b128 a[68:71], v150 offset:40960
    s_add_u32 s93, s38, 22020096
    v_mfma_f32_16x16x32_bf16 v[40:43], a[76:79], a[104:107], v[40:43]
    ds_read_b128 a[32:35], v148 offset:32768
    s_add_u32 m0, s37, 65536
    s_lshl_b32 s38, s32, 11
    v_mfma_f32_16x16x32_bf16 v[44:47], a[76:79], a[108:111], v[44:47]
    ds_read_b128 a[36:39], v148 offset:34816
    v_mfma_f32_16x16x32_bf16 v[48:51], a[80:83], a[104:107], v[48:51]
    ds_read_b128 a[40:43], v148 offset:36864
    s_add_u32 s38, s38, s33
    v_mfma_f32_16x16x32_bf16 v[52:55], a[80:83], a[108:111], v[52:55]
    ds_read_b128 a[44:47], v148 offset:38912
    s_lshl_b32 s36, s36, 7
    s_lshl_b32 s5, s38, 8
    v_mfma_f32_16x16x32_bf16 v[56:59], a[84:87], a[104:107], v[56:59]
    ds_read_b128 a[48:51], v148 offset:40960
    v_mfma_f32_16x16x32_bf16 v[60:63], a[84:87], a[108:111], v[60:63]
    ds_read_b128 a[52:55], v148 offset:43008
    s_lshl_b32 s38, s94, 16
    v_mfma_f32_16x16x32_bf16 v[64:67], a[88:91], a[104:107], v[64:67]
    ds_read_b128 a[56:59], v148 offset:45056
    buffer_load_dwordx4 v16, s[8:11], s36 offen offset:0 lds
    s_andn2_b32 s95, s5, 0x700
    buffer_store_dwordx4 v[184:187], v188, s[24:27], s77 offen sc1
    v_mfma_f32_16x16x32_bf16 v[68:71], a[88:91], a[108:111], v[68:71]
    ds_read_b128 a[60:63], v148 offset:47104
    v_mfma_f32_16x16x32_bf16 v[72:75], a[92:95], a[104:107], v[72:75]
    buffer_load_dwordx4 v17, s[8:11], s36 offen offset:1024 lds
    s_add_u32 s95, s95, s38
    v_mfma_f32_16x16x32_bf16 v[76:79], a[92:95], a[108:111], v[76:79]
    s_cmp_lt_u32 s34, 2
    s_cselect_b64 s[16:17], s[80:81], s[82:83]
    v_mfma_f32_16x16x32_bf16 v[80:83], a[96:99], a[104:107], v[80:83]
    v_mfma_f32_16x16x32_bf16 v[84:87], a[96:99], a[108:111], v[84:87]
    buffer_load_dwordx4 v18, s[8:11], s36 offen offset:2048 lds
    s_mov_b32 s18, 0x200000
    v_mfma_f32_16x16x32_bf16 v[88:91], a[100:103], a[104:107], v[88:91]
    v_mfma_f32_16x16x32_bf16 v[92:95], a[100:103], a[108:111], v[92:95]
    s_waitcnt lgkmcnt(0)
    v_mfma_f32_16x16x32_bf16 v[32:35], a[32:35], a[64:67], v[32:35]
    ds_read_b128 a[104:107], v151 offset:32768
    buffer_load_dwordx4 v19, s[8:11], s36 offen offset:3072 lds
    v_lshlrev_b32_e64 v144, 16, v144
    v_mfma_f32_16x16x32_bf16 v[36:39], a[32:35], a[68:71], v[36:39]
    ds_read_b128 a[108:111], v151 offset:40960
    v_lshlrev_b32_e64 v142, 16, v142
    v_mfma_f32_16x16x32_bf16 v[40:43], a[36:39], a[64:67], v[40:43]
    ds_read_b128 a[72:75], v149 offset:32768
    s_add_u32 m0, s37, 81920
    v_mul_f32 v144, 0x3fb8aa3b, v144
    v_mfma_f32_16x16x32_bf16 v[44:47], a[36:39], a[68:71], v[44:47]
    ds_read_b128 a[76:79], v149 offset:34816
    v_mfma_f32_16x16x32_bf16 v[48:51], a[40:43], a[64:67], v[48:51]
    ds_read_b128 a[80:83], v149 offset:36864
    v_exp_f32_e64 v144, v144
    v_mfma_f32_16x16x32_bf16 v[52:55], a[40:43], a[68:71], v[52:55]
    ds_read_b128 a[84:87], v149 offset:38912
    buffer_load_dwordx4 v20, s[12:15], s36 offen offset:0 lds
    v_lshlrev_b32_e64 v143, 16, v143
    v_mfma_f32_16x16x32_bf16 v[56:59], a[44:47], a[64:67], v[56:59]
    ds_read_b128 a[88:91], v149 offset:40960
    v_mfma_f32_16x16x32_bf16 v[60:63], a[44:47], a[68:71], v[60:63]
    ds_read_b128 a[92:95], v149 offset:43008
    v_cvt_pk_bf16_f32 v144, v144, v144
    v_mfma_f32_16x16x32_bf16 v[64:67], a[48:51], a[64:67], v[64:67]
    ds_read_b128 a[96:99], v149 offset:45056
    buffer_load_dwordx4 v21, s[12:15], s36 offen offset:1024 lds
    v_lshlrev_b32_e64 v144, 16, v144
    buffer_store_dwordx4 v[168:171], v228, s[28:31], s76 offen sc1
    v_mfma_f32_16x16x32_bf16 v[68:71], a[48:51], a[68:71], v[68:71]
    ds_read_b128 a[100:103], v149 offset:47104
    v_mfma_f32_16x16x32_bf16 v[72:75], a[52:55], a[64:67], v[72:75]
    buffer_load_dwordx4 v22, s[12:15], s36 offen offset:2048 lds
    v_mul_f32_e64 v14, v144, v142
    v_mfma_f32_16x16x32_bf16 v[76:79], a[52:55], a[68:71], v[76:79]
    v_mul_f32_e64 v4, v144, v143
    v_mfma_f32_16x16x32_bf16 v[80:83], a[56:59], a[64:67], v[80:83]
    v_mfma_f32_16x16x32_bf16 v[84:87], a[56:59], a[68:71], v[84:87]
    buffer_load_dwordx4 v23, s[12:15], s36 offen offset:3072 lds
    v_mul_f32 v14, 0x3fb8aa3b, v14
    v_mfma_f32_16x16x32_bf16 v[88:91], a[60:63], a[64:67], v[88:91]
    v_mul_f32_e64 v4, 0x3e22f983, v4
    v_mfma_f32_16x16x32_bf16 v[92:95], a[60:63], a[68:71], v[92:95]
    s_waitcnt lgkmcnt(0) vmcnt(20)
    s_barrier
    v_mfma_f32_16x16x32_bf16 v[32:35], a[72:75], a[104:107], v[32:35]
    ds_read_b128 a[64:67], v26 offset:0
    s_bfe_u32 s36, s66, 262172
    v_exp_f32_e64 v14, v14
    v_mfma_f32_16x16x32_bf16 v[36:39], a[72:75], a[108:111], v[36:39]
    ds_read_b128 a[68:71], v26 offset:8192
    v_fract_f32_e64 v4, v4
    v_mfma_f32_16x16x32_bf16 v[40:43], a[76:79], a[104:107], v[40:43]
    ds_read_b128 a[32:35], v24 offset:0
    s_add_u32 m0, s37, 98304
    v_cos_f32_e64 v5, v4
    v_mfma_f32_16x16x32_bf16 v[44:47], a[76:79], a[108:111], v[44:47]
    ds_read_b128 a[36:39], v24 offset:2048
    v_mfma_f32_16x16x32_bf16 v[48:51], a[80:83], a[104:107], v[48:51]
    ds_read_b128 a[40:43], v24 offset:4096
    v_sin_f32_e64 v6, v4
    v_mfma_f32_16x16x32_bf16 v[52:55], a[80:83], a[108:111], v[52:55]
    ds_read_b128 a[44:47], v24 offset:6144
    s_lshl_b32 s36, s36, 7
    v_mul_f32 v128, v14, v5
    v_mfma_f32_16x16x32_bf16 v[56:59], a[84:87], a[104:107], v[56:59]
    ds_read_b128 a[48:51], v24 offset:8192
    v_mfma_f32_16x16x32_bf16 v[60:63], a[84:87], a[108:111], v[60:63]
    ds_read_b128 a[52:55], v24 offset:10240
    v_mul_f32_e64 v129, v14, v6
    v_mfma_f32_16x16x32_bf16 v[64:67], a[88:91], a[104:107], v[64:67]
    ds_read_b128 a[56:59], v24 offset:12288
    buffer_load_dwordx4 v16, s[8:11], s36 offen offset:0 lds
    v_mul_f32_e64 v14, v142, v142
    buffer_store_dwordx4 v[172:175], v229, s[28:31], s76 offen sc1
    v_mfma_f32_16x16x32_bf16 v[68:71], a[88:91], a[108:111], v[68:71]
    ds_read_b128 a[60:63], v24 offset:14336
    v_mfma_f32_16x16x32_bf16 v[72:75], a[92:95], a[104:107], v[72:75]
    buffer_load_dwordx4 v17, s[8:11], s36 offen offset:1024 lds
    v_fma_f32 v14, v143, v143, v14
    v_mfma_f32_16x16x32_bf16 v[76:79], a[92:95], a[108:111], v[76:79]
    v_rcp_f32_e64 v14, v14
    v_mfma_f32_16x16x32_bf16 v[80:83], a[96:99], a[104:107], v[80:83]
    v_mfma_f32_16x16x32_bf16 v[84:87], a[96:99], a[108:111], v[84:87]
    buffer_load_dwordx4 v18, s[8:11], s36 offen offset:2048 lds
    v_add_f32_e64 v4, -1.0, v128
    v_mfma_f32_16x16x32_bf16 v[88:91], a[100:103], a[104:107], v[88:91]
    v_add_f32_e64 v14, v14, v14
    v_mfma_f32_16x16x32_bf16 v[92:95], a[100:103], a[108:111], v[92:95]
    s_waitcnt lgkmcnt(0)
    v_mfma_f32_16x16x32_bf16 v[32:35], a[32:35], a[64:67], v[32:35]
    ds_read_b128 a[104:107], v27 offset:0
    buffer_load_dwordx4 v19, s[8:11], s36 offen offset:3072 lds
    v_mul_f32 v5, v4, v142
    v_mfma_f32_16x16x32_bf16 v[36:39], a[32:35], a[68:71], v[36:39]
    ds_read_b128 a[108:111], v27 offset:8192
    v_fma_f32 v5, v129, v143, v5
    v_mfma_f32_16x16x32_bf16 v[40:43], a[36:39], a[64:67], v[40:43]
    ds_read_b128 a[72:75], v25 offset:0
    s_add_u32 m0, s37, 114688
    v_mul_f32_e64 v6, v129, v142
    v_mfma_f32_16x16x32_bf16 v[44:47], a[36:39], a[68:71], v[44:47]
    ds_read_b128 a[76:79], v25 offset:2048
    v_mfma_f32_16x16x32_bf16 v[48:51], a[40:43], a[64:67], v[48:51]
    ds_read_b128 a[80:83], v25 offset:4096
    v_fma_f32 v6, -v4, v143, v6
    v_mfma_f32_16x16x32_bf16 v[52:55], a[40:43], a[68:71], v[52:55]
    ds_read_b128 a[84:87], v25 offset:6144
    buffer_load_dwordx4 v20, s[12:15], s36 offen offset:0 lds
    v_mul_f32_e64 v130, v5, v14
    v_mfma_f32_16x16x32_bf16 v[56:59], a[44:47], a[64:67], v[56:59]
    ds_read_b128 a[88:91], v25 offset:8192
    v_mfma_f32_16x16x32_bf16 v[60:63], a[44:47], a[68:71], v[60:63]
    ds_read_b128 a[92:95], v25 offset:10240
    v_mul_f32_e64 v131, v6, v14
    v_mfma_f32_16x16x32_bf16 v[64:67], a[48:51], a[64:67], v[64:67]
    ds_read_b128 a[96:99], v25 offset:12288
    buffer_load_dwordx4 v21, s[12:15], s36 offen offset:1024 lds
    v_mul_f32_e64 v4, v128, v128
    buffer_store_dwordx4 v[176:179], v231, s[28:31], s76 offen sc1
    v_mfma_f32_16x16x32_bf16 v[68:71], a[48:51], a[68:71], v[68:71]
    ds_read_b128 a[100:103], v25 offset:14336
    v_mfma_f32_16x16x32_bf16 v[72:75], a[52:55], a[64:67], v[72:75]
    buffer_load_dwordx4 v22, s[12:15], s36 offen offset:2048 lds
    v_mul_f32_e64 v5, v128, v129
    v_mfma_f32_16x16x32_bf16 v[76:79], a[52:55], a[68:71], v[76:79]
    v_fma_f32 v4, -v129, v129, v4
    v_mfma_f32_16x16x32_bf16 v[80:83], a[56:59], a[64:67], v[80:83]
    v_mfma_f32_16x16x32_bf16 v[84:87], a[56:59], a[68:71], v[84:87]
    buffer_load_dwordx4 v23, s[12:15], s36 offen offset:3072 lds
    v_add_f32_e64 v5, v5, v5
    v_mfma_f32_16x16x32_bf16 v[88:91], a[60:63], a[64:67], v[88:91]
    v_mul_f32_e64 v6, v4, v4
    v_mfma_f32_16x16x32_bf16 v[92:95], a[60:63], a[68:71], v[92:95]
    s_waitcnt lgkmcnt(0) vmcnt(20)
    s_barrier
    v_mfma_f32_16x16x32_bf16 v[32:35], a[72:75], a[104:107], v[32:35]
    ds_read_b128 a[64:67], v26 offset:32768
    s_bfe_u32 s36, s67, 262144
    v_mul_f32_e64 v7, v4, v5
    v_mfma_f32_16x16x32_bf16 v[36:39], a[72:75], a[108:111], v[36:39]
    ds_read_b128 a[68:71], v26 offset:40960
    v_fma_f32 v6, -v5, v5, v6
    v_mfma_f32_16x16x32_bf16 v[40:43], a[76:79], a[104:107], v[40:43]
    ds_read_b128 a[32:35], v24 offset:32768
    s_add_u32 m0, s37, 0
    v_add_f32 v7, v7, v7
    v_mfma_f32_16x16x32_bf16 v[44:47], a[76:79], a[108:111], v[44:47]
    ds_read_b128 a[36:39], v24 offset:34816
    v_mfma_f32_16x16x32_bf16 v[48:51], a[80:83], a[104:107], v[48:51]
    ds_read_b128 a[40:43], v24 offset:36864
    v_mul_f32_e64 v4, v6, v6
    v_mfma_f32_16x16x32_bf16 v[52:55], a[80:83], a[108:111], v[52:55]
    ds_read_b128 a[44:47], v24 offset:38912
    s_lshl_b32 s36, s36, 7
    v_mul_f32 v5, v6, v7
    v_mfma_f32_16x16x32_bf16 v[56:59], a[84:87], a[104:107], v[56:59]
    ds_read_b128 a[48:51], v24 offset:40960
    v_mfma_f32_16x16x32_bf16 v[60:63], a[84:87], a[108:111], v[60:63]
    ds_read_b128 a[52:55], v24 offset:43008
    v_fma_f32 v4, -v7, v7, v4
    v_mfma_f32_16x16x32_bf16 v[64:67], a[88:91], a[104:107], v[64:67]
    ds_read_b128 a[56:59], v24 offset:45056
    buffer_load_dwordx4 v16, s[8:11], s36 offen offset:0 lds
    v_add_f32_e64 v5, v5, v5
    buffer_store_dwordx4 v[180:183], v193, s[28:31], s76 offen sc1
    v_mfma_f32_16x16x32_bf16 v[68:71], a[88:91], a[108:111], v[68:71]
    ds_read_b128 a[60:63], v24 offset:47104
    v_mfma_f32_16x16x32_bf16 v[72:75], a[92:95], a[104:107], v[72:75]
    buffer_load_dwordx4 v17, s[8:11], s36 offen offset:1024 lds
    v_mul_f32_e64 v132, v4, v4
    v_mfma_f32_16x16x32_bf16 v[76:79], a[92:95], a[108:111], v[76:79]
    v_mul_f32_e64 v133, v4, v5
    v_mfma_f32_16x16x32_bf16 v[80:83], a[96:99], a[104:107], v[80:83]
    v_mfma_f32_16x16x32_bf16 v[84:87], a[96:99], a[108:111], v[84:87]
    buffer_load_dwordx4 v18, s[8:11], s36 offen offset:2048 lds
    v_fma_f32 v132, -v5, v5, v132
    v_mfma_f32_16x16x32_bf16 v[88:91], a[100:103], a[104:107], v[88:91]
    v_add_f32_e64 v133, v133, v133
    v_mfma_f32_16x16x32_bf16 v[92:95], a[100:103], a[108:111], v[92:95]
    s_waitcnt lgkmcnt(0)
    v_mfma_f32_16x16x32_bf16 v[32:35], a[32:35], a[64:67], v[32:35]
    ds_read_b128 a[104:107], v27 offset:32768
    buffer_load_dwordx4 v19, s[8:11], s36 offen offset:3072 lds
    v_mul_f32 v134, v132, v132
    v_mfma_f32_16x16x32_bf16 v[36:39], a[32:35], a[68:71], v[36:39]
    ds_read_b128 a[108:111], v27 offset:40960
    v_mul_f32_e64 v135, v132, v133
    v_mfma_f32_16x16x32_bf16 v[40:43], a[36:39], a[64:67], v[40:43]
    ds_read_b128 a[72:75], v25 offset:32768
    s_add_u32 m0, s37, 16384
    v_fma_f32 v134, -v133, v133, v134
    v_mfma_f32_16x16x32_bf16 v[44:47], a[36:39], a[68:71], v[44:47]
    ds_read_b128 a[76:79], v25 offset:34816
    v_mfma_f32_16x16x32_bf16 v[48:51], a[40:43], a[64:67], v[48:51]
    ds_read_b128 a[80:83], v25 offset:36864
    v_add_f32_e64 v135, v135, v135
    v_mfma_f32_16x16x32_bf16 v[52:55], a[40:43], a[68:71], v[52:55]
    ds_read_b128 a[84:87], v25 offset:38912
    buffer_load_dwordx4 v20, s[12:15], s36 offen offset:0 lds
    v_mul_f32_e64 v8, v134, v134
    v_mfma_f32_16x16x32_bf16 v[56:59], a[44:47], a[64:67], v[56:59]
    ds_read_b128 a[88:91], v25 offset:40960
    v_mfma_f32_16x16x32_bf16 v[60:63], a[44:47], a[68:71], v[60:63]
    ds_read_b128 a[92:95], v25 offset:43008
    v_mul_f32_e64 v9, v134, v135
    v_mfma_f32_16x16x32_bf16 v[64:67], a[48:51], a[64:67], v[64:67]
    ds_read_b128 a[96:99], v25 offset:45056
    buffer_load_dwordx4 v21, s[12:15], s36 offen offset:1024 lds
    v_fma_f32 v8, -v135, v135, v8
    v_mfma_f32_16x16x32_bf16 v[68:71], a[48:51], a[68:71], v[68:71]
    ds_read_b128 a[100:103], v25 offset:47104
    v_mfma_f32_16x16x32_bf16 v[72:75], a[52:55], a[64:67], v[72:75]
    buffer_load_dwordx4 v22, s[12:15], s36 offen offset:2048 lds
    v_add_f32_e64 v9, v9, v9
    v_mfma_f32_16x16x32_bf16 v[76:79], a[52:55], a[68:71], v[76:79]
    v_mul_f32_e64 v136, v8, v8
    v_mfma_f32_16x16x32_bf16 v[80:83], a[56:59], a[64:67], v[80:83]
    v_mfma_f32_16x16x32_bf16 v[84:87], a[56:59], a[68:71], v[84:87]
    buffer_load_dwordx4 v23, s[12:15], s36 offen offset:3072 lds
    v_mul_f32_e64 v137, v8, v9
    v_mfma_f32_16x16x32_bf16 v[88:91], a[60:63], a[64:67], v[88:91]
    v_fma_f32 v136, -v9, v9, v136
    v_mfma_f32_16x16x32_bf16 v[92:95], a[60:63], a[68:71], v[92:95]
    s_waitcnt lgkmcnt(0) vmcnt(19)
    s_barrier
    v_mfma_f32_16x16x32_bf16 v[32:35], a[72:75], a[104:107], v[32:35]
    ds_read_b128 a[64:67], v150 offset:0
    s_bfe_u32 s36, s67, 262148
    v_add_f32_e64 v137, v137, v137
    v_mfma_f32_16x16x32_bf16 v[36:39], a[72:75], a[108:111], v[36:39]
    ds_read_b128 a[68:71], v150 offset:8192
    v_mul_f32_e64 v4, v136, v136
    v_mfma_f32_16x16x32_bf16 v[40:43], a[76:79], a[104:107], v[40:43]
    ds_read_b128 a[32:35], v148 offset:0
    s_add_u32 m0, s37, 32768
    v_mul_f32_e64 v5, v136, v137
    v_mfma_f32_16x16x32_bf16 v[44:47], a[76:79], a[108:111], v[44:47]
    ds_read_b128 a[36:39], v148 offset:2048
    v_mfma_f32_16x16x32_bf16 v[48:51], a[80:83], a[104:107], v[48:51]
    ds_read_b128 a[40:43], v148 offset:4096
    v_fma_f32 v4, -v137, v137, v4
    v_mfma_f32_16x16x32_bf16 v[52:55], a[80:83], a[108:111], v[52:55]
    ds_read_b128 a[44:47], v148 offset:6144
    s_lshl_b32 s36, s36, 7
    v_add_f32 v5, v5, v5
    v_mfma_f32_16x16x32_bf16 v[56:59], a[84:87], a[104:107], v[56:59]
    ds_read_b128 a[48:51], v148 offset:8192
    v_mfma_f32_16x16x32_bf16 v[60:63], a[84:87], a[108:111], v[60:63]
    ds_read_b128 a[52:55], v148 offset:10240
    v_mul_f32_e64 v10, v4, v4
    v_mfma_f32_16x16x32_bf16 v[64:67], a[88:91], a[104:107], v[64:67]
    ds_read_b128 a[56:59], v148 offset:12288
    buffer_load_dwordx4 v16, s[8:11], s36 offen offset:0 lds
    v_mul_f32_e64 v11, v4, v5
    v_mfma_f32_16x16x32_bf16 v[68:71], a[88:91], a[108:111], v[68:71]
    ds_read_b128 a[60:63], v148 offset:14336
    v_mfma_f32_16x16x32_bf16 v[72:75], a[92:95], a[104:107], v[72:75]
    buffer_load_dwordx4 v17, s[8:11], s36 offen offset:1024 lds
    v_fma_f32 v10, -v5, v5, v10
    v_mfma_f32_16x16x32_bf16 v[76:79], a[92:95], a[108:111], v[76:79]
    v_add_f32_e64 v11, v11, v11
    v_mfma_f32_16x16x32_bf16 v[80:83], a[96:99], a[104:107], v[80:83]
    v_mfma_f32_16x16x32_bf16 v[84:87], a[96:99], a[108:111], v[84:87]
    buffer_load_dwordx4 v18, s[8:11], s36 offen offset:2048 lds
    v_mul_f32_e64 v12, v10, v10
    v_mfma_f32_16x16x32_bf16 v[88:91], a[100:103], a[104:107], v[88:91]
    v_mul_f32_e64 v13, v10, v11
    v_mfma_f32_16x16x32_bf16 v[92:95], a[100:103], a[108:111], v[92:95]
    s_waitcnt lgkmcnt(0)
    v_mfma_f32_16x16x32_bf16 v[32:35], a[32:35], a[64:67], v[32:35]
    ds_read_b128 a[104:107], v151 offset:0
    buffer_load_dwordx4 v19, s[8:11], s36 offen offset:3072 lds
    v_fma_f32 v12, -v11, v11, v12
    v_mfma_f32_16x16x32_bf16 v[36:39], a[32:35], a[68:71], v[36:39]
    ds_read_b128 a[108:111], v151 offset:8192
    v_add_f32 v13, v13, v13
    v_mfma_f32_16x16x32_bf16 v[40:43], a[36:39], a[64:67], v[40:43]
    ds_read_b128 a[72:75], v149 offset:0
    s_add_u32 m0, s37, 49152
    v_and_b32_e64 v14, 1, v2
    v_mfma_f32_16x16x32_bf16 v[44:47], a[36:39], a[68:71], v[44:47]
    ds_read_b128 a[76:79], v149 offset:2048
    v_mfma_f32_16x16x32_bf16 v[48:51], a[40:43], a[64:67], v[48:51]
    ds_read_b128 a[80:83], v149 offset:4096
    v_cmp_eq_u32 s[78:79], 1, v14
    v_mfma_f32_16x16x32_bf16 v[52:55], a[40:43], a[68:71], v[52:55]
    ds_read_b128 a[84:87], v149 offset:6144
    buffer_load_dwordx4 v20, s[12:15], s36 offen offset:0 lds
    v_cndmask_b32 v4, 1.0, v134, s[78:79]
    v_mfma_f32_16x16x32_bf16 v[56:59], a[44:47], a[64:67], v[56:59]
    ds_read_b128 a[88:91], v149 offset:8192
    v_mfma_f32_16x16x32_bf16 v[60:63], a[44:47], a[68:71], v[60:63]
    ds_read_b128 a[92:95], v149 offset:10240
    v_cndmask_b32 v5, 0, v135, s[78:79]
    v_mfma_f32_16x16x32_bf16 v[64:67], a[48:51], a[64:67], v[64:67]
    ds_read_b128 a[96:99], v149 offset:12288
    buffer_load_dwordx4 v21, s[12:15], s36 offen offset:1024 lds
    v_cndmask_b32 v10, 1.0, v10, s[78:79]
    v_mfma_f32_16x16x32_bf16 v[68:71], a[48:51], a[68:71], v[68:71]
    ds_read_b128 a[100:103], v149 offset:14336
    v_mfma_f32_16x16x32_bf16 v[72:75], a[52:55], a[64:67], v[72:75]
    buffer_load_dwordx4 v22, s[12:15], s36 offen offset:2048 lds
    v_cndmask_b32 v11, 0, v11, s[78:79]
    v_mfma_f32_16x16x32_bf16 v[76:79], a[52:55], a[68:71], v[76:79]
    v_cmp_lt_u32 s[78:79], 1, v2
    v_mfma_f32_16x16x32_bf16 v[80:83], a[56:59], a[64:67], v[80:83]
    v_mfma_f32_16x16x32_bf16 v[84:87], a[56:59], a[68:71], v[84:87]
    buffer_load_dwordx4 v23, s[12:15], s36 offen offset:3072 lds
    v_cndmask_b32 v8, 1.0, v8, s[78:79]
    v_mfma_f32_16x16x32_bf16 v[88:91], a[60:63], a[64:67], v[88:91]
    v_cndmask_b32 v9, 0, v9, s[78:79]
    v_mfma_f32_16x16x32_bf16 v[92:95], a[60:63], a[68:71], v[92:95]
    s_waitcnt lgkmcnt(0) vmcnt(15)
    s_barrier
    v_mfma_f32_16x16x32_bf16 v[32:35], a[72:75], a[104:107], v[32:35]
    ds_read_b128 a[64:67], v150 offset:32768
    s_lshl_b32 s69, s2, 4
    v_cndmask_b32 v12, 1.0, v12, s[78:79]
    v_mfma_f32_16x16x32_bf16 v[36:39], a[72:75], a[108:111], v[36:39]
    ds_read_b128 a[68:71], v150 offset:40960
    s_add_u32 s69, s69, 22347776
    v_cndmask_b32 v13, 0, v13, s[78:79]
    v_mfma_f32_16x16x32_bf16 v[40:43], a[76:79], a[104:107], v[40:43]
    ds_read_b128 a[32:35], v148 offset:32768
    v_mul_f32 v138, v4, v8
    v_mfma_f32_16x16x32_bf16 v[44:47], a[76:79], a[108:111], v[44:47]
    ds_read_b128 a[36:39], v148 offset:34816
    v_mov_b32_e64 v28, s35
    v_mfma_f32_16x16x32_bf16 v[48:51], a[80:83], a[104:107], v[48:51]
    ds_read_b128 a[40:43], v148 offset:36864
    v_mul_f32_e64 v139, v4, v9
    v_mfma_f32_16x16x32_bf16 v[52:55], a[80:83], a[108:111], v[52:55]
    ds_read_b128 a[44:47], v148 offset:38912
    v_and_b32 v255, 1073741839, v30
    v_fma_f32 v138, -v5, v9, v138
    v_mfma_f32_16x16x32_bf16 v[56:59], a[84:87], a[104:107], v[56:59]
    ds_read_b128 a[48:51], v148 offset:40960
    v_mfma_f32_16x16x32_bf16 v[60:63], a[84:87], a[108:111], v[60:63]
    ds_read_b128 a[52:55], v148 offset:43008
    buffer_store_dword v28, v255, s[24:27], s69 offen sc1
    v_fma_f32 v139, v5, v8, v139
    v_mfma_f32_16x16x32_bf16 v[64:67], a[88:91], a[104:107], v[64:67]
    ds_read_b128 a[56:59], v148 offset:45056
    s_bfe_u32 s36, s67, 262152
    v_mul_f32_e64 v140, v10, v12
    v_mfma_f32_16x16x32_bf16 v[68:71], a[88:91], a[108:111], v[68:71]
    ds_read_b128 a[60:63], v148 offset:47104
    v_mfma_f32_16x16x32_bf16 v[72:75], a[92:95], a[104:107], v[72:75]
    s_add_u32 m0, s37, 65536
    v_mul_f32_e64 v141, v10, v13
    v_mfma_f32_16x16x32_bf16 v[76:79], a[92:95], a[108:111], v[76:79]
    v_fma_f32 v140, -v11, v13, v140
    v_mfma_f32_16x16x32_bf16 v[80:83], a[96:99], a[104:107], v[80:83]
    s_lshl_b32 s36, s36, 7
    v_mfma_f32_16x16x32_bf16 v[84:87], a[96:99], a[108:111], v[84:87]
    v_fma_f32 v141, v11, v12, v141
    v_mfma_f32_16x16x32_bf16 v[88:91], a[100:103], a[104:107], v[88:91]
    buffer_load_dwordx4 v16, s[8:11], s36 offen offset:0 lds
    v_add_u32 v251, s63, v1
    v_mfma_f32_16x16x32_bf16 v[92:95], a[100:103], a[108:111], v[92:95]
    s_waitcnt lgkmcnt(0)
    v_mfma_f32_16x16x32_bf16 v[32:35], a[32:35], a[64:67], v[32:35]
    ds_read_b128 a[104:107], v151 offset:32768
    buffer_load_dwordx4 v17, s[8:11], s36 offen offset:1024 lds
    v_cvt_f32_u32 v251, v251
    v_mfma_f32_16x16x32_bf16 v[36:39], a[32:35], a[68:71], v[36:39]
    ds_read_b128 a[108:111], v151 offset:40960
    v_mul_f32 v251, 0x3a800000, v251
    v_mfma_f32_16x16x32_bf16 v[40:43], a[36:39], a[64:67], v[40:43]
    ds_read_b128 a[72:75], v149 offset:32768
    buffer_load_dwordx4 v18, s[8:11], s36 offen offset:2048 lds
    v_mul_f32_e64 v248, v250, v251
    v_mfma_f32_16x16x32_bf16 v[44:47], a[36:39], a[68:71], v[44:47]
    ds_read_b128 a[76:79], v149 offset:34816
    v_mfma_f32_16x16x32_bf16 v[48:51], a[40:43], a[64:67], v[48:51]
    ds_read_b128 a[80:83], v149 offset:36864
    buffer_load_dwordx4 v19, s[8:11], s36 offen offset:3072 lds
    v_fmamk_f32 v4, v251, 0x00000000, v248
    v_mfma_f32_16x16x32_bf16 v[52:55], a[40:43], a[68:71], v[52:55]
    ds_read_b128 a[84:87], v149 offset:38912
    v_fmamk_f32 v5, v251, 0x3f000000, v248
    v_mfma_f32_16x16x32_bf16 v[56:59], a[44:47], a[64:67], v[56:59]
    ds_read_b128 a[88:91], v149 offset:40960
    s_add_u32 m0, s37, 81920
    v_mfma_f32_16x16x32_bf16 v[60:63], a[44:47], a[68:71], v[60:63]
    ds_read_b128 a[92:95], v149 offset:43008
    v_fmamk_f32 v6, v251, 0x3f800000, v248
    v_mfma_f32_16x16x32_bf16 v[64:67], a[48:51], a[64:67], v[64:67]
    ds_read_b128 a[96:99], v149 offset:45056
    buffer_load_dwordx4 v20, s[12:15], s36 offen offset:0 lds
    v_fmamk_f32 v7, v251, 0x3fc00000, v248
    v_mfma_f32_16x16x32_bf16 v[68:71], a[48:51], a[68:71], v[68:71]
    ds_read_b128 a[100:103], v149 offset:47104
    v_mfma_f32_16x16x32_bf16 v[72:75], a[52:55], a[64:67], v[72:75]
    buffer_load_dwordx4 v21, s[12:15], s36 offen offset:1024 lds
    v_cos_f32_e64 v96, v4
    v_mfma_f32_16x16x32_bf16 v[76:79], a[52:55], a[68:71], v[76:79]
    v_cos_f32_e64 v98, v5
    v_mfma_f32_16x16x32_bf16 v[80:83], a[56:59], a[64:67], v[80:83]
    buffer_load_dwordx4 v22, s[12:15], s36 offen offset:2048 lds
    v_mfma_f32_16x16x32_bf16 v[84:87], a[56:59], a[68:71], v[84:87]
    v_cos_f32_e64 v100, v6
    v_mfma_f32_16x16x32_bf16 v[88:91], a[60:63], a[64:67], v[88:91]
    buffer_load_dwordx4 v23, s[12:15], s36 offen offset:3072 lds
    v_cos_f32_e64 v102, v7
    v_mfma_f32_16x16x32_bf16 v[92:95], a[60:63], a[68:71], v[92:95]
    s_waitcnt lgkmcnt(0) vmcnt(17)
    s_barrier
    v_mfma_f32_16x16x32_bf16 v[32:35], a[72:75], a[104:107], v[32:35]
    ds_read_b128 a[64:67], v26 offset:0
    s_bfe_u32 s36, s67, 262156
    v_sin_f32_e64 v97, v4
    v_mfma_f32_16x16x32_bf16 v[36:39], a[72:75], a[108:111], v[36:39]
    ds_read_b128 a[68:71], v26 offset:8192
    v_sin_f32_e64 v99, v5
    v_mfma_f32_16x16x32_bf16 v[40:43], a[76:79], a[104:107], v[40:43]
    ds_read_b128 a[32:35], v24 offset:0
    s_add_u32 m0, s37, 98304
    v_sin_f32_e64 v101, v6
    v_mfma_f32_16x16x32_bf16 v[44:47], a[76:79], a[108:111], v[44:47]
    ds_read_b128 a[36:39], v24 offset:2048
    v_mfma_f32_16x16x32_bf16 v[48:51], a[80:83], a[104:107], v[48:51]
    ds_read_b128 a[40:43], v24 offset:4096
    v_sin_f32_e64 v103, v7
    v_mfma_f32_16x16x32_bf16 v[52:55], a[80:83], a[108:111], v[52:55]
    ds_read_b128 a[44:47], v24 offset:6144
    s_lshl_b32 s36, s36, 7
    v_fmamk_f32 v4, v251, 0x40000000, v248
    v_mfma_f32_16x16x32_bf16 v[56:59], a[84:87], a[104:107], v[56:59]
    ds_read_b128 a[48:51], v24 offset:8192
    v_mfma_f32_16x16x32_bf16 v[60:63], a[84:87], a[108:111], v[60:63]
    ds_read_b128 a[52:55], v24 offset:10240
    v_fmamk_f32 v5, v251, 0x40200000, v248
    v_mfma_f32_16x16x32_bf16 v[64:67], a[88:91], a[104:107], v[64:67]
    ds_read_b128 a[56:59], v24 offset:12288
    buffer_load_dwordx4 v16, s[8:11], s36 offen offset:0 lds
    v_fmamk_f32 v6, v251, 0x40400000, v248
    v_mfma_f32_16x16x32_bf16 v[68:71], a[88:91], a[108:111], v[68:71]
    ds_read_b128 a[60:63], v24 offset:14336
    v_mfma_f32_16x16x32_bf16 v[72:75], a[92:95], a[104:107], v[72:75]
    buffer_load_dwordx4 v17, s[8:11], s36 offen offset:1024 lds
    v_fmamk_f32 v7, v251, 0x40600000, v248
    v_mfma_f32_16x16x32_bf16 v[76:79], a[92:95], a[108:111], v[76:79]
    v_cos_f32 v104, v4
    v_mfma_f32_16x16x32_bf16 v[80:83], a[96:99], a[104:107], v[80:83]
    v_mfma_f32_16x16x32_bf16 v[84:87], a[96:99], a[108:111], v[84:87]
    buffer_load_dwordx4 v18, s[8:11], s36 offen offset:2048 lds
    v_cos_f32_e64 v106, v5
    v_mfma_f32_16x16x32_bf16 v[88:91], a[100:103], a[104:107], v[88:91]
    v_cos_f32_e64 v108, v6
    v_mfma_f32_16x16x32_bf16 v[92:95], a[100:103], a[108:111], v[92:95]
    s_waitcnt lgkmcnt(0)
    v_mfma_f32_16x16x32_bf16 v[32:35], a[32:35], a[64:67], v[32:35]
    ds_read_b128 a[104:107], v27 offset:0
    buffer_load_dwordx4 v19, s[8:11], s36 offen offset:3072 lds
    v_cos_f32 v110, v7
    v_mfma_f32_16x16x32_bf16 v[36:39], a[32:35], a[68:71], v[36:39]
    ds_read_b128 a[108:111], v27 offset:8192
    v_sin_f32_e64 v105, v4
    v_mfma_f32_16x16x32_bf16 v[40:43], a[36:39], a[64:67], v[40:43]
    ds_read_b128 a[72:75], v25 offset:0
    s_add_u32 m0, s37, 114688
    v_sin_f32_e64 v107, v5
    v_mfma_f32_16x16x32_bf16 v[44:47], a[36:39], a[68:71], v[44:47]
    ds_read_b128 a[76:79], v25 offset:2048
    v_mfma_f32_16x16x32_bf16 v[48:51], a[40:43], a[64:67], v[48:51]
    ds_read_b128 a[80:83], v25 offset:4096
    v_sin_f32_e64 v109, v6
    v_mfma_f32_16x16x32_bf16 v[52:55], a[40:43], a[68:71], v[52:55]
    ds_read_b128 a[84:87], v25 offset:6144
    buffer_load_dwordx4 v20, s[12:15], s36 offen offset:0 lds
    v_sin_f32_e64 v111, v7
    v_mfma_f32_16x16x32_bf16 v[56:59], a[44:47], a[64:67], v[56:59]
    ds_read_b128 a[88:91], v25 offset:8192
    v_mfma_f32_16x16x32_bf16 v[60:63], a[44:47], a[68:71], v[60:63]
    ds_read_b128 a[92:95], v25 offset:10240
    v_cvt_f32_u32_e64 v9, s4
    v_mfma_f32_16x16x32_bf16 v[64:67], a[48:51], a[64:67], v[64:67]
    ds_read_b128 a[96:99], v25 offset:12288
    buffer_load_dwordx4 v21, s[12:15], s36 offen offset:1024 lds
    v_mul_f32 v9, 0x3a800000, v9
    v_mfma_f32_16x16x32_bf16 v[68:71], a[48:51], a[68:71], v[68:71]
    ds_read_b128 a[100:103], v25 offset:14336
    v_mfma_f32_16x16x32_bf16 v[72:75], a[52:55], a[64:67], v[72:75]
    buffer_load_dwordx4 v22, s[12:15], s36 offen offset:2048 lds
    v_sin_f32_e64 v11, v9
    v_mfma_f32_16x16x32_bf16 v[76:79], a[52:55], a[68:71], v[76:79]
    v_cos_f32_e64 v10, v9
    v_mfma_f32_16x16x32_bf16 v[80:83], a[56:59], a[64:67], v[80:83]
    v_mfma_f32_16x16x32_bf16 v[84:87], a[56:59], a[68:71], v[84:87]
    buffer_load_dwordx4 v23, s[12:15], s36 offen offset:3072 lds
    v_add_f32_e64 v11, 1.0, v11
    v_mfma_f32_16x16x32_bf16 v[88:91], a[60:63], a[64:67], v[88:91]
    v_rcp_f32_e64 v9, v11
    v_mfma_f32_16x16x32_bf16 v[92:95], a[60:63], a[68:71], v[92:95]
    s_waitcnt lgkmcnt(0) vmcnt(17)
    s_barrier
    v_mfma_f32_16x16x32_bf16 v[32:35], a[72:75], a[104:107], v[32:35]
    ds_read_b128 a[64:67], v26 offset:32768
    s_bfe_u32 s36, s67, 262160
    v_mul_f32 v15, 0x35000000, v11
    v_mfma_f32_16x16x32_bf16 v[36:39], a[72:75], a[108:111], v[36:39]
    ds_read_b128 a[68:71], v26 offset:40960
    v_mul_f32_e64 v10, -v10, v9
    v_mfma_f32_16x16x32_bf16 v[40:43], a[76:79], a[104:107], v[40:43]
    ds_read_b128 a[32:35], v24 offset:32768
    s_add_u32 m0, s37, 0
    v_cvt_f32_u32 v14, s63
    v_mfma_f32_16x16x32_bf16 v[44:47], a[76:79], a[108:111], v[44:47]
    ds_read_b128 a[36:39], v24 offset:34816
    v_mfma_f32_16x16x32_bf16 v[48:51], a[80:83], a[104:107], v[48:51]
    ds_read_b128 a[40:43], v24 offset:36864
    v_readfirstlane_b32 s42, v10
    v_mfma_f32_16x16x32_bf16 v[52:55], a[80:83], a[108:111], v[52:55]
    ds_read_b128 a[44:47], v24 offset:38912
    s_lshl_b32 s36, s36, 7
    v_add_f32_e64 v14, v14, v250
    v_mfma_f32_16x16x32_bf16 v[56:59], a[84:87], a[104:107], v[56:59]
    ds_read_b128 a[48:51], v24 offset:40960
    v_mfma_f32_16x16x32_bf16 v[60:63], a[84:87], a[108:111], v[60:63]
    ds_read_b128 a[52:55], v24 offset:43008
    v_fma_f32 v251, v249, 2.0, 0
    v_mfma_f32_16x16x32_bf16 v[64:67], a[88:91], a[104:107], v[64:67]
    ds_read_b128 a[56:59], v24 offset:45056
    buffer_load_dwordx4 v16, s[8:11], s36 offen offset:0 lds
    v_mul_f32 v251, 0x3a000000, v251
    v_mfma_f32_16x16x32_bf16 v[68:71], a[88:91], a[108:111], v[68:71]
    ds_read_b128 a[60:63], v24 offset:47104
    v_mfma_f32_16x16x32_bf16 v[72:75], a[92:95], a[104:107], v[72:75]
    buffer_load_dwordx4 v17, s[8:11], s36 offen offset:1024 lds
    v_mul_f32_e64 v248, v14, v251
    v_mfma_f32_16x16x32_bf16 v[76:79], a[92:95], a[108:111], v[76:79]
    v_fmamk_f32 v4, v251, 0x00000000, v248
    v_mfma_f32_16x16x32_bf16 v[80:83], a[96:99], a[104:107], v[80:83]
    v_mfma_f32_16x16x32_bf16 v[84:87], a[96:99], a[108:111], v[84:87]
    buffer_load_dwordx4 v18, s[8:11], s36 offen offset:2048 lds
    v_fmamk_f32 v5, v251, 0x3f800000, v248
    v_mfma_f32_16x16x32_bf16 v[88:91], a[100:103], a[104:107], v[88:91]
    v_fmamk_f32 v6, v251, 0x40000000, v248
    v_mfma_f32_16x16x32_bf16 v[92:95], a[100:103], a[108:111], v[92:95]
    s_waitcnt lgkmcnt(0)
    v_mfma_f32_16x16x32_bf16 v[32:35], a[32:35], a[64:67], v[32:35]
    ds_read_b128 a[104:107], v27 offset:32768
    buffer_load_dwordx4 v19, s[8:11], s36 offen offset:3072 lds
    v_fmamk_f32 v7, v251, 0x40400000, v248
    v_mfma_f32_16x16x32_bf16 v[36:39], a[32:35], a[68:71], v[36:39]
    ds_read_b128 a[108:111], v27 offset:40960
    v_cos_f32 v112, v4
    v_mfma_f32_16x16x32_bf16 v[40:43], a[36:39], a[64:67], v[40:43]
    ds_read_b128 a[72:75], v25 offset:32768
    s_add_u32 m0, s37, 16384
    v_cos_f32_e64 v113, v5
    v_mfma_f32_16x16x32_bf16 v[44:47], a[36:39], a[68:71], v[44:47]
    ds_read_b128 a[76:79], v25 offset:34816
    v_mfma_f32_16x16x32_bf16 v[48:51], a[40:43], a[64:67], v[48:51]
    ds_read_b128 a[80:83], v25 offset:36864
    v_cos_f32_e64 v114, v6
    v_mfma_f32_16x16x32_bf16 v[52:55], a[40:43], a[68:71], v[52:55]
    ds_read_b128 a[84:87], v25 offset:38912
    buffer_load_dwordx4 v20, s[12:15], s36 offen offset:0 lds
    v_cos_f32_e64 v115, v7
    v_mfma_f32_16x16x32_bf16 v[56:59], a[44:47], a[64:67], v[56:59]
    ds_read_b128 a[88:91], v25 offset:40960
    v_mfma_f32_16x16x32_bf16 v[60:63], a[44:47], a[68:71], v[60:63]
    ds_read_b128 a[92:95], v25 offset:43008
    v_sin_f32_e64 v116, v4
    v_mfma_f32_16x16x32_bf16 v[64:67], a[48:51], a[64:67], v[64:67]
    ds_read_b128 a[96:99], v25 offset:45056
    buffer_load_dwordx4 v21, s[12:15], s36 offen offset:1024 lds
    v_sin_f32_e64 v117, v5
    v_mfma_f32_16x16x32_bf16 v[68:71], a[48:51], a[68:71], v[68:71]
    ds_read_b128 a[100:103], v25 offset:47104
    v_mfma_f32_16x16x32_bf16 v[72:75], a[52:55], a[64:67], v[72:75]
    buffer_load_dwordx4 v22, s[12:15], s36 offen offset:2048 lds
    v_sin_f32_e64 v118, v6
    v_mfma_f32_16x16x32_bf16 v[76:79], a[52:55], a[68:71], v[76:79]
    v_sin_f32_e64 v119, v7
    v_mfma_f32_16x16x32_bf16 v[80:83], a[56:59], a[64:67], v[80:83]
    v_mfma_f32_16x16x32_bf16 v[84:87], a[56:59], a[68:71], v[84:87]
    buffer_load_dwordx4 v23, s[12:15], s36 offen offset:3072 lds
    v_mul_f32_e64 v112, v15, v112
    v_mfma_f32_16x16x32_bf16 v[88:91], a[60:63], a[64:67], v[88:91]
    v_mul_f32_e64 v113, v15, v113
    v_mfma_f32_16x16x32_bf16 v[92:95], a[60:63], a[68:71], v[92:95]
    s_waitcnt lgkmcnt(0) vmcnt(16)
    s_barrier
    v_mfma_f32_16x16x32_bf16 v[32:35], a[72:75], a[104:107], v[32:35]
    ds_read_b128 a[64:67], v150 offset:0
    s_bfe_u32 s36, s67, 262164
    v_mul_f32_e64 v114, v15, v114
    v_mfma_f32_16x16x32_bf16 v[36:39], a[72:75], a[108:111], v[36:39]
    ds_read_b128 a[68:71], v150 offset:8192
    s_add_u32 m0, s37, 32768
    v_mul_f32_e64 v115, v15, v115
    v_mfma_f32_16x16x32_bf16 v[40:43], a[76:79], a[104:107], v[40:43]
    ds_read_b128 a[32:35], v148 offset:0
    v_mul_f32_e64 v116, v15, v116
    v_mfma_f32_16x16x32_bf16 v[44:47], a[76:79], a[108:111], v[44:47]
    ds_read_b128 a[36:39], v148 offset:2048
    s_lshl_b32 s36, s36, 7
    v_mfma_f32_16x16x32_bf16 v[48:51], a[80:83], a[104:107], v[48:51]
    ds_read_b128 a[40:43], v148 offset:4096
    v_mul_f32 v117, v15, v117
    v_mfma_f32_16x16x32_bf16 v[52:55], a[80:83], a[108:111], v[52:55]
    ds_read_b128 a[44:47], v148 offset:6144
    buffer_load_dwordx4 v16, s[8:11], s36 offen offset:0 lds
    v_mul_f32_e64 v118, v15, v118
    v_mfma_f32_16x16x32_bf16 v[56:59], a[84:87], a[104:107], v[56:59]
    ds_read_b128 a[48:51], v148 offset:8192
    v_mfma_f32_16x16x32_bf16 v[60:63], a[84:87], a[108:111], v[60:63]
    ds_read_b128 a[52:55], v148 offset:10240
    buffer_load_dwordx4 v17, s[8:11], s36 offen offset:1024 lds
    v_mul_f32_e64 v119, v15, v119
    v_mfma_f32_16x16x32_bf16 v[64:67], a[88:91], a[104:107], v[64:67]
    ds_read_b128 a[56:59], v148 offset:12288
    buffer_load_dwordx4 v18, s[8:11], s36 offen offset:2048 lds
    v_fma_f32 v251, v249, 2.0, 1.0
    v_mfma_f32_16x16x32_bf16 v[68:71], a[88:91], a[108:111], v[68:71]
    ds_read_b128 a[60:63], v148 offset:14336
    v_mfma_f32_16x16x32_bf16 v[72:75], a[92:95], a[104:107], v[72:75]
    buffer_load_dwordx4 v19, s[8:11], s36 offen offset:3072 lds
    v_mul_f32 v251, 0x3a000000, v251
    v_mfma_f32_16x16x32_bf16 v[76:79], a[92:95], a[108:111], v[76:79]
    v_mul_f32_e64 v248, v14, v251
    v_mfma_f32_16x16x32_bf16 v[80:83], a[96:99], a[104:107], v[80:83]
    s_add_u32 m0, s37, 49152
    v_mfma_f32_16x16x32_bf16 v[84:87], a[96:99], a[108:111], v[84:87]
    v_fmamk_f32 v4, v251, 0x00000000, v248
    v_mfma_f32_16x16x32_bf16 v[88:91], a[100:103], a[104:107], v[88:91]
    buffer_load_dwordx4 v20, s[12:15], s36 offen offset:0 lds
    v_fmamk_f32 v5, v251, 0x3f800000, v248
    v_mfma_f32_16x16x32_bf16 v[92:95], a[100:103], a[108:111], v[92:95]
    s_waitcnt lgkmcnt(0)
    v_mfma_f32_16x16x32_bf16 v[32:35], a[32:35], a[64:67], v[32:35]
    ds_read_b128 a[104:107], v151 offset:0
    buffer_load_dwordx4 v21, s[12:15], s36 offen offset:1024 lds
    v_fmamk_f32 v6, v251, 0x40000000, v248
    v_mfma_f32_16x16x32_bf16 v[36:39], a[32:35], a[68:71], v[36:39]
    ds_read_b128 a[108:111], v151 offset:8192
    buffer_load_dwordx4 v22, s[12:15], s36 offen offset:2048 lds
    v_fmamk_f32 v7, v251, 0x40400000, v248
    v_mfma_f32_16x16x32_bf16 v[40:43], a[36:39], a[64:67], v[40:43]
    ds_read_b128 a[72:75], v149 offset:0
    v_cos_f32 v120, v4
    v_mfma_f32_16x16x32_bf16 v[44:47], a[36:39], a[68:71], v[44:47]
    ds_read_b128 a[76:79], v149 offset:2048
    buffer_load_dwordx4 v23, s[12:15], s36 offen offset:3072 lds
    v_mfma_f32_16x16x32_bf16 v[48:51], a[40:43], a[64:67], v[48:51]
    ds_read_b128 a[80:83], v149 offset:4096
    v_cos_f32_e64 v121, v5
    v_mfma_f32_16x16x32_bf16 v[52:55], a[40:43], a[68:71], v[52:55]
    ds_read_b128 a[84:87], v149 offset:6144
    s_getpc_b64 s[20:21]
K_PC2:
    s_mov_b32 s22, K_CODE_END-K_PC2
    v_cos_f32 v122, v6
    v_mfma_f32_16x16x32_bf16 v[56:59], a[44:47], a[64:67], v[56:59]
    ds_read_b128 a[88:91], v149 offset:8192
    v_mfma_f32_16x16x32_bf16 v[60:63], a[44:47], a[68:71], v[60:63]
    ds_read_b128 a[92:95], v149 offset:10240
    s_bfe_u32 s3, s2, 0x20003
    v_cos_f32_e64 v123, v7
    v_mfma_f32_16x16x32_bf16 v[64:67], a[48:51], a[64:67], v[64:67]
    ds_read_b128 a[96:99], v149 offset:12288
    s_lshl2_add_u32 s3, s3, s34
    v_sin_f32 v124, v4
    v_mfma_f32_16x16x32_bf16 v[68:71], a[48:51], a[68:71], v[68:71]
    ds_read_b128 a[100:103], v149 offset:14336
    v_mfma_f32_16x16x32_bf16 v[72:75], a[52:55], a[64:67], v[72:75]
    s_lshl_b32 s3, s3, 11
    v_sin_f32 v125, v5
    v_mfma_f32_16x16x32_bf16 v[76:79], a[52:55], a[68:71], v[76:79]
    v_sin_f32_e64 v126, v6
    v_mfma_f32_16x16x32_bf16 v[80:83], a[56:59], a[64:67], v[80:83]
    v_lshl_add_u32 v28, v0, 5, s3
    v_mfma_f32_16x16x32_bf16 v[84:87], a[56:59], a[68:71], v[84:87]
    v_sin_f32_e64 v127, v7
    v_mfma_f32_16x16x32_bf16 v[88:91], a[60:63], a[64:67], v[88:91]
    buffer_load_dword a221, v28, s[20:23], 0 offen
    v_mul_f32_e64 v120, v15, v120
    v_mfma_f32_16x16x32_bf16 v[92:95], a[60:63], a[68:71], v[92:95]
    s_waitcnt lgkmcnt(0) vmcnt(17)
    s_barrier
    v_mfma_f32_16x16x32_bf16 v[32:35], a[72:75], a[104:107], v[32:35]
    ds_read_b128 a[64:67], v150 offset:32768
    v_lshlrev_b32 v217, 4, v0
    v_mul_f32 v121, v15, v121
    v_mfma_f32_16x16x32_bf16 v[36:39], a[72:75], a[108:111], v[36:39]
    ds_read_b128 a[68:71], v150 offset:40960
    v_mfma_f32_16x16x32_bf16 v[40:43], a[76:79], a[104:107], v[40:43]
    ds_read_b128 a[32:35], v148 offset:32768
    s_lshl_b32 s68, s34, 10
    v_mul_f32 v122, v15, v122
    v_mfma_f32_16x16x32_bf16 v[44:47], a[76:79], a[108:111], v[44:47]
    ds_read_b128 a[36:39], v148 offset:34816
    v_mfma_f32_16x16x32_bf16 v[48:51], a[80:83], a[104:107], v[48:51]
    ds_read_b128 a[40:43], v148 offset:36864
    s_add_u32 s68, s68, 22347776
    v_mul_f32_e64 v123, v15, v123
    v_mfma_f32_16x16x32_bf16 v[52:55], a[80:83], a[108:111], v[52:55]
    ds_read_b128 a[44:47], v148 offset:38912
    v_mfma_f32_16x16x32_bf16 v[56:59], a[84:87], a[104:107], v[56:59]
    ds_read_b128 a[48:51], v148 offset:40960
    buffer_load_dword v216, v217, s[24:27], s68 offen sc1
    v_mul_f32_e64 v124, v15, v124
    v_mfma_f32_16x16x32_bf16 v[60:63], a[84:87], a[108:111], v[60:63]
    ds_read_b128 a[52:55], v148 offset:43008
    v_mfma_f32_16x16x32_bf16 v[64:67], a[88:91], a[104:107], v[64:67]
    ds_read_b128 a[56:59], v148 offset:45056
    s_bfe_u32 s36, s67, 262168
    v_mfma_f32_16x16x32_bf16 v[68:71], a[88:91], a[108:111], v[68:71]
    ds_read_b128 a[60:63], v148 offset:47104
    v_mul_f32_e64 v125, v15, v125
    v_mfma_f32_16x16x32_bf16 v[72:75], a[92:95], a[104:107], v[72:75]
    s_add_u32 m0, s37, 65536
    v_mfma_f32_16x16x32_bf16 v[76:79], a[92:95], a[108:111], v[76:79]
    v_mul_f32_e64 v126, v15, v126
    v_mfma_f32_16x16x32_bf16 v[80:83], a[96:99], a[104:107], v[80:83]
    s_lshl_b32 s36, s36, 7
    v_mfma_f32_16x16x32_bf16 v[84:87], a[96:99], a[108:111], v[84:87]
    v_mul_f32 v127, v15, v127
    v_mfma_f32_16x16x32_bf16 v[88:91], a[100:103], a[104:107], v[88:91]
    buffer_load_dwordx4 v16, s[8:11], s36 offen offset:0 lds
    v_mfma_f32_16x16x32_bf16 v[92:95], a[100:103], a[108:111], v[92:95]
    s_waitcnt lgkmcnt(0)
    v_mfma_f32_16x16x32_bf16 v[32:35], a[32:35], a[64:67], v[32:35]
    ds_read_b128 a[104:107], v151 offset:32768
    buffer_load_dwordx4 v17, s[8:11], s36 offen offset:1024 lds
    v_mfma_f32_16x16x32_bf16 v[36:39], a[32:35], a[68:71], v[36:39]
    ds_read_b128 a[108:111], v151 offset:40960
    v_mfma_f32_16x16x32_bf16 v[40:43], a[36:39], a[64:67], v[40:43]
    ds_read_b128 a[72:75], v149 offset:32768
    buffer_load_dwordx4 v18, s[8:11], s36 offen offset:2048 lds
    v_mfma_f32_16x16x32_bf16 v[44:47], a[36:39], a[68:71], v[44:47]
    ds_read_b128 a[76:79], v149 offset:34816
    v_mfma_f32_16x16x32_bf16 v[48:51], a[40:43], a[64:67], v[48:51]
    ds_read_b128 a[80:83], v149 offset:36864
    buffer_load_dwordx4 v19, s[8:11], s36 offen offset:3072 lds
    v_mfma_f32_16x16x32_bf16 v[52:55], a[40:43], a[68:71], v[52:55]
    ds_read_b128 a[84:87], v149 offset:38912
    v_mfma_f32_16x16x32_bf16 v[56:59], a[44:47], a[64:67], v[56:59]
    ds_read_b128 a[88:91], v149 offset:40960
    s_add_u32 m0, s37, 81920
    v_mfma_f32_16x16x32_bf16 v[60:63], a[44:47], a[68:71], v[60:63]
    ds_read_b128 a[92:95], v149 offset:43008
    v_mfma_f32_16x16x32_bf16 v[64:67], a[48:51], a[64:67], v[64:67]
    ds_read_b128 a[96:99], v149 offset:45056
    buffer_load_dwordx4 v20, s[12:15], s36 offen offset:0 lds
    v_mfma_f32_16x16x32_bf16 v[68:71], a[48:51], a[68:71], v[68:71]
    ds_read_b128 a[100:103], v149 offset:47104
    v_mfma_f32_16x16x32_bf16 v[72:75], a[52:55], a[64:67], v[72:75]
    buffer_load_dwordx4 v21, s[12:15], s36 offen offset:1024 lds
    v_mfma_f32_16x16x32_bf16 v[76:79], a[52:55], a[68:71], v[76:79]
    v_mfma_f32_16x16x32_bf16 v[80:83], a[56:59], a[64:67], v[80:83]
    buffer_load_dwordx4 v22, s[12:15], s36 offen offset:2048 lds
    v_mfma_f32_16x16x32_bf16 v[84:87], a[56:59], a[68:71], v[84:87]
    v_mfma_f32_16x16x32_bf16 v[88:91], a[60:63], a[64:67], v[88:91]
    buffer_load_dwordx4 v23, s[12:15], s36 offen offset:3072 lds
    v_mfma_f32_16x16x32_bf16 v[92:95], a[60:63], a[68:71], v[92:95]
    s_waitcnt lgkmcnt(0) vmcnt(18)
    s_barrier
    v_mfma_f32_16x16x32_bf16 v[32:35], a[72:75], a[104:107], v[32:35]
    ds_read_b128 a[64:67], v26 offset:0
    s_bfe_u32 s36, s67, 262172
    v_mfma_f32_16x16x32_bf16 v[36:39], a[72:75], a[108:111], v[36:39]
    ds_read_b128 a[68:71], v26 offset:8192
    v_mfma_f32_16x16x32_bf16 v[40:43], a[76:79], a[104:107], v[40:43]
    ds_read_b128 a[32:35], v24 offset:0
    s_add_u32 m0, s37, 98304
    v_mfma_f32_16x16x32_bf16 v[44:47], a[76:79], a[108:111], v[44:47]
    ds_read_b128 a[36:39], v24 offset:2048
    v_mfma_f32_16x16x32_bf16 v[48:51], a[80:83], a[104:107], v[48:51]
    ds_read_b128 a[40:43], v24 offset:4096
    s_lshl_b32 s36, s36, 7
    v_mfma_f32_16x16x32_bf16 v[52:55], a[80:83], a[108:111], v[52:55]
    ds_read_b128 a[44:47], v24 offset:6144
    v_mfma_f32_16x16x32_bf16 v[56:59], a[84:87], a[104:107], v[56:59]
    ds_read_b128 a[48:51], v24 offset:8192
    buffer_load_dwordx4 v16, s[8:11], s36 offen offset:0 lds
    v_mfma_f32_16x16x32_bf16 v[60:63], a[84:87], a[108:111], v[60:63]
    ds_read_b128 a[52:55], v24 offset:10240
    v_mfma_f32_16x16x32_bf16 v[64:67], a[88:91], a[104:107], v[64:67]
    ds_read_b128 a[56:59], v24 offset:12288
    v_mfma_f32_16x16x32_bf16 v[68:71], a[88:91], a[108:111], v[68:71]
    ds_read_b128 a[60:63], v24 offset:14336
    buffer_load_dwordx4 v17, s[8:11], s36 offen offset:1024 lds
    v_mfma_f32_16x16x32_bf16 v[72:75], a[92:95], a[104:107], v[72:75]
    v_mfma_f32_16x16x32_bf16 v[76:79], a[92:95], a[108:111], v[76:79]
    buffer_load_dwordx4 v18, s[8:11], s36 offen offset:2048 lds
    v_mfma_f32_16x16x32_bf16 v[80:83], a[96:99], a[104:107], v[80:83]
    v_mfma_f32_16x16x32_bf16 v[84:87], a[96:99], a[108:111], v[84:87]
    buffer_load_dwordx4 v19, s[8:11], s36 offen offset:3072 lds
    v_mfma_f32_16x16x32_bf16 v[88:91], a[100:103], a[104:107], v[88:91]
    v_mfma_f32_16x16x32_bf16 v[92:95], a[100:103], a[108:111], v[92:95]
    s_waitcnt lgkmcnt(0)
    v_mfma_f32_16x16x32_bf16 v[32:35], a[32:35], a[64:67], v[32:35]
    ds_read_b128 a[104:107], v27 offset:0
    s_add_u32 m0, s37, 114688
    v_and_b32 v6, 7, v0
    v_xor_b32_e64 v6, v6, v2
    v_mfma_f32_16x16x32_bf16 v[36:39], a[32:35], a[68:71], v[36:39]
    ds_read_b128 a[108:111], v27 offset:8192
    s_and_b32 s38, s33, 8
    s_lshl_b32 s38, s38, 7
    v_mfma_f32_16x16x32_bf16 v[40:43], a[36:39], a[64:67], v[40:43]
    ds_read_b128 a[72:75], v25 offset:0
    v_lshl_add_u32 v6, v6, 4, s38
    v_lshrrev_b32_e64 v8, 3, v0
    v_mfma_f32_16x16x32_bf16 v[44:47], a[36:39], a[68:71], v[44:47]
    ds_read_b128 a[76:79], v25 offset:2048
    buffer_load_dwordx4 v20, s[12:15], s36 offen offset:0 lds
    s_xor_b32 s38, s33, 8
    v_mfma_f32_16x16x32_bf16 v[48:51], a[40:43], a[64:67], v[48:51]
    ds_read_b128 a[80:83], v25 offset:4096
    s_lshl_b32 s38, s38, 5
    s_add_u32 s38, s38, s6
    v_mfma_f32_16x16x32_bf16 v[52:55], a[40:43], a[68:71], v[52:55]
    ds_read_b128 a[84:87], v25 offset:6144
    s_lshl_b32 s38, s38, 1
    v_lshl_add_u32 v8, v8, 2, s38
    v_mfma_f32_16x16x32_bf16 v[56:59], a[44:47], a[64:67], v[56:59]
    ds_read_b128 a[88:91], v25 offset:8192
    buffer_load_dwordx4 v21, s[12:15], s36 offen offset:1024 lds
    v_lshl_add_u32 v16, v8, 11, v6
    v_mfma_f32_16x16x32_bf16 v[60:63], a[44:47], a[68:71], v[60:63]
    ds_read_b128 a[92:95], v25 offset:10240
    v_xor_b32_e64 v8, 64, v16
    v_add_u32 v17, 64512, v8
    v_mfma_f32_16x16x32_bf16 v[64:67], a[48:51], a[64:67], v[64:67]
    ds_read_b128 a[96:99], v25 offset:12288
    v_mov_b32_e64 v18, v16
    v_add_u32 v19, 64512, v8
    v_mfma_f32_16x16x32_bf16 v[68:71], a[48:51], a[68:71], v[68:71]
    ds_read_b128 a[100:103], v25 offset:14336
    buffer_load_dwordx4 v22, s[12:15], s36 offen offset:2048 lds
    s_lshl1_add_u32 s40, s33, s6
    v_mfma_f32_16x16x32_bf16 v[72:75], a[52:55], a[64:67], v[72:75]
    s_lshl_b32 s40, s40, 6
    s_lshr_b32 s41, s33, 3
    v_mfma_f32_16x16x32_bf16 v[76:79], a[52:55], a[68:71], v[76:79]
    s_add_u32 s40, s40, s41
    s_and_b32 s41, s32, 3
    v_mfma_f32_16x16x32_bf16 v[80:83], a[56:59], a[64:67], v[80:83]
    buffer_load_dwordx4 v23, s[12:15], s36 offen offset:3072 lds
    s_lshl2_add_u32 s40, s40, s41
    v_mfma_f32_16x16x32_bf16 v[84:87], a[56:59], a[68:71], v[84:87]
    s_and_b32 s41, s2, 1
    s_lshl1_add_u32 s40, s40, s41
    v_mfma_f32_16x16x32_bf16 v[88:91], a[60:63], a[64:67], v[88:91]
    s_lshl_b32 s92, s40, 7
    v_lshrrev_b32 v29, 1, v0
    v_mfma_f32_16x16x32_bf16 v[92:95], a[60:63], a[68:71], v[92:95]
    v_lshlrev_b32 v29, 11, v29
    s_waitcnt lgkmcnt(0) vmcnt(16)
    v_cmp_ne_u32 vcc, s35, v216
    s_nop 0
    s_cbranch_vccnz K_POLL1
K_POLL1_OK:
    s_barrier
    v_mfma_f32_16x16x32_bf16 v[32:35], a[72:75], a[104:107], v[32:35]
    ds_read_b128 a[64:67], v26 offset:32768
    v_lshlrev_b32_e64 v28, 12, v2
    v_mfma_f32_16x16x32_bf16 v[36:39], a[72:75], a[108:111], v[36:39]
    ds_read_b128 a[68:71], v26 offset:40960
    v_lshl_add_u32 v28, v1, 4, v28
    v_mfma_f32_16x16x32_bf16 v[40:43], a[76:79], a[104:107], v[40:43]
    ds_read_b128 a[32:35], v24 offset:32768
    s_lshl4_add_u32 s68, s37, s5
    v_mfma_f32_16x16x32_bf16 v[44:47], a[76:79], a[108:111], v[44:47]
    ds_read_b128 a[36:39], v24 offset:34816
    s_add_u32 m0, s37, 131072
    v_mfma_f32_16x16x32_bf16 v[48:51], a[80:83], a[104:107], v[48:51]
    ds_read_b128 a[40:43], v24 offset:36864
    s_add_u32 s69, s68, 0
    v_mfma_f32_16x16x32_bf16 v[52:55], a[80:83], a[108:111], v[52:55]
    ds_read_b128 a[44:47], v24 offset:38912
    v_mfma_f32_16x16x32_bf16 v[56:59], a[84:87], a[104:107], v[56:59]
    ds_read_b128 a[48:51], v24 offset:40960
    buffer_load_dwordx4 v28, s[28:31], s69 offen sc1 lds
    v_mfma_f32_16x16x32_bf16 v[60:63], a[84:87], a[108:111], v[60:63]
    ds_read_b128 a[52:55], v24 offset:43008
    s_add_u32 m0, s37, 132096
    v_mfma_f32_16x16x32_bf16 v[64:67], a[88:91], a[104:107], v[64:67]
    ds_read_b128 a[56:59], v24 offset:45056
    s_add_u32 s69, s68, 16384
    v_mfma_f32_16x16x32_bf16 v[68:71], a[88:91], a[108:111], v[68:71]
    ds_read_b128 a[60:63], v24 offset:47104
    buffer_load_dwordx4 v28, s[28:31], s69 offen sc1 lds
    v_mfma_f32_16x16x32_bf16 v[72:75], a[92:95], a[104:107], v[72:75]
    v_mfma_f32_16x16x32_bf16 v[76:79], a[92:95], a[108:111], v[76:79]
    s_add_u32 m0, s37, 133120
    v_mfma_f32_16x16x32_bf16 v[80:83], a[96:99], a[104:107], v[80:83]
    s_add_u32 s69, s68, 32768
    v_mfma_f32_16x16x32_bf16 v[84:87], a[96:99], a[108:111], v[84:87]
    buffer_load_dwordx4 v28, s[28:31], s69 offen sc1 lds
    v_mfma_f32_16x16x32_bf16 v[88:91], a[100:103], a[104:107], v[88:91]
    s_add_u32 m0, s37, 134144
    v_mfma_f32_16x16x32_bf16 v[92:95], a[100:103], a[108:111], v[92:95]
    s_waitcnt lgkmcnt(0)
    v_mfma_f32_16x16x32_bf16 v[32:35], a[32:35], a[64:67], v[32:35]
    ds_read_b128 a[104:107], v27 offset:32768
    s_add_u32 s69, s68, 49152
    v_mfma_f32_16x16x32_bf16 v[36:39], a[32:35], a[68:71], v[36:39]
    ds_read_b128 a[108:111], v27 offset:40960
    buffer_load_dwordx4 v28, s[28:31], s69 offen sc1 lds
    v_mfma_f32_16x16x32_bf16 v[40:43], a[36:39], a[64:67], v[40:43]
    ds_read_b128 a[72:75], v25 offset:32768
    s_add_u32 s69, s68, 262144
    v_mfma_f32_16x16x32_bf16 v[44:47], a[36:39], a[68:71], v[44:47]
    ds_read_b128 a[76:79], v25 offset:34816
    buffer_load_dwordx4 v[200:203], v28, s[28:31], s69 offen sc1
    v_mfma_f32_16x16x32_bf16 v[48:51], a[40:43], a[64:67], v[48:51]
    ds_read_b128 a[80:83], v25 offset:36864
    s_add_u32 s69, s68, 278528
    v_mfma_f32_16x16x32_bf16 v[52:55], a[40:43], a[68:71], v[52:55]
    ds_read_b128 a[84:87], v25 offset:38912
    v_mfma_f32_16x16x32_bf16 v[56:59], a[44:47], a[64:67], v[56:59]
    ds_read_b128 a[88:91], v25 offset:40960
    buffer_load_dwordx4 v[204:207], v28, s[28:31], s69 offen sc1
    v_mfma_f32_16x16x32_bf16 v[60:63], a[44:47], a[68:71], v[60:63]
    ds_read_b128 a[92:95], v25 offset:43008
    s_add_u32 s69, s68, 294912
    v_mfma_f32_16x16x32_bf16 v[64:67], a[48:51], a[64:67], v[64:67]
    ds_read_b128 a[96:99], v25 offset:45056
    buffer_load_dwordx4 v[208:211], v28, s[28:31], s69 offen sc1
    v_mfma_f32_16x16x32_bf16 v[68:71], a[48:51], a[68:71], v[68:71]
    ds_read_b128 a[100:103], v25 offset:47104
    s_add_u32 s69, s68, 311296
    v_mfma_f32_16x16x32_bf16 v[72:75], a[52:55], a[64:67], v[72:75]
    v_mfma_f32_16x16x32_bf16 v[76:79], a[52:55], a[68:71], v[76:79]
    buffer_load_dwordx4 v[212:215], v28, s[28:31], s69 offen sc1
    v_mfma_f32_16x16x32_bf16 v[80:83], a[56:59], a[64:67], v[80:83]
    s_cmp_eq_u32 s2, 0
    s_cbranch_scc1 K_W256
K_W256_RET:
    v_mfma_f32_16x16x32_bf16 v[84:87], a[56:59], a[68:71], v[84:87]
    v_lshlrev_b32 v28, 6, v1
    v_mfma_f32_16x16x32_bf16 v[88:91], a[60:63], a[64:67], v[88:91]
    buffer_load_dword a222, v28, s[24:27], s51 offen sc1
    v_mfma_f32_16x16x32_bf16 v[92:95], a[60:63], a[68:71], v[92:95]
    s_waitcnt lgkmcnt(0) vmcnt(17)
    s_barrier
    v_mfma_f32_16x16x32_bf16 v[32:35], a[72:75], a[104:107], v[32:35]
    ds_read_b128 a[64:67], v150 offset:0
    v_and_b32_e64 v14, 8, v1
    v_mfma_f32_16x16x32_bf16 v[36:39], a[72:75], a[108:111], v[36:39]
    ds_read_b128 a[68:71], v150 offset:8192
    v_and_b32_e64 v15, 3, v1
    v_mfma_f32_16x16x32_bf16 v[40:43], a[76:79], a[104:107], v[40:43]
    ds_read_b128 a[32:35], v148 offset:0
    v_lshl_or_b32 v14, v15, 1, v14
    v_mfma_f32_16x16x32_bf16 v[44:47], a[76:79], a[108:111], v[44:47]
    ds_read_b128 a[36:39], v148 offset:2048
    v_bfe_u32 v15, v1, 2, 1
    v_mfma_f32_16x16x32_bf16 v[48:51], a[80:83], a[104:107], v[48:51]
    ds_read_b128 a[40:43], v148 offset:4096
    v_lshlrev_b32_e64 v13, 2, v2
    v_mfma_f32_16x16x32_bf16 v[52:55], a[80:83], a[108:111], v[52:55]
    ds_read_b128 a[44:47], v148 offset:6144
    v_or_b32_e64 v14, v14, v15
    v_mfma_f32_16x16x32_bf16 v[56:59], a[84:87], a[104:107], v[56:59]
    ds_read_b128 a[48:51], v148 offset:8192
    v_xor_b32_e64 v14, v14, v13
    v_mfma_f32_16x16x32_bf16 v[60:63], a[84:87], a[108:111], v[60:63]
    ds_read_b128 a[52:55], v148 offset:10240
    v_lshl_add_u32 v14, v1, 4, v14
    v_mfma_f32_16x16x32_bf16 v[64:67], a[88:91], a[104:107], v[64:67]
    ds_read_b128 a[56:59], v148 offset:12288
    s_lshl1_add_u32 s38, s37, 131072
    v_mfma_f32_16x16x32_bf16 v[68:71], a[88:91], a[108:111], v[68:71]
    ds_read_b128 a[60:63], v148 offset:14336
    v_lshl_add_u32 v216, v14, 4, s38
    v_mfma_f32_16x16x32_bf16 v[72:75], a[92:95], a[104:107], v[72:75]
    v_xor_b32_e64 v217, 16, v216
    v_mfma_f32_16x16x32_bf16 v[76:79], a[92:95], a[108:111], v[76:79]
    v_xor_b32_e64 v218, 32, v216
    v_mfma_f32_16x16x32_bf16 v[80:83], a[96:99], a[104:107], v[80:83]
    v_xor_b32_e64 v219, 48, v216
    v_mfma_f32_16x16x32_bf16 v[84:87], a[96:99], a[108:111], v[84:87]
    v_and_b32_e64 v14, 1, v2
    v_mfma_f32_16x16x32_bf16 v[88:91], a[100:103], a[104:107], v[88:91]
    v_lshrrev_b32_e64 v15, 2, v1
    v_mfma_f32_16x16x32_bf16 v[92:95], a[100:103], a[108:111], v[92:95]
    s_waitcnt lgkmcnt(0)
    v_mfma_f32_16x16x32_bf16 v[32:35], a[32:35], a[64:67], v[32:35]
    ds_read_b128 a[104:107], v151 offset:0
    v_lshl_add_u32 v12, v2, 3, v15
    v_mfma_f32_16x16x32_bf16 v[36:39], a[32:35], a[68:71], v[36:39]
    ds_read_b128 a[108:111], v151 offset:8192
    v_lshlrev_b32 v14, 3, v14
    v_mfma_f32_16x16x32_bf16 v[40:43], a[36:39], a[64:67], v[40:43]
    ds_read_b128 a[72:75], v149 offset:0
    v_lshl_or_b32 v14, v15, 1, v14
    v_mfma_f32_16x16x32_bf16 v[44:47], a[36:39], a[68:71], v[44:47]
    ds_read_b128 a[76:79], v149 offset:2048
    v_bfe_u32 v15, v1, 1, 1
    v_mfma_f32_16x16x32_bf16 v[48:51], a[40:43], a[64:67], v[48:51]
    ds_read_b128 a[80:83], v149 offset:4096
    v_xor_b32_e64 v14, v14, v15
    v_mfma_f32_16x16x32_bf16 v[52:55], a[40:43], a[68:71], v[52:55]
    ds_read_b128 a[84:87], v149 offset:6144
    v_lshl_add_u32 v12, v12, 4, v14
    v_mfma_f32_16x16x32_bf16 v[56:59], a[44:47], a[64:67], v[56:59]
    ds_read_b128 a[88:91], v149 offset:8192
    v_and_b32_e64 v15, 1, v1
    v_mfma_f32_16x16x32_bf16 v[60:63], a[44:47], a[68:71], v[60:63]
    ds_read_b128 a[92:95], v149 offset:10240
    v_lshl_add_u32 v12, v12, 1, v15
    v_mfma_f32_16x16x32_bf16 v[64:67], a[48:51], a[64:67], v[64:67]
    ds_read_b128 a[96:99], v149 offset:12288
    s_lshl_b32 s38, s94, 5
    v_mfma_f32_16x16x32_bf16 v[68:71], a[48:51], a[68:71], v[68:71]
    ds_read_b128 a[100:103], v149 offset:14336
    s_add_u32 s38, s38, 131072
    v_mfma_f32_16x16x32_bf16 v[72:75], a[52:55], a[64:67], v[72:75]
    v_lshlrev_b32 v12, 3, v12
    v_mfma_f32_16x16x32_bf16 v[76:79], a[52:55], a[68:71], v[76:79]
    v_xor_b32_e64 v220, s38, v12
    v_mfma_f32_16x16x32_bf16 v[80:83], a[56:59], a[64:67], v[80:83]
    v_xor_b32_e64 v221, 16, v220
    v_mfma_f32_16x16x32_bf16 v[84:87], a[56:59], a[68:71], v[84:87]
    v_xor_b32_e64 v222, 64, v220
    v_mfma_f32_16x16x32_bf16 v[88:91], a[60:63], a[64:67], v[88:91]
    v_xor_b32 v223, 80, v220
    v_mfma_f32_16x16x32_bf16 v[92:95], a[60:63], a[68:71], v[92:95]
    s_waitcnt lgkmcnt(0) vmcnt(9)
    s_barrier
    v_mfma_f32_16x16x32_bf16 v[32:35], a[72:75], a[104:107], v[32:35]
    ds_read_b128 a[64:67], v150 offset:32768
    s_bfe_u32 s72, s97, 262148
    v_and_b32_e64 v8, 1, v2
    v_mfma_f32_16x16x32_bf16 v[36:39], a[72:75], a[108:111], v[36:39]
    ds_read_b128 a[68:71], v150 offset:40960
    v_lshrrev_b32_e64 v9, 1, v1
    v_mfma_f32_16x16x32_bf16 v[40:43], a[76:79], a[104:107], v[40:43]
    ds_read_b128 a[32:35], v148 offset:32768
    v_xor_b32_e64 v8, v8, v9
    v_mfma_f32_16x16x32_bf16 v[44:47], a[76:79], a[108:111], v[44:47]
    ds_read_b128 a[36:39], v148 offset:34816
    v_lshlrev_b32_e64 v8, 4, v8
    v_mfma_f32_16x16x32_bf16 v[48:51], a[80:83], a[104:107], v[48:51]
    ds_read_b128 a[40:43], v148 offset:36864
    s_add_u32 m0, s37, 16384
    v_lshl_add_u32 v8, v1, 7, v8
    v_mfma_f32_16x16x32_bf16 v[52:55], a[80:83], a[108:111], v[52:55]
    ds_read_b128 a[44:47], v148 offset:38912
    v_lshrrev_b32_e64 v9, 1, v2
    v_mfma_f32_16x16x32_bf16 v[56:59], a[84:87], a[104:107], v[56:59]
    ds_read_b128 a[48:51], v148 offset:40960
    v_lshl_add_u32 v20, v9, 13, v8
    v_mfma_f32_16x16x32_bf16 v[60:63], a[84:87], a[108:111], v[60:63]
    ds_read_b128 a[52:55], v148 offset:43008
    v_lshlrev_b32_e64 v9, 12, v2
    v_mfma_f32_16x16x32_bf16 v[64:67], a[88:91], a[104:107], v[64:67]
    ds_read_b128 a[56:59], v148 offset:45056
    s_lshl_b32 s72, s72, 7
    v_lshl_add_u32 v24, v1, 4, v9
    v_mfma_f32_16x16x32_bf16 v[68:71], a[88:91], a[108:111], v[68:71]
    ds_read_b128 a[60:63], v148 offset:47104
    v_xor_b32 v21, 32, v20
    v_mfma_f32_16x16x32_bf16 v[72:75], a[92:95], a[104:107], v[72:75]
    v_add_u32 v25, 16384, v24
    v_mfma_f32_16x16x32_bf16 v[76:79], a[92:95], a[108:111], v[76:79]
    v_xor_b32_e64 v22, 64, v20
    v_mfma_f32_16x16x32_bf16 v[80:83], a[96:99], a[104:107], v[80:83]
    buffer_load_dwordx4 v16, s[16:19], s72 offen offset:0  lds
    v_add_u32 v26, 32768, v24
    v_mfma_f32_16x16x32_bf16 v[84:87], a[96:99], a[108:111], v[84:87]
    v_xor_b32 v23, 96, v20
    v_mfma_f32_16x16x32_bf16 v[88:91], a[100:103], a[104:107], v[88:91]
    v_add_u32 v27, 49152, v24
    v_mfma_f32_16x16x32_bf16 v[92:95], a[100:103], a[108:111], v[92:95]
    s_waitcnt lgkmcnt(0)
    v_mfma_f32_16x16x32_bf16 v[32:35], a[32:35], a[64:67], v[32:35]
    ds_read_b128 a[104:107], v151 offset:32768
    buffer_load_dwordx4 v17, s[16:19], s72 offen offset:1024  lds
    v_mfma_f32_16x16x32_bf16 v[36:39], a[32:35], a[68:71], v[36:39]
    ds_read_b128 a[108:111], v151 offset:40960
    v_mfma_f32_16x16x32_bf16 v[40:43], a[36:39], a[64:67], v[40:43]
    ds_read_b128 a[72:75], v149 offset:32768
    v_mfma_f32_16x16x32_bf16 v[44:47], a[36:39], a[68:71], v[44:47]
    ds_read_b128 a[76:79], v149 offset:34816
    v_mfma_f32_16x16x32_bf16 v[48:51], a[40:43], a[64:67], v[48:51]
    ds_read_b128 a[80:83], v149 offset:36864
    v_mfma_f32_16x16x32_bf16 v[52:55], a[40:43], a[68:71], v[52:55]
    ds_read_b128 a[84:87], v149 offset:38912
    buffer_load_dwordx4 v18, s[16:19], s72 offen offset:2048  lds
    v_mfma_f32_16x16x32_bf16 v[56:59], a[44:47], a[64:67], v[56:59]
    ds_read_b128 a[88:91], v149 offset:40960
    v_mfma_f32_16x16x32_bf16 v[60:63], a[44:47], a[68:71], v[60:63]
    ds_read_b128 a[92:95], v149 offset:43008
    v_mfma_f32_16x16x32_bf16 v[64:67], a[48:51], a[64:67], v[64:67]
    ds_read_b128 a[96:99], v149 offset:45056
    v_mfma_f32_16x16x32_bf16 v[68:71], a[48:51], a[68:71], v[68:71]
    ds_read_b128 a[100:103], v149 offset:47104
    v_mfma_f32_16x16x32_bf16 v[72:75], a[52:55], a[64:67], v[72:75]
    buffer_load_dwordx4 v19, s[16:19], s72 offen offset:3072  lds
    v_mfma_f32_16x16x32_bf16 v[76:79], a[52:55], a[68:71], v[76:79]
    v_mfma_f32_16x16x32_bf16 v[80:83], a[56:59], a[64:67], v[80:83]
    v_mfma_f32_16x16x32_bf16 v[84:87], a[56:59], a[68:71], v[84:87]
    v_mfma_f32_16x16x32_bf16 v[88:91], a[60:63], a[64:67], v[88:91]
    v_mfma_f32_16x16x32_bf16 v[92:95], a[60:63], a[68:71], v[92:95]
    s_waitcnt lgkmcnt(0)
    v_mfma_f32_16x16x32_bf16 v[32:35], a[72:75], a[104:107], v[32:35]
    v_add_u32 v28, 131072, v3
    v_lshlrev_b32_e64 v12, 2, v2
    v_mfma_f32_16x16x32_bf16 v[36:39], a[72:75], a[108:111], v[36:39]
    v_sub_u32_e64 v12, s32, v12
    v_mfma_f32_16x16x32_bf16 v[40:43], a[76:79], a[104:107], v[40:43]
    v_lshlrev_b32_e64 v12, 10, v12
    v_mfma_f32_16x16x32_bf16 v[44:47], a[76:79], a[108:111], v[44:47]
    v_lshl_add_u32 v12, v1, 4, v12
    v_subrev_u32 v148, 1024, v12
    v_mfma_f32_16x16x32_bf16 v[48:51], a[80:83], a[104:107], v[48:51]
    v_min_u32_e64 v148, 2.0, v148
    v_mfma_f32_16x16x32_bf16 v[52:55], a[80:83], a[108:111], v[52:55]
    v_subrev_u32 v149, 2048, v12
    v_mfma_f32_16x16x32_bf16 v[56:59], a[84:87], a[104:107], v[56:59]
    v_min_u32_e64 v149, 2.0, v149
    v_subrev_u32 v150, 3072, v12
    v_mfma_f32_16x16x32_bf16 v[60:63], a[84:87], a[108:111], v[60:63]
    v_min_u32_e64 v150, 2.0, v150
    v_mfma_f32_16x16x32_bf16 v[64:67], a[88:91], a[104:107], v[64:67]
    v_subrev_u32 v151, 4096, v12
    v_mfma_f32_16x16x32_bf16 v[68:71], a[88:91], a[108:111], v[68:71]
    v_min_u32 v151, 2.0, v151
    v_mov_b32 v186, s35
    v_mfma_f32_16x16x32_bf16 v[72:75], a[92:95], a[104:107], v[72:75]
    v_mov_b32_e64 v187, s35
    v_mfma_f32_16x16x32_bf16 v[76:79], a[92:95], a[108:111], v[76:79]
    s_lshl_b32 s38, s32, 10
    v_mfma_f32_16x16x32_bf16 v[80:83], a[96:99], a[104:107], v[80:83]
    s_add_u32 s38, s38, s93
    v_cmp_gt_u32 s[78:79], 16, v0
    v_mfma_f32_16x16x32_bf16 v[84:87], a[96:99], a[108:111], v[84:87]
    v_cmp_eq_u32 s[46:47], 2, v2
    v_mfma_f32_16x16x32_bf16 v[88:91], a[100:103], a[104:107], v[88:91]
    v_cmp_eq_u32 s[44:45], 3, v2
    v_mfma_f32_16x16x32_bf16 v[92:95], a[100:103], a[108:111], v[92:95]
    v_cndmask_b32 v188, 2.0, v3, s[78:79]
    v_pk_fma_f32 v[4:5], v[32:33], v[128:129], v[34:35] op_sel_hi:[1,0,1]
    v_pk_fma_f32 v[6:7], v[36:37], v[128:129], v[38:39] op_sel_hi:[1,0,1]
    v_pk_fma_f32 v[4:5], v[36:37], v[128:129], v[4:5] op_sel:[0,1,0] neg_lo:[1,0,0] neg_hi:[1,0,0]
    v_pk_fma_f32 v[6:7], v[32:33], v[128:129], v[6:7] op_sel:[0,1,0]
    v_pk_fma_f32 v[8:9], v[4:5], v[128:129], v[40:41] op_sel_hi:[1,0,1]
    v_pk_fma_f32 v[10:11], v[6:7], v[128:129], v[44:45] op_sel_hi:[1,0,1]
    v_pk_fma_f32 v[8:9], v[6:7], v[128:129], v[8:9] op_sel:[0,1,0] neg_lo:[1,0,0] neg_hi:[1,0,0]
    v_pk_fma_f32 v[10:11], v[4:5], v[128:129], v[10:11] op_sel:[0,1,0]
    v_pk_fma_f32 v[4:5], v[8:9], v[128:129], v[42:43] op_sel_hi:[1,0,1]
    v_pk_fma_f32 v[6:7], v[10:11], v[128:129], v[46:47] op_sel_hi:[1,0,1]
    v_pk_fma_f32 v[4:5], v[10:11], v[128:129], v[4:5] op_sel:[0,1,0] neg_lo:[1,0,0] neg_hi:[1,0,0]
    v_pk_fma_f32 v[6:7], v[8:9], v[128:129], v[6:7] op_sel:[0,1,0]
    v_pk_fma_f32 v[8:9], v[4:5], v[128:129], v[48:49] op_sel_hi:[1,0,1]
    v_pk_fma_f32 v[10:11], v[6:7], v[128:129], v[52:53] op_sel_hi:[1,0,1]
    v_pk_fma_f32 v[8:9], v[6:7], v[128:129], v[8:9] op_sel:[0,1,0] neg_lo:[1,0,0] neg_hi:[1,0,0]
    v_pk_fma_f32 v[10:11], v[4:5], v[128:129], v[10:11] op_sel:[0,1,0]
    v_pk_fma_f32 v[4:5], v[8:9], v[128:129], v[50:51] op_sel_hi:[1,0,1]
    v_pk_fma_f32 v[6:7], v[10:11], v[128:129], v[54:55] op_sel_hi:[1,0,1]
    v_pk_fma_f32 v[4:5], v[10:11], v[128:129], v[4:5] op_sel:[0,1,0] neg_lo:[1,0,0] neg_hi:[1,0,0]
    v_pk_fma_f32 v[6:7], v[8:9], v[128:129], v[6:7] op_sel:[0,1,0]
    v_pk_fma_f32 v[8:9], v[4:5], v[128:129], v[56:57] op_sel_hi:[1,0,1]
    v_pk_fma_f32 v[10:11], v[6:7], v[128:129], v[60:61] op_sel_hi:[1,0,1]
    v_pk_fma_f32 v[8:9], v[6:7], v[128:129], v[8:9] op_sel:[0,1,0] neg_lo:[1,0,0] neg_hi:[1,0,0]
    v_pk_fma_f32 v[10:11], v[4:5], v[128:129], v[10:11] op_sel:[0,1,0]
    v_pk_fma_f32 v[4:5], v[8:9], v[128:129], v[58:59] op_sel_hi:[1,0,1]
    v_pk_fma_f32 v[6:7], v[10:11], v[128:129], v[62:63] op_sel_hi:[1,0,1]
    v_pk_fma_f32 v[4:5], v[10:11], v[128:129], v[4:5] op_sel:[0,1,0] neg_lo:[1,0,0] neg_hi:[1,0,0]
    v_pk_fma_f32 v[6:7], v[8:9], v[128:129], v[6:7] op_sel:[0,1,0]
    v_pk_fma_f32 v[8:9], v[4:5], v[128:129], v[64:65] op_sel_hi:[1,0,1]
    v_pk_fma_f32 v[10:11], v[6:7], v[128:129], v[68:69] op_sel_hi:[1,0,1]
    v_pk_fma_f32 v[8:9], v[6:7], v[128:129], v[8:9] op_sel:[0,1,0] neg_lo:[1,0,0] neg_hi:[1,0,0]
    v_pk_fma_f32 v[10:11], v[4:5], v[128:129], v[10:11] op_sel:[0,1,0]
    s_waitcnt vmcnt(9)
    s_barrier
    ds_read_b128 a[32:35], v28 offset:0
    ds_read_b128 a[36:39], v28 offset:1024
    ds_read_b128 a[40:43], v28 offset:2048
    ds_read_b128 a[44:47], v28 offset:3072
    ds_read_b128 a[48:51], v28 offset:4096
    ds_read_b128 a[52:55], v28 offset:5120
    ds_read_b128 a[56:59], v28 offset:6144
    ds_read_b128 a[60:63], v28 offset:7168
    v_pk_fma_f32 v[4:5], v[8:9], v[128:129], v[66:67] op_sel_hi:[1,0,1]
    v_pk_fma_f32 v[6:7], v[10:11], v[128:129], v[70:71] op_sel_hi:[1,0,1]
    v_pk_fma_f32 v[4:5], v[10:11], v[128:129], v[4:5] op_sel:[0,1,0] neg_lo:[1,0,0] neg_hi:[1,0,0]
    v_pk_fma_f32 v[6:7], v[8:9], v[128:129], v[6:7] op_sel:[0,1,0]
    v_pk_fma_f32 v[8:9], v[4:5], v[128:129], v[72:73] op_sel_hi:[1,0,1]
    v_pk_fma_f32 v[10:11], v[6:7], v[128:129], v[76:77] op_sel_hi:[1,0,1]
    v_pk_fma_f32 v[8:9], v[6:7], v[128:129], v[8:9] op_sel:[0,1,0] neg_lo:[1,0,0] neg_hi:[1,0,0]
    v_pk_fma_f32 v[10:11], v[4:5], v[128:129], v[10:11] op_sel:[0,1,0]
    v_pk_fma_f32 v[4:5], v[8:9], v[128:129], v[74:75] op_sel_hi:[1,0,1]
    v_pk_fma_f32 v[6:7], v[10:11], v[128:129], v[78:79] op_sel_hi:[1,0,1]
    v_pk_fma_f32 v[4:5], v[10:11], v[128:129], v[4:5] op_sel:[0,1,0] neg_lo:[1,0,0] neg_hi:[1,0,0]
    v_pk_fma_f32 v[6:7], v[8:9], v[128:129], v[6:7] op_sel:[0,1,0]
    v_pk_fma_f32 v[8:9], v[4:5], v[128:129], v[80:81] op_sel_hi:[1,0,1]
    v_pk_fma_f32 v[10:11], v[6:7], v[128:129], v[84:85] op_sel_hi:[1,0,1]
    v_pk_fma_f32 v[8:9], v[6:7], v[128:129], v[8:9] op_sel:[0,1,0] neg_lo:[1,0,0] neg_hi:[1,0,0]
    v_pk_fma_f32 v[10:11], v[4:5], v[128:129], v[10:11] op_sel:[0,1,0]
    v_pk_fma_f32 v[4:5], v[8:9], v[128:129], v[82:83] op_sel_hi:[1,0,1]
    v_pk_fma_f32 v[6:7], v[10:11], v[128:129], v[86:87] op_sel_hi:[1,0,1]
    v_pk_fma_f32 v[4:5], v[10:11], v[128:129], v[4:5] op_sel:[0,1,0] neg_lo:[1,0,0] neg_hi:[1,0,0]
    v_pk_fma_f32 v[6:7], v[8:9], v[128:129], v[6:7] op_sel:[0,1,0]
    v_pk_fma_f32 v[8:9], v[4:5], v[128:129], v[88:89] op_sel_hi:[1,0,1]
    v_pk_fma_f32 v[10:11], v[6:7], v[128:129], v[92:93] op_sel_hi:[1,0,1]
    v_pk_fma_f32 v[8:9], v[6:7], v[128:129], v[8:9] op_sel:[0,1,0] neg_lo:[1,0,0] neg_hi:[1,0,0]
    v_pk_fma_f32 v[10:11], v[4:5], v[128:129], v[10:11] op_sel:[0,1,0]
    v_pk_fma_f32 v[4:5], v[8:9], v[128:129], v[90:91] op_sel_hi:[1,0,1]
    v_pk_fma_f32 v[6:7], v[10:11], v[128:129], v[94:95] op_sel_hi:[1,0,1]
    v_pk_fma_f32 v[4:5], v[10:11], v[128:129], v[4:5] op_sel:[0,1,0] neg_lo:[1,0,0] neg_hi:[1,0,0]
    v_pk_fma_f32 v[6:7], v[8:9], v[128:129], v[6:7] op_sel:[0,1,0]
    v_pk_mul_f32 v[142:143], v[4:5], v[130:131] op_sel_hi:[1,0]
    v_pk_mul_f32 v[144:145], v[6:7], v[130:131] op_sel_hi:[1,0]
    v_pk_fma_f32 v[142:143], v[6:7], v[130:131], v[142:143] op_sel:[0,1,0] neg_lo:[1,0,0] neg_hi:[1,0,0]
    v_pk_fma_f32 v[144:145], v[4:5], v[130:131], v[144:145] op_sel:[0,1,0]
    s_waitcnt lgkmcnt(4)
    v_mfma_f32_16x16x32_bf16 v[224:227], a[32:35], a[0:3], 0
    ds_read_b128 a[64:67], v28 offset:8192
    v_fma_f32 v4, v142, v132, v143
    v_fma_f32 v8, v142, v133, v145
    v_mfma_f32_16x16x32_bf16 v[228:231], a[32:35], a[4:7], 0
    ds_read_b128 a[68:71], v28 offset:9216
    v_fma_f32 v4, -v144, v133, v4
    v_mfma_f32_16x16x32_bf16 v[224:227], a[36:39], a[8:11], v[224:227]
    ds_read_b128 a[72:75], v28 offset:10240
    v_fma_f32 v8, v144, v132, v8
    v_mov_b32 v6, v4
    v_mfma_f32_16x16x32_bf16 v[228:231], a[36:39], a[12:15], v[228:231]
    ds_read_b128 a[76:79], v28 offset:11264
    v_mov_b32_e64 v10, v8
    v_mfma_f32_16x16x32_bf16 v[224:227], a[40:43], a[16:19], v[224:227]
    ds_read_b128 a[80:83], v28 offset:12288
    v_permlane32_swap_b32 v4, v6
    v_mfma_f32_16x16x32_bf16 v[228:231], a[40:43], a[20:23], v[228:231]
    ds_read_b128 a[84:87], v28 offset:13312
    v_permlane32_swap_b32 v8, v10
    v_mov_b32_e64 v5, v4
    v_mfma_f32_16x16x32_bf16 v[224:227], a[44:47], a[24:27], v[224:227]
    ds_read_b128 a[88:91], v28 offset:14336
    v_mov_b32_e64 v7, v6
    v_mfma_f32_16x16x32_bf16 v[228:231], a[44:47], a[28:31], v[228:231]
    ds_read_b128 a[92:95], v28 offset:15360
    v_mov_b32 v9, v8
    v_mov_b32 v11, v10
    s_waitcnt lgkmcnt(8)
    v_permlane16_swap_b32 v4, v5
    v_mfma_f32_16x16x32_bf16 v[232:235], a[48:51], a[0:3], 0
    v_permlane16_swap_b32 v6, v7
    v_mfma_f32_16x16x32_bf16 v[236:239], a[48:51], a[4:7], 0
    v_permlane16_swap_b32 v8, v9
    v_permlane16_swap_b32 v10, v11
    v_mfma_f32_16x16x32_bf16 v[232:235], a[52:55], a[8:11], v[232:235]
    v_fma_f32 v12, v4, v134, v5
    v_mfma_f32_16x16x32_bf16 v[236:239], a[52:55], a[12:15], v[236:239]
    v_fma_f32 v13, v4, v135, v9
    v_mfma_f32_16x16x32_bf16 v[232:235], a[56:59], a[16:19], v[232:235]
    v_fma_f32 v12, -v8, v135, v12
    v_fma_f32 v13, v8, v134, v13
    v_mfma_f32_16x16x32_bf16 v[236:239], a[56:59], a[20:23], v[236:239]
    v_fma_f32 v14, v12, v134, v6
    v_mfma_f32_16x16x32_bf16 v[232:235], a[60:63], a[24:27], v[232:235]
    v_fma_f32 v15, v12, v135, v10
    v_fma_f32 v14, -v13, v135, v14
    v_mfma_f32_16x16x32_bf16 v[236:239], a[60:63], a[28:31], v[236:239]
    v_fma_f32 v15, v13, v134, v15
    s_waitcnt lgkmcnt(4)
    v_fma_f32 v184, v14, v134, v7
    v_mfma_f32_16x16x32_bf16 v[240:243], a[64:67], a[0:3], 0
    v_fma_f32 v185, v14, v135, v11
    v_fma_f32 v184, -v15, v135, v184
    v_mfma_f32_16x16x32_bf16 v[244:247], a[64:67], a[4:7], 0
    v_fma_f32 v185, v15, v134, v185
    v_mfma_f32_16x16x32_bf16 v[240:243], a[68:71], a[8:11], v[240:243]
    buffer_store_dwordx4 v[184:187], v188, s[24:27], s38 offen sc1
    v_mfma_f32_16x16x32_bf16 v[244:247], a[68:71], a[12:15], v[244:247]
    v_cndmask_b32 v146, v4, 0, s[78:79]
    v_mfma_f32_16x16x32_bf16 v[240:243], a[72:75], a[16:19], v[240:243]
    v_cndmask_b32 v147, v8, 0, s[78:79]
    v_mfma_f32_16x16x32_bf16 v[244:247], a[72:75], a[20:23], v[244:247]
    v_cndmask_b32 v146, v146, v12, s[46:47]
    v_cndmask_b32 v147, v147, v13, s[46:47]
    v_mfma_f32_16x16x32_bf16 v[240:243], a[76:79], a[24:27], v[240:243]
    v_cndmask_b32 v146, v146, v14, s[44:45]
    v_mfma_f32_16x16x32_bf16 v[244:247], a[76:79], a[28:31], v[244:247]
    v_cndmask_b32 v147, v147, v15, s[44:45]
    s_waitcnt lgkmcnt(0)
    s_bfe_u32 s72, s97, 262152
    s_add_u32 m0, s37, 32768
    s_lshl_b32 s72, s72, 7
    buffer_load_dwordx4 v16, s[16:19], s72 offen offset:0  lds
    buffer_load_dwordx4 v17, s[16:19], s72 offen offset:1024  lds
    buffer_load_dwordx4 v18, s[16:19], s72 offen offset:2048  lds
    buffer_load_dwordx4 v19, s[16:19], s72 offen offset:3072  lds
    s_waitcnt vmcnt(9)
    v_lshlrev_b32 v152, 16, v200
    v_mfma_f32_16x16x32_bf16 v[248:251], a[80:83], a[0:3], 0
    v_and_b32 v160, 0xffff0000, v200
    v_lshlrev_b32_e64 v168, 16, v201
    v_mfma_f32_16x16x32_bf16 v[252:255], a[80:83], a[4:7], 0
    v_and_b32 v176, 0xffff0000, v201
    v_lshlrev_b32_e64 v153, 16, v202
    v_mfma_f32_16x16x32_bf16 v[248:251], a[84:87], a[8:11], v[248:251]
    v_and_b32 v161, 0xffff0000, v202
    v_lshlrev_b32_e64 v169, 16, v203
    v_mfma_f32_16x16x32_bf16 v[252:255], a[84:87], a[12:15], v[252:255]
    v_and_b32 v177, 0xffff0000, v203
    v_lshlrev_b32_e64 v154, 16, v204
    v_mfma_f32_16x16x32_bf16 v[248:251], a[88:91], a[16:19], v[248:251]
    v_and_b32 v162, 0xffff0000, v204
    v_lshlrev_b32_e64 v170, 16, v205
    v_mfma_f32_16x16x32_bf16 v[252:255], a[88:91], a[20:23], v[252:255]
    v_and_b32 v178, 0xffff0000, v205
    v_lshlrev_b32_e64 v155, 16, v206
    v_mfma_f32_16x16x32_bf16 v[248:251], a[92:95], a[24:27], v[248:251]
    v_and_b32 v163, 0xffff0000, v206
    v_lshlrev_b32_e64 v171, 16, v207
    v_mfma_f32_16x16x32_bf16 v[252:255], a[92:95], a[28:31], v[252:255]
    v_and_b32 v179, 0xffff0000, v207
    v_pk_mul_f32 v[4:5], v[224:225], v[96:97] op_sel_hi:[1,0]
    v_pk_mul_f32 v[6:7], v[228:229], v[96:97] op_sel_hi:[1,0]
    v_pk_fma_f32 v[4:5], v[228:229], v[96:97], v[4:5] op_sel:[0,1,0]
    v_pk_fma_f32 v[6:7], v[224:225], v[96:97], v[6:7] op_sel:[0,1,0] neg_lo:[1,0,0] neg_hi:[1,0,0]
    v_pk_mul_f32 v[8:9], v[226:227], v[98:99] op_sel_hi:[1,0]
    v_pk_mul_f32 v[10:11], v[230:231], v[98:99] op_sel_hi:[1,0]
    v_pk_fma_f32 v[8:9], v[230:231], v[98:99], v[8:9] op_sel:[0,1,0]
    v_pk_fma_f32 v[10:11], v[226:227], v[98:99], v[10:11] op_sel:[0,1,0] neg_lo:[1,0,0] neg_hi:[1,0,0]
    v_cvt_pk_bf16_f32 v184, v4, v6
    v_cvt_pk_bf16_f32 v192, v5, v7
    v_cvt_pk_bf16_f32 v188, v8, v10
    v_cvt_pk_bf16_f32 v196, v9, v11
    v_pk_mul_f32 v[4:5], v[232:233], v[100:101] op_sel_hi:[1,0]
    v_pk_mul_f32 v[6:7], v[236:237], v[100:101] op_sel_hi:[1,0]
    v_pk_fma_f32 v[4:5], v[236:237], v[100:101], v[4:5] op_sel:[0,1,0]
    v_pk_fma_f32 v[6:7], v[232:233], v[100:101], v[6:7] op_sel:[0,1,0] neg_lo:[1,0,0] neg_hi:[1,0,0]
    v_pk_mul_f32 v[8:9], v[234:235], v[102:103] op_sel_hi:[1,0]
    v_pk_mul_f32 v[10:11], v[238:239], v[102:103] op_sel_hi:[1,0]
    v_pk_fma_f32 v[8:9], v[238:239], v[102:103], v[8:9] op_sel:[0,1,0]
    v_pk_fma_f32 v[10:11], v[234:235], v[102:103], v[10:11] op_sel:[0,1,0] neg_lo:[1,0,0] neg_hi:[1,0,0]
    v_cvt_pk_bf16_f32 v185, v4, v6
    v_cvt_pk_bf16_f32 v193, v5, v7
    v_cvt_pk_bf16_f32 v189, v8, v10
    v_cvt_pk_bf16_f32 v197, v9, v11
    v_pk_mul_f32 v[4:5], v[240:241], v[104:105] op_sel_hi:[1,0]
    v_pk_mul_f32 v[6:7], v[244:245], v[104:105] op_sel_hi:[1,0]
    v_pk_fma_f32 v[4:5], v[244:245], v[104:105], v[4:5] op_sel:[0,1,0]
    v_pk_fma_f32 v[6:7], v[240:241], v[104:105], v[6:7] op_sel:[0,1,0] neg_lo:[1,0,0] neg_hi:[1,0,0]
    v_pk_mul_f32 v[8:9], v[242:243], v[106:107] op_sel_hi:[1,0]
    v_pk_mul_f32 v[10:11], v[246:247], v[106:107] op_sel_hi:[1,0]
    v_pk_fma_f32 v[8:9], v[246:247], v[106:107], v[8:9] op_sel:[0,1,0]
    v_pk_fma_f32 v[10:11], v[242:243], v[106:107], v[10:11] op_sel:[0,1,0] neg_lo:[1,0,0] neg_hi:[1,0,0]
    v_cvt_pk_bf16_f32 v186, v4, v6
    v_cvt_pk_bf16_f32 v194, v5, v7
    v_cvt_pk_bf16_f32 v190, v8, v10
    v_cvt_pk_bf16_f32 v198, v9, v11
    v_pk_mul_f32 v[4:5], v[248:249], v[108:109] op_sel_hi:[1,0]
    s_bfe_u32 s72, s97, 262144
    s_add_u32 m0, s37, 0
    s_lshl_b32 s72, s72, 7
    buffer_load_dwordx4 v16, s[16:19], s72 offen offset:0  lds
    buffer_load_dwordx4 v17, s[16:19], s72 offen offset:1024  lds
    buffer_load_dwordx4 v18, s[16:19], s72 offen offset:2048  lds
    buffer_load_dwordx4 v19, s[16:19], s72 offen offset:3072  lds
    v_pk_mul_f32 v[6:7], v[252:253], v[108:109] op_sel_hi:[1,0]
    v_pk_fma_f32 v[4:5], v[252:253], v[108:109], v[4:5] op_sel:[0,1,0]
    v_pk_fma_f32 v[6:7], v[248:249], v[108:109], v[6:7] op_sel:[0,1,0] neg_lo:[1,0,0] neg_hi:[1,0,0]
    v_pk_mul_f32 v[8:9], v[250:251], v[110:111] op_sel_hi:[1,0]
    v_pk_mul_f32 v[10:11], v[254:255], v[110:111] op_sel_hi:[1,0]
    v_pk_fma_f32 v[8:9], v[254:255], v[110:111], v[8:9] op_sel:[0,1,0]
    v_pk_fma_f32 v[10:11], v[250:251], v[110:111], v[10:11] op_sel:[0,1,0] neg_lo:[1,0,0] neg_hi:[1,0,0]
    v_cvt_pk_bf16_f32 v187, v4, v6
    v_cvt_pk_bf16_f32 v195, v5, v7
    v_cvt_pk_bf16_f32 v191, v8, v10
    v_cvt_pk_bf16_f32 v199, v9, v11
    v_mfma_f32_16x16x32_bf16 v[224:227], a[224:227], v[184:187], 0
    v_lshlrev_b32_e64 v156, 16, v208
    v_and_b32 v164, 0xffff0000, v208
    v_lshlrev_b32_e64 v172, 16, v209
    v_mfma_f32_16x16x32_bf16 v[228:231], a[228:231], v[184:187], 0
    v_and_b32 v180, 0xffff0000, v209
    v_lshlrev_b32_e64 v157, 16, v210
    v_mfma_f32_16x16x32_bf16 v[232:235], a[248:251], v[188:191], 0
    v_and_b32 v165, 0xffff0000, v210
    v_lshlrev_b32_e64 v173, 16, v211
    v_mfma_f32_16x16x32_bf16 v[236:239], a[252:255], v[188:191], 0
    v_and_b32 v181, 0xffff0000, v211
    v_lshlrev_b32_e64 v158, 16, v212
    v_mfma_f32_16x16x32_bf16 v[240:243], a[224:227], v[192:195], 0
    v_and_b32 v166, 0xffff0000, v212
    v_lshlrev_b32_e64 v174, 16, v213
    v_mfma_f32_16x16x32_bf16 v[244:247], a[228:231], v[192:195], 0
    v_and_b32 v182, 0xffff0000, v213
    v_lshlrev_b32_e64 v159, 16, v214
    v_mfma_f32_16x16x32_bf16 v[248:251], a[248:251], v[196:199], 0
    v_and_b32 v167, 0xffff0000, v214
    v_lshlrev_b32_e64 v175, 16, v215
    v_mfma_f32_16x16x32_bf16 v[252:255], a[252:255], v[196:199], 0
    v_and_b32 v183, 0xffff0000, v215
    v_accvgpr_read_b32 v28, a222
    v_cmp_ne_u32 s[78:79], s96, v28
    s_nop 0
    s_and_b32 s78, s78, 0x5555
    s_cmp_eq_u32 s78, 0
    s_cselect_b32 s50, 0, 2.0
    s_cselect_b32 s7, 2.0, 0
    v_cmp_eq_u32 vcc, 2.0, v148
    v_mov_b32 v200, s35
    s_nop 0
    v_cndmask_b32 v200, v200, 0, vcc
    v_cmp_eq_u32 vcc, 2.0, v149
    v_mov_b32 v201, s35
    s_nop 0
    v_cndmask_b32 v201, v201, 0, vcc
    v_cmp_eq_u32 vcc, 2.0, v150
    v_mov_b32 v202, s35
    s_nop 0
    v_cndmask_b32 v202, v202, 0, vcc
    v_cmp_eq_u32 vcc, 2.0, v151
    v_mov_b32 v203, s35
    s_nop 0
    v_cndmask_b32 v203, v203, 0, vcc
    v_pk_add_f32 v[224:225], v[224:225], v[232:233]
    v_pk_add_f32 v[226:227], v[226:227], v[234:235]
    v_pk_add_f32 v[228:229], v[228:229], v[236:237]
    v_pk_add_f32 v[230:231], v[230:231], v[238:239]
    v_pk_fma_f32 v[232:233], v[232:233], -2.0, v[224:225] op_sel_hi:[1,0,1]
    v_pk_fma_f32 v[234:235], v[234:235], -2.0, v[226:227] op_sel_hi:[1,0,1]
    v_pk_fma_f32 v[236:237], v[236:237], -2.0, v[228:229] op_sel_hi:[1,0,1]
    v_pk_fma_f32 v[238:239], v[238:239], -2.0, v[230:231] op_sel_hi:[1,0,1]
    v_pk_add_f32 v[240:241], v[240:241], v[248:249]
    v_pk_add_f32 v[242:243], v[242:243], v[250:251]
    v_pk_add_f32 v[244:245], v[244:245], v[252:253]
    v_pk_add_f32 v[246:247], v[246:247], v[254:255]
    s_xor_b32 s40, s92, 0
    buffer_load_dword a223, v29, s[16:19], s40 offen
    v_pk_fma_f32 v[248:249], v[248:249], -2.0, v[240:241] op_sel_hi:[1,0,1]
    v_pk_fma_f32 v[250:251], v[250:251], -2.0, v[242:243] op_sel_hi:[1,0,1]
    v_pk_fma_f32 v[252:253], v[252:253], -2.0, v[244:245] op_sel_hi:[1,0,1]
    v_pk_fma_f32 v[254:255], v[254:255], -2.0, v[246:247] op_sel_hi:[1,0,1]
    s_cmp_eq_u32 s2, 0
    s_cbranch_scc1 K_SPECIAL
K_SPECIAL_RET:
    s_nop 0
    v_pk_fma_f32 v[4:5], v[224:225], s[42:43], v[244:245] op_sel_hi:[1,0,1]
    v_pk_fma_f32 v[6:7], v[228:229], s[42:43], v[240:241] op_sel_hi:[1,0,1] neg_lo:[0,0,1] neg_hi:[0,0,1]
    v_pk_fma_f32 v[8:9], v[240:241], s[42:43], v[228:229] op_sel_hi:[1,0,1]
    v_pk_fma_f32 v[10:11], v[244:245], s[42:43], v[224:225] op_sel_hi:[1,0,1] neg_lo:[0,0,1] neg_hi:[0,0,1]
    v_pk_mul_f32 v[224:225], v[4:5], v[152:153]
    v_pk_mul_f32 v[228:229], v[6:7], v[152:153]
    v_pk_mul_f32 v[240:241], v[8:9], v[168:169]
    v_pk_mul_f32 v[244:245], v[10:11], v[168:169]
    v_pk_fma_f32 v[152:153], v[6:7], v[160:161], v[224:225] neg_lo:[1,0,0] neg_hi:[1,0,0]
    v_pk_fma_f32 v[160:161], v[4:5], v[160:161], v[228:229]
    v_pk_fma_f32 v[168:169], v[10:11], v[176:177], v[240:241]
    v_pk_fma_f32 v[176:177], v[8:9], v[176:177], v[244:245] neg_lo:[1,0,0] neg_hi:[1,0,0]
    v_pk_fma_f32 v[224:225], v[152:153], s[42:43], v[176:177] op_sel_hi:[1,0,1] neg_lo:[0,0,1] neg_hi:[0,0,1]
    v_pk_fma_f32 v[228:229], v[160:161], s[42:43], v[168:169] op_sel_hi:[1,0,1]
    v_pk_fma_f32 v[240:241], v[168:169], s[42:43], v[160:161] op_sel_hi:[1,0,1] neg_lo:[0,0,1] neg_hi:[0,0,1]
    v_pk_fma_f32 v[244:245], v[176:177], s[42:43], v[152:153] op_sel_hi:[1,0,1]
    v_pk_fma_f32 v[4:5], v[226:227], s[42:43], v[246:247] op_sel_hi:[1,0,1]
    v_pk_fma_f32 v[6:7], v[230:231], s[42:43], v[242:243] op_sel_hi:[1,0,1] neg_lo:[0,0,1] neg_hi:[0,0,1]
    v_pk_fma_f32 v[8:9], v[242:243], s[42:43], v[230:231] op_sel_hi:[1,0,1]
    v_pk_fma_f32 v[10:11], v[246:247], s[42:43], v[226:227] op_sel_hi:[1,0,1] neg_lo:[0,0,1] neg_hi:[0,0,1]
    v_pk_mul_f32 v[226:227], v[4:5], v[154:155]
    v_pk_mul_f32 v[230:231], v[6:7], v[154:155]
    v_pk_mul_f32 v[242:243], v[8:9], v[170:171]
    v_pk_mul_f32 v[246:247], v[10:11], v[170:171]
    v_pk_fma_f32 v[154:155], v[6:7], v[162:163], v[226:227] neg_lo:[1,0,0] neg_hi:[1,0,0]
    v_pk_fma_f32 v[162:163], v[4:5], v[162:163], v[230:231]
    v_pk_fma_f32 v[170:171], v[10:11], v[178:179], v[242:243]
    v_pk_fma_f32 v[178:179], v[8:9], v[178:179], v[246:247] neg_lo:[1,0,0] neg_hi:[1,0,0]
    v_pk_fma_f32 v[226:227], v[154:155], s[42:43], v[178:179] op_sel_hi:[1,0,1] neg_lo:[0,0,1] neg_hi:[0,0,1]
    v_pk_fma_f32 v[230:231], v[162:163], s[42:43], v[170:171] op_sel_hi:[1,0,1]
    v_pk_fma_f32 v[242:243], v[170:171], s[42:43], v[162:163] op_sel_hi:[1,0,1] neg_lo:[0,0,1] neg_hi:[0,0,1]
    v_pk_fma_f32 v[246:247], v[178:179], s[42:43], v[154:155] op_sel_hi:[1,0,1]
    v_pk_fma_f32 v[4:5], v[232:233], s[42:43], v[252:253] op_sel_hi:[1,0,1]
    v_pk_fma_f32 v[6:7], v[236:237], s[42:43], v[248:249] op_sel_hi:[1,0,1] neg_lo:[0,0,1] neg_hi:[0,0,1]
    v_pk_fma_f32 v[8:9], v[248:249], s[42:43], v[236:237] op_sel_hi:[1,0,1]
    v_pk_fma_f32 v[10:11], v[252:253], s[42:43], v[232:233] op_sel_hi:[1,0,1] neg_lo:[0,0,1] neg_hi:[0,0,1]
    v_pk_mul_f32 v[232:233], v[4:5], v[156:157]
    v_pk_mul_f32 v[236:237], v[6:7], v[156:157]
    v_pk_mul_f32 v[248:249], v[8:9], v[172:173]
    v_pk_mul_f32 v[252:253], v[10:11], v[172:173]
    v_pk_fma_f32 v[156:157], v[6:7], v[164:165], v[232:233] neg_lo:[1,0,0] neg_hi:[1,0,0]
    v_pk_fma_f32 v[164:165], v[4:5], v[164:165], v[236:237]
    v_pk_fma_f32 v[172:173], v[10:11], v[180:181], v[248:249]
    v_pk_fma_f32 v[180:181], v[8:9], v[180:181], v[252:253] neg_lo:[1,0,0] neg_hi:[1,0,0]
    v_pk_fma_f32 v[232:233], v[156:157], s[42:43], v[180:181] op_sel_hi:[1,0,1] neg_lo:[0,0,1] neg_hi:[0,0,1]
    v_pk_fma_f32 v[236:237], v[164:165], s[42:43], v[172:173] op_sel_hi:[1,0,1]
    v_pk_fma_f32 v[248:249], v[172:173], s[42:43], v[164:165] op_sel_hi:[1,0,1] neg_lo:[0,0,1] neg_hi:[0,0,1]
    v_pk_fma_f32 v[252:253], v[180:181], s[42:43], v[156:157] op_sel_hi:[1,0,1]
    v_pk_fma_f32 v[4:5], v[234:235], s[42:43], v[254:255] op_sel_hi:[1,0,1]
    v_pk_fma_f32 v[6:7], v[238:239], s[42:43], v[250:251] op_sel_hi:[1,0,1] neg_lo:[0,0,1] neg_hi:[0,0,1]
    v_pk_fma_f32 v[8:9], v[250:251], s[42:43], v[238:239] op_sel_hi:[1,0,1]
    v_pk_fma_f32 v[10:11], v[254:255], s[42:43], v[234:235] op_sel_hi:[1,0,1] neg_lo:[0,0,1] neg_hi:[0,0,1]
    v_pk_mul_f32 v[234:235], v[4:5], v[158:159]
    v_pk_mul_f32 v[238:239], v[6:7], v[158:159]
    v_pk_mul_f32 v[250:251], v[8:9], v[174:175]
    v_pk_mul_f32 v[254:255], v[10:11], v[174:175]
    v_pk_fma_f32 v[158:159], v[6:7], v[166:167], v[234:235] neg_lo:[1,0,0] neg_hi:[1,0,0]
    v_pk_fma_f32 v[166:167], v[4:5], v[166:167], v[238:239]
    v_pk_fma_f32 v[174:175], v[10:11], v[182:183], v[250:251]
    v_pk_fma_f32 v[182:183], v[8:9], v[182:183], v[254:255] neg_lo:[1,0,0] neg_hi:[1,0,0]
    v_pk_fma_f32 v[234:235], v[158:159], s[42:43], v[182:183] op_sel_hi:[1,0,1] neg_lo:[0,0,1] neg_hi:[0,0,1]
    v_pk_fma_f32 v[238:239], v[166:167], s[42:43], v[174:175] op_sel_hi:[1,0,1]
    v_pk_fma_f32 v[250:251], v[174:175], s[42:43], v[166:167] op_sel_hi:[1,0,1] neg_lo:[0,0,1] neg_hi:[0,0,1]
    v_pk_fma_f32 v[254:255], v[182:183], s[42:43], v[158:159] op_sel_hi:[1,0,1]
    s_cmp_eq_u32 s2, 0
    s_cbranch_scc1 K_SPECIAL2
K_SPECIAL2_RET:
    v_pk_add_f32 v[224:225], v[224:225], v[232:233]
    v_pk_add_f32 v[226:227], v[226:227], v[234:235]
    v_pk_add_f32 v[228:229], v[228:229], v[236:237]
    v_pk_add_f32 v[230:231], v[230:231], v[238:239]
    v_pk_fma_f32 v[232:233], v[232:233], -2.0, v[224:225] op_sel_hi:[1,0,1]
    v_pk_fma_f32 v[234:235], v[234:235], -2.0, v[226:227] op_sel_hi:[1,0,1]
    v_pk_fma_f32 v[236:237], v[236:237], -2.0, v[228:229] op_sel_hi:[1,0,1]
    v_pk_fma_f32 v[238:239], v[238:239], -2.0, v[230:231] op_sel_hi:[1,0,1]
    v_cvt_pk_bf16_f32 v184, v224, -v228
    v_cvt_pk_bf16_f32 v185, v225, -v229
    v_cvt_pk_bf16_f32 v186, v226, -v230
    v_cvt_pk_bf16_f32 v187, v227, -v231
    v_cvt_pk_bf16_f32 v188, v232, -v236
    v_cvt_pk_bf16_f32 v189, v233, -v237
    v_cvt_pk_bf16_f32 v190, v234, -v238
    v_cvt_pk_bf16_f32 v191, v235, -v239
    v_pk_add_f32 v[240:241], v[240:241], v[248:249]
    v_pk_add_f32 v[242:243], v[242:243], v[250:251]
    v_pk_add_f32 v[244:245], v[244:245], v[252:253]
    v_pk_add_f32 v[246:247], v[246:247], v[254:255]
    v_pk_fma_f32 v[248:249], v[248:249], -2.0, v[240:241] op_sel_hi:[1,0,1]
    v_pk_fma_f32 v[250:251], v[250:251], -2.0, v[242:243] op_sel_hi:[1,0,1]
    v_pk_fma_f32 v[252:253], v[252:253], -2.0, v[244:245] op_sel_hi:[1,0,1]
    v_pk_fma_f32 v[254:255], v[254:255], -2.0, v[246:247] op_sel_hi:[1,0,1]
    v_cvt_pk_bf16_f32 v192, v240, -v244
    v_cvt_pk_bf16_f32 v193, v241, -v245
    v_cvt_pk_bf16_f32 v194, v242, -v246
    v_cvt_pk_bf16_f32 v195, v243, -v247
    v_cvt_pk_bf16_f32 v196, v248, -v252
    v_cvt_pk_bf16_f32 v197, v249, -v253
    v_cvt_pk_bf16_f32 v198, v250, -v254
    v_cvt_pk_bf16_f32 v199, v251, -v255
    v_mfma_f32_16x16x32_bf16 v[224:227], v[184:187], a[224:227], 0
    v_and_b32_e64 v12, 3, v1
    v_mul_u32_u24 v13, 4112, v12
    v_and_b32_e64 v14, 60, v0
    v_mfma_f32_16x16x32_bf16 v[228:231], v[184:187], a[228:231], 0
    v_lshl_add_u32 v13, v14, 4, v13
    s_lshl_b32 s38, s34, 10
    v_mfma_f32_16x16x32_bf16 v[232:235], v[188:191], a[232:235], 0
    s_add_u32 s38, s38, 114624
    v_add_u32 v204, s38, v13
    v_add_u32 v205, 114624, v3
    v_mfma_f32_16x16x32_bf16 v[236:239], v[188:191], a[236:239], 0
    v_lshlrev_b32_e64 v12, 4, v12
    v_lshl_add_u32 v206, v14, 14, v12
    v_mfma_f32_16x16x32_bf16 v[240:243], v[192:195], a[224:227], 0
    v_lshlrev_b32 v207, 31, v1
    s_lshl_b32 s68, s94, 16
    s_add_u32 s68, s68, s5
    v_mfma_f32_16x16x32_bf16 v[244:247], v[192:195], a[228:231], 0
    s_add_u32 s69, s68, 0x20000
    s_lshl_b32 s38, s34, 14
    v_mfma_f32_16x16x32_bf16 v[248:251], v[196:199], a[232:235], 0
    s_add_u32 s38, s38, s4
    s_lshl_b32 s38, s38, 6
    s_add_u32 s38, s38, 9437184
    v_mfma_f32_16x16x32_bf16 v[252:255], v[196:199], a[236:239], 0
    s_and_b32 s70, s2, 0xe0
    s_lshl2_add_u32 s70, s70, s51
    s_nop 0
    v_pk_mul_f32 v[4:5], v[224:225], v[112:113]
    buffer_load_dwordx4 v[96:99], v148, s[24:27], s93 offen sc1
    buffer_load_dwordx4 v[100:103], v149, s[24:27], s93 offen sc1
    buffer_load_dwordx4 v[104:107], v150, s[24:27], s93 offen sc1
    buffer_load_dwordx4 v[108:111], v151, s[24:27], s93 offen sc1
    v_pk_mul_f32 v[6:7], v[228:229], v[112:113]
    v_pk_fma_f32 v[4:5], v[228:229], v[116:117], v[4:5]
    v_pk_fma_f32 v[6:7], v[224:225], v[116:117], v[6:7] neg_lo:[1,0,0] neg_hi:[1,0,0]
    v_pk_mul_f32 v[8:9], v[226:227], v[114:115]
    v_pk_mul_f32 v[10:11], v[230:231], v[114:115]
    v_pk_fma_f32 v[8:9], v[230:231], v[118:119], v[8:9]
    v_pk_fma_f32 v[10:11], v[226:227], v[118:119], v[10:11] neg_lo:[1,0,0] neg_hi:[1,0,0]
    v_cvt_pk_bf16_f32 v184, v4, v6
    v_cvt_pk_bf16_f32 v185, v5, v7
    v_cvt_pk_bf16_f32 v186, v8, v10
    v_cvt_pk_bf16_f32 v187, v9, v11
    ds_write_b128 v204, v[184:187] offset:0
    v_pk_mul_f32 v[4:5], v[232:233], v[120:121]
    v_pk_mul_f32 v[6:7], v[236:237], v[120:121]
    v_pk_fma_f32 v[4:5], v[236:237], v[124:125], v[4:5]
    v_pk_fma_f32 v[6:7], v[232:233], v[124:125], v[6:7] neg_lo:[1,0,0] neg_hi:[1,0,0]
    v_pk_mul_f32 v[8:9], v[234:235], v[122:123]
    v_pk_mul_f32 v[10:11], v[238:239], v[122:123]
    v_pk_fma_f32 v[8:9], v[238:239], v[126:127], v[8:9]
    v_pk_fma_f32 v[10:11], v[234:235], v[126:127], v[10:11] neg_lo:[1,0,0] neg_hi:[1,0,0]
    v_cvt_pk_bf16_f32 v188, v4, v6
    v_cvt_pk_bf16_f32 v189, v5, v7
    v_cvt_pk_bf16_f32 v190, v8, v10
    v_cvt_pk_bf16_f32 v191, v9, v11
    ds_write_b128 v204, v[188:191] offset:32
    v_pk_mul_f32 v[4:5], v[240:241], v[112:113]
    v_pk_mul_f32 v[6:7], v[244:245], v[112:113]
    v_pk_fma_f32 v[4:5], v[244:245], v[116:117], v[4:5]
    v_pk_fma_f32 v[6:7], v[240:241], v[116:117], v[6:7] neg_lo:[1,0,0] neg_hi:[1,0,0]
    v_pk_mul_f32 v[8:9], v[242:243], v[114:115]
    v_pk_mul_f32 v[10:11], v[246:247], v[114:115]
    v_pk_fma_f32 v[8:9], v[246:247], v[118:119], v[8:9]
    v_pk_fma_f32 v[10:11], v[242:243], v[118:119], v[10:11] neg_lo:[1,0,0] neg_hi:[1,0,0]
    v_cvt_pk_bf16_f32 v192, v4, v6
    v_cvt_pk_bf16_f32 v193, v5, v7
    v_cvt_pk_bf16_f32 v194, v8, v10
    v_cvt_pk_bf16_f32 v195, v9, v11
    ds_write_b128 v204, v[192:195] offset:16
    v_pk_mul_f32 v[4:5], v[248:249], v[120:121]
    v_pk_mul_f32 v[6:7], v[252:253], v[120:121]
    v_pk_fma_f32 v[4:5], v[252:253], v[124:125], v[4:5]
    v_pk_fma_f32 v[6:7], v[248:249], v[124:125], v[6:7] neg_lo:[1,0,0] neg_hi:[1,0,0]
    v_pk_mul_f32 v[8:9], v[250:251], v[122:123]
    v_pk_mul_f32 v[10:11], v[254:255], v[122:123]
    v_pk_fma_f32 v[8:9], v[254:255], v[126:127], v[8:9]
    v_pk_fma_f32 v[10:11], v[250:251], v[126:127], v[10:11] neg_lo:[1,0,0] neg_hi:[1,0,0]
    v_cvt_pk_bf16_f32 v196, v4, v6
    v_cvt_pk_bf16_f32 v197, v5, v7
    v_cvt_pk_bf16_f32 v198, v8, v10
    v_cvt_pk_bf16_f32 v199, v9, v11
    ds_write_b128 v204, v[196:199] offset:48
    s_bfe_u32 s72, s97, 262156
    s_add_u32 m0, s37, 49152
    s_lshl_b32 s72, s72, 7
    s_nop 0
    buffer_load_dwordx4 v16, s[16:19], s72 offen offset:0  lds
    buffer_load_dwordx4 v17, s[16:19], s72 offen offset:1024  lds
    buffer_load_dwordx4 v18, s[16:19], s72 offen offset:2048  lds
    buffer_load_dwordx4 v19, s[16:19], s72 offen offset:3072  lds
    v_pk_mul_f32 v[4:5], v[36:37], v[130:131] op_sel:[0,1]
    v_pk_mul_f32 v[6:7], v[32:33], v[130:131] op_sel:[0,1]
    v_pk_fma_f32 v[32:33], v[32:33], v[130:131], v[4:5] op_sel_hi:[1,0,1] neg_lo:[0,0,1] neg_hi:[0,0,1]
    v_pk_fma_f32 v[36:37], v[36:37], v[130:131], v[6:7] op_sel_hi:[1,0,1]
    v_pk_mul_f32 v[8:9], v[38:39], v[130:131] op_sel:[0,1]
    v_pk_mul_f32 v[10:11], v[34:35], v[130:131] op_sel:[0,1]
    v_pk_fma_f32 v[34:35], v[34:35], v[130:131], v[8:9] op_sel_hi:[1,0,1] neg_lo:[0,0,1] neg_hi:[0,0,1]
    v_pk_fma_f32 v[38:39], v[38:39], v[130:131], v[10:11] op_sel_hi:[1,0,1]
    v_pk_mul_f32 v[4:5], v[44:45], v[130:131] op_sel:[0,1]
    v_pk_mul_f32 v[6:7], v[40:41], v[130:131] op_sel:[0,1]
    v_pk_fma_f32 v[40:41], v[40:41], v[130:131], v[4:5] op_sel_hi:[1,0,1] neg_lo:[0,0,1] neg_hi:[0,0,1]
    v_pk_fma_f32 v[44:45], v[44:45], v[130:131], v[6:7] op_sel_hi:[1,0,1]
    v_pk_mul_f32 v[8:9], v[46:47], v[130:131] op_sel:[0,1]
    v_pk_mul_f32 v[10:11], v[42:43], v[130:131] op_sel:[0,1]
    v_pk_fma_f32 v[42:43], v[42:43], v[130:131], v[8:9] op_sel_hi:[1,0,1] neg_lo:[0,0,1] neg_hi:[0,0,1]
    v_pk_fma_f32 v[46:47], v[46:47], v[130:131], v[10:11] op_sel_hi:[1,0,1]
    v_pk_mul_f32 v[4:5], v[52:53], v[130:131] op_sel:[0,1]
    v_pk_mul_f32 v[6:7], v[48:49], v[130:131] op_sel:[0,1]
    v_pk_fma_f32 v[48:49], v[48:49], v[130:131], v[4:5] op_sel_hi:[1,0,1] neg_lo:[0,0,1] neg_hi:[0,0,1]
    v_pk_fma_f32 v[52:53], v[52:53], v[130:131], v[6:7] op_sel_hi:[1,0,1]
    v_pk_mul_f32 v[8:9], v[54:55], v[130:131] op_sel:[0,1]
    v_pk_mul_f32 v[10:11], v[50:51], v[130:131] op_sel:[0,1]
    v_pk_fma_f32 v[50:51], v[50:51], v[130:131], v[8:9] op_sel_hi:[1,0,1] neg_lo:[0,0,1] neg_hi:[0,0,1]
    v_pk_fma_f32 v[54:55], v[54:55], v[130:131], v[10:11] op_sel_hi:[1,0,1]
    v_pk_mul_f32 v[4:5], v[60:61], v[130:131] op_sel:[0,1]
    v_pk_mul_f32 v[6:7], v[56:57], v[130:131] op_sel:[0,1]
    v_pk_fma_f32 v[56:57], v[56:57], v[130:131], v[4:5] op_sel_hi:[1,0,1] neg_lo:[0,0,1] neg_hi:[0,0,1]
    v_pk_fma_f32 v[60:61], v[60:61], v[130:131], v[6:7] op_sel_hi:[1,0,1]
    v_pk_mul_f32 v[8:9], v[62:63], v[130:131] op_sel:[0,1]
    v_pk_mul_f32 v[10:11], v[58:59], v[130:131] op_sel:[0,1]
    v_pk_fma_f32 v[58:59], v[58:59], v[130:131], v[8:9] op_sel_hi:[1,0,1] neg_lo:[0,0,1] neg_hi:[0,0,1]
    v_pk_fma_f32 v[62:63], v[62:63], v[130:131], v[10:11] op_sel_hi:[1,0,1]
    v_pk_mul_f32 v[4:5], v[68:69], v[130:131] op_sel:[0,1]
    v_pk_mul_f32 v[6:7], v[64:65], v[130:131] op_sel:[0,1]
    v_pk_fma_f32 v[64:65], v[64:65], v[130:131], v[4:5] op_sel_hi:[1,0,1] neg_lo:[0,0,1] neg_hi:[0,0,1]
    v_pk_fma_f32 v[68:69], v[68:69], v[130:131], v[6:7] op_sel_hi:[1,0,1]
    v_pk_mul_f32 v[8:9], v[70:71], v[130:131] op_sel:[0,1]
    v_pk_mul_f32 v[10:11], v[66:67], v[130:131] op_sel:[0,1]
    v_pk_fma_f32 v[66:67], v[66:67], v[130:131], v[8:9] op_sel_hi:[1,0,1] neg_lo:[0,0,1] neg_hi:[0,0,1]
    v_pk_fma_f32 v[70:71], v[70:71], v[130:131], v[10:11] op_sel_hi:[1,0,1]
    s_waitcnt lgkmcnt(0)
    s_barrier
    ds_read_b128 a[32:35], v205 offset:0
    ds_read_b128 a[36:39], v205 offset:1024
    ds_read_b128 a[40:43], v205 offset:2048
    ds_read_b128 a[44:47], v205 offset:3072
    ds_read_b128 a[48:51], v205 offset:4112
    ds_read_b128 a[52:55], v205 offset:5136
    ds_read_b128 a[56:59], v205 offset:6160
    ds_read_b128 a[60:63], v205 offset:7184
    v_pk_mul_f32 v[4:5], v[76:77], v[130:131] op_sel:[0,1]
    v_pk_mul_f32 v[6:7], v[72:73], v[130:131] op_sel:[0,1]
    v_pk_fma_f32 v[72:73], v[72:73], v[130:131], v[4:5] op_sel_hi:[1,0,1] neg_lo:[0,0,1] neg_hi:[0,0,1]
    v_pk_fma_f32 v[76:77], v[76:77], v[130:131], v[6:7] op_sel_hi:[1,0,1]
    v_pk_mul_f32 v[8:9], v[78:79], v[130:131] op_sel:[0,1]
    v_pk_mul_f32 v[10:11], v[74:75], v[130:131] op_sel:[0,1]
    v_pk_fma_f32 v[74:75], v[74:75], v[130:131], v[8:9] op_sel_hi:[1,0,1] neg_lo:[0,0,1] neg_hi:[0,0,1]
    v_pk_fma_f32 v[78:79], v[78:79], v[130:131], v[10:11] op_sel_hi:[1,0,1]
    v_pk_mul_f32 v[4:5], v[84:85], v[130:131] op_sel:[0,1]
    v_pk_mul_f32 v[6:7], v[80:81], v[130:131] op_sel:[0,1]
    v_pk_fma_f32 v[80:81], v[80:81], v[130:131], v[4:5] op_sel_hi:[1,0,1] neg_lo:[0,0,1] neg_hi:[0,0,1]
    v_pk_fma_f32 v[84:85], v[84:85], v[130:131], v[6:7] op_sel_hi:[1,0,1]
    v_pk_mul_f32 v[8:9], v[86:87], v[130:131] op_sel:[0,1]
    v_pk_mul_f32 v[10:11], v[82:83], v[130:131] op_sel:[0,1]
    v_pk_fma_f32 v[82:83], v[82:83], v[130:131], v[8:9] op_sel_hi:[1,0,1] neg_lo:[0,0,1] neg_hi:[0,0,1]
    v_pk_fma_f32 v[86:87], v[86:87], v[130:131], v[10:11] op_sel_hi:[1,0,1]
    v_pk_mul_f32 v[4:5], v[92:93], v[130:131] op_sel:[0,1]
    v_pk_mul_f32 v[6:7], v[88:89], v[130:131] op_sel:[0,1]
    v_pk_fma_f32 v[88:89], v[88:89], v[130:131], v[4:5] op_sel_hi:[1,0,1] neg_lo:[0,0,1] neg_hi:[0,0,1]
    v_pk_fma_f32 v[92:93], v[92:93], v[130:131], v[6:7] op_sel_hi:[1,0,1]
    v_pk_mul_f32 v[8:9], v[94:95], v[130:131] op_sel:[0,1]
    v_pk_mul_f32 v[10:11], v[90:91], v[130:131] op_sel:[0,1]
    v_pk_fma_f32 v[90:91], v[90:91], v[130:131], v[8:9] op_sel_hi:[1,0,1] neg_lo:[0,0,1] neg_hi:[0,0,1]
    v_pk_fma_f32 v[94:95], v[94:95], v[130:131], v[10:11] op_sel_hi:[1,0,1]
    s_waitcnt lgkmcnt(4)
    v_mfma_f32_16x16x32_bf16 v[224:227], a[0:3], a[32:35], 0
    ds_read_b128 a[64:67], v205 offset:8224
    v_mfma_f32_16x16x32_bf16 v[228:231], a[4:7], a[32:35], 0
    ds_read_b128 a[68:71], v205 offset:9248
    v_mfma_f32_16x16x32_bf16 v[224:227], a[8:11], a[36:39], v[224:227]
    ds_read_b128 a[72:75], v205 offset:10272
    v_mfma_f32_16x16x32_bf16 v[228:231], a[12:15], a[36:39], v[228:231]
    ds_read_b128 a[76:79], v205 offset:11296
    v_mfma_f32_16x16x32_bf16 v[224:227], a[16:19], a[40:43], v[224:227]
    ds_read_b128 a[80:83], v205 offset:12336
    v_mfma_f32_16x16x32_bf16 v[228:231], a[20:23], a[40:43], v[228:231]
    ds_read_b128 a[84:87], v205 offset:13360
    v_mfma_f32_16x16x32_bf16 v[224:227], a[24:27], a[44:47], v[224:227]
    ds_read_b128 a[88:91], v205 offset:14384
    v_mfma_f32_16x16x32_bf16 v[228:231], a[28:31], a[44:47], v[228:231]
    ds_read_b128 a[92:95], v205 offset:15408
    s_waitcnt lgkmcnt(8)
    v_mfma_f32_16x16x32_bf16 v[232:235], a[0:3], a[48:51], 0
    v_accvgpr_read_b32 v112, a152
    v_accvgpr_read_b32 v113, a153
    v_mfma_f32_16x16x32_bf16 v[236:239], a[4:7], a[48:51], 0
    v_accvgpr_read_b32 v114, a154
    v_mfma_f32_16x16x32_bf16 v[232:235], a[8:11], a[52:55], v[232:235]
    v_accvgpr_read_b32 v115, a155
    v_mfma_f32_16x16x32_bf16 v[236:239], a[12:15], a[52:55], v[236:239]
    v_cvt_pk_bf16_f32 v184, v224, v228
    v_cvt_pk_bf16_f32 v185, v225, v229
    v_mfma_f32_16x16x32_bf16 v[232:235], a[16:19], a[56:59], v[232:235]
    v_cvt_pk_bf16_f32 v186, v226, v230
    v_cvt_pk_bf16_f32 v187, v227, v231
    v_mfma_f32_16x16x32_bf16 v[236:239], a[20:23], a[56:59], v[236:239]
    v_xor_b32 v184, v207, v184
    v_xor_b32 v185, v207, v185
    v_mfma_f32_16x16x32_bf16 v[232:235], a[24:27], a[60:63], v[232:235]
    v_xor_b32 v186, v207, v186
    v_xor_b32 v187, v207, v187
    v_mfma_f32_16x16x32_bf16 v[236:239], a[28:31], a[60:63], v[236:239]
    buffer_store_dwordx4 v[184:187], v206, s[24:27], s38 offen sc1
    s_add_u32 s38, s38, 16384
    s_waitcnt lgkmcnt(4)
    v_mfma_f32_16x16x32_bf16 v[240:243], a[0:3], a[64:67], 0
    v_accvgpr_read_b32 v116, a156
    v_accvgpr_read_b32 v117, a157
    v_mfma_f32_16x16x32_bf16 v[244:247], a[4:7], a[64:67], 0
    v_accvgpr_read_b32 v118, a158
    v_mfma_f32_16x16x32_bf16 v[240:243], a[8:11], a[68:71], v[240:243]
    v_accvgpr_read_b32 v119, a159
    v_mfma_f32_16x16x32_bf16 v[244:247], a[12:15], a[68:71], v[244:247]
    v_cvt_pk_bf16_f32 v188, v232, v236
    v_cvt_pk_bf16_f32 v189, v233, v237
    v_mfma_f32_16x16x32_bf16 v[240:243], a[16:19], a[72:75], v[240:243]
    v_cvt_pk_bf16_f32 v190, v234, v238
    v_cvt_pk_bf16_f32 v191, v235, v239
    v_mfma_f32_16x16x32_bf16 v[244:247], a[20:23], a[72:75], v[244:247]
    v_xor_b32 v188, v207, v188
    v_xor_b32_e64 v189, v207, v189
    v_mfma_f32_16x16x32_bf16 v[240:243], a[24:27], a[76:79], v[240:243]
    v_xor_b32 v190, v207, v190
    v_xor_b32 v191, v207, v191
    v_mfma_f32_16x16x32_bf16 v[244:247], a[28:31], a[76:79], v[244:247]
    buffer_store_dwordx4 v[188:191], v206, s[24:27], s38 offen sc1
    s_add_u32 s38, s38, 16384
    s_waitcnt lgkmcnt(0)
    v_mfma_f32_16x16x32_bf16 v[248:251], a[0:3], a[80:83], 0
    v_accvgpr_read_b32 v120, a160
    v_accvgpr_read_b32 v121, a161
    v_mfma_f32_16x16x32_bf16 v[252:255], a[4:7], a[80:83], 0
    v_accvgpr_read_b32 v122, a162
    v_mfma_f32_16x16x32_bf16 v[248:251], a[8:11], a[84:87], v[248:251]
    v_accvgpr_read_b32 v123, a163
    v_mfma_f32_16x16x32_bf16 v[252:255], a[12:15], a[84:87], v[252:255]
    v_cvt_pk_bf16_f32 v192, v240, v244
    v_cvt_pk_bf16_f32 v193, v241, v245
    v_mfma_f32_16x16x32_bf16 v[248:251], a[16:19], a[88:91], v[248:251]
    v_cvt_pk_bf16_f32 v194, v242, v246
    v_cvt_pk_bf16_f32 v195, v243, v247
    v_mfma_f32_16x16x32_bf16 v[252:255], a[20:23], a[88:91], v[252:255]
    v_xor_b32 v192, v207, v192
    v_xor_b32_e64 v193, v207, v193
    v_mfma_f32_16x16x32_bf16 v[248:251], a[24:27], a[92:95], v[248:251]
    v_xor_b32 v194, v207, v194
    v_xor_b32 v195, v207, v195
    v_mfma_f32_16x16x32_bf16 v[252:255], a[28:31], a[92:95], v[252:255]
    buffer_store_dwordx4 v[192:195], v206, s[24:27], s38 offen sc1
    s_add_u32 s38, s38, 16384
    v_accvgpr_read_b32 v124, a164
    v_accvgpr_read_b32 v125, a165
    v_accvgpr_read_b32 v126, a166
    v_accvgpr_read_b32 v127, a167
    s_nop 1
    v_cvt_pk_bf16_f32 v196, v248, v252
    v_cvt_pk_bf16_f32 v197, v249, v253
    v_cvt_pk_bf16_f32 v198, v250, v254
    v_cvt_pk_bf16_f32 v199, v251, v255
    v_xor_b32 v196, v207, v196
    v_xor_b32 v197, v207, v197
    v_xor_b32 v198, v207, v198
    v_xor_b32_e64 v199, v207, v199
    buffer_store_dwordx4 v[196:199], v206, s[24:27], s38 offen sc1
    s_waitcnt vmcnt(8)
    v_xor_b32 v4, v200, v98
    v_xor_b32 v5, v201, v102
    v_xor_b32 v6, v202, v106
    v_xor_b32_e64 v7, v203, v110
    v_or3_b32 v4, v4, v5, v6
    v_or_b32 v4, v4, v7
    v_cmp_ne_u32 vcc, 0, v4
    s_nop 0
    s_cbranch_vccnz K_POLL2
K_POLL2_OK:
    s_nop 0
    s_nop 0
    s_xor_b32 s40, s92, 128
    buffer_load_dword a223, v29, s[16:19], s40 offen
    v_fma_f32 v4, v108, v136, v104
    v_fma_f32 v5, v108, v137, v105
    v_fma_f32 v4, -v109, v137, v4
    v_fma_f32 v5, v109, v136, v5
    v_fma_f32 v6, v4, v136, v100
    v_fma_f32 v7, v4, v137, v101
    v_fma_f32 v6, -v5, v137, v6
    v_fma_f32 v7, v5, v136, v7
    v_fma_f32 v4, v6, v136, v96
    v_fma_f32 v5, v6, v137, v97
    v_fma_f32 v4, -v7, v137, v4
    v_fma_f32 v5, v7, v136, v5
    v_mul_f32 v6, v4, v140
    v_mul_f32 v8, v4, v141
    v_fma_f32 v6, -v5, v141, v6
    v_fma_f32 v8, v5, v140, v8
    v_and_b32_e64 v210, 7, v0
    v_lshl_add_u32 v210, v210, 7, s99
    v_permlane32_swap_b32 v6, v8
    v_add_f32 v6, v6, v8
    v_mov_b32 v8, v6
    v_add_u32 v208, s50, v30
    v_add_u32 v209, s7, v30
    v_permlane16_swap_b32 v6, v8
    v_add_f32 v6, v6, v8
    v_mov_b32 v8, v6
    v_mov_b32 v28, s35
    s_nop 0
    v_permlane32_swap_b32 v6, v8
    s_nop 0
    v_fma_f32 v10, v6, v138, v146
    v_fma_f32 v12, v6, v139, v147
    v_fma_f32 v10, -v8, v139, v10
    v_fma_f32 v12, v8, v138, v12
    v_fma_f32 v11, v10, v132, v142
    v_fma_f32 v13, v10, v133, v144
    v_fma_f32 v11, -v12, v133, v11
    v_fma_f32 v13, v12, v132, v13
    v_pk_fma_f32 v[32:33], v[10:11], v[128:129], v[32:33] op_sel_hi:[1,0,1]
    v_pk_fma_f32 v[36:37], v[12:13], v[128:129], v[36:37] op_sel_hi:[1,0,1]
    v_pk_fma_f32 v[32:33], v[12:13], v[128:129], v[32:33] op_sel:[0,1,0] neg_lo:[1,0,0] neg_hi:[1,0,0]
    v_pk_fma_f32 v[36:37], v[10:11], v[128:129], v[36:37] op_sel:[0,1,0]
    v_pk_fma_f32 v[34:35], v[32:33], v[128:129], v[34:35] op_sel_hi:[1,0,1]
    v_pk_fma_f32 v[38:39], v[36:37], v[128:129], v[38:39] op_sel_hi:[1,0,1]
    v_pk_fma_f32 v[34:35], v[36:37], v[128:129], v[34:35] op_sel:[0,1,0] neg_lo:[1,0,0] neg_hi:[1,0,0]
    v_pk_fma_f32 v[38:39], v[32:33], v[128:129], v[38:39] op_sel:[0,1,0]
    v_cvt_pk_bf16_f32 v224, v32, v34
    v_cvt_pk_bf16_f32 v232, v33, v35
    v_cvt_pk_bf16_f32 v240, -v36, -v38
    v_cvt_pk_bf16_f32 v248, -v37, -v39
    v_pk_fma_f32 v[40:41], v[34:35], v[128:129], v[40:41] op_sel_hi:[1,0,1]
    v_pk_fma_f32 v[44:45], v[38:39], v[128:129], v[44:45] op_sel_hi:[1,0,1]
    v_pk_fma_f32 v[40:41], v[38:39], v[128:129], v[40:41] op_sel:[0,1,0] neg_lo:[1,0,0] neg_hi:[1,0,0]
    v_pk_fma_f32 v[44:45], v[34:35], v[128:129], v[44:45] op_sel:[0,1,0]
    v_pk_fma_f32 v[42:43], v[40:41], v[128:129], v[42:43] op_sel_hi:[1,0,1]
    v_pk_fma_f32 v[46:47], v[44:45], v[128:129], v[46:47] op_sel_hi:[1,0,1]
    v_pk_fma_f32 v[42:43], v[44:45], v[128:129], v[42:43] op_sel:[0,1,0] neg_lo:[1,0,0] neg_hi:[1,0,0]
    v_pk_fma_f32 v[46:47], v[40:41], v[128:129], v[46:47] op_sel:[0,1,0]
    v_cvt_pk_bf16_f32 v225, v40, v42
    v_cvt_pk_bf16_f32 v233, v41, v43
    v_cvt_pk_bf16_f32 v241, -v44, -v46
    v_cvt_pk_bf16_f32 v249, -v45, -v47
    v_pk_fma_f32 v[48:49], v[42:43], v[128:129], v[48:49] op_sel_hi:[1,0,1]
    v_pk_fma_f32 v[52:53], v[46:47], v[128:129], v[52:53] op_sel_hi:[1,0,1]
    v_pk_fma_f32 v[48:49], v[46:47], v[128:129], v[48:49] op_sel:[0,1,0] neg_lo:[1,0,0] neg_hi:[1,0,0]
    v_pk_fma_f32 v[52:53], v[42:43], v[128:129], v[52:53] op_sel:[0,1,0]
    v_pk_fma_f32 v[50:51], v[48:49], v[128:129], v[50:51] op_sel_hi:[1,0,1]
    v_pk_fma_f32 v[54:55], v[52:53], v[128:129], v[54:55] op_sel_hi:[1,0,1]
    v_pk_fma_f32 v[50:51], v[52:53], v[128:129], v[50:51] op_sel:[0,1,0] neg_lo:[1,0,0] neg_hi:[1,0,0]
    v_pk_fma_f32 v[54:55], v[48:49], v[128:129], v[54:55] op_sel:[0,1,0]
    v_cvt_pk_bf16_f32 v226, v48, v50
    v_cvt_pk_bf16_f32 v234, v49, v51
    v_cvt_pk_bf16_f32 v242, -v52, -v54
    v_cvt_pk_bf16_f32 v250, -v53, -v55
    v_pk_fma_f32 v[56:57], v[50:51], v[128:129], v[56:57] op_sel_hi:[1,0,1]
    v_pk_fma_f32 v[60:61], v[54:55], v[128:129], v[60:61] op_sel_hi:[1,0,1]
    v_pk_fma_f32 v[56:57], v[54:55], v[128:129], v[56:57] op_sel:[0,1,0] neg_lo:[1,0,0] neg_hi:[1,0,0]
    v_pk_fma_f32 v[60:61], v[50:51], v[128:129], v[60:61] op_sel:[0,1,0]
    v_pk_fma_f32 v[58:59], v[56:57], v[128:129], v[58:59] op_sel_hi:[1,0,1]
    v_pk_fma_f32 v[62:63], v[60:61], v[128:129], v[62:63] op_sel_hi:[1,0,1]
    v_pk_fma_f32 v[58:59], v[60:61], v[128:129], v[58:59] op_sel:[0,1,0] neg_lo:[1,0,0] neg_hi:[1,0,0]
    v_pk_fma_f32 v[62:63], v[56:57], v[128:129], v[62:63] op_sel:[0,1,0]
    v_cvt_pk_bf16_f32 v227, v56, v58
    v_cvt_pk_bf16_f32 v235, v57, v59
    v_cvt_pk_bf16_f32 v243, -v60, -v62
    v_cvt_pk_bf16_f32 v251, -v61, -v63
    ds_write_b128 v216, v[224:227] offset:0
    ds_write_b128 v218, v[232:235] offset:0
    ds_write_b128 v216, v[240:243] offset:4096
    ds_write_b128 v218, v[248:251] offset:4096
    v_pk_fma_f32 v[64:65], v[58:59], v[128:129], v[64:65] op_sel_hi:[1,0,1]
    v_pk_fma_f32 v[68:69], v[62:63], v[128:129], v[68:69] op_sel_hi:[1,0,1]
    v_pk_fma_f32 v[64:65], v[62:63], v[128:129], v[64:65] op_sel:[0,1,0] neg_lo:[1,0,0] neg_hi:[1,0,0]
    v_pk_fma_f32 v[68:69], v[58:59], v[128:129], v[68:69] op_sel:[0,1,0]
    v_pk_fma_f32 v[66:67], v[64:65], v[128:129], v[66:67] op_sel_hi:[1,0,1]
    v_pk_fma_f32 v[70:71], v[68:69], v[128:129], v[70:71] op_sel_hi:[1,0,1]
    v_pk_fma_f32 v[66:67], v[68:69], v[128:129], v[66:67] op_sel:[0,1,0] neg_lo:[1,0,0] neg_hi:[1,0,0]
    v_pk_fma_f32 v[70:71], v[64:65], v[128:129], v[70:71] op_sel:[0,1,0]
    v_cvt_pk_bf16_f32 v228, v64, v66
    v_cvt_pk_bf16_f32 v236, v65, v67
    v_cvt_pk_bf16_f32 v244, -v68, -v70
    v_cvt_pk_bf16_f32 v252, -v69, -v71
    v_pk_fma_f32 v[72:73], v[66:67], v[128:129], v[72:73] op_sel_hi:[1,0,1]
    v_pk_fma_f32 v[76:77], v[70:71], v[128:129], v[76:77] op_sel_hi:[1,0,1]
    v_pk_fma_f32 v[72:73], v[70:71], v[128:129], v[72:73] op_sel:[0,1,0] neg_lo:[1,0,0] neg_hi:[1,0,0]
    v_pk_fma_f32 v[76:77], v[66:67], v[128:129], v[76:77] op_sel:[0,1,0]
    v_pk_fma_f32 v[74:75], v[72:73], v[128:129], v[74:75] op_sel_hi:[1,0,1]
    v_pk_fma_f32 v[78:79], v[76:77], v[128:129], v[78:79] op_sel_hi:[1,0,1]
    v_pk_fma_f32 v[74:75], v[76:77], v[128:129], v[74:75] op_sel:[0,1,0] neg_lo:[1,0,0] neg_hi:[1,0,0]
    v_pk_fma_f32 v[78:79], v[72:73], v[128:129], v[78:79] op_sel:[0,1,0]
    v_cvt_pk_bf16_f32 v229, v72, v74
    v_cvt_pk_bf16_f32 v237, v73, v75
    v_cvt_pk_bf16_f32 v245, -v76, -v78
    v_cvt_pk_bf16_f32 v253, -v77, -v79
    v_pk_fma_f32 v[80:81], v[74:75], v[128:129], v[80:81] op_sel_hi:[1,0,1]
    v_pk_fma_f32 v[84:85], v[78:79], v[128:129], v[84:85] op_sel_hi:[1,0,1]
    v_pk_fma_f32 v[80:81], v[78:79], v[128:129], v[80:81] op_sel:[0,1,0] neg_lo:[1,0,0] neg_hi:[1,0,0]
    v_pk_fma_f32 v[84:85], v[74:75], v[128:129], v[84:85] op_sel:[0,1,0]
    v_pk_fma_f32 v[82:83], v[80:81], v[128:129], v[82:83] op_sel_hi:[1,0,1]
    v_pk_fma_f32 v[86:87], v[84:85], v[128:129], v[86:87] op_sel_hi:[1,0,1]
    v_pk_fma_f32 v[82:83], v[84:85], v[128:129], v[82:83] op_sel:[0,1,0] neg_lo:[1,0,0] neg_hi:[1,0,0]
    v_pk_fma_f32 v[86:87], v[80:81], v[128:129], v[86:87] op_sel:[0,1,0]
    v_cvt_pk_bf16_f32 v230, v80, v82
    v_cvt_pk_bf16_f32 v238, v81, v83
    v_cvt_pk_bf16_f32 v246, -v84, -v86
    v_cvt_pk_bf16_f32 v254, -v85, -v87
    v_pk_fma_f32 v[88:89], v[82:83], v[128:129], v[88:89] op_sel_hi:[1,0,1]
    v_pk_fma_f32 v[92:93], v[86:87], v[128:129], v[92:93] op_sel_hi:[1,0,1]
    v_pk_fma_f32 v[88:89], v[86:87], v[128:129], v[88:89] op_sel:[0,1,0] neg_lo:[1,0,0] neg_hi:[1,0,0]
    v_pk_fma_f32 v[92:93], v[82:83], v[128:129], v[92:93] op_sel:[0,1,0]
    v_pk_fma_f32 v[90:91], v[88:89], v[128:129], v[90:91] op_sel_hi:[1,0,1]
    v_pk_fma_f32 v[94:95], v[92:93], v[128:129], v[94:95] op_sel_hi:[1,0,1]
    v_pk_fma_f32 v[90:91], v[92:93], v[128:129], v[90:91] op_sel:[0,1,0] neg_lo:[1,0,0] neg_hi:[1,0,0]
    v_pk_fma_f32 v[94:95], v[88:89], v[128:129], v[94:95] op_sel:[0,1,0]
    v_cvt_pk_bf16_f32 v231, v88, v90
    v_cvt_pk_bf16_f32 v239, v89, v91
    v_cvt_pk_bf16_f32 v247, -v92, -v94
    v_cvt_pk_bf16_f32 v255, -v93, -v95
    ds_write_b128 v217, v[228:231] offset:0
    ds_write_b128 v219, v[236:239] offset:0
    ds_write_b128 v217, v[244:247] offset:4096
    ds_write_b128 v219, v[252:255] offset:4096
    v_accvgpr_read_b32 v96, a136
    v_accvgpr_read_b32 v97, a137
    v_accvgpr_read_b32 v98, a138
    v_accvgpr_read_b32 v99, a139
    v_accvgpr_read_b32 v100, a140
    v_accvgpr_read_b32 v101, a141
    v_accvgpr_read_b32 v102, a142
    v_accvgpr_read_b32 v103, a143
    v_accvgpr_read_b32 v104, a144
    v_accvgpr_read_b32 v105, a145
    v_accvgpr_read_b32 v106, a146
    v_accvgpr_read_b32 v107, a147
    v_accvgpr_read_b32 v108, a148
    v_accvgpr_read_b32 v109, a149
    v_accvgpr_read_b32 v110, a150
    v_accvgpr_read_b32 v111, a151
    v_accvgpr_read_b32 v128, a168
    v_accvgpr_read_b32 v129, a169
    v_accvgpr_read_b32 v130, a170
    v_accvgpr_read_b32 v131, a171
    v_accvgpr_read_b32 v132, a172
    v_accvgpr_read_b32 v133, a173
    s_waitcnt lgkmcnt(0) vmcnt(5)
    s_barrier
    ds_read_b64_tr_b16 v[64:65], v220 offset:0
    ds_read_b64_tr_b16 v[66:67], v221 offset:1024
    ds_read_b64_tr_b16 v[68:69], v220 offset:8192
    ds_read_b64_tr_b16 v[70:71], v221 offset:9216
    ds_read_b64_tr_b16 v[72:73], v220 offset:16384
    ds_read_b64_tr_b16 v[74:75], v221 offset:17408
    ds_read_b64_tr_b16 v[76:77], v220 offset:24576
    ds_read_b64_tr_b16 v[78:79], v221 offset:25600
    ds_read_b64_tr_b16 v[80:81], v222 offset:0
    ds_read_b64_tr_b16 v[82:83], v223 offset:1024
    ds_read_b64_tr_b16 v[84:85], v222 offset:8192
    ds_read_b64_tr_b16 v[86:87], v223 offset:9216
    ds_read_b64_tr_b16 v[88:89], v222 offset:16384
    ds_read_b64_tr_b16 v[90:91], v223 offset:17408
    ds_read_b64_tr_b16 v[92:93], v222 offset:24576
    ds_read_b64_tr_b16 v[94:95], v223 offset:25600
    ds_read_b128 v[152:155], v20 offset:0
    ds_read_b128 v[156:159], v20 offset:2048
    ds_read_b128 v[160:163], v20 offset:4096
    ds_read_b128 v[164:167], v20 offset:6144
    s_waitcnt lgkmcnt(0)
    s_cmp_lg_u32 s50, 0
    s_cbranch_scc1 K_HFAR
    buffer_store_dwordx4 v[64:67], v24, s[28:31], s68 offen
    buffer_store_dwordx4 v[80:83], v24, s[28:31], s69 offen
    v_mfma_f32_16x16x32_bf16 v[32:35], v[64:67], v[152:155], 0
    ds_read_b128 v[168:171], v21 offset:0
    buffer_store_dwordx4 v[68:71], v25, s[28:31], s68 offen
    v_mfma_f32_16x16x32_bf16 v[48:51], v[80:83], v[152:155], 0
    ds_read_b128 v[172:175], v21 offset:2048
    v_mfma_f32_16x16x32_bf16 v[36:39], v[64:67], v[156:159], 0
    ds_read_b128 v[176:179], v21 offset:4096
    buffer_store_dwordx4 v[84:87], v25, s[28:31], s69 offen
    v_mfma_f32_16x16x32_bf16 v[52:55], v[80:83], v[156:159], 0
    ds_read_b128 v[180:183], v21 offset:6144
    v_mfma_f32_16x16x32_bf16 v[40:43], v[64:67], v[160:163], 0
    v_mfma_f32_16x16x32_bf16 v[56:59], v[80:83], v[160:163], 0
    buffer_store_dwordx4 v[72:75], v26, s[28:31], s68 offen
    v_mfma_f32_16x16x32_bf16 v[44:47], v[64:67], v[164:167], 0
    v_mfma_f32_16x16x32_bf16 v[60:63], v[80:83], v[164:167], 0
    s_waitcnt lgkmcnt(0)
    v_mfma_f32_16x16x32_bf16 v[32:35], v[68:71], v[168:171], v[32:35]
    ds_read_b128 v[152:155], v22 offset:0
    buffer_store_dwordx4 v[88:91], v26, s[28:31], s69 offen
    v_mfma_f32_16x16x32_bf16 v[48:51], v[84:87], v[168:171], v[48:51]
    ds_read_b128 v[156:159], v22 offset:2048
    v_mfma_f32_16x16x32_bf16 v[36:39], v[68:71], v[172:175], v[36:39]
    ds_read_b128 v[160:163], v22 offset:4096
    buffer_store_dwordx4 v[76:79], v27, s[28:31], s68 offen
    v_mfma_f32_16x16x32_bf16 v[52:55], v[84:87], v[172:175], v[52:55]
    ds_read_b128 v[164:167], v22 offset:6144
    v_mfma_f32_16x16x32_bf16 v[40:43], v[68:71], v[176:179], v[40:43]
    v_mfma_f32_16x16x32_bf16 v[56:59], v[84:87], v[176:179], v[56:59]
    buffer_store_dwordx4 v[92:95], v27, s[28:31], s69 offen
    v_mfma_f32_16x16x32_bf16 v[44:47], v[68:71], v[180:183], v[44:47]
    v_mfma_f32_16x16x32_bf16 v[60:63], v[84:87], v[180:183], v[60:63]
K_HFAR_RET:
    s_bfe_u32 s72, s97, 262160
    s_add_u32 m0, s37, 65536
    s_lshl_b32 s72, s72, 7
    buffer_load_dwordx4 v16, s[16:19], s72 offen offset:0  lds
    buffer_load_dwordx4 v17, s[16:19], s72 offen offset:1024  lds
    buffer_load_dwordx4 v18, s[16:19], s72 offen offset:2048  lds
    buffer_load_dwordx4 v19, s[16:19], s72 offen offset:3072  lds
    s_bfe_u32 s72, s97, 262164
    s_add_u32 m0, s37, 81920
    s_lshl_b32 s72, s72, 7
    buffer_load_dwordx4 v16, s[16:19], s72 offen offset:0  lds
    buffer_load_dwordx4 v17, s[16:19], s72 offen offset:1024  lds
    buffer_load_dwordx4 v18, s[16:19], s72 offen offset:2048  lds
    buffer_load_dwordx4 v19, s[16:19], s72 offen offset:3072  lds
    s_waitcnt vmcnt(8)
    s_barrier
    buffer_store_dword v28, v208, s[24:27], s70 offen offset:64
    buffer_store_dword v28, v209, s[24:27], s70 offen offset:64 sc1
    s_waitcnt lgkmcnt(0)
    v_mfma_f32_16x16x32_bf16 v[32:35], v[72:75], v[152:155], v[32:35]
    ds_read_b128 v[168:171], v23 offset:0
    s_bfe_u32 s72, s97, 262168
    s_add_u32 m0, s37, 98304
    s_lshl_b32 s72, s72, 7
    v_mfma_f32_16x16x32_bf16 v[48:51], v[88:91], v[152:155], v[48:51]
    ds_read_b128 v[172:175], v23 offset:2048
    buffer_load_dwordx4 v16, s[16:19], s72 offen offset:0  lds
    buffer_load_dwordx4 v17, s[16:19], s72 offen offset:1024  lds
    v_mfma_f32_16x16x32_bf16 v[36:39], v[72:75], v[156:159], v[36:39]
    ds_read_b128 v[176:179], v23 offset:4096
    buffer_load_dwordx4 v18, s[16:19], s72 offen offset:2048  lds
    buffer_load_dwordx4 v19, s[16:19], s72 offen offset:3072  lds
    s_bfe_u32 s72, s97, 262172
    v_mfma_f32_16x16x32_bf16 v[52:55], v[88:91], v[156:159], v[52:55]
    ds_read_b128 v[180:183], v23 offset:6144
    s_add_u32 m0, s37, 114688
    s_lshl_b32 s72, s72, 7
    v_mfma_f32_16x16x32_bf16 v[40:43], v[72:75], v[160:163], v[40:43]
    buffer_load_dwordx4 v16, s[16:19], s72 offen offset:0  lds
    buffer_load_dwordx4 v17, s[16:19], s72 offen offset:1024  lds
    buffer_load_dwordx4 v18, s[16:19], s72 offen offset:2048  lds
    v_mfma_f32_16x16x32_bf16 v[56:59], v[88:91], v[160:163], v[56:59]
    buffer_load_dwordx4 v19, s[16:19], s72 offen offset:3072  lds
    buffer_load_dword v4, v210, s[24:27], s51 offen offset:64 sc1
    v_mfma_f32_16x16x32_bf16 v[44:47], v[72:75], v[164:167], v[44:47]
    s_lshl_b32 s70, s2, 4
    s_add_u32 s70, s70, 22396928
    v_mov_b32_e64 v28, s35
    v_mfma_f32_16x16x32_bf16 v[60:63], v[88:91], v[164:167], v[60:63]
    v_and_b32 v255, 1073741839, v30
    buffer_store_dword v28, v255, s[24:27], s70 offen sc1
    s_waitcnt lgkmcnt(0) vmcnt(1)
    v_cmp_ne_u32 vcc, s98, v4
    s_nop 0
    s_cbranch_vccnz K_POLL3
K_POLL3_OK:
    s_barrier
    v_mfma_f32_16x16x32_bf16 v[32:35], v[76:79], v[168:171], v[32:35]
    ds_read_b128 v[152:155], v20 offset:16384
    s_bfe_u32 s73, s97, 262148
    s_lshl_b32 s73, s73, 8
    s_add_u32 s73, s73, s95
    v_mfma_f32_16x16x32_bf16 v[48:51], v[92:95], v[168:171], v[48:51]
    ds_read_b128 v[156:159], v20 offset:18432
    s_add_u32 s74, s73, 0x20000
    buffer_load_dwordx4 a[0:3], v24, s[28:31], s73 offen sc1
    v_mfma_f32_16x16x32_bf16 v[36:39], v[76:79], v[172:175], v[36:39]
    ds_read_b128 v[160:163], v20 offset:20480
    buffer_load_dwordx4 a[16:19], v24, s[28:31], s74 offen sc1
    buffer_load_dwordx4 a[4:7], v25, s[28:31], s73 offen sc1
    v_mfma_f32_16x16x32_bf16 v[52:55], v[92:95], v[172:175], v[52:55]
    ds_read_b128 v[164:167], v20 offset:22528
    buffer_load_dwordx4 a[20:23], v25, s[28:31], s74 offen sc1
    buffer_load_dwordx4 a[8:11], v26, s[28:31], s73 offen sc1
    v_mfma_f32_16x16x32_bf16 v[40:43], v[76:79], v[176:179], v[40:43]
    buffer_load_dwordx4 a[24:27], v26, s[28:31], s74 offen sc1
    buffer_load_dwordx4 a[12:15], v27, s[28:31], s73 offen sc1
    buffer_load_dwordx4 a[28:31], v27, s[28:31], s74 offen sc1
    v_mfma_f32_16x16x32_bf16 v[56:59], v[92:95], v[176:179], v[56:59]
    s_bfe_u32 s73, s97, 262152
    s_lshl_b32 s73, s73, 8
    v_mfma_f32_16x16x32_bf16 v[44:47], v[76:79], v[180:183], v[44:47]
    s_add_u32 s73, s73, s95
    s_add_u32 s74, s73, 0x20000
    v_mfma_f32_16x16x32_bf16 v[60:63], v[92:95], v[180:183], v[60:63]
    buffer_load_dwordx4 a[32:35], v24, s[28:31], s73 offen sc1
    buffer_load_dwordx4 a[48:51], v24, s[28:31], s74 offen sc1
    s_waitcnt lgkmcnt(0) vmcnt(8)
    v_mfma_f32_16x16x32_bf16 v[32:35], a[0:3], v[152:155], v[32:35]
    ds_read_b128 v[168:171], v21 offset:16384
    buffer_load_dwordx4 a[36:39], v25, s[28:31], s73 offen sc1
    v_mfma_f32_16x16x32_bf16 v[48:51], a[16:19], v[152:155], v[48:51]
    ds_read_b128 v[172:175], v21 offset:18432
    v_mfma_f32_16x16x32_bf16 v[36:39], a[0:3], v[156:159], v[36:39]
    ds_read_b128 v[176:179], v21 offset:20480
    buffer_load_dwordx4 a[52:55], v25, s[28:31], s74 offen sc1
    v_mfma_f32_16x16x32_bf16 v[52:55], a[16:19], v[156:159], v[52:55]
    ds_read_b128 v[180:183], v21 offset:22528
    v_mfma_f32_16x16x32_bf16 v[40:43], a[0:3], v[160:163], v[40:43]
    v_mfma_f32_16x16x32_bf16 v[56:59], a[16:19], v[160:163], v[56:59]
    buffer_load_dwordx4 a[40:43], v26, s[28:31], s73 offen sc1
    v_mfma_f32_16x16x32_bf16 v[44:47], a[0:3], v[164:167], v[44:47]
    v_mfma_f32_16x16x32_bf16 v[60:63], a[16:19], v[164:167], v[60:63]
    s_waitcnt lgkmcnt(0) vmcnt(9)
    v_mfma_f32_16x16x32_bf16 v[32:35], a[4:7], v[168:171], v[32:35]
    ds_read_b128 v[152:155], v22 offset:16384
    buffer_load_dwordx4 a[56:59], v26, s[28:31], s74 offen sc1
    v_mfma_f32_16x16x32_bf16 v[48:51], a[20:23], v[168:171], v[48:51]
    ds_read_b128 v[156:159], v22 offset:18432
    v_mfma_f32_16x16x32_bf16 v[36:39], a[4:7], v[172:175], v[36:39]
    ds_read_b128 v[160:163], v22 offset:20480
    buffer_load_dwordx4 a[44:47], v27, s[28:31], s73 offen sc1
    v_mfma_f32_16x16x32_bf16 v[52:55], a[20:23], v[172:175], v[52:55]
    ds_read_b128 v[164:167], v22 offset:22528
    v_mfma_f32_16x16x32_bf16 v[40:43], a[4:7], v[176:179], v[40:43]
    v_mfma_f32_16x16x32_bf16 v[56:59], a[20:23], v[176:179], v[56:59]
    buffer_load_dwordx4 a[60:63], v27, s[28:31], s74 offen sc1
    v_mfma_f32_16x16x32_bf16 v[44:47], a[4:7], v[180:183], v[44:47]
    v_mfma_f32_16x16x32_bf16 v[60:63], a[20:23], v[180:183], v[60:63]
    s_waitcnt lgkmcnt(0) vmcnt(10)
    v_mfma_f32_16x16x32_bf16 v[32:35], a[8:11], v[152:155], v[32:35]
    ds_read_b128 v[168:171], v23 offset:16384
    s_bfe_u32 s73, s97, 262156
    v_mfma_f32_16x16x32_bf16 v[48:51], a[24:27], v[152:155], v[48:51]
    ds_read_b128 v[172:175], v23 offset:18432
    s_lshl_b32 s73, s73, 8
    v_mfma_f32_16x16x32_bf16 v[36:39], a[8:11], v[156:159], v[36:39]
    ds_read_b128 v[176:179], v23 offset:20480
    s_add_u32 s73, s73, s95
    v_mfma_f32_16x16x32_bf16 v[52:55], a[24:27], v[156:159], v[52:55]
    ds_read_b128 v[180:183], v23 offset:22528
    s_add_u32 s74, s73, 0x20000
    v_mfma_f32_16x16x32_bf16 v[40:43], a[8:11], v[160:163], v[40:43]
    buffer_load_dwordx4 a[64:67], v24, s[28:31], s73 offen sc1
    v_mfma_f32_16x16x32_bf16 v[56:59], a[24:27], v[160:163], v[56:59]
    buffer_load_dwordx4 a[80:83], v24, s[28:31], s74 offen sc1
    v_mfma_f32_16x16x32_bf16 v[44:47], a[8:11], v[164:167], v[44:47]
    buffer_load_dwordx4 a[68:71], v25, s[28:31], s73 offen sc1
    v_mfma_f32_16x16x32_bf16 v[60:63], a[24:27], v[164:167], v[60:63]
    s_waitcnt lgkmcnt(0) vmcnt(11)
    v_mfma_f32_16x16x32_bf16 v[32:35], a[12:15], v[168:171], v[32:35]
    ds_read_b128 v[152:155], v20 offset:32768
    buffer_load_dwordx4 a[84:87], v25, s[28:31], s74 offen sc1
    v_lshlrev_b32 v216, 16, v112
    v_mfma_f32_16x16x32_bf16 v[48:51], a[28:31], v[168:171], v[48:51]
    ds_read_b128 v[156:159], v20 offset:34816
    v_and_b32 v220, 0xffff0000, v112
    v_mfma_f32_16x16x32_bf16 v[36:39], a[12:15], v[172:175], v[36:39]
    ds_read_b128 v[160:163], v20 offset:36864
    buffer_load_dwordx4 a[72:75], v26, s[28:31], s73 offen sc1
    v_lshlrev_b32_e64 v217, 16, v113
    v_mfma_f32_16x16x32_bf16 v[52:55], a[28:31], v[172:175], v[52:55]
    ds_read_b128 v[164:167], v20 offset:38912
    v_mfma_f32_16x16x32_bf16 v[40:43], a[12:15], v[176:179], v[40:43]
    v_and_b32 v221, 0xffff0000, v113
    v_mfma_f32_16x16x32_bf16 v[56:59], a[28:31], v[176:179], v[56:59]
    buffer_load_dwordx4 a[88:91], v26, s[28:31], s74 offen sc1
    v_lshlrev_b32_e64 v218, 16, v114
    v_mfma_f32_16x16x32_bf16 v[44:47], a[12:15], v[180:183], v[44:47]
    v_and_b32 v222, 0xffff0000, v114
    v_mfma_f32_16x16x32_bf16 v[60:63], a[28:31], v[180:183], v[60:63]
    s_waitcnt lgkmcnt(0) vmcnt(12)
    v_mfma_f32_16x16x32_bf16 v[32:35], a[32:35], v[152:155], v[32:35]
    ds_read_b128 v[168:171], v21 offset:32768
    buffer_load_dwordx4 a[76:79], v27, s[28:31], s73 offen sc1
    v_lshlrev_b32 v219, 16, v115
    v_mfma_f32_16x16x32_bf16 v[48:51], a[48:51], v[152:155], v[48:51]
    ds_read_b128 v[172:175], v21 offset:34816
    v_and_b32 v223, 0xffff0000, v115
    v_mfma_f32_16x16x32_bf16 v[36:39], a[32:35], v[156:159], v[36:39]
    ds_read_b128 v[176:179], v21 offset:36864
    v_lshlrev_b32_e64 v224, 16, v116
    v_mfma_f32_16x16x32_bf16 v[52:55], a[48:51], v[156:159], v[52:55]
    ds_read_b128 v[180:183], v21 offset:38912
    v_mfma_f32_16x16x32_bf16 v[40:43], a[32:35], v[160:163], v[40:43]
    buffer_load_dwordx4 a[92:95], v27, s[28:31], s74 offen sc1
    v_and_b32 v228, 0xffff0000, v116
    v_mfma_f32_16x16x32_bf16 v[56:59], a[48:51], v[160:163], v[56:59]
    v_lshlrev_b32_e64 v225, 16, v117
    v_mfma_f32_16x16x32_bf16 v[44:47], a[32:35], v[164:167], v[44:47]
    v_and_b32 v229, 0xffff0000, v117
    v_mfma_f32_16x16x32_bf16 v[60:63], a[48:51], v[164:167], v[60:63]
    s_waitcnt lgkmcnt(0) vmcnt(12)
    v_mfma_f32_16x16x32_bf16 v[32:35], a[36:39], v[168:171], v[32:35]
    ds_read_b128 v[152:155], v22 offset:32768
    s_bfe_u32 s73, s97, 262160
    v_lshlrev_b32 v226, 16, v118
    v_mfma_f32_16x16x32_bf16 v[48:51], a[52:55], v[168:171], v[48:51]
    ds_read_b128 v[156:159], v22 offset:34816
    s_lshl_b32 s73, s73, 8
    v_and_b32 v230, 0xffff0000, v118
    v_mfma_f32_16x16x32_bf16 v[36:39], a[36:39], v[172:175], v[36:39]
    ds_read_b128 v[160:163], v22 offset:36864
    s_add_u32 s73, s73, s95
    v_lshlrev_b32_e64 v227, 16, v119
    v_mfma_f32_16x16x32_bf16 v[52:55], a[52:55], v[172:175], v[52:55]
    ds_read_b128 v[164:167], v22 offset:38912
    v_mfma_f32_16x16x32_bf16 v[40:43], a[36:39], v[176:179], v[40:43]
    s_add_u32 s74, s73, 0x20000
    v_and_b32 v231, 0xffff0000, v119
    v_mfma_f32_16x16x32_bf16 v[56:59], a[52:55], v[176:179], v[56:59]
    buffer_load_dwordx4 a[96:99], v24, s[28:31], s73 offen sc1
    v_lshlrev_b32_e64 v232, 16, v120
    v_mfma_f32_16x16x32_bf16 v[44:47], a[36:39], v[180:183], v[44:47]
    buffer_load_dwordx4 a[112:115], v24, s[28:31], s74 offen sc1
    v_and_b32 v236, 0xffff0000, v120
    v_mfma_f32_16x16x32_bf16 v[60:63], a[52:55], v[180:183], v[60:63]
    s_waitcnt lgkmcnt(0) vmcnt(12)
    v_mfma_f32_16x16x32_bf16 v[32:35], a[40:43], v[152:155], v[32:35]
    ds_read_b128 v[168:171], v23 offset:32768
    buffer_load_dwordx4 a[100:103], v25, s[28:31], s73 offen sc1
    v_lshlrev_b32 v233, 16, v121
    v_mfma_f32_16x16x32_bf16 v[48:51], a[56:59], v[152:155], v[48:51]
    ds_read_b128 v[172:175], v23 offset:34816
    v_and_b32 v237, 0xffff0000, v121
    v_mfma_f32_16x16x32_bf16 v[36:39], a[40:43], v[156:159], v[36:39]
    ds_read_b128 v[176:179], v23 offset:36864
    v_lshlrev_b32_e64 v234, 16, v122
    v_mfma_f32_16x16x32_bf16 v[52:55], a[56:59], v[156:159], v[52:55]
    ds_read_b128 v[180:183], v23 offset:38912
    v_mfma_f32_16x16x32_bf16 v[40:43], a[40:43], v[160:163], v[40:43]
    buffer_load_dwordx4 a[116:119], v25, s[28:31], s74 offen sc1
    v_and_b32 v238, 0xffff0000, v122
    v_mfma_f32_16x16x32_bf16 v[56:59], a[56:59], v[160:163], v[56:59]
    v_lshlrev_b32_e64 v235, 16, v123
    v_mfma_f32_16x16x32_bf16 v[44:47], a[40:43], v[164:167], v[44:47]
    v_and_b32 v239, 0xffff0000, v123
    v_mfma_f32_16x16x32_bf16 v[60:63], a[56:59], v[164:167], v[60:63]
    s_waitcnt lgkmcnt(0) vmcnt(12)
    v_mfma_f32_16x16x32_bf16 v[32:35], a[44:47], v[168:171], v[32:35]
    ds_read_b128 v[152:155], v20 offset:49152
    buffer_load_dwordx4 a[104:107], v26, s[28:31], s73 offen sc1
    v_lshlrev_b32 v240, 16, v124
    v_mfma_f32_16x16x32_bf16 v[48:51], a[60:63], v[168:171], v[48:51]
    ds_read_b128 v[156:159], v20 offset:51200
    v_and_b32 v244, 0xffff0000, v124
    v_mfma_f32_16x16x32_bf16 v[36:39], a[44:47], v[172:175], v[36:39]
    ds_read_b128 v[160:163], v20 offset:53248
    v_lshlrev_b32_e64 v241, 16, v125
    v_mfma_f32_16x16x32_bf16 v[52:55], a[60:63], v[172:175], v[52:55]
    ds_read_b128 v[164:167], v20 offset:55296
    v_mfma_f32_16x16x32_bf16 v[40:43], a[44:47], v[176:179], v[40:43]
    buffer_load_dwordx4 a[120:123], v26, s[28:31], s74 offen sc1
    v_and_b32 v245, 0xffff0000, v125
    v_mfma_f32_16x16x32_bf16 v[56:59], a[60:63], v[176:179], v[56:59]
    v_lshlrev_b32_e64 v242, 16, v126
    v_mfma_f32_16x16x32_bf16 v[44:47], a[44:47], v[180:183], v[44:47]
    v_and_b32 v246, 0xffff0000, v126
    v_xor_b32 v20, 0x10000, v20
    v_mfma_f32_16x16x32_bf16 v[60:63], a[60:63], v[180:183], v[60:63]
    s_waitcnt lgkmcnt(0) vmcnt(12)
    v_mfma_f32_16x16x32_bf16 v[32:35], a[64:67], v[152:155], v[32:35]
    ds_read_b128 v[168:171], v21 offset:49152
    buffer_load_dwordx4 a[108:111], v27, s[28:31], s73 offen sc1
    v_lshlrev_b32 v243, 16, v127
    v_mfma_f32_16x16x32_bf16 v[48:51], a[80:83], v[152:155], v[48:51]
    ds_read_b128 v[172:175], v21 offset:51200
    v_and_b32 v247, 0xffff0000, v127
    v_mfma_f32_16x16x32_bf16 v[36:39], a[64:67], v[156:159], v[36:39]
    ds_read_b128 v[176:179], v21 offset:53248
    v_xor_b32 v16, 0x100000, v16
    v_mfma_f32_16x16x32_bf16 v[52:55], a[80:83], v[156:159], v[52:55]
    ds_read_b128 v[180:183], v21 offset:55296
    v_mfma_f32_16x16x32_bf16 v[40:43], a[64:67], v[160:163], v[40:43]
    buffer_load_dwordx4 a[124:127], v27, s[28:31], s74 offen sc1
    v_xor_b32 v17, 0x100000, v17
    v_mfma_f32_16x16x32_bf16 v[56:59], a[80:83], v[160:163], v[56:59]
    v_xor_b32 v18, 0x100000, v18
    v_mfma_f32_16x16x32_bf16 v[44:47], a[64:67], v[164:167], v[44:47]
    v_xor_b32 v19, 0x100000, v19
    v_xor_b32 v21, 0x10000, v21
    v_mfma_f32_16x16x32_bf16 v[60:63], a[80:83], v[164:167], v[60:63]
    s_waitcnt lgkmcnt(0) vmcnt(12)
    v_mfma_f32_16x16x32_bf16 v[32:35], a[68:71], v[168:171], v[32:35]
    ds_read_b128 v[152:155], v22 offset:49152
    s_bfe_u32 s73, s97, 262164
    v_lshlrev_b32 v4, 16, v2
    v_mfma_f32_16x16x32_bf16 v[48:51], a[84:87], v[168:171], v[48:51]
    ds_read_b128 v[156:159], v22 offset:51200
    s_lshl_b32 s73, s73, 8
    v_lshl_add_u32 v4, v1, 4, v4
    v_mfma_f32_16x16x32_bf16 v[36:39], a[68:71], v[172:175], v[36:39]
    ds_read_b128 v[160:163], v22 offset:53248
    s_add_u32 s73, s73, s95
    s_lshl_b32 s38, s2, 14
    v_mfma_f32_16x16x32_bf16 v[52:55], a[84:87], v[172:175], v[52:55]
    ds_read_b128 v[164:167], v22 offset:55296
    v_mfma_f32_16x16x32_bf16 v[40:43], a[68:71], v[176:179], v[40:43]
    s_add_u32 s74, s73, 0x20000
    s_add_u32 s38, s38, s37
    v_mfma_f32_16x16x32_bf16 v[56:59], a[84:87], v[176:179], v[56:59]
    buffer_load_dwordx4 a[128:131], v24, s[28:31], s73 offen sc1
    s_add_u32 s52, s38, 17825792
    v_mfma_f32_16x16x32_bf16 v[44:47], a[68:71], v[180:183], v[44:47]
    buffer_load_dwordx4 a[144:147], v24, s[28:31], s74 offen sc1
    s_xor_b32 s38, s38, 65536
    v_xor_b32 v22, 0x10000, v22
    v_mfma_f32_16x16x32_bf16 v[60:63], a[84:87], v[180:183], v[60:63]
    s_waitcnt lgkmcnt(0) vmcnt(12)
    v_mfma_f32_16x16x32_bf16 v[32:35], a[72:75], v[152:155], v[32:35]
    ds_read_b128 v[168:171], v23 offset:49152
    v_lshlrev_b32 v13, 4, v0
    s_add_u32 s54, s38, 17825792
    v_mfma_f32_16x16x32_bf16 v[48:51], a[88:91], v[152:155], v[48:51]
    ds_read_b128 v[172:175], v23 offset:51200
    s_lshl_b32 s70, s34, 10
    s_lshl_b32 s38, s4, 14
    v_mfma_f32_16x16x32_bf16 v[36:39], a[72:75], v[156:159], v[36:39]
    ds_read_b128 v[176:179], v23 offset:53248
    s_add_u32 s70, s70, 22396928
    s_add_u32 s38, s38, s37
    v_mfma_f32_16x16x32_bf16 v[52:55], a[88:91], v[156:159], v[52:55]
    ds_read_b128 v[180:183], v23 offset:55296
    v_mfma_f32_16x16x32_bf16 v[40:43], a[72:75], v[160:163], v[40:43]
    buffer_load_dword v8, v13, s[24:27], s70 offen sc1
    s_add_u32 s53, s38, 13631488
    v_mfma_f32_16x16x32_bf16 v[56:59], a[88:91], v[160:163], v[56:59]
    buffer_load_dwordx4 a[132:135], v25, s[28:31], s73 offen sc1
    s_lshl2_add_u32 s38, s32, s34
    v_mfma_f32_16x16x32_bf16 v[44:47], a[72:75], v[164:167], v[44:47]
    buffer_load_dwordx4 a[148:151], v25, s[28:31], s74 offen sc1
    s_lshl_b32 s38, s38, 10
    v_xor_b32 v23, 0x10000, v23
    v_mfma_f32_16x16x32_bf16 v[60:63], a[88:91], v[164:167], v[60:63]
    s_waitcnt lgkmcnt(0) vmcnt(13)
    v_mfma_f32_16x16x32_bf16 v[32:35], a[76:79], v[168:171], v[32:35]
    ds_read_b128 v[152:155], v20 offset:0
    buffer_load_dwordx4 a[136:139], v26, s[28:31], s73 offen sc1
    s_add_u32 s55, s38, 22282240
    v_mfma_f32_16x16x32_bf16 v[48:51], a[92:95], v[168:171], v[48:51]
    ds_read_b128 v[156:159], v20 offset:2048
    buffer_load_dwordx4 a[152:155], v26, s[28:31], s74 offen sc1
    v_lshlrev_b32_e64 v7, 8, v2
    v_mfma_f32_16x16x32_bf16 v[36:39], a[76:79], v[172:175], v[36:39]
    ds_read_b128 v[160:163], v20 offset:4096
    s_getpc_b64 s[20:21]
K_PC3:
    s_mov_b32 s22, K_CODE_END-K_PC3
    s_lshl_b32 s38, s94, 16
    v_mfma_f32_16x16x32_bf16 v[52:55], a[92:95], v[172:175], v[52:55]
    ds_read_b128 v[164:167], v20 offset:6144
    s_bfe_u32 s3, s2, 0x20003
    v_mfma_f32_16x16x32_bf16 v[40:43], a[76:79], v[176:179], v[40:43]
    s_lshl2_add_u32 s3, s3, s34
    s_add_u32 s56, s38, s5
    v_mfma_f32_16x16x32_bf16 v[56:59], a[92:95], v[176:179], v[56:59]
    s_lshl_b32 s3, s3, 11
    v_lshlrev_b32 v12, 14, v2
    v_mfma_f32_16x16x32_bf16 v[44:47], a[76:79], v[180:183], v[44:47]
    v_lshl_add_u32 v28, v0, 5, s3
    v_lshl_add_u32 v12, v1, 4, v12
    v_mfma_f32_16x16x32_bf16 v[60:63], a[92:95], v[180:183], v[60:63]
    buffer_load_dword v11, v28, s[20:23], 0 offen
    s_waitcnt lgkmcnt(0) vmcnt(14)
    v_mfma_f32_16x16x32_bf16 v[32:35], a[96:99], v[152:155], v[32:35]
    ds_read_b128 v[168:171], v21 offset:0
    buffer_load_dwordx4 a[140:143], v27, s[28:31], s73 offen sc1
    s_lshl_b32 s38, s4, 6
    v_mfma_f32_16x16x32_bf16 v[48:51], a[112:115], v[152:155], v[48:51]
    ds_read_b128 v[172:175], v21 offset:2048
    s_add_u32 s58, s38, 22429696
    v_mfma_f32_16x16x32_bf16 v[36:39], a[96:99], v[156:159], v[36:39]
    ds_read_b128 v[176:179], v21 offset:4096
    s_add_u32 s57, s38, 22413312
    v_mfma_f32_16x16x32_bf16 v[52:55], a[112:115], v[156:159], v[52:55]
    ds_read_b128 v[180:183], v21 offset:6144
    v_mfma_f32_16x16x32_bf16 v[40:43], a[96:99], v[160:163], v[40:43]
    buffer_load_dwordx4 a[156:159], v27, s[28:31], s74 offen sc1
    v_lshl_add_u32 v5, v1, 6, s99
    v_mfma_f32_16x16x32_bf16 v[56:59], a[112:115], v[160:163], v[56:59]
    s_xor_b32 s38, s33, 264
    v_mfma_f32_16x16x32_bf16 v[44:47], a[96:99], v[164:167], v[44:47]
    s_lshl_b32 s38, s38, 6
    v_mfma_f32_16x16x32_bf16 v[60:63], a[112:115], v[164:167], v[60:63]
    s_waitcnt lgkmcnt(0) vmcnt(14)
    v_mfma_f32_16x16x32_bf16 v[32:35], a[100:103], v[168:171], v[32:35]
    ds_read_b128 v[152:155], v22 offset:0
    s_bfe_u32 s73, s97, 262168
    s_add_u32 s38, s38, s99
    v_mfma_f32_16x16x32_bf16 v[48:51], a[116:119], v[168:171], v[48:51]
    ds_read_b128 v[156:159], v22 offset:2048
    s_lshl_b32 s73, s73, 8
    v_mfma_f32_16x16x32_bf16 v[36:39], a[100:103], v[172:175], v[36:39]
    ds_read_b128 v[160:163], v22 offset:4096
    s_add_u32 s73, s73, s95
    v_mfma_f32_16x16x32_bf16 v[52:55], a[116:119], v[172:175], v[52:55]
    ds_read_b128 v[164:167], v22 offset:6144
    v_mfma_f32_16x16x32_bf16 v[40:43], a[100:103], v[176:179], v[40:43]
    s_add_u32 s74, s73, 0x20000
    v_mov_b32 v9, s38
    v_mfma_f32_16x16x32_bf16 v[56:59], a[116:119], v[176:179], v[56:59]
    buffer_load_dwordx4 a[160:163], v24, s[28:31], s73 offen sc1
    v_mfma_f32_16x16x32_bf16 v[44:47], a[100:103], v[180:183], v[44:47]
    buffer_load_dwordx4 a[176:179], v24, s[28:31], s74 offen sc1
    v_mfma_f32_16x16x32_bf16 v[60:63], a[116:119], v[180:183], v[60:63]
    s_waitcnt lgkmcnt(0) vmcnt(14)
    v_mfma_f32_16x16x32_bf16 v[32:35], a[104:107], v[152:155], v[32:35]
    ds_read_b128 v[168:171], v23 offset:0
    buffer_load_dwordx4 a[164:167], v25, s[28:31], s73 offen sc1
    v_mfma_f32_16x16x32_bf16 v[48:51], a[120:123], v[152:155], v[48:51]
    ds_read_b128 v[172:175], v23 offset:2048
    v_mfma_f32_16x16x32_bf16 v[36:39], a[104:107], v[156:159], v[36:39]
    ds_read_b128 v[176:179], v23 offset:4096
    v_mfma_f32_16x16x32_bf16 v[52:55], a[120:123], v[156:159], v[52:55]
    ds_read_b128 v[180:183], v23 offset:6144
    v_mfma_f32_16x16x32_bf16 v[40:43], a[104:107], v[160:163], v[40:43]
    buffer_load_dwordx4 a[180:183], v25, s[28:31], s74 offen sc1
    v_mfma_f32_16x16x32_bf16 v[56:59], a[120:123], v[160:163], v[56:59]
    v_mfma_f32_16x16x32_bf16 v[44:47], a[104:107], v[164:167], v[44:47]
    v_mfma_f32_16x16x32_bf16 v[60:63], a[120:123], v[164:167], v[60:63]
    s_waitcnt lgkmcnt(0) vmcnt(11)
    v_cmp_ne_u32 vcc, s35, v8
    s_nop 0
    s_cbranch_vccnz K_POLL4
K_POLL4_OK:
    s_barrier
    v_mfma_f32_16x16x32_bf16 v[32:35], a[108:111], v[168:171], v[32:35]
    ds_read_b128 v[152:155], v20 offset:16384
    s_lshl4_add_u32 s70, s4, s34
    s_lshl_b32 s70, s70, 10
    v_mfma_f32_16x16x32_bf16 v[48:51], a[124:127], v[168:171], v[48:51]
    ds_read_b128 v[156:159], v20 offset:18432
    s_add_u32 s70, s70, 9437184
    v_mfma_f32_16x16x32_bf16 v[36:39], a[108:111], v[172:175], v[36:39]
    ds_read_b128 v[160:163], v20 offset:20480
    buffer_load_dwordx4 v[184:187], v3, s[24:27], s70 offen sc1 nt
    s_add_u32 s70, s70, 4096
    v_mfma_f32_16x16x32_bf16 v[52:55], a[124:127], v[172:175], v[52:55]
    ds_read_b128 v[164:167], v20 offset:22528
    buffer_load_dwordx4 v[188:191], v3, s[24:27], s70 offen sc1 nt
    v_mfma_f32_16x16x32_bf16 v[40:43], a[108:111], v[176:179], v[40:43]
    s_add_u32 s70, s70, 4096
    buffer_load_dwordx4 v[192:195], v3, s[24:27], s70 offen sc1 nt
    v_mfma_f32_16x16x32_bf16 v[56:59], a[124:127], v[176:179], v[56:59]
    s_add_u32 s70, s70, 4096
    v_mfma_f32_16x16x32_bf16 v[44:47], a[108:111], v[180:183], v[44:47]
    buffer_load_dwordx4 v[196:199], v3, s[24:27], s70 offen sc1 nt
    buffer_load_dwordx4 a[168:171], v26, s[28:31], s73 offen sc1
    v_mfma_f32_16x16x32_bf16 v[60:63], a[124:127], v[180:183], v[60:63]
    buffer_load_dwordx4 a[184:187], v26, s[28:31], s74 offen sc1
    s_waitcnt lgkmcnt(0)
    v_mfma_f32_16x16x32_bf16 v[32:35], a[128:131], v[152:155], v[32:35]
    ds_read_b128 v[168:171], v21 offset:16384
    buffer_load_dwordx4 a[172:175], v27, s[28:31], s73 offen sc1
    v_mfma_f32_16x16x32_bf16 v[48:51], a[144:147], v[152:155], v[48:51]
    ds_read_b128 v[172:175], v21 offset:18432
    v_mfma_f32_16x16x32_bf16 v[36:39], a[128:131], v[156:159], v[36:39]
    ds_read_b128 v[176:179], v21 offset:20480
    v_mfma_f32_16x16x32_bf16 v[52:55], a[144:147], v[156:159], v[52:55]
    ds_read_b128 v[180:183], v21 offset:22528
    v_mfma_f32_16x16x32_bf16 v[40:43], a[128:131], v[160:163], v[40:43]
    buffer_load_dwordx4 a[188:191], v27, s[28:31], s74 offen sc1
    v_mfma_f32_16x16x32_bf16 v[56:59], a[144:147], v[160:163], v[56:59]
    v_mfma_f32_16x16x32_bf16 v[44:47], a[128:131], v[164:167], v[44:47]
    v_mfma_f32_16x16x32_bf16 v[60:63], a[144:147], v[164:167], v[60:63]
    s_waitcnt lgkmcnt(0) vmcnt(17)
    v_mfma_f32_16x16x32_bf16 v[32:35], a[132:135], v[168:171], v[32:35]
    ds_read_b128 v[152:155], v22 offset:16384
    s_bfe_u32 s73, s97, 262172
    v_mfma_f32_16x16x32_bf16 v[48:51], a[148:151], v[168:171], v[48:51]
    ds_read_b128 v[156:159], v22 offset:18432
    s_lshl_b32 s73, s73, 8
    v_mfma_f32_16x16x32_bf16 v[36:39], a[132:135], v[172:175], v[36:39]
    ds_read_b128 v[160:163], v22 offset:20480
    s_add_u32 s73, s73, s95
    v_mfma_f32_16x16x32_bf16 v[52:55], a[148:151], v[172:175], v[52:55]
    ds_read_b128 v[164:167], v22 offset:22528
    v_mfma_f32_16x16x32_bf16 v[40:43], a[132:135], v[176:179], v[40:43]
    s_add_u32 s74, s73, 0x20000
    v_mfma_f32_16x16x32_bf16 v[56:59], a[148:151], v[176:179], v[56:59]
    buffer_load_dwordx4 a[192:195], v24, s[28:31], s73 offen sc1
    v_mfma_f32_16x16x32_bf16 v[44:47], a[132:135], v[180:183], v[44:47]
    buffer_load_dwordx4 a[208:211], v24, s[28:31], s74 offen sc1
    v_mfma_f32_16x16x32_bf16 v[60:63], a[148:151], v[180:183], v[60:63]
    s_waitcnt lgkmcnt(0) vmcnt(17)
    v_mfma_f32_16x16x32_bf16 v[32:35], a[136:139], v[152:155], v[32:35]
    ds_read_b128 v[168:171], v23 offset:16384
    buffer_load_dwordx4 a[196:199], v25, s[28:31], s73 offen sc1
    v_mfma_f32_16x16x32_bf16 v[48:51], a[152:155], v[152:155], v[48:51]
    ds_read_b128 v[172:175], v23 offset:18432
    v_mfma_f32_16x16x32_bf16 v[36:39], a[136:139], v[156:159], v[36:39]
    ds_read_b128 v[176:179], v23 offset:20480
    v_mfma_f32_16x16x32_bf16 v[52:55], a[152:155], v[156:159], v[52:55]
    ds_read_b128 v[180:183], v23 offset:22528
    v_mfma_f32_16x16x32_bf16 v[40:43], a[136:139], v[160:163], v[40:43]
    buffer_load_dwordx4 a[212:215], v25, s[28:31], s74 offen sc1
    v_mfma_f32_16x16x32_bf16 v[56:59], a[152:155], v[160:163], v[56:59]
    v_mfma_f32_16x16x32_bf16 v[44:47], a[136:139], v[164:167], v[44:47]
    v_mfma_f32_16x16x32_bf16 v[60:63], a[152:155], v[164:167], v[60:63]
    s_waitcnt lgkmcnt(0) vmcnt(16)
    v_mfma_f32_16x16x32_bf16 v[32:35], a[140:143], v[168:171], v[32:35]
    ds_read_b128 v[152:155], v20 offset:32768
    buffer_load_dwordx4 a[200:203], v26, s[28:31], s73 offen sc1
    v_mfma_f32_16x16x32_bf16 v[48:51], a[156:159], v[168:171], v[48:51]
    ds_read_b128 v[156:159], v20 offset:34816
    v_mfma_f32_16x16x32_bf16 v[36:39], a[140:143], v[172:175], v[36:39]
    ds_read_b128 v[160:163], v20 offset:36864
    v_mfma_f32_16x16x32_bf16 v[52:55], a[156:159], v[172:175], v[52:55]
    ds_read_b128 v[164:167], v20 offset:38912
    v_mfma_f32_16x16x32_bf16 v[40:43], a[140:143], v[176:179], v[40:43]
    buffer_load_dwordx4 a[216:219], v26, s[28:31], s74 offen sc1
    v_mfma_f32_16x16x32_bf16 v[56:59], a[156:159], v[176:179], v[56:59]
    v_mfma_f32_16x16x32_bf16 v[44:47], a[140:143], v[180:183], v[44:47]
    v_mfma_f32_16x16x32_bf16 v[60:63], a[156:159], v[180:183], v[60:63]
    s_waitcnt lgkmcnt(0) vmcnt(16)
    v_mfma_f32_16x16x32_bf16 v[32:35], a[160:163], v[152:155], v[32:35]
    ds_read_b128 v[168:171], v21 offset:32768
    buffer_load_dwordx4 a[204:207], v27, s[28:31], s73 offen sc1
    v_mfma_f32_16x16x32_bf16 v[48:51], a[176:179], v[152:155], v[48:51]
    ds_read_b128 v[172:175], v21 offset:34816
    v_mfma_f32_16x16x32_bf16 v[36:39], a[160:163], v[156:159], v[36:39]
    ds_read_b128 v[176:179], v21 offset:36864
    v_mfma_f32_16x16x32_bf16 v[52:55], a[176:179], v[156:159], v[52:55]
    ds_read_b128 v[180:183], v21 offset:38912
    v_mfma_f32_16x16x32_bf16 v[40:43], a[160:163], v[160:163], v[40:43]
    s_waitcnt vmcnt(11)
    ds_write_b64 v132, v[184:185] offset:0
    ds_write_b64 v132, v[186:187] offset:2080
    buffer_load_dwordx4 a[220:223], v27, s[28:31], s74 offen sc1
    v_mfma_f32_16x16x32_bf16 v[56:59], a[176:179], v[160:163], v[56:59]
    ds_write_b64 v133, v[188:189] offset:512
    ds_write_b64 v133, v[190:191] offset:2592
    v_mfma_f32_16x16x32_bf16 v[44:47], a[160:163], v[164:167], v[44:47]
    v_mfma_f32_16x16x32_bf16 v[60:63], a[176:179], v[164:167], v[60:63]
    s_waitcnt lgkmcnt(4)
    v_mfma_f32_16x16x32_bf16 v[32:35], a[164:167], v[168:171], v[32:35]
    ds_read_b128 v[152:155], v22 offset:32768
    v_mfma_f32_16x16x32_bf16 v[48:51], a[180:183], v[168:171], v[48:51]
    ds_read_b128 v[156:159], v22 offset:34816
    v_mfma_f32_16x16x32_bf16 v[36:39], a[164:167], v[172:175], v[36:39]
    ds_read_b128 v[160:163], v22 offset:36864
    v_mfma_f32_16x16x32_bf16 v[52:55], a[180:183], v[172:175], v[52:55]
    ds_read_b128 v[164:167], v22 offset:38912
    v_mfma_f32_16x16x32_bf16 v[40:43], a[164:167], v[176:179], v[40:43]
    ds_write_b64 v133, v[192:193] offset:1024
    ds_write_b64 v133, v[194:195] offset:3104
    v_mfma_f32_16x16x32_bf16 v[56:59], a[180:183], v[176:179], v[56:59]
    ds_write_b64 v133, v[196:197] offset:1536
    ds_write_b64 v133, v[198:199] offset:3616
    v_mfma_f32_16x16x32_bf16 v[44:47], a[164:167], v[180:183], v[44:47]
    v_mfma_f32_16x16x32_bf16 v[60:63], a[180:183], v[180:183], v[60:63]
    s_waitcnt lgkmcnt(4) vmcnt(10)
    v_mfma_f32_16x16x32_bf16 v[32:35], a[168:171], v[152:155], v[32:35]
    ds_read_b128 v[168:171], v23 offset:32768
    s_bfe_u32 s72, s97, 262144
    v_mfma_f32_16x16x32_bf16 v[48:51], a[184:187], v[152:155], v[48:51]
    ds_read_b128 v[172:175], v23 offset:34816
    s_add_u32 m0, s37, 0
    v_mfma_f32_16x16x32_bf16 v[36:39], a[168:171], v[156:159], v[36:39]
    ds_read_b128 v[176:179], v23 offset:36864
    s_lshl_b32 s72, s72, 7
    v_mfma_f32_16x16x32_bf16 v[52:55], a[184:187], v[156:159], v[52:55]
    ds_read_b128 v[180:183], v23 offset:38912
    buffer_load_dwordx4 v16, s[16:19], s72 offen offset:0 nt lds
    v_mfma_f32_16x16x32_bf16 v[40:43], a[168:171], v[160:163], v[40:43]
    buffer_load_dwordx4 v17, s[16:19], s72 offen offset:1024 nt lds
    v_mfma_f32_16x16x32_bf16 v[56:59], a[184:187], v[160:163], v[56:59]
    buffer_load_dwordx4 v18, s[16:19], s72 offen offset:2048 nt lds
    v_mfma_f32_16x16x32_bf16 v[44:47], a[168:171], v[164:167], v[44:47]
    buffer_load_dwordx4 v19, s[16:19], s72 offen offset:3072 nt lds
    v_mfma_f32_16x16x32_bf16 v[60:63], a[184:187], v[164:167], v[60:63]
    s_waitcnt lgkmcnt(0)
    s_barrier
    s_waitcnt vmcnt(12)
    v_mfma_f32_16x16x32_bf16 v[32:35], a[172:175], v[168:171], v[32:35]
    ds_read2_b32 v[184:185], v130 offset0:0 offset1:32
    ds_read2_b32 v[186:187], v130 offset0:64 offset1:96
    v_mfma_f32_16x16x32_bf16 v[48:51], a[188:191], v[168:171], v[48:51]
    ds_read2_b32 v[188:189], v131 offset0:96 offset1:64
    v_mfma_f32_16x16x32_bf16 v[36:39], a[172:175], v[172:175], v[36:39]
    ds_read2_b32 v[190:191], v131 offset0:32 offset1:0
    v_mfma_f32_16x16x32_bf16 v[52:55], a[188:191], v[172:175], v[52:55]
    ds_read2_b32 v[192:193], v130 offset0:1 offset1:33
    ds_read2_b32 v[194:195], v130 offset0:65 offset1:97
    v_mfma_f32_16x16x32_bf16 v[40:43], a[172:175], v[176:179], v[40:43]
    ds_read2_b32 v[196:197], v131 offset0:97 offset1:65
    v_mfma_f32_16x16x32_bf16 v[56:59], a[188:191], v[176:179], v[56:59]
    ds_read2_b32 v[198:199], v131 offset0:33 offset1:1
    v_mfma_f32_16x16x32_bf16 v[44:47], a[172:175], v[180:183], v[44:47]
    v_mfma_f32_16x16x32_bf16 v[60:63], a[188:191], v[180:183], v[60:63]
    s_waitcnt lgkmcnt(4)
    v_mfma_f32_16x16x32_bf16 v[152:155], v[184:187], a[224:227], 0
    s_bfe_u32 s72, s97, 262148
    v_mfma_f32_16x16x32_bf16 v[156:159], v[184:187], a[228:231], 0
    s_add_u32 m0, s37, 16384
    v_mfma_f32_16x16x32_bf16 v[160:163], v[184:187], a[232:235], 0
    v_mfma_f32_16x16x32_bf16 v[164:167], v[184:187], a[236:239], 0
    s_lshl_b32 s72, s72, 7
    v_mfma_f32_16x16x32_bf16 v[152:155], v[188:191], a[224:227], v[152:155]
    v_mfma_f32_16x16x32_bf16 v[156:159], v[188:191], a[228:231], v[156:159]
    buffer_load_dwordx4 v16, s[16:19], s72 offen offset:0 nt lds
    v_mfma_f32_16x16x32_bf16 v[160:163], v[188:191], a[240:243], v[160:163]
    buffer_load_dwordx4 v17, s[16:19], s72 offen offset:1024 nt lds
    v_mfma_f32_16x16x32_bf16 v[164:167], v[188:191], a[244:247], v[164:167]
    s_waitcnt lgkmcnt(0)
    buffer_load_dwordx4 v18, s[16:19], s72 offen offset:2048 nt lds
    v_mfma_f32_16x16x32_bf16 v[168:171], v[192:195], a[224:227], 0
    v_mfma_f32_16x16x32_bf16 v[172:175], v[192:195], a[228:231], 0
    buffer_load_dwordx4 v19, s[16:19], s72 offen offset:3072 nt lds
    v_mfma_f32_16x16x32_bf16 v[176:179], v[192:195], a[232:235], 0
    v_mfma_f32_16x16x32_bf16 v[180:183], v[192:195], a[236:239], 0
    v_mfma_f32_16x16x32_bf16 v[168:171], v[196:199], a[224:227], v[168:171]
    v_mfma_f32_16x16x32_bf16 v[172:175], v[196:199], a[228:231], v[172:175]
    v_mfma_f32_16x16x32_bf16 v[176:179], v[196:199], a[240:243], v[176:179]
    v_mfma_f32_16x16x32_bf16 v[180:183], v[196:199], a[244:247], v[180:183]
    v_pk_mul_f32 v[134:135], v[152:153], v[96:97]
    v_pk_mul_f32 v[136:137], v[156:157], v[96:97]
    v_pk_fma_f32 v[134:135], v[156:157], v[104:105], v[134:135]
    v_pk_fma_f32 v[136:137], v[152:153], v[104:105], v[136:137] neg_lo:[1,0,0] neg_hi:[1,0,0]
    v_pk_mul_f32 v[138:139], v[154:155], v[98:99]
    v_pk_mul_f32 v[140:141], v[158:159], v[98:99]
    v_pk_fma_f32 v[138:139], v[158:159], v[106:107], v[138:139]
    v_pk_fma_f32 v[140:141], v[154:155], v[106:107], v[140:141] neg_lo:[1,0,0] neg_hi:[1,0,0]
    v_cvt_pk_bf16_f32 v184, v134, v136
    v_cvt_pk_bf16_f32 v185, v135, v137
    v_cvt_pk_bf16_f32 v186, v138, v140
    v_cvt_pk_bf16_f32 v187, v139, v141
    v_pk_mul_f32 v[134:135], v[160:161], v[100:101]
    v_pk_mul_f32 v[136:137], v[164:165], v[100:101]
    v_pk_fma_f32 v[134:135], v[164:165], v[108:109], v[134:135]
    v_pk_fma_f32 v[136:137], v[160:161], v[108:109], v[136:137] neg_lo:[1,0,0] neg_hi:[1,0,0]
    v_pk_mul_f32 v[138:139], v[162:163], v[102:103]
    v_pk_mul_f32 v[140:141], v[166:167], v[102:103]
    v_pk_fma_f32 v[138:139], v[166:167], v[110:111], v[138:139]
    v_pk_fma_f32 v[140:141], v[162:163], v[110:111], v[140:141] neg_lo:[1,0,0] neg_hi:[1,0,0]
    s_bfe_u32 s72, s97, 262152
    s_add_u32 m0, s37, 32768
    s_lshl_b32 s72, s72, 7
    s_nop 0
    buffer_load_dwordx4 v16, s[16:19], s72 offen offset:0 nt lds
    buffer_load_dwordx4 v17, s[16:19], s72 offen offset:1024 nt lds
    buffer_load_dwordx4 v18, s[16:19], s72 offen offset:2048 nt lds
    buffer_load_dwordx4 v19, s[16:19], s72 offen offset:3072 nt lds
    v_cvt_pk_bf16_f32 v188, v134, v136
    v_cvt_pk_bf16_f32 v189, v135, v137
    v_cvt_pk_bf16_f32 v190, v138, v140
    v_cvt_pk_bf16_f32 v191, v139, v141
    v_pk_mul_f32 v[134:135], v[168:169], v[96:97]
    v_pk_mul_f32 v[136:137], v[172:173], v[96:97]
    v_pk_fma_f32 v[134:135], v[172:173], v[104:105], v[134:135]
    v_pk_fma_f32 v[136:137], v[168:169], v[104:105], v[136:137] neg_lo:[1,0,0] neg_hi:[1,0,0]
    v_pk_mul_f32 v[138:139], v[170:171], v[98:99]
    v_pk_mul_f32 v[140:141], v[174:175], v[98:99]
    v_pk_fma_f32 v[138:139], v[174:175], v[106:107], v[138:139]
    v_pk_fma_f32 v[140:141], v[170:171], v[106:107], v[140:141] neg_lo:[1,0,0] neg_hi:[1,0,0]
    v_cvt_pk_bf16_f32 v192, v134, v136
    v_cvt_pk_bf16_f32 v193, v135, v137
    v_cvt_pk_bf16_f32 v194, v138, v140
    v_cvt_pk_bf16_f32 v195, v139, v141
    v_pk_mul_f32 v[134:135], v[176:177], v[100:101]
    v_pk_mul_f32 v[136:137], v[180:181], v[100:101]
    v_pk_fma_f32 v[134:135], v[180:181], v[108:109], v[134:135]
    v_pk_fma_f32 v[136:137], v[176:177], v[108:109], v[136:137] neg_lo:[1,0,0] neg_hi:[1,0,0]
    v_pk_mul_f32 v[138:139], v[178:179], v[102:103]
    v_pk_mul_f32 v[140:141], v[182:183], v[102:103]
    v_pk_fma_f32 v[138:139], v[182:183], v[110:111], v[138:139]
    v_pk_fma_f32 v[140:141], v[178:179], v[110:111], v[140:141] neg_lo:[1,0,0] neg_hi:[1,0,0]
    v_cvt_pk_bf16_f32 v196, v134, v136
    v_cvt_pk_bf16_f32 v197, v135, v137
    v_cvt_pk_bf16_f32 v198, v138, v140
    v_cvt_pk_bf16_f32 v199, v139, v141
    v_mfma_f32_16x16x32_bf16 v[152:155], a[224:227], v[184:187], 0
    s_bfe_u32 s72, s97, 262156
    v_mfma_f32_16x16x32_bf16 v[156:159], a[228:231], v[184:187], 0
    s_add_u32 m0, s37, 49152
    v_mfma_f32_16x16x32_bf16 v[160:163], a[224:227], v[188:191], 0
    s_lshl_b32 s72, s72, 7
    s_nop 0
    v_mfma_f32_16x16x32_bf16 v[164:167], a[228:231], v[188:191], 0
    buffer_load_dwordx4 v16, s[16:19], s72 offen offset:0 nt lds
    v_mfma_f32_16x16x32_bf16 v[168:171], a[224:227], v[192:195], 0
    buffer_load_dwordx4 v17, s[16:19], s72 offen offset:1024 nt lds
    v_mfma_f32_16x16x32_bf16 v[172:175], a[228:231], v[192:195], 0
    buffer_load_dwordx4 v18, s[16:19], s72 offen offset:2048 nt lds
    v_mfma_f32_16x16x32_bf16 v[176:179], a[224:227], v[196:199], 0
    buffer_load_dwordx4 v19, s[16:19], s72 offen offset:3072 nt lds
    v_mfma_f32_16x16x32_bf16 v[180:183], a[228:231], v[196:199], 0
    v_pk_fma_f32 v[216:217], v[152:153], v[128:129], v[216:217] op_sel_hi:[1,0,1]
    v_pk_fma_f32 v[218:219], v[154:155], v[128:129], v[218:219] op_sel_hi:[1,0,1]
    v_pk_fma_f32 v[220:221], v[156:157], v[128:129], v[220:221] op_sel_hi:[1,0,1] neg_lo:[1,0,0] neg_hi:[1,0,0]
    v_pk_fma_f32 v[222:223], v[158:159], v[128:129], v[222:223] op_sel_hi:[1,0,1] neg_lo:[1,0,0] neg_hi:[1,0,0]
    v_pk_fma_f32 v[224:225], v[160:161], v[128:129], v[224:225] op_sel_hi:[1,0,1]
    v_pk_fma_f32 v[226:227], v[162:163], v[128:129], v[226:227] op_sel_hi:[1,0,1]
    v_pk_fma_f32 v[228:229], v[164:165], v[128:129], v[228:229] op_sel_hi:[1,0,1] neg_lo:[1,0,0] neg_hi:[1,0,0]
    v_pk_fma_f32 v[230:231], v[166:167], v[128:129], v[230:231] op_sel_hi:[1,0,1] neg_lo:[1,0,0] neg_hi:[1,0,0]
    v_pk_fma_f32 v[232:233], v[168:169], v[128:129], v[232:233] op_sel:[0,1,0]
    v_pk_fma_f32 v[234:235], v[170:171], v[128:129], v[234:235] op_sel:[0,1,0]
    v_pk_fma_f32 v[236:237], v[172:173], v[128:129], v[236:237] op_sel:[0,1,0] neg_lo:[1,0,0] neg_hi:[1,0,0]
    v_pk_fma_f32 v[238:239], v[174:175], v[128:129], v[238:239] op_sel:[0,1,0] neg_lo:[1,0,0] neg_hi:[1,0,0]
    v_pk_fma_f32 v[240:241], v[176:177], v[128:129], v[240:241] op_sel:[0,1,0]
    v_pk_fma_f32 v[242:243], v[178:179], v[128:129], v[242:243] op_sel:[0,1,0]
    v_pk_fma_f32 v[244:245], v[180:181], v[128:129], v[244:245] op_sel:[0,1,0] neg_lo:[1,0,0] neg_hi:[1,0,0]
    v_pk_fma_f32 v[246:247], v[182:183], v[128:129], v[246:247] op_sel:[0,1,0] neg_lo:[1,0,0] neg_hi:[1,0,0]
    s_bfe_u32 s72, s97, 262160
    s_add_u32 m0, s37, 65536
    s_lshl_b32 s72, s72, 7
    s_nop 0
    buffer_load_dwordx4 v16, s[16:19], s72 offen offset:0 nt lds
    buffer_load_dwordx4 v17, s[16:19], s72 offen offset:1024 nt lds
    buffer_load_dwordx4 v18, s[16:19], s72 offen offset:2048 nt lds
    buffer_load_dwordx4 v19, s[16:19], s72 offen offset:3072 nt lds
    ds_read_b128 v[152:155], v20 offset:49152
    ds_read_b128 v[156:159], v20 offset:51200
    ds_read_b128 v[160:163], v20 offset:53248
    ds_read_b128 v[164:167], v20 offset:55296
    v_cvt_pk_bf16_f32 v184, v216, v220
    v_cvt_pk_bf16_f32 v185, v224, v228
    v_cvt_pk_bf16_f32 v186, v232, v236
    v_cvt_pk_bf16_f32 v187, v240, v244
    v_cvt_pk_bf16_f32 v188, v217, v221
    v_cvt_pk_bf16_f32 v189, v225, v229
    v_cvt_pk_bf16_f32 v190, v233, v237
    v_cvt_pk_bf16_f32 v191, v241, v245
    v_cvt_pk_bf16_f32 v192, v218, v222
    v_cvt_pk_bf16_f32 v193, v226, v230
    v_cvt_pk_bf16_f32 v194, v234, v238
    v_cvt_pk_bf16_f32 v195, v242, v246
    v_cvt_pk_bf16_f32 v196, v219, v223
    v_cvt_pk_bf16_f32 v197, v227, v231
    v_cvt_pk_bf16_f32 v198, v235, v239
    v_cvt_pk_bf16_f32 v199, v243, v247
    buffer_store_dwordx4 v[184:187], v4, s[24:27], s75 offen sc1
    s_add_u32 s75, s75, 16384
    buffer_store_dwordx4 v[188:191], v4, s[24:27], s75 offen sc1
    v_xor_b32 v20, 0x10000, v20
    s_waitcnt lgkmcnt(0) vmcnt(28)
    v_mfma_f32_16x16x32_bf16 v[32:35], a[192:195], v[152:155], v[32:35]
    ds_read_b128 v[168:171], v21 offset:49152
    s_add_u32 s75, s75, 16384
    v_mfma_f32_16x16x32_bf16 v[48:51], a[208:211], v[152:155], v[48:51]
    ds_read_b128 v[172:175], v21 offset:51200
    buffer_store_dwordx4 v[192:195], v4, s[24:27], s75 offen sc1
    v_mfma_f32_16x16x32_bf16 v[36:39], a[192:195], v[156:159], v[36:39]
    ds_read_b128 v[176:179], v21 offset:53248
    s_add_u32 s75, s75, 16384
    v_mfma_f32_16x16x32_bf16 v[52:55], a[208:211], v[156:159], v[52:55]
    ds_read_b128 v[180:183], v21 offset:55296
    v_mfma_f32_16x16x32_bf16 v[40:43], a[192:195], v[160:163], v[40:43]
    buffer_store_dwordx4 v[196:199], v4, s[24:27], s75 offen sc1
    v_mfma_f32_16x16x32_bf16 v[56:59], a[208:211], v[160:163], v[56:59]
    s_lshl_b32 s70, s32, 10
    v_mfma_f32_16x16x32_bf16 v[44:47], a[192:195], v[164:167], v[44:47]
    s_add_u32 s70, s70, 22413312
    v_xor_b32 v21, 0x10000, v21
    v_mfma_f32_16x16x32_bf16 v[60:63], a[208:211], v[164:167], v[60:63]
    s_waitcnt lgkmcnt(0) vmcnt(28)
    v_mfma_f32_16x16x32_bf16 v[32:35], a[196:199], v[168:171], v[32:35]
    ds_read_b128 v[152:155], v22 offset:49152
    v_mfma_f32_16x16x32_bf16 v[48:51], a[212:215], v[168:171], v[48:51]
    ds_read_b128 v[156:159], v22 offset:51200
    v_mfma_f32_16x16x32_bf16 v[36:39], a[196:199], v[172:175], v[36:39]
    ds_read_b128 v[160:163], v22 offset:53248
    v_mfma_f32_16x16x32_bf16 v[52:55], a[212:215], v[172:175], v[52:55]
    ds_read_b128 v[164:167], v22 offset:55296
    v_mfma_f32_16x16x32_bf16 v[40:43], a[196:199], v[176:179], v[40:43]
    v_mfma_f32_16x16x32_bf16 v[56:59], a[212:215], v[176:179], v[56:59]
    v_mfma_f32_16x16x32_bf16 v[44:47], a[196:199], v[180:183], v[44:47]
    v_xor_b32 v22, 0x10000, v22
    v_mfma_f32_16x16x32_bf16 v[60:63], a[212:215], v[180:183], v[60:63]
    s_waitcnt lgkmcnt(0) vmcnt(26)
    v_mfma_f32_16x16x32_bf16 v[32:35], a[200:203], v[152:155], v[32:35]
    ds_read_b128 v[168:171], v23 offset:49152
    v_mfma_f32_16x16x32_bf16 v[48:51], a[216:219], v[152:155], v[48:51]
    ds_read_b128 v[172:175], v23 offset:51200
    v_mfma_f32_16x16x32_bf16 v[36:39], a[200:203], v[156:159], v[36:39]
    ds_read_b128 v[176:179], v23 offset:53248
    v_mfma_f32_16x16x32_bf16 v[52:55], a[216:219], v[156:159], v[52:55]
    ds_read_b128 v[180:183], v23 offset:55296
    v_mfma_f32_16x16x32_bf16 v[40:43], a[200:203], v[160:163], v[40:43]
    v_mfma_f32_16x16x32_bf16 v[56:59], a[216:219], v[160:163], v[56:59]
    v_mfma_f32_16x16x32_bf16 v[44:47], a[200:203], v[164:167], v[44:47]
    v_xor_b32 v23, 0x10000, v23
    v_mfma_f32_16x16x32_bf16 v[60:63], a[216:219], v[164:167], v[60:63]
    s_waitcnt lgkmcnt(0) vmcnt(20)
    s_barrier
    v_mfma_f32_16x16x32_bf16 v[32:35], a[204:207], v[168:171], v[32:35]
    ds_read_b128 v[152:155], v20 offset:0
    v_mfma_f32_16x16x32_bf16 v[48:51], a[220:223], v[168:171], v[48:51]
    ds_read_b128 v[156:159], v20 offset:2048
    v_mfma_f32_16x16x32_bf16 v[36:39], a[204:207], v[172:175], v[36:39]
    ds_read_b128 v[160:163], v20 offset:4096
    v_mfma_f32_16x16x32_bf16 v[52:55], a[220:223], v[172:175], v[52:55]
    ds_read_b128 v[164:167], v20 offset:6144
    v_mfma_f32_16x16x32_bf16 v[40:43], a[204:207], v[176:179], v[40:43]
    v_mfma_f32_16x16x32_bf16 v[56:59], a[220:223], v[176:179], v[56:59]
    v_mfma_f32_16x16x32_bf16 v[44:47], a[204:207], v[180:183], v[44:47]
    v_mfma_f32_16x16x32_bf16 v[60:63], a[220:223], v[180:183], v[60:63]
    s_waitcnt lgkmcnt(0)
    v_mfma_f32_16x16x32_bf16 v[216:219], v[64:67], v[152:155], 0
    ds_read_b128 v[168:171], v21 offset:0
    v_mfma_f32_16x16x32_bf16 v[232:235], v[80:83], v[152:155], 0
    ds_read_b128 v[172:175], v21 offset:2048
    v_mfma_f32_16x16x32_bf16 v[220:223], v[64:67], v[156:159], 0
    ds_read_b128 v[176:179], v21 offset:4096
    v_cvt_pk_bf16_f32 v200, v32, v36
    v_cvt_pk_bf16_f32 v201, v40, v44
    v_mfma_f32_16x16x32_bf16 v[236:239], v[80:83], v[156:159], 0
    ds_read_b128 v[180:183], v21 offset:6144
    v_cvt_pk_bf16_f32 v202, v48, v52
    v_mfma_f32_16x16x32_bf16 v[224:227], v[64:67], v[160:163], 0
    v_cvt_pk_bf16_f32 v203, v56, v60
    v_mfma_f32_16x16x32_bf16 v[240:243], v[80:83], v[160:163], 0
    v_cvt_pk_bf16_f32 v204, v33, v37
    v_cvt_pk_bf16_f32 v205, v41, v45
    v_mfma_f32_16x16x32_bf16 v[228:231], v[64:67], v[164:167], 0
    v_cvt_pk_bf16_f32 v206, v49, v53
    v_mfma_f32_16x16x32_bf16 v[244:247], v[80:83], v[164:167], 0
    v_cvt_pk_bf16_f32 v207, v57, v61
    s_waitcnt lgkmcnt(0)
    v_mfma_f32_16x16x32_bf16 v[216:219], v[68:71], v[168:171], v[216:219]
    ds_read_b128 v[152:155], v22 offset:0
    buffer_store_dwordx4 v[200:203], v3, s[24:27], s52 offen offset:0 sc1
    v_cvt_pk_bf16_f32 v208, v34, v38
    v_mfma_f32_16x16x32_bf16 v[232:235], v[84:87], v[168:171], v[232:235]
    ds_read_b128 v[156:159], v22 offset:2048
    v_cvt_pk_bf16_f32 v209, v42, v46
    v_mfma_f32_16x16x32_bf16 v[220:223], v[68:71], v[172:175], v[220:223]
    ds_read_b128 v[160:163], v22 offset:4096
    v_cvt_pk_bf16_f32 v210, v50, v54
    v_mfma_f32_16x16x32_bf16 v[236:239], v[84:87], v[172:175], v[236:239]
    ds_read_b128 v[164:167], v22 offset:6144
    v_cvt_pk_bf16_f32 v211, v58, v62
    v_mfma_f32_16x16x32_bf16 v[224:227], v[68:71], v[176:179], v[224:227]
    buffer_store_dwordx4 v[204:207], v3, s[24:27], s52 offen offset:1024 sc1
    v_cvt_pk_bf16_f32 v212, v35, v39
    v_mfma_f32_16x16x32_bf16 v[240:243], v[84:87], v[176:179], v[240:243]
    v_cvt_pk_bf16_f32 v213, v43, v47
    v_mfma_f32_16x16x32_bf16 v[228:231], v[68:71], v[180:183], v[228:231]
    v_cvt_pk_bf16_f32 v214, v51, v55
    v_mfma_f32_16x16x32_bf16 v[244:247], v[84:87], v[180:183], v[244:247]
    v_cvt_pk_bf16_f32 v215, v59, v63
    s_waitcnt lgkmcnt(0)
    v_mfma_f32_16x16x32_bf16 v[216:219], v[72:75], v[152:155], v[216:219]
    ds_read_b128 v[168:171], v23 offset:0
    buffer_store_dwordx4 v[208:211], v3, s[24:27], s52 offen offset:2048 sc1
    v_mfma_f32_16x16x32_bf16 v[232:235], v[88:91], v[152:155], v[232:235]
    ds_read_b128 v[172:175], v23 offset:2048
    v_mfma_f32_16x16x32_bf16 v[220:223], v[72:75], v[156:159], v[220:223]
    ds_read_b128 v[176:179], v23 offset:4096
    v_mfma_f32_16x16x32_bf16 v[236:239], v[88:91], v[156:159], v[236:239]
    ds_read_b128 v[180:183], v23 offset:6144
    v_mfma_f32_16x16x32_bf16 v[224:227], v[72:75], v[160:163], v[224:227]
    buffer_store_dwordx4 v[212:215], v3, s[24:27], s52 offen offset:3072 sc1
    v_mfma_f32_16x16x32_bf16 v[240:243], v[88:91], v[160:163], v[240:243]
    v_mfma_f32_16x16x32_bf16 v[228:231], v[72:75], v[164:167], v[228:231]
    v_mfma_f32_16x16x32_bf16 v[244:247], v[88:91], v[164:167], v[244:247]
    s_waitcnt lgkmcnt(0) vmcnt(20)
    s_barrier
    v_mfma_f32_16x16x32_bf16 v[216:219], v[76:79], v[168:171], v[216:219]
    ds_read_b128 v[152:155], v20 offset:16384
    v_mfma_f32_16x16x32_bf16 v[232:235], v[92:95], v[168:171], v[232:235]
    ds_read_b128 v[156:159], v20 offset:18432
    v_mfma_f32_16x16x32_bf16 v[220:223], v[76:79], v[172:175], v[220:223]
    ds_read_b128 v[160:163], v20 offset:20480
    v_mfma_f32_16x16x32_bf16 v[236:239], v[92:95], v[172:175], v[236:239]
    ds_read_b128 v[164:167], v20 offset:22528
    v_mfma_f32_16x16x32_bf16 v[224:227], v[76:79], v[176:179], v[224:227]
    v_mfma_f32_16x16x32_bf16 v[240:243], v[92:95], v[176:179], v[240:243]
    v_mfma_f32_16x16x32_bf16 v[228:231], v[76:79], v[180:183], v[228:231]
    v_mfma_f32_16x16x32_bf16 v[244:247], v[92:95], v[180:183], v[244:247]
    s_waitcnt lgkmcnt(0)
    v_mfma_f32_16x16x32_bf16 v[216:219], a[0:3], v[152:155], v[216:219]
    ds_read_b128 v[168:171], v21 offset:16384
    v_mfma_f32_16x16x32_bf16 v[232:235], a[16:19], v[152:155], v[232:235]
    ds_read_b128 v[172:175], v21 offset:18432
    v_mfma_f32_16x16x32_bf16 v[220:223], a[0:3], v[156:159], v[220:223]
    ds_read_b128 v[176:179], v21 offset:20480
    v_mfma_f32_16x16x32_bf16 v[236:239], a[16:19], v[156:159], v[236:239]
    ds_read_b128 v[180:183], v21 offset:22528
    v_mfma_f32_16x16x32_bf16 v[224:227], a[0:3], v[160:163], v[224:227]
    v_mfma_f32_16x16x32_bf16 v[240:243], a[16:19], v[160:163], v[240:243]
    v_mfma_f32_16x16x32_bf16 v[228:231], a[0:3], v[164:167], v[228:231]
    v_mfma_f32_16x16x32_bf16 v[244:247], a[16:19], v[164:167], v[244:247]
    s_waitcnt lgkmcnt(0)
    v_mfma_f32_16x16x32_bf16 v[216:219], a[4:7], v[168:171], v[216:219]
    ds_read_b128 v[152:155], v22 offset:16384
    v_mfma_f32_16x16x32_bf16 v[232:235], a[20:23], v[168:171], v[232:235]
    ds_read_b128 v[156:159], v22 offset:18432
    v_mfma_f32_16x16x32_bf16 v[220:223], a[4:7], v[172:175], v[220:223]
    ds_read_b128 v[160:163], v22 offset:20480
    v_mfma_f32_16x16x32_bf16 v[236:239], a[20:23], v[172:175], v[236:239]
    ds_read_b128 v[164:167], v22 offset:22528
    v_mfma_f32_16x16x32_bf16 v[224:227], a[4:7], v[176:179], v[224:227]
    v_mfma_f32_16x16x32_bf16 v[240:243], a[20:23], v[176:179], v[240:243]
    v_mfma_f32_16x16x32_bf16 v[228:231], a[4:7], v[180:183], v[228:231]
    v_mfma_f32_16x16x32_bf16 v[244:247], a[20:23], v[180:183], v[244:247]
    s_waitcnt lgkmcnt(0)
    v_mfma_f32_16x16x32_bf16 v[216:219], a[8:11], v[152:155], v[216:219]
    ds_read_b128 v[168:171], v23 offset:16384
    v_mfma_f32_16x16x32_bf16 v[232:235], a[24:27], v[152:155], v[232:235]
    ds_read_b128 v[172:175], v23 offset:18432
    v_mfma_f32_16x16x32_bf16 v[220:223], a[8:11], v[156:159], v[220:223]
    ds_read_b128 v[176:179], v23 offset:20480
    v_mfma_f32_16x16x32_bf16 v[236:239], a[24:27], v[156:159], v[236:239]
    ds_read_b128 v[180:183], v23 offset:22528
    v_mfma_f32_16x16x32_bf16 v[224:227], a[8:11], v[160:163], v[224:227]
    v_mfma_f32_16x16x32_bf16 v[240:243], a[24:27], v[160:163], v[240:243]
    v_mfma_f32_16x16x32_bf16 v[228:231], a[8:11], v[164:167], v[228:231]
    v_mfma_f32_16x16x32_bf16 v[244:247], a[24:27], v[164:167], v[244:247]
    s_waitcnt lgkmcnt(0) vmcnt(8)
    s_barrier
    v_mfma_f32_16x16x32_bf16 v[216:219], a[12:15], v[168:171], v[216:219]
    ds_read_b128 v[152:155], v20 offset:32768
    v_mfma_f32_16x16x32_bf16 v[232:235], a[28:31], v[168:171], v[232:235]
    ds_read_b128 v[156:159], v20 offset:34816
    v_mfma_f32_16x16x32_bf16 v[220:223], a[12:15], v[172:175], v[220:223]
    ds_read_b128 v[160:163], v20 offset:36864
    v_mfma_f32_16x16x32_bf16 v[236:239], a[28:31], v[172:175], v[236:239]
    ds_read_b128 v[164:167], v20 offset:38912
    v_mfma_f32_16x16x32_bf16 v[224:227], a[12:15], v[176:179], v[224:227]
    v_mfma_f32_16x16x32_bf16 v[240:243], a[28:31], v[176:179], v[240:243]
    v_mfma_f32_16x16x32_bf16 v[228:231], a[12:15], v[180:183], v[228:231]
    v_mfma_f32_16x16x32_bf16 v[244:247], a[28:31], v[180:183], v[244:247]
    s_waitcnt lgkmcnt(0)
    v_mfma_f32_16x16x32_bf16 v[216:219], a[32:35], v[152:155], v[216:219]
    ds_read_b128 v[168:171], v21 offset:32768
    v_mfma_f32_16x16x32_bf16 v[232:235], a[48:51], v[152:155], v[232:235]
    ds_read_b128 v[172:175], v21 offset:34816
    v_mfma_f32_16x16x32_bf16 v[220:223], a[32:35], v[156:159], v[220:223]
    ds_read_b128 v[176:179], v21 offset:36864
    v_mfma_f32_16x16x32_bf16 v[236:239], a[48:51], v[156:159], v[236:239]
    ds_read_b128 v[180:183], v21 offset:38912
    v_mfma_f32_16x16x32_bf16 v[224:227], a[32:35], v[160:163], v[224:227]
    v_mfma_f32_16x16x32_bf16 v[240:243], a[48:51], v[160:163], v[240:243]
    v_mfma_f32_16x16x32_bf16 v[228:231], a[32:35], v[164:167], v[228:231]
    v_mfma_f32_16x16x32_bf16 v[244:247], a[48:51], v[164:167], v[244:247]
    s_waitcnt lgkmcnt(0) vmcnt(4)
    s_barrier
    v_mfma_f32_16x16x32_bf16 v[216:219], a[36:39], v[168:171], v[216:219]
    ds_read_b128 v[152:155], v22 offset:32768
    v_mov_b32 v28, s35
    v_mfma_f32_16x16x32_bf16 v[232:235], a[52:55], v[168:171], v[232:235]
    ds_read_b128 v[156:159], v22 offset:34816
    v_mfma_f32_16x16x32_bf16 v[220:223], a[36:39], v[172:175], v[220:223]
    ds_read_b128 v[160:163], v22 offset:36864
    v_mfma_f32_16x16x32_bf16 v[236:239], a[52:55], v[172:175], v[236:239]
    ds_read_b128 v[164:167], v22 offset:38912
    v_mfma_f32_16x16x32_bf16 v[224:227], a[36:39], v[176:179], v[224:227]
    buffer_store_dword v28, v30, s[24:27], s57 offen sc1
    v_mfma_f32_16x16x32_bf16 v[240:243], a[52:55], v[176:179], v[240:243]
    v_mfma_f32_16x16x32_bf16 v[228:231], a[36:39], v[180:183], v[228:231]
    v_mfma_f32_16x16x32_bf16 v[244:247], a[52:55], v[180:183], v[244:247]
    s_waitcnt lgkmcnt(0)
    v_mfma_f32_16x16x32_bf16 v[216:219], a[40:43], v[152:155], v[216:219]
    ds_read_b128 v[168:171], v23 offset:32768
    v_mfma_f32_16x16x32_bf16 v[232:235], a[56:59], v[152:155], v[232:235]
    ds_read_b128 v[172:175], v23 offset:34816
    v_mfma_f32_16x16x32_bf16 v[220:223], a[40:43], v[156:159], v[220:223]
    ds_read_b128 v[176:179], v23 offset:36864
    v_mfma_f32_16x16x32_bf16 v[236:239], a[56:59], v[156:159], v[236:239]
    ds_read_b128 v[180:183], v23 offset:38912
    v_mfma_f32_16x16x32_bf16 v[224:227], a[40:43], v[160:163], v[224:227]
    v_mfma_f32_16x16x32_bf16 v[240:243], a[56:59], v[160:163], v[240:243]
    v_mfma_f32_16x16x32_bf16 v[228:231], a[40:43], v[164:167], v[228:231]
    v_mfma_f32_16x16x32_bf16 v[244:247], a[56:59], v[164:167], v[244:247]
    s_waitcnt lgkmcnt(0)
    v_mfma_f32_16x16x32_bf16 v[216:219], a[44:47], v[168:171], v[216:219]
    ds_read_b128 v[152:155], v20 offset:49152
    v_mfma_f32_16x16x32_bf16 v[232:235], a[60:63], v[168:171], v[232:235]
    ds_read_b128 v[156:159], v20 offset:51200
    v_mfma_f32_16x16x32_bf16 v[220:223], a[44:47], v[172:175], v[220:223]
    ds_read_b128 v[160:163], v20 offset:53248
    v_mfma_f32_16x16x32_bf16 v[236:239], a[60:63], v[172:175], v[236:239]
    ds_read_b128 v[164:167], v20 offset:55296
    v_mfma_f32_16x16x32_bf16 v[224:227], a[44:47], v[176:179], v[224:227]
    v_mfma_f32_16x16x32_bf16 v[240:243], a[60:63], v[176:179], v[240:243]
    v_mfma_f32_16x16x32_bf16 v[228:231], a[44:47], v[180:183], v[228:231]
    v_xor_b32 v20, 0x10000, v20
    v_mfma_f32_16x16x32_bf16 v[244:247], a[60:63], v[180:183], v[244:247]
    s_waitcnt lgkmcnt(0)
    v_mfma_f32_16x16x32_bf16 v[216:219], a[64:67], v[152:155], v[216:219]
    ds_read_b128 v[168:171], v21 offset:49152
    s_bfe_u32 s72, s97, 262164
    v_mfma_f32_16x16x32_bf16 v[232:235], a[80:83], v[152:155], v[232:235]
    ds_read_b128 v[172:175], v21 offset:51200
    s_add_u32 m0, s37, 81920
    v_mfma_f32_16x16x32_bf16 v[220:223], a[64:67], v[156:159], v[220:223]
    ds_read_b128 v[176:179], v21 offset:53248
    s_lshl_b32 s72, s72, 7
    v_mfma_f32_16x16x32_bf16 v[236:239], a[80:83], v[156:159], v[236:239]
    ds_read_b128 v[180:183], v21 offset:55296
    buffer_load_dwordx4 v16, s[16:19], s72 offen offset:0 nt lds
    v_mfma_f32_16x16x32_bf16 v[224:227], a[64:67], v[160:163], v[224:227]
    buffer_load_dwordx4 v17, s[16:19], s72 offen offset:1024 nt lds
    v_mfma_f32_16x16x32_bf16 v[240:243], a[80:83], v[160:163], v[240:243]
    buffer_load_dwordx4 v18, s[16:19], s72 offen offset:2048 nt lds
    v_mfma_f32_16x16x32_bf16 v[228:231], a[64:67], v[164:167], v[228:231]
    buffer_load_dwordx4 v19, s[16:19], s72 offen offset:3072 nt lds
    v_xor_b32 v21, 0x10000, v21
    v_mfma_f32_16x16x32_bf16 v[244:247], a[80:83], v[164:167], v[244:247]
    s_waitcnt lgkmcnt(0) vmcnt(5)
    s_barrier
    v_mfma_f32_16x16x32_bf16 v[216:219], a[68:71], v[168:171], v[216:219]
    ds_read_b128 v[152:155], v22 offset:49152
    v_mov_b32_e64 v28, s35
    v_mfma_f32_16x16x32_bf16 v[232:235], a[84:87], v[168:171], v[232:235]
    ds_read_b128 v[156:159], v22 offset:51200
    v_mfma_f32_16x16x32_bf16 v[220:223], a[68:71], v[172:175], v[220:223]
    ds_read_b128 v[160:163], v22 offset:53248
    v_mfma_f32_16x16x32_bf16 v[236:239], a[84:87], v[172:175], v[236:239]
    ds_read_b128 v[164:167], v22 offset:55296
    v_mfma_f32_16x16x32_bf16 v[224:227], a[68:71], v[176:179], v[224:227]
    buffer_store_dword v28, v30, s[24:27], s58 offen sc1
    v_mfma_f32_16x16x32_bf16 v[240:243], a[84:87], v[176:179], v[240:243]
    v_mfma_f32_16x16x32_bf16 v[228:231], a[68:71], v[180:183], v[228:231]
    v_xor_b32 v22, 0x10000, v22
    v_mfma_f32_16x16x32_bf16 v[244:247], a[84:87], v[180:183], v[244:247]
    s_waitcnt lgkmcnt(0)
    v_mfma_f32_16x16x32_bf16 v[216:219], a[72:75], v[152:155], v[216:219]
    ds_read_b128 v[168:171], v23 offset:49152
    s_bfe_u32 s72, s97, 262168
    v_mfma_f32_16x16x32_bf16 v[232:235], a[88:91], v[152:155], v[232:235]
    ds_read_b128 v[172:175], v23 offset:51200
    s_add_u32 m0, s37, 98304
    v_mfma_f32_16x16x32_bf16 v[220:223], a[72:75], v[156:159], v[220:223]
    ds_read_b128 v[176:179], v23 offset:53248
    s_lshl_b32 s72, s72, 7
    v_mfma_f32_16x16x32_bf16 v[236:239], a[88:91], v[156:159], v[236:239]
    ds_read_b128 v[180:183], v23 offset:55296
    buffer_load_dwordx4 v16, s[16:19], s72 offen offset:0 nt lds
    v_mfma_f32_16x16x32_bf16 v[224:227], a[72:75], v[160:163], v[224:227]
    buffer_load_dwordx4 v17, s[16:19], s72 offen offset:1024 nt lds
    v_mfma_f32_16x16x32_bf16 v[240:243], a[88:91], v[160:163], v[240:243]
    buffer_load_dwordx4 v18, s[16:19], s72 offen offset:2048 nt lds
    v_mfma_f32_16x16x32_bf16 v[228:231], a[72:75], v[164:167], v[228:231]
    buffer_load_dwordx4 v19, s[16:19], s72 offen offset:3072 nt lds
    v_xor_b32 v23, 0x10000, v23
    v_mfma_f32_16x16x32_bf16 v[244:247], a[88:91], v[164:167], v[244:247]
    s_waitcnt lgkmcnt(0)
    v_mfma_f32_16x16x32_bf16 v[216:219], a[76:79], v[168:171], v[216:219]
    ds_read_b128 v[152:155], v20 offset:0
    buffer_load_dword v10, v5, s[24:27], s70 offen sc1
    v_mfma_f32_16x16x32_bf16 v[232:235], a[92:95], v[168:171], v[232:235]
    ds_read_b128 v[156:159], v20 offset:2048
    v_mfma_f32_16x16x32_bf16 v[220:223], a[76:79], v[172:175], v[220:223]
    ds_read_b128 v[160:163], v20 offset:4096
    v_mfma_f32_16x16x32_bf16 v[236:239], a[92:95], v[172:175], v[236:239]
    ds_read_b128 v[164:167], v20 offset:6144
    v_mfma_f32_16x16x32_bf16 v[224:227], a[76:79], v[176:179], v[224:227]
    v_mfma_f32_16x16x32_bf16 v[240:243], a[92:95], v[176:179], v[240:243]
    v_mfma_f32_16x16x32_bf16 v[228:231], a[76:79], v[180:183], v[228:231]
    v_mfma_f32_16x16x32_bf16 v[244:247], a[92:95], v[180:183], v[244:247]
    s_waitcnt lgkmcnt(0)
    v_mfma_f32_16x16x32_bf16 v[216:219], a[96:99], v[152:155], v[216:219]
    ds_read_b128 v[168:171], v21 offset:0
    s_bfe_u32 s72, s97, 262172
    v_mfma_f32_16x16x32_bf16 v[232:235], a[112:115], v[152:155], v[232:235]
    ds_read_b128 v[172:175], v21 offset:2048
    s_add_u32 m0, s37, 114688
    v_mfma_f32_16x16x32_bf16 v[220:223], a[96:99], v[156:159], v[220:223]
    ds_read_b128 v[176:179], v21 offset:4096
    s_lshl_b32 s72, s72, 7
    v_mfma_f32_16x16x32_bf16 v[236:239], a[112:115], v[156:159], v[236:239]
    ds_read_b128 v[180:183], v21 offset:6144
    buffer_load_dwordx4 v16, s[16:19], s72 offen offset:0 nt lds
    v_mfma_f32_16x16x32_bf16 v[224:227], a[96:99], v[160:163], v[224:227]
    buffer_load_dwordx4 v17, s[16:19], s72 offen offset:1024 nt lds
    v_mfma_f32_16x16x32_bf16 v[240:243], a[112:115], v[160:163], v[240:243]
    buffer_load_dwordx4 v18, s[16:19], s72 offen offset:2048 nt lds
    v_mfma_f32_16x16x32_bf16 v[228:231], a[96:99], v[164:167], v[228:231]
    buffer_load_dwordx4 v19, s[16:19], s72 offen offset:3072 nt lds
    v_mfma_f32_16x16x32_bf16 v[244:247], a[112:115], v[164:167], v[244:247]
    s_waitcnt lgkmcnt(0)
    v_mfma_f32_16x16x32_bf16 v[216:219], a[100:103], v[168:171], v[216:219]
    ds_read_b128 v[152:155], v22 offset:0
    v_mfma_f32_16x16x32_bf16 v[232:235], a[116:119], v[168:171], v[232:235]
    ds_read_b128 v[156:159], v22 offset:2048
    v_mfma_f32_16x16x32_bf16 v[220:223], a[100:103], v[172:175], v[220:223]
    ds_read_b128 v[160:163], v22 offset:4096
    v_mfma_f32_16x16x32_bf16 v[236:239], a[116:119], v[172:175], v[236:239]
    ds_read_b128 v[164:167], v22 offset:6144
    v_mfma_f32_16x16x32_bf16 v[224:227], a[100:103], v[176:179], v[224:227]
    v_mfma_f32_16x16x32_bf16 v[240:243], a[116:119], v[176:179], v[240:243]
    v_mfma_f32_16x16x32_bf16 v[228:231], a[100:103], v[180:183], v[228:231]
    v_mfma_f32_16x16x32_bf16 v[244:247], a[116:119], v[180:183], v[244:247]
    s_waitcnt lgkmcnt(0)
    v_mfma_f32_16x16x32_bf16 v[216:219], a[104:107], v[152:155], v[216:219]
    ds_read_b128 v[168:171], v23 offset:0
    v_mfma_f32_16x16x32_bf16 v[232:235], a[120:123], v[152:155], v[232:235]
    ds_read_b128 v[172:175], v23 offset:2048
    v_mfma_f32_16x16x32_bf16 v[220:223], a[104:107], v[156:159], v[220:223]
    ds_read_b128 v[176:179], v23 offset:4096
    v_mfma_f32_16x16x32_bf16 v[236:239], a[120:123], v[156:159], v[236:239]
    ds_read_b128 v[180:183], v23 offset:6144
    v_mfma_f32_16x16x32_bf16 v[224:227], a[104:107], v[160:163], v[224:227]
    v_mfma_f32_16x16x32_bf16 v[240:243], a[120:123], v[160:163], v[240:243]
    v_mfma_f32_16x16x32_bf16 v[228:231], a[104:107], v[164:167], v[228:231]
    v_mfma_f32_16x16x32_bf16 v[244:247], a[120:123], v[164:167], v[244:247]
    s_waitcnt lgkmcnt(0) vmcnt(4)
    v_cmp_ne_u32 vcc, s98, v10
    s_nop 0
    s_cbranch_vccnz K_POLL5
K_POLL5_OK:
    s_barrier
    v_mfma_f32_16x16x32_bf16 v[216:219], a[108:111], v[168:171], v[216:219]
    ds_read_b128 v[152:155], v20 offset:16384
    buffer_load_dword v6, v9, s[24:27], s70 offen sc1
    v_mfma_f32_16x16x32_bf16 v[232:235], a[124:127], v[168:171], v[232:235]
    ds_read_b128 v[156:159], v20 offset:18432
    buffer_load_dwordx2 v[128:129], v7, s[24:27], s55 offen offset:0 sc1
    v_mfma_f32_16x16x32_bf16 v[220:223], a[108:111], v[172:175], v[220:223]
    ds_read_b128 v[160:163], v20 offset:20480
    v_mfma_f32_16x16x32_bf16 v[236:239], a[124:127], v[172:175], v[236:239]
    ds_read_b128 v[164:167], v20 offset:22528
    buffer_load_dwordx2 v[130:131], v7, s[24:27], s55 offen offset:64 sc1
    v_mfma_f32_16x16x32_bf16 v[224:227], a[108:111], v[176:179], v[224:227]
    buffer_load_dwordx2 v[132:133], v7, s[24:27], s55 offen offset:128 sc1
    v_mfma_f32_16x16x32_bf16 v[240:243], a[124:127], v[176:179], v[240:243]
    v_mfma_f32_16x16x32_bf16 v[228:231], a[108:111], v[180:183], v[228:231]
    buffer_load_dwordx2 v[134:135], v7, s[24:27], s55 offen offset:192 sc1
    v_mfma_f32_16x16x32_bf16 v[244:247], a[124:127], v[180:183], v[244:247]
    s_waitcnt lgkmcnt(0)
    v_mfma_f32_16x16x32_bf16 v[216:219], a[128:131], v[152:155], v[216:219]
    ds_read_b128 v[168:171], v21 offset:16384
    buffer_load_dwordx4 v[96:99], v3, s[24:27], s53 offen offset:0 sc1 nt
    v_mfma_f32_16x16x32_bf16 v[232:235], a[144:147], v[152:155], v[232:235]
    ds_read_b128 v[172:175], v21 offset:18432
    v_mfma_f32_16x16x32_bf16 v[220:223], a[128:131], v[156:159], v[220:223]
    ds_read_b128 v[176:179], v21 offset:20480
    buffer_load_dwordx4 v[100:103], v3, s[24:27], s53 offen offset:1024 sc1 nt
    v_mfma_f32_16x16x32_bf16 v[236:239], a[144:147], v[156:159], v[236:239]
    ds_read_b128 v[180:183], v21 offset:22528
    v_mfma_f32_16x16x32_bf16 v[224:227], a[128:131], v[160:163], v[224:227]
    buffer_load_dwordx4 v[104:107], v3, s[24:27], s53 offen offset:2048 sc1 nt
    v_mfma_f32_16x16x32_bf16 v[240:243], a[144:147], v[160:163], v[240:243]
    v_mfma_f32_16x16x32_bf16 v[228:231], a[128:131], v[164:167], v[228:231]
    buffer_load_dwordx4 v[108:111], v3, s[24:27], s53 offen offset:3072 sc1 nt
    v_mfma_f32_16x16x32_bf16 v[244:247], a[144:147], v[164:167], v[244:247]
    s_waitcnt lgkmcnt(0)
    v_mfma_f32_16x16x32_bf16 v[216:219], a[132:135], v[168:171], v[216:219]
    ds_read_b128 v[152:155], v22 offset:16384
    v_mfma_f32_16x16x32_bf16 v[232:235], a[148:151], v[168:171], v[232:235]
    ds_read_b128 v[156:159], v22 offset:18432
    v_mfma_f32_16x16x32_bf16 v[220:223], a[132:135], v[172:175], v[220:223]
    ds_read_b128 v[160:163], v22 offset:20480
    v_mfma_f32_16x16x32_bf16 v[236:239], a[148:151], v[172:175], v[236:239]
    ds_read_b128 v[164:167], v22 offset:22528
    v_mfma_f32_16x16x32_bf16 v[224:227], a[132:135], v[176:179], v[224:227]
    v_mfma_f32_16x16x32_bf16 v[240:243], a[148:151], v[176:179], v[240:243]
    v_mfma_f32_16x16x32_bf16 v[228:231], a[132:135], v[180:183], v[228:231]
    v_mfma_f32_16x16x32_bf16 v[244:247], a[148:151], v[180:183], v[244:247]
    s_waitcnt lgkmcnt(0)
    v_mfma_f32_16x16x32_bf16 v[216:219], a[136:139], v[152:155], v[216:219]
    ds_read_b128 v[168:171], v23 offset:16384
    v_mfma_f32_16x16x32_bf16 v[232:235], a[152:155], v[152:155], v[232:235]
    ds_read_b128 v[172:175], v23 offset:18432
    v_mfma_f32_16x16x32_bf16 v[220:223], a[136:139], v[156:159], v[220:223]
    ds_read_b128 v[176:179], v23 offset:20480
    v_mfma_f32_16x16x32_bf16 v[236:239], a[152:155], v[156:159], v[236:239]
    ds_read_b128 v[180:183], v23 offset:22528
    v_mfma_f32_16x16x32_bf16 v[224:227], a[136:139], v[160:163], v[224:227]
    v_mfma_f32_16x16x32_bf16 v[240:243], a[152:155], v[160:163], v[240:243]
    v_mfma_f32_16x16x32_bf16 v[228:231], a[136:139], v[164:167], v[228:231]
    v_mfma_f32_16x16x32_bf16 v[244:247], a[152:155], v[164:167], v[244:247]
    s_waitcnt lgkmcnt(0) vmcnt(8)
    v_cmp_ne_u32 vcc, s98, v6
    s_nop 0
    s_cbranch_vccnz K_POLL6
K_POLL6_OK:
    s_barrier
    v_mfma_f32_16x16x32_bf16 v[216:219], a[140:143], v[168:171], v[216:219]
    ds_read_b128 v[152:155], v20 offset:32768
    buffer_load_dwordx4 v[112:115], v3, s[24:27], s54 offen offset:0 sc1 nt
    v_mfma_f32_16x16x32_bf16 v[232:235], a[156:159], v[168:171], v[232:235]
    ds_read_b128 v[156:159], v20 offset:34816
    v_mfma_f32_16x16x32_bf16 v[220:223], a[140:143], v[172:175], v[220:223]
    ds_read_b128 v[160:163], v20 offset:36864
    buffer_load_dwordx4 v[116:119], v3, s[24:27], s54 offen offset:1024 sc1 nt
    v_mfma_f32_16x16x32_bf16 v[236:239], a[156:159], v[172:175], v[236:239]
    ds_read_b128 v[164:167], v20 offset:38912
    v_mfma_f32_16x16x32_bf16 v[224:227], a[140:143], v[176:179], v[224:227]
    buffer_load_dwordx4 v[120:123], v3, s[24:27], s54 offen offset:2048 sc1 nt
    v_mfma_f32_16x16x32_bf16 v[240:243], a[156:159], v[176:179], v[240:243]
    v_mfma_f32_16x16x32_bf16 v[228:231], a[140:143], v[180:183], v[228:231]
    buffer_load_dwordx4 v[124:127], v3, s[24:27], s54 offen offset:3072 sc1 nt
    v_mfma_f32_16x16x32_bf16 v[244:247], a[156:159], v[180:183], v[244:247]
    s_waitcnt lgkmcnt(0)
    v_mfma_f32_16x16x32_bf16 v[216:219], a[160:163], v[152:155], v[216:219]
    ds_read_b128 v[168:171], v21 offset:32768
    v_mfma_f32_16x16x32_bf16 v[232:235], a[176:179], v[152:155], v[232:235]
    ds_read_b128 v[172:175], v21 offset:34816
    v_mfma_f32_16x16x32_bf16 v[220:223], a[160:163], v[156:159], v[220:223]
    ds_read_b128 v[176:179], v21 offset:36864
    v_mfma_f32_16x16x32_bf16 v[236:239], a[176:179], v[156:159], v[236:239]
    ds_read_b128 v[180:183], v21 offset:38912
    v_mfma_f32_16x16x32_bf16 v[224:227], a[160:163], v[160:163], v[224:227]
    v_mfma_f32_16x16x32_bf16 v[240:243], a[176:179], v[160:163], v[240:243]
    v_mfma_f32_16x16x32_bf16 v[228:231], a[160:163], v[164:167], v[228:231]
    v_mfma_f32_16x16x32_bf16 v[244:247], a[176:179], v[164:167], v[244:247]
    s_waitcnt lgkmcnt(0)
    v_mfma_f32_16x16x32_bf16 v[216:219], a[164:167], v[168:171], v[216:219]
    ds_read_b128 v[152:155], v22 offset:32768
    v_mfma_f32_16x16x32_bf16 v[232:235], a[180:183], v[168:171], v[232:235]
    ds_read_b128 v[156:159], v22 offset:34816
    v_mfma_f32_16x16x32_bf16 v[220:223], a[164:167], v[172:175], v[220:223]
    ds_read_b128 v[160:163], v22 offset:36864
    v_mfma_f32_16x16x32_bf16 v[236:239], a[180:183], v[172:175], v[236:239]
    ds_read_b128 v[164:167], v22 offset:38912
    v_mfma_f32_16x16x32_bf16 v[224:227], a[164:167], v[176:179], v[224:227]
    v_mfma_f32_16x16x32_bf16 v[240:243], a[180:183], v[176:179], v[240:243]
    v_mfma_f32_16x16x32_bf16 v[228:231], a[164:167], v[180:183], v[228:231]
    v_mfma_f32_16x16x32_bf16 v[244:247], a[180:183], v[180:183], v[244:247]
    s_waitcnt lgkmcnt(0)
    v_mfma_f32_16x16x32_bf16 v[216:219], a[168:171], v[152:155], v[216:219]
    ds_read_b128 v[168:171], v23 offset:32768
    v_mfma_f32_16x16x32_bf16 v[232:235], a[184:187], v[152:155], v[232:235]
    ds_read_b128 v[172:175], v23 offset:34816
    v_mfma_f32_16x16x32_bf16 v[220:223], a[168:171], v[156:159], v[220:223]
    ds_read_b128 v[176:179], v23 offset:36864
    v_mfma_f32_16x16x32_bf16 v[236:239], a[184:187], v[156:159], v[236:239]
    ds_read_b128 v[180:183], v23 offset:38912
    v_mfma_f32_16x16x32_bf16 v[224:227], a[168:171], v[160:163], v[224:227]
    v_mfma_f32_16x16x32_bf16 v[240:243], a[184:187], v[160:163], v[240:243]
    v_mfma_f32_16x16x32_bf16 v[228:231], a[168:171], v[164:167], v[228:231]
    v_mfma_f32_16x16x32_bf16 v[244:247], a[184:187], v[164:167], v[244:247]
    s_waitcnt lgkmcnt(0)
    s_barrier
    v_mfma_f32_16x16x32_bf16 v[216:219], a[172:175], v[168:171], v[216:219]
    ds_read_b128 v[152:155], v20 offset:49152
    v_mfma_f32_16x16x32_bf16 v[232:235], a[188:191], v[168:171], v[232:235]
    ds_read_b128 v[156:159], v20 offset:51200
    v_mfma_f32_16x16x32_bf16 v[220:223], a[172:175], v[172:175], v[220:223]
    ds_read_b128 v[160:163], v20 offset:53248
    v_mfma_f32_16x16x32_bf16 v[236:239], a[188:191], v[172:175], v[236:239]
    ds_read_b128 v[164:167], v20 offset:55296
    v_mfma_f32_16x16x32_bf16 v[224:227], a[172:175], v[176:179], v[224:227]
    v_mfma_f32_16x16x32_bf16 v[240:243], a[188:191], v[176:179], v[240:243]
    v_mfma_f32_16x16x32_bf16 v[228:231], a[172:175], v[180:183], v[228:231]
    v_mfma_f32_16x16x32_bf16 v[244:247], a[188:191], v[180:183], v[244:247]
    s_waitcnt lgkmcnt(0)
    v_mfma_f32_16x16x32_bf16 v[216:219], a[192:195], v[152:155], v[216:219]
    ds_read_b128 v[168:171], v21 offset:49152
    s_waitcnt vmcnt(4)
    v_lshlrev_b32 v184, 16, v96
    v_mfma_f32_16x16x32_bf16 v[232:235], a[208:211], v[152:155], v[232:235]
    ds_read_b128 v[172:175], v21 offset:51200
    v_and_b32 v185, 0xffff0000, v96
    v_mfma_f32_16x16x32_bf16 v[220:223], a[192:195], v[156:159], v[220:223]
    ds_read_b128 v[176:179], v21 offset:53248
    v_lshlrev_b32_e64 v186, 16, v97
    v_and_b32 v187, 0xffff0000, v97
    v_mfma_f32_16x16x32_bf16 v[236:239], a[208:211], v[156:159], v[236:239]
    ds_read_b128 v[180:183], v21 offset:55296
    v_lshlrev_b32_e64 v188, 16, v98
    v_mfma_f32_16x16x32_bf16 v[224:227], a[192:195], v[160:163], v[224:227]
    v_and_b32 v189, 0xffff0000, v98
    v_mfma_f32_16x16x32_bf16 v[240:243], a[208:211], v[160:163], v[240:243]
    v_lshlrev_b32_e64 v190, 16, v99
    v_and_b32 v191, 0xffff0000, v99
    v_mfma_f32_16x16x32_bf16 v[228:231], a[192:195], v[164:167], v[228:231]
    v_lshlrev_b32_e64 v192, 16, v100
    v_mfma_f32_16x16x32_bf16 v[244:247], a[208:211], v[164:167], v[244:247]
    v_and_b32 v193, 0xffff0000, v100
    s_waitcnt lgkmcnt(0)
    v_mfma_f32_16x16x32_bf16 v[216:219], a[196:199], v[168:171], v[216:219]
    ds_read_b128 v[152:155], v22 offset:49152
    v_lshlrev_b32 v194, 16, v101
    v_and_b32 v195, 0xffff0000, v101
    v_mfma_f32_16x16x32_bf16 v[232:235], a[212:215], v[168:171], v[232:235]
    ds_read_b128 v[156:159], v22 offset:51200
    v_lshlrev_b32_e64 v196, 16, v102
    v_mfma_f32_16x16x32_bf16 v[220:223], a[196:199], v[172:175], v[220:223]
    ds_read_b128 v[160:163], v22 offset:53248
    v_and_b32 v197, 0xffff0000, v102
    v_lshlrev_b32_e64 v198, 16, v103
    v_mfma_f32_16x16x32_bf16 v[236:239], a[212:215], v[172:175], v[236:239]
    ds_read_b128 v[164:167], v22 offset:55296
    v_and_b32 v199, 0xffff0000, v103
    v_mfma_f32_16x16x32_bf16 v[224:227], a[196:199], v[176:179], v[224:227]
    v_lshlrev_b32_e64 v200, 16, v104
    v_mfma_f32_16x16x32_bf16 v[240:243], a[212:215], v[176:179], v[240:243]
    v_and_b32 v201, 0xffff0000, v104
    v_lshlrev_b32_e64 v202, 16, v105
    v_mfma_f32_16x16x32_bf16 v[228:231], a[196:199], v[180:183], v[228:231]
    v_and_b32 v203, 0xffff0000, v105
    v_mfma_f32_16x16x32_bf16 v[244:247], a[212:215], v[180:183], v[244:247]
    v_lshlrev_b32 v204, 16, v106
    s_waitcnt lgkmcnt(0)
    v_mfma_f32_16x16x32_bf16 v[216:219], a[200:203], v[152:155], v[216:219]
    ds_read_b128 v[168:171], v23 offset:49152
    v_and_b32 v205, 0xffff0000, v106
    v_lshlrev_b32_e64 v206, 16, v107
    v_mfma_f32_16x16x32_bf16 v[232:235], a[216:219], v[152:155], v[232:235]
    ds_read_b128 v[172:175], v23 offset:51200
    v_and_b32 v207, 0xffff0000, v107
    v_mfma_f32_16x16x32_bf16 v[220:223], a[200:203], v[156:159], v[220:223]
    ds_read_b128 v[176:179], v23 offset:53248
    v_lshlrev_b32_e64 v208, 16, v108
    v_and_b32 v209, 0xffff0000, v108
    v_mfma_f32_16x16x32_bf16 v[236:239], a[216:219], v[156:159], v[236:239]
    ds_read_b128 v[180:183], v23 offset:55296
    v_lshlrev_b32_e64 v210, 16, v109
    v_mfma_f32_16x16x32_bf16 v[224:227], a[200:203], v[160:163], v[224:227]
    v_and_b32 v211, 0xffff0000, v109
    v_mfma_f32_16x16x32_bf16 v[240:243], a[216:219], v[160:163], v[240:243]
    v_lshlrev_b32_e64 v212, 16, v110
    v_and_b32 v213, 0xffff0000, v110
    v_mfma_f32_16x16x32_bf16 v[228:231], a[200:203], v[164:167], v[228:231]
    v_lshlrev_b32_e64 v214, 16, v111
    v_mfma_f32_16x16x32_bf16 v[244:247], a[216:219], v[164:167], v[244:247]
    v_and_b32 v215, 0xffff0000, v111
    s_waitcnt lgkmcnt(0)
    v_mfma_f32_16x16x32_bf16 v[216:219], a[204:207], v[168:171], v[216:219]
    v_mfma_f32_16x16x32_bf16 v[232:235], a[220:223], v[168:171], v[232:235]
    v_mfma_f32_16x16x32_bf16 v[220:223], a[204:207], v[172:175], v[220:223]
    v_mfma_f32_16x16x32_bf16 v[236:239], a[220:223], v[172:175], v[236:239]
    v_mfma_f32_16x16x32_bf16 v[224:227], a[204:207], v[176:179], v[224:227]
    v_mfma_f32_16x16x32_bf16 v[240:243], a[220:223], v[176:179], v[240:243]
    v_mfma_f32_16x16x32_bf16 v[228:231], a[204:207], v[180:183], v[228:231]
    v_mfma_f32_16x16x32_bf16 v[244:247], a[220:223], v[180:183], v[244:247]
    s_waitcnt vmcnt(3)
    v_lshlrev_b32_e64 v32, 16, v112
    v_and_b32 v33, 0xffff0000, v112
    v_lshlrev_b32_e64 v34, 16, v113
    v_and_b32 v35, 0xffff0000, v113
    v_lshlrev_b32_e64 v36, 16, v114
    v_and_b32 v37, 0xffff0000, v114
    v_lshlrev_b32_e64 v38, 16, v115
    v_and_b32 v39, 0xffff0000, v115
    v_add_f32 v32, v32, v216
    v_add_f32 v33, v33, v220
    v_add_f32 v34, v34, v224
    v_add_f32 v35, v35, v228
    v_pk_fma_f32 v[184:185], v[32:33], v[128:129], v[184:185] op_sel_hi:[1,0,1]
    v_pk_fma_f32 v[186:187], v[34:35], v[128:129], v[186:187] op_sel_hi:[1,0,1]
    s_add_u32 s39, s56, 0
    buffer_store_dwordx4 v[184:187], v12, s[28:31], s39 offen
    v_add_f32 v36, v36, v232
    v_add_f32 v37, v37, v236
    v_add_f32 v38, v38, v240
    v_add_f32_e64 v39, v39, v244
    v_pk_fma_f32 v[188:189], v[36:37], v[128:129], v[188:189] op_sel:[0,1,0]
    v_pk_fma_f32 v[190:191], v[38:39], v[128:129], v[190:191] op_sel:[0,1,0]
    s_add_u32 s39, s56, 131072
    buffer_store_dwordx4 v[188:191], v12, s[28:31], s39 offen
    s_waitcnt vmcnt(4)
    v_lshlrev_b32 v40, 16, v116
    v_and_b32 v41, 0xffff0000, v116
    v_lshlrev_b32_e64 v42, 16, v117
    v_and_b32 v43, 0xffff0000, v117
    v_lshlrev_b32_e64 v44, 16, v118
    v_and_b32 v45, 0xffff0000, v118
    v_lshlrev_b32_e64 v46, 16, v119
    v_and_b32 v47, 0xffff0000, v119
    v_add_f32 v40, v40, v217
    v_add_f32 v41, v41, v221
    v_add_f32 v42, v42, v225
    v_add_f32 v43, v43, v229
    v_pk_fma_f32 v[192:193], v[40:41], v[130:131], v[192:193] op_sel_hi:[1,0,1]
    v_pk_fma_f32 v[194:195], v[42:43], v[130:131], v[194:195] op_sel_hi:[1,0,1]
    s_add_u32 s39, s56, 4096
    buffer_store_dwordx4 v[192:195], v12, s[28:31], s39 offen
    v_add_f32 v44, v44, v233
    v_add_f32 v45, v45, v237
    v_add_f32 v46, v46, v241
    v_add_f32 v47, v47, v245
    v_pk_fma_f32 v[196:197], v[44:45], v[130:131], v[196:197] op_sel:[0,1,0]
    v_pk_fma_f32 v[198:199], v[46:47], v[130:131], v[198:199] op_sel:[0,1,0]
    s_add_u32 s39, s56, 135168
    buffer_store_dwordx4 v[196:199], v12, s[28:31], s39 offen
    s_waitcnt vmcnt(5)
    v_lshlrev_b32 v48, 16, v120
    v_and_b32 v49, 0xffff0000, v120
    v_lshlrev_b32_e64 v50, 16, v121
    v_and_b32 v51, 0xffff0000, v121
    v_lshlrev_b32_e64 v52, 16, v122
    v_and_b32 v53, 0xffff0000, v122
    v_lshlrev_b32_e64 v54, 16, v123
    v_and_b32 v55, 0xffff0000, v123
    v_add_f32 v48, v48, v218
    v_add_f32 v49, v49, v222
    v_add_f32 v50, v50, v226
    v_add_f32 v51, v51, v230
    v_pk_fma_f32 v[200:201], v[48:49], v[132:133], v[200:201] op_sel_hi:[1,0,1]
    v_pk_fma_f32 v[202:203], v[50:51], v[132:133], v[202:203] op_sel_hi:[1,0,1]
    s_add_u32 s39, s56, 8192
    buffer_store_dwordx4 v[200:203], v12, s[28:31], s39 offen
    v_add_f32 v52, v52, v234
    v_add_f32 v53, v53, v238
    v_add_f32 v54, v54, v242
    v_add_f32 v55, v55, v246
    v_pk_fma_f32 v[204:205], v[52:53], v[132:133], v[204:205] op_sel:[0,1,0]
    v_pk_fma_f32 v[206:207], v[54:55], v[132:133], v[206:207] op_sel:[0,1,0]
    s_add_u32 s39, s56, 139264
    buffer_store_dwordx4 v[204:207], v12, s[28:31], s39 offen
    s_waitcnt vmcnt(6)
    v_lshlrev_b32 v56, 16, v124
    v_and_b32 v57, 0xffff0000, v124
    v_lshlrev_b32_e64 v58, 16, v125
    v_and_b32 v59, 0xffff0000, v125
    v_lshlrev_b32_e64 v60, 16, v126
    v_and_b32 v61, 0xffff0000, v126
    v_lshlrev_b32_e64 v62, 16, v127
    v_and_b32 v63, 0xffff0000, v127
    v_add_f32 v56, v56, v219
    v_add_f32 v57, v57, v223
    v_add_f32 v58, v58, v227
    v_add_f32 v59, v59, v231
    v_pk_fma_f32 v[208:209], v[56:57], v[134:135], v[208:209] op_sel_hi:[1,0,1]
    v_pk_fma_f32 v[210:211], v[58:59], v[134:135], v[210:211] op_sel_hi:[1,0,1]
    s_add_u32 s39, s56, 12288
    buffer_store_dwordx4 v[208:211], v12, s[28:31], s39 offen
    v_add_f32 v60, v60, v235
    v_add_f32 v61, v61, v239
    v_add_f32 v62, v62, v243
    v_add_f32 v63, v63, v247
    v_pk_fma_f32 v[212:213], v[60:61], v[134:135], v[212:213] op_sel:[0,1,0]
    v_pk_fma_f32 v[214:215], v[62:63], v[134:135], v[214:215] op_sel:[0,1,0]
    s_add_u32 s39, s56, 143360
    buffer_store_dwordx4 v[212:215], v12, s[28:31], s39 offen
K_END:
    s_endpgm
K_W256:
    buffer_load_dwordx4 a[120:123], v3, s[24:27], s37 offen offset:0 sc1
    buffer_load_dwordx4 a[124:127], v3, s[24:27], s37 offen offset:1024 sc1
    buffer_load_dwordx4 a[128:131], v3, s[24:27], s37 offen offset:2048 sc1
    buffer_load_dwordx4 a[132:135], v3, s[24:27], s37 offen offset:3072 sc1
    s_branch K_W256_RET
K_POLL1:
    s_mov_b32 s71, 0
K_POLL1_L:
    s_sleep 2
    buffer_load_dword v216, v217, s[24:27], s68 offen sc1
    s_add_u32 s71, s71, 1
    s_waitcnt vmcnt(0)
    v_cmp_ne_u32 vcc, s35, v216
    s_nop 0
    s_cbranch_vccz K_POLL1_OK
    s_cmp_lt_u32 s71, 200000
    s_cbranch_scc1 K_POLL1_L
    s_branch K_POLL1_OK
K_SPECIAL:
    v_lshl_add_u32 v12, v2, 8, v1
    v_add_u32 v12, s63, v12
    v_sub_u32 v13, 21312, v12
    v_add_u32 v12, 20480, v12
    v_lshlrev_b32 v13, 2, v13
    v_lshlrev_b32 v12, 2, v12
    v_pk_mul_f32 v[224:225], v[224:225], 0.5 op_sel_hi:[1,0]
    v_pk_mul_f32 v[226:227], v[226:227], 0.5 op_sel_hi:[1,0]
    v_pk_mul_f32 v[228:229], v[228:229], 0.5 op_sel_hi:[1,0]
    v_pk_mul_f32 v[230:231], v[230:231], 0.5 op_sel_hi:[1,0]
    v_pk_mul_f32 v[232:233], v[232:233], 0.5 op_sel_hi:[1,0]
    v_pk_mul_f32 v[234:235], v[234:235], 0.5 op_sel_hi:[1,0]
    v_pk_mul_f32 v[236:237], v[236:237], 0.5 op_sel_hi:[1,0]
    v_pk_mul_f32 v[238:239], v[238:239], 0.5 op_sel_hi:[1,0]
    ds_write2st64_b32 v12, v224, v228 offset0:0 offset1:46
    ds_write2st64_b32 v12, v225, v229 offset0:1 offset1:47
    ds_write2st64_b32 v12, v226, v230 offset0:2 offset1:48
    ds_write2st64_b32 v12, v227, v231 offset0:3 offset1:49
    ds_write2st64_b32 v12, v232, v236 offset0:16 offset1:62
    ds_write2st64_b32 v12, v233, v237 offset0:17 offset1:63
    ds_write2st64_b32 v12, v234, v238 offset0:18 offset1:64
    ds_write2st64_b32 v12, v235, v239 offset0:19 offset1:65
    ds_write2st64_b32 v12, v224, v228 offset0:32 offset1:78
    v_accvgpr_read_b32 v8, a120
    v_accvgpr_read_b32 v9, a122
    v_lshlrev_b32 v4, 16, v8
    v_lshlrev_b32 v5, 16, v9
    v_and_b32 v6, 0xffff0000, v8
    v_and_b32 v7, 0xffff0000, v9
    v_pk_mul_f32 v[184:185], v[240:241], v[4:5]
    v_pk_mul_f32 v[188:189], v[244:245], v[4:5]
    v_pk_fma_f32 v[184:185], v[244:245], v[6:7], v[184:185] neg_lo:[1,0,0] neg_hi:[1,0,0]
    v_pk_fma_f32 v[188:189], v[240:241], v[6:7], v[188:189]
    v_accvgpr_read_b32 v8, a124
    v_accvgpr_read_b32 v9, a126
    v_lshlrev_b32 v4, 16, v8
    v_lshlrev_b32 v5, 16, v9
    v_and_b32 v6, 0xffff0000, v8
    v_and_b32 v7, 0xffff0000, v9
    v_pk_mul_f32 v[186:187], v[242:243], v[4:5]
    v_pk_mul_f32 v[190:191], v[246:247], v[4:5]
    v_pk_fma_f32 v[186:187], v[246:247], v[6:7], v[186:187] neg_lo:[1,0,0] neg_hi:[1,0,0]
    v_pk_fma_f32 v[190:191], v[242:243], v[6:7], v[190:191]
    v_accvgpr_read_b32 v8, a128
    v_accvgpr_read_b32 v9, a130
    v_lshlrev_b32 v4, 16, v8
    v_lshlrev_b32 v5, 16, v9
    v_and_b32 v6, 0xffff0000, v8
    v_and_b32 v7, 0xffff0000, v9
    v_pk_mul_f32 v[192:193], v[248:249], v[4:5]
    v_pk_mul_f32 v[196:197], v[252:253], v[4:5]
    v_pk_fma_f32 v[192:193], v[252:253], v[6:7], v[192:193] neg_lo:[1,0,0] neg_hi:[1,0,0]
    v_pk_fma_f32 v[196:197], v[248:249], v[6:7], v[196:197]
    v_accvgpr_read_b32 v8, a132
    v_accvgpr_read_b32 v9, a134
    v_lshlrev_b32 v4, 16, v8
    v_lshlrev_b32 v5, 16, v9
    v_and_b32 v6, 0xffff0000, v8
    v_and_b32 v7, 0xffff0000, v9
    v_pk_mul_f32 v[194:195], v[250:251], v[4:5]
    v_pk_mul_f32 v[198:199], v[254:255], v[4:5]
    v_pk_fma_f32 v[194:195], v[254:255], v[6:7], v[194:195] neg_lo:[1,0,0] neg_hi:[1,0,0]
    v_pk_fma_f32 v[198:199], v[250:251], v[6:7], v[198:199]
    s_add_u32 s39, s62, 1
    v_mov_b32 v6, s39
    s_mov_b32 s39, 22446080
    buffer_store_dword v6, v30, s[24:27], s39 offen sc1
    s_waitcnt lgkmcnt(0)
    s_barrier
    ds_read2st64_b32 v[240:241], v13 offset0:19 offset1:18
    ds_read2st64_b32 v[244:245], v13 offset0:65 offset1:64
    ds_read2st64_b32 v[242:243], v13 offset0:17 offset1:16
    ds_read2st64_b32 v[246:247], v13 offset0:63 offset1:62
    ds_read2st64_b32 v[248:249], v13 offset0:3 offset1:2
    ds_read2st64_b32 v[252:253], v13 offset0:49 offset1:48
    ds_read2st64_b32 v[250:251], v13 offset0:1 offset1:0
    ds_read2st64_b32 v[254:255], v13 offset0:47 offset1:46
    s_waitcnt lgkmcnt(0)
    v_pk_mul_f32 v[244:245], v[244:245], -1.0 op_sel_hi:[1,0]
    v_pk_mul_f32 v[246:247], v[246:247], -1.0 op_sel_hi:[1,0]
    v_pk_mul_f32 v[252:253], v[252:253], -1.0 op_sel_hi:[1,0]
    v_pk_mul_f32 v[254:255], v[254:255], -1.0 op_sel_hi:[1,0]
    s_branch K_SPECIAL_RET
K_SPECIAL2:
    ds_write2st64_b32 v12, v240, v244 offset0:92 offset1:138
    ds_write2st64_b32 v12, v241, v245 offset0:93 offset1:139
    ds_write2st64_b32 v12, v242, v246 offset0:94 offset1:140
    ds_write2st64_b32 v12, v243, v247 offset0:95 offset1:141
    ds_write2st64_b32 v12, v248, v252 offset0:108 offset1:154
    ds_write2st64_b32 v12, v249, v253 offset0:109 offset1:155
    ds_write2st64_b32 v12, v250, v254 offset0:110 offset1:156
    ds_write2st64_b32 v12, v251, v255 offset0:111 offset1:157
    ds_write2st64_b32 v12, v240, v244 offset0:124 offset1:170
    s_waitcnt lgkmcnt(0)
    s_barrier
    ds_read2st64_b32 v[240:241], v13 offset0:111 offset1:110
    ds_read2st64_b32 v[244:245], v13 offset0:157 offset1:156
    ds_read2st64_b32 v[242:243], v13 offset0:109 offset1:108
    ds_read2st64_b32 v[246:247], v13 offset0:155 offset1:154
    ds_read2st64_b32 v[248:249], v13 offset0:95 offset1:94
    ds_read2st64_b32 v[252:253], v13 offset0:141 offset1:140
    ds_read2st64_b32 v[250:251], v13 offset0:93 offset1:92
    ds_read2st64_b32 v[254:255], v13 offset0:139 offset1:138
    s_waitcnt lgkmcnt(0)
    s_nop 0
    v_pk_add_f32 v[224:225], v[224:225], v[240:241]
    v_pk_add_f32 v[240:241], v[184:185], v[184:185]
    v_pk_add_f32 v[226:227], v[226:227], v[242:243]
    v_pk_add_f32 v[242:243], v[186:187], v[186:187]
    v_pk_add_f32 v[228:229], v[228:229], v[244:245] neg_lo:[0,1] neg_hi:[0,1]
    v_pk_add_f32 v[244:245], v[188:189], v[188:189]
    v_pk_add_f32 v[230:231], v[230:231], v[246:247] neg_lo:[0,1] neg_hi:[0,1]
    v_pk_add_f32 v[246:247], v[190:191], v[190:191]
    v_pk_add_f32 v[232:233], v[232:233], v[248:249]
    v_pk_add_f32 v[248:249], v[192:193], v[192:193]
    v_pk_add_f32 v[234:235], v[234:235], v[250:251]
    v_pk_add_f32 v[250:251], v[194:195], v[194:195]
    v_pk_add_f32 v[236:237], v[236:237], v[252:253] neg_lo:[0,1] neg_hi:[0,1]
    v_pk_add_f32 v[252:253], v[196:197], v[196:197]
    v_pk_add_f32 v[238:239], v[238:239], v[254:255] neg_lo:[0,1] neg_hi:[0,1]
    v_pk_add_f32 v[254:255], v[198:199], v[198:199]
    s_barrier
    s_branch K_SPECIAL2_RET
K_POLL2:
    s_mov_b32 s71, 0
K_POLL2_L:
    buffer_load_dwordx4 v[96:99], v148, s[24:27], s93 offen sc1
    buffer_load_dwordx4 v[100:103], v149, s[24:27], s93 offen sc1
    buffer_load_dwordx4 v[104:107], v150, s[24:27], s93 offen sc1
    buffer_load_dwordx4 v[108:111], v151, s[24:27], s93 offen sc1
    s_add_u32 s71, s71, 1
    s_waitcnt vmcnt(0)
    v_xor_b32 v4, v200, v98
    v_xor_b32 v5, v201, v102
    v_xor_b32 v6, v202, v106
    v_xor_b32_e64 v7, v203, v110
    v_or3_b32 v4, v4, v5, v6
    v_or_b32 v4, v4, v7
    v_cmp_ne_u32 vcc, 0, v4
    s_nop 0
    s_cbranch_vccz K_POLL2_OK
    s_cmp_lt_u32 s71, 200000
    s_cbranch_scc1 K_POLL2_L
    s_branch K_POLL2_OK
K_POLL3:
    s_mov_b32 s71, 0
K_POLL3_L:
    s_sleep 0
    buffer_load_dword v4, v210, s[24:27], s51 offen offset:64 sc1
    s_add_u32 s71, s71, 1
    s_waitcnt vmcnt(0)
    v_cmp_ne_u32 vcc, s98, v4
    s_nop 0
    s_cbranch_vccz K_POLL3_OK
    s_cmp_lt_u32 s71, 200000
    s_cbranch_scc1 K_POLL3_L
    s_branch K_POLL3_OK
K_POLL4:
    s_mov_b32 s71, 0
K_POLL4_L:
    s_sleep 2
    buffer_load_dword v8, v13, s[24:27], s70 offen sc1
    s_add_u32 s71, s71, 1
    s_waitcnt vmcnt(0)
    v_cmp_ne_u32 vcc, s35, v8
    s_nop 0
    s_cbranch_vccz K_POLL4_OK
    s_cmp_lt_u32 s71, 200000
    s_cbranch_scc1 K_POLL4_L
    s_branch K_POLL4_OK
K_POLL5:
    s_mov_b32 s71, 0
K_POLL5_L:
    s_sleep 2
    buffer_load_dword v10, v5, s[24:27], s70 offen sc1
    s_add_u32 s71, s71, 1
    s_waitcnt vmcnt(0)
    v_cmp_ne_u32 vcc, s98, v10
    s_nop 0
    s_cbranch_vccz K_POLL5_OK
    s_cmp_lt_u32 s71, 200000
    s_cbranch_scc1 K_POLL5_L
    s_branch K_POLL5_OK
K_POLL6:
    s_mov_b32 s71, 0
K_POLL6_L:
    s_sleep 2
    buffer_load_dword v6, v9, s[24:27], s70 offen sc1
    s_add_u32 s71, s71, 1
    s_waitcnt vmcnt(0)
    v_cmp_ne_u32 vcc, s98, v6
    s_nop 0
    s_cbranch_vccz K_POLL6_OK
    s_cmp_lt_u32 s71, 200000
    s_cbranch_scc1 K_POLL6_L
    s_branch K_POLL6_OK
K_HFAR:
    buffer_store_dwordx4 v[64:67], v24, s[28:31], s68 offen sc1
    buffer_store_dwordx4 v[80:83], v24, s[28:31], s69 offen sc1
    v_mfma_f32_16x16x32_bf16 v[32:35], v[64:67], v[152:155], 0
    ds_read_b128 v[168:171], v21 offset:0
    buffer_store_dwordx4 v[68:71], v25, s[28:31], s68 offen sc1
    v_mfma_f32_16x16x32_bf16 v[48:51], v[80:83], v[152:155], 0
    ds_read_b128 v[172:175], v21 offset:2048
    v_mfma_f32_16x16x32_bf16 v[36:39], v[64:67], v[156:159], 0
    ds_read_b128 v[176:179], v21 offset:4096
    buffer_store_dwordx4 v[84:87], v25, s[28:31], s69 offen sc1
    v_mfma_f32_16x16x32_bf16 v[52:55], v[80:83], v[156:159], 0
    ds_read_b128 v[180:183], v21 offset:6144
    v_mfma_f32_16x16x32_bf16 v[40:43], v[64:67], v[160:163], 0
    v_mfma_f32_16x16x32_bf16 v[56:59], v[80:83], v[160:163], 0
    buffer_store_dwordx4 v[72:75], v26, s[28:31], s68 offen sc1
    v_mfma_f32_16x16x32_bf16 v[44:47], v[64:67], v[164:167], 0
    v_mfma_f32_16x16x32_bf16 v[60:63], v[80:83], v[164:167], 0
    s_waitcnt lgkmcnt(0)
    v_mfma_f32_16x16x32_bf16 v[32:35], v[68:71], v[168:171], v[32:35]
    ds_read_b128 v[152:155], v22 offset:0
    buffer_store_dwordx4 v[88:91], v26, s[28:31], s69 offen sc1
    v_mfma_f32_16x16x32_bf16 v[48:51], v[84:87], v[168:171], v[48:51]
    ds_read_b128 v[156:159], v22 offset:2048
    v_mfma_f32_16x16x32_bf16 v[36:39], v[68:71], v[172:175], v[36:39]
    ds_read_b128 v[160:163], v22 offset:4096
    buffer_store_dwordx4 v[76:79], v27, s[28:31], s68 offen sc1
    v_mfma_f32_16x16x32_bf16 v[52:55], v[84:87], v[172:175], v[52:55]
    ds_read_b128 v[164:167], v22 offset:6144
    v_mfma_f32_16x16x32_bf16 v[40:43], v[68:71], v[176:179], v[40:43]
    v_mfma_f32_16x16x32_bf16 v[56:59], v[84:87], v[176:179], v[56:59]
    buffer_store_dwordx4 v[92:95], v27, s[28:31], s69 offen sc1
    v_mfma_f32_16x16x32_bf16 v[44:47], v[68:71], v[180:183], v[44:47]
    v_mfma_f32_16x16x32_bf16 v[60:63], v[84:87], v[180:183], v[60:63]
    s_branch K_HFAR_RET
K_CODE_END:
.section .rodata,"a"
.p2align 6
.amdhsa_kernel gated_mix__spectral_gfnet__ssm_conv_s5__prompt_kernel
  .amdhsa_next_free_vgpr 512
  .amdhsa_next_free_sgpr 102
  .amdhsa_accum_offset 256
  .amdhsa_group_segment_fixed_size 0
  .amdhsa_kernarg_size 128
  .amdhsa_user_sgpr_count 2
  .amdhsa_user_sgpr_kernarg_segment_ptr 1
  .amdhsa_system_sgpr_workgroup_id_x 1
.end_amdhsa_kernel
```

```asm
; @launch grid=(256,1,1) block=(256,1,1) lds=163840
.amdgcn_target "amdgcn-amd-amdhsa--gfx950"
.text
.globl gated_mix__spectral_gfnet__ssm_conv_s5__prompt_kernel
.p2align 8
.type gated_mix__spectral_gfnet__ssm_conv_s5__prompt_kernel,@function
gated_mix__spectral_gfnet__ssm_conv_s5__prompt_kernel:
    s_load_dwordx2 s[8:9], s[0:1], 0
    s_load_dwordx2 s[60:61], s[0:1], 120
    s_cmp_ge_u32 s2, 256
    s_cbranch_scc1 K_END
    s_getpc_b64 s[28:29]
K_PC:
    s_mov_b32 s30, K_CODE_END-K_PC
    s_mov_b32 s31, 0x00020000
    s_lshr_b32 s38, s2, 3
    s_mul_i32 s38, s38, 1280
    v_lshl_add_u32 v4, v0, 3, s38
    v_lshrrev_b32 v3, 6, v0
    buffer_load_dword v255, v4, s[28:31], 0 offen
    s_load_dwordx8 s[52:59], s[0:1], 32
    s_load_dwordx4 s[44:47], s[0:1], 8
    s_load_dwordx8 s[80:87], s[0:1], 64
    s_load_dwordx4 s[88:91], s[0:1], 96
    v_readfirstlane_b32 s34, v3
    v_and_b32 v1, 15, v0
    v_bfe_u32 v2, v0, 4, 2
    s_and_b32 s38, s2, 3
    s_bfe_u32 s39, s2, 0x20003
    s_lshl2_add_u32 s32, s38, s39
    s_bfe_u32 s38, s2, 0x10002
    s_lshr_b32 s39, s2, 5
    s_lshl3_add_u32 s33, s38, s39
    s_and_b32 s6, s34, 1
    s_lshr_b32 s41, s34, 1
    s_lshl1_add_u32 s38, s32, s6
    s_lshl_b32 s38, s38, 5
    s_add_u32 s38, s38, s33
    s_lshl1_add_u32 s68, s38, s41
    s_lshl_b32 s68, s68, 11
    s_add_u32 s69, s68, 65536
    v_lshlrev_b32 v5, 9, v2
    v_lshl_add_u32 v29, v1, 3, v5
    s_mov_b32 s10, 0x400000
    s_mov_b32 s11, s31
    s_waitcnt lgkmcnt(0)
    buffer_load_dwordx2 v[96:97], v29, s[8:11], s68 offen offset:0
    buffer_load_dwordx2 v[98:99], v29, s[8:11], s68 offen offset:128
    v_cmp_gt_u32_e64 vcc, 16, v0
    buffer_load_dwordx2 v[100:101], v29, s[8:11], s68 offen offset:256
    v_lshlrev_b32 v30, 2, v0
    s_lshl4_add_u32 s4, s32, s33
    s_lshl_b32 s37, s34, 12
    v_cndmask_b32 v30, 2.0, v30, vcc
    v_and_b32 v0, 63, v0
    v_lshlrev_b32 v3, 4, v0
    buffer_load_dwordx2 v[102:103], v29, s[8:11], s68 offen offset:384
    s_lshl_b32 s63, s34, 4
    s_lshl2_add_u32 s94, s6, s41
    v_and_b32 v6, 7, v0
    v_xor_b32 v6, v6, v2
    v_lshlrev_b32 v6, 4, v6
    v_and_b32 v8, 32, v0
    v_bfe_u32 v9, v0, 3, 1
    buffer_load_dwordx2 v[104:105], v29, s[8:11], s69 offen offset:0
    v_lshl_add_u32 v8, v9, 4, v8
    v_bfe_u32 v9, v0, 4, 1
    s_lshl_b32 s38, s32, 5
    s_add_u32 s38, s38, s34
    s_lshl_b32 s38, s38, 2
    v_add3_u32 v8, v8, v9, s38
    v_lshl_add_u32 v16, v8, 11, v6
    buffer_load_dwordx2 v[106:107], v29, s[8:11], s69 offen offset:128
    v_lshrrev_b32 v9, 3, v0
    s_lshl1_add_u32 s38, s33, s6
    s_lshl_b32 s38, s38, 5
    v_add_u32_e64 v9, s38, v9
    v_lshl_add_u32 v20, v9, 11, v6
    v_xor_b32 v8, 64, v16
    v_xor_b32 v9, 64, v20
    buffer_load_dwordx2 v[108:109], v29, s[8:11], s69 offen offset:256
    v_add_u32 v17, 130048, v8
    v_add_u32 v18, 2048, v16
    v_add_u32 v19, 132096, v8
    v_add_u32 v21, 15360, v9
    v_add_u32 v22, 30720, v20
    v_add_u32 v23, 46080, v9
    s_add_u32 s38, s32, s33
    buffer_load_dwordx2 v[110:111], v29, s[8:11], s69 offen offset:384
    s_and_b32 s38, s38, 3
    s_mov_b32 s66, 2253603344
    s_mov_b32 s67, 4275817111
    s_cmp_eq_u32 s38, 1
    s_cselect_b32 s66, 2539672353, s66
    s_cselect_b32 s67, 3488144292, s67
    s_cmp_eq_u32 s38, 2
    s_cselect_b32 s66, 1417023538, s66
    s_cselect_b32 s67, 3707672762, s67
    s_cmp_eq_u32 s38, 3
    s_cselect_b32 s66, 1699160323, s66
    s_cselect_b32 s67, 3989809547, s67
    s_and_b32 s38, s2, 3
    s_mul_i32 s38, s38, 0x44444444
    s_xor_b32 s66, s66, s38
    s_xor_b32 s67, s67, s38
    s_mov_b32 s14, 0x200000
    s_mov_b32 s15, s31
    s_nop 0
    s_cmp_lt_u32 s34, 2
    s_cselect_b64 s[12:13], s[56:57], s[58:59]
    s_cselect_b64 s[28:29], s[88:89], s[86:87]
    s_mov_b32 s30, 2048
    s_lshl_b32 s39, s34, 10
    s_add_u32 m0, s39, 147712
    s_lshl_b32 s38, s6, 10
    buffer_load_dwordx4 v3, s[28:31], s38 offen lds
    v_cvt_f32_u32 v249, v1
    v_cvt_f32_u32_e64 v250, v2
    v_mul_f32 v251, 0x3d800000, v249
    v_mul_f32 v250, 4.0, v250
    v_mul_f32 v248, v250, v251
    v_fmamk_f32 v4, v251, 0x00000000, v248
    v_fmamk_f32 v5, v251, 0x3f800000, v248
    v_fmamk_f32 v6, v251, 0x40000000, v248
    s_bfe_u32 s36, s66, 262144
    s_add_u32 m0, s37, 16384
    s_lshl_b32 s36, s36, 7
    buffer_load_dwordx4 v20, s[12:15], s36 offen offset:0 lds
    buffer_load_dwordx4 v21, s[12:15], s36 offen offset:1024 lds
    buffer_load_dwordx4 v22, s[12:15], s36 offen offset:2048 lds
    buffer_load_dwordx4 v23, s[12:15], s36 offen offset:3072 lds
    v_fmamk_f32 v7, v251, 0x40400000, v248
    v_cos_f32 v8, v4
    v_cos_f32 v9, v5
    v_cos_f32 v10, v6
    v_cos_f32 v11, v7
    v_sin_f32 v12, v4
    v_sin_f32 v13, v5
    v_sin_f32 v14, v6
    v_sin_f32_e64 v15, v7
    v_cvt_pk_bf16_f32 v4, v8, v12
    v_cvt_pk_bf16_f32 v5, -v12, v8
    v_accvgpr_write_b32 a224, v4
    v_accvgpr_write_b32 a228, v5
    v_cvt_pk_bf16_f32 v4, v9, v13
    v_cvt_pk_bf16_f32 v5, -v13, v9
    v_accvgpr_write_b32 a225, v4
    v_accvgpr_write_b32 a229, v5
    v_cvt_pk_bf16_f32 v4, v10, v14
    v_cvt_pk_bf16_f32 v5, -v14, v10
    v_accvgpr_write_b32 a226, v4
    v_accvgpr_write_b32 a230, v5
    v_cvt_pk_bf16_f32 v4, v11, v15
    v_cvt_pk_bf16_f32 v5, -v15, v11
    v_accvgpr_write_b32 a227, v4
    v_accvgpr_write_b32 a231, v5
    v_fmamk_f32 v4, v251, 0x3f000000, v248
    v_fmamk_f32 v5, v251, 0x3fc00000, v248
    v_fmamk_f32 v6, v251, 0x40200000, v248
    v_fmamk_f32 v7, v251, 0x40600000, v248
    v_cos_f32 v8, v4
    v_cos_f32 v9, v5
    v_cos_f32_e64 v10, v6
    s_add_u32 s40, s60, 22446080
    s_addc_u32 s41, s61, 0
    s_load_dword s62, s[40:41], 0
    v_cos_f32 v11, v7
    v_sin_f32 v12, v4
    v_sin_f32 v13, v5
    v_sin_f32 v14, v6
    v_sin_f32 v15, v7
    v_cvt_pk_bf16_f32 v4, v8, v12
    v_cvt_pk_bf16_f32 v5, -v12, v8
    v_accvgpr_write_b32 a248, v4
    v_accvgpr_write_b32 a252, v5
    v_cvt_pk_bf16_f32 v4, v9, v13
    v_cvt_pk_bf16_f32 v5, -v13, v9
    v_accvgpr_write_b32 a249, v4
    v_accvgpr_write_b32 a253, v5
    v_cvt_pk_bf16_f32 v4, v10, v14
    v_cvt_pk_bf16_f32 v5, -v14, v10
    v_accvgpr_write_b32 a250, v4
    v_accvgpr_write_b32 a254, v5
    v_cvt_pk_bf16_f32 v4, v11, v15
    v_cvt_pk_bf16_f32 v5, -v15, v11
    v_accvgpr_write_b32 a251, v4
    v_accvgpr_write_b32 a255, v5
    v_mul_f32 v251, 0x3d800000, v251
    v_mul_f32 v248, 0x3d800000, v248
    v_fmamk_f32 v4, v251, 0x00000000, v248
    v_fmamk_f32 v5, v251, 0x3f800000, v248
    v_fmamk_f32 v6, v251, 0x40000000, v248
    v_fmamk_f32 v7, v251, 0x40400000, v248
    v_cos_f32 v232, v4
    v_cos_f32 v233, v5
    v_cos_f32 v234, v6
    v_cos_f32 v235, v7
    v_sin_f32 v240, v4
    v_sin_f32 v241, v5
    v_sin_f32 v242, v6
    v_sin_f32 v243, v7
    v_fmamk_f32 v4, v251, 0x3f000000, v248
    v_fmamk_f32 v5, v251, 0x3fc00000, v248
    v_fmamk_f32 v6, v251, 0x40200000, v248
    v_fmamk_f32 v7, v251, 0x40600000, v248
    v_cos_f32 v236, v4
    v_cos_f32 v237, v5
    v_cos_f32 v238, v6
    v_cos_f32 v239, v7
    v_sin_f32 v244, v4
    v_sin_f32 v245, v5
    v_sin_f32 v246, v6
    v_sin_f32 v247, v7
    s_mov_b64 s[24:25], s[60:61]
    s_mov_b32 s26, 33554432
    s_mov_b32 s27, 0x00020000
    v_lshrrev_b32 v15, 1, v1
    v_xor_b32 v15, v15, v2
    v_lshlrev_b32 v15, 4, v15
    v_lshl_add_u32 v24, v1, 7, v15
    v_xor_b32 v25, 64, v24
    s_lshl_b32 s76, s34, 11
    s_add_u32 s76, s76, 16384
    v_add_u32 v26, s76, v24
    v_add_u32 v27, s76, v25
    v_add_u32 v148, 0x10000, v24
    v_add_u32 v149, 0x10000, v25
    v_add_u32 v150, 0x10000, v26
    v_add_u32 v151, 0x10000, v27
    s_and_b32 s76, s34, 2
    s_lshl1_add_u32 s76, s76, s6
    s_mul_i32 s76, s76, 2080
    s_add_u32 s76, s76, 131072
    v_lshl_add_u32 v15, v2, 6, v1
    v_lshl_add_u32 v252, v15, 3, s76
    v_sub_u32 v15, 728, v15
    v_lshl_add_u32 v253, v15, 3, s76
    v_lshrrev_b32 v7, 2, v0
    v_add_u32 v7, s63, v7
    v_and_b32 v15, 3, v0
    v_lshlrev_b32 v12, 4, v15
    v_mul_u32_u24 v229, 4160, v15
    v_lshl_add_u32 v229, v7, 3, v229
    v_add_u32 v229, 131072, v229
    v_lshrrev_b32_e64 v14, 2, v0
    v_lshl_add_u32 v230, v14, 8, v12
    v_and_b32_e64 v14, 3, v14
    v_lshl_add_u32 v231, v14, 10, v12
    v_lshl_add_u32 v231, v2, 19, v231
    v_and_b32 v15, 1, v15
    v_lshlrev_b32 v15, 11, v15
    v_cmp_eq_u32_e64 vcc, 0, v7
    v_add_u32 v254, 147712, v29
    s_nop 0
    v_cndmask_b32 v15, 0, v15, vcc
    v_add_u32_e64 v228, v229, v15
    v_accvgpr_write_b32 a136, v232
    v_accvgpr_write_b32 a144, v240
    v_accvgpr_write_b32 a137, v233
    v_accvgpr_write_b32 a145, v241
    v_accvgpr_write_b32 a138, v234
    v_accvgpr_write_b32 a146, v242
    v_accvgpr_write_b32 a139, v235
    v_accvgpr_write_b32 a147, v243
    v_fma_f32 v251, v249, 2.0, 1.0
    v_mul_f32 v251, 0x3d000000, v251
    v_mul_f32_e64 v248, v250, v251
    v_fmamk_f32 v4, v251, 0x00000000, v248
    v_fmamk_f32 v5, v251, 0x3f800000, v248
    v_fmamk_f32 v6, v251, 0x40000000, v248
    v_fmamk_f32 v7, v251, 0x40400000, v248
    v_cos_f32 v8, v4
    v_cos_f32 v9, v5
    v_cos_f32 v10, v6
    v_cos_f32 v11, v7
    v_sin_f32 v12, v4
    v_sin_f32 v13, v5
    v_sin_f32 v14, v6
    v_sin_f32 v15, v7
    v_cvt_pk_bf16_f32 v4, v8, v12
    v_cvt_pk_bf16_f32 v5, -v12, v8
    v_accvgpr_write_b32 a232, v4
    v_accvgpr_write_b32 a236, v5
    v_cvt_pk_bf16_f32 v4, v9, v13
    v_cvt_pk_bf16_f32 v5, -v13, v9
    v_accvgpr_write_b32 a233, v4
    v_accvgpr_write_b32 a237, v5
    v_cvt_pk_bf16_f32 v4, v10, v14
    v_cvt_pk_bf16_f32 v5, -v14, v10
    v_accvgpr_write_b32 a234, v4
    v_accvgpr_write_b32 a238, v5
    v_cvt_pk_bf16_f32 v4, v11, v15
    v_cvt_pk_bf16_f32 v5, -v15, v11
    v_accvgpr_write_b32 a235, v4
    v_accvgpr_write_b32 a239, v5
    v_cvt_pk_bf16_f32 v4, -v8, -v12
    v_cvt_pk_bf16_f32 v5, v12, -v8
    v_accvgpr_write_b32 a240, v4
    v_accvgpr_write_b32 a244, v5
    v_cvt_pk_bf16_f32 v4, -v9, -v13
    v_cvt_pk_bf16_f32 v5, v13, -v9
    v_accvgpr_write_b32 a241, v4
    v_accvgpr_write_b32 a245, v5
    v_cvt_pk_bf16_f32 v4, -v10, -v14
    v_cvt_pk_bf16_f32 v5, v14, -v10
    v_accvgpr_write_b32 a242, v4
    v_accvgpr_write_b32 a246, v5
    v_cvt_pk_bf16_f32 v4, -v11, -v15
    v_cvt_pk_bf16_f32 v5, v15, -v11
    v_accvgpr_write_b32 a243, v4
    v_accvgpr_write_b32 a247, v5
    v_mul_f32 v251, 0x3d800000, v251
    v_mul_f32 v248, 0x3d800000, v248
    v_fmamk_f32 v4, v251, 0x00000000, v248
    v_fmamk_f32 v5, v251, 0x3f800000, v248
    v_fmamk_f32 v6, v251, 0x40000000, v248
    v_fmamk_f32 v7, v251, 0x40400000, v248
    v_cos_f32 v8, v4
    v_cos_f32 v9, v5
    v_cos_f32 v10, v6
    v_cos_f32 v11, v7
    v_sin_f32 v12, v4
    v_sin_f32 v13, v5
    v_sin_f32 v14, v6
    v_sin_f32 v15, v7
    v_accvgpr_write_b32 a140, v8
    v_accvgpr_write_b32 a148, v12
    v_accvgpr_write_b32 a141, v9
    v_accvgpr_write_b32 a149, v13
    v_accvgpr_write_b32 a142, v10
    v_accvgpr_write_b32 a150, v14
    v_accvgpr_write_b32 a143, v11
    v_accvgpr_write_b32 a151, v15
    v_add_u32 v251, s63, v1
    v_cvt_f32_u32 v251, v251
    v_and_b32_e64 v147, 1, v1
    v_mul_f32 v251, 0x3c800000, v251
    v_mul_u32_u24 v147, 0x8000, v147
    v_mul_f32_e64 v248, v250, v251
    v_lshl_or_b32 v147, v147, 16, v147
    v_fmamk_f32 v4, v251, 0x00000000, v248
    v_fmamk_f32 v5, v251, 0x3f800000, v248
    v_fmamk_f32 v6, v251, 0x40000000, v248
    v_fmamk_f32 v7, v251, 0x40400000, v248
    v_cos_f32 v8, v4
    v_cos_f32 v9, v5
    s_mov_b64 s[16:17], s[44:45]
    s_mov_b32 s18, 2101248
    s_mov_b32 s19, 0x00020000
    s_mov_b64 s[20:21], s[46:47]
    s_mov_b32 s22, 2101248
    s_mov_b32 s23, 0x00020000
    s_lshr_b32 s38, s2, 6
    s_and_b32 s39, s2, 3
    s_lshl2_add_u32 s38, s38, s39
    s_lshl2_add_u32 s38, s38, s34
    s_bfe_u32 s39, s2, 0x10005
    s_bfe_u32 s40, s2, 0x20002
    s_lshl2_add_u32 s39, s39, s40
    s_bfe_u32 s40, s2, 0x10004
    s_lshl1_add_u32 s39, s39, s40
    s_lshl_b32 s39, s39, 7
    s_add_u32 s38, s38, s39
    s_mul_i32 s44, s38, 1026
    s_andn2_b32 s44, s44, 3
    s_add_u32 s45, s44, 65664
    s_sub_u32 s38, 2048, s38
    s_and_b32 s39, s38, 2047
    s_mul_i32 s39, s39, 1026
    s_add_u32 s39, s39, 514
    s_andn2_b32 s46, s39, 3
    s_mul_i32 s39, s38, 1026
    s_sub_u32 s39, s39, 65150
    s_andn2_b32 s47, s39, 3
    v_lshlrev_b32 v192, 3, v0
    v_sub_u32 v193, 504, v192
    s_lshl_b32 s38, s34, 2
    v_add_u32 v184, s38, v1
    v_and_b32_e64 v184, 15, v184
    v_and_or_b32 v184, v0, 48, v184
    s_lshl_b32 s38, s34, 10
    s_add_u32 s38, s38, 131072
    v_lshl_add_u32 v194, v184, 4, s38
    v_lshrrev_b32 v185, 2, v0
    v_and_b32_e64 v186, 3, v0
    v_lshl_add_u32 v184, v186, 2, v185
    v_and_b32_e64 v184, 15, v184
    v_lshl_add_u32 v184, v186, 6, v184
    s_lshl_b32 s38, s34, 8
    s_add_u32 s38, s38, 131072
    v_lshl_add_u32 v195, v184, 4, s38
    s_mov_b64 s[28:29], s[90:91]
    s_mov_b32 s30, 0x800000
    s_waitcnt vmcnt(9)
    v_swap_b32 v97, v98
    v_swap_b32 v101, v102
    v_swap_b32 v98, v100
    v_swap_b32 v99, v101
    s_waitcnt vmcnt(5)
    v_swap_b32 v105, v106
    v_swap_b32 v109, v110
    v_swap_b32 v106, v108
    v_swap_b32 v107, v109
    v_mfma_f32_16x16x32_bf16 v[32:35], v[96:99], a[224:227], 0
    buffer_load_dwordx3 v[196:198], v192, s[16:19], s44 offen
    buffer_load_dwordx3 v[200:202], v192, s[20:23], s44 offen
    s_and_b32 s38, s33, 3
    s_lshr_b32 s39, s32, 2
    v_mfma_f32_16x16x32_bf16 v[36:39], v[96:99], a[228:231], 0
    s_lshl2_add_u32 s38, s38, s39
    s_and_b32 s39, s32, 3
    v_mfma_f32_16x16x32_bf16 v[40:43], v[100:103], a[224:227], 0
    s_lshl2_add_u32 s38, s38, s39
    s_lshl_b32 s39, s34, 7
    v_mfma_f32_16x16x32_bf16 v[44:47], v[100:103], a[228:231], 0
    s_add_u32 s38, s38, s39
    s_lshl_b32 s38, s38, 6
    v_mfma_f32_16x16x32_bf16 v[48:51], v[104:107], a[224:227], 0
    s_lshr_b32 s39, s33, 2
    s_add_u32 s38, s38, s39
    v_mfma_f32_16x16x32_bf16 v[52:55], v[104:107], a[228:231], 0
    s_lshl_b32 s68, s38, 6
    s_lshr_b32 s39, s34, 1
    v_mfma_f32_16x16x32_bf16 v[56:59], v[108:111], a[224:227], 0
    s_lshl1_add_u32 s38, s33, s39
    s_lshr_b32 s39, s38, 4
    v_mfma_f32_16x16x32_bf16 v[60:63], v[108:111], a[228:231], 0
    s_lshl1_add_u32 s39, s39, s6
    s_lshl2_add_u32 s41, s32, s39
    buffer_load_dwordx3 v[204:206], v193, s[16:19], s46 offen
    buffer_load_dwordx3 v[208:210], v193, s[20:23], s46 offen
    s_and_b32 s40, s38, 15
    s_lshl4_add_u32 s41, s41, s40
    s_lshl_b32 s41, s41, 6
    s_nop 0
    v_pk_mul_f32 v[184:185], v[32:33], v[232:233]
    v_pk_mul_f32 v[186:187], v[36:37], v[232:233]
    v_pk_fma_f32 v[184:185], v[36:37], v[240:241], v[184:185]
    v_pk_fma_f32 v[186:187], v[32:33], v[240:241], v[186:187] neg_lo:[1,0,0] neg_hi:[1,0,0]
    v_pk_mul_f32 v[188:189], v[34:35], v[234:235]
    v_pk_mul_f32 v[190:191], v[38:39], v[234:235]
    v_pk_fma_f32 v[188:189], v[38:39], v[242:243], v[188:189]
    v_pk_fma_f32 v[190:191], v[34:35], v[242:243], v[190:191] neg_lo:[1,0,0] neg_hi:[1,0,0]
    v_cvt_pk_bf16_f32 v152, v184, v186
    v_cvt_pk_bf16_f32 v153, v185, v187
    v_cvt_pk_bf16_f32 v154, v188, v190
    v_cvt_pk_bf16_f32 v155, v189, v191
    v_pk_mul_f32 v[184:185], v[40:41], v[236:237]
    v_pk_mul_f32 v[186:187], v[44:45], v[236:237]
    v_pk_fma_f32 v[184:185], v[44:45], v[244:245], v[184:185]
    v_pk_fma_f32 v[186:187], v[40:41], v[244:245], v[186:187] neg_lo:[1,0,0] neg_hi:[1,0,0]
    v_pk_mul_f32 v[188:189], v[42:43], v[238:239]
    v_pk_mul_f32 v[190:191], v[46:47], v[238:239]
    v_pk_fma_f32 v[188:189], v[46:47], v[246:247], v[188:189]
    v_pk_fma_f32 v[190:191], v[42:43], v[246:247], v[190:191] neg_lo:[1,0,0] neg_hi:[1,0,0]
    v_cvt_pk_bf16_f32 v156, v184, v186
    v_cvt_pk_bf16_f32 v157, v185, v187
    v_cvt_pk_bf16_f32 v158, v188, v190
    v_cvt_pk_bf16_f32 v159, v189, v191
    v_pk_mul_f32 v[184:185], v[48:49], v[232:233]
    v_pk_mul_f32 v[186:187], v[52:53], v[232:233]
    v_pk_fma_f32 v[184:185], v[52:53], v[240:241], v[184:185]
    buffer_load_dwordx3 v[212:214], v192, s[16:19], s45 offen
    buffer_load_dwordx3 v[216:218], v192, s[20:23], s45 offen
    v_pk_fma_f32 v[186:187], v[48:49], v[240:241], v[186:187] neg_lo:[1,0,0] neg_hi:[1,0,0]
    v_pk_mul_f32 v[188:189], v[50:51], v[234:235]
    v_pk_mul_f32 v[190:191], v[54:55], v[234:235]
    v_pk_fma_f32 v[188:189], v[54:55], v[242:243], v[188:189]
    v_pk_fma_f32 v[190:191], v[50:51], v[242:243], v[190:191] neg_lo:[1,0,0] neg_hi:[1,0,0]
    v_cvt_pk_bf16_f32 v160, v184, v186
    v_cvt_pk_bf16_f32 v161, v185, v187
    v_cvt_pk_bf16_f32 v162, v188, v190
    v_cvt_pk_bf16_f32 v163, v189, v191
    v_pk_mul_f32 v[184:185], v[56:57], v[236:237]
    v_pk_mul_f32 v[186:187], v[60:61], v[236:237]
    v_pk_fma_f32 v[184:185], v[60:61], v[244:245], v[184:185]
    v_pk_fma_f32 v[186:187], v[56:57], v[244:245], v[186:187] neg_lo:[1,0,0] neg_hi:[1,0,0]
    v_pk_mul_f32 v[188:189], v[58:59], v[238:239]
    v_pk_mul_f32 v[190:191], v[62:63], v[238:239]
    v_pk_fma_f32 v[188:189], v[62:63], v[246:247], v[188:189]
    v_pk_fma_f32 v[190:191], v[58:59], v[246:247], v[190:191] neg_lo:[1,0,0] neg_hi:[1,0,0]
    v_cvt_pk_bf16_f32 v164, v184, v186
    v_cvt_pk_bf16_f32 v165, v185, v187
    v_cvt_pk_bf16_f32 v166, v188, v190
    v_cvt_pk_bf16_f32 v167, v189, v191
    v_mfma_f32_16x16x32_bf16 v[64:67], a[224:227], v[152:155], 0
    s_add_u32 s69, s41, 22282240
    s_lshl_b32 s41, s32, 6
    v_mfma_f32_16x16x32_bf16 v[68:71], a[228:231], v[152:155], 0
    s_add_u32 s39, s39, s41
    buffer_load_dwordx3 v[220:222], v193, s[16:19], s47 offen
    buffer_load_dwordx3 v[224:226], v193, s[20:23], s47 offen
    s_and_b32 s40, s38, 3
    v_mfma_f32_16x16x32_bf16 v[72:75], a[248:251], v[156:159], 0
    s_lshl2_add_u32 s39, s39, s40
    s_bfe_u32 s40, s38, 0x20002
    v_mfma_f32_16x16x32_bf16 v[76:79], a[252:255], v[156:159], 0
    s_lshl2_add_u32 s39, s39, s40
    s_lshl_b32 s39, s39, 8
    v_mfma_f32_16x16x32_bf16 v[80:83], a[224:227], v[160:163], 0
    s_add_u32 s75, s39, 13631488
    s_getreg_b32 s96, hwreg(HW_REG_XCC_ID, 0, 4)
    v_mfma_f32_16x16x32_bf16 v[84:87], a[228:231], v[160:163], 0
    s_and_b32 s38, s2, 31
    s_lshl_b32 s38, s38, 10
    v_mfma_f32_16x16x32_bf16 v[88:91], a[248:251], v[164:167], 0
    s_add_u32 s51, s38, 22364160
    s_and_b32 s38, s2, 0xe0
    v_mfma_f32_16x16x32_bf16 v[92:95], a[252:255], v[164:167], 0
    s_lshl2_add_u32 s70, s38, s51
    v_pk_add_f32 v[32:33], v[64:65], v[72:73]
    v_pk_add_f32 v[40:41], v[64:65], v[72:73] neg_lo:[0,1] neg_hi:[0,1]
    v_pk_add_f32 v[34:35], v[66:67], v[74:75]
    v_pk_add_f32 v[42:43], v[66:67], v[74:75] neg_lo:[0,1] neg_hi:[0,1]
    v_pk_add_f32 v[36:37], v[68:69], v[76:77]
    v_pk_add_f32 v[44:45], v[68:69], v[76:77] neg_lo:[0,1] neg_hi:[0,1]
    v_pk_add_f32 v[38:39], v[70:71], v[78:79]
    v_pk_add_f32 v[46:47], v[70:71], v[78:79] neg_lo:[0,1] neg_hi:[0,1]
    v_pk_add_f32 v[48:49], v[80:81], v[88:89]
    v_pk_add_f32 v[56:57], v[80:81], v[88:89] neg_lo:[0,1] neg_hi:[0,1]
    v_pk_add_f32 v[50:51], v[82:83], v[90:91]
    v_pk_add_f32 v[58:59], v[82:83], v[90:91] neg_lo:[0,1] neg_hi:[0,1]
    v_pk_add_f32 v[52:53], v[84:85], v[92:93]
    v_pk_add_f32 v[60:61], v[84:85], v[92:93] neg_lo:[0,1] neg_hi:[0,1]
    v_pk_add_f32 v[54:55], v[86:87], v[94:95]
    v_pk_add_f32 v[62:63], v[86:87], v[94:95] neg_lo:[0,1] neg_hi:[0,1]
    v_cvt_pk_bf16_f32 v168, v32, v36
    v_cvt_pk_bf16_f32 v169, v48, v52
    ds_write_b64 v252, v[168:169] offset:0
    v_cvt_pk_bf16_f32 v170, v33, v37
    v_cvt_pk_bf16_f32 v171, v49, v53
    ds_write_b64 v252, v[170:171] offset:128
    v_cvt_pk_bf16_f32 v172, v34, v38
    v_cvt_pk_bf16_f32 v173, v50, v54
    ds_write_b64 v252, v[172:173] offset:256
    v_cvt_pk_bf16_f32 v174, v35, v39
    v_cvt_pk_bf16_f32 v175, v51, v55
    ds_write_b64 v252, v[174:175] offset:384
    v_cvt_pk_bf16_f32 v176, v40, -v44
    v_cvt_pk_bf16_f32 v177, v56, -v60
    ds_write_b64 v253, v[176:177] offset:384
    v_cvt_pk_bf16_f32 v178, v41, -v45
    v_cvt_pk_bf16_f32 v179, v57, -v61
    ds_write_b64 v253, v[178:179] offset:256
    v_cvt_pk_bf16_f32 v180, v42, -v46
    v_cvt_pk_bf16_f32 v181, v58, -v62
    ds_write_b64 v253, v[180:181] offset:128
    v_cvt_pk_bf16_f32 v182, v43, -v47
    v_cvt_pk_bf16_f32 v183, v59, -v63
    ds_write_b64 v253, v[182:183] offset:0
    v_lshlrev_b32_e64 v64, 16, v96
    v_and_b32 v68, 0xffff0000, v96
    v_lshlrev_b32_e64 v65, 16, v97
    v_and_b32 v69, 0xffff0000, v97
    v_lshlrev_b32_e64 v66, 16, v98
    v_and_b32 v70, 0xffff0000, v98
    v_lshlrev_b32_e64 v67, 16, v99
    v_and_b32 v71, 0xffff0000, v99
    v_lshlrev_b32_e64 v72, 16, v100
    v_and_b32 v76, 0xffff0000, v100
    v_lshlrev_b32_e64 v73, 16, v101
    v_and_b32 v77, 0xffff0000, v101
    v_lshlrev_b32_e64 v74, 16, v102
    v_and_b32 v78, 0xffff0000, v102
    v_lshlrev_b32_e64 v75, 16, v103
    v_and_b32 v79, 0xffff0000, v103
    v_lshlrev_b32_e64 v80, 16, v104
    v_and_b32 v84, 0xffff0000, v104
    v_lshlrev_b32_e64 v81, 16, v105
    v_and_b32 v85, 0xffff0000, v105
    v_lshlrev_b32_e64 v82, 16, v106
    v_and_b32 v86, 0xffff0000, v106
    v_lshlrev_b32_e64 v83, 16, v107
    v_and_b32 v87, 0xffff0000, v107
    v_lshlrev_b32_e64 v88, 16, v108
    v_and_b32 v92, 0xffff0000, v108
    v_lshlrev_b32_e64 v89, 16, v109
    v_and_b32 v93, 0xffff0000, v109
    v_lshlrev_b32_e64 v90, 16, v110
    v_and_b32 v94, 0xffff0000, v110
    v_lshlrev_b32_e64 v91, 16, v111
    v_and_b32 v95, 0xffff0000, v111
    s_waitcnt lgkmcnt(0) vmcnt(12)
    s_barrier
    ds_read_b64 v[112:113], v254 offset:0
    ds_read_b64 v[114:115], v254 offset:128
    ds_read_b64 v[116:117], v254 offset:256
    ds_read_b64 v[118:119], v254 offset:384
    ds_read_b64 v[120:121], v254 offset:2048
    ds_read_b64 v[122:123], v254 offset:2176
    ds_read_b64 v[124:125], v254 offset:2304
    ds_read_b64 v[126:127], v254 offset:2432
    ds_read_b64 v[232:233], v228 offset:0
    ds_read_b64 v[234:235], v228 offset:2080
    ds_read_b64 v[236:237], v229 offset:512
    ds_read_b64 v[238:239], v229 offset:2592
    ds_read_b64 v[240:241], v229 offset:1024
    ds_read_b64 v[242:243], v229 offset:3104
    ds_read_b64 v[244:245], v229 offset:1536
    ds_read_b64 v[246:247], v229 offset:3616
    s_mul_i32 s35, s62, 2654435761
    s_add_u32 s35, s35, 2135587861
    s_cmp_eq_u32 s34, 0
    s_cselect_b32 s98, s35, 0
    s_cselect_b32 s99, 0, 2.0
    s_waitcnt lgkmcnt(12)
    s_add_u32 m0, s37, 0
    s_nop 0
    buffer_load_dwordx4 v16, s[8:11], s36 offen offset:0 lds
    buffer_load_dwordx4 v17, s[8:11], s36 offen offset:1024 lds
    buffer_load_dwordx4 v18, s[8:11], s36 offen offset:2048 lds
    buffer_load_dwordx4 v19, s[8:11], s36 offen offset:3072 lds
    v_dot2_f32_bf16 v184, v96, v112, 0
    v_dot2_f32_bf16 v185, v104, v112, 0
    v_dot2_f32_bf16 v184, v100, v113, v184
    v_dot2_f32_bf16 v185, v108, v113, v185
    v_dot2_f32_bf16 v184, v97, v114, v184
    v_dot2_f32_bf16 v185, v105, v114, v185
    v_dot2_f32_bf16 v184, v101, v115, v184
    v_dot2_f32_bf16 v185, v109, v115, v185
    v_dot2_f32_bf16 v184, v98, v116, v184
    v_dot2_f32_bf16 v185, v106, v116, v185
    v_dot2_f32_bf16 v184, v102, v117, v184
    v_dot2_f32_bf16 v185, v110, v117, v185
    v_dot2_f32_bf16 v184, v99, v118, v184
    v_dot2_f32_bf16 v185, v107, v118, v185
    v_dot2_f32_bf16 v184, v103, v119, v184
    v_dot2_f32_bf16 v185, v111, v119, v185
    s_waitcnt lgkmcnt(8)
    v_lshlrev_b32 v32, 16, v120
    v_and_b32 v36, 0xffff0000, v120
    v_add_f32_dpp v184, v184, v184 row_ror:8 row_mask:0xf bank_mask:0xf
    v_add_f32_dpp v185, v185, v185 row_ror:8 row_mask:0xf bank_mask:0xf
    v_lshlrev_b32_e64 v40, 16, v121
    v_add_f32_dpp v184, v184, v184 row_ror:4 row_mask:0xf bank_mask:0xf
    v_and_b32 v44, 0xffff0000, v121
    v_add_f32_dpp v185, v185, v185 row_ror:4 row_mask:0xf bank_mask:0xf
    v_lshlrev_b32_e64 v33, 16, v122
    v_add_f32_dpp v184, v184, v184 row_ror:2 row_mask:0xf bank_mask:0xf
    v_and_b32 v37, 0xffff0000, v122
    v_add_f32_dpp v185, v185, v185 row_ror:2 row_mask:0xf bank_mask:0xf
    v_lshlrev_b32_e64 v41, 16, v123
    v_add_f32_dpp v184, v184, v184 row_ror:1 row_mask:0xf bank_mask:0xf
    v_and_b32 v45, 0xffff0000, v123
    v_add_f32_dpp v185, v185, v185 row_ror:1 row_mask:0xf bank_mask:0xf
    v_lshlrev_b32 v34, 16, v124
    s_nop 0
    v_permlane32_swap_b32 v184, v185
    v_and_b32 v38, 0xffff0000, v124
    v_add_f32 v184, v184, v185
    v_lshlrev_b32 v42, 16, v125
    v_mov_b32 v185, v184
    v_and_b32 v46, 0xffff0000, v125
    s_nop 0
    v_permlane16_swap_b32 v184, v185
    v_lshlrev_b32 v35, 16, v126
    v_add_f32 v184, v184, v185
    v_and_b32 v39, 0xffff0000, v126
    v_cvt_pk_bf16_f32 v184, v184, v184
    v_lshlrev_b32 v43, 16, v127
    v_lshlrev_b32 v184, 16, v184
    v_and_b32 v47, 0xffff0000, v127
    v_mul_f32 v184, 0xbfb8aa3b, v184
    v_pk_mul_f32 v[64:65], v[64:65], v[32:33]
    v_exp_f32 v184, v184
    s_nop 0
    v_add_f32_e64 v184, 1.0, v184
    v_pk_mul_f32 v[66:67], v[66:67], v[34:35]
    v_rcp_f32_e64 v184, v184
    s_bfe_u32 s36, s66, 262148
    s_add_u32 m0, s37, 32768
    s_lshl_b32 s36, s36, 7
    s_nop 0
    buffer_load_dwordx4 v16, s[8:11], s36 offen offset:0 lds
    buffer_load_dwordx4 v17, s[8:11], s36 offen offset:1024 lds
    buffer_load_dwordx4 v18, s[8:11], s36 offen offset:2048 lds
    buffer_load_dwordx4 v19, s[8:11], s36 offen offset:3072 lds
    v_pk_mul_f32 v[68:69], v[68:69], v[36:37]
    v_cvt_pk_bf16_f32 v184, v184, v184
    v_pk_mul_f32 v[70:71], v[70:71], v[38:39]
    v_lshlrev_b32_e64 v184, 16, v184
    v_pk_mul_f32 v[72:73], v[72:73], v[40:41]
    v_sub_f32_e64 v252, 1.0, v184
    v_pk_mul_f32 v[74:75], v[74:75], v[42:43]
    v_cvt_pk_bf16_f32 v252, v252, v252
    v_pk_mul_f32 v[76:77], v[76:77], v[44:45]
    v_lshlrev_b32_e64 v252, 16, v252
    v_pk_mul_f32 v[78:79], v[78:79], v[46:47]
    v_mov_b32_e64 v185, v184
    v_pk_mul_f32 v[80:81], v[80:81], v[32:33]
    v_mov_b32_e64 v253, v252
    v_pk_mul_f32 v[82:83], v[82:83], v[34:35]
    v_permlane32_swap_b32 v184, v185
    v_pk_mul_f32 v[84:85], v[84:85], v[36:37]
    v_permlane32_swap_b32 v252, v253
    v_pk_mul_f32 v[86:87], v[86:87], v[38:39]
    v_cmp_gt_u32_e64 vcc, 8, v0
    v_pk_mul_f32 v[88:89], v[88:89], v[40:41]
    v_lshlrev_b32_e64 v254, 3, v0
    v_pk_mul_f32 v[90:91], v[90:91], v[42:43]
    v_accvgpr_write_b32 a168, v184
    v_pk_mul_f32 v[92:93], v[92:93], v[44:45]
    v_accvgpr_write_b32 a169, v185
    v_pk_mul_f32 v[94:95], v[94:95], v[46:47]
    v_cndmask_b32_e64 v254, 2.0, v254, vcc
    v_pk_mul_f32 v[64:65], v[64:65], v[252:253] op_sel_hi:[1,0]
    v_pk_mul_f32 v[66:67], v[66:67], v[252:253] op_sel_hi:[1,0]
    v_pk_mul_f32 v[68:69], v[68:69], v[252:253] op_sel_hi:[1,0]
    v_pk_mul_f32 v[70:71], v[70:71], v[252:253] op_sel_hi:[1,0]
    v_cvt_pk_bf16_f32 v190, v64, v68
    v_accvgpr_write_b32 a152, v190
    v_cvt_pk_bf16_f32 v191, v65, v69
    v_accvgpr_write_b32 a153, v191
    v_cvt_pk_bf16_f32 v190, v66, v70
    v_accvgpr_write_b32 a154, v190
    v_cvt_pk_bf16_f32 v191, v67, v71
    v_accvgpr_write_b32 a155, v191
    v_pk_mul_f32 v[72:73], v[72:73], v[252:253] op_sel_hi:[1,0]
    v_pk_mul_f32 v[74:75], v[74:75], v[252:253] op_sel_hi:[1,0]
    v_pk_mul_f32 v[76:77], v[76:77], v[252:253] op_sel_hi:[1,0]
    v_pk_mul_f32 v[78:79], v[78:79], v[252:253] op_sel_hi:[1,0]
    v_cvt_pk_bf16_f32 v190, v72, v76
    v_accvgpr_write_b32 a156, v190
    v_cvt_pk_bf16_f32 v191, v73, v77
    v_accvgpr_write_b32 a157, v191
    v_cvt_pk_bf16_f32 v190, v74, v78
    v_accvgpr_write_b32 a158, v190
    v_cvt_pk_bf16_f32 v191, v75, v79
    v_accvgpr_write_b32 a159, v191
    v_pk_mul_f32 v[80:81], v[80:81], v[252:253] op_sel:[0,1]
    v_pk_mul_f32 v[82:83], v[82:83], v[252:253] op_sel:[0,1]
    v_pk_mul_f32 v[84:85], v[84:85], v[252:253] op_sel:[0,1]
    s_add_u32 m0, s37, 49152
    s_nop 0
    s_nop 0
    buffer_load_dwordx4 v20, s[12:15], s36 offen offset:0 lds
    buffer_load_dwordx4 v21, s[12:15], s36 offen offset:1024 lds
    buffer_load_dwordx4 v22, s[12:15], s36 offen offset:2048 lds
    buffer_load_dwordx4 v23, s[12:15], s36 offen offset:3072 lds
    v_pk_mul_f32 v[86:87], v[86:87], v[252:253] op_sel:[0,1]
    v_cvt_pk_bf16_f32 v190, v80, v84
    v_accvgpr_write_b32 a160, v190
    v_cvt_pk_bf16_f32 v191, v81, v85
    v_accvgpr_write_b32 a161, v191
    v_cvt_pk_bf16_f32 v190, v82, v86
    v_accvgpr_write_b32 a162, v190
    v_cvt_pk_bf16_f32 v191, v83, v87
    v_accvgpr_write_b32 a163, v191
    v_pk_mul_f32 v[88:89], v[88:89], v[252:253] op_sel:[0,1]
    v_pk_mul_f32 v[90:91], v[90:91], v[252:253] op_sel:[0,1]
    v_pk_mul_f32 v[92:93], v[92:93], v[252:253] op_sel:[0,1]
    v_pk_mul_f32 v[94:95], v[94:95], v[252:253] op_sel:[0,1]
    v_cvt_pk_bf16_f32 v190, v88, v92
    v_accvgpr_write_b32 a164, v190
    v_cvt_pk_bf16_f32 v191, v89, v93
    v_accvgpr_write_b32 a165, v191
    v_cvt_pk_bf16_f32 v190, v90, v94
    v_accvgpr_write_b32 a166, v190
    v_cvt_pk_bf16_f32 v191, v91, v95
    v_accvgpr_write_b32 a167, v191
    v_cos_f32 v10, v6
    v_cos_f32 v11, v7
    v_sin_f32 v12, v4
    v_sin_f32 v13, v5
    v_sin_f32 v14, v6
    v_sin_f32 v15, v7
    v_cvt_pk_bf16_f32 v4, v8, v12
    v_cvt_pk_bf16_f32 v5, -v12, v8
    v_accvgpr_write_b32 a0, v4
    v_accvgpr_write_b32 a4, v5
    v_xor_b32 v4, v147, v4
    v_xor_b32 v5, v147, v5
    v_accvgpr_write_b32 a16, v4
    v_accvgpr_write_b32 a20, v5
    v_cvt_pk_bf16_f32 v4, v9, v13
    v_cvt_pk_bf16_f32 v5, -v13, v9
    v_accvgpr_write_b32 a1, v4
    v_accvgpr_write_b32 a5, v5
    v_xor_b32 v4, v147, v4
    v_xor_b32 v5, v147, v5
    v_accvgpr_write_b32 a17, v4
    v_accvgpr_write_b32 a21, v5
    v_cvt_pk_bf16_f32 v4, v10, v14
    v_cvt_pk_bf16_f32 v5, -v14, v10
    v_accvgpr_write_b32 a2, v4
    v_accvgpr_write_b32 a6, v5
    v_xor_b32 v4, v147, v4
    v_xor_b32 v5, v147, v5
    v_accvgpr_write_b32 a18, v4
    v_accvgpr_write_b32 a22, v5
    v_cvt_pk_bf16_f32 v4, v11, v15
    s_lshl2_add_u32 s3, s33, s34
    s_lshl_b32 s3, s3, 4
    v_add_lshl_u32 v145, v1, s3, 1
    s_nop 0
    global_load_ushort v142, v145, s[52:53]
    global_load_ushort v143, v145, s[54:55]
    global_load_ushort v144, v145, s[84:85]
    v_cvt_pk_bf16_f32 v5, -v15, v11
    v_accvgpr_write_b32 a3, v4
    v_accvgpr_write_b32 a7, v5
    v_xor_b32 v4, v147, v4
    v_xor_b32_e64 v5, v147, v5
    v_accvgpr_write_b32 a19, v4
    v_accvgpr_write_b32 a23, v5
    v_fmamk_f32 v4, v251, 0x41800000, v248
    v_fmamk_f32 v5, v251, 0x41880000, v248
    v_fmamk_f32 v6, v251, 0x41900000, v248
    v_fmamk_f32 v7, v251, 0x41980000, v248
    v_cos_f32 v8, v4
    v_cos_f32 v9, v5
    v_cos_f32 v10, v6
    v_cos_f32 v11, v7
    v_sin_f32 v12, v4
    v_sin_f32 v13, v5
    v_sin_f32 v14, v6
    v_sin_f32 v15, v7
    v_cvt_pk_bf16_f32 v4, v8, v12
    v_cvt_pk_bf16_f32 v5, -v12, v8
    v_accvgpr_write_b32 a8, v4
    v_accvgpr_write_b32 a12, v5
    v_xor_b32 v4, v147, v4
    v_xor_b32 v5, v147, v5
    v_accvgpr_write_b32 a24, v4
    v_accvgpr_write_b32 a28, v5
    v_cvt_pk_bf16_f32 v4, v9, v13
    v_cvt_pk_bf16_f32 v5, -v13, v9
    v_accvgpr_write_b32 a9, v4
    v_accvgpr_write_b32 a13, v5
    v_xor_b32_e64 v4, v147, v4
    s_bfe_u32 s36, s66, 262152
    s_add_u32 m0, s37, 65536
    s_lshl_b32 s36, s36, 7
    buffer_load_dwordx4 v16, s[8:11], s36 offen offset:0 lds
    buffer_load_dwordx4 v17, s[8:11], s36 offen offset:1024 lds
    buffer_load_dwordx4 v18, s[8:11], s36 offen offset:2048 lds
    buffer_load_dwordx4 v19, s[8:11], s36 offen offset:3072 lds
    v_xor_b32 v5, v147, v5
    v_accvgpr_write_b32 a25, v4
    v_accvgpr_write_b32 a29, v5
    v_cvt_pk_bf16_f32 v4, v10, v14
    v_cvt_pk_bf16_f32 v5, -v14, v10
    v_accvgpr_write_b32 a10, v4
    v_accvgpr_write_b32 a14, v5
    v_xor_b32 v4, v147, v4
    v_xor_b32 v5, v147, v5
    v_accvgpr_write_b32 a26, v4
    v_accvgpr_write_b32 a30, v5
    v_cvt_pk_bf16_f32 v4, v11, v15
    v_cvt_pk_bf16_f32 v5, -v15, v11
    v_accvgpr_write_b32 a11, v4
    v_accvgpr_write_b32 a15, v5
    v_xor_b32 v4, v147, v4
    v_xor_b32 v5, v147, v5
    v_accvgpr_write_b32 a27, v4
    v_accvgpr_write_b32 a31, v5
    s_add_u32 m0, s37, 81920
    s_nop 0
    buffer_load_dwordx4 v20, s[12:15], s36 offen offset:0 lds
    buffer_load_dwordx4 v21, s[12:15], s36 offen offset:1024 lds
    buffer_load_dwordx4 v22, s[12:15], s36 offen offset:2048 lds
    buffer_load_dwordx4 v23, s[12:15], s36 offen offset:3072 lds
    s_waitcnt lgkmcnt(0) vmcnt(19)
    s_barrier
    s_nop 0
    ds_read_b128 a[64:67], v26 offset:0
    ds_read_b128 a[68:71], v26 offset:8192
    ds_read_b128 a[32:35], v24 offset:0
    ds_read_b128 a[36:39], v24 offset:2048
    ds_read_b128 a[40:43], v24 offset:4096
    ds_read_b128 a[44:47], v24 offset:6144
    ds_read_b128 a[48:51], v24 offset:8192
    ds_read_b128 a[52:55], v24 offset:10240
    ds_read_b128 a[56:59], v24 offset:12288
    ds_read_b128 a[60:63], v24 offset:14336
    s_bfe_u32 s36, s66, 262156
    s_add_u32 m0, s37, 98304
    s_lshl_b32 s36, s36, 7
    buffer_load_dwordx4 v16, s[8:11], s36 offen offset:0 lds
    buffer_load_dwordx4 v17, s[8:11], s36 offen offset:1024 lds
    buffer_load_dwordx4 v18, s[8:11], s36 offen offset:2048 lds
    s_waitcnt lgkmcnt(0)
    v_mfma_f32_16x16x32_bf16 v[32:35], a[32:35], a[64:67], 0
    ds_read_b128 a[104:107], v27 offset:0
    buffer_load_dwordx4 v19, s[8:11], s36 offen offset:3072 lds
    v_mfma_f32_16x16x32_bf16 v[36:39], a[32:35], a[68:71], 0
    ds_read_b128 a[108:111], v27 offset:8192
    v_mfma_f32_16x16x32_bf16 v[40:43], a[36:39], a[64:67], 0
    ds_read_b128 a[72:75], v25 offset:0
    s_add_u32 m0, s37, 114688
    v_mfma_f32_16x16x32_bf16 v[44:47], a[36:39], a[68:71], 0
    ds_read_b128 a[76:79], v25 offset:2048
    v_mfma_f32_16x16x32_bf16 v[48:51], a[40:43], a[64:67], 0
    ds_read_b128 a[80:83], v25 offset:4096
    v_mfma_f32_16x16x32_bf16 v[52:55], a[40:43], a[68:71], 0
    ds_read_b128 a[84:87], v25 offset:6144
    buffer_load_dwordx4 v20, s[12:15], s36 offen offset:0 lds
    v_mfma_f32_16x16x32_bf16 v[56:59], a[44:47], a[64:67], 0
    ds_read_b128 a[88:91], v25 offset:8192
    v_mov_b32_e64 v28, s96
    v_mfma_f32_16x16x32_bf16 v[60:63], a[44:47], a[68:71], 0
    ds_read_b128 a[92:95], v25 offset:10240
    buffer_store_dword v28, v30, s[24:27], s70 offen sc1
    v_mfma_f32_16x16x32_bf16 v[64:67], a[48:51], a[64:67], 0
    ds_read_b128 a[96:99], v25 offset:12288
    buffer_load_dwordx4 v21, s[12:15], s36 offen offset:1024 lds
    buffer_store_dwordx2 v[252:253], v254, s[24:27], s69 offen sc1
    v_mfma_f32_16x16x32_bf16 v[68:71], a[48:51], a[68:71], 0
    ds_read_b128 a[100:103], v25 offset:14336
    v_mfma_f32_16x16x32_bf16 v[72:75], a[52:55], a[64:67], 0
    buffer_load_dwordx4 v22, s[12:15], s36 offen offset:2048 lds
    v_mfma_f32_16x16x32_bf16 v[76:79], a[52:55], a[68:71], 0
    v_mfma_f32_16x16x32_bf16 v[80:83], a[56:59], a[64:67], 0
    v_mfma_f32_16x16x32_bf16 v[84:87], a[56:59], a[68:71], 0
    buffer_load_dwordx4 v23, s[12:15], s36 offen offset:3072 lds
    v_mfma_f32_16x16x32_bf16 v[88:91], a[60:63], a[64:67], 0
    v_mfma_f32_16x16x32_bf16 v[92:95], a[60:63], a[68:71], 0
    s_waitcnt lgkmcnt(0) vmcnt(21)
    s_barrier
    v_mfma_f32_16x16x32_bf16 v[32:35], a[72:75], a[104:107], v[32:35]
    ds_read_b128 a[64:67], v26 offset:32768
    s_bfe_u32 s36, s66, 262160
    s_mov_b32 s76, 0x05040100
    v_mfma_f32_16x16x32_bf16 v[36:39], a[72:75], a[108:111], v[36:39]
    ds_read_b128 a[68:71], v26 offset:40960
    s_mov_b32 s77, 0x07060302
    s_lshl_b32 s38, s6, 4
    v_mfma_f32_16x16x32_bf16 v[40:43], a[76:79], a[104:107], v[40:43]
    ds_read_b128 a[32:35], v24 offset:32768
    s_add_u32 m0, s37, 0
    s_xor_b32 s39, s38, 16
    v_alignbit_b32 v196, v197, v196, s38
    v_mfma_f32_16x16x32_bf16 v[44:47], a[76:79], a[108:111], v[44:47]
    ds_read_b128 a[36:39], v24 offset:34816
    v_alignbit_b32 v197, v198, v197, s38
    v_mfma_f32_16x16x32_bf16 v[48:51], a[80:83], a[104:107], v[48:51]
    ds_read_b128 a[40:43], v24 offset:36864
    v_lshrrev_b32 v198, s38, v198
    v_alignbit_b32 v200, v201, v200, s38
    v_mfma_f32_16x16x32_bf16 v[52:55], a[80:83], a[108:111], v[52:55]
    ds_read_b128 a[44:47], v24 offset:38912
    s_lshl_b32 s36, s36, 7
    v_alignbit_b32 v201, v202, v201, s38
    v_lshrrev_b32 v202, s38, v202
    v_mfma_f32_16x16x32_bf16 v[56:59], a[84:87], a[104:107], v[56:59]
    ds_read_b128 a[48:51], v24 offset:40960
    v_alignbit_b32 v204, v205, v204, s39
    v_alignbit_b32 v205, v206, v205, s39
    buffer_store_dwordx4 v[232:235], v230, s[28:31], s68 offen sc1
    v_mfma_f32_16x16x32_bf16 v[60:63], a[84:87], a[108:111], v[60:63]
    ds_read_b128 a[52:55], v24 offset:43008
    v_alignbit_b32 v208, v209, v208, s39
    v_mfma_f32_16x16x32_bf16 v[64:67], a[88:91], a[104:107], v[64:67]
    ds_read_b128 a[56:59], v24 offset:45056
    buffer_load_dwordx4 v16, s[8:11], s36 offen offset:0 lds
    v_alignbit_b32 v209, v210, v209, s39
    v_alignbit_b32 v212, v213, v212, s38
    s_add_u32 s68, s68, 2097152
    v_mfma_f32_16x16x32_bf16 v[68:71], a[88:91], a[108:111], v[68:71]
    ds_read_b128 a[60:63], v24 offset:47104
    v_alignbit_b32 v213, v214, v213, s38
    v_lshrrev_b32_e64 v214, s38, v214
    v_mfma_f32_16x16x32_bf16 v[72:75], a[92:95], a[104:107], v[72:75]
    buffer_load_dwordx4 v17, s[8:11], s36 offen offset:1024 lds
    v_alignbit_b32 v216, v217, v216, s38
    v_alignbit_b32 v217, v218, v217, s38
    v_mfma_f32_16x16x32_bf16 v[76:79], a[92:95], a[108:111], v[76:79]
    v_lshrrev_b32_e64 v218, s38, v218
    v_mfma_f32_16x16x32_bf16 v[80:83], a[96:99], a[104:107], v[80:83]
    v_alignbit_b32 v220, v221, v220, s39
    v_alignbit_b32 v221, v222, v221, s39
    v_mfma_f32_16x16x32_bf16 v[84:87], a[96:99], a[108:111], v[84:87]
    buffer_load_dwordx4 v18, s[8:11], s36 offen offset:2048 lds
    v_alignbit_b32 v224, v225, v224, s39
    v_alignbit_b32 v225, v226, v225, s39
    v_mfma_f32_16x16x32_bf16 v[88:91], a[100:103], a[104:107], v[88:91]
    v_perm_b32 v184, v202, v198, s76
    v_perm_b32 v186, v218, v214, s76
    v_mfma_f32_16x16x32_bf16 v[92:95], a[100:103], a[108:111], v[92:95]
    ds_write_b128 v194, v[184:187] offset:16384
    s_waitcnt lgkmcnt(1)
    v_mfma_f32_16x16x32_bf16 v[32:35], a[32:35], a[64:67], v[32:35]
    ds_read_b128 a[104:107], v27 offset:32768
    buffer_load_dwordx4 v19, s[8:11], s36 offen offset:3072 lds
    v_perm_b32 v152, v200, v196, s76
    v_perm_b32 v153, v209, v205, s77
    v_mfma_f32_16x16x32_bf16 v[36:39], a[32:35], a[68:71], v[36:39]
    ds_read_b128 a[108:111], v27 offset:40960
    v_perm_b32 v154, v216, v212, s76
    v_perm_b32 v155, v225, v221, s77
    v_mfma_f32_16x16x32_bf16 v[40:43], a[36:39], a[64:67], v[40:43]
    ds_read_b128 a[72:75], v25 offset:32768
    s_add_u32 m0, s37, 16384
    ds_write_b128 v194, v[152:155] offset:0
    v_perm_b32 v156, v200, v196, s77
    v_mfma_f32_16x16x32_bf16 v[44:47], a[36:39], a[68:71], v[44:47]
    ds_read_b128 a[76:79], v25 offset:34816
    v_perm_b32 v157, v209, v205, s76
    v_perm_b32 v158, v216, v212, s77
    v_mfma_f32_16x16x32_bf16 v[48:51], a[40:43], a[64:67], v[48:51]
    ds_read_b128 a[80:83], v25 offset:36864
    v_perm_b32 v159, v225, v221, s76
    ds_write_b128 v194, v[156:159] offset:4096
    v_mfma_f32_16x16x32_bf16 v[52:55], a[40:43], a[68:71], v[52:55]
    ds_read_b128 a[84:87], v25 offset:38912
    buffer_load_dwordx4 v20, s[12:15], s36 offen offset:0 lds
    v_perm_b32 v160, v201, v197, s76
    v_mfma_f32_16x16x32_bf16 v[56:59], a[44:47], a[64:67], v[56:59]
    ds_read_b128 a[88:91], v25 offset:40960
    v_perm_b32 v161, v208, v204, s77
    v_perm_b32 v162, v217, v213, s76
    buffer_store_dwordx4 v[236:239], v230, s[28:31], s68 offen sc1
    v_mfma_f32_16x16x32_bf16 v[60:63], a[44:47], a[68:71], v[60:63]
    ds_read_b128 a[92:95], v25 offset:43008
    v_perm_b32 v163, v224, v220, s77
    ds_write_b128 v194, v[160:163] offset:8192
    v_mfma_f32_16x16x32_bf16 v[64:67], a[48:51], a[64:67], v[64:67]
    ds_read_b128 a[96:99], v25 offset:45056
    buffer_load_dwordx4 v21, s[12:15], s36 offen offset:1024 lds
    v_perm_b32 v164, v201, v197, s77
    v_perm_b32 v165, v208, v204, s76
    s_add_u32 s68, s68, 2097152
    v_mfma_f32_16x16x32_bf16 v[68:71], a[48:51], a[68:71], v[68:71]
    ds_read_b128 a[100:103], v25 offset:47104
    v_perm_b32 v166, v217, v213, s77
    v_perm_b32 v167, v224, v220, s76
    v_mfma_f32_16x16x32_bf16 v[72:75], a[52:55], a[64:67], v[72:75]
    buffer_load_dwordx4 v22, s[12:15], s36 offen offset:2048 lds
    ds_write_b128 v194, v[164:167] offset:12288
    v_mfma_f32_16x16x32_bf16 v[76:79], a[52:55], a[68:71], v[76:79]
    v_bfe_u32 v189, v0, 2, 2
    v_lshl_add_u32 v228, v189, 8, v231
    v_mfma_f32_16x16x32_bf16 v[80:83], a[56:59], a[64:67], v[80:83]
    v_lshl_add_u32 v189, v189, 12, v195
    v_xor_b32 v190, 0x1000, v189
    v_mfma_f32_16x16x32_bf16 v[84:87], a[56:59], a[68:71], v[84:87]
    buffer_load_dwordx4 v23, s[12:15], s36 offen offset:3072 lds
    v_xor_b32 v191, 0x2000, v189
    v_xor_b32 v192, 0x3000, v189
    v_mfma_f32_16x16x32_bf16 v[88:91], a[60:63], a[64:67], v[88:91]
    v_xor_b32 v229, 0x100, v228
    v_xor_b32 v231, 0x200, v228
    v_mfma_f32_16x16x32_bf16 v[92:95], a[60:63], a[68:71], v[92:95]
    v_xor_b32 v193, 0x300, v228
    s_waitcnt lgkmcnt(0) vmcnt(20)
    s_barrier
    v_mfma_f32_16x16x32_bf16 v[32:35], a[72:75], a[104:107], v[32:35]
    ds_read_b128 a[64:67], v150 offset:0
    s_bfe_u32 s36, s66, 262164
    ds_read_b128 v[184:187], v195 offset:16384
    ds_read_b128 v[168:171], v189
    v_mfma_f32_16x16x32_bf16 v[36:39], a[72:75], a[108:111], v[36:39]
    ds_read_b128 a[68:71], v150 offset:8192
    ds_read_b128 v[172:175], v190
    v_mfma_f32_16x16x32_bf16 v[40:43], a[76:79], a[104:107], v[40:43]
    ds_read_b128 a[32:35], v148 offset:0
    s_add_u32 m0, s37, 32768
    ds_read_b128 v[176:179], v191
    v_mfma_f32_16x16x32_bf16 v[44:47], a[76:79], a[108:111], v[44:47]
    ds_read_b128 a[36:39], v148 offset:2048
    ds_read_b128 v[180:183], v192
    v_mfma_f32_16x16x32_bf16 v[48:51], a[80:83], a[104:107], v[48:51]
    ds_read_b128 a[40:43], v148 offset:4096
    s_lshr_b32 s40, s2, 2
    v_mfma_f32_16x16x32_bf16 v[52:55], a[80:83], a[108:111], v[52:55]
    ds_read_b128 a[44:47], v148 offset:6144
    s_lshl_b32 s36, s36, 7
    s_lshl_b32 s41, s34, 9
    v_mfma_f32_16x16x32_bf16 v[56:59], a[84:87], a[104:107], v[56:59]
    ds_read_b128 a[48:51], v148 offset:8192
    s_add_u32 s40, s40, s41
    v_mfma_f32_16x16x32_bf16 v[60:63], a[84:87], a[108:111], v[60:63]
    ds_read_b128 a[52:55], v148 offset:10240
    s_add_u32 s40, s40, 64
    v_mfma_f32_16x16x32_bf16 v[64:67], a[88:91], a[104:107], v[64:67]
    ds_read_b128 a[56:59], v148 offset:12288
    buffer_load_dwordx4 v16, s[8:11], s36 offen offset:0 lds
    s_lshl_b32 s40, s40, 6
    s_and_b32 s41, s2, 3
    v_mfma_f32_16x16x32_bf16 v[68:71], a[88:91], a[108:111], v[68:71]
    ds_read_b128 a[60:63], v148 offset:14336
    s_add_u32 s40, s40, s41
    v_mfma_f32_16x16x32_bf16 v[72:75], a[92:95], a[104:107], v[72:75]
    buffer_load_dwordx4 v17, s[8:11], s36 offen offset:1024 lds
    s_lshl_b32 s76, s40, 6
    v_mfma_f32_16x16x32_bf16 v[76:79], a[92:95], a[108:111], v[76:79]
    s_lshl_b32 s40, s34, 10
    v_mfma_f32_16x16x32_bf16 v[80:83], a[96:99], a[104:107], v[80:83]
    v_add_u32 v188, s40, v3
    v_mfma_f32_16x16x32_bf16 v[84:87], a[96:99], a[108:111], v[84:87]
    buffer_load_dwordx4 v18, s[8:11], s36 offen offset:2048 lds
    v_subrev_u32 v188, 4032, v188
    v_mfma_f32_16x16x32_bf16 v[88:91], a[100:103], a[104:107], v[88:91]
    v_min_u32_e64 v188, 2.0, v188
    v_mfma_f32_16x16x32_bf16 v[92:95], a[100:103], a[108:111], v[92:95]
    s_lshl_b32 s77, s2, 6
    s_waitcnt lgkmcnt(0)
    v_mfma_f32_16x16x32_bf16 v[32:35], a[32:35], a[64:67], v[32:35]
    ds_read_b128 a[104:107], v151 offset:0
    buffer_load_dwordx4 v19, s[8:11], s36 offen offset:3072 lds
    s_and_b32 s38, s32, 3
    v_mfma_f32_16x16x32_bf16 v[36:39], a[32:35], a[68:71], v[36:39]
    ds_read_b128 a[108:111], v151 offset:8192
    s_mov_b32 s97, 1985229328
    v_mfma_f32_16x16x32_bf16 v[40:43], a[36:39], a[64:67], v[40:43]
    ds_read_b128 a[72:75], v149 offset:0
    s_add_u32 m0, s37, 49152
    s_cmp_eq_u32 s38, 1
    s_cselect_b32 s97, 561402928, s97
    v_mfma_f32_16x16x32_bf16 v[44:47], a[36:39], a[68:71], v[44:47]
    ds_read_b128 a[76:79], v149 offset:2048
    v_mfma_f32_16x16x32_bf16 v[48:51], a[40:43], a[64:67], v[48:51]
    ds_read_b128 a[80:83], v149 offset:4096
    s_cmp_eq_u32 s38, 2
    s_cselect_b32 s97, 1126266448, s97
    v_mfma_f32_16x16x32_bf16 v[52:55], a[40:43], a[68:71], v[52:55]
    ds_read_b128 a[84:87], v149 offset:6144
    buffer_load_dwordx4 v20, s[12:15], s36 offen offset:0 lds
    s_cmp_eq_u32 s38, 3
    s_cselect_b32 s97, 1698898288, s97
    v_mfma_f32_16x16x32_bf16 v[56:59], a[44:47], a[64:67], v[56:59]
    ds_read_b128 a[88:91], v149 offset:8192
    buffer_store_dwordx4 v[240:243], v230, s[28:31], s68 offen sc1
    v_mfma_f32_16x16x32_bf16 v[60:63], a[44:47], a[68:71], v[60:63]
    ds_read_b128 a[92:95], v149 offset:10240
    s_lshr_b32 s38, s2, 5
    v_mfma_f32_16x16x32_bf16 v[64:67], a[48:51], a[64:67], v[64:67]
    ds_read_b128 a[96:99], v149 offset:12288
    buffer_load_dwordx4 v21, s[12:15], s36 offen offset:1024 lds
    s_mul_i32 s38, s38, 0x11111111
    s_add_u32 s68, s68, 2097152
    v_mfma_f32_16x16x32_bf16 v[68:71], a[48:51], a[68:71], v[68:71]
    ds_read_b128 a[100:103], v149 offset:14336
    v_mfma_f32_16x16x32_bf16 v[72:75], a[52:55], a[64:67], v[72:75]
    buffer_load_dwordx4 v22, s[12:15], s36 offen offset:2048 lds
    s_add_u32 s97, s97, s38
    v_mfma_f32_16x16x32_bf16 v[76:79], a[52:55], a[68:71], v[76:79]
    s_and_b32 s97, s97, 0x77777777
    v_mfma_f32_16x16x32_bf16 v[80:83], a[56:59], a[64:67], v[80:83]
    v_mfma_f32_16x16x32_bf16 v[84:87], a[56:59], a[68:71], v[84:87]
    buffer_load_dwordx4 v23, s[12:15], s36 offen offset:3072 lds
    s_lshl_b32 s38, s33, 6
    v_mfma_f32_16x16x32_bf16 v[88:91], a[60:63], a[64:67], v[88:91]
    s_add_u32 s38, s38, s34
    v_mfma_f32_16x16x32_bf16 v[92:95], a[60:63], a[68:71], v[92:95]
    s_waitcnt lgkmcnt(0) vmcnt(19)
    s_barrier
    v_mfma_f32_16x16x32_bf16 v[32:35], a[72:75], a[104:107], v[32:35]
    ds_read_b128 a[64:67], v150 offset:32768
    s_bfe_u32 s36, s66, 262168
    s_lshl_b32 s38, s38, 8
    v_mfma_f32_16x16x32_bf16 v[36:39], a[72:75], a[108:111], v[36:39]
    ds_read_b128 a[68:71], v150 offset:40960
    s_add_u32 s93, s38, 22020096
    v_mfma_f32_16x16x32_bf16 v[40:43], a[76:79], a[104:107], v[40:43]
    ds_read_b128 a[32:35], v148 offset:32768
    s_add_u32 m0, s37, 65536
    s_lshl_b32 s38, s32, 11
    v_mfma_f32_16x16x32_bf16 v[44:47], a[76:79], a[108:111], v[44:47]
    ds_read_b128 a[36:39], v148 offset:34816
    v_mfma_f32_16x16x32_bf16 v[48:51], a[80:83], a[104:107], v[48:51]
    ds_read_b128 a[40:43], v148 offset:36864
    s_add_u32 s38, s38, s33
    v_mfma_f32_16x16x32_bf16 v[52:55], a[80:83], a[108:111], v[52:55]
    ds_read_b128 a[44:47], v148 offset:38912
    s_lshl_b32 s36, s36, 7
    s_lshl_b32 s5, s38, 8
    v_mfma_f32_16x16x32_bf16 v[56:59], a[84:87], a[104:107], v[56:59]
    ds_read_b128 a[48:51], v148 offset:40960
    buffer_store_dwordx4 v[244:247], v230, s[28:31], s68 offen sc1
    v_mfma_f32_16x16x32_bf16 v[60:63], a[84:87], a[108:111], v[60:63]
    ds_read_b128 a[52:55], v148 offset:43008
    s_lshl_b32 s38, s94, 16
    v_mfma_f32_16x16x32_bf16 v[64:67], a[88:91], a[104:107], v[64:67]
    ds_read_b128 a[56:59], v148 offset:45056
    buffer_load_dwordx4 v16, s[8:11], s36 offen offset:0 lds
    s_andn2_b32 s95, s5, 0x700
    v_mfma_f32_16x16x32_bf16 v[68:71], a[88:91], a[108:111], v[68:71]
    ds_read_b128 a[60:63], v148 offset:47104
    v_mfma_f32_16x16x32_bf16 v[72:75], a[92:95], a[104:107], v[72:75]
    buffer_load_dwordx4 v17, s[8:11], s36 offen offset:1024 lds
    s_add_u32 s95, s95, s38
    v_mfma_f32_16x16x32_bf16 v[76:79], a[92:95], a[108:111], v[76:79]
    s_cmp_lt_u32 s34, 2
    s_cselect_b64 s[16:17], s[80:81], s[82:83]
    v_mfma_f32_16x16x32_bf16 v[80:83], a[96:99], a[104:107], v[80:83]
    v_mfma_f32_16x16x32_bf16 v[84:87], a[96:99], a[108:111], v[84:87]
    buffer_load_dwordx4 v18, s[8:11], s36 offen offset:2048 lds
    s_mov_b32 s18, 0x200000
    v_mfma_f32_16x16x32_bf16 v[88:91], a[100:103], a[104:107], v[88:91]
    v_mfma_f32_16x16x32_bf16 v[92:95], a[100:103], a[108:111], v[92:95]
    s_waitcnt lgkmcnt(0)
    v_mfma_f32_16x16x32_bf16 v[32:35], a[32:35], a[64:67], v[32:35]
    ds_read_b128 a[104:107], v151 offset:32768
    buffer_load_dwordx4 v19, s[8:11], s36 offen offset:3072 lds
    v_lshlrev_b32_e64 v144, 16, v144
    v_mfma_f32_16x16x32_bf16 v[36:39], a[32:35], a[68:71], v[36:39]
    ds_read_b128 a[108:111], v151 offset:40960
    v_lshlrev_b32_e64 v142, 16, v142
    v_mfma_f32_16x16x32_bf16 v[40:43], a[36:39], a[64:67], v[40:43]
    ds_read_b128 a[72:75], v149 offset:32768
    s_add_u32 m0, s37, 81920
    v_mul_f32 v144, 0x3fb8aa3b, v144
    v_mfma_f32_16x16x32_bf16 v[44:47], a[36:39], a[68:71], v[44:47]
    ds_read_b128 a[76:79], v149 offset:34816
    v_mfma_f32_16x16x32_bf16 v[48:51], a[40:43], a[64:67], v[48:51]
    ds_read_b128 a[80:83], v149 offset:36864
    v_exp_f32_e64 v144, v144
    v_mfma_f32_16x16x32_bf16 v[52:55], a[40:43], a[68:71], v[52:55]
    ds_read_b128 a[84:87], v149 offset:38912
    buffer_load_dwordx4 v20, s[12:15], s36 offen offset:0 lds
    v_lshlrev_b32_e64 v143, 16, v143
    v_mfma_f32_16x16x32_bf16 v[56:59], a[44:47], a[64:67], v[56:59]
    ds_read_b128 a[88:91], v149 offset:40960
    v_mfma_f32_16x16x32_bf16 v[60:63], a[44:47], a[68:71], v[60:63]
    ds_read_b128 a[92:95], v149 offset:43008
    v_cvt_pk_bf16_f32 v144, v144, v144
    v_mfma_f32_16x16x32_bf16 v[64:67], a[48:51], a[64:67], v[64:67]
    ds_read_b128 a[96:99], v149 offset:45056
    buffer_load_dwordx4 v21, s[12:15], s36 offen offset:1024 lds
    v_lshlrev_b32_e64 v144, 16, v144
    buffer_store_dwordx4 v[184:187], v188, s[24:27], s77 offen sc1
    v_mfma_f32_16x16x32_bf16 v[68:71], a[48:51], a[68:71], v[68:71]
    ds_read_b128 a[100:103], v149 offset:47104
    v_mfma_f32_16x16x32_bf16 v[72:75], a[52:55], a[64:67], v[72:75]
    buffer_load_dwordx4 v22, s[12:15], s36 offen offset:2048 lds
    v_mul_f32_e64 v14, v144, v142
    v_mfma_f32_16x16x32_bf16 v[76:79], a[52:55], a[68:71], v[76:79]
    v_mul_f32_e64 v4, v144, v143
    v_mfma_f32_16x16x32_bf16 v[80:83], a[56:59], a[64:67], v[80:83]
    v_mfma_f32_16x16x32_bf16 v[84:87], a[56:59], a[68:71], v[84:87]
    buffer_load_dwordx4 v23, s[12:15], s36 offen offset:3072 lds
    v_mul_f32 v14, 0x3fb8aa3b, v14
    v_mfma_f32_16x16x32_bf16 v[88:91], a[60:63], a[64:67], v[88:91]
    v_mul_f32_e64 v4, 0x3e22f983, v4
    v_mfma_f32_16x16x32_bf16 v[92:95], a[60:63], a[68:71], v[92:95]
    s_waitcnt lgkmcnt(0) vmcnt(19)
    s_barrier
    v_mfma_f32_16x16x32_bf16 v[32:35], a[72:75], a[104:107], v[32:35]
    ds_read_b128 a[64:67], v26 offset:0
    s_bfe_u32 s36, s66, 262172
    v_exp_f32_e64 v14, v14
    v_mfma_f32_16x16x32_bf16 v[36:39], a[72:75], a[108:111], v[36:39]
    ds_read_b128 a[68:71], v26 offset:8192
    v_fract_f32_e64 v4, v4
    v_mfma_f32_16x16x32_bf16 v[40:43], a[76:79], a[104:107], v[40:43]
    ds_read_b128 a[32:35], v24 offset:0
    s_add_u32 m0, s37, 98304
    v_cos_f32_e64 v5, v4
    v_mfma_f32_16x16x32_bf16 v[44:47], a[76:79], a[108:111], v[44:47]
    ds_read_b128 a[36:39], v24 offset:2048
    v_mfma_f32_16x16x32_bf16 v[48:51], a[80:83], a[104:107], v[48:51]
    ds_read_b128 a[40:43], v24 offset:4096
    v_sin_f32_e64 v6, v4
    v_mfma_f32_16x16x32_bf16 v[52:55], a[80:83], a[108:111], v[52:55]
    ds_read_b128 a[44:47], v24 offset:6144
    s_lshl_b32 s36, s36, 7
    v_mul_f32 v128, v14, v5
    v_mfma_f32_16x16x32_bf16 v[56:59], a[84:87], a[104:107], v[56:59]
    ds_read_b128 a[48:51], v24 offset:8192
    v_mfma_f32_16x16x32_bf16 v[60:63], a[84:87], a[108:111], v[60:63]
    ds_read_b128 a[52:55], v24 offset:10240
    v_mul_f32_e64 v129, v14, v6
    v_mfma_f32_16x16x32_bf16 v[64:67], a[88:91], a[104:107], v[64:67]
    ds_read_b128 a[56:59], v24 offset:12288
    buffer_load_dwordx4 v16, s[8:11], s36 offen offset:0 lds
    v_mul_f32_e64 v14, v142, v142
    v_mfma_f32_16x16x32_bf16 v[68:71], a[88:91], a[108:111], v[68:71]
    ds_read_b128 a[60:63], v24 offset:14336
    v_mfma_f32_16x16x32_bf16 v[72:75], a[92:95], a[104:107], v[72:75]
    buffer_load_dwordx4 v17, s[8:11], s36 offen offset:1024 lds
    v_fma_f32 v14, v143, v143, v14
    v_mfma_f32_16x16x32_bf16 v[76:79], a[92:95], a[108:111], v[76:79]
    v_rcp_f32_e64 v14, v14
    v_mfma_f32_16x16x32_bf16 v[80:83], a[96:99], a[104:107], v[80:83]
    v_mfma_f32_16x16x32_bf16 v[84:87], a[96:99], a[108:111], v[84:87]
    buffer_load_dwordx4 v18, s[8:11], s36 offen offset:2048 lds
    v_add_f32_e64 v4, -1.0, v128
    v_mfma_f32_16x16x32_bf16 v[88:91], a[100:103], a[104:107], v[88:91]
    v_add_f32_e64 v14, v14, v14
    v_mfma_f32_16x16x32_bf16 v[92:95], a[100:103], a[108:111], v[92:95]
    s_waitcnt lgkmcnt(0)
    v_mfma_f32_16x16x32_bf16 v[32:35], a[32:35], a[64:67], v[32:35]
    ds_read_b128 a[104:107], v27 offset:0
    buffer_load_dwordx4 v19, s[8:11], s36 offen offset:3072 lds
    v_mul_f32 v5, v4, v142
    v_mfma_f32_16x16x32_bf16 v[36:39], a[32:35], a[68:71], v[36:39]
    ds_read_b128 a[108:111], v27 offset:8192
    v_fma_f32 v5, v129, v143, v5
    v_mfma_f32_16x16x32_bf16 v[40:43], a[36:39], a[64:67], v[40:43]
    ds_read_b128 a[72:75], v25 offset:0
    s_add_u32 m0, s37, 114688
    v_mul_f32_e64 v6, v129, v142
    v_mfma_f32_16x16x32_bf16 v[44:47], a[36:39], a[68:71], v[44:47]
    ds_read_b128 a[76:79], v25 offset:2048
    v_mfma_f32_16x16x32_bf16 v[48:51], a[40:43], a[64:67], v[48:51]
    ds_read_b128 a[80:83], v25 offset:4096
    v_fma_f32 v6, -v4, v143, v6
    v_mfma_f32_16x16x32_bf16 v[52:55], a[40:43], a[68:71], v[52:55]
    ds_read_b128 a[84:87], v25 offset:6144
    buffer_load_dwordx4 v20, s[12:15], s36 offen offset:0 lds
    v_mul_f32_e64 v130, v5, v14
    v_mfma_f32_16x16x32_bf16 v[56:59], a[44:47], a[64:67], v[56:59]
    ds_read_b128 a[88:91], v25 offset:8192
    v_mfma_f32_16x16x32_bf16 v[60:63], a[44:47], a[68:71], v[60:63]
    ds_read_b128 a[92:95], v25 offset:10240
    v_mul_f32_e64 v131, v6, v14
    v_mfma_f32_16x16x32_bf16 v[64:67], a[48:51], a[64:67], v[64:67]
    ds_read_b128 a[96:99], v25 offset:12288
    buffer_load_dwordx4 v21, s[12:15], s36 offen offset:1024 lds
    v_mul_f32_e64 v4, v128, v128
    buffer_store_dwordx4 v[168:171], v228, s[28:31], s76 offen sc1
    v_mfma_f32_16x16x32_bf16 v[68:71], a[48:51], a[68:71], v[68:71]
    ds_read_b128 a[100:103], v25 offset:14336
    v_mfma_f32_16x16x32_bf16 v[72:75], a[52:55], a[64:67], v[72:75]
    buffer_load_dwordx4 v22, s[12:15], s36 offen offset:2048 lds
    v_mul_f32_e64 v5, v128, v129
    v_mfma_f32_16x16x32_bf16 v[76:79], a[52:55], a[68:71], v[76:79]
    v_fma_f32 v4, -v129, v129, v4
    v_mfma_f32_16x16x32_bf16 v[80:83], a[56:59], a[64:67], v[80:83]
    v_mfma_f32_16x16x32_bf16 v[84:87], a[56:59], a[68:71], v[84:87]
    buffer_load_dwordx4 v23, s[12:15], s36 offen offset:3072 lds
    v_add_f32_e64 v5, v5, v5
    v_mfma_f32_16x16x32_bf16 v[88:91], a[60:63], a[64:67], v[88:91]
    v_mul_f32_e64 v6, v4, v4
    v_mfma_f32_16x16x32_bf16 v[92:95], a[60:63], a[68:71], v[92:95]
    s_waitcnt lgkmcnt(0) vmcnt(19)
    s_barrier
    v_mfma_f32_16x16x32_bf16 v[32:35], a[72:75], a[104:107], v[32:35]
    ds_read_b128 a[64:67], v26 offset:32768
    s_bfe_u32 s36, s67, 262144
    v_mul_f32_e64 v7, v4, v5
    v_mfma_f32_16x16x32_bf16 v[36:39], a[72:75], a[108:111], v[36:39]
    ds_read_b128 a[68:71], v26 offset:40960
    v_fma_f32 v6, -v5, v5, v6
    v_mfma_f32_16x16x32_bf16 v[40:43], a[76:79], a[104:107], v[40:43]
    ds_read_b128 a[32:35], v24 offset:32768
    s_add_u32 m0, s37, 0
    v_add_f32 v7, v7, v7
    v_mfma_f32_16x16x32_bf16 v[44:47], a[76:79], a[108:111], v[44:47]
    ds_read_b128 a[36:39], v24 offset:34816
    v_mfma_f32_16x16x32_bf16 v[48:51], a[80:83], a[104:107], v[48:51]
    ds_read_b128 a[40:43], v24 offset:36864
    v_mul_f32_e64 v4, v6, v6
    v_mfma_f32_16x16x32_bf16 v[52:55], a[80:83], a[108:111], v[52:55]
    ds_read_b128 a[44:47], v24 offset:38912
    s_lshl_b32 s36, s36, 7
    v_mul_f32 v5, v6, v7
    v_mfma_f32_16x16x32_bf16 v[56:59], a[84:87], a[104:107], v[56:59]
    ds_read_b128 a[48:51], v24 offset:40960
    v_mfma_f32_16x16x32_bf16 v[60:63], a[84:87], a[108:111], v[60:63]
    ds_read_b128 a[52:55], v24 offset:43008
    v_fma_f32 v4, -v7, v7, v4
    v_mfma_f32_16x16x32_bf16 v[64:67], a[88:91], a[104:107], v[64:67]
    ds_read_b128 a[56:59], v24 offset:45056
    buffer_load_dwordx4 v16, s[8:11], s36 offen offset:0 lds
    v_add_f32_e64 v5, v5, v5
    buffer_store_dwordx4 v[172:175], v229, s[28:31], s76 offen sc1
    v_mfma_f32_16x16x32_bf16 v[68:71], a[88:91], a[108:111], v[68:71]
    ds_read_b128 a[60:63], v24 offset:47104
    v_mfma_f32_16x16x32_bf16 v[72:75], a[92:95], a[104:107], v[72:75]
    buffer_load_dwordx4 v17, s[8:11], s36 offen offset:1024 lds
    v_mul_f32_e64 v132, v4, v4
    v_mfma_f32_16x16x32_bf16 v[76:79], a[92:95], a[108:111], v[76:79]
    v_mul_f32_e64 v133, v4, v5
    v_mfma_f32_16x16x32_bf16 v[80:83], a[96:99], a[104:107], v[80:83]
    v_mfma_f32_16x16x32_bf16 v[84:87], a[96:99], a[108:111], v[84:87]
    buffer_load_dwordx4 v18, s[8:11], s36 offen offset:2048 lds
    v_fma_f32 v132, -v5, v5, v132
    v_mfma_f32_16x16x32_bf16 v[88:91], a[100:103], a[104:107], v[88:91]
    v_add_f32_e64 v133, v133, v133
    v_mfma_f32_16x16x32_bf16 v[92:95], a[100:103], a[108:111], v[92:95]
    s_waitcnt lgkmcnt(0)
    v_mfma_f32_16x16x32_bf16 v[32:35], a[32:35], a[64:67], v[32:35]
    ds_read_b128 a[104:107], v27 offset:32768
    buffer_load_dwordx4 v19, s[8:11], s36 offen offset:3072 lds
    v_mul_f32 v134, v132, v132
    v_mfma_f32_16x16x32_bf16 v[36:39], a[32:35], a[68:71], v[36:39]
    ds_read_b128 a[108:111], v27 offset:40960
    v_mul_f32_e64 v135, v132, v133
    v_mfma_f32_16x16x32_bf16 v[40:43], a[36:39], a[64:67], v[40:43]
    ds_read_b128 a[72:75], v25 offset:32768
    s_add_u32 m0, s37, 16384
    v_fma_f32 v134, -v133, v133, v134
    v_mfma_f32_16x16x32_bf16 v[44:47], a[36:39], a[68:71], v[44:47]
    ds_read_b128 a[76:79], v25 offset:34816
    v_mfma_f32_16x16x32_bf16 v[48:51], a[40:43], a[64:67], v[48:51]
    ds_read_b128 a[80:83], v25 offset:36864
    v_add_f32_e64 v135, v135, v135
    v_mfma_f32_16x16x32_bf16 v[52:55], a[40:43], a[68:71], v[52:55]
    ds_read_b128 a[84:87], v25 offset:38912
    buffer_load_dwordx4 v20, s[12:15], s36 offen offset:0 lds
    v_mul_f32_e64 v8, v134, v134
    v_mfma_f32_16x16x32_bf16 v[56:59], a[44:47], a[64:67], v[56:59]
    ds_read_b128 a[88:91], v25 offset:40960
    v_mfma_f32_16x16x32_bf16 v[60:63], a[44:47], a[68:71], v[60:63]
    ds_read_b128 a[92:95], v25 offset:43008
    v_mul_f32_e64 v9, v134, v135
    v_mfma_f32_16x16x32_bf16 v[64:67], a[48:51], a[64:67], v[64:67]
    ds_read_b128 a[96:99], v25 offset:45056
    buffer_load_dwordx4 v21, s[12:15], s36 offen offset:1024 lds
    v_fma_f32 v8, -v135, v135, v8
    buffer_store_dwordx4 v[176:179], v231, s[28:31], s76 offen sc1
    v_mfma_f32_16x16x32_bf16 v[68:71], a[48:51], a[68:71], v[68:71]
    ds_read_b128 a[100:103], v25 offset:47104
    v_mfma_f32_16x16x32_bf16 v[72:75], a[52:55], a[64:67], v[72:75]
    buffer_load_dwordx4 v22, s[12:15], s36 offen offset:2048 lds
    v_add_f32_e64 v9, v9, v9
    v_mfma_f32_16x16x32_bf16 v[76:79], a[52:55], a[68:71], v[76:79]
    v_mul_f32_e64 v136, v8, v8
    v_mfma_f32_16x16x32_bf16 v[80:83], a[56:59], a[64:67], v[80:83]
    v_mfma_f32_16x16x32_bf16 v[84:87], a[56:59], a[68:71], v[84:87]
    buffer_load_dwordx4 v23, s[12:15], s36 offen offset:3072 lds
    v_mul_f32_e64 v137, v8, v9
    v_mfma_f32_16x16x32_bf16 v[88:91], a[60:63], a[64:67], v[88:91]
    v_fma_f32 v136, -v9, v9, v136
    v_mfma_f32_16x16x32_bf16 v[92:95], a[60:63], a[68:71], v[92:95]
    s_waitcnt lgkmcnt(0) vmcnt(19)
    s_barrier
    v_mfma_f32_16x16x32_bf16 v[32:35], a[72:75], a[104:107], v[32:35]
    ds_read_b128 a[64:67], v150 offset:0
    s_bfe_u32 s36, s67, 262148
    v_add_f32_e64 v137, v137, v137
    v_mfma_f32_16x16x32_bf16 v[36:39], a[72:75], a[108:111], v[36:39]
    ds_read_b128 a[68:71], v150 offset:8192
    v_mul_f32_e64 v4, v136, v136
    v_mfma_f32_16x16x32_bf16 v[40:43], a[76:79], a[104:107], v[40:43]
    ds_read_b128 a[32:35], v148 offset:0
    s_add_u32 m0, s37, 32768
    v_mul_f32_e64 v5, v136, v137
    v_mfma_f32_16x16x32_bf16 v[44:47], a[76:79], a[108:111], v[44:47]
    ds_read_b128 a[36:39], v148 offset:2048
    v_mfma_f32_16x16x32_bf16 v[48:51], a[80:83], a[104:107], v[48:51]
    ds_read_b128 a[40:43], v148 offset:4096
    v_fma_f32 v4, -v137, v137, v4
    v_mfma_f32_16x16x32_bf16 v[52:55], a[80:83], a[108:111], v[52:55]
    ds_read_b128 a[44:47], v148 offset:6144
    s_lshl_b32 s36, s36, 7
    v_add_f32 v5, v5, v5
    v_mfma_f32_16x16x32_bf16 v[56:59], a[84:87], a[104:107], v[56:59]
    ds_read_b128 a[48:51], v148 offset:8192
    v_mfma_f32_16x16x32_bf16 v[60:63], a[84:87], a[108:111], v[60:63]
    ds_read_b128 a[52:55], v148 offset:10240
    v_mul_f32_e64 v10, v4, v4
    v_mfma_f32_16x16x32_bf16 v[64:67], a[88:91], a[104:107], v[64:67]
    ds_read_b128 a[56:59], v148 offset:12288
    buffer_load_dwordx4 v16, s[8:11], s36 offen offset:0 lds
    v_mul_f32_e64 v11, v4, v5
    v_mfma_f32_16x16x32_bf16 v[68:71], a[88:91], a[108:111], v[68:71]
    ds_read_b128 a[60:63], v148 offset:14336
    v_mfma_f32_16x16x32_bf16 v[72:75], a[92:95], a[104:107], v[72:75]
    buffer_load_dwordx4 v17, s[8:11], s36 offen offset:1024 lds
    v_fma_f32 v10, -v5, v5, v10
    v_mfma_f32_16x16x32_bf16 v[76:79], a[92:95], a[108:111], v[76:79]
    v_add_f32_e64 v11, v11, v11
    v_mfma_f32_16x16x32_bf16 v[80:83], a[96:99], a[104:107], v[80:83]
    v_mfma_f32_16x16x32_bf16 v[84:87], a[96:99], a[108:111], v[84:87]
    buffer_load_dwordx4 v18, s[8:11], s36 offen offset:2048 lds
    v_mul_f32_e64 v12, v10, v10
    v_mfma_f32_16x16x32_bf16 v[88:91], a[100:103], a[104:107], v[88:91]
    v_mul_f32_e64 v13, v10, v11
    v_mfma_f32_16x16x32_bf16 v[92:95], a[100:103], a[108:111], v[92:95]
    s_waitcnt lgkmcnt(0)
    v_mfma_f32_16x16x32_bf16 v[32:35], a[32:35], a[64:67], v[32:35]
    ds_read_b128 a[104:107], v151 offset:0
    buffer_load_dwordx4 v19, s[8:11], s36 offen offset:3072 lds
    v_fma_f32 v12, -v11, v11, v12
    v_mfma_f32_16x16x32_bf16 v[36:39], a[32:35], a[68:71], v[36:39]
    ds_read_b128 a[108:111], v151 offset:8192
    v_add_f32 v13, v13, v13
    v_mfma_f32_16x16x32_bf16 v[40:43], a[36:39], a[64:67], v[40:43]
    ds_read_b128 a[72:75], v149 offset:0
    s_add_u32 m0, s37, 49152
    v_and_b32_e64 v14, 1, v2
    v_mfma_f32_16x16x32_bf16 v[44:47], a[36:39], a[68:71], v[44:47]
    ds_read_b128 a[76:79], v149 offset:2048
    v_mfma_f32_16x16x32_bf16 v[48:51], a[40:43], a[64:67], v[48:51]
    ds_read_b128 a[80:83], v149 offset:4096
    v_cmp_eq_u32 s[78:79], 1, v14
    v_mfma_f32_16x16x32_bf16 v[52:55], a[40:43], a[68:71], v[52:55]
    ds_read_b128 a[84:87], v149 offset:6144
    buffer_load_dwordx4 v20, s[12:15], s36 offen offset:0 lds
    v_cndmask_b32 v4, 1.0, v134, s[78:79]
    v_mfma_f32_16x16x32_bf16 v[56:59], a[44:47], a[64:67], v[56:59]
    ds_read_b128 a[88:91], v149 offset:8192
    v_mfma_f32_16x16x32_bf16 v[60:63], a[44:47], a[68:71], v[60:63]
    ds_read_b128 a[92:95], v149 offset:10240
    v_cndmask_b32 v5, 0, v135, s[78:79]
    v_mfma_f32_16x16x32_bf16 v[64:67], a[48:51], a[64:67], v[64:67]
    ds_read_b128 a[96:99], v149 offset:12288
    buffer_load_dwordx4 v21, s[12:15], s36 offen offset:1024 lds
    v_cndmask_b32 v10, 1.0, v10, s[78:79]
    buffer_store_dwordx4 v[180:183], v193, s[28:31], s76 offen sc1
    v_mfma_f32_16x16x32_bf16 v[68:71], a[48:51], a[68:71], v[68:71]
    ds_read_b128 a[100:103], v149 offset:14336
    v_mfma_f32_16x16x32_bf16 v[72:75], a[52:55], a[64:67], v[72:75]
    buffer_load_dwordx4 v22, s[12:15], s36 offen offset:2048 lds
    v_cndmask_b32 v11, 0, v11, s[78:79]
    v_mfma_f32_16x16x32_bf16 v[76:79], a[52:55], a[68:71], v[76:79]
    v_cmp_lt_u32 s[78:79], 1, v2
    v_mfma_f32_16x16x32_bf16 v[80:83], a[56:59], a[64:67], v[80:83]
    v_mfma_f32_16x16x32_bf16 v[84:87], a[56:59], a[68:71], v[84:87]
    buffer_load_dwordx4 v23, s[12:15], s36 offen offset:3072 lds
    v_cndmask_b32 v8, 1.0, v8, s[78:79]
    v_mfma_f32_16x16x32_bf16 v[88:91], a[60:63], a[64:67], v[88:91]
    v_cndmask_b32 v9, 0, v9, s[78:79]
    v_mfma_f32_16x16x32_bf16 v[92:95], a[60:63], a[68:71], v[92:95]
    s_waitcnt lgkmcnt(0) vmcnt(19)
    s_barrier
    v_mfma_f32_16x16x32_bf16 v[32:35], a[72:75], a[104:107], v[32:35]
    ds_read_b128 a[64:67], v150 offset:32768
    s_bfe_u32 s36, s67, 262152
    v_cndmask_b32 v12, 1.0, v12, s[78:79]
    v_mfma_f32_16x16x32_bf16 v[36:39], a[72:75], a[108:111], v[36:39]
    ds_read_b128 a[68:71], v150 offset:40960
    v_cndmask_b32 v13, 0, v13, s[78:79]
    v_mfma_f32_16x16x32_bf16 v[40:43], a[76:79], a[104:107], v[40:43]
    ds_read_b128 a[32:35], v148 offset:32768
    s_add_u32 m0, s37, 65536
    v_mul_f32_e64 v138, v4, v8
    v_mfma_f32_16x16x32_bf16 v[44:47], a[76:79], a[108:111], v[44:47]
    ds_read_b128 a[36:39], v148 offset:34816
    v_mfma_f32_16x16x32_bf16 v[48:51], a[80:83], a[104:107], v[48:51]
    ds_read_b128 a[40:43], v148 offset:36864
    v_mul_f32_e64 v139, v4, v9
    v_mfma_f32_16x16x32_bf16 v[52:55], a[80:83], a[108:111], v[52:55]
    ds_read_b128 a[44:47], v148 offset:38912
    s_lshl_b32 s36, s36, 7
    v_fma_f32 v138, -v5, v9, v138
    v_mfma_f32_16x16x32_bf16 v[56:59], a[84:87], a[104:107], v[56:59]
    ds_read_b128 a[48:51], v148 offset:40960
    v_mfma_f32_16x16x32_bf16 v[60:63], a[84:87], a[108:111], v[60:63]
    ds_read_b128 a[52:55], v148 offset:43008
    v_fma_f32 v139, v5, v8, v139
    v_mfma_f32_16x16x32_bf16 v[64:67], a[88:91], a[104:107], v[64:67]
    ds_read_b128 a[56:59], v148 offset:45056
    buffer_load_dwordx4 v16, s[8:11], s36 offen offset:0 lds
    v_mul_f32 v140, v10, v12
    v_mfma_f32_16x16x32_bf16 v[68:71], a[88:91], a[108:111], v[68:71]
    ds_read_b128 a[60:63], v148 offset:47104
    v_mfma_f32_16x16x32_bf16 v[72:75], a[92:95], a[104:107], v[72:75]
    buffer_load_dwordx4 v17, s[8:11], s36 offen offset:1024 lds
    v_mul_f32_e64 v141, v10, v13
    v_mfma_f32_16x16x32_bf16 v[76:79], a[92:95], a[108:111], v[76:79]
    v_fma_f32 v140, -v11, v13, v140
    v_mfma_f32_16x16x32_bf16 v[80:83], a[96:99], a[104:107], v[80:83]
    v_mfma_f32_16x16x32_bf16 v[84:87], a[96:99], a[108:111], v[84:87]
    buffer_load_dwordx4 v18, s[8:11], s36 offen offset:2048 lds
    v_fma_f32 v141, v11, v12, v141
    v_mfma_f32_16x16x32_bf16 v[88:91], a[100:103], a[104:107], v[88:91]
    v_add_u32_e64 v251, s63, v1
    v_mfma_f32_16x16x32_bf16 v[92:95], a[100:103], a[108:111], v[92:95]
    s_waitcnt lgkmcnt(0)
    v_mfma_f32_16x16x32_bf16 v[32:35], a[32:35], a[64:67], v[32:35]
    ds_read_b128 a[104:107], v151 offset:32768
    buffer_load_dwordx4 v19, s[8:11], s36 offen offset:3072 lds
    v_cvt_f32_u32 v251, v251
    v_mfma_f32_16x16x32_bf16 v[36:39], a[32:35], a[68:71], v[36:39]
    ds_read_b128 a[108:111], v151 offset:40960
    v_mul_f32 v251, 0x3a800000, v251
    v_mfma_f32_16x16x32_bf16 v[40:43], a[36:39], a[64:67], v[40:43]
    ds_read_b128 a[72:75], v149 offset:32768
    s_add_u32 m0, s37, 81920
    v_mul_f32_e64 v248, v250, v251
    v_mfma_f32_16x16x32_bf16 v[44:47], a[36:39], a[68:71], v[44:47]
    ds_read_b128 a[76:79], v149 offset:34816
    v_mfma_f32_16x16x32_bf16 v[48:51], a[40:43], a[64:67], v[48:51]
    ds_read_b128 a[80:83], v149 offset:36864
    v_fmamk_f32 v4, v251, 0x00000000, v248
    v_mfma_f32_16x16x32_bf16 v[52:55], a[40:43], a[68:71], v[52:55]
    ds_read_b128 a[84:87], v149 offset:38912
    buffer_load_dwordx4 v20, s[12:15], s36 offen offset:0 lds
    v_fmamk_f32 v5, v251, 0x3f000000, v248
    v_mfma_f32_16x16x32_bf16 v[56:59], a[44:47], a[64:67], v[56:59]
    ds_read_b128 a[88:91], v149 offset:40960
    v_mfma_f32_16x16x32_bf16 v[60:63], a[44:47], a[68:71], v[60:63]
    ds_read_b128 a[92:95], v149 offset:43008
    v_fmamk_f32 v6, v251, 0x3f800000, v248
    v_mfma_f32_16x16x32_bf16 v[64:67], a[48:51], a[64:67], v[64:67]
    ds_read_b128 a[96:99], v149 offset:45056
    buffer_load_dwordx4 v21, s[12:15], s36 offen offset:1024 lds
    v_fmamk_f32 v7, v251, 0x3fc00000, v248
    v_mfma_f32_16x16x32_bf16 v[68:71], a[48:51], a[68:71], v[68:71]
    ds_read_b128 a[100:103], v149 offset:47104
    v_mfma_f32_16x16x32_bf16 v[72:75], a[52:55], a[64:67], v[72:75]
    buffer_load_dwordx4 v22, s[12:15], s36 offen offset:2048 lds
    v_cos_f32_e64 v96, v4
    v_mfma_f32_16x16x32_bf16 v[76:79], a[52:55], a[68:71], v[76:79]
    v_cos_f32_e64 v98, v5
    v_mfma_f32_16x16x32_bf16 v[80:83], a[56:59], a[64:67], v[80:83]
    v_mfma_f32_16x16x32_bf16 v[84:87], a[56:59], a[68:71], v[84:87]
    buffer_load_dwordx4 v23, s[12:15], s36 offen offset:3072 lds
    v_cos_f32_e64 v100, v6
    v_mfma_f32_16x16x32_bf16 v[88:91], a[60:63], a[64:67], v[88:91]
    v_cos_f32_e64 v102, v7
    v_mfma_f32_16x16x32_bf16 v[92:95], a[60:63], a[68:71], v[92:95]
    s_waitcnt lgkmcnt(0) vmcnt(10)
    s_barrier
    v_mfma_f32_16x16x32_bf16 v[32:35], a[72:75], a[104:107], v[32:35]
    ds_read_b128 a[64:67], v26 offset:0
    s_lshl_b32 s69, s2, 3
    v_sin_f32 v97, v4
    v_mfma_f32_16x16x32_bf16 v[36:39], a[72:75], a[108:111], v[36:39]
    ds_read_b128 a[68:71], v26 offset:8192
    s_add_u32 s69, s69, 22347776
    v_sin_f32_e64 v99, v5
    v_mfma_f32_16x16x32_bf16 v[40:43], a[76:79], a[104:107], v[40:43]
    ds_read_b128 a[32:35], v24 offset:0
    v_sin_f32_e64 v101, v6
    v_mfma_f32_16x16x32_bf16 v[44:47], a[76:79], a[108:111], v[44:47]
    ds_read_b128 a[36:39], v24 offset:2048
    v_mov_b32_e64 v28, s35
    v_mfma_f32_16x16x32_bf16 v[48:51], a[80:83], a[104:107], v[48:51]
    ds_read_b128 a[40:43], v24 offset:4096
    v_sin_f32_e64 v103, v7
    v_mfma_f32_16x16x32_bf16 v[52:55], a[80:83], a[108:111], v[52:55]
    ds_read_b128 a[44:47], v24 offset:6144
    v_and_b32 v255, 1073741831, v30
    v_fmamk_f32 v4, v251, 0x40000000, v248
    v_mfma_f32_16x16x32_bf16 v[56:59], a[84:87], a[104:107], v[56:59]
    ds_read_b128 a[48:51], v24 offset:8192
    v_mfma_f32_16x16x32_bf16 v[60:63], a[84:87], a[108:111], v[60:63]
    ds_read_b128 a[52:55], v24 offset:10240
    buffer_store_dword v28, v255, s[24:27], s69 offen sc1
    v_fmamk_f32 v5, v251, 0x40200000, v248
    v_mfma_f32_16x16x32_bf16 v[64:67], a[88:91], a[104:107], v[64:67]
    ds_read_b128 a[56:59], v24 offset:12288
    s_bfe_u32 s36, s67, 262156
    v_fmamk_f32 v6, v251, 0x40400000, v248
    v_mfma_f32_16x16x32_bf16 v[68:71], a[88:91], a[108:111], v[68:71]
    ds_read_b128 a[60:63], v24 offset:14336
    v_mfma_f32_16x16x32_bf16 v[72:75], a[92:95], a[104:107], v[72:75]
    s_add_u32 m0, s37, 98304
    v_fmamk_f32 v7, v251, 0x40600000, v248
    v_mfma_f32_16x16x32_bf16 v[76:79], a[92:95], a[108:111], v[76:79]
    v_cos_f32_e64 v104, v4
    v_mfma_f32_16x16x32_bf16 v[80:83], a[96:99], a[104:107], v[80:83]
    s_lshl_b32 s36, s36, 7
    v_mfma_f32_16x16x32_bf16 v[84:87], a[96:99], a[108:111], v[84:87]
    v_cos_f32 v106, v5
    v_mfma_f32_16x16x32_bf16 v[88:91], a[100:103], a[104:107], v[88:91]
    buffer_load_dwordx4 v16, s[8:11], s36 offen offset:0 lds
    v_cos_f32_e64 v108, v6
    v_mfma_f32_16x16x32_bf16 v[92:95], a[100:103], a[108:111], v[92:95]
    s_waitcnt lgkmcnt(0)
    v_mfma_f32_16x16x32_bf16 v[32:35], a[32:35], a[64:67], v[32:35]
    ds_read_b128 a[104:107], v27 offset:0
    buffer_load_dwordx4 v17, s[8:11], s36 offen offset:1024 lds
    v_cos_f32 v110, v7
    v_mfma_f32_16x16x32_bf16 v[36:39], a[32:35], a[68:71], v[36:39]
    ds_read_b128 a[108:111], v27 offset:8192
    v_sin_f32_e64 v105, v4
    v_mfma_f32_16x16x32_bf16 v[40:43], a[36:39], a[64:67], v[40:43]
    ds_read_b128 a[72:75], v25 offset:0
    buffer_load_dwordx4 v18, s[8:11], s36 offen offset:2048 lds
    v_sin_f32_e64 v107, v5
    v_mfma_f32_16x16x32_bf16 v[44:47], a[36:39], a[68:71], v[44:47]
    ds_read_b128 a[76:79], v25 offset:2048
    v_mfma_f32_16x16x32_bf16 v[48:51], a[40:43], a[64:67], v[48:51]
    ds_read_b128 a[80:83], v25 offset:4096
    buffer_load_dwordx4 v19, s[8:11], s36 offen offset:3072 lds
    v_sin_f32_e64 v109, v6
    v_mfma_f32_16x16x32_bf16 v[52:55], a[40:43], a[68:71], v[52:55]
    ds_read_b128 a[84:87], v25 offset:6144
    v_sin_f32_e64 v111, v7
    v_mfma_f32_16x16x32_bf16 v[56:59], a[44:47], a[64:67], v[56:59]
    ds_read_b128 a[88:91], v25 offset:8192
    s_add_u32 m0, s37, 114688
    v_mfma_f32_16x16x32_bf16 v[60:63], a[44:47], a[68:71], v[60:63]
    ds_read_b128 a[92:95], v25 offset:10240
    v_cvt_f32_u32_e64 v9, s4
    v_mfma_f32_16x16x32_bf16 v[64:67], a[48:51], a[64:67], v[64:67]
    ds_read_b128 a[96:99], v25 offset:12288
    buffer_load_dwordx4 v20, s[12:15], s36 offen offset:0 lds
    v_mul_f32 v9, 0x3a800000, v9
    v_mfma_f32_16x16x32_bf16 v[68:71], a[48:51], a[68:71], v[68:71]
    ds_read_b128 a[100:103], v25 offset:14336
    v_mfma_f32_16x16x32_bf16 v[72:75], a[52:55], a[64:67], v[72:75]
    buffer_load_dwordx4 v21, s[12:15], s36 offen offset:1024 lds
    v_sin_f32_e64 v11, v9
    v_mfma_f32_16x16x32_bf16 v[76:79], a[52:55], a[68:71], v[76:79]
    v_cos_f32_e64 v10, v9
    v_mfma_f32_16x16x32_bf16 v[80:83], a[56:59], a[64:67], v[80:83]
    buffer_load_dwordx4 v22, s[12:15], s36 offen offset:2048 lds
    v_mfma_f32_16x16x32_bf16 v[84:87], a[56:59], a[68:71], v[84:87]
    v_add_f32_e64 v11, 1.0, v11
    v_mfma_f32_16x16x32_bf16 v[88:91], a[60:63], a[64:67], v[88:91]
    buffer_load_dwordx4 v23, s[12:15], s36 offen offset:3072 lds
    v_rcp_f32_e64 v9, v11
    v_mfma_f32_16x16x32_bf16 v[92:95], a[60:63], a[68:71], v[92:95]
    s_waitcnt lgkmcnt(0) vmcnt(17)
    s_barrier
    v_mfma_f32_16x16x32_bf16 v[32:35], a[72:75], a[104:107], v[32:35]
    ds_read_b128 a[64:67], v26 offset:32768
    s_bfe_u32 s36, s67, 262160
    s_mov_b32 s39, 0x35000000
    v_mfma_f32_16x16x32_bf16 v[36:39], a[72:75], a[108:111], v[36:39]
    ds_read_b128 a[68:71], v26 offset:40960
    s_cmp_eq_u32 s2, 0
    s_cselect_b32 s39, 0x34800000, s39
    v_mfma_f32_16x16x32_bf16 v[40:43], a[76:79], a[104:107], v[40:43]
    ds_read_b128 a[32:35], v24 offset:32768
    s_add_u32 m0, s37, 0
    v_mul_f32_e64 v15, s39, v11
    v_mfma_f32_16x16x32_bf16 v[44:47], a[76:79], a[108:111], v[44:47]
    ds_read_b128 a[36:39], v24 offset:34816
    v_mfma_f32_16x16x32_bf16 v[48:51], a[80:83], a[104:107], v[48:51]
    ds_read_b128 a[40:43], v24 offset:36864
    v_mul_f32_e64 v10, -v10, v9
    v_mfma_f32_16x16x32_bf16 v[52:55], a[80:83], a[108:111], v[52:55]
    ds_read_b128 a[44:47], v24 offset:38912
    s_lshl_b32 s36, s36, 7
    v_cvt_f32_u32 v14, s63
    v_mfma_f32_16x16x32_bf16 v[56:59], a[84:87], a[104:107], v[56:59]
    ds_read_b128 a[48:51], v24 offset:40960
    v_mfma_f32_16x16x32_bf16 v[60:63], a[84:87], a[108:111], v[60:63]
    ds_read_b128 a[52:55], v24 offset:43008
    v_readfirstlane_b32 s42, v10
    v_mfma_f32_16x16x32_bf16 v[64:67], a[88:91], a[104:107], v[64:67]
    ds_read_b128 a[56:59], v24 offset:45056
    buffer_load_dwordx4 v16, s[8:11], s36 offen offset:0 lds
    v_add_f32 v14, v14, v250
    v_mfma_f32_16x16x32_bf16 v[68:71], a[88:91], a[108:111], v[68:71]
    ds_read_b128 a[60:63], v24 offset:47104
    v_mfma_f32_16x16x32_bf16 v[72:75], a[92:95], a[104:107], v[72:75]
    buffer_load_dwordx4 v17, s[8:11], s36 offen offset:1024 lds
    v_fma_f32 v251, v249, 2.0, 0
    v_mfma_f32_16x16x32_bf16 v[76:79], a[92:95], a[108:111], v[76:79]
    v_mul_f32 v251, 0x3a000000, v251
    v_mfma_f32_16x16x32_bf16 v[80:83], a[96:99], a[104:107], v[80:83]
    v_mfma_f32_16x16x32_bf16 v[84:87], a[96:99], a[108:111], v[84:87]
    buffer_load_dwordx4 v18, s[8:11], s36 offen offset:2048 lds
    v_mul_f32_e64 v248, v14, v251
    v_mfma_f32_16x16x32_bf16 v[88:91], a[100:103], a[104:107], v[88:91]
    v_fmamk_f32 v4, v251, 0x00000000, v248
    v_mfma_f32_16x16x32_bf16 v[92:95], a[100:103], a[108:111], v[92:95]
    s_waitcnt lgkmcnt(0)
    v_mfma_f32_16x16x32_bf16 v[32:35], a[32:35], a[64:67], v[32:35]
    ds_read_b128 a[104:107], v27 offset:32768
    buffer_load_dwordx4 v19, s[8:11], s36 offen offset:3072 lds
    v_fmamk_f32 v5, v251, 0x3f800000, v248
    v_mfma_f32_16x16x32_bf16 v[36:39], a[32:35], a[68:71], v[36:39]
    ds_read_b128 a[108:111], v27 offset:40960
    v_fmamk_f32 v6, v251, 0x40000000, v248
    v_mfma_f32_16x16x32_bf16 v[40:43], a[36:39], a[64:67], v[40:43]
    ds_read_b128 a[72:75], v25 offset:32768
    s_add_u32 m0, s37, 16384
    v_fmamk_f32 v7, v251, 0x40400000, v248
    v_mfma_f32_16x16x32_bf16 v[44:47], a[36:39], a[68:71], v[44:47]
    ds_read_b128 a[76:79], v25 offset:34816
    v_mfma_f32_16x16x32_bf16 v[48:51], a[40:43], a[64:67], v[48:51]
    ds_read_b128 a[80:83], v25 offset:36864
    v_cos_f32 v112, v4
    v_mfma_f32_16x16x32_bf16 v[52:55], a[40:43], a[68:71], v[52:55]
    ds_read_b128 a[84:87], v25 offset:38912
    buffer_load_dwordx4 v20, s[12:15], s36 offen offset:0 lds
    v_cos_f32_e64 v113, v5
    v_mfma_f32_16x16x32_bf16 v[56:59], a[44:47], a[64:67], v[56:59]
    ds_read_b128 a[88:91], v25 offset:40960
    v_mfma_f32_16x16x32_bf16 v[60:63], a[44:47], a[68:71], v[60:63]
    ds_read_b128 a[92:95], v25 offset:43008
    v_cos_f32_e64 v114, v6
    v_mfma_f32_16x16x32_bf16 v[64:67], a[48:51], a[64:67], v[64:67]
    ds_read_b128 a[96:99], v25 offset:45056
    buffer_load_dwordx4 v21, s[12:15], s36 offen offset:1024 lds
    v_cos_f32_e64 v115, v7
    v_mfma_f32_16x16x32_bf16 v[68:71], a[48:51], a[68:71], v[68:71]
    ds_read_b128 a[100:103], v25 offset:47104
    v_mfma_f32_16x16x32_bf16 v[72:75], a[52:55], a[64:67], v[72:75]
    buffer_load_dwordx4 v22, s[12:15], s36 offen offset:2048 lds
    v_sin_f32_e64 v116, v4
    v_mfma_f32_16x16x32_bf16 v[76:79], a[52:55], a[68:71], v[76:79]
    v_sin_f32_e64 v117, v5
    v_mfma_f32_16x16x32_bf16 v[80:83], a[56:59], a[64:67], v[80:83]
    v_mfma_f32_16x16x32_bf16 v[84:87], a[56:59], a[68:71], v[84:87]
    buffer_load_dwordx4 v23, s[12:15], s36 offen offset:3072 lds
    v_sin_f32_e64 v118, v6
    v_mfma_f32_16x16x32_bf16 v[88:91], a[60:63], a[64:67], v[88:91]
    v_sin_f32_e64 v119, v7
    v_mfma_f32_16x16x32_bf16 v[92:95], a[60:63], a[68:71], v[92:95]
    s_waitcnt lgkmcnt(0) vmcnt(17)
    s_barrier
    v_mfma_f32_16x16x32_bf16 v[32:35], a[72:75], a[104:107], v[32:35]
    ds_read_b128 a[64:67], v150 offset:0
    s_bfe_u32 s36, s67, 262164
    v_mul_f32_e64 v112, v15, v112
    v_mfma_f32_16x16x32_bf16 v[36:39], a[72:75], a[108:111], v[36:39]
    ds_read_b128 a[68:71], v150 offset:8192
    v_mul_f32_e64 v113, v15, v113
    v_mfma_f32_16x16x32_bf16 v[40:43], a[76:79], a[104:107], v[40:43]
    ds_read_b128 a[32:35], v148 offset:0
    s_add_u32 m0, s37, 32768
    v_mul_f32_e64 v114, v15, v114
    v_mfma_f32_16x16x32_bf16 v[44:47], a[76:79], a[108:111], v[44:47]
    ds_read_b128 a[36:39], v148 offset:2048
    v_mfma_f32_16x16x32_bf16 v[48:51], a[80:83], a[104:107], v[48:51]
    ds_read_b128 a[40:43], v148 offset:4096
    v_mul_f32_e64 v115, v15, v115
    v_mfma_f32_16x16x32_bf16 v[52:55], a[80:83], a[108:111], v[52:55]
    ds_read_b128 a[44:47], v148 offset:6144
    s_lshl_b32 s36, s36, 7
    v_mul_f32 v116, v15, v116
    v_mfma_f32_16x16x32_bf16 v[56:59], a[84:87], a[104:107], v[56:59]
    ds_read_b128 a[48:51], v148 offset:8192
    v_mfma_f32_16x16x32_bf16 v[60:63], a[84:87], a[108:111], v[60:63]
    ds_read_b128 a[52:55], v148 offset:10240
    v_mul_f32_e64 v117, v15, v117
    v_mfma_f32_16x16x32_bf16 v[64:67], a[88:91], a[104:107], v[64:67]
    ds_read_b128 a[56:59], v148 offset:12288
    buffer_load_dwordx4 v16, s[8:11], s36 offen offset:0 lds
    v_mul_f32_e64 v118, v15, v118
    v_mfma_f32_16x16x32_bf16 v[68:71], a[88:91], a[108:111], v[68:71]
    ds_read_b128 a[60:63], v148 offset:14336
    v_mfma_f32_16x16x32_bf16 v[72:75], a[92:95], a[104:107], v[72:75]
    buffer_load_dwordx4 v17, s[8:11], s36 offen offset:1024 lds
    v_mul_f32_e64 v119, v15, v119
    v_mfma_f32_16x16x32_bf16 v[76:79], a[92:95], a[108:111], v[76:79]
    v_fma_f32 v251, v249, 2.0, 1.0
    v_mfma_f32_16x16x32_bf16 v[80:83], a[96:99], a[104:107], v[80:83]
    v_mfma_f32_16x16x32_bf16 v[84:87], a[96:99], a[108:111], v[84:87]
    buffer_load_dwordx4 v18, s[8:11], s36 offen offset:2048 lds
    v_mul_f32 v251, 0x3a000000, v251
    v_mfma_f32_16x16x32_bf16 v[88:91], a[100:103], a[104:107], v[88:91]
    v_mul_f32_e64 v248, v14, v251
    v_mfma_f32_16x16x32_bf16 v[92:95], a[100:103], a[108:111], v[92:95]
    s_waitcnt lgkmcnt(0)
    v_mfma_f32_16x16x32_bf16 v[32:35], a[32:35], a[64:67], v[32:35]
    ds_read_b128 a[104:107], v151 offset:0
    buffer_load_dwordx4 v19, s[8:11], s36 offen offset:3072 lds
    v_fmamk_f32 v4, v251, 0x00000000, v248
    v_mfma_f32_16x16x32_bf16 v[36:39], a[32:35], a[68:71], v[36:39]
    ds_read_b128 a[108:111], v151 offset:8192
    v_fmamk_f32 v5, v251, 0x3f800000, v248
    v_mfma_f32_16x16x32_bf16 v[40:43], a[36:39], a[64:67], v[40:43]
    ds_read_b128 a[72:75], v149 offset:0
    s_add_u32 m0, s37, 49152
    v_fmamk_f32 v6, v251, 0x40000000, v248
    v_mfma_f32_16x16x32_bf16 v[44:47], a[36:39], a[68:71], v[44:47]
    ds_read_b128 a[76:79], v149 offset:2048
    v_mfma_f32_16x16x32_bf16 v[48:51], a[40:43], a[64:67], v[48:51]
    ds_read_b128 a[80:83], v149 offset:4096
    v_fmamk_f32 v7, v251, 0x40400000, v248
    v_mfma_f32_16x16x32_bf16 v[52:55], a[40:43], a[68:71], v[52:55]
    ds_read_b128 a[84:87], v149 offset:6144
    buffer_load_dwordx4 v20, s[12:15], s36 offen offset:0 lds
    v_cos_f32 v120, v4
    v_mfma_f32_16x16x32_bf16 v[56:59], a[44:47], a[64:67], v[56:59]
    ds_read_b128 a[88:91], v149 offset:8192
    v_mfma_f32_16x16x32_bf16 v[60:63], a[44:47], a[68:71], v[60:63]
    ds_read_b128 a[92:95], v149 offset:10240
    v_cos_f32_e64 v121, v5
    v_mfma_f32_16x16x32_bf16 v[64:67], a[48:51], a[64:67], v[64:67]
    ds_read_b128 a[96:99], v149 offset:12288
    buffer_load_dwordx4 v21, s[12:15], s36 offen offset:1024 lds
    v_cos_f32_e64 v122, v6
    v_mfma_f32_16x16x32_bf16 v[68:71], a[48:51], a[68:71], v[68:71]
    ds_read_b128 a[100:103], v149 offset:14336
    v_mfma_f32_16x16x32_bf16 v[72:75], a[52:55], a[64:67], v[72:75]
    buffer_load_dwordx4 v22, s[12:15], s36 offen offset:2048 lds
    v_cos_f32_e64 v123, v7
    v_mfma_f32_16x16x32_bf16 v[76:79], a[52:55], a[68:71], v[76:79]
    v_sin_f32_e64 v124, v4
    v_mfma_f32_16x16x32_bf16 v[80:83], a[56:59], a[64:67], v[80:83]
    v_mfma_f32_16x16x32_bf16 v[84:87], a[56:59], a[68:71], v[84:87]
    buffer_load_dwordx4 v23, s[12:15], s36 offen offset:3072 lds
    v_sin_f32_e64 v125, v5
    v_mfma_f32_16x16x32_bf16 v[88:91], a[60:63], a[64:67], v[88:91]
    v_sin_f32_e64 v126, v6
    v_mfma_f32_16x16x32_bf16 v[92:95], a[60:63], a[68:71], v[92:95]
    s_waitcnt lgkmcnt(0) vmcnt(16)
    s_barrier
    v_mfma_f32_16x16x32_bf16 v[32:35], a[72:75], a[104:107], v[32:35]
    ds_read_b128 a[64:67], v150 offset:32768
    s_bfe_u32 s36, s67, 262168
    v_sin_f32_e64 v127, v7
    v_mfma_f32_16x16x32_bf16 v[36:39], a[72:75], a[108:111], v[36:39]
    ds_read_b128 a[68:71], v150 offset:40960
    v_mul_f32_e64 v120, v15, v120
    v_mfma_f32_16x16x32_bf16 v[40:43], a[76:79], a[104:107], v[40:43]
    ds_read_b128 a[32:35], v148 offset:32768
    s_add_u32 m0, s37, 65536
    v_mfma_f32_16x16x32_bf16 v[44:47], a[76:79], a[108:111], v[44:47]
    ds_read_b128 a[36:39], v148 offset:34816
    v_mul_f32_e64 v121, v15, v121
    v_mfma_f32_16x16x32_bf16 v[48:51], a[80:83], a[104:107], v[48:51]
    ds_read_b128 a[40:43], v148 offset:36864
    v_mfma_f32_16x16x32_bf16 v[52:55], a[80:83], a[108:111], v[52:55]
    ds_read_b128 a[44:47], v148 offset:38912
    s_lshl_b32 s36, s36, 7
    v_mul_f32 v122, v15, v122
    v_mfma_f32_16x16x32_bf16 v[56:59], a[84:87], a[104:107], v[56:59]
    ds_read_b128 a[48:51], v148 offset:40960
    v_mfma_f32_16x16x32_bf16 v[60:63], a[84:87], a[108:111], v[60:63]
    ds_read_b128 a[52:55], v148 offset:43008
    v_mul_f32_e64 v123, v15, v123
    v_mfma_f32_16x16x32_bf16 v[64:67], a[88:91], a[104:107], v[64:67]
    ds_read_b128 a[56:59], v148 offset:45056
    buffer_load_dwordx4 v16, s[8:11], s36 offen offset:0 lds
    v_mul_f32_e64 v124, v15, v124
    v_mfma_f32_16x16x32_bf16 v[68:71], a[88:91], a[108:111], v[68:71]
    ds_read_b128 a[60:63], v148 offset:47104
    v_mfma_f32_16x16x32_bf16 v[72:75], a[92:95], a[104:107], v[72:75]
    buffer_load_dwordx4 v17, s[8:11], s36 offen offset:1024 lds
    v_mul_f32_e64 v125, v15, v125
    v_mfma_f32_16x16x32_bf16 v[76:79], a[92:95], a[108:111], v[76:79]
    v_mfma_f32_16x16x32_bf16 v[80:83], a[96:99], a[104:107], v[80:83]
    v_mul_f32_e64 v126, v15, v126
    v_mfma_f32_16x16x32_bf16 v[84:87], a[96:99], a[108:111], v[84:87]
    buffer_load_dwordx4 v18, s[8:11], s36 offen offset:2048 lds
    v_mfma_f32_16x16x32_bf16 v[88:91], a[100:103], a[104:107], v[88:91]
    v_mul_f32_e64 v127, v15, v127
    v_mfma_f32_16x16x32_bf16 v[92:95], a[100:103], a[108:111], v[92:95]
    s_waitcnt lgkmcnt(0)
    v_mfma_f32_16x16x32_bf16 v[32:35], a[32:35], a[64:67], v[32:35]
    ds_read_b128 a[104:107], v151 offset:32768
    buffer_load_dwordx4 v19, s[8:11], s36 offen offset:3072 lds
    v_mfma_f32_16x16x32_bf16 v[36:39], a[32:35], a[68:71], v[36:39]
    ds_read_b128 a[108:111], v151 offset:40960
    v_mfma_f32_16x16x32_bf16 v[40:43], a[36:39], a[64:67], v[40:43]
    ds_read_b128 a[72:75], v149 offset:32768
    s_add_u32 m0, s37, 81920
    v_mfma_f32_16x16x32_bf16 v[44:47], a[36:39], a[68:71], v[44:47]
    ds_read_b128 a[76:79], v149 offset:34816
    v_mfma_f32_16x16x32_bf16 v[48:51], a[40:43], a[64:67], v[48:51]
    ds_read_b128 a[80:83], v149 offset:36864
    v_mfma_f32_16x16x32_bf16 v[52:55], a[40:43], a[68:71], v[52:55]
    ds_read_b128 a[84:87], v149 offset:38912
    buffer_load_dwordx4 v20, s[12:15], s36 offen offset:0 lds
    v_mfma_f32_16x16x32_bf16 v[56:59], a[44:47], a[64:67], v[56:59]
    ds_read_b128 a[88:91], v149 offset:40960
    v_mfma_f32_16x16x32_bf16 v[60:63], a[44:47], a[68:71], v[60:63]
    ds_read_b128 a[92:95], v149 offset:43008
    v_mfma_f32_16x16x32_bf16 v[64:67], a[48:51], a[64:67], v[64:67]
    ds_read_b128 a[96:99], v149 offset:45056
    buffer_load_dwordx4 v21, s[12:15], s36 offen offset:1024 lds
    v_mfma_f32_16x16x32_bf16 v[68:71], a[48:51], a[68:71], v[68:71]
    ds_read_b128 a[100:103], v149 offset:47104
    v_mfma_f32_16x16x32_bf16 v[72:75], a[52:55], a[64:67], v[72:75]
    buffer_load_dwordx4 v22, s[12:15], s36 offen offset:2048 lds
    v_mfma_f32_16x16x32_bf16 v[76:79], a[52:55], a[68:71], v[76:79]
    v_mfma_f32_16x16x32_bf16 v[80:83], a[56:59], a[64:67], v[80:83]
    v_mfma_f32_16x16x32_bf16 v[84:87], a[56:59], a[68:71], v[84:87]
    buffer_load_dwordx4 v23, s[12:15], s36 offen offset:3072 lds
    v_mfma_f32_16x16x32_bf16 v[88:91], a[60:63], a[64:67], v[88:91]
    v_mfma_f32_16x16x32_bf16 v[92:95], a[60:63], a[68:71], v[92:95]
    s_waitcnt lgkmcnt(0) vmcnt(16)
    s_barrier
    v_mfma_f32_16x16x32_bf16 v[32:35], a[72:75], a[104:107], v[32:35]
    ds_read_b128 a[64:67], v26 offset:0
    v_lshlrev_b32 v217, 3, v0
    v_mfma_f32_16x16x32_bf16 v[36:39], a[72:75], a[108:111], v[36:39]
    ds_read_b128 a[68:71], v26 offset:8192
    s_lshl_b32 s68, s34, 9
    v_mfma_f32_16x16x32_bf16 v[40:43], a[76:79], a[104:107], v[40:43]
    ds_read_b128 a[32:35], v24 offset:0
    s_add_u32 s68, s68, 22347776
    v_mfma_f32_16x16x32_bf16 v[44:47], a[76:79], a[108:111], v[44:47]
    ds_read_b128 a[36:39], v24 offset:2048
    v_mfma_f32_16x16x32_bf16 v[48:51], a[80:83], a[104:107], v[48:51]
    ds_read_b128 a[40:43], v24 offset:4096
    buffer_load_dword v216, v217, s[24:27], s68 offen sc1
    v_mfma_f32_16x16x32_bf16 v[52:55], a[80:83], a[108:111], v[52:55]
    ds_read_b128 a[44:47], v24 offset:6144
    s_bfe_u32 s36, s67, 262172
    v_mfma_f32_16x16x32_bf16 v[56:59], a[84:87], a[104:107], v[56:59]
    ds_read_b128 a[48:51], v24 offset:8192
    v_mfma_f32_16x16x32_bf16 v[60:63], a[84:87], a[108:111], v[60:63]
    ds_read_b128 a[52:55], v24 offset:10240
    s_add_u32 m0, s37, 98304
    v_mfma_f32_16x16x32_bf16 v[64:67], a[88:91], a[104:107], v[64:67]
    ds_read_b128 a[56:59], v24 offset:12288
    s_lshl_b32 s36, s36, 7
    v_mfma_f32_16x16x32_bf16 v[68:71], a[88:91], a[108:111], v[68:71]
    ds_read_b128 a[60:63], v24 offset:14336
    v_mfma_f32_16x16x32_bf16 v[72:75], a[92:95], a[104:107], v[72:75]
    buffer_load_dwordx4 v16, s[8:11], s36 offen offset:0 lds
    v_mfma_f32_16x16x32_bf16 v[76:79], a[92:95], a[108:111], v[76:79]
    buffer_load_dwordx4 v17, s[8:11], s36 offen offset:1024 lds
    v_mfma_f32_16x16x32_bf16 v[80:83], a[96:99], a[104:107], v[80:83]
    v_mfma_f32_16x16x32_bf16 v[84:87], a[96:99], a[108:111], v[84:87]
    buffer_load_dwordx4 v18, s[8:11], s36 offen offset:2048 lds
    v_mfma_f32_16x16x32_bf16 v[88:91], a[100:103], a[104:107], v[88:91]
    buffer_load_dwordx4 v19, s[8:11], s36 offen offset:3072 lds
    v_mfma_f32_16x16x32_bf16 v[92:95], a[100:103], a[108:111], v[92:95]
    s_waitcnt lgkmcnt(0)
    v_mfma_f32_16x16x32_bf16 v[32:35], a[32:35], a[64:67], v[32:35]
    ds_read_b128 a[104:107], v27 offset:0
    s_add_u32 m0, s37, 114688
    v_and_b32 v6, 7, v0
    v_xor_b32_e64 v6, v6, v2
    v_mfma_f32_16x16x32_bf16 v[36:39], a[32:35], a[68:71], v[36:39]
    ds_read_b128 a[108:111], v27 offset:8192
    buffer_load_dwordx4 v20, s[12:15], s36 offen offset:0 lds
    s_and_b32 s38, s33, 8
    s_lshl_b32 s38, s38, 7
    v_mfma_f32_16x16x32_bf16 v[40:43], a[36:39], a[64:67], v[40:43]
    ds_read_b128 a[72:75], v25 offset:0
    buffer_load_dwordx4 v21, s[12:15], s36 offen offset:1024 lds
    v_lshl_add_u32 v6, v6, 4, s38
    v_lshrrev_b32_e64 v8, 3, v0
    v_mfma_f32_16x16x32_bf16 v[44:47], a[36:39], a[68:71], v[44:47]
    ds_read_b128 a[76:79], v25 offset:2048
    s_xor_b32 s38, s33, 8
    v_mfma_f32_16x16x32_bf16 v[48:51], a[40:43], a[64:67], v[48:51]
    ds_read_b128 a[80:83], v25 offset:4096
    buffer_load_dwordx4 v22, s[12:15], s36 offen offset:2048 lds
    s_lshl_b32 s38, s38, 5
    s_add_u32 s38, s38, s6
    v_mfma_f32_16x16x32_bf16 v[52:55], a[40:43], a[68:71], v[52:55]
    ds_read_b128 a[84:87], v25 offset:6144
    buffer_load_dwordx4 v23, s[12:15], s36 offen offset:3072 lds
    s_lshl_b32 s38, s38, 1
    v_lshl_add_u32 v8, v8, 2, s38
    v_mfma_f32_16x16x32_bf16 v[56:59], a[44:47], a[64:67], v[56:59]
    ds_read_b128 a[88:91], v25 offset:8192
    v_lshl_add_u32 v16, v8, 11, v6
    v_mfma_f32_16x16x32_bf16 v[60:63], a[44:47], a[68:71], v[60:63]
    ds_read_b128 a[92:95], v25 offset:10240
    s_getpc_b64 s[20:21]
K_PC2:
    s_mov_b32 s22, K_CODE_END-K_PC2
    v_xor_b32 v8, 64, v16
    v_add_u32 v17, 64512, v8
    v_mfma_f32_16x16x32_bf16 v[64:67], a[48:51], a[64:67], v[64:67]
    ds_read_b128 a[96:99], v25 offset:12288
    s_bfe_u32 s3, s2, 0x20003
    v_mov_b32_e64 v18, v16
    v_add_u32 v19, 64512, v8
    v_mfma_f32_16x16x32_bf16 v[68:71], a[48:51], a[68:71], v[68:71]
    ds_read_b128 a[100:103], v25 offset:14336
    s_lshl1_add_u32 s40, s33, s6
    v_mfma_f32_16x16x32_bf16 v[72:75], a[52:55], a[64:67], v[72:75]
    s_lshl2_add_u32 s3, s3, s34
    s_lshl_b32 s40, s40, 6
    s_lshr_b32 s41, s33, 3
    v_mfma_f32_16x16x32_bf16 v[76:79], a[52:55], a[68:71], v[76:79]
    s_lshl_b32 s3, s3, 11
    s_add_u32 s40, s40, s41
    s_and_b32 s41, s32, 3
    v_mfma_f32_16x16x32_bf16 v[80:83], a[56:59], a[64:67], v[80:83]
    s_lshl2_add_u32 s40, s40, s41
    v_mfma_f32_16x16x32_bf16 v[84:87], a[56:59], a[68:71], v[84:87]
    v_lshl_add_u32 v28, v0, 5, s3
    s_and_b32 s41, s2, 1
    s_lshl1_add_u32 s40, s40, s41
    v_mfma_f32_16x16x32_bf16 v[88:91], a[60:63], a[64:67], v[88:91]
    buffer_load_dword a221, v28, s[20:23], 0 offen
    s_lshl_b32 s92, s40, 7
    v_lshrrev_b32 v29, 1, v0
    v_mfma_f32_16x16x32_bf16 v[92:95], a[60:63], a[68:71], v[92:95]
    v_lshlrev_b32 v29, 11, v29
    s_waitcnt lgkmcnt(0) vmcnt(9)
    v_cmp_ne_u32 vcc, s35, v216
    s_nop 0
    s_cbranch_vccnz K_POLL1
K_POLL1_OK:
    s_barrier
    v_mfma_f32_16x16x32_bf16 v[32:35], a[72:75], a[104:107], v[32:35]
    ds_read_b128 a[64:67], v26 offset:32768
    v_lshlrev_b32_e64 v28, 12, v2
    v_mfma_f32_16x16x32_bf16 v[36:39], a[72:75], a[108:111], v[36:39]
    ds_read_b128 a[68:71], v26 offset:40960
    v_lshl_add_u32 v28, v1, 4, v28
    v_mfma_f32_16x16x32_bf16 v[40:43], a[76:79], a[104:107], v[40:43]
    ds_read_b128 a[32:35], v24 offset:32768
    s_lshl4_add_u32 s68, s37, s5
    v_mfma_f32_16x16x32_bf16 v[44:47], a[76:79], a[108:111], v[44:47]
    ds_read_b128 a[36:39], v24 offset:34816
    s_add_u32 m0, s37, 131072
    v_mfma_f32_16x16x32_bf16 v[48:51], a[80:83], a[104:107], v[48:51]
    ds_read_b128 a[40:43], v24 offset:36864
    s_add_u32 s69, s68, 0
    v_mfma_f32_16x16x32_bf16 v[52:55], a[80:83], a[108:111], v[52:55]
    ds_read_b128 a[44:47], v24 offset:38912
    v_mfma_f32_16x16x32_bf16 v[56:59], a[84:87], a[104:107], v[56:59]
    ds_read_b128 a[48:51], v24 offset:40960
    buffer_load_dwordx4 v28, s[28:31], s69 offen sc1 lds
    v_mfma_f32_16x16x32_bf16 v[60:63], a[84:87], a[108:111], v[60:63]
    ds_read_b128 a[52:55], v24 offset:43008
    s_add_u32 m0, s37, 132096
    v_mfma_f32_16x16x32_bf16 v[64:67], a[88:91], a[104:107], v[64:67]
    ds_read_b128 a[56:59], v24 offset:45056
    s_add_u32 s69, s68, 16384
    v_mfma_f32_16x16x32_bf16 v[68:71], a[88:91], a[108:111], v[68:71]
    ds_read_b128 a[60:63], v24 offset:47104
    buffer_load_dwordx4 v28, s[28:31], s69 offen sc1 lds
    v_mfma_f32_16x16x32_bf16 v[72:75], a[92:95], a[104:107], v[72:75]
    v_mfma_f32_16x16x32_bf16 v[76:79], a[92:95], a[108:111], v[76:79]
    s_add_u32 m0, s37, 133120
    v_mfma_f32_16x16x32_bf16 v[80:83], a[96:99], a[104:107], v[80:83]
    s_add_u32 s69, s68, 32768
    v_mfma_f32_16x16x32_bf16 v[84:87], a[96:99], a[108:111], v[84:87]
    buffer_load_dwordx4 v28, s[28:31], s69 offen sc1 lds
    v_mfma_f32_16x16x32_bf16 v[88:91], a[100:103], a[104:107], v[88:91]
    s_add_u32 m0, s37, 134144
    v_mfma_f32_16x16x32_bf16 v[92:95], a[100:103], a[108:111], v[92:95]
    s_waitcnt lgkmcnt(0)
    v_mfma_f32_16x16x32_bf16 v[32:35], a[32:35], a[64:67], v[32:35]
    ds_read_b128 a[104:107], v27 offset:32768
    s_add_u32 s69, s68, 49152
    v_mfma_f32_16x16x32_bf16 v[36:39], a[32:35], a[68:71], v[36:39]
    ds_read_b128 a[108:111], v27 offset:40960
    buffer_load_dwordx4 v28, s[28:31], s69 offen sc1 lds
    v_mfma_f32_16x16x32_bf16 v[40:43], a[36:39], a[64:67], v[40:43]
    ds_read_b128 a[72:75], v25 offset:32768
    s_add_u32 s69, s68, 262144
    v_mfma_f32_16x16x32_bf16 v[44:47], a[36:39], a[68:71], v[44:47]
    ds_read_b128 a[76:79], v25 offset:34816
    buffer_load_dwordx4 v[200:203], v28, s[28:31], s69 offen sc1
    v_mfma_f32_16x16x32_bf16 v[48:51], a[40:43], a[64:67], v[48:51]
    ds_read_b128 a[80:83], v25 offset:36864
    s_add_u32 s69, s68, 278528
    v_mfma_f32_16x16x32_bf16 v[52:55], a[40:43], a[68:71], v[52:55]
    ds_read_b128 a[84:87], v25 offset:38912
    v_mfma_f32_16x16x32_bf16 v[56:59], a[44:47], a[64:67], v[56:59]
    ds_read_b128 a[88:91], v25 offset:40960
    buffer_load_dwordx4 v[204:207], v28, s[28:31], s69 offen sc1
    v_mfma_f32_16x16x32_bf16 v[60:63], a[44:47], a[68:71], v[60:63]
    ds_read_b128 a[92:95], v25 offset:43008
    s_add_u32 s69, s68, 294912
    v_mfma_f32_16x16x32_bf16 v[64:67], a[48:51], a[64:67], v[64:67]
    ds_read_b128 a[96:99], v25 offset:45056
    buffer_load_dwordx4 v[208:211], v28, s[28:31], s69 offen sc1
    v_mfma_f32_16x16x32_bf16 v[68:71], a[48:51], a[68:71], v[68:71]
    ds_read_b128 a[100:103], v25 offset:47104
    s_add_u32 s69, s68, 311296
    v_mfma_f32_16x16x32_bf16 v[72:75], a[52:55], a[64:67], v[72:75]
    v_mfma_f32_16x16x32_bf16 v[76:79], a[52:55], a[68:71], v[76:79]
    buffer_load_dwordx4 v[212:215], v28, s[28:31], s69 offen sc1
    v_mfma_f32_16x16x32_bf16 v[80:83], a[56:59], a[64:67], v[80:83]
    s_cmp_eq_u32 s2, 0
    s_cbranch_scc1 K_W256
K_W256_RET:
    v_mfma_f32_16x16x32_bf16 v[84:87], a[56:59], a[68:71], v[84:87]
    v_lshlrev_b32 v28, 6, v1
    v_mfma_f32_16x16x32_bf16 v[88:91], a[60:63], a[64:67], v[88:91]
    buffer_load_dword a222, v28, s[24:27], s51 offen sc1
    v_mfma_f32_16x16x32_bf16 v[92:95], a[60:63], a[68:71], v[92:95]
    s_waitcnt lgkmcnt(0)
    s_barrier
    v_mfma_f32_16x16x32_bf16 v[32:35], a[72:75], a[104:107], v[32:35]
    ds_read_b128 a[64:67], v150 offset:0
    v_and_b32_e64 v14, 8, v1
    v_mfma_f32_16x16x32_bf16 v[36:39], a[72:75], a[108:111], v[36:39]
    ds_read_b128 a[68:71], v150 offset:8192
    v_and_b32_e64 v15, 3, v1
    v_mfma_f32_16x16x32_bf16 v[40:43], a[76:79], a[104:107], v[40:43]
    ds_read_b128 a[32:35], v148 offset:0
    v_lshl_or_b32 v14, v15, 1, v14
    v_mfma_f32_16x16x32_bf16 v[44:47], a[76:79], a[108:111], v[44:47]
    ds_read_b128 a[36:39], v148 offset:2048
    v_bfe_u32 v15, v1, 2, 1
    v_mfma_f32_16x16x32_bf16 v[48:51], a[80:83], a[104:107], v[48:51]
    ds_read_b128 a[40:43], v148 offset:4096
    v_lshlrev_b32_e64 v13, 2, v2
    v_mfma_f32_16x16x32_bf16 v[52:55], a[80:83], a[108:111], v[52:55]
    ds_read_b128 a[44:47], v148 offset:6144
    v_or_b32_e64 v14, v14, v15
    v_mfma_f32_16x16x32_bf16 v[56:59], a[84:87], a[104:107], v[56:59]
    ds_read_b128 a[48:51], v148 offset:8192
    v_xor_b32_e64 v14, v14, v13
    v_mfma_f32_16x16x32_bf16 v[60:63], a[84:87], a[108:111], v[60:63]
    ds_read_b128 a[52:55], v148 offset:10240
    v_lshl_add_u32 v14, v1, 4, v14
    v_mfma_f32_16x16x32_bf16 v[64:67], a[88:91], a[104:107], v[64:67]
    ds_read_b128 a[56:59], v148 offset:12288
    s_lshl1_add_u32 s38, s37, 131072
    v_mfma_f32_16x16x32_bf16 v[68:71], a[88:91], a[108:111], v[68:71]
    ds_read_b128 a[60:63], v148 offset:14336
    v_lshl_add_u32 v216, v14, 4, s38
    v_mfma_f32_16x16x32_bf16 v[72:75], a[92:95], a[104:107], v[72:75]
    v_xor_b32_e64 v217, 16, v216
    v_mfma_f32_16x16x32_bf16 v[76:79], a[92:95], a[108:111], v[76:79]
    v_xor_b32_e64 v218, 32, v216
    v_mfma_f32_16x16x32_bf16 v[80:83], a[96:99], a[104:107], v[80:83]
    v_xor_b32_e64 v219, 48, v216
    v_mfma_f32_16x16x32_bf16 v[84:87], a[96:99], a[108:111], v[84:87]
    v_and_b32_e64 v14, 1, v2
    v_mfma_f32_16x16x32_bf16 v[88:91], a[100:103], a[104:107], v[88:91]
    v_lshrrev_b32_e64 v15, 2, v1
    v_mfma_f32_16x16x32_bf16 v[92:95], a[100:103], a[108:111], v[92:95]
    s_waitcnt lgkmcnt(0)
    v_mfma_f32_16x16x32_bf16 v[32:35], a[32:35], a[64:67], v[32:35]
    ds_read_b128 a[104:107], v151 offset:0
    v_lshl_add_u32 v12, v2, 3, v15
    v_mfma_f32_16x16x32_bf16 v[36:39], a[32:35], a[68:71], v[36:39]
    ds_read_b128 a[108:111], v151 offset:8192
    v_lshlrev_b32 v14, 3, v14
    v_mfma_f32_16x16x32_bf16 v[40:43], a[36:39], a[64:67], v[40:43]
    ds_read_b128 a[72:75], v149 offset:0
    v_lshl_or_b32 v14, v15, 1, v14
    v_mfma_f32_16x16x32_bf16 v[44:47], a[36:39], a[68:71], v[44:47]
    ds_read_b128 a[76:79], v149 offset:2048
    v_bfe_u32 v15, v1, 1, 1
    v_mfma_f32_16x16x32_bf16 v[48:51], a[40:43], a[64:67], v[48:51]
    ds_read_b128 a[80:83], v149 offset:4096
    v_xor_b32_e64 v14, v14, v15
    v_mfma_f32_16x16x32_bf16 v[52:55], a[40:43], a[68:71], v[52:55]
    ds_read_b128 a[84:87], v149 offset:6144
    v_lshl_add_u32 v12, v12, 4, v14
    v_mfma_f32_16x16x32_bf16 v[56:59], a[44:47], a[64:67], v[56:59]
    ds_read_b128 a[88:91], v149 offset:8192
    v_and_b32_e64 v15, 1, v1
    v_mfma_f32_16x16x32_bf16 v[60:63], a[44:47], a[68:71], v[60:63]
    ds_read_b128 a[92:95], v149 offset:10240
    v_lshl_add_u32 v12, v12, 1, v15
    v_mfma_f32_16x16x32_bf16 v[64:67], a[48:51], a[64:67], v[64:67]
    ds_read_b128 a[96:99], v149 offset:12288
    s_lshl_b32 s38, s94, 5
    v_mfma_f32_16x16x32_bf16 v[68:71], a[48:51], a[68:71], v[68:71]
    ds_read_b128 a[100:103], v149 offset:14336
    s_add_u32 s38, s38, 131072
    v_mfma_f32_16x16x32_bf16 v[72:75], a[52:55], a[64:67], v[72:75]
    v_lshlrev_b32 v12, 3, v12
    v_mfma_f32_16x16x32_bf16 v[76:79], a[52:55], a[68:71], v[76:79]
    v_xor_b32_e64 v220, s38, v12
    v_mfma_f32_16x16x32_bf16 v[80:83], a[56:59], a[64:67], v[80:83]
    v_xor_b32_e64 v221, 16, v220
    v_mfma_f32_16x16x32_bf16 v[84:87], a[56:59], a[68:71], v[84:87]
    v_xor_b32_e64 v222, 64, v220
    v_mfma_f32_16x16x32_bf16 v[88:91], a[60:63], a[64:67], v[88:91]
    v_xor_b32 v223, 80, v220
    v_mfma_f32_16x16x32_bf16 v[92:95], a[60:63], a[68:71], v[92:95]
    s_waitcnt lgkmcnt(0) vmcnt(10)
    s_barrier
    v_mfma_f32_16x16x32_bf16 v[32:35], a[72:75], a[104:107], v[32:35]
    ds_read_b128 a[64:67], v150 offset:32768
    s_bfe_u32 s72, s97, 262148
    v_and_b32_e64 v8, 1, v2
    v_mfma_f32_16x16x32_bf16 v[36:39], a[72:75], a[108:111], v[36:39]
    ds_read_b128 a[68:71], v150 offset:40960
    v_lshrrev_b32_e64 v9, 1, v1
    v_mfma_f32_16x16x32_bf16 v[40:43], a[76:79], a[104:107], v[40:43]
    ds_read_b128 a[32:35], v148 offset:32768
    v_xor_b32_e64 v8, v8, v9
    v_mfma_f32_16x16x32_bf16 v[44:47], a[76:79], a[108:111], v[44:47]
    ds_read_b128 a[36:39], v148 offset:34816
    v_lshlrev_b32_e64 v8, 4, v8
    v_mfma_f32_16x16x32_bf16 v[48:51], a[80:83], a[104:107], v[48:51]
    ds_read_b128 a[40:43], v148 offset:36864
    s_add_u32 m0, s37, 16384
    v_lshl_add_u32 v8, v1, 7, v8
    v_mfma_f32_16x16x32_bf16 v[52:55], a[80:83], a[108:111], v[52:55]
    ds_read_b128 a[44:47], v148 offset:38912
    v_lshrrev_b32_e64 v9, 1, v2
    v_mfma_f32_16x16x32_bf16 v[56:59], a[84:87], a[104:107], v[56:59]
    ds_read_b128 a[48:51], v148 offset:40960
    v_lshl_add_u32 v20, v9, 13, v8
    v_mfma_f32_16x16x32_bf16 v[60:63], a[84:87], a[108:111], v[60:63]
    ds_read_b128 a[52:55], v148 offset:43008
    v_lshlrev_b32_e64 v9, 12, v2
    v_mfma_f32_16x16x32_bf16 v[64:67], a[88:91], a[104:107], v[64:67]
    ds_read_b128 a[56:59], v148 offset:45056
    s_lshl_b32 s72, s72, 7
    v_lshl_add_u32 v24, v1, 4, v9
    v_mfma_f32_16x16x32_bf16 v[68:71], a[88:91], a[108:111], v[68:71]
    ds_read_b128 a[60:63], v148 offset:47104
    v_xor_b32 v21, 32, v20
    v_mfma_f32_16x16x32_bf16 v[72:75], a[92:95], a[104:107], v[72:75]
    v_add_u32 v25, 16384, v24
    v_mfma_f32_16x16x32_bf16 v[76:79], a[92:95], a[108:111], v[76:79]
    v_xor_b32_e64 v22, 64, v20
    v_mfma_f32_16x16x32_bf16 v[80:83], a[96:99], a[104:107], v[80:83]
    buffer_load_dwordx4 v16, s[16:19], s72 offen offset:0  lds
    v_add_u32 v26, 32768, v24
    v_mfma_f32_16x16x32_bf16 v[84:87], a[96:99], a[108:111], v[84:87]
    v_xor_b32 v23, 96, v20
    v_mfma_f32_16x16x32_bf16 v[88:91], a[100:103], a[104:107], v[88:91]
    v_add_u32 v27, 49152, v24
    v_mfma_f32_16x16x32_bf16 v[92:95], a[100:103], a[108:111], v[92:95]
    s_waitcnt lgkmcnt(0)
    v_mfma_f32_16x16x32_bf16 v[32:35], a[32:35], a[64:67], v[32:35]
    ds_read_b128 a[104:107], v151 offset:32768
    buffer_load_dwordx4 v17, s[16:19], s72 offen offset:1024  lds
    v_add_u32 v28, 131072, v3
    v_mfma_f32_16x16x32_bf16 v[36:39], a[32:35], a[68:71], v[36:39]
    ds_read_b128 a[108:111], v151 offset:40960
    v_mfma_f32_16x16x32_bf16 v[40:43], a[36:39], a[64:67], v[40:43]
    ds_read_b128 a[72:75], v149 offset:32768
    v_mfma_f32_16x16x32_bf16 v[44:47], a[36:39], a[68:71], v[44:47]
    ds_read_b128 a[76:79], v149 offset:34816
    v_mfma_f32_16x16x32_bf16 v[48:51], a[40:43], a[64:67], v[48:51]
    ds_read_b128 a[80:83], v149 offset:36864
    v_mfma_f32_16x16x32_bf16 v[52:55], a[40:43], a[68:71], v[52:55]
    ds_read_b128 a[84:87], v149 offset:38912
    buffer_load_dwordx4 v18, s[16:19], s72 offen offset:2048  lds
    v_mfma_f32_16x16x32_bf16 v[56:59], a[44:47], a[64:67], v[56:59]
    ds_read_b128 a[88:91], v149 offset:40960
    v_mfma_f32_16x16x32_bf16 v[60:63], a[44:47], a[68:71], v[60:63]
    ds_read_b128 a[92:95], v149 offset:43008
    v_mfma_f32_16x16x32_bf16 v[64:67], a[48:51], a[64:67], v[64:67]
    ds_read_b128 a[96:99], v149 offset:45056
    v_mfma_f32_16x16x32_bf16 v[68:71], a[48:51], a[68:71], v[68:71]
    ds_read_b128 a[100:103], v149 offset:47104
    v_mfma_f32_16x16x32_bf16 v[72:75], a[52:55], a[64:67], v[72:75]
    buffer_load_dwordx4 v19, s[16:19], s72 offen offset:3072  lds
    v_mfma_f32_16x16x32_bf16 v[76:79], a[52:55], a[68:71], v[76:79]
    v_mfma_f32_16x16x32_bf16 v[80:83], a[56:59], a[64:67], v[80:83]
    v_mfma_f32_16x16x32_bf16 v[84:87], a[56:59], a[68:71], v[84:87]
    v_mfma_f32_16x16x32_bf16 v[88:91], a[60:63], a[64:67], v[88:91]
    v_mfma_f32_16x16x32_bf16 v[92:95], a[60:63], a[68:71], v[92:95]
    s_waitcnt lgkmcnt(0) vmcnt(9)
    s_barrier
    v_mfma_f32_16x16x32_bf16 v[32:35], a[72:75], a[104:107], v[32:35]
    ds_read_b128 a[32:35], v28 offset:0
    v_lshlrev_b32 v12, 2, v2
    v_sub_u32_e64 v12, s32, v12
    v_mfma_f32_16x16x32_bf16 v[36:39], a[72:75], a[108:111], v[36:39]
    ds_read_b128 a[36:39], v28 offset:1024
    v_lshlrev_b32_e64 v12, 10, v12
    v_mfma_f32_16x16x32_bf16 v[40:43], a[76:79], a[104:107], v[40:43]
    ds_read_b128 a[40:43], v28 offset:2048
    v_lshl_add_u32 v12, v1, 4, v12
    v_mfma_f32_16x16x32_bf16 v[44:47], a[76:79], a[108:111], v[44:47]
    v_subrev_u32 v148, 1024, v12
    v_mfma_f32_16x16x32_bf16 v[48:51], a[80:83], a[104:107], v[48:51]
    ds_read_b128 a[44:47], v28 offset:3072
    v_min_u32_e64 v148, 2.0, v148
    v_subrev_u32 v149, 2048, v12
    v_mfma_f32_16x16x32_bf16 v[52:55], a[80:83], a[108:111], v[52:55]
    ds_read_b128 a[48:51], v28 offset:4096
    v_min_u32_e64 v149, 2.0, v149
    v_mfma_f32_16x16x32_bf16 v[56:59], a[84:87], a[104:107], v[56:59]
    ds_read_b128 a[52:55], v28 offset:5120
    v_subrev_u32 v150, 3072, v12
    v_mfma_f32_16x16x32_bf16 v[60:63], a[84:87], a[108:111], v[60:63]
    v_min_u32_e64 v150, 2.0, v150
    v_mfma_f32_16x16x32_bf16 v[64:67], a[88:91], a[104:107], v[64:67]
    ds_read_b128 a[56:59], v28 offset:6144
    v_subrev_u32 v151, 4096, v12
    v_min_u32_e64 v151, 2.0, v151
    v_mfma_f32_16x16x32_bf16 v[68:71], a[88:91], a[108:111], v[68:71]
    ds_read_b128 a[60:63], v28 offset:7168
    v_mov_b32_e64 v186, s35
    v_mfma_f32_16x16x32_bf16 v[72:75], a[92:95], a[104:107], v[72:75]
    v_mov_b32_e64 v187, s35
    v_mfma_f32_16x16x32_bf16 v[76:79], a[92:95], a[108:111], v[76:79]
    s_lshl_b32 s38, s32, 10
    v_mfma_f32_16x16x32_bf16 v[80:83], a[96:99], a[104:107], v[80:83]
    s_add_u32 s38, s38, s93
    v_cmp_gt_u32 s[78:79], 16, v0
    v_mfma_f32_16x16x32_bf16 v[84:87], a[96:99], a[108:111], v[84:87]
    v_cmp_eq_u32 s[46:47], 2, v2
    v_mfma_f32_16x16x32_bf16 v[88:91], a[100:103], a[104:107], v[88:91]
    v_cmp_eq_u32 s[44:45], 3, v2
    v_mfma_f32_16x16x32_bf16 v[92:95], a[100:103], a[108:111], v[92:95]
    v_cndmask_b32 v188, 2.0, v3, s[78:79]
    v_pk_fma_f32 v[4:5], v[32:33], v[128:129], v[34:35] op_sel_hi:[1,0,1]
    v_pk_fma_f32 v[6:7], v[36:37], v[128:129], v[38:39] op_sel_hi:[1,0,1]
    v_pk_fma_f32 v[4:5], v[36:37], v[128:129], v[4:5] op_sel:[0,1,0] neg_lo:[1,0,0] neg_hi:[1,0,0]
    v_pk_fma_f32 v[6:7], v[32:33], v[128:129], v[6:7] op_sel:[0,1,0]
    v_pk_fma_f32 v[8:9], v[4:5], v[128:129], v[40:41] op_sel_hi:[1,0,1]
    v_pk_fma_f32 v[10:11], v[6:7], v[128:129], v[44:45] op_sel_hi:[1,0,1]
    v_pk_fma_f32 v[8:9], v[6:7], v[128:129], v[8:9] op_sel:[0,1,0] neg_lo:[1,0,0] neg_hi:[1,0,0]
    v_pk_fma_f32 v[10:11], v[4:5], v[128:129], v[10:11] op_sel:[0,1,0]
    v_pk_fma_f32 v[4:5], v[8:9], v[128:129], v[42:43] op_sel_hi:[1,0,1]
    v_pk_fma_f32 v[6:7], v[10:11], v[128:129], v[46:47] op_sel_hi:[1,0,1]
    v_pk_fma_f32 v[4:5], v[10:11], v[128:129], v[4:5] op_sel:[0,1,0] neg_lo:[1,0,0] neg_hi:[1,0,0]
    v_pk_fma_f32 v[6:7], v[8:9], v[128:129], v[6:7] op_sel:[0,1,0]
    v_pk_fma_f32 v[8:9], v[4:5], v[128:129], v[48:49] op_sel_hi:[1,0,1]
    v_pk_fma_f32 v[10:11], v[6:7], v[128:129], v[52:53] op_sel_hi:[1,0,1]
    v_pk_fma_f32 v[8:9], v[6:7], v[128:129], v[8:9] op_sel:[0,1,0] neg_lo:[1,0,0] neg_hi:[1,0,0]
    v_pk_fma_f32 v[10:11], v[4:5], v[128:129], v[10:11] op_sel:[0,1,0]
    v_pk_fma_f32 v[4:5], v[8:9], v[128:129], v[50:51] op_sel_hi:[1,0,1]
    v_pk_fma_f32 v[6:7], v[10:11], v[128:129], v[54:55] op_sel_hi:[1,0,1]
    v_pk_fma_f32 v[4:5], v[10:11], v[128:129], v[4:5] op_sel:[0,1,0] neg_lo:[1,0,0] neg_hi:[1,0,0]
    v_pk_fma_f32 v[6:7], v[8:9], v[128:129], v[6:7] op_sel:[0,1,0]
    v_pk_fma_f32 v[8:9], v[4:5], v[128:129], v[56:57] op_sel_hi:[1,0,1]
    v_pk_fma_f32 v[10:11], v[6:7], v[128:129], v[60:61] op_sel_hi:[1,0,1]
    v_pk_fma_f32 v[8:9], v[6:7], v[128:129], v[8:9] op_sel:[0,1,0] neg_lo:[1,0,0] neg_hi:[1,0,0]
    v_pk_fma_f32 v[10:11], v[4:5], v[128:129], v[10:11] op_sel:[0,1,0]
    v_pk_fma_f32 v[4:5], v[8:9], v[128:129], v[58:59] op_sel_hi:[1,0,1]
    v_pk_fma_f32 v[6:7], v[10:11], v[128:129], v[62:63] op_sel_hi:[1,0,1]
    v_pk_fma_f32 v[4:5], v[10:11], v[128:129], v[4:5] op_sel:[0,1,0] neg_lo:[1,0,0] neg_hi:[1,0,0]
    v_pk_fma_f32 v[6:7], v[8:9], v[128:129], v[6:7] op_sel:[0,1,0]
    v_pk_fma_f32 v[8:9], v[4:5], v[128:129], v[64:65] op_sel_hi:[1,0,1]
    v_pk_fma_f32 v[10:11], v[6:7], v[128:129], v[68:69] op_sel_hi:[1,0,1]
    v_pk_fma_f32 v[8:9], v[6:7], v[128:129], v[8:9] op_sel:[0,1,0] neg_lo:[1,0,0] neg_hi:[1,0,0]
    v_pk_fma_f32 v[10:11], v[4:5], v[128:129], v[10:11] op_sel:[0,1,0]
    v_pk_fma_f32 v[4:5], v[8:9], v[128:129], v[66:67] op_sel_hi:[1,0,1]
    v_pk_fma_f32 v[6:7], v[10:11], v[128:129], v[70:71] op_sel_hi:[1,0,1]
    v_pk_fma_f32 v[4:5], v[10:11], v[128:129], v[4:5] op_sel:[0,1,0] neg_lo:[1,0,0] neg_hi:[1,0,0]
    v_pk_fma_f32 v[6:7], v[8:9], v[128:129], v[6:7] op_sel:[0,1,0]
    v_pk_fma_f32 v[8:9], v[4:5], v[128:129], v[72:73] op_sel_hi:[1,0,1]
    v_pk_fma_f32 v[10:11], v[6:7], v[128:129], v[76:77] op_sel_hi:[1,0,1]
    v_pk_fma_f32 v[8:9], v[6:7], v[128:129], v[8:9] op_sel:[0,1,0] neg_lo:[1,0,0] neg_hi:[1,0,0]
    v_pk_fma_f32 v[10:11], v[4:5], v[128:129], v[10:11] op_sel:[0,1,0]
    v_pk_fma_f32 v[4:5], v[8:9], v[128:129], v[74:75] op_sel_hi:[1,0,1]
    v_pk_fma_f32 v[6:7], v[10:11], v[128:129], v[78:79] op_sel_hi:[1,0,1]
    v_pk_fma_f32 v[4:5], v[10:11], v[128:129], v[4:5] op_sel:[0,1,0] neg_lo:[1,0,0] neg_hi:[1,0,0]
    v_pk_fma_f32 v[6:7], v[8:9], v[128:129], v[6:7] op_sel:[0,1,0]
    v_pk_fma_f32 v[8:9], v[4:5], v[128:129], v[80:81] op_sel_hi:[1,0,1]
    v_pk_fma_f32 v[10:11], v[6:7], v[128:129], v[84:85] op_sel_hi:[1,0,1]
    v_pk_fma_f32 v[8:9], v[6:7], v[128:129], v[8:9] op_sel:[0,1,0] neg_lo:[1,0,0] neg_hi:[1,0,0]
    v_pk_fma_f32 v[10:11], v[4:5], v[128:129], v[10:11] op_sel:[0,1,0]
    v_pk_fma_f32 v[4:5], v[8:9], v[128:129], v[82:83] op_sel_hi:[1,0,1]
    v_pk_fma_f32 v[6:7], v[10:11], v[128:129], v[86:87] op_sel_hi:[1,0,1]
    v_pk_fma_f32 v[4:5], v[10:11], v[128:129], v[4:5] op_sel:[0,1,0] neg_lo:[1,0,0] neg_hi:[1,0,0]
    v_pk_fma_f32 v[6:7], v[8:9], v[128:129], v[6:7] op_sel:[0,1,0]
    v_pk_fma_f32 v[8:9], v[4:5], v[128:129], v[88:89] op_sel_hi:[1,0,1]
    v_pk_fma_f32 v[10:11], v[6:7], v[128:129], v[92:93] op_sel_hi:[1,0,1]
    v_pk_fma_f32 v[8:9], v[6:7], v[128:129], v[8:9] op_sel:[0,1,0] neg_lo:[1,0,0] neg_hi:[1,0,0]
    v_pk_fma_f32 v[10:11], v[4:5], v[128:129], v[10:11] op_sel:[0,1,0]
    v_pk_fma_f32 v[4:5], v[8:9], v[128:129], v[90:91] op_sel_hi:[1,0,1]
    v_pk_fma_f32 v[6:7], v[10:11], v[128:129], v[94:95] op_sel_hi:[1,0,1]
    v_pk_fma_f32 v[4:5], v[10:11], v[128:129], v[4:5] op_sel:[0,1,0] neg_lo:[1,0,0] neg_hi:[1,0,0]
    v_pk_fma_f32 v[6:7], v[8:9], v[128:129], v[6:7] op_sel:[0,1,0]
    v_pk_mul_f32 v[142:143], v[4:5], v[130:131] op_sel_hi:[1,0]
    v_pk_mul_f32 v[144:145], v[6:7], v[130:131] op_sel_hi:[1,0]
    v_pk_fma_f32 v[142:143], v[6:7], v[130:131], v[142:143] op_sel:[0,1,0] neg_lo:[1,0,0] neg_hi:[1,0,0]
    v_pk_fma_f32 v[144:145], v[4:5], v[130:131], v[144:145] op_sel:[0,1,0]
    s_waitcnt lgkmcnt(4)
    v_mfma_f32_16x16x32_bf16 v[224:227], a[32:35], a[0:3], 0
    ds_read_b128 a[64:67], v28 offset:8192
    v_fma_f32 v4, v142, v132, v143
    v_fma_f32 v8, v142, v133, v145
    v_mfma_f32_16x16x32_bf16 v[228:231], a[32:35], a[4:7], 0
    ds_read_b128 a[68:71], v28 offset:9216
    v_fma_f32 v4, -v144, v133, v4
    v_mfma_f32_16x16x32_bf16 v[224:227], a[36:39], a[8:11], v[224:227]
    ds_read_b128 a[72:75], v28 offset:10240
    v_fma_f32 v8, v144, v132, v8
    v_mov_b32 v6, v4
    v_mfma_f32_16x16x32_bf16 v[228:231], a[36:39], a[12:15], v[228:231]
    ds_read_b128 a[76:79], v28 offset:11264
    v_mov_b32_e64 v10, v8
    v_mfma_f32_16x16x32_bf16 v[224:227], a[40:43], a[16:19], v[224:227]
    ds_read_b128 a[80:83], v28 offset:12288
    v_permlane32_swap_b32 v4, v6
    v_mfma_f32_16x16x32_bf16 v[228:231], a[40:43], a[20:23], v[228:231]
    ds_read_b128 a[84:87], v28 offset:13312
    v_permlane32_swap_b32 v8, v10
    v_mov_b32_e64 v5, v4
    v_mfma_f32_16x16x32_bf16 v[224:227], a[44:47], a[24:27], v[224:227]
    ds_read_b128 a[88:91], v28 offset:14336
    v_mov_b32_e64 v7, v6
    v_mfma_f32_16x16x32_bf16 v[228:231], a[44:47], a[28:31], v[228:231]
    ds_read_b128 a[92:95], v28 offset:15360
    v_mov_b32 v9, v8
    v_mov_b32 v11, v10
    s_waitcnt lgkmcnt(8)
    s_bfe_u32 s72, s97, 262152
    v_permlane16_swap_b32 v4, v5
    v_mfma_f32_16x16x32_bf16 v[232:235], a[48:51], a[0:3], 0
    s_add_u32 m0, s37, 32768
    v_permlane16_swap_b32 v6, v7
    v_mfma_f32_16x16x32_bf16 v[236:239], a[48:51], a[4:7], 0
    v_permlane16_swap_b32 v8, v9
    v_permlane16_swap_b32 v10, v11
    v_mfma_f32_16x16x32_bf16 v[232:235], a[52:55], a[8:11], v[232:235]
    s_lshl_b32 s72, s72, 7
    v_fma_f32 v12, v4, v134, v5
    v_mfma_f32_16x16x32_bf16 v[236:239], a[52:55], a[12:15], v[236:239]
    v_fma_f32 v13, v4, v135, v9
    v_mfma_f32_16x16x32_bf16 v[232:235], a[56:59], a[16:19], v[232:235]
    buffer_load_dwordx4 v16, s[16:19], s72 offen offset:0  lds
    v_fma_f32 v12, -v8, v135, v12
    v_fma_f32 v13, v8, v134, v13
    v_mfma_f32_16x16x32_bf16 v[236:239], a[56:59], a[20:23], v[236:239]
    v_fma_f32 v14, v12, v134, v6
    v_mfma_f32_16x16x32_bf16 v[232:235], a[60:63], a[24:27], v[232:235]
    buffer_load_dwordx4 v17, s[16:19], s72 offen offset:1024  lds
    v_fma_f32 v15, v12, v135, v10
    v_fma_f32 v14, -v13, v135, v14
    v_mfma_f32_16x16x32_bf16 v[236:239], a[60:63], a[28:31], v[236:239]
    v_fma_f32 v15, v13, v134, v15
    s_waitcnt lgkmcnt(4)
    buffer_load_dwordx4 v18, s[16:19], s72 offen offset:2048  lds
    v_fma_f32 v184, v14, v134, v7
    v_mfma_f32_16x16x32_bf16 v[240:243], a[64:67], a[0:3], 0
    v_fma_f32 v185, v14, v135, v11
    v_fma_f32 v184, -v15, v135, v184
    v_mfma_f32_16x16x32_bf16 v[244:247], a[64:67], a[4:7], 0
    buffer_load_dwordx4 v19, s[16:19], s72 offen offset:3072  lds
    v_fma_f32 v185, v15, v134, v185
    v_mfma_f32_16x16x32_bf16 v[240:243], a[68:71], a[8:11], v[240:243]
    buffer_store_dwordx4 v[184:187], v188, s[24:27], s38 offen sc1
    v_mfma_f32_16x16x32_bf16 v[244:247], a[68:71], a[12:15], v[244:247]
    s_bfe_u32 s72, s97, 262144
    v_cndmask_b32 v146, v4, 0, s[78:79]
    v_mfma_f32_16x16x32_bf16 v[240:243], a[72:75], a[16:19], v[240:243]
    v_cndmask_b32 v147, v8, 0, s[78:79]
    v_mfma_f32_16x16x32_bf16 v[244:247], a[72:75], a[20:23], v[244:247]
    s_add_u32 m0, s37, 0
    v_cndmask_b32 v146, v146, v12, s[46:47]
    v_cndmask_b32 v147, v147, v13, s[46:47]
    v_mfma_f32_16x16x32_bf16 v[240:243], a[76:79], a[24:27], v[240:243]
    v_cndmask_b32 v146, v146, v14, s[44:45]
    v_mfma_f32_16x16x32_bf16 v[244:247], a[76:79], a[28:31], v[244:247]
    s_lshl_b32 s72, s72, 7
    v_cndmask_b32 v147, v147, v15, s[44:45]
    s_waitcnt lgkmcnt(0) vmcnt(9)
    v_lshlrev_b32_e64 v152, 16, v200
    v_mfma_f32_16x16x32_bf16 v[248:251], a[80:83], a[0:3], 0
    buffer_load_dwordx4 v16, s[16:19], s72 offen offset:0  lds
    v_and_b32 v160, 0xffff0000, v200
    v_lshlrev_b32_e64 v168, 16, v201
    v_mfma_f32_16x16x32_bf16 v[252:255], a[80:83], a[4:7], 0
    v_and_b32 v176, 0xffff0000, v201
    v_lshlrev_b32_e64 v153, 16, v202
    v_mfma_f32_16x16x32_bf16 v[248:251], a[84:87], a[8:11], v[248:251]
    buffer_load_dwordx4 v17, s[16:19], s72 offen offset:1024  lds
    v_and_b32 v161, 0xffff0000, v202
    v_lshlrev_b32_e64 v169, 16, v203
    v_mfma_f32_16x16x32_bf16 v[252:255], a[84:87], a[12:15], v[252:255]
    v_and_b32 v177, 0xffff0000, v203
    v_lshlrev_b32_e64 v154, 16, v204
    v_mfma_f32_16x16x32_bf16 v[248:251], a[88:91], a[16:19], v[248:251]
    buffer_load_dwordx4 v18, s[16:19], s72 offen offset:2048  lds
    v_and_b32 v162, 0xffff0000, v204
    v_lshlrev_b32_e64 v170, 16, v205
    v_mfma_f32_16x16x32_bf16 v[252:255], a[88:91], a[20:23], v[252:255]
    v_and_b32 v178, 0xffff0000, v205
    v_lshlrev_b32_e64 v155, 16, v206
    v_mfma_f32_16x16x32_bf16 v[248:251], a[92:95], a[24:27], v[248:251]
    buffer_load_dwordx4 v19, s[16:19], s72 offen offset:3072  lds
    v_and_b32 v163, 0xffff0000, v206
    v_lshlrev_b32_e64 v171, 16, v207
    v_mfma_f32_16x16x32_bf16 v[252:255], a[92:95], a[28:31], v[252:255]
    v_and_b32 v179, 0xffff0000, v207
    v_pk_mul_f32 v[4:5], v[224:225], v[96:97] op_sel_hi:[1,0]
    v_pk_mul_f32 v[6:7], v[228:229], v[96:97] op_sel_hi:[1,0]
    v_pk_fma_f32 v[4:5], v[228:229], v[96:97], v[4:5] op_sel:[0,1,0]
    v_pk_fma_f32 v[6:7], v[224:225], v[96:97], v[6:7] op_sel:[0,1,0] neg_lo:[1,0,0] neg_hi:[1,0,0]
    v_pk_mul_f32 v[8:9], v[226:227], v[98:99] op_sel_hi:[1,0]
    v_pk_mul_f32 v[10:11], v[230:231], v[98:99] op_sel_hi:[1,0]
    v_pk_fma_f32 v[8:9], v[230:231], v[98:99], v[8:9] op_sel:[0,1,0]
    v_pk_fma_f32 v[10:11], v[226:227], v[98:99], v[10:11] op_sel:[0,1,0] neg_lo:[1,0,0] neg_hi:[1,0,0]
    v_cvt_pk_bf16_f32 v184, v4, v6
    v_cvt_pk_bf16_f32 v192, v5, v7
    v_cvt_pk_bf16_f32 v188, v8, v10
    v_cvt_pk_bf16_f32 v196, v9, v11
    v_pk_mul_f32 v[4:5], v[232:233], v[100:101] op_sel_hi:[1,0]
    v_pk_mul_f32 v[6:7], v[236:237], v[100:101] op_sel_hi:[1,0]
    v_pk_fma_f32 v[4:5], v[236:237], v[100:101], v[4:5] op_sel:[0,1,0]
    v_pk_fma_f32 v[6:7], v[232:233], v[100:101], v[6:7] op_sel:[0,1,0] neg_lo:[1,0,0] neg_hi:[1,0,0]
    v_pk_mul_f32 v[8:9], v[234:235], v[102:103] op_sel_hi:[1,0]
    v_pk_mul_f32 v[10:11], v[238:239], v[102:103] op_sel_hi:[1,0]
    v_pk_fma_f32 v[8:9], v[238:239], v[102:103], v[8:9] op_sel:[0,1,0]
    v_pk_fma_f32 v[10:11], v[234:235], v[102:103], v[10:11] op_sel:[0,1,0] neg_lo:[1,0,0] neg_hi:[1,0,0]
    v_cvt_pk_bf16_f32 v185, v4, v6
    v_cvt_pk_bf16_f32 v193, v5, v7
    v_cvt_pk_bf16_f32 v189, v8, v10
    v_cvt_pk_bf16_f32 v197, v9, v11
    v_pk_mul_f32 v[4:5], v[240:241], v[104:105] op_sel_hi:[1,0]
    v_pk_mul_f32 v[6:7], v[244:245], v[104:105] op_sel_hi:[1,0]
    v_pk_fma_f32 v[4:5], v[244:245], v[104:105], v[4:5] op_sel:[0,1,0]
    v_pk_fma_f32 v[6:7], v[240:241], v[104:105], v[6:7] op_sel:[0,1,0] neg_lo:[1,0,0] neg_hi:[1,0,0]
    v_pk_mul_f32 v[8:9], v[242:243], v[106:107] op_sel_hi:[1,0]
    v_pk_mul_f32 v[10:11], v[246:247], v[106:107] op_sel_hi:[1,0]
    v_pk_fma_f32 v[8:9], v[246:247], v[106:107], v[8:9] op_sel:[0,1,0]
    v_pk_fma_f32 v[10:11], v[242:243], v[106:107], v[10:11] op_sel:[0,1,0] neg_lo:[1,0,0] neg_hi:[1,0,0]
    v_cvt_pk_bf16_f32 v186, v4, v6
    v_cvt_pk_bf16_f32 v194, v5, v7
    v_cvt_pk_bf16_f32 v190, v8, v10
    v_cvt_pk_bf16_f32 v198, v9, v11
    v_pk_mul_f32 v[4:5], v[248:249], v[108:109] op_sel_hi:[1,0]
    v_pk_mul_f32 v[6:7], v[252:253], v[108:109] op_sel_hi:[1,0]
    v_pk_fma_f32 v[4:5], v[252:253], v[108:109], v[4:5] op_sel:[0,1,0]
    v_pk_fma_f32 v[6:7], v[248:249], v[108:109], v[6:7] op_sel:[0,1,0] neg_lo:[1,0,0] neg_hi:[1,0,0]
    v_pk_mul_f32 v[8:9], v[250:251], v[110:111] op_sel_hi:[1,0]
    v_pk_mul_f32 v[10:11], v[254:255], v[110:111] op_sel_hi:[1,0]
    v_pk_fma_f32 v[8:9], v[254:255], v[110:111], v[8:9] op_sel:[0,1,0]
    v_pk_fma_f32 v[10:11], v[250:251], v[110:111], v[10:11] op_sel:[0,1,0] neg_lo:[1,0,0] neg_hi:[1,0,0]
    v_cvt_pk_bf16_f32 v187, v4, v6
    v_cvt_pk_bf16_f32 v195, v5, v7
    v_cvt_pk_bf16_f32 v191, v8, v10
    v_cvt_pk_bf16_f32 v199, v9, v11
    v_mfma_f32_16x16x32_bf16 v[224:227], a[224:227], v[184:187], 0
    s_xor_b32 s40, s92, 0
    v_lshlrev_b32 v156, 16, v208
    v_and_b32 v164, 0xffff0000, v208
    v_mfma_f32_16x16x32_bf16 v[228:231], a[228:231], v[184:187], 0
    v_lshlrev_b32_e64 v172, 16, v209
    v_and_b32 v180, 0xffff0000, v209
    v_mfma_f32_16x16x32_bf16 v[232:235], a[248:251], v[188:191], 0
    v_lshlrev_b32_e64 v157, 16, v210
    v_and_b32 v165, 0xffff0000, v210
    v_mfma_f32_16x16x32_bf16 v[236:239], a[252:255], v[188:191], 0
    v_lshlrev_b32_e64 v173, 16, v211
    v_and_b32 v181, 0xffff0000, v211
    v_mfma_f32_16x16x32_bf16 v[240:243], a[224:227], v[192:195], 0
    buffer_load_dword a223, v29, s[16:19], s40 offen
    v_lshlrev_b32_e64 v158, 16, v212
    v_and_b32 v166, 0xffff0000, v212
    v_mfma_f32_16x16x32_bf16 v[244:247], a[228:231], v[192:195], 0
    v_lshlrev_b32_e64 v174, 16, v213
    v_and_b32 v182, 0xffff0000, v213
    v_mfma_f32_16x16x32_bf16 v[248:251], a[248:251], v[196:199], 0
    v_lshlrev_b32_e64 v159, 16, v214
    v_and_b32 v167, 0xffff0000, v214
    v_mfma_f32_16x16x32_bf16 v[252:255], a[252:255], v[196:199], 0
    v_lshlrev_b32_e64 v175, 16, v215
    v_and_b32 v183, 0xffff0000, v215
    v_accvgpr_read_b32 v28, a222
    v_cmp_ne_u32 s[78:79], s96, v28
    s_nop 0
    s_and_b32 s78, s78, 0x5555
    s_cmp_eq_u32 s78, 0
    s_cselect_b32 s50, 0, 2.0
    s_cselect_b32 s7, 2.0, 0
    v_cmp_eq_u32 vcc, 2.0, v148
    v_mov_b32 v200, s35
    s_nop 0
    v_cndmask_b32 v200, v200, 0, vcc
    v_cmp_eq_u32 vcc, 2.0, v149
    v_mov_b32 v201, s35
    s_nop 0
    v_cndmask_b32 v201, v201, 0, vcc
    v_cmp_eq_u32 vcc, 2.0, v150
    v_mov_b32 v202, s35
    s_nop 0
    v_cndmask_b32 v202, v202, 0, vcc
    v_cmp_eq_u32 vcc, 2.0, v151
    v_mov_b32 v203, s35
    s_nop 0
    v_cndmask_b32 v203, v203, 0, vcc
    v_pk_add_f32 v[224:225], v[224:225], v[232:233]
    v_pk_add_f32 v[226:227], v[226:227], v[234:235]
    v_pk_add_f32 v[228:229], v[228:229], v[236:237]
    v_pk_add_f32 v[230:231], v[230:231], v[238:239]
    v_pk_fma_f32 v[232:233], v[232:233], -2.0, v[224:225] op_sel_hi:[1,0,1]
    v_pk_fma_f32 v[234:235], v[234:235], -2.0, v[226:227] op_sel_hi:[1,0,1]
    v_pk_fma_f32 v[236:237], v[236:237], -2.0, v[228:229] op_sel_hi:[1,0,1]
    v_pk_fma_f32 v[238:239], v[238:239], -2.0, v[230:231] op_sel_hi:[1,0,1]
    v_pk_add_f32 v[240:241], v[240:241], v[248:249]
    v_pk_add_f32 v[242:243], v[242:243], v[250:251]
    v_pk_add_f32 v[244:245], v[244:245], v[252:253]
    v_pk_add_f32 v[246:247], v[246:247], v[254:255]
    v_pk_fma_f32 v[248:249], v[248:249], -2.0, v[240:241] op_sel_hi:[1,0,1]
    v_pk_fma_f32 v[250:251], v[250:251], -2.0, v[242:243] op_sel_hi:[1,0,1]
    v_pk_fma_f32 v[252:253], v[252:253], -2.0, v[244:245] op_sel_hi:[1,0,1]
    v_pk_fma_f32 v[254:255], v[254:255], -2.0, v[246:247] op_sel_hi:[1,0,1]
    s_cmp_eq_u32 s2, 0
    s_cbranch_scc1 K_SPECIAL
    v_pk_fma_f32 v[4:5], v[224:225], s[42:43], v[244:245] op_sel_hi:[1,0,1]
    v_pk_fma_f32 v[6:7], v[228:229], s[42:43], v[240:241] op_sel_hi:[1,0,1] neg_lo:[0,0,1] neg_hi:[0,0,1]
    v_pk_fma_f32 v[8:9], v[240:241], s[42:43], v[228:229] op_sel_hi:[1,0,1]
    v_pk_fma_f32 v[10:11], v[244:245], s[42:43], v[224:225] op_sel_hi:[1,0,1] neg_lo:[0,0,1] neg_hi:[0,0,1]
    v_pk_mul_f32 v[224:225], v[4:5], v[152:153]
    v_pk_mul_f32 v[228:229], v[6:7], v[152:153]
    v_pk_mul_f32 v[240:241], v[8:9], v[168:169]
    v_pk_mul_f32 v[244:245], v[10:11], v[168:169]
    v_pk_fma_f32 v[152:153], v[6:7], v[160:161], v[224:225] neg_lo:[1,0,0] neg_hi:[1,0,0]
    v_pk_fma_f32 v[160:161], v[4:5], v[160:161], v[228:229]
    v_pk_fma_f32 v[168:169], v[10:11], v[176:177], v[240:241]
    v_pk_fma_f32 v[176:177], v[8:9], v[176:177], v[244:245] neg_lo:[1,0,0] neg_hi:[1,0,0]
    v_pk_fma_f32 v[224:225], v[152:153], s[42:43], v[176:177] op_sel_hi:[1,0,1] neg_lo:[0,0,1] neg_hi:[0,0,1]
    v_pk_fma_f32 v[228:229], v[160:161], s[42:43], v[168:169] op_sel_hi:[1,0,1]
    v_pk_fma_f32 v[240:241], v[168:169], s[42:43], v[160:161] op_sel_hi:[1,0,1] neg_lo:[0,0,1] neg_hi:[0,0,1]
    v_pk_fma_f32 v[244:245], v[176:177], s[42:43], v[152:153] op_sel_hi:[1,0,1]
    v_pk_fma_f32 v[4:5], v[226:227], s[42:43], v[246:247] op_sel_hi:[1,0,1]
    v_pk_fma_f32 v[6:7], v[230:231], s[42:43], v[242:243] op_sel_hi:[1,0,1] neg_lo:[0,0,1] neg_hi:[0,0,1]
    v_pk_fma_f32 v[8:9], v[242:243], s[42:43], v[230:231] op_sel_hi:[1,0,1]
    v_pk_fma_f32 v[10:11], v[246:247], s[42:43], v[226:227] op_sel_hi:[1,0,1] neg_lo:[0,0,1] neg_hi:[0,0,1]
    v_pk_mul_f32 v[226:227], v[4:5], v[154:155]
    v_pk_mul_f32 v[230:231], v[6:7], v[154:155]
    v_pk_mul_f32 v[242:243], v[8:9], v[170:171]
    v_pk_mul_f32 v[246:247], v[10:11], v[170:171]
    v_pk_fma_f32 v[154:155], v[6:7], v[162:163], v[226:227] neg_lo:[1,0,0] neg_hi:[1,0,0]
    v_pk_fma_f32 v[162:163], v[4:5], v[162:163], v[230:231]
    v_pk_fma_f32 v[170:171], v[10:11], v[178:179], v[242:243]
    v_pk_fma_f32 v[178:179], v[8:9], v[178:179], v[246:247] neg_lo:[1,0,0] neg_hi:[1,0,0]
    v_pk_fma_f32 v[226:227], v[154:155], s[42:43], v[178:179] op_sel_hi:[1,0,1] neg_lo:[0,0,1] neg_hi:[0,0,1]
    v_pk_fma_f32 v[230:231], v[162:163], s[42:43], v[170:171] op_sel_hi:[1,0,1]
    v_pk_fma_f32 v[242:243], v[170:171], s[42:43], v[162:163] op_sel_hi:[1,0,1] neg_lo:[0,0,1] neg_hi:[0,0,1]
    v_pk_fma_f32 v[246:247], v[178:179], s[42:43], v[154:155] op_sel_hi:[1,0,1]
    v_pk_fma_f32 v[4:5], v[232:233], s[42:43], v[252:253] op_sel_hi:[1,0,1]
    v_pk_fma_f32 v[6:7], v[236:237], s[42:43], v[248:249] op_sel_hi:[1,0,1] neg_lo:[0,0,1] neg_hi:[0,0,1]
    v_pk_fma_f32 v[8:9], v[248:249], s[42:43], v[236:237] op_sel_hi:[1,0,1]
    v_pk_fma_f32 v[10:11], v[252:253], s[42:43], v[232:233] op_sel_hi:[1,0,1] neg_lo:[0,0,1] neg_hi:[0,0,1]
    v_pk_mul_f32 v[232:233], v[4:5], v[156:157]
    v_pk_mul_f32 v[236:237], v[6:7], v[156:157]
    v_pk_mul_f32 v[248:249], v[8:9], v[172:173]
    v_pk_mul_f32 v[252:253], v[10:11], v[172:173]
    v_pk_fma_f32 v[156:157], v[6:7], v[164:165], v[232:233] neg_lo:[1,0,0] neg_hi:[1,0,0]
    v_pk_fma_f32 v[164:165], v[4:5], v[164:165], v[236:237]
    v_pk_fma_f32 v[172:173], v[10:11], v[180:181], v[248:249]
    v_pk_fma_f32 v[180:181], v[8:9], v[180:181], v[252:253] neg_lo:[1,0,0] neg_hi:[1,0,0]
    v_pk_fma_f32 v[232:233], v[156:157], s[42:43], v[180:181] op_sel_hi:[1,0,1] neg_lo:[0,0,1] neg_hi:[0,0,1]
    v_pk_fma_f32 v[236:237], v[164:165], s[42:43], v[172:173] op_sel_hi:[1,0,1]
    v_pk_fma_f32 v[248:249], v[172:173], s[42:43], v[164:165] op_sel_hi:[1,0,1] neg_lo:[0,0,1] neg_hi:[0,0,1]
    v_pk_fma_f32 v[252:253], v[180:181], s[42:43], v[156:157] op_sel_hi:[1,0,1]
    v_pk_fma_f32 v[4:5], v[234:235], s[42:43], v[254:255] op_sel_hi:[1,0,1]
    v_pk_fma_f32 v[6:7], v[238:239], s[42:43], v[250:251] op_sel_hi:[1,0,1] neg_lo:[0,0,1] neg_hi:[0,0,1]
    v_pk_fma_f32 v[8:9], v[250:251], s[42:43], v[238:239] op_sel_hi:[1,0,1]
    v_pk_fma_f32 v[10:11], v[254:255], s[42:43], v[234:235] op_sel_hi:[1,0,1] neg_lo:[0,0,1] neg_hi:[0,0,1]
    v_pk_mul_f32 v[234:235], v[4:5], v[158:159]
    v_pk_mul_f32 v[238:239], v[6:7], v[158:159]
    v_pk_mul_f32 v[250:251], v[8:9], v[174:175]
    v_pk_mul_f32 v[254:255], v[10:11], v[174:175]
    v_pk_fma_f32 v[158:159], v[6:7], v[166:167], v[234:235] neg_lo:[1,0,0] neg_hi:[1,0,0]
    v_pk_fma_f32 v[166:167], v[4:5], v[166:167], v[238:239]
    v_pk_fma_f32 v[174:175], v[10:11], v[182:183], v[250:251]
    v_pk_fma_f32 v[182:183], v[8:9], v[182:183], v[254:255] neg_lo:[1,0,0] neg_hi:[1,0,0]
    v_pk_fma_f32 v[234:235], v[158:159], s[42:43], v[182:183] op_sel_hi:[1,0,1] neg_lo:[0,0,1] neg_hi:[0,0,1]
    v_pk_fma_f32 v[238:239], v[166:167], s[42:43], v[174:175] op_sel_hi:[1,0,1]
    v_pk_fma_f32 v[250:251], v[174:175], s[42:43], v[166:167] op_sel_hi:[1,0,1] neg_lo:[0,0,1] neg_hi:[0,0,1]
    v_pk_fma_f32 v[254:255], v[182:183], s[42:43], v[158:159] op_sel_hi:[1,0,1]
K_SPECIAL2_RET:
    v_pk_add_f32 v[224:225], v[224:225], v[232:233]
    v_pk_add_f32 v[226:227], v[226:227], v[234:235]
    v_pk_add_f32 v[228:229], v[228:229], v[236:237]
    v_pk_add_f32 v[230:231], v[230:231], v[238:239]
    v_pk_fma_f32 v[232:233], v[232:233], -2.0, v[224:225] op_sel_hi:[1,0,1]
    v_pk_fma_f32 v[234:235], v[234:235], -2.0, v[226:227] op_sel_hi:[1,0,1]
    v_pk_fma_f32 v[236:237], v[236:237], -2.0, v[228:229] op_sel_hi:[1,0,1]
    v_pk_fma_f32 v[238:239], v[238:239], -2.0, v[230:231] op_sel_hi:[1,0,1]
    v_cvt_pk_bf16_f32 v184, v224, -v228
    v_cvt_pk_bf16_f32 v185, v225, -v229
    v_cvt_pk_bf16_f32 v186, v226, -v230
    v_cvt_pk_bf16_f32 v187, v227, -v231
    v_cvt_pk_bf16_f32 v188, v232, -v236
    v_cvt_pk_bf16_f32 v189, v233, -v237
    v_cvt_pk_bf16_f32 v190, v234, -v238
    v_cvt_pk_bf16_f32 v191, v235, -v239
    v_pk_add_f32 v[240:241], v[240:241], v[248:249]
    v_pk_add_f32 v[242:243], v[242:243], v[250:251]
    v_pk_add_f32 v[244:245], v[244:245], v[252:253]
    v_pk_add_f32 v[246:247], v[246:247], v[254:255]
    v_pk_fma_f32 v[248:249], v[248:249], -2.0, v[240:241] op_sel_hi:[1,0,1]
    v_pk_fma_f32 v[250:251], v[250:251], -2.0, v[242:243] op_sel_hi:[1,0,1]
    v_pk_fma_f32 v[252:253], v[252:253], -2.0, v[244:245] op_sel_hi:[1,0,1]
    v_pk_fma_f32 v[254:255], v[254:255], -2.0, v[246:247] op_sel_hi:[1,0,1]
    v_cvt_pk_bf16_f32 v192, v240, -v244
    v_cvt_pk_bf16_f32 v193, v241, -v245
    v_cvt_pk_bf16_f32 v194, v242, -v246
    v_cvt_pk_bf16_f32 v195, v243, -v247
    v_cvt_pk_bf16_f32 v196, v248, -v252
    v_cvt_pk_bf16_f32 v197, v249, -v253
    v_cvt_pk_bf16_f32 v198, v250, -v254
    v_cvt_pk_bf16_f32 v199, v251, -v255
    v_mfma_f32_16x16x32_bf16 v[224:227], v[184:187], a[224:227], 0
    v_and_b32_e64 v12, 3, v1
    v_mul_u32_u24 v13, 4112, v12
    v_mfma_f32_16x16x32_bf16 v[228:231], v[184:187], a[228:231], 0
    v_and_b32_e64 v14, 60, v0
    v_lshl_add_u32 v13, v14, 4, v13
    v_mfma_f32_16x16x32_bf16 v[232:235], v[188:191], a[232:235], 0
    s_lshl_b32 s38, s34, 10
    s_add_u32 s38, s38, 114624
    v_mfma_f32_16x16x32_bf16 v[236:239], v[188:191], a[236:239], 0
    v_add_u32 v204, s38, v13
    v_add_u32 v205, 114624, v3
    v_lshlrev_b32_e64 v12, 4, v12
    v_lshl_add_u32 v206, v14, 14, v12
    v_lshlrev_b32_e64 v207, 31, v1
    v_pk_mul_f32 v[4:5], v[36:37], v[130:131] op_sel:[0,1]
    v_pk_mul_f32 v[6:7], v[32:33], v[130:131] op_sel:[0,1]
    v_pk_fma_f32 v[32:33], v[32:33], v[130:131], v[4:5] op_sel_hi:[1,0,1] neg_lo:[0,0,1] neg_hi:[0,0,1]
    v_pk_fma_f32 v[36:37], v[36:37], v[130:131], v[6:7] op_sel_hi:[1,0,1]
    v_pk_mul_f32 v[8:9], v[38:39], v[130:131] op_sel:[0,1]
    v_pk_mul_f32 v[10:11], v[34:35], v[130:131] op_sel:[0,1]
    v_pk_fma_f32 v[34:35], v[34:35], v[130:131], v[8:9] op_sel_hi:[1,0,1] neg_lo:[0,0,1] neg_hi:[0,0,1]
    v_pk_fma_f32 v[38:39], v[38:39], v[130:131], v[10:11] op_sel_hi:[1,0,1]
    v_pk_mul_f32 v[4:5], v[44:45], v[130:131] op_sel:[0,1]
    v_pk_mul_f32 v[6:7], v[40:41], v[130:131] op_sel:[0,1]
    v_pk_fma_f32 v[40:41], v[40:41], v[130:131], v[4:5] op_sel_hi:[1,0,1] neg_lo:[0,0,1] neg_hi:[0,0,1]
    v_pk_fma_f32 v[44:45], v[44:45], v[130:131], v[6:7] op_sel_hi:[1,0,1]
    v_pk_mul_f32 v[8:9], v[46:47], v[130:131] op_sel:[0,1]
    v_pk_mul_f32 v[10:11], v[42:43], v[130:131] op_sel:[0,1]
    v_pk_fma_f32 v[42:43], v[42:43], v[130:131], v[8:9] op_sel_hi:[1,0,1] neg_lo:[0,0,1] neg_hi:[0,0,1]
    v_pk_fma_f32 v[46:47], v[46:47], v[130:131], v[10:11] op_sel_hi:[1,0,1]
    v_pk_mul_f32 v[4:5], v[52:53], v[130:131] op_sel:[0,1]
    v_pk_mul_f32 v[6:7], v[48:49], v[130:131] op_sel:[0,1]
    v_pk_fma_f32 v[48:49], v[48:49], v[130:131], v[4:5] op_sel_hi:[1,0,1] neg_lo:[0,0,1] neg_hi:[0,0,1]
    v_pk_fma_f32 v[52:53], v[52:53], v[130:131], v[6:7] op_sel_hi:[1,0,1]
    v_pk_mul_f32 v[8:9], v[54:55], v[130:131] op_sel:[0,1]
    v_pk_mul_f32 v[10:11], v[50:51], v[130:131] op_sel:[0,1]
    v_pk_fma_f32 v[50:51], v[50:51], v[130:131], v[8:9] op_sel_hi:[1,0,1] neg_lo:[0,0,1] neg_hi:[0,0,1]
    v_pk_fma_f32 v[54:55], v[54:55], v[130:131], v[10:11] op_sel_hi:[1,0,1]
    v_pk_mul_f32 v[4:5], v[60:61], v[130:131] op_sel:[0,1]
    v_pk_mul_f32 v[6:7], v[56:57], v[130:131] op_sel:[0,1]
    v_pk_fma_f32 v[56:57], v[56:57], v[130:131], v[4:5] op_sel_hi:[1,0,1] neg_lo:[0,0,1] neg_hi:[0,0,1]
    v_pk_fma_f32 v[60:61], v[60:61], v[130:131], v[6:7] op_sel_hi:[1,0,1]
    v_pk_mul_f32 v[8:9], v[62:63], v[130:131] op_sel:[0,1]
    v_pk_mul_f32 v[10:11], v[58:59], v[130:131] op_sel:[0,1]
    v_pk_fma_f32 v[58:59], v[58:59], v[130:131], v[8:9] op_sel_hi:[1,0,1] neg_lo:[0,0,1] neg_hi:[0,0,1]
    v_pk_fma_f32 v[62:63], v[62:63], v[130:131], v[10:11] op_sel_hi:[1,0,1]
    v_pk_mul_f32 v[4:5], v[68:69], v[130:131] op_sel:[0,1]
    v_pk_mul_f32 v[6:7], v[64:65], v[130:131] op_sel:[0,1]
    v_pk_fma_f32 v[64:65], v[64:65], v[130:131], v[4:5] op_sel_hi:[1,0,1] neg_lo:[0,0,1] neg_hi:[0,0,1]
    v_pk_fma_f32 v[68:69], v[68:69], v[130:131], v[6:7] op_sel_hi:[1,0,1]
    v_pk_mul_f32 v[8:9], v[70:71], v[130:131] op_sel:[0,1]
    v_pk_mul_f32 v[10:11], v[66:67], v[130:131] op_sel:[0,1]
    v_pk_fma_f32 v[66:67], v[66:67], v[130:131], v[8:9] op_sel_hi:[1,0,1] neg_lo:[0,0,1] neg_hi:[0,0,1]
    v_pk_fma_f32 v[70:71], v[70:71], v[130:131], v[10:11] op_sel_hi:[1,0,1]
    v_pk_mul_f32 v[4:5], v[76:77], v[130:131] op_sel:[0,1]
    v_pk_mul_f32 v[6:7], v[72:73], v[130:131] op_sel:[0,1]
    v_pk_fma_f32 v[72:73], v[72:73], v[130:131], v[4:5] op_sel_hi:[1,0,1] neg_lo:[0,0,1] neg_hi:[0,0,1]
    v_pk_fma_f32 v[76:77], v[76:77], v[130:131], v[6:7] op_sel_hi:[1,0,1]
    v_pk_mul_f32 v[8:9], v[78:79], v[130:131] op_sel:[0,1]
    v_pk_mul_f32 v[10:11], v[74:75], v[130:131] op_sel:[0,1]
    v_pk_fma_f32 v[74:75], v[74:75], v[130:131], v[8:9] op_sel_hi:[1,0,1] neg_lo:[0,0,1] neg_hi:[0,0,1]
    v_pk_fma_f32 v[78:79], v[78:79], v[130:131], v[10:11] op_sel_hi:[1,0,1]
    v_pk_mul_f32 v[4:5], v[84:85], v[130:131] op_sel:[0,1]
    v_pk_mul_f32 v[6:7], v[80:81], v[130:131] op_sel:[0,1]
    v_pk_fma_f32 v[80:81], v[80:81], v[130:131], v[4:5] op_sel_hi:[1,0,1] neg_lo:[0,0,1] neg_hi:[0,0,1]
    v_pk_fma_f32 v[84:85], v[84:85], v[130:131], v[6:7] op_sel_hi:[1,0,1]
    v_pk_mul_f32 v[8:9], v[86:87], v[130:131] op_sel:[0,1]
    v_pk_mul_f32 v[10:11], v[82:83], v[130:131] op_sel:[0,1]
    v_pk_fma_f32 v[82:83], v[82:83], v[130:131], v[8:9] op_sel_hi:[1,0,1] neg_lo:[0,0,1] neg_hi:[0,0,1]
    v_pk_fma_f32 v[86:87], v[86:87], v[130:131], v[10:11] op_sel_hi:[1,0,1]
    v_pk_mul_f32 v[4:5], v[92:93], v[130:131] op_sel:[0,1]
    v_pk_mul_f32 v[6:7], v[88:89], v[130:131] op_sel:[0,1]
    v_pk_fma_f32 v[88:89], v[88:89], v[130:131], v[4:5] op_sel_hi:[1,0,1] neg_lo:[0,0,1] neg_hi:[0,0,1]
    v_pk_fma_f32 v[92:93], v[92:93], v[130:131], v[6:7] op_sel_hi:[1,0,1]
    v_pk_mul_f32 v[8:9], v[94:95], v[130:131] op_sel:[0,1]
    v_pk_mul_f32 v[10:11], v[90:91], v[130:131] op_sel:[0,1]
    v_pk_fma_f32 v[90:91], v[90:91], v[130:131], v[8:9] op_sel_hi:[1,0,1] neg_lo:[0,0,1] neg_hi:[0,0,1]
    v_pk_fma_f32 v[94:95], v[94:95], v[130:131], v[10:11] op_sel_hi:[1,0,1]
    v_pk_mul_f32 v[4:5], v[224:225], v[112:113]
    v_pk_mul_f32 v[6:7], v[228:229], v[112:113]
    v_pk_fma_f32 v[4:5], v[228:229], v[116:117], v[4:5]
    v_pk_fma_f32 v[6:7], v[224:225], v[116:117], v[6:7] neg_lo:[1,0,0] neg_hi:[1,0,0]
    v_pk_mul_f32 v[8:9], v[226:227], v[114:115]
    v_pk_mul_f32 v[10:11], v[230:231], v[114:115]
    v_pk_fma_f32 v[8:9], v[230:231], v[118:119], v[8:9]
    v_pk_fma_f32 v[10:11], v[226:227], v[118:119], v[10:11] neg_lo:[1,0,0] neg_hi:[1,0,0]
    v_cvt_pk_bf16_f32 v184, v4, v6
    v_cvt_pk_bf16_f32 v185, v5, v7
    v_cvt_pk_bf16_f32 v186, v8, v10
    v_cvt_pk_bf16_f32 v187, v9, v11
    v_pk_mul_f32 v[4:5], v[232:233], v[120:121]
    v_pk_mul_f32 v[6:7], v[236:237], v[120:121]
    v_pk_fma_f32 v[4:5], v[236:237], v[124:125], v[4:5]
    v_pk_fma_f32 v[6:7], v[232:233], v[124:125], v[6:7] neg_lo:[1,0,0] neg_hi:[1,0,0]
    v_pk_mul_f32 v[8:9], v[234:235], v[122:123]
    v_pk_mul_f32 v[10:11], v[238:239], v[122:123]
    v_pk_fma_f32 v[8:9], v[238:239], v[126:127], v[8:9]
    v_pk_fma_f32 v[10:11], v[234:235], v[126:127], v[10:11] neg_lo:[1,0,0] neg_hi:[1,0,0]
    v_cvt_pk_bf16_f32 v188, v4, v6
    v_cvt_pk_bf16_f32 v189, v5, v7
    v_cvt_pk_bf16_f32 v190, v8, v10
    v_cvt_pk_bf16_f32 v191, v9, v11
    v_mfma_f32_16x16x32_bf16 v[240:243], v[192:195], a[224:227], 0
    ds_write_b128 v204, v[184:187] offset:0
    v_mfma_f32_16x16x32_bf16 v[244:247], v[192:195], a[228:231], 0
    ds_write_b128 v204, v[188:191] offset:32
    v_mfma_f32_16x16x32_bf16 v[248:251], v[196:199], a[232:235], 0
    v_mfma_f32_16x16x32_bf16 v[252:255], v[196:199], a[236:239], 0
    s_lshl_b32 s68, s94, 16
    s_add_u32 s68, s68, s5
    s_add_u32 s69, s68, 0x20000
    s_lshl_b32 s38, s34, 14
    s_nop 0
    v_pk_mul_f32 v[4:5], v[240:241], v[112:113]
    v_pk_mul_f32 v[6:7], v[244:245], v[112:113]
    v_pk_fma_f32 v[4:5], v[244:245], v[116:117], v[4:5]
    v_pk_fma_f32 v[6:7], v[240:241], v[116:117], v[6:7] neg_lo:[1,0,0] neg_hi:[1,0,0]
    v_pk_mul_f32 v[8:9], v[242:243], v[114:115]
    v_pk_mul_f32 v[10:11], v[246:247], v[114:115]
    v_pk_fma_f32 v[8:9], v[246:247], v[118:119], v[8:9]
    v_pk_fma_f32 v[10:11], v[242:243], v[118:119], v[10:11] neg_lo:[1,0,0] neg_hi:[1,0,0]
    v_cvt_pk_bf16_f32 v192, v4, v6
    v_cvt_pk_bf16_f32 v193, v5, v7
    v_cvt_pk_bf16_f32 v194, v8, v10
    v_cvt_pk_bf16_f32 v195, v9, v11
    v_pk_mul_f32 v[4:5], v[248:249], v[120:121]
    v_pk_mul_f32 v[6:7], v[252:253], v[120:121]
    v_pk_fma_f32 v[4:5], v[252:253], v[124:125], v[4:5]
    v_pk_fma_f32 v[6:7], v[248:249], v[124:125], v[6:7] neg_lo:[1,0,0] neg_hi:[1,0,0]
    v_pk_mul_f32 v[8:9], v[250:251], v[122:123]
    v_pk_mul_f32 v[10:11], v[254:255], v[122:123]
    v_pk_fma_f32 v[8:9], v[254:255], v[126:127], v[8:9]
    v_pk_fma_f32 v[10:11], v[250:251], v[126:127], v[10:11] neg_lo:[1,0,0] neg_hi:[1,0,0]
    v_cvt_pk_bf16_f32 v196, v4, v6
    v_cvt_pk_bf16_f32 v197, v5, v7
    v_cvt_pk_bf16_f32 v198, v8, v10
    v_cvt_pk_bf16_f32 v199, v9, v11
    s_add_u32 s38, s38, s4
    s_lshl_b32 s38, s38, 6
    ds_write_b128 v204, v[192:195] offset:16
    ds_write_b128 v204, v[196:199] offset:48
    s_add_u32 s38, s38, 9437184
    s_and_b32 s70, s2, 0xe0
    s_lshl2_add_u32 s70, s70, s51
    s_waitcnt lgkmcnt(0)
    s_barrier
    s_nop 0
    ds_read_b128 a[32:35], v205 offset:0
    ds_read_b128 a[36:39], v205 offset:1024
    ds_read_b128 a[40:43], v205 offset:2048
    ds_read_b128 a[44:47], v205 offset:3072
    buffer_load_dwordx4 v[96:99], v148, s[24:27], s93 offen sc1
    buffer_load_dwordx4 v[100:103], v149, s[24:27], s93 offen sc1
    buffer_load_dwordx4 v[104:107], v150, s[24:27], s93 offen sc1
    buffer_load_dwordx4 v[108:111], v151, s[24:27], s93 offen sc1
    s_bfe_u32 s72, s97, 262156
    s_add_u32 m0, s37, 49152
    s_lshl_b32 s72, s72, 7
    buffer_load_dwordx4 v16, s[16:19], s72 offen offset:0  lds
    buffer_load_dwordx4 v17, s[16:19], s72 offen offset:1024  lds
    buffer_load_dwordx4 v18, s[16:19], s72 offen offset:2048  lds
    buffer_load_dwordx4 v19, s[16:19], s72 offen offset:3072  lds
    s_waitcnt lgkmcnt(0)
    v_mfma_f32_16x16x32_bf16 v[224:227], a[0:3], a[32:35], 0
    ds_read_b128 a[48:51], v205 offset:4112
    v_accvgpr_read_b32 v112, a152
    v_mfma_f32_16x16x32_bf16 v[228:231], a[4:7], a[32:35], 0
    ds_read_b128 a[52:55], v205 offset:5136
    v_accvgpr_read_b32 v113, a153
    v_mfma_f32_16x16x32_bf16 v[224:227], a[8:11], a[36:39], v[224:227]
    ds_read_b128 a[56:59], v205 offset:6160
    v_accvgpr_read_b32 v114, a154
    v_mfma_f32_16x16x32_bf16 v[228:231], a[12:15], a[36:39], v[228:231]
    ds_read_b128 a[60:63], v205 offset:7184
    v_mfma_f32_16x16x32_bf16 v[224:227], a[16:19], a[40:43], v[224:227]
    ds_read_b128 a[64:67], v205 offset:8224
    v_accvgpr_read_b32 v115, a155
    v_mfma_f32_16x16x32_bf16 v[228:231], a[20:23], a[40:43], v[228:231]
    ds_read_b128 a[68:71], v205 offset:9248
    v_accvgpr_read_b32 v116, a156
    v_mfma_f32_16x16x32_bf16 v[224:227], a[24:27], a[44:47], v[224:227]
    ds_read_b128 a[72:75], v205 offset:10272
    v_accvgpr_read_b32 v117, a157
    v_mfma_f32_16x16x32_bf16 v[228:231], a[28:31], a[44:47], v[228:231]
    ds_read_b128 a[76:79], v205 offset:11296
    s_waitcnt lgkmcnt(4)
    v_mfma_f32_16x16x32_bf16 v[232:235], a[0:3], a[48:51], 0
    ds_read_b128 a[80:83], v205 offset:12336
    s_bfe_u32 s72, s97, 262160
    v_accvgpr_read_b32 v118, a158
    v_mfma_f32_16x16x32_bf16 v[236:239], a[4:7], a[48:51], 0
    ds_read_b128 a[84:87], v205 offset:13360
    v_accvgpr_read_b32 v119, a159
    v_mfma_f32_16x16x32_bf16 v[232:235], a[8:11], a[52:55], v[232:235]
    ds_read_b128 a[88:91], v205 offset:14384
    s_add_u32 m0, s37, 65536
    v_mfma_f32_16x16x32_bf16 v[236:239], a[12:15], a[52:55], v[236:239]
    ds_read_b128 a[92:95], v205 offset:15408
    v_cvt_pk_bf16_f32 v184, v224, v228
    v_cvt_pk_bf16_f32 v185, v225, v229
    v_mfma_f32_16x16x32_bf16 v[232:235], a[16:19], a[56:59], v[232:235]
    s_lshl_b32 s72, s72, 7
    v_cvt_pk_bf16_f32 v186, v226, v230
    v_cvt_pk_bf16_f32 v187, v227, v231
    v_mfma_f32_16x16x32_bf16 v[236:239], a[20:23], a[56:59], v[236:239]
    v_xor_b32 v184, v207, v184
    v_xor_b32 v185, v207, v185
    v_mfma_f32_16x16x32_bf16 v[232:235], a[24:27], a[60:63], v[232:235]
    v_xor_b32 v186, v207, v186
    v_xor_b32 v187, v207, v187
    v_mfma_f32_16x16x32_bf16 v[236:239], a[28:31], a[60:63], v[236:239]
    buffer_store_dwordx4 v[184:187], v206, s[24:27], s38 offen sc1
    s_add_u32 s38, s38, 16384
    s_waitcnt lgkmcnt(4)
    v_mfma_f32_16x16x32_bf16 v[240:243], a[0:3], a[64:67], 0
    buffer_load_dwordx4 v16, s[16:19], s72 offen offset:0  lds
    v_accvgpr_read_b32 v120, a160
    v_mfma_f32_16x16x32_bf16 v[244:247], a[4:7], a[64:67], 0
    v_accvgpr_read_b32 v121, a161
    v_mfma_f32_16x16x32_bf16 v[240:243], a[8:11], a[68:71], v[240:243]
    buffer_load_dwordx4 v17, s[16:19], s72 offen offset:1024  lds
    v_mfma_f32_16x16x32_bf16 v[244:247], a[12:15], a[68:71], v[244:247]
    v_cvt_pk_bf16_f32 v188, v232, v236
    v_cvt_pk_bf16_f32 v189, v233, v237
    v_mfma_f32_16x16x32_bf16 v[240:243], a[16:19], a[72:75], v[240:243]
    buffer_load_dwordx4 v18, s[16:19], s72 offen offset:2048  lds
    v_cvt_pk_bf16_f32 v190, v234, v238
    v_cvt_pk_bf16_f32 v191, v235, v239
    v_mfma_f32_16x16x32_bf16 v[244:247], a[20:23], a[72:75], v[244:247]
    v_xor_b32 v188, v207, v188
    v_xor_b32_e64 v189, v207, v189
    v_mfma_f32_16x16x32_bf16 v[240:243], a[24:27], a[76:79], v[240:243]
    v_xor_b32 v190, v207, v190
    v_xor_b32 v191, v207, v191
    v_mfma_f32_16x16x32_bf16 v[244:247], a[28:31], a[76:79], v[244:247]
    buffer_store_dwordx4 v[188:191], v206, s[24:27], s38 offen sc1
    s_add_u32 s38, s38, 16384
    s_waitcnt lgkmcnt(0)
    v_mfma_f32_16x16x32_bf16 v[248:251], a[0:3], a[80:83], 0
    buffer_load_dwordx4 v19, s[16:19], s72 offen offset:3072  lds
    v_accvgpr_read_b32 v122, a162
    v_mfma_f32_16x16x32_bf16 v[252:255], a[4:7], a[80:83], 0
    v_accvgpr_read_b32 v123, a163
    v_mfma_f32_16x16x32_bf16 v[248:251], a[8:11], a[84:87], v[248:251]
    v_mfma_f32_16x16x32_bf16 v[252:255], a[12:15], a[84:87], v[252:255]
    v_cvt_pk_bf16_f32 v192, v240, v244
    v_cvt_pk_bf16_f32 v193, v241, v245
    v_mfma_f32_16x16x32_bf16 v[248:251], a[16:19], a[88:91], v[248:251]
    v_cvt_pk_bf16_f32 v194, v242, v246
    v_cvt_pk_bf16_f32 v195, v243, v247
    v_mfma_f32_16x16x32_bf16 v[252:255], a[20:23], a[88:91], v[252:255]
    v_xor_b32 v192, v207, v192
    v_xor_b32_e64 v193, v207, v193
    v_mfma_f32_16x16x32_bf16 v[248:251], a[24:27], a[92:95], v[248:251]
    v_xor_b32 v194, v207, v194
    v_xor_b32 v195, v207, v195
    v_mfma_f32_16x16x32_bf16 v[252:255], a[28:31], a[92:95], v[252:255]
    buffer_store_dwordx4 v[192:195], v206, s[24:27], s38 offen sc1
    s_add_u32 s38, s38, 16384
    v_accvgpr_read_b32 v124, a164
    v_accvgpr_read_b32 v125, a165
    v_accvgpr_read_b32 v126, a166
    v_accvgpr_read_b32 v127, a167
    s_nop 1
    v_cvt_pk_bf16_f32 v196, v248, v252
    v_cvt_pk_bf16_f32 v197, v249, v253
    v_cvt_pk_bf16_f32 v198, v250, v254
    v_cvt_pk_bf16_f32 v199, v251, v255
    v_xor_b32 v196, v207, v196
    v_xor_b32 v197, v207, v197
    v_xor_b32 v198, v207, v198
    v_xor_b32_e64 v199, v207, v199
    buffer_store_dwordx4 v[196:199], v206, s[24:27], s38 offen sc1
    s_waitcnt vmcnt(12)
    v_xor_b32 v4, v200, v98
    v_xor_b32 v5, v201, v102
    v_xor_b32 v6, v202, v106
    v_xor_b32_e64 v7, v203, v110
    v_or3_b32 v4, v4, v5, v6
    v_or_b32 v4, v4, v7
    v_cmp_ne_u32 vcc, 0, v4
    s_nop 0
    s_cbranch_vccnz K_POLL2
K_POLL2_OK:
    s_xor_b32 s40, s92, 128
    buffer_load_dword a223, v29, s[16:19], s40 offen
    v_fma_f32 v4, v108, v136, v104
    v_fma_f32 v5, v108, v137, v105
    v_fma_f32 v4, -v109, v137, v4
    v_fma_f32 v5, v109, v136, v5
    v_fma_f32 v6, v4, v136, v100
    v_fma_f32 v7, v4, v137, v101
    v_fma_f32 v6, -v5, v137, v6
    v_fma_f32 v7, v5, v136, v7
    v_fma_f32 v4, v6, v136, v96
    v_fma_f32 v5, v6, v137, v97
    v_fma_f32 v4, -v7, v137, v4
    v_fma_f32 v5, v7, v136, v5
    v_mul_f32 v6, v4, v140
    v_mul_f32 v8, v4, v141
    v_fma_f32 v6, -v5, v141, v6
    v_fma_f32 v8, v5, v140, v8
    v_and_b32_e64 v210, 7, v0
    v_lshl_add_u32 v210, v210, 7, s99
    v_permlane32_swap_b32 v6, v8
    v_add_f32 v6, v6, v8
    v_mov_b32 v8, v6
    v_add_u32 v208, s50, v30
    v_add_u32 v209, s7, v30
    v_permlane16_swap_b32 v6, v8
    v_add_f32 v6, v6, v8
    v_mov_b32 v8, v6
    v_mov_b32 v28, s35
    s_nop 0
    v_permlane32_swap_b32 v6, v8
    s_nop 0
    v_fma_f32 v10, v6, v138, v146
    v_fma_f32 v12, v6, v139, v147
    v_fma_f32 v10, -v8, v139, v10
    v_fma_f32 v12, v8, v138, v12
    v_fma_f32 v11, v10, v132, v142
    v_fma_f32 v13, v10, v133, v144
    v_fma_f32 v11, -v12, v133, v11
    v_fma_f32 v13, v12, v132, v13
    v_pk_fma_f32 v[32:33], v[10:11], v[128:129], v[32:33] op_sel_hi:[1,0,1]
    v_pk_fma_f32 v[36:37], v[12:13], v[128:129], v[36:37] op_sel_hi:[1,0,1]
    v_pk_fma_f32 v[32:33], v[12:13], v[128:129], v[32:33] op_sel:[0,1,0] neg_lo:[1,0,0] neg_hi:[1,0,0]
    v_pk_fma_f32 v[36:37], v[10:11], v[128:129], v[36:37] op_sel:[0,1,0]
    v_pk_fma_f32 v[34:35], v[32:33], v[128:129], v[34:35] op_sel_hi:[1,0,1]
    v_pk_fma_f32 v[38:39], v[36:37], v[128:129], v[38:39] op_sel_hi:[1,0,1]
    v_pk_fma_f32 v[34:35], v[36:37], v[128:129], v[34:35] op_sel:[0,1,0] neg_lo:[1,0,0] neg_hi:[1,0,0]
    v_pk_fma_f32 v[38:39], v[32:33], v[128:129], v[38:39] op_sel:[0,1,0]
    v_cvt_pk_bf16_f32 v224, v32, v34
    v_cvt_pk_bf16_f32 v232, v33, v35
    v_cvt_pk_bf16_f32 v240, -v36, -v38
    v_cvt_pk_bf16_f32 v248, -v37, -v39
    v_pk_fma_f32 v[40:41], v[34:35], v[128:129], v[40:41] op_sel_hi:[1,0,1]
    v_pk_fma_f32 v[44:45], v[38:39], v[128:129], v[44:45] op_sel_hi:[1,0,1]
    v_pk_fma_f32 v[40:41], v[38:39], v[128:129], v[40:41] op_sel:[0,1,0] neg_lo:[1,0,0] neg_hi:[1,0,0]
    v_pk_fma_f32 v[44:45], v[34:35], v[128:129], v[44:45] op_sel:[0,1,0]
    v_pk_fma_f32 v[42:43], v[40:41], v[128:129], v[42:43] op_sel_hi:[1,0,1]
    v_pk_fma_f32 v[46:47], v[44:45], v[128:129], v[46:47] op_sel_hi:[1,0,1]
    v_pk_fma_f32 v[42:43], v[44:45], v[128:129], v[42:43] op_sel:[0,1,0] neg_lo:[1,0,0] neg_hi:[1,0,0]
    v_pk_fma_f32 v[46:47], v[40:41], v[128:129], v[46:47] op_sel:[0,1,0]
    v_cvt_pk_bf16_f32 v225, v40, v42
    v_cvt_pk_bf16_f32 v233, v41, v43
    v_cvt_pk_bf16_f32 v241, -v44, -v46
    v_cvt_pk_bf16_f32 v249, -v45, -v47
    v_pk_fma_f32 v[48:49], v[42:43], v[128:129], v[48:49] op_sel_hi:[1,0,1]
    v_pk_fma_f32 v[52:53], v[46:47], v[128:129], v[52:53] op_sel_hi:[1,0,1]
    v_pk_fma_f32 v[48:49], v[46:47], v[128:129], v[48:49] op_sel:[0,1,0] neg_lo:[1,0,0] neg_hi:[1,0,0]
    v_pk_fma_f32 v[52:53], v[42:43], v[128:129], v[52:53] op_sel:[0,1,0]
    v_pk_fma_f32 v[50:51], v[48:49], v[128:129], v[50:51] op_sel_hi:[1,0,1]
    v_pk_fma_f32 v[54:55], v[52:53], v[128:129], v[54:55] op_sel_hi:[1,0,1]
    v_pk_fma_f32 v[50:51], v[52:53], v[128:129], v[50:51] op_sel:[0,1,0] neg_lo:[1,0,0] neg_hi:[1,0,0]
    v_pk_fma_f32 v[54:55], v[48:49], v[128:129], v[54:55] op_sel:[0,1,0]
    v_cvt_pk_bf16_f32 v226, v48, v50
    v_cvt_pk_bf16_f32 v234, v49, v51
    v_cvt_pk_bf16_f32 v242, -v52, -v54
    v_cvt_pk_bf16_f32 v250, -v53, -v55
    v_pk_fma_f32 v[56:57], v[50:51], v[128:129], v[56:57] op_sel_hi:[1,0,1]
    v_pk_fma_f32 v[60:61], v[54:55], v[128:129], v[60:61] op_sel_hi:[1,0,1]
    v_pk_fma_f32 v[56:57], v[54:55], v[128:129], v[56:57] op_sel:[0,1,0] neg_lo:[1,0,0] neg_hi:[1,0,0]
    v_pk_fma_f32 v[60:61], v[50:51], v[128:129], v[60:61] op_sel:[0,1,0]
    v_pk_fma_f32 v[58:59], v[56:57], v[128:129], v[58:59] op_sel_hi:[1,0,1]
    v_pk_fma_f32 v[62:63], v[60:61], v[128:129], v[62:63] op_sel_hi:[1,0,1]
    v_pk_fma_f32 v[58:59], v[60:61], v[128:129], v[58:59] op_sel:[0,1,0] neg_lo:[1,0,0] neg_hi:[1,0,0]
    v_pk_fma_f32 v[62:63], v[56:57], v[128:129], v[62:63] op_sel:[0,1,0]
    v_cvt_pk_bf16_f32 v227, v56, v58
    v_cvt_pk_bf16_f32 v235, v57, v59
    v_cvt_pk_bf16_f32 v243, -v60, -v62
    v_cvt_pk_bf16_f32 v251, -v61, -v63
    v_pk_fma_f32 v[64:65], v[58:59], v[128:129], v[64:65] op_sel_hi:[1,0,1]
    ds_write_b128 v216, v[224:227] offset:0
    v_pk_fma_f32 v[68:69], v[62:63], v[128:129], v[68:69] op_sel_hi:[1,0,1]
    v_pk_fma_f32 v[64:65], v[62:63], v[128:129], v[64:65] op_sel:[0,1,0] neg_lo:[1,0,0] neg_hi:[1,0,0]
    v_pk_fma_f32 v[68:69], v[58:59], v[128:129], v[68:69] op_sel:[0,1,0]
    v_pk_fma_f32 v[66:67], v[64:65], v[128:129], v[66:67] op_sel_hi:[1,0,1]
    v_pk_fma_f32 v[70:71], v[68:69], v[128:129], v[70:71] op_sel_hi:[1,0,1]
    v_pk_fma_f32 v[66:67], v[68:69], v[128:129], v[66:67] op_sel:[0,1,0] neg_lo:[1,0,0] neg_hi:[1,0,0]
    v_pk_fma_f32 v[70:71], v[64:65], v[128:129], v[70:71] op_sel:[0,1,0]
    v_cvt_pk_bf16_f32 v228, v64, v66
    v_cvt_pk_bf16_f32 v236, v65, v67
    v_cvt_pk_bf16_f32 v244, -v68, -v70
    ds_write_b128 v218, v[232:235] offset:0
    v_cvt_pk_bf16_f32 v252, -v69, -v71
    v_pk_fma_f32 v[72:73], v[66:67], v[128:129], v[72:73] op_sel_hi:[1,0,1]
    v_pk_fma_f32 v[76:77], v[70:71], v[128:129], v[76:77] op_sel_hi:[1,0,1]
    v_pk_fma_f32 v[72:73], v[70:71], v[128:129], v[72:73] op_sel:[0,1,0] neg_lo:[1,0,0] neg_hi:[1,0,0]
    v_pk_fma_f32 v[76:77], v[66:67], v[128:129], v[76:77] op_sel:[0,1,0]
    v_pk_fma_f32 v[74:75], v[72:73], v[128:129], v[74:75] op_sel_hi:[1,0,1]
    v_pk_fma_f32 v[78:79], v[76:77], v[128:129], v[78:79] op_sel_hi:[1,0,1]
    v_pk_fma_f32 v[74:75], v[76:77], v[128:129], v[74:75] op_sel:[0,1,0] neg_lo:[1,0,0] neg_hi:[1,0,0]
    v_pk_fma_f32 v[78:79], v[72:73], v[128:129], v[78:79] op_sel:[0,1,0]
    v_cvt_pk_bf16_f32 v229, v72, v74
    ds_write_b128 v216, v[240:243] offset:4096
    v_cvt_pk_bf16_f32 v237, v73, v75
    v_cvt_pk_bf16_f32 v245, -v76, -v78
    v_cvt_pk_bf16_f32 v253, -v77, -v79
    v_pk_fma_f32 v[80:81], v[74:75], v[128:129], v[80:81] op_sel_hi:[1,0,1]
    v_pk_fma_f32 v[84:85], v[78:79], v[128:129], v[84:85] op_sel_hi:[1,0,1]
    v_pk_fma_f32 v[80:81], v[78:79], v[128:129], v[80:81] op_sel:[0,1,0] neg_lo:[1,0,0] neg_hi:[1,0,0]
    v_pk_fma_f32 v[84:85], v[74:75], v[128:129], v[84:85] op_sel:[0,1,0]
    v_pk_fma_f32 v[82:83], v[80:81], v[128:129], v[82:83] op_sel_hi:[1,0,1]
    v_pk_fma_f32 v[86:87], v[84:85], v[128:129], v[86:87] op_sel_hi:[1,0,1]
    v_pk_fma_f32 v[82:83], v[84:85], v[128:129], v[82:83] op_sel:[0,1,0] neg_lo:[1,0,0] neg_hi:[1,0,0]
    ds_write_b128 v218, v[248:251] offset:4096
    v_pk_fma_f32 v[86:87], v[80:81], v[128:129], v[86:87] op_sel:[0,1,0]
    v_cvt_pk_bf16_f32 v230, v80, v82
    v_cvt_pk_bf16_f32 v238, v81, v83
    v_cvt_pk_bf16_f32 v246, -v84, -v86
    v_cvt_pk_bf16_f32 v254, -v85, -v87
    v_pk_fma_f32 v[88:89], v[82:83], v[128:129], v[88:89] op_sel_hi:[1,0,1]
    v_pk_fma_f32 v[92:93], v[86:87], v[128:129], v[92:93] op_sel_hi:[1,0,1]
    v_pk_fma_f32 v[88:89], v[86:87], v[128:129], v[88:89] op_sel:[0,1,0] neg_lo:[1,0,0] neg_hi:[1,0,0]
    v_pk_fma_f32 v[92:93], v[82:83], v[128:129], v[92:93] op_sel:[0,1,0]
    v_pk_fma_f32 v[90:91], v[88:89], v[128:129], v[90:91] op_sel_hi:[1,0,1]
    v_pk_fma_f32 v[94:95], v[92:93], v[128:129], v[94:95] op_sel_hi:[1,0,1]
    v_pk_fma_f32 v[90:91], v[92:93], v[128:129], v[90:91] op_sel:[0,1,0] neg_lo:[1,0,0] neg_hi:[1,0,0]
    v_pk_fma_f32 v[94:95], v[88:89], v[128:129], v[94:95] op_sel:[0,1,0]
    v_cvt_pk_bf16_f32 v231, v88, v90
    v_cvt_pk_bf16_f32 v239, v89, v91
    v_cvt_pk_bf16_f32 v247, -v92, -v94
    v_cvt_pk_bf16_f32 v255, -v93, -v95
    ds_write_b128 v217, v[228:231] offset:0
    ds_write_b128 v219, v[236:239] offset:0
    ds_write_b128 v217, v[244:247] offset:4096
    ds_write_b128 v219, v[252:255] offset:4096
    v_accvgpr_read_b32 v96, a136
    v_accvgpr_read_b32 v97, a137
    v_accvgpr_read_b32 v98, a138
    v_accvgpr_read_b32 v99, a139
    v_accvgpr_read_b32 v100, a140
    v_accvgpr_read_b32 v101, a141
    v_accvgpr_read_b32 v102, a142
    v_accvgpr_read_b32 v103, a143
    v_accvgpr_read_b32 v104, a144
    v_accvgpr_read_b32 v105, a145
    v_accvgpr_read_b32 v106, a146
    v_accvgpr_read_b32 v107, a147
    v_accvgpr_read_b32 v108, a148
    v_accvgpr_read_b32 v109, a149
    v_accvgpr_read_b32 v110, a150
    v_accvgpr_read_b32 v111, a151
    v_accvgpr_read_b32 v128, a168
    v_accvgpr_read_b32 v129, a169
    s_waitcnt lgkmcnt(0) vmcnt(3)
    s_barrier
    ds_read_b64_tr_b16 v[64:65], v220 offset:0
    ds_read_b64_tr_b16 v[66:67], v221 offset:1024
    ds_read_b64_tr_b16 v[68:69], v220 offset:8192
    ds_read_b64_tr_b16 v[70:71], v221 offset:9216
    ds_read_b64_tr_b16 v[72:73], v220 offset:16384
    ds_read_b64_tr_b16 v[74:75], v221 offset:17408
    ds_read_b64_tr_b16 v[76:77], v220 offset:24576
    ds_read_b64_tr_b16 v[78:79], v221 offset:25600
    ds_read_b64_tr_b16 v[80:81], v222 offset:0
    ds_read_b64_tr_b16 v[82:83], v223 offset:1024
    ds_read_b64_tr_b16 v[84:85], v222 offset:8192
    ds_read_b64_tr_b16 v[86:87], v223 offset:9216
    ds_read_b64_tr_b16 v[88:89], v222 offset:16384
    ds_read_b64_tr_b16 v[90:91], v223 offset:17408
    ds_read_b64_tr_b16 v[92:93], v222 offset:24576
    ds_read_b64_tr_b16 v[94:95], v223 offset:25600
    ds_read_b128 v[152:155], v20 offset:0
    ds_read_b128 v[156:159], v20 offset:2048
    ds_read_b128 v[160:163], v20 offset:4096
    ds_read_b128 v[164:167], v20 offset:6144
    s_waitcnt lgkmcnt(0)
    s_cmp_lg_u32 s50, 0
    s_cbranch_scc1 K_HFAR
    buffer_store_dwordx4 v[64:67], v24, s[28:31], s68 offen
    buffer_store_dwordx4 v[80:83], v24, s[28:31], s69 offen
    v_mfma_f32_16x16x32_bf16 v[32:35], v[64:67], v[152:155], 0
    ds_read_b128 v[168:171], v21 offset:0
    buffer_store_dwordx4 v[68:71], v25, s[28:31], s68 offen
    v_mfma_f32_16x16x32_bf16 v[48:51], v[80:83], v[152:155], 0
    ds_read_b128 v[172:175], v21 offset:2048
    v_mfma_f32_16x16x32_bf16 v[36:39], v[64:67], v[156:159], 0
    ds_read_b128 v[176:179], v21 offset:4096
    buffer_store_dwordx4 v[84:87], v25, s[28:31], s69 offen
    v_mfma_f32_16x16x32_bf16 v[52:55], v[80:83], v[156:159], 0
    ds_read_b128 v[180:183], v21 offset:6144
    v_mfma_f32_16x16x32_bf16 v[40:43], v[64:67], v[160:163], 0
    v_mfma_f32_16x16x32_bf16 v[56:59], v[80:83], v[160:163], 0
    buffer_store_dwordx4 v[72:75], v26, s[28:31], s68 offen
    v_mfma_f32_16x16x32_bf16 v[44:47], v[64:67], v[164:167], 0
    v_mfma_f32_16x16x32_bf16 v[60:63], v[80:83], v[164:167], 0
    s_waitcnt lgkmcnt(0)
    v_mfma_f32_16x16x32_bf16 v[32:35], v[68:71], v[168:171], v[32:35]
    ds_read_b128 v[152:155], v22 offset:0
    buffer_store_dwordx4 v[88:91], v26, s[28:31], s69 offen
    v_mfma_f32_16x16x32_bf16 v[48:51], v[84:87], v[168:171], v[48:51]
    ds_read_b128 v[156:159], v22 offset:2048
    v_mfma_f32_16x16x32_bf16 v[36:39], v[68:71], v[172:175], v[36:39]
    ds_read_b128 v[160:163], v22 offset:4096
    buffer_store_dwordx4 v[76:79], v27, s[28:31], s68 offen
    v_mfma_f32_16x16x32_bf16 v[52:55], v[84:87], v[172:175], v[52:55]
    ds_read_b128 v[164:167], v22 offset:6144
    v_mfma_f32_16x16x32_bf16 v[40:43], v[68:71], v[176:179], v[40:43]
    v_mfma_f32_16x16x32_bf16 v[56:59], v[84:87], v[176:179], v[56:59]
    buffer_store_dwordx4 v[92:95], v27, s[28:31], s69 offen
    v_mfma_f32_16x16x32_bf16 v[44:47], v[68:71], v[180:183], v[44:47]
    v_mfma_f32_16x16x32_bf16 v[60:63], v[84:87], v[180:183], v[60:63]
K_HFAR_RET:
    s_bfe_u32 s72, s97, 262164
    s_add_u32 m0, s37, 81920
    s_lshl_b32 s72, s72, 7
    buffer_load_dwordx4 v16, s[16:19], s72 offen offset:0  lds
    buffer_load_dwordx4 v17, s[16:19], s72 offen offset:1024  lds
    buffer_load_dwordx4 v18, s[16:19], s72 offen offset:2048  lds
    buffer_load_dwordx4 v19, s[16:19], s72 offen offset:3072  lds
    s_bfe_u32 s72, s97, 262168
    s_add_u32 m0, s37, 98304
    s_lshl_b32 s72, s72, 7
    buffer_load_dwordx4 v16, s[16:19], s72 offen offset:0  lds
    buffer_load_dwordx4 v17, s[16:19], s72 offen offset:1024  lds
    buffer_load_dwordx4 v18, s[16:19], s72 offen offset:2048  lds
    buffer_load_dwordx4 v19, s[16:19], s72 offen offset:3072  lds
    s_waitcnt vmcnt(8)
    s_barrier
    buffer_store_dword v28, v208, s[24:27], s70 offen offset:64
    buffer_store_dword v28, v209, s[24:27], s70 offen offset:64 sc1
    s_waitcnt lgkmcnt(0)
    v_mfma_f32_16x16x32_bf16 v[32:35], v[72:75], v[152:155], v[32:35]
    ds_read_b128 v[168:171], v23 offset:0
    s_bfe_u32 s72, s97, 262172
    s_add_u32 m0, s37, 114688
    v_mfma_f32_16x16x32_bf16 v[48:51], v[88:91], v[152:155], v[48:51]
    ds_read_b128 v[172:175], v23 offset:2048
    s_lshl_b32 s72, s72, 7
    buffer_load_dwordx4 v16, s[16:19], s72 offen offset:0  lds
    v_mfma_f32_16x16x32_bf16 v[36:39], v[72:75], v[156:159], v[36:39]
    ds_read_b128 v[176:179], v23 offset:4096
    buffer_load_dwordx4 v17, s[16:19], s72 offen offset:1024  lds
    v_mfma_f32_16x16x32_bf16 v[52:55], v[88:91], v[156:159], v[52:55]
    ds_read_b128 v[180:183], v23 offset:6144
    buffer_load_dwordx4 v18, s[16:19], s72 offen offset:2048  lds
    buffer_load_dwordx4 v19, s[16:19], s72 offen offset:3072  lds
    v_mfma_f32_16x16x32_bf16 v[40:43], v[72:75], v[160:163], v[40:43]
    buffer_load_dword v4, v210, s[24:27], s51 offen offset:64 sc1
    s_lshl_b32 s3, s2, 3
    v_mfma_f32_16x16x32_bf16 v[56:59], v[88:91], v[160:163], v[56:59]
    s_add_u32 s3, s3, 22396928
    v_mfma_f32_16x16x32_bf16 v[44:47], v[72:75], v[164:167], v[44:47]
    v_mov_b32 v28, s35
    v_and_b32 v255, 1073741831, v30
    v_mfma_f32_16x16x32_bf16 v[60:63], v[88:91], v[164:167], v[60:63]
    buffer_store_dword v28, v255, s[24:27], s3 offen sc1
    s_waitcnt lgkmcnt(0) vmcnt(1)
    v_cmp_ne_u32 vcc, s98, v4
    s_nop 0
    s_cbranch_vccnz K_POLL3
K_POLL3_OK:
    s_barrier
    v_mfma_f32_16x16x32_bf16 v[32:35], v[76:79], v[168:171], v[32:35]
    ds_read_b128 v[152:155], v20 offset:16384
    s_bfe_u32 s73, s97, 262148
    s_lshl_b32 s73, s73, 8
    s_add_u32 s73, s73, s95
    v_mfma_f32_16x16x32_bf16 v[48:51], v[92:95], v[168:171], v[48:51]
    ds_read_b128 v[156:159], v20 offset:18432
    s_add_u32 s74, s73, 0x20000
    buffer_load_dwordx4 a[0:3], v24, s[28:31], s73 offen sc1
    buffer_load_dwordx4 a[16:19], v24, s[28:31], s74 offen sc1
    v_mfma_f32_16x16x32_bf16 v[36:39], v[76:79], v[172:175], v[36:39]
    ds_read_b128 v[160:163], v20 offset:20480
    buffer_load_dwordx4 a[4:7], v25, s[28:31], s73 offen sc1
    buffer_load_dwordx4 a[20:23], v25, s[28:31], s74 offen sc1
    buffer_load_dwordx4 a[8:11], v26, s[28:31], s73 offen sc1
    v_mfma_f32_16x16x32_bf16 v[52:55], v[92:95], v[172:175], v[52:55]
    ds_read_b128 v[164:167], v20 offset:22528
    buffer_load_dwordx4 a[24:27], v26, s[28:31], s74 offen sc1
    buffer_load_dwordx4 a[12:15], v27, s[28:31], s73 offen sc1
    v_mfma_f32_16x16x32_bf16 v[40:43], v[76:79], v[176:179], v[40:43]
    buffer_load_dwordx4 a[28:31], v27, s[28:31], s74 offen sc1
    s_bfe_u32 s73, s97, 262152
    s_lshl_b32 s73, s73, 8
    v_mfma_f32_16x16x32_bf16 v[56:59], v[92:95], v[176:179], v[56:59]
    s_add_u32 s73, s73, s95
    s_add_u32 s74, s73, 0x20000
    buffer_load_dwordx4 a[32:35], v24, s[28:31], s73 offen sc1
    v_mfma_f32_16x16x32_bf16 v[44:47], v[76:79], v[180:183], v[44:47]
    buffer_load_dwordx4 a[48:51], v24, s[28:31], s74 offen sc1
    buffer_load_dwordx4 a[36:39], v25, s[28:31], s73 offen sc1
    buffer_load_dwordx4 a[52:55], v25, s[28:31], s74 offen sc1
    v_mfma_f32_16x16x32_bf16 v[60:63], v[92:95], v[180:183], v[60:63]
    buffer_load_dwordx4 a[40:43], v26, s[28:31], s73 offen sc1
    buffer_load_dwordx4 a[56:59], v26, s[28:31], s74 offen sc1
    s_waitcnt lgkmcnt(0) vmcnt(12)
    v_mfma_f32_16x16x32_bf16 v[32:35], a[0:3], v[152:155], v[32:35]
    ds_read_b128 v[168:171], v21 offset:16384
    buffer_load_dwordx4 a[44:47], v27, s[28:31], s73 offen sc1
    v_mfma_f32_16x16x32_bf16 v[48:51], a[16:19], v[152:155], v[48:51]
    ds_read_b128 v[172:175], v21 offset:18432
    buffer_load_dwordx4 a[60:63], v27, s[28:31], s74 offen sc1
    v_mfma_f32_16x16x32_bf16 v[36:39], a[0:3], v[156:159], v[36:39]
    ds_read_b128 v[176:179], v21 offset:20480
    s_bfe_u32 s73, s97, 262156
    v_mfma_f32_16x16x32_bf16 v[52:55], a[16:19], v[156:159], v[52:55]
    ds_read_b128 v[180:183], v21 offset:22528
    s_lshl_b32 s73, s73, 8
    v_mfma_f32_16x16x32_bf16 v[40:43], a[0:3], v[160:163], v[40:43]
    s_add_u32 s73, s73, s95
    v_mfma_f32_16x16x32_bf16 v[56:59], a[16:19], v[160:163], v[56:59]
    s_add_u32 s74, s73, 0x20000
    v_mfma_f32_16x16x32_bf16 v[44:47], a[0:3], v[164:167], v[44:47]
    buffer_load_dwordx4 a[64:67], v24, s[28:31], s73 offen sc1
    v_mfma_f32_16x16x32_bf16 v[60:63], a[16:19], v[164:167], v[60:63]
    s_waitcnt lgkmcnt(0) vmcnt(13)
    v_mfma_f32_16x16x32_bf16 v[32:35], a[4:7], v[168:171], v[32:35]
    ds_read_b128 v[152:155], v22 offset:16384
    buffer_load_dwordx4 a[80:83], v24, s[28:31], s74 offen sc1
    v_mfma_f32_16x16x32_bf16 v[48:51], a[20:23], v[168:171], v[48:51]
    ds_read_b128 v[156:159], v22 offset:18432
    v_mfma_f32_16x16x32_bf16 v[36:39], a[4:7], v[172:175], v[36:39]
    ds_read_b128 v[160:163], v22 offset:20480
    buffer_load_dwordx4 a[68:71], v25, s[28:31], s73 offen sc1
    v_mfma_f32_16x16x32_bf16 v[52:55], a[20:23], v[172:175], v[52:55]
    ds_read_b128 v[164:167], v22 offset:22528
    v_mfma_f32_16x16x32_bf16 v[40:43], a[4:7], v[176:179], v[40:43]
    v_mfma_f32_16x16x32_bf16 v[56:59], a[20:23], v[176:179], v[56:59]
    buffer_load_dwordx4 a[84:87], v25, s[28:31], s74 offen sc1
    v_mfma_f32_16x16x32_bf16 v[44:47], a[4:7], v[180:183], v[44:47]
    v_mfma_f32_16x16x32_bf16 v[60:63], a[20:23], v[180:183], v[60:63]
    s_waitcnt lgkmcnt(0) vmcnt(14)
    v_mfma_f32_16x16x32_bf16 v[32:35], a[8:11], v[152:155], v[32:35]
    ds_read_b128 v[168:171], v23 offset:16384
    buffer_load_dwordx4 a[72:75], v26, s[28:31], s73 offen sc1
    v_mfma_f32_16x16x32_bf16 v[48:51], a[24:27], v[152:155], v[48:51]
    ds_read_b128 v[172:175], v23 offset:18432
    v_mfma_f32_16x16x32_bf16 v[36:39], a[8:11], v[156:159], v[36:39]
    ds_read_b128 v[176:179], v23 offset:20480
    v_mfma_f32_16x16x32_bf16 v[52:55], a[24:27], v[156:159], v[52:55]
    ds_read_b128 v[180:183], v23 offset:22528
    v_mfma_f32_16x16x32_bf16 v[40:43], a[8:11], v[160:163], v[40:43]
    buffer_load_dwordx4 a[88:91], v26, s[28:31], s74 offen sc1
    v_mfma_f32_16x16x32_bf16 v[56:59], a[24:27], v[160:163], v[56:59]
    v_mfma_f32_16x16x32_bf16 v[44:47], a[8:11], v[164:167], v[44:47]
    v_mfma_f32_16x16x32_bf16 v[60:63], a[24:27], v[164:167], v[60:63]
    s_waitcnt lgkmcnt(0) vmcnt(14)
    v_mfma_f32_16x16x32_bf16 v[32:35], a[12:15], v[168:171], v[32:35]
    ds_read_b128 v[152:155], v20 offset:32768
    buffer_load_dwordx4 a[76:79], v27, s[28:31], s73 offen sc1
    v_sub_u32 v14, v0, v2
    v_mfma_f32_16x16x32_bf16 v[48:51], a[28:31], v[168:171], v[48:51]
    ds_read_b128 v[156:159], v20 offset:34816
    v_and_b32_e64 v14, 3, v14
    v_mfma_f32_16x16x32_bf16 v[36:39], a[12:15], v[172:175], v[36:39]
    ds_read_b128 v[160:163], v20 offset:36864
    v_and_or_b32 v14, v0, 60, v14
    v_mfma_f32_16x16x32_bf16 v[52:55], a[28:31], v[172:175], v[52:55]
    ds_read_b128 v[164:167], v20 offset:38912
    v_lshlrev_b32_e64 v133, 4, v14
    v_mfma_f32_16x16x32_bf16 v[40:43], a[12:15], v[176:179], v[40:43]
    buffer_load_dwordx4 a[92:95], v27, s[28:31], s74 offen sc1
    s_and_b32 s38, s34, 2
    v_mfma_f32_16x16x32_bf16 v[56:59], a[28:31], v[176:179], v[56:59]
    s_lshl3_add_u32 s39, s6, 131072
    v_mfma_f32_16x16x32_bf16 v[44:47], a[12:15], v[180:183], v[44:47]
    v_lshl_add_u32 v14, v2, 6, v1
    v_mfma_f32_16x16x32_bf16 v[60:63], a[28:31], v[180:183], v[60:63]
    s_waitcnt lgkmcnt(0) vmcnt(14)
    v_mfma_f32_16x16x32_bf16 v[32:35], a[32:35], v[152:155], v[32:35]
    ds_read_b128 v[168:171], v21 offset:32768
    s_bfe_u32 s73, s97, 262160
    v_lshrrev_b32_e64 v15, 2, v1
    v_mfma_f32_16x16x32_bf16 v[48:51], a[48:51], v[152:155], v[48:51]
    ds_read_b128 v[172:175], v21 offset:34816
    s_lshl_b32 s73, s73, 8
    v_add_u32 v15, s38, v15
    v_mfma_f32_16x16x32_bf16 v[36:39], a[32:35], v[156:159], v[36:39]
    ds_read_b128 v[176:179], v21 offset:36864
    s_add_u32 s73, s73, s95
    v_and_b32 v15, 3, v15
    v_mfma_f32_16x16x32_bf16 v[52:55], a[48:51], v[156:159], v[52:55]
    ds_read_b128 v[180:183], v21 offset:38912
    v_lshl_add_u32 v15, v14, 2, v15
    v_mfma_f32_16x16x32_bf16 v[40:43], a[32:35], v[160:163], v[40:43]
    s_add_u32 s74, s73, 0x20000
    v_lshl_add_u32 v130, v15, 4, s39
    v_mfma_f32_16x16x32_bf16 v[56:59], a[48:51], v[160:163], v[56:59]
    buffer_load_dwordx4 a[96:99], v24, s[28:31], s73 offen sc1
    v_sub_u32 v14, 256, v14
    v_mfma_f32_16x16x32_bf16 v[44:47], a[32:35], v[164:167], v[44:47]
    buffer_load_dwordx4 a[112:115], v24, s[28:31], s74 offen sc1
    v_lshrrev_b32_e64 v15, 2, v14
    v_mfma_f32_16x16x32_bf16 v[60:63], a[48:51], v[164:167], v[60:63]
    s_waitcnt lgkmcnt(0) vmcnt(14)
    v_mfma_f32_16x16x32_bf16 v[32:35], a[36:39], v[168:171], v[32:35]
    ds_read_b128 v[152:155], v22 offset:32768
    buffer_load_dwordx4 a[100:103], v25, s[28:31], s73 offen sc1
    v_add3_u32 v15, v15, s38, 1
    v_mfma_f32_16x16x32_bf16 v[48:51], a[52:55], v[168:171], v[48:51]
    ds_read_b128 v[156:159], v22 offset:34816
    buffer_load_dwordx4 a[116:119], v25, s[28:31], s74 offen sc1
    v_and_b32 v15, 3, v15
    v_mfma_f32_16x16x32_bf16 v[36:39], a[36:39], v[172:175], v[36:39]
    ds_read_b128 v[160:163], v22 offset:36864
    s_getpc_b64 s[20:21]
K_PC3:
    s_mov_b32 s22, K_CODE_END-K_PC3
    v_lshl_add_u32 v15, v14, 2, v15
    v_mfma_f32_16x16x32_bf16 v[52:55], a[52:55], v[172:175], v[52:55]
    ds_read_b128 v[164:167], v22 offset:38912
    s_bfe_u32 s3, s2, 0x20003
    v_lshl_add_u32 v131, v15, 4, s39
    v_mfma_f32_16x16x32_bf16 v[40:43], a[36:39], v[176:179], v[40:43]
    s_lshl2_add_u32 s3, s3, s34
    v_and_b32 v15, 1023, v15
    v_mfma_f32_16x16x32_bf16 v[56:59], a[52:55], v[176:179], v[56:59]
    s_lshl_b32 s3, s3, 11
    v_lshl_add_u32 v132, v15, 4, s39
    v_mfma_f32_16x16x32_bf16 v[44:47], a[36:39], v[180:183], v[44:47]
    v_lshl_add_u32 v28, v0, 5, s3
    v_subrev_u32 v131, 3072, v131
    v_mfma_f32_16x16x32_bf16 v[60:63], a[52:55], v[180:183], v[60:63]
    buffer_load_dword v11, v28, s[20:23], 0 offen
    s_waitcnt lgkmcnt(0) vmcnt(15)
    v_mfma_f32_16x16x32_bf16 v[32:35], a[40:43], v[152:155], v[32:35]
    ds_read_b128 v[168:171], v23 offset:32768
    buffer_load_dwordx4 a[104:107], v26, s[28:31], s73 offen sc1
    v_lshlrev_b32_e64 v216, 16, v112
    v_mfma_f32_16x16x32_bf16 v[48:51], a[56:59], v[152:155], v[48:51]
    ds_read_b128 v[172:175], v23 offset:34816
    v_and_b32 v220, 0xffff0000, v112
    v_mfma_f32_16x16x32_bf16 v[36:39], a[40:43], v[156:159], v[36:39]
    ds_read_b128 v[176:179], v23 offset:36864
    v_lshlrev_b32_e64 v217, 16, v113
    v_mfma_f32_16x16x32_bf16 v[52:55], a[56:59], v[156:159], v[52:55]
    ds_read_b128 v[180:183], v23 offset:38912
    v_and_b32 v221, 0xffff0000, v113
    v_mfma_f32_16x16x32_bf16 v[40:43], a[40:43], v[160:163], v[40:43]
    buffer_load_dwordx4 a[120:123], v26, s[28:31], s74 offen sc1
    v_lshlrev_b32_e64 v218, 16, v114
    v_mfma_f32_16x16x32_bf16 v[56:59], a[56:59], v[160:163], v[56:59]
    v_and_b32 v222, 0xffff0000, v114
    v_mfma_f32_16x16x32_bf16 v[44:47], a[40:43], v[164:167], v[44:47]
    v_lshlrev_b32_e64 v219, 16, v115
    v_mfma_f32_16x16x32_bf16 v[60:63], a[56:59], v[164:167], v[60:63]
    s_waitcnt lgkmcnt(0) vmcnt(15)
    v_mfma_f32_16x16x32_bf16 v[32:35], a[44:47], v[168:171], v[32:35]
    ds_read_b128 v[152:155], v20 offset:49152
    v_lshlrev_b32 v13, 3, v0
    v_and_b32 v223, 0xffff0000, v115
    v_mfma_f32_16x16x32_bf16 v[48:51], a[60:63], v[168:171], v[48:51]
    ds_read_b128 v[156:159], v20 offset:51200
    s_lshl_b32 s70, s34, 9
    v_lshlrev_b32 v224, 16, v116
    v_mfma_f32_16x16x32_bf16 v[36:39], a[44:47], v[172:175], v[36:39]
    ds_read_b128 v[160:163], v20 offset:53248
    s_add_u32 s70, s70, 22396928
    v_and_b32 v228, 0xffff0000, v116
    v_mfma_f32_16x16x32_bf16 v[52:55], a[60:63], v[172:175], v[52:55]
    ds_read_b128 v[164:167], v20 offset:55296
    v_lshlrev_b32_e64 v225, 16, v117
    v_mfma_f32_16x16x32_bf16 v[40:43], a[44:47], v[176:179], v[40:43]
    buffer_load_dword v8, v13, s[24:27], s70 offen sc1
    v_and_b32 v229, 0xffff0000, v117
    v_mfma_f32_16x16x32_bf16 v[56:59], a[60:63], v[176:179], v[56:59]
    buffer_load_dwordx4 a[108:111], v27, s[28:31], s73 offen sc1
    v_lshlrev_b32_e64 v226, 16, v118
    v_mfma_f32_16x16x32_bf16 v[44:47], a[44:47], v[180:183], v[44:47]
    buffer_load_dwordx4 a[124:127], v27, s[28:31], s74 offen sc1
    v_and_b32 v230, 0xffff0000, v118
    v_xor_b32 v20, 0x10000, v20
    v_mfma_f32_16x16x32_bf16 v[60:63], a[60:63], v[180:183], v[60:63]
    s_waitcnt lgkmcnt(0) vmcnt(16)
    v_mfma_f32_16x16x32_bf16 v[32:35], a[64:67], v[152:155], v[32:35]
    ds_read_b128 v[168:171], v21 offset:49152
    s_bfe_u32 s73, s97, 262164
    v_lshlrev_b32 v227, 16, v119
    v_mfma_f32_16x16x32_bf16 v[48:51], a[80:83], v[152:155], v[48:51]
    ds_read_b128 v[172:175], v21 offset:51200
    s_lshl_b32 s73, s73, 8
    v_and_b32 v231, 0xffff0000, v119
    v_mfma_f32_16x16x32_bf16 v[36:39], a[64:67], v[156:159], v[36:39]
    ds_read_b128 v[176:179], v21 offset:53248
    s_add_u32 s73, s73, s95
    v_lshlrev_b32_e64 v232, 16, v120
    v_mfma_f32_16x16x32_bf16 v[52:55], a[80:83], v[156:159], v[52:55]
    ds_read_b128 v[180:183], v21 offset:55296
    v_and_b32 v236, 0xffff0000, v120
    v_mfma_f32_16x16x32_bf16 v[40:43], a[64:67], v[160:163], v[40:43]
    s_add_u32 s74, s73, 0x20000
    v_lshlrev_b32_e64 v233, 16, v121
    v_mfma_f32_16x16x32_bf16 v[56:59], a[80:83], v[160:163], v[56:59]
    buffer_load_dwordx4 a[128:131], v24, s[28:31], s73 offen sc1
    v_and_b32 v237, 0xffff0000, v121
    v_mfma_f32_16x16x32_bf16 v[44:47], a[64:67], v[164:167], v[44:47]
    buffer_load_dwordx4 a[144:147], v24, s[28:31], s74 offen sc1
    v_lshlrev_b32_e64 v234, 16, v122
    v_xor_b32 v21, 0x10000, v21
    v_mfma_f32_16x16x32_bf16 v[60:63], a[80:83], v[164:167], v[60:63]
    s_waitcnt lgkmcnt(0) vmcnt(16)
    v_mfma_f32_16x16x32_bf16 v[32:35], a[68:71], v[168:171], v[32:35]
    ds_read_b128 v[152:155], v22 offset:49152
    buffer_load_dwordx4 a[132:135], v25, s[28:31], s73 offen sc1
    v_and_b32 v238, 0xffff0000, v122
    v_mfma_f32_16x16x32_bf16 v[48:51], a[84:87], v[168:171], v[48:51]
    ds_read_b128 v[156:159], v22 offset:51200
    v_lshlrev_b32 v235, 16, v123
    v_mfma_f32_16x16x32_bf16 v[36:39], a[68:71], v[172:175], v[36:39]
    ds_read_b128 v[160:163], v22 offset:53248
    v_and_b32 v239, 0xffff0000, v123
    v_mfma_f32_16x16x32_bf16 v[52:55], a[84:87], v[172:175], v[52:55]
    ds_read_b128 v[164:167], v22 offset:55296
    v_lshlrev_b32_e64 v240, 16, v124
    v_mfma_f32_16x16x32_bf16 v[40:43], a[68:71], v[176:179], v[40:43]
    buffer_load_dwordx4 a[148:151], v25, s[28:31], s74 offen sc1
    v_and_b32 v244, 0xffff0000, v124
    v_mfma_f32_16x16x32_bf16 v[56:59], a[84:87], v[176:179], v[56:59]
    v_lshlrev_b32_e64 v241, 16, v125
    v_mfma_f32_16x16x32_bf16 v[44:47], a[68:71], v[180:183], v[44:47]
    v_and_b32 v245, 0xffff0000, v125
    v_xor_b32 v22, 0x10000, v22
    v_mfma_f32_16x16x32_bf16 v[60:63], a[84:87], v[180:183], v[60:63]
    s_waitcnt lgkmcnt(0) vmcnt(16)
    v_mfma_f32_16x16x32_bf16 v[32:35], a[72:75], v[152:155], v[32:35]
    ds_read_b128 v[168:171], v23 offset:49152
    buffer_load_dwordx4 a[136:139], v26, s[28:31], s73 offen sc1
    v_lshlrev_b32 v242, 16, v126
    v_mfma_f32_16x16x32_bf16 v[48:51], a[88:91], v[152:155], v[48:51]
    ds_read_b128 v[172:175], v23 offset:51200
    v_and_b32 v246, 0xffff0000, v126
    v_mfma_f32_16x16x32_bf16 v[36:39], a[72:75], v[156:159], v[36:39]
    ds_read_b128 v[176:179], v23 offset:53248
    v_lshlrev_b32_e64 v243, 16, v127
    v_mfma_f32_16x16x32_bf16 v[52:55], a[88:91], v[156:159], v[52:55]
    ds_read_b128 v[180:183], v23 offset:55296
    v_and_b32 v247, 0xffff0000, v127
    v_mfma_f32_16x16x32_bf16 v[40:43], a[72:75], v[160:163], v[40:43]
    buffer_load_dwordx4 a[152:155], v26, s[28:31], s74 offen sc1
    v_xor_b32 v16, 0x100000, v16
    v_mfma_f32_16x16x32_bf16 v[56:59], a[88:91], v[160:163], v[56:59]
    v_xor_b32 v17, 0x100000, v17
    v_mfma_f32_16x16x32_bf16 v[44:47], a[72:75], v[164:167], v[44:47]
    v_xor_b32 v18, 0x100000, v18
    v_xor_b32 v23, 0x10000, v23
    v_mfma_f32_16x16x32_bf16 v[60:63], a[88:91], v[164:167], v[60:63]
    s_waitcnt lgkmcnt(0) vmcnt(16)
    v_mfma_f32_16x16x32_bf16 v[32:35], a[76:79], v[168:171], v[32:35]
    ds_read_b128 v[152:155], v20 offset:0
    buffer_load_dwordx4 a[140:143], v27, s[28:31], s73 offen sc1
    v_xor_b32 v19, 0x100000, v19
    v_mfma_f32_16x16x32_bf16 v[48:51], a[92:95], v[168:171], v[48:51]
    ds_read_b128 v[156:159], v20 offset:2048
    v_lshlrev_b32 v4, 16, v2
    v_mfma_f32_16x16x32_bf16 v[36:39], a[76:79], v[172:175], v[36:39]
    ds_read_b128 v[160:163], v20 offset:4096
    v_lshl_add_u32 v4, v1, 4, v4
    v_mfma_f32_16x16x32_bf16 v[52:55], a[92:95], v[172:175], v[52:55]
    ds_read_b128 v[164:167], v20 offset:6144
    s_lshl_b32 s38, s2, 14
    v_mfma_f32_16x16x32_bf16 v[40:43], a[76:79], v[176:179], v[40:43]
    buffer_load_dwordx4 a[156:159], v27, s[28:31], s74 offen sc1
    s_add_u32 s38, s38, s37
    v_mfma_f32_16x16x32_bf16 v[56:59], a[92:95], v[176:179], v[56:59]
    s_add_u32 s52, s38, 17825792
    v_mfma_f32_16x16x32_bf16 v[44:47], a[76:79], v[180:183], v[44:47]
    s_xor_b32 s38, s38, 65536
    v_mfma_f32_16x16x32_bf16 v[60:63], a[92:95], v[180:183], v[60:63]
    s_waitcnt lgkmcnt(0) vmcnt(16)
    v_mfma_f32_16x16x32_bf16 v[32:35], a[96:99], v[152:155], v[32:35]
    ds_read_b128 v[168:171], v21 offset:0
    s_bfe_u32 s73, s97, 262168
    s_add_u32 s54, s38, 17825792
    v_mfma_f32_16x16x32_bf16 v[48:51], a[112:115], v[152:155], v[48:51]
    ds_read_b128 v[172:175], v21 offset:2048
    s_lshl_b32 s73, s73, 8
    s_lshl_b32 s38, s4, 14
    v_mfma_f32_16x16x32_bf16 v[36:39], a[96:99], v[156:159], v[36:39]
    ds_read_b128 v[176:179], v21 offset:4096
    s_add_u32 s73, s73, s95
    s_add_u32 s38, s38, s37
    v_mfma_f32_16x16x32_bf16 v[52:55], a[112:115], v[156:159], v[52:55]
    ds_read_b128 v[180:183], v21 offset:6144
    s_add_u32 s53, s38, 13631488
    v_mfma_f32_16x16x32_bf16 v[40:43], a[96:99], v[160:163], v[40:43]
    s_add_u32 s74, s73, 0x20000
    s_lshl2_add_u32 s38, s32, s34
    v_mfma_f32_16x16x32_bf16 v[56:59], a[112:115], v[160:163], v[56:59]
    buffer_load_dwordx4 a[160:163], v24, s[28:31], s73 offen sc1
    s_lshl_b32 s38, s38, 10
    v_mfma_f32_16x16x32_bf16 v[44:47], a[96:99], v[164:167], v[44:47]
    buffer_load_dwordx4 a[176:179], v24, s[28:31], s74 offen sc1
    s_add_u32 s55, s38, 22282240
    v_mfma_f32_16x16x32_bf16 v[60:63], a[112:115], v[164:167], v[60:63]
    s_waitcnt lgkmcnt(0) vmcnt(16)
    v_mfma_f32_16x16x32_bf16 v[32:35], a[100:103], v[168:171], v[32:35]
    ds_read_b128 v[152:155], v22 offset:0
    buffer_load_dwordx4 a[164:167], v25, s[28:31], s73 offen sc1
    v_lshlrev_b32_e64 v7, 8, v2
    v_mfma_f32_16x16x32_bf16 v[48:51], a[116:119], v[168:171], v[48:51]
    ds_read_b128 v[156:159], v22 offset:2048
    s_lshl_b32 s38, s94, 16
    v_mfma_f32_16x16x32_bf16 v[36:39], a[100:103], v[172:175], v[36:39]
    ds_read_b128 v[160:163], v22 offset:4096
    s_add_u32 s56, s38, s5
    v_mfma_f32_16x16x32_bf16 v[52:55], a[116:119], v[172:175], v[52:55]
    ds_read_b128 v[164:167], v22 offset:6144
    v_lshlrev_b32_e64 v12, 14, v2
    v_mfma_f32_16x16x32_bf16 v[40:43], a[100:103], v[176:179], v[40:43]
    buffer_load_dwordx4 a[180:183], v25, s[28:31], s74 offen sc1
    v_lshl_add_u32 v12, v1, 4, v12
    v_mfma_f32_16x16x32_bf16 v[56:59], a[116:119], v[176:179], v[56:59]
    s_lshl_b32 s38, s4, 6
    v_mfma_f32_16x16x32_bf16 v[44:47], a[100:103], v[180:183], v[44:47]
    s_add_u32 s58, s38, 22429696
    v_mfma_f32_16x16x32_bf16 v[60:63], a[116:119], v[180:183], v[60:63]
    s_waitcnt lgkmcnt(0) vmcnt(14)
    v_cmp_ne_u32 vcc, s35, v8
    s_nop 0
    s_cbranch_vccnz K_POLL4
K_POLL4_OK:
    s_barrier
    v_mfma_f32_16x16x32_bf16 v[32:35], a[104:107], v[152:155], v[32:35]
    ds_read_b128 v[168:171], v23 offset:0
    buffer_load_dwordx4 a[168:171], v26, s[28:31], s73 offen sc1
    s_add_u32 s57, s38, 22413312
    v_mfma_f32_16x16x32_bf16 v[48:51], a[120:123], v[152:155], v[48:51]
    ds_read_b128 v[172:175], v23 offset:2048
    v_lshl_add_u32 v5, v1, 6, s99
    v_mfma_f32_16x16x32_bf16 v[36:39], a[104:107], v[156:159], v[36:39]
    ds_read_b128 v[176:179], v23 offset:4096
    s_xor_b32 s38, s33, 264
    v_mfma_f32_16x16x32_bf16 v[52:55], a[120:123], v[156:159], v[52:55]
    ds_read_b128 v[180:183], v23 offset:6144
    v_mfma_f32_16x16x32_bf16 v[40:43], a[104:107], v[160:163], v[40:43]
    buffer_load_dwordx4 a[184:187], v26, s[28:31], s74 offen sc1
    s_lshl_b32 s38, s38, 6
    v_mfma_f32_16x16x32_bf16 v[56:59], a[120:123], v[160:163], v[56:59]
    s_add_u32 s38, s38, s99
    v_mfma_f32_16x16x32_bf16 v[44:47], a[104:107], v[164:167], v[44:47]
    v_mov_b32_e64 v9, s38
    v_mfma_f32_16x16x32_bf16 v[60:63], a[120:123], v[164:167], v[60:63]
    s_waitcnt lgkmcnt(0) vmcnt(14)
    v_mfma_f32_16x16x32_bf16 v[32:35], a[108:111], v[168:171], v[32:35]
    ds_read_b128 v[152:155], v20 offset:16384
    s_lshl2_add_u32 s70, s4, s34
    v_mfma_f32_16x16x32_bf16 v[48:51], a[124:127], v[168:171], v[48:51]
    ds_read_b128 v[156:159], v20 offset:18432
    s_lshl_b32 s70, s70, 12
    v_mfma_f32_16x16x32_bf16 v[36:39], a[108:111], v[172:175], v[36:39]
    ds_read_b128 v[160:163], v20 offset:20480
    s_add_u32 m0, s37, 131072
    v_mfma_f32_16x16x32_bf16 v[52:55], a[124:127], v[172:175], v[52:55]
    ds_read_b128 v[164:167], v20 offset:22528
    s_add_u32 s70, s70, 9437184
    v_mfma_f32_16x16x32_bf16 v[40:43], a[108:111], v[176:179], v[40:43]
    buffer_load_dwordx4 v133, s[24:27], s70 offen offset:0 sc1 nt lds
    v_mfma_f32_16x16x32_bf16 v[56:59], a[124:127], v[176:179], v[56:59]
    buffer_load_dwordx4 v133, s[24:27], s70 offen offset:1024 sc1 nt lds
    v_mfma_f32_16x16x32_bf16 v[44:47], a[108:111], v[180:183], v[44:47]
    buffer_load_dwordx4 a[172:175], v27, s[28:31], s73 offen sc1
    v_mfma_f32_16x16x32_bf16 v[60:63], a[124:127], v[180:183], v[60:63]
    buffer_load_dwordx4 a[188:191], v27, s[28:31], s74 offen sc1
    s_waitcnt lgkmcnt(0) vmcnt(16)
    v_mfma_f32_16x16x32_bf16 v[32:35], a[128:131], v[152:155], v[32:35]
    ds_read_b128 v[168:171], v21 offset:16384
    buffer_load_dwordx4 v133, s[24:27], s70 offen offset:2048 sc1 nt lds
    v_mfma_f32_16x16x32_bf16 v[48:51], a[144:147], v[152:155], v[48:51]
    ds_read_b128 v[172:175], v21 offset:18432
    buffer_load_dwordx4 v133, s[24:27], s70 offen offset:3072 sc1 nt lds
    v_mfma_f32_16x16x32_bf16 v[36:39], a[128:131], v[156:159], v[36:39]
    ds_read_b128 v[176:179], v21 offset:20480
    s_bfe_u32 s73, s97, 262172
    v_mfma_f32_16x16x32_bf16 v[52:55], a[144:147], v[156:159], v[52:55]
    ds_read_b128 v[180:183], v21 offset:22528
    s_lshl_b32 s73, s73, 8
    v_mfma_f32_16x16x32_bf16 v[40:43], a[128:131], v[160:163], v[40:43]
    s_add_u32 s73, s73, s95
    v_mfma_f32_16x16x32_bf16 v[56:59], a[144:147], v[160:163], v[56:59]
    s_add_u32 s74, s73, 0x20000
    v_mfma_f32_16x16x32_bf16 v[44:47], a[128:131], v[164:167], v[44:47]
    buffer_load_dwordx4 a[192:195], v24, s[28:31], s73 offen sc1
    v_mfma_f32_16x16x32_bf16 v[60:63], a[144:147], v[164:167], v[60:63]
    buffer_load_dwordx4 a[208:211], v24, s[28:31], s74 offen sc1
    s_waitcnt lgkmcnt(0) vmcnt(18)
    v_mfma_f32_16x16x32_bf16 v[32:35], a[132:135], v[168:171], v[32:35]
    ds_read_b128 v[152:155], v22 offset:16384
    buffer_load_dwordx4 a[196:199], v25, s[28:31], s73 offen sc1
    v_mfma_f32_16x16x32_bf16 v[48:51], a[148:151], v[168:171], v[48:51]
    ds_read_b128 v[156:159], v22 offset:18432
    v_mfma_f32_16x16x32_bf16 v[36:39], a[132:135], v[172:175], v[36:39]
    ds_read_b128 v[160:163], v22 offset:20480
    v_mfma_f32_16x16x32_bf16 v[52:55], a[148:151], v[172:175], v[52:55]
    ds_read_b128 v[164:167], v22 offset:22528
    v_mfma_f32_16x16x32_bf16 v[40:43], a[132:135], v[176:179], v[40:43]
    buffer_load_dwordx4 a[212:215], v25, s[28:31], s74 offen sc1
    v_mfma_f32_16x16x32_bf16 v[56:59], a[148:151], v[176:179], v[56:59]
    v_mfma_f32_16x16x32_bf16 v[44:47], a[132:135], v[180:183], v[44:47]
    v_mfma_f32_16x16x32_bf16 v[60:63], a[148:151], v[180:183], v[60:63]
    s_waitcnt lgkmcnt(0) vmcnt(18)
    v_mfma_f32_16x16x32_bf16 v[32:35], a[136:139], v[152:155], v[32:35]
    ds_read_b128 v[168:171], v23 offset:16384
    buffer_load_dwordx4 a[200:203], v26, s[28:31], s73 offen sc1
    v_mfma_f32_16x16x32_bf16 v[48:51], a[152:155], v[152:155], v[48:51]
    ds_read_b128 v[172:175], v23 offset:18432
    v_mfma_f32_16x16x32_bf16 v[36:39], a[136:139], v[156:159], v[36:39]
    ds_read_b128 v[176:179], v23 offset:20480
    v_mfma_f32_16x16x32_bf16 v[52:55], a[152:155], v[156:159], v[52:55]
    ds_read_b128 v[180:183], v23 offset:22528
    v_mfma_f32_16x16x32_bf16 v[40:43], a[136:139], v[160:163], v[40:43]
    buffer_load_dwordx4 a[216:219], v26, s[28:31], s74 offen sc1
    v_mfma_f32_16x16x32_bf16 v[56:59], a[152:155], v[160:163], v[56:59]
    v_mfma_f32_16x16x32_bf16 v[44:47], a[136:139], v[164:167], v[44:47]
    v_mfma_f32_16x16x32_bf16 v[60:63], a[152:155], v[164:167], v[60:63]
    s_waitcnt lgkmcnt(0) vmcnt(18)
    v_mfma_f32_16x16x32_bf16 v[32:35], a[140:143], v[168:171], v[32:35]
    ds_read_b128 v[152:155], v20 offset:32768
    buffer_load_dwordx4 a[204:207], v27, s[28:31], s73 offen sc1
    v_mfma_f32_16x16x32_bf16 v[48:51], a[156:159], v[168:171], v[48:51]
    ds_read_b128 v[156:159], v20 offset:34816
    v_mfma_f32_16x16x32_bf16 v[36:39], a[140:143], v[172:175], v[36:39]
    ds_read_b128 v[160:163], v20 offset:36864
    v_mfma_f32_16x16x32_bf16 v[52:55], a[156:159], v[172:175], v[52:55]
    ds_read_b128 v[164:167], v20 offset:38912
    v_mfma_f32_16x16x32_bf16 v[40:43], a[140:143], v[176:179], v[40:43]
    buffer_load_dwordx4 a[220:223], v27, s[28:31], s74 offen sc1
    v_mfma_f32_16x16x32_bf16 v[56:59], a[156:159], v[176:179], v[56:59]
    v_mfma_f32_16x16x32_bf16 v[44:47], a[140:143], v[180:183], v[44:47]
    v_mfma_f32_16x16x32_bf16 v[60:63], a[156:159], v[180:183], v[60:63]
    s_waitcnt lgkmcnt(0) vmcnt(18)
    v_mfma_f32_16x16x32_bf16 v[32:35], a[160:163], v[152:155], v[32:35]
    ds_read_b128 v[168:171], v21 offset:32768
    s_bfe_u32 s72, s97, 262144
    v_mfma_f32_16x16x32_bf16 v[48:51], a[176:179], v[152:155], v[48:51]
    ds_read_b128 v[172:175], v21 offset:34816
    s_add_u32 m0, s37, 0
    v_mfma_f32_16x16x32_bf16 v[36:39], a[160:163], v[156:159], v[36:39]
    ds_read_b128 v[176:179], v21 offset:36864
    v_mfma_f32_16x16x32_bf16 v[52:55], a[176:179], v[156:159], v[52:55]
    ds_read_b128 v[180:183], v21 offset:38912
    s_lshl_b32 s72, s72, 7
    v_mfma_f32_16x16x32_bf16 v[40:43], a[160:163], v[160:163], v[40:43]
    buffer_load_dwordx4 v16, s[16:19], s72 offen offset:0 nt lds
    v_mfma_f32_16x16x32_bf16 v[56:59], a[176:179], v[160:163], v[56:59]
    v_mfma_f32_16x16x32_bf16 v[44:47], a[160:163], v[164:167], v[44:47]
    buffer_load_dwordx4 v17, s[16:19], s72 offen offset:1024 nt lds
    v_mfma_f32_16x16x32_bf16 v[60:63], a[176:179], v[164:167], v[60:63]
    s_waitcnt lgkmcnt(0) vmcnt(18)
    v_mfma_f32_16x16x32_bf16 v[32:35], a[164:167], v[168:171], v[32:35]
    ds_read_b128 v[152:155], v22 offset:32768
    buffer_load_dwordx4 v18, s[16:19], s72 offen offset:2048 nt lds
    v_mfma_f32_16x16x32_bf16 v[48:51], a[180:183], v[168:171], v[48:51]
    ds_read_b128 v[156:159], v22 offset:34816
    v_mfma_f32_16x16x32_bf16 v[36:39], a[164:167], v[172:175], v[36:39]
    ds_read_b128 v[160:163], v22 offset:36864
    v_mfma_f32_16x16x32_bf16 v[52:55], a[180:183], v[172:175], v[52:55]
    ds_read_b128 v[164:167], v22 offset:38912
    v_mfma_f32_16x16x32_bf16 v[40:43], a[164:167], v[176:179], v[40:43]
    buffer_load_dwordx4 v19, s[16:19], s72 offen offset:3072 nt lds
    v_mfma_f32_16x16x32_bf16 v[56:59], a[180:183], v[176:179], v[56:59]
    v_mfma_f32_16x16x32_bf16 v[44:47], a[164:167], v[180:183], v[44:47]
    v_mfma_f32_16x16x32_bf16 v[60:63], a[180:183], v[180:183], v[60:63]
    s_waitcnt lgkmcnt(0) vmcnt(12)
    s_barrier
    v_mfma_f32_16x16x32_bf16 v[32:35], a[168:171], v[152:155], v[32:35]
    ds_read_b128 v[168:171], v23 offset:32768
    s_bfe_u32 s72, s97, 262148
    v_mfma_f32_16x16x32_bf16 v[48:51], a[184:187], v[152:155], v[48:51]
    ds_read_b128 v[172:175], v23 offset:34816
    s_add_u32 m0, s37, 16384
    v_mfma_f32_16x16x32_bf16 v[36:39], a[168:171], v[156:159], v[36:39]
    ds_read_b128 v[176:179], v23 offset:36864
    v_mfma_f32_16x16x32_bf16 v[52:55], a[184:187], v[156:159], v[52:55]
    ds_read_b128 v[180:183], v23 offset:38912
    s_lshl_b32 s72, s72, 7
    v_mfma_f32_16x16x32_bf16 v[40:43], a[168:171], v[160:163], v[40:43]
    ds_read_b64 v[184:185], v130 offset:0
    buffer_load_dwordx4 v16, s[16:19], s72 offen offset:0 nt lds
    v_mfma_f32_16x16x32_bf16 v[56:59], a[184:187], v[160:163], v[56:59]
    ds_read_b64 v[186:187], v130 offset:1024
    v_mfma_f32_16x16x32_bf16 v[44:47], a[168:171], v[164:167], v[44:47]
    ds_read_b64 v[188:189], v130 offset:2048
    buffer_load_dwordx4 v17, s[16:19], s72 offen offset:1024 nt lds
    v_mfma_f32_16x16x32_bf16 v[60:63], a[184:187], v[164:167], v[60:63]
    ds_read_b64 v[190:191], v130 offset:3072
    s_waitcnt lgkmcnt(4)
    v_mfma_f32_16x16x32_bf16 v[32:35], a[172:175], v[168:171], v[32:35]
    ds_read_b128 v[152:155], v20 offset:49152
    buffer_load_dwordx4 v18, s[16:19], s72 offen offset:2048 nt lds
    s_waitcnt lgkmcnt(1)
    v_mfma_f32_16x16x32_bf16 v[48:51], a[188:191], v[168:171], v[48:51]
    ds_read_b128 v[156:159], v20 offset:51200
    v_swap_b32 v185, v186
    v_mfma_f32_16x16x32_bf16 v[36:39], a[172:175], v[172:175], v[36:39]
    ds_read_b128 v[160:163], v20 offset:53248
    v_mfma_f32_16x16x32_bf16 v[52:55], a[188:191], v[172:175], v[52:55]
    ds_read_b128 v[164:167], v20 offset:55296
    v_swap_b32 v189, v190
    v_mfma_f32_16x16x32_bf16 v[40:43], a[172:175], v[176:179], v[40:43]
    ds_read_b64 v[192:193], v132 offset:0
    buffer_load_dwordx4 v19, s[16:19], s72 offen offset:3072 nt lds
    v_swap_b32 v186, v188
    v_mfma_f32_16x16x32_bf16 v[56:59], a[188:191], v[176:179], v[56:59]
    ds_read_b64 v[194:195], v131 offset:2048
    v_mfma_f32_16x16x32_bf16 v[44:47], a[172:175], v[180:183], v[44:47]
    ds_read_b64 v[196:197], v131 offset:1024
    v_swap_b32 v187, v189
    v_xor_b32 v20, 0x10000, v20
    v_mfma_f32_16x16x32_bf16 v[60:63], a[188:191], v[180:183], v[60:63]
    ds_read_b64 v[198:199], v131 offset:0
    v_mfma_f32_16x16x32_bf16 v[112:115], v[184:187], a[224:227], 0
    s_bfe_u32 s72, s97, 262152
    v_mfma_f32_16x16x32_bf16 v[116:119], v[184:187], a[228:231], 0
    s_add_u32 m0, s37, 32768
    s_waitcnt lgkmcnt(0)
    v_swap_b32 v193, v194
    v_mfma_f32_16x16x32_bf16 v[120:123], v[184:187], a[232:235], 0
    v_swap_b32 v197, v198
    v_swap_b32 v194, v196
    v_mfma_f32_16x16x32_bf16 v[124:127], v[184:187], a[236:239], 0
    s_lshl_b32 s72, s72, 7
    v_swap_b32 v195, v197
    v_mfma_f32_16x16x32_bf16 v[144:147], v[188:191], a[224:227], 0
    buffer_load_dwordx4 v16, s[16:19], s72 offen offset:0 nt lds
    v_mfma_f32_16x16x32_bf16 v[148:151], v[188:191], a[228:231], 0
    v_mfma_f32_16x16x32_bf16 v[248:251], v[188:191], a[232:235], 0
    buffer_load_dwordx4 v17, s[16:19], s72 offen offset:1024 nt lds
    v_mfma_f32_16x16x32_bf16 v[252:255], v[188:191], a[236:239], 0
    buffer_load_dwordx4 v18, s[16:19], s72 offen offset:2048 nt lds
    v_mfma_f32_16x16x32_bf16 v[112:115], v[192:195], a[224:227], v[112:115]
    v_mfma_f32_16x16x32_bf16 v[116:119], v[192:195], a[228:231], v[116:119]
    buffer_load_dwordx4 v19, s[16:19], s72 offen offset:3072 nt lds
    v_mfma_f32_16x16x32_bf16 v[120:123], v[192:195], a[240:243], v[120:123]
    s_bfe_u32 s72, s97, 262156
    v_mfma_f32_16x16x32_bf16 v[124:127], v[192:195], a[244:247], v[124:127]
    v_mfma_f32_16x16x32_bf16 v[144:147], v[196:199], a[224:227], v[144:147]
    s_add_u32 m0, s37, 49152
    v_mfma_f32_16x16x32_bf16 v[148:151], v[196:199], a[228:231], v[148:151]
    s_lshl_b32 s72, s72, 7
    s_nop 0
    v_mfma_f32_16x16x32_bf16 v[248:251], v[196:199], a[240:243], v[248:251]
    v_mfma_f32_16x16x32_bf16 v[252:255], v[196:199], a[244:247], v[252:255]
    v_pk_mul_f32 v[134:135], v[112:113], v[96:97]
    v_pk_mul_f32 v[136:137], v[116:117], v[96:97]
    v_pk_fma_f32 v[134:135], v[116:117], v[104:105], v[134:135]
    v_pk_fma_f32 v[136:137], v[112:113], v[104:105], v[136:137] neg_lo:[1,0,0] neg_hi:[1,0,0]
    v_pk_mul_f32 v[138:139], v[114:115], v[98:99]
    v_pk_mul_f32 v[140:141], v[118:119], v[98:99]
    v_pk_fma_f32 v[138:139], v[118:119], v[106:107], v[138:139]
    v_pk_fma_f32 v[140:141], v[114:115], v[106:107], v[140:141] neg_lo:[1,0,0] neg_hi:[1,0,0]
    v_cvt_pk_bf16_f32 v184, v134, v136
    v_cvt_pk_bf16_f32 v185, v135, v137
    v_cvt_pk_bf16_f32 v186, v138, v140
    v_cvt_pk_bf16_f32 v187, v139, v141
    v_pk_mul_f32 v[134:135], v[120:121], v[100:101]
    v_pk_mul_f32 v[136:137], v[124:125], v[100:101]
    v_pk_fma_f32 v[134:135], v[124:125], v[108:109], v[134:135]
    v_pk_fma_f32 v[136:137], v[120:121], v[108:109], v[136:137] neg_lo:[1,0,0] neg_hi:[1,0,0]
    v_pk_mul_f32 v[138:139], v[122:123], v[102:103]
    v_pk_mul_f32 v[140:141], v[126:127], v[102:103]
    v_pk_fma_f32 v[138:139], v[126:127], v[110:111], v[138:139]
    v_pk_fma_f32 v[140:141], v[122:123], v[110:111], v[140:141] neg_lo:[1,0,0] neg_hi:[1,0,0]
    v_cvt_pk_bf16_f32 v188, v134, v136
    v_cvt_pk_bf16_f32 v189, v135, v137
    v_cvt_pk_bf16_f32 v190, v138, v140
    v_cvt_pk_bf16_f32 v191, v139, v141
    v_pk_mul_f32 v[134:135], v[144:145], v[96:97]
    v_pk_mul_f32 v[136:137], v[148:149], v[96:97]
    v_pk_fma_f32 v[134:135], v[148:149], v[104:105], v[134:135]
    v_pk_fma_f32 v[136:137], v[144:145], v[104:105], v[136:137] neg_lo:[1,0,0] neg_hi:[1,0,0]
    v_pk_mul_f32 v[138:139], v[146:147], v[98:99]
    v_pk_mul_f32 v[140:141], v[150:151], v[98:99]
    v_pk_fma_f32 v[138:139], v[150:151], v[106:107], v[138:139]
    v_pk_fma_f32 v[140:141], v[146:147], v[106:107], v[140:141] neg_lo:[1,0,0] neg_hi:[1,0,0]
    v_cvt_pk_bf16_f32 v192, v134, v136
    v_cvt_pk_bf16_f32 v193, v135, v137
    v_cvt_pk_bf16_f32 v194, v138, v140
    v_cvt_pk_bf16_f32 v195, v139, v141
    v_pk_mul_f32 v[134:135], v[248:249], v[100:101]
    v_pk_mul_f32 v[136:137], v[252:253], v[100:101]
    v_pk_fma_f32 v[134:135], v[252:253], v[108:109], v[134:135]
    v_pk_fma_f32 v[136:137], v[248:249], v[108:109], v[136:137] neg_lo:[1,0,0] neg_hi:[1,0,0]
    v_pk_mul_f32 v[138:139], v[250:251], v[102:103]
    v_pk_mul_f32 v[140:141], v[254:255], v[102:103]
    v_pk_fma_f32 v[138:139], v[254:255], v[110:111], v[138:139]
    v_pk_fma_f32 v[140:141], v[250:251], v[110:111], v[140:141] neg_lo:[1,0,0] neg_hi:[1,0,0]
    v_cvt_pk_bf16_f32 v196, v134, v136
    v_cvt_pk_bf16_f32 v197, v135, v137
    v_cvt_pk_bf16_f32 v198, v138, v140
    v_cvt_pk_bf16_f32 v199, v139, v141
    v_mfma_f32_16x16x32_bf16 v[112:115], a[224:227], v[184:187], 0
    buffer_load_dwordx4 v16, s[16:19], s72 offen offset:0 nt lds
    v_mfma_f32_16x16x32_bf16 v[116:119], a[228:231], v[184:187], 0
    buffer_load_dwordx4 v17, s[16:19], s72 offen offset:1024 nt lds
    v_mfma_f32_16x16x32_bf16 v[120:123], a[224:227], v[188:191], 0
    v_mfma_f32_16x16x32_bf16 v[124:127], a[228:231], v[188:191], 0
    buffer_load_dwordx4 v18, s[16:19], s72 offen offset:2048 nt lds
    v_mfma_f32_16x16x32_bf16 v[144:147], a[224:227], v[192:195], 0
    buffer_load_dwordx4 v19, s[16:19], s72 offen offset:3072 nt lds
    v_mfma_f32_16x16x32_bf16 v[148:151], a[228:231], v[192:195], 0
    v_mfma_f32_16x16x32_bf16 v[248:251], a[224:227], v[196:199], 0
    v_mfma_f32_16x16x32_bf16 v[252:255], a[228:231], v[196:199], 0
    v_pk_fma_f32 v[216:217], v[112:113], v[128:129], v[216:217] op_sel_hi:[1,0,1]
    v_pk_fma_f32 v[218:219], v[114:115], v[128:129], v[218:219] op_sel_hi:[1,0,1]
    v_pk_fma_f32 v[220:221], v[116:117], v[128:129], v[220:221] op_sel_hi:[1,0,1] neg_lo:[1,0,0] neg_hi:[1,0,0]
    v_pk_fma_f32 v[222:223], v[118:119], v[128:129], v[222:223] op_sel_hi:[1,0,1] neg_lo:[1,0,0] neg_hi:[1,0,0]
    v_pk_fma_f32 v[224:225], v[120:121], v[128:129], v[224:225] op_sel_hi:[1,0,1]
    v_pk_fma_f32 v[226:227], v[122:123], v[128:129], v[226:227] op_sel_hi:[1,0,1]
    v_pk_fma_f32 v[228:229], v[124:125], v[128:129], v[228:229] op_sel_hi:[1,0,1] neg_lo:[1,0,0] neg_hi:[1,0,0]
    v_pk_fma_f32 v[230:231], v[126:127], v[128:129], v[230:231] op_sel_hi:[1,0,1] neg_lo:[1,0,0] neg_hi:[1,0,0]
    v_pk_fma_f32 v[232:233], v[144:145], v[128:129], v[232:233] op_sel:[0,1,0]
    v_pk_fma_f32 v[234:235], v[146:147], v[128:129], v[234:235] op_sel:[0,1,0]
    v_pk_fma_f32 v[236:237], v[148:149], v[128:129], v[236:237] op_sel:[0,1,0] neg_lo:[1,0,0] neg_hi:[1,0,0]
    v_pk_fma_f32 v[238:239], v[150:151], v[128:129], v[238:239] op_sel:[0,1,0] neg_lo:[1,0,0] neg_hi:[1,0,0]
    v_pk_fma_f32 v[240:241], v[248:249], v[128:129], v[240:241] op_sel:[0,1,0]
    v_pk_fma_f32 v[242:243], v[250:251], v[128:129], v[242:243] op_sel:[0,1,0]
    v_pk_fma_f32 v[244:245], v[252:253], v[128:129], v[244:245] op_sel:[0,1,0] neg_lo:[1,0,0] neg_hi:[1,0,0]
    v_pk_fma_f32 v[246:247], v[254:255], v[128:129], v[246:247] op_sel:[0,1,0] neg_lo:[1,0,0] neg_hi:[1,0,0]
    s_waitcnt vmcnt(22)
    v_mfma_f32_16x16x32_bf16 v[32:35], a[192:195], v[152:155], v[32:35]
    ds_read_b128 v[168:171], v21 offset:49152
    s_lshl_b32 s70, s32, 10
    v_cvt_pk_bf16_f32 v184, v216, v220
    v_mfma_f32_16x16x32_bf16 v[48:51], a[208:211], v[152:155], v[48:51]
    ds_read_b128 v[172:175], v21 offset:51200
    v_cvt_pk_bf16_f32 v185, v224, v228
    v_mfma_f32_16x16x32_bf16 v[36:39], a[192:195], v[156:159], v[36:39]
    ds_read_b128 v[176:179], v21 offset:53248
    v_cvt_pk_bf16_f32 v186, v232, v236
    v_mfma_f32_16x16x32_bf16 v[52:55], a[208:211], v[156:159], v[52:55]
    ds_read_b128 v[180:183], v21 offset:55296
    v_cvt_pk_bf16_f32 v187, v240, v244
    v_mfma_f32_16x16x32_bf16 v[40:43], a[192:195], v[160:163], v[40:43]
    s_add_u32 s70, s70, 22413312
    v_cvt_pk_bf16_f32 v188, v217, v221
    v_mfma_f32_16x16x32_bf16 v[56:59], a[208:211], v[160:163], v[56:59]
    v_cvt_pk_bf16_f32 v189, v225, v229
    v_mfma_f32_16x16x32_bf16 v[44:47], a[192:195], v[164:167], v[44:47]
    v_cvt_pk_bf16_f32 v190, v233, v237
    v_xor_b32 v21, 0x10000, v21
    v_mfma_f32_16x16x32_bf16 v[60:63], a[208:211], v[164:167], v[60:63]
    v_cvt_pk_bf16_f32 v191, v241, v245
    s_waitcnt lgkmcnt(0) vmcnt(20)
    v_mfma_f32_16x16x32_bf16 v[32:35], a[196:199], v[168:171], v[32:35]
    ds_read_b128 v[152:155], v22 offset:49152
    buffer_store_dwordx4 v[184:187], v4, s[24:27], s75 offen sc1
    v_cvt_pk_bf16_f32 v192, v218, v222
    v_mfma_f32_16x16x32_bf16 v[48:51], a[212:215], v[168:171], v[48:51]
    ds_read_b128 v[156:159], v22 offset:51200
    v_cvt_pk_bf16_f32 v193, v226, v230
    v_mfma_f32_16x16x32_bf16 v[36:39], a[196:199], v[172:175], v[36:39]
    ds_read_b128 v[160:163], v22 offset:53248
    v_cvt_pk_bf16_f32 v194, v234, v238
    v_mfma_f32_16x16x32_bf16 v[52:55], a[212:215], v[172:175], v[52:55]
    ds_read_b128 v[164:167], v22 offset:55296
    v_cvt_pk_bf16_f32 v195, v242, v246
    v_mfma_f32_16x16x32_bf16 v[40:43], a[196:199], v[176:179], v[40:43]
    s_add_u32 s75, s75, 16384
    v_cvt_pk_bf16_f32 v196, v219, v223
    v_mfma_f32_16x16x32_bf16 v[56:59], a[212:215], v[176:179], v[56:59]
    v_cvt_pk_bf16_f32 v197, v227, v231
    v_mfma_f32_16x16x32_bf16 v[44:47], a[196:199], v[180:183], v[44:47]
    v_cvt_pk_bf16_f32 v198, v235, v239
    v_xor_b32 v22, 0x10000, v22
    v_mfma_f32_16x16x32_bf16 v[60:63], a[212:215], v[180:183], v[60:63]
    v_cvt_pk_bf16_f32 v199, v243, v247
    s_waitcnt lgkmcnt(0) vmcnt(19)
    v_mfma_f32_16x16x32_bf16 v[32:35], a[200:203], v[152:155], v[32:35]
    ds_read_b128 v[168:171], v23 offset:49152
    buffer_store_dwordx4 v[188:191], v4, s[24:27], s75 offen sc1
    v_mfma_f32_16x16x32_bf16 v[48:51], a[216:219], v[152:155], v[48:51]
    ds_read_b128 v[172:175], v23 offset:51200
    v_mfma_f32_16x16x32_bf16 v[36:39], a[200:203], v[156:159], v[36:39]
    ds_read_b128 v[176:179], v23 offset:53248
    v_mfma_f32_16x16x32_bf16 v[52:55], a[216:219], v[156:159], v[52:55]
    ds_read_b128 v[180:183], v23 offset:55296
    v_mfma_f32_16x16x32_bf16 v[40:43], a[200:203], v[160:163], v[40:43]
    s_add_u32 s75, s75, 16384
    v_mfma_f32_16x16x32_bf16 v[56:59], a[216:219], v[160:163], v[56:59]
    v_mfma_f32_16x16x32_bf16 v[44:47], a[200:203], v[164:167], v[44:47]
    v_xor_b32 v23, 0x10000, v23
    v_mfma_f32_16x16x32_bf16 v[60:63], a[216:219], v[164:167], v[60:63]
    s_waitcnt lgkmcnt(0) vmcnt(14)
    s_barrier
    v_mfma_f32_16x16x32_bf16 v[32:35], a[204:207], v[168:171], v[32:35]
    ds_read_b128 v[152:155], v20 offset:0
    v_mfma_f32_16x16x32_bf16 v[48:51], a[220:223], v[168:171], v[48:51]
    ds_read_b128 v[156:159], v20 offset:2048
    v_mfma_f32_16x16x32_bf16 v[36:39], a[204:207], v[172:175], v[36:39]
    ds_read_b128 v[160:163], v20 offset:4096
    v_mfma_f32_16x16x32_bf16 v[52:55], a[220:223], v[172:175], v[52:55]
    ds_read_b128 v[164:167], v20 offset:6144
    v_mfma_f32_16x16x32_bf16 v[40:43], a[204:207], v[176:179], v[40:43]
    v_mfma_f32_16x16x32_bf16 v[56:59], a[220:223], v[176:179], v[56:59]
    v_mfma_f32_16x16x32_bf16 v[44:47], a[204:207], v[180:183], v[44:47]
    v_mfma_f32_16x16x32_bf16 v[60:63], a[220:223], v[180:183], v[60:63]
    s_waitcnt lgkmcnt(0)
    v_mfma_f32_16x16x32_bf16 v[216:219], v[64:67], v[152:155], 0
    ds_read_b128 v[168:171], v21 offset:0
    buffer_store_dwordx4 v[192:195], v4, s[24:27], s75 offen sc1
    v_mfma_f32_16x16x32_bf16 v[232:235], v[80:83], v[152:155], 0
    ds_read_b128 v[172:175], v21 offset:2048
    v_mfma_f32_16x16x32_bf16 v[220:223], v[64:67], v[156:159], 0
    ds_read_b128 v[176:179], v21 offset:4096
    v_cvt_pk_bf16_f32 v200, v32, v36
    v_cvt_pk_bf16_f32 v201, v40, v44
    v_mfma_f32_16x16x32_bf16 v[236:239], v[80:83], v[156:159], 0
    ds_read_b128 v[180:183], v21 offset:6144
    v_cvt_pk_bf16_f32 v202, v48, v52
    v_mfma_f32_16x16x32_bf16 v[224:227], v[64:67], v[160:163], 0
    s_add_u32 s75, s75, 16384
    v_cvt_pk_bf16_f32 v203, v56, v60
    v_mfma_f32_16x16x32_bf16 v[240:243], v[80:83], v[160:163], 0
    v_cvt_pk_bf16_f32 v204, v33, v37
    v_cvt_pk_bf16_f32 v205, v41, v45
    v_mfma_f32_16x16x32_bf16 v[228:231], v[64:67], v[164:167], 0
    v_cvt_pk_bf16_f32 v206, v49, v53
    v_mfma_f32_16x16x32_bf16 v[244:247], v[80:83], v[164:167], 0
    v_cvt_pk_bf16_f32 v207, v57, v61
    s_waitcnt lgkmcnt(0)
    v_mfma_f32_16x16x32_bf16 v[216:219], v[68:71], v[168:171], v[216:219]
    ds_read_b128 v[152:155], v22 offset:0
    buffer_store_dwordx4 v[196:199], v4, s[24:27], s75 offen sc1
    v_cvt_pk_bf16_f32 v208, v34, v38
    v_mfma_f32_16x16x32_bf16 v[232:235], v[84:87], v[168:171], v[232:235]
    ds_read_b128 v[156:159], v22 offset:2048
    v_cvt_pk_bf16_f32 v209, v42, v46
    v_mfma_f32_16x16x32_bf16 v[220:223], v[68:71], v[172:175], v[220:223]
    ds_read_b128 v[160:163], v22 offset:4096
    buffer_store_dwordx4 v[200:203], v3, s[24:27], s52 offen offset:0 sc1
    v_cvt_pk_bf16_f32 v210, v50, v54
    v_mfma_f32_16x16x32_bf16 v[236:239], v[84:87], v[172:175], v[236:239]
    ds_read_b128 v[164:167], v22 offset:6144
    v_cvt_pk_bf16_f32 v211, v58, v62
    v_mfma_f32_16x16x32_bf16 v[224:227], v[68:71], v[176:179], v[224:227]
    v_cvt_pk_bf16_f32 v212, v35, v39
    v_mfma_f32_16x16x32_bf16 v[240:243], v[84:87], v[176:179], v[240:243]
    buffer_store_dwordx4 v[204:207], v3, s[24:27], s52 offen offset:1024 sc1
    v_cvt_pk_bf16_f32 v213, v43, v47
    v_mfma_f32_16x16x32_bf16 v[228:231], v[68:71], v[180:183], v[228:231]
    v_cvt_pk_bf16_f32 v214, v51, v55
    v_mfma_f32_16x16x32_bf16 v[244:247], v[84:87], v[180:183], v[244:247]
    v_cvt_pk_bf16_f32 v215, v59, v63
    s_waitcnt lgkmcnt(0)
    v_mfma_f32_16x16x32_bf16 v[216:219], v[72:75], v[152:155], v[216:219]
    ds_read_b128 v[168:171], v23 offset:0
    buffer_store_dwordx4 v[208:211], v3, s[24:27], s52 offen offset:2048 sc1
    v_mfma_f32_16x16x32_bf16 v[232:235], v[88:91], v[152:155], v[232:235]
    ds_read_b128 v[172:175], v23 offset:2048
    v_mfma_f32_16x16x32_bf16 v[220:223], v[72:75], v[156:159], v[220:223]
    ds_read_b128 v[176:179], v23 offset:4096
    v_mfma_f32_16x16x32_bf16 v[236:239], v[88:91], v[156:159], v[236:239]
    ds_read_b128 v[180:183], v23 offset:6144
    v_mfma_f32_16x16x32_bf16 v[224:227], v[72:75], v[160:163], v[224:227]
    buffer_store_dwordx4 v[212:215], v3, s[24:27], s52 offen offset:3072 sc1
    v_mfma_f32_16x16x32_bf16 v[240:243], v[88:91], v[160:163], v[240:243]
    v_mfma_f32_16x16x32_bf16 v[228:231], v[72:75], v[164:167], v[228:231]
    v_mfma_f32_16x16x32_bf16 v[244:247], v[88:91], v[164:167], v[244:247]
    s_waitcnt lgkmcnt(0) vmcnt(8)
    s_barrier
    v_mfma_f32_16x16x32_bf16 v[216:219], v[76:79], v[168:171], v[216:219]
    ds_read_b128 v[152:155], v20 offset:16384
    v_mfma_f32_16x16x32_bf16 v[232:235], v[92:95], v[168:171], v[232:235]
    ds_read_b128 v[156:159], v20 offset:18432
    v_mfma_f32_16x16x32_bf16 v[220:223], v[76:79], v[172:175], v[220:223]
    ds_read_b128 v[160:163], v20 offset:20480
    v_mfma_f32_16x16x32_bf16 v[236:239], v[92:95], v[172:175], v[236:239]
    ds_read_b128 v[164:167], v20 offset:22528
    v_mfma_f32_16x16x32_bf16 v[224:227], v[76:79], v[176:179], v[224:227]
    v_mfma_f32_16x16x32_bf16 v[240:243], v[92:95], v[176:179], v[240:243]
    v_mfma_f32_16x16x32_bf16 v[228:231], v[76:79], v[180:183], v[228:231]
    v_mfma_f32_16x16x32_bf16 v[244:247], v[92:95], v[180:183], v[244:247]
    s_waitcnt lgkmcnt(0)
    v_mfma_f32_16x16x32_bf16 v[216:219], a[0:3], v[152:155], v[216:219]
    ds_read_b128 v[168:171], v21 offset:16384
    v_mfma_f32_16x16x32_bf16 v[232:235], a[16:19], v[152:155], v[232:235]
    ds_read_b128 v[172:175], v21 offset:18432
    v_mfma_f32_16x16x32_bf16 v[220:223], a[0:3], v[156:159], v[220:223]
    ds_read_b128 v[176:179], v21 offset:20480
    v_mfma_f32_16x16x32_bf16 v[236:239], a[16:19], v[156:159], v[236:239]
    ds_read_b128 v[180:183], v21 offset:22528
    v_mfma_f32_16x16x32_bf16 v[224:227], a[0:3], v[160:163], v[224:227]
    v_mfma_f32_16x16x32_bf16 v[240:243], a[16:19], v[160:163], v[240:243]
    v_mfma_f32_16x16x32_bf16 v[228:231], a[0:3], v[164:167], v[228:231]
    v_mfma_f32_16x16x32_bf16 v[244:247], a[16:19], v[164:167], v[244:247]
    s_waitcnt lgkmcnt(0)
    v_mfma_f32_16x16x32_bf16 v[216:219], a[4:7], v[168:171], v[216:219]
    ds_read_b128 v[152:155], v22 offset:16384
    v_mfma_f32_16x16x32_bf16 v[232:235], a[20:23], v[168:171], v[232:235]
    ds_read_b128 v[156:159], v22 offset:18432
    v_mfma_f32_16x16x32_bf16 v[220:223], a[4:7], v[172:175], v[220:223]
    ds_read_b128 v[160:163], v22 offset:20480
    v_mfma_f32_16x16x32_bf16 v[236:239], a[20:23], v[172:175], v[236:239]
    ds_read_b128 v[164:167], v22 offset:22528
    v_mfma_f32_16x16x32_bf16 v[224:227], a[4:7], v[176:179], v[224:227]
    v_mfma_f32_16x16x32_bf16 v[240:243], a[20:23], v[176:179], v[240:243]
    v_mfma_f32_16x16x32_bf16 v[228:231], a[4:7], v[180:183], v[228:231]
    v_mfma_f32_16x16x32_bf16 v[244:247], a[20:23], v[180:183], v[244:247]
    s_waitcnt lgkmcnt(0) vmcnt(4)
    s_barrier
    v_mfma_f32_16x16x32_bf16 v[216:219], a[8:11], v[152:155], v[216:219]
    ds_read_b128 v[168:171], v23 offset:16384
    v_mov_b32 v28, s35
    v_mfma_f32_16x16x32_bf16 v[232:235], a[24:27], v[152:155], v[232:235]
    ds_read_b128 v[172:175], v23 offset:18432
    v_mfma_f32_16x16x32_bf16 v[220:223], a[8:11], v[156:159], v[220:223]
    ds_read_b128 v[176:179], v23 offset:20480
    v_mfma_f32_16x16x32_bf16 v[236:239], a[24:27], v[156:159], v[236:239]
    ds_read_b128 v[180:183], v23 offset:22528
    v_mfma_f32_16x16x32_bf16 v[224:227], a[8:11], v[160:163], v[224:227]
    buffer_store_dword v28, v30, s[24:27], s57 offen sc1
    v_mfma_f32_16x16x32_bf16 v[240:243], a[24:27], v[160:163], v[240:243]
    v_mfma_f32_16x16x32_bf16 v[228:231], a[8:11], v[164:167], v[228:231]
    v_mfma_f32_16x16x32_bf16 v[244:247], a[24:27], v[164:167], v[244:247]
    s_waitcnt lgkmcnt(0)
    v_mfma_f32_16x16x32_bf16 v[216:219], a[12:15], v[168:171], v[216:219]
    ds_read_b128 v[152:155], v20 offset:32768
    v_mfma_f32_16x16x32_bf16 v[232:235], a[28:31], v[168:171], v[232:235]
    ds_read_b128 v[156:159], v20 offset:34816
    v_mfma_f32_16x16x32_bf16 v[220:223], a[12:15], v[172:175], v[220:223]
    ds_read_b128 v[160:163], v20 offset:36864
    v_mfma_f32_16x16x32_bf16 v[236:239], a[28:31], v[172:175], v[236:239]
    ds_read_b128 v[164:167], v20 offset:38912
    v_mfma_f32_16x16x32_bf16 v[224:227], a[12:15], v[176:179], v[224:227]
    v_mfma_f32_16x16x32_bf16 v[240:243], a[28:31], v[176:179], v[240:243]
    v_mfma_f32_16x16x32_bf16 v[228:231], a[12:15], v[180:183], v[228:231]
    v_mfma_f32_16x16x32_bf16 v[244:247], a[28:31], v[180:183], v[244:247]
    s_waitcnt lgkmcnt(0)
    v_mfma_f32_16x16x32_bf16 v[216:219], a[32:35], v[152:155], v[216:219]
    ds_read_b128 v[168:171], v21 offset:32768
    buffer_load_dwordx2 v[128:129], v7, s[24:27], s55 offen offset:0 sc1
    v_mfma_f32_16x16x32_bf16 v[232:235], a[48:51], v[152:155], v[232:235]
    ds_read_b128 v[172:175], v21 offset:34816
    v_mfma_f32_16x16x32_bf16 v[220:223], a[32:35], v[156:159], v[220:223]
    ds_read_b128 v[176:179], v21 offset:36864
    v_mfma_f32_16x16x32_bf16 v[236:239], a[48:51], v[156:159], v[236:239]
    ds_read_b128 v[180:183], v21 offset:38912
    v_mfma_f32_16x16x32_bf16 v[224:227], a[32:35], v[160:163], v[224:227]
    buffer_load_dwordx2 v[130:131], v7, s[24:27], s55 offen offset:64 sc1
    v_mfma_f32_16x16x32_bf16 v[240:243], a[48:51], v[160:163], v[240:243]
    v_mfma_f32_16x16x32_bf16 v[228:231], a[32:35], v[164:167], v[228:231]
    v_mfma_f32_16x16x32_bf16 v[244:247], a[48:51], v[164:167], v[244:247]
    s_waitcnt lgkmcnt(0)
    v_mfma_f32_16x16x32_bf16 v[216:219], a[36:39], v[168:171], v[216:219]
    ds_read_b128 v[152:155], v22 offset:32768
    buffer_load_dwordx2 v[132:133], v7, s[24:27], s55 offen offset:128 sc1
    v_mfma_f32_16x16x32_bf16 v[232:235], a[52:55], v[168:171], v[232:235]
    ds_read_b128 v[156:159], v22 offset:34816
    v_mfma_f32_16x16x32_bf16 v[220:223], a[36:39], v[172:175], v[220:223]
    ds_read_b128 v[160:163], v22 offset:36864
    v_mfma_f32_16x16x32_bf16 v[236:239], a[52:55], v[172:175], v[236:239]
    ds_read_b128 v[164:167], v22 offset:38912
    v_mfma_f32_16x16x32_bf16 v[224:227], a[36:39], v[176:179], v[224:227]
    buffer_load_dwordx2 v[134:135], v7, s[24:27], s55 offen offset:192 sc1
    v_mfma_f32_16x16x32_bf16 v[240:243], a[52:55], v[176:179], v[240:243]
    v_mfma_f32_16x16x32_bf16 v[228:231], a[36:39], v[180:183], v[228:231]
    v_mfma_f32_16x16x32_bf16 v[244:247], a[52:55], v[180:183], v[244:247]
    s_waitcnt lgkmcnt(0) vmcnt(5)
    s_barrier
    v_mfma_f32_16x16x32_bf16 v[216:219], a[40:43], v[152:155], v[216:219]
    ds_read_b128 v[168:171], v23 offset:32768
    v_mov_b32 v28, s35
    v_mfma_f32_16x16x32_bf16 v[232:235], a[56:59], v[152:155], v[232:235]
    ds_read_b128 v[172:175], v23 offset:34816
    buffer_store_dword v28, v30, s[24:27], s58 offen sc1
    v_mfma_f32_16x16x32_bf16 v[220:223], a[40:43], v[156:159], v[220:223]
    ds_read_b128 v[176:179], v23 offset:36864
    s_bfe_u32 s72, s97, 262160
    v_mfma_f32_16x16x32_bf16 v[236:239], a[56:59], v[156:159], v[236:239]
    ds_read_b128 v[180:183], v23 offset:38912
    s_add_u32 m0, s37, 65536
    v_mfma_f32_16x16x32_bf16 v[224:227], a[40:43], v[160:163], v[224:227]
    s_lshl_b32 s72, s72, 7
    v_mfma_f32_16x16x32_bf16 v[240:243], a[56:59], v[160:163], v[240:243]
    buffer_load_dwordx4 v16, s[16:19], s72 offen offset:0 nt lds
    v_mfma_f32_16x16x32_bf16 v[228:231], a[40:43], v[164:167], v[228:231]
    buffer_load_dwordx4 v17, s[16:19], s72 offen offset:1024 nt lds
    v_mfma_f32_16x16x32_bf16 v[244:247], a[56:59], v[164:167], v[244:247]
    s_waitcnt lgkmcnt(0)
    v_mfma_f32_16x16x32_bf16 v[216:219], a[44:47], v[168:171], v[216:219]
    ds_read_b128 v[152:155], v20 offset:49152
    buffer_load_dwordx4 v18, s[16:19], s72 offen offset:2048 nt lds
    v_mfma_f32_16x16x32_bf16 v[232:235], a[60:63], v[168:171], v[232:235]
    ds_read_b128 v[156:159], v20 offset:51200
    v_mfma_f32_16x16x32_bf16 v[220:223], a[44:47], v[172:175], v[220:223]
    ds_read_b128 v[160:163], v20 offset:53248
    v_mfma_f32_16x16x32_bf16 v[236:239], a[60:63], v[172:175], v[236:239]
    ds_read_b128 v[164:167], v20 offset:55296
    v_mfma_f32_16x16x32_bf16 v[224:227], a[44:47], v[176:179], v[224:227]
    buffer_load_dwordx4 v19, s[16:19], s72 offen offset:3072 nt lds
    v_mfma_f32_16x16x32_bf16 v[240:243], a[60:63], v[176:179], v[240:243]
    v_mfma_f32_16x16x32_bf16 v[228:231], a[44:47], v[180:183], v[228:231]
    v_xor_b32 v20, 0x10000, v20
    v_mfma_f32_16x16x32_bf16 v[244:247], a[60:63], v[180:183], v[244:247]
    s_waitcnt lgkmcnt(0)
    v_mfma_f32_16x16x32_bf16 v[216:219], a[64:67], v[152:155], v[216:219]
    ds_read_b128 v[168:171], v21 offset:49152
    s_bfe_u32 s72, s97, 262164
    v_mfma_f32_16x16x32_bf16 v[232:235], a[80:83], v[152:155], v[232:235]
    ds_read_b128 v[172:175], v21 offset:51200
    s_add_u32 m0, s37, 81920
    v_mfma_f32_16x16x32_bf16 v[220:223], a[64:67], v[156:159], v[220:223]
    ds_read_b128 v[176:179], v21 offset:53248
    v_mfma_f32_16x16x32_bf16 v[236:239], a[80:83], v[156:159], v[236:239]
    ds_read_b128 v[180:183], v21 offset:55296
    s_lshl_b32 s72, s72, 7
    v_mfma_f32_16x16x32_bf16 v[224:227], a[64:67], v[160:163], v[224:227]
    buffer_load_dwordx4 v16, s[16:19], s72 offen offset:0 nt lds
    v_mfma_f32_16x16x32_bf16 v[240:243], a[80:83], v[160:163], v[240:243]
    v_mfma_f32_16x16x32_bf16 v[228:231], a[64:67], v[164:167], v[228:231]
    buffer_load_dwordx4 v17, s[16:19], s72 offen offset:1024 nt lds
    v_xor_b32 v21, 0x10000, v21
    v_mfma_f32_16x16x32_bf16 v[244:247], a[80:83], v[164:167], v[244:247]
    s_waitcnt lgkmcnt(0)
    v_mfma_f32_16x16x32_bf16 v[216:219], a[68:71], v[168:171], v[216:219]
    ds_read_b128 v[152:155], v22 offset:49152
    buffer_load_dwordx4 v18, s[16:19], s72 offen offset:2048 nt lds
    v_mfma_f32_16x16x32_bf16 v[232:235], a[84:87], v[168:171], v[232:235]
    ds_read_b128 v[156:159], v22 offset:51200
    v_mfma_f32_16x16x32_bf16 v[220:223], a[68:71], v[172:175], v[220:223]
    ds_read_b128 v[160:163], v22 offset:53248
    v_mfma_f32_16x16x32_bf16 v[236:239], a[84:87], v[172:175], v[236:239]
    ds_read_b128 v[164:167], v22 offset:55296
    v_mfma_f32_16x16x32_bf16 v[224:227], a[68:71], v[176:179], v[224:227]
    buffer_load_dwordx4 v19, s[16:19], s72 offen offset:3072 nt lds
    v_mfma_f32_16x16x32_bf16 v[240:243], a[84:87], v[176:179], v[240:243]
    v_mfma_f32_16x16x32_bf16 v[228:231], a[68:71], v[180:183], v[228:231]
    v_xor_b32 v22, 0x10000, v22
    v_mfma_f32_16x16x32_bf16 v[244:247], a[84:87], v[180:183], v[244:247]
    s_waitcnt lgkmcnt(0)
    v_mfma_f32_16x16x32_bf16 v[216:219], a[72:75], v[152:155], v[216:219]
    ds_read_b128 v[168:171], v23 offset:49152
    s_bfe_u32 s72, s97, 262168
    v_mfma_f32_16x16x32_bf16 v[232:235], a[88:91], v[152:155], v[232:235]
    ds_read_b128 v[172:175], v23 offset:51200
    s_add_u32 m0, s37, 98304
    v_mfma_f32_16x16x32_bf16 v[220:223], a[72:75], v[156:159], v[220:223]
    ds_read_b128 v[176:179], v23 offset:53248
    v_mfma_f32_16x16x32_bf16 v[236:239], a[88:91], v[156:159], v[236:239]
    ds_read_b128 v[180:183], v23 offset:55296
    s_lshl_b32 s72, s72, 7
    v_mfma_f32_16x16x32_bf16 v[224:227], a[72:75], v[160:163], v[224:227]
    buffer_load_dwordx4 v16, s[16:19], s72 offen offset:0 nt lds
    v_mfma_f32_16x16x32_bf16 v[240:243], a[88:91], v[160:163], v[240:243]
    v_mfma_f32_16x16x32_bf16 v[228:231], a[72:75], v[164:167], v[228:231]
    buffer_load_dwordx4 v17, s[16:19], s72 offen offset:1024 nt lds
    v_xor_b32 v23, 0x10000, v23
    v_mfma_f32_16x16x32_bf16 v[244:247], a[88:91], v[164:167], v[244:247]
    s_waitcnt lgkmcnt(0) vmcnt(6)
    s_barrier
    v_mfma_f32_16x16x32_bf16 v[216:219], a[76:79], v[168:171], v[216:219]
    ds_read_b128 v[152:155], v20 offset:0
    buffer_load_dwordx4 v18, s[16:19], s72 offen offset:2048 nt lds
    v_mfma_f32_16x16x32_bf16 v[232:235], a[92:95], v[168:171], v[232:235]
    ds_read_b128 v[156:159], v20 offset:2048
    v_mfma_f32_16x16x32_bf16 v[220:223], a[76:79], v[172:175], v[220:223]
    ds_read_b128 v[160:163], v20 offset:4096
    buffer_load_dwordx4 v19, s[16:19], s72 offen offset:3072 nt lds
    v_mfma_f32_16x16x32_bf16 v[236:239], a[92:95], v[172:175], v[236:239]
    ds_read_b128 v[164:167], v20 offset:6144
    v_mfma_f32_16x16x32_bf16 v[224:227], a[76:79], v[176:179], v[224:227]
    v_mfma_f32_16x16x32_bf16 v[240:243], a[92:95], v[176:179], v[240:243]
    buffer_load_dword v10, v5, s[24:27], s70 offen sc1
    v_mfma_f32_16x16x32_bf16 v[228:231], a[76:79], v[180:183], v[228:231]
    v_mfma_f32_16x16x32_bf16 v[244:247], a[92:95], v[180:183], v[244:247]
    s_waitcnt lgkmcnt(0)
    v_mfma_f32_16x16x32_bf16 v[216:219], a[96:99], v[152:155], v[216:219]
    ds_read_b128 v[168:171], v21 offset:0
    s_bfe_u32 s72, s97, 262172
    v_mfma_f32_16x16x32_bf16 v[232:235], a[112:115], v[152:155], v[232:235]
    ds_read_b128 v[172:175], v21 offset:2048
    s_add_u32 m0, s37, 114688
    v_mfma_f32_16x16x32_bf16 v[220:223], a[96:99], v[156:159], v[220:223]
    ds_read_b128 v[176:179], v21 offset:4096
    v_mfma_f32_16x16x32_bf16 v[236:239], a[112:115], v[156:159], v[236:239]
    ds_read_b128 v[180:183], v21 offset:6144
    s_lshl_b32 s72, s72, 7
    v_mfma_f32_16x16x32_bf16 v[224:227], a[96:99], v[160:163], v[224:227]
    buffer_load_dwordx4 v16, s[16:19], s72 offen offset:0 nt lds
    v_mfma_f32_16x16x32_bf16 v[240:243], a[112:115], v[160:163], v[240:243]
    v_mfma_f32_16x16x32_bf16 v[228:231], a[96:99], v[164:167], v[228:231]
    buffer_load_dwordx4 v17, s[16:19], s72 offen offset:1024 nt lds
    v_mfma_f32_16x16x32_bf16 v[244:247], a[112:115], v[164:167], v[244:247]
    s_waitcnt lgkmcnt(0)
    v_mfma_f32_16x16x32_bf16 v[216:219], a[100:103], v[168:171], v[216:219]
    ds_read_b128 v[152:155], v22 offset:0
    buffer_load_dwordx4 v18, s[16:19], s72 offen offset:2048 nt lds
    v_mfma_f32_16x16x32_bf16 v[232:235], a[116:119], v[168:171], v[232:235]
    ds_read_b128 v[156:159], v22 offset:2048
    v_mfma_f32_16x16x32_bf16 v[220:223], a[100:103], v[172:175], v[220:223]
    ds_read_b128 v[160:163], v22 offset:4096
    v_mfma_f32_16x16x32_bf16 v[236:239], a[116:119], v[172:175], v[236:239]
    ds_read_b128 v[164:167], v22 offset:6144
    v_mfma_f32_16x16x32_bf16 v[224:227], a[100:103], v[176:179], v[224:227]
    buffer_load_dwordx4 v19, s[16:19], s72 offen offset:3072 nt lds
    v_mfma_f32_16x16x32_bf16 v[240:243], a[116:119], v[176:179], v[240:243]
    v_mfma_f32_16x16x32_bf16 v[228:231], a[100:103], v[180:183], v[228:231]
    v_mfma_f32_16x16x32_bf16 v[244:247], a[116:119], v[180:183], v[244:247]
    s_waitcnt lgkmcnt(0)
    v_mfma_f32_16x16x32_bf16 v[216:219], a[104:107], v[152:155], v[216:219]
    ds_read_b128 v[168:171], v23 offset:0
    v_mfma_f32_16x16x32_bf16 v[232:235], a[120:123], v[152:155], v[232:235]
    ds_read_b128 v[172:175], v23 offset:2048
    v_mfma_f32_16x16x32_bf16 v[220:223], a[104:107], v[156:159], v[220:223]
    ds_read_b128 v[176:179], v23 offset:4096
    v_mfma_f32_16x16x32_bf16 v[236:239], a[120:123], v[156:159], v[236:239]
    ds_read_b128 v[180:183], v23 offset:6144
    v_mfma_f32_16x16x32_bf16 v[224:227], a[104:107], v[160:163], v[224:227]
    v_mfma_f32_16x16x32_bf16 v[240:243], a[120:123], v[160:163], v[240:243]
    v_mfma_f32_16x16x32_bf16 v[228:231], a[104:107], v[164:167], v[228:231]
    v_mfma_f32_16x16x32_bf16 v[244:247], a[120:123], v[164:167], v[244:247]
    s_waitcnt lgkmcnt(0) vmcnt(4)
    v_cmp_ne_u32 vcc, s98, v10
    s_nop 0
    s_cbranch_vccnz K_POLL5
K_POLL5_OK:
    s_barrier
    v_mfma_f32_16x16x32_bf16 v[216:219], a[108:111], v[168:171], v[216:219]
    ds_read_b128 v[152:155], v20 offset:16384
    buffer_load_dword v6, v9, s[24:27], s70 offen sc1
    v_mfma_f32_16x16x32_bf16 v[232:235], a[124:127], v[168:171], v[232:235]
    ds_read_b128 v[156:159], v20 offset:18432
    v_mfma_f32_16x16x32_bf16 v[220:223], a[108:111], v[172:175], v[220:223]
    ds_read_b128 v[160:163], v20 offset:20480
    buffer_load_dwordx4 v[96:99], v3, s[24:27], s53 offen offset:0 sc1 nt
    v_mfma_f32_16x16x32_bf16 v[236:239], a[124:127], v[172:175], v[236:239]
    ds_read_b128 v[164:167], v20 offset:22528
    v_mfma_f32_16x16x32_bf16 v[224:227], a[108:111], v[176:179], v[224:227]
    v_mfma_f32_16x16x32_bf16 v[240:243], a[124:127], v[176:179], v[240:243]
    buffer_load_dwordx4 v[100:103], v3, s[24:27], s53 offen offset:1024 sc1 nt
    v_mfma_f32_16x16x32_bf16 v[228:231], a[108:111], v[180:183], v[228:231]
    v_mfma_f32_16x16x32_bf16 v[244:247], a[124:127], v[180:183], v[244:247]
    s_waitcnt lgkmcnt(0)
    v_mfma_f32_16x16x32_bf16 v[216:219], a[128:131], v[152:155], v[216:219]
    ds_read_b128 v[168:171], v21 offset:16384
    buffer_load_dwordx4 v[104:107], v3, s[24:27], s53 offen offset:2048 sc1 nt
    v_mfma_f32_16x16x32_bf16 v[232:235], a[144:147], v[152:155], v[232:235]
    ds_read_b128 v[172:175], v21 offset:18432
    v_mfma_f32_16x16x32_bf16 v[220:223], a[128:131], v[156:159], v[220:223]
    ds_read_b128 v[176:179], v21 offset:20480
    v_mfma_f32_16x16x32_bf16 v[236:239], a[144:147], v[156:159], v[236:239]
    ds_read_b128 v[180:183], v21 offset:22528
    v_mfma_f32_16x16x32_bf16 v[224:227], a[128:131], v[160:163], v[224:227]
    buffer_load_dwordx4 v[108:111], v3, s[24:27], s53 offen offset:3072 sc1 nt
    v_mfma_f32_16x16x32_bf16 v[240:243], a[144:147], v[160:163], v[240:243]
    v_mfma_f32_16x16x32_bf16 v[228:231], a[128:131], v[164:167], v[228:231]
    v_mfma_f32_16x16x32_bf16 v[244:247], a[144:147], v[164:167], v[244:247]
    s_waitcnt lgkmcnt(0)
    v_mfma_f32_16x16x32_bf16 v[216:219], a[132:135], v[168:171], v[216:219]
    ds_read_b128 v[152:155], v22 offset:16384
    v_mfma_f32_16x16x32_bf16 v[232:235], a[148:151], v[168:171], v[232:235]
    ds_read_b128 v[156:159], v22 offset:18432
    v_mfma_f32_16x16x32_bf16 v[220:223], a[132:135], v[172:175], v[220:223]
    ds_read_b128 v[160:163], v22 offset:20480
    v_mfma_f32_16x16x32_bf16 v[236:239], a[148:151], v[172:175], v[236:239]
    ds_read_b128 v[164:167], v22 offset:22528
    v_mfma_f32_16x16x32_bf16 v[224:227], a[132:135], v[176:179], v[224:227]
    v_mfma_f32_16x16x32_bf16 v[240:243], a[148:151], v[176:179], v[240:243]
    v_mfma_f32_16x16x32_bf16 v[228:231], a[132:135], v[180:183], v[228:231]
    v_mfma_f32_16x16x32_bf16 v[244:247], a[148:151], v[180:183], v[244:247]
    s_waitcnt lgkmcnt(0)
    v_mfma_f32_16x16x32_bf16 v[216:219], a[136:139], v[152:155], v[216:219]
    ds_read_b128 v[168:171], v23 offset:16384
    v_mfma_f32_16x16x32_bf16 v[232:235], a[152:155], v[152:155], v[232:235]
    ds_read_b128 v[172:175], v23 offset:18432
    v_mfma_f32_16x16x32_bf16 v[220:223], a[136:139], v[156:159], v[220:223]
    ds_read_b128 v[176:179], v23 offset:20480
    v_mfma_f32_16x16x32_bf16 v[236:239], a[152:155], v[156:159], v[236:239]
    ds_read_b128 v[180:183], v23 offset:22528
    v_mfma_f32_16x16x32_bf16 v[224:227], a[136:139], v[160:163], v[224:227]
    v_mfma_f32_16x16x32_bf16 v[240:243], a[152:155], v[160:163], v[240:243]
    v_mfma_f32_16x16x32_bf16 v[228:231], a[136:139], v[164:167], v[228:231]
    v_mfma_f32_16x16x32_bf16 v[244:247], a[152:155], v[164:167], v[244:247]
    s_waitcnt lgkmcnt(0) vmcnt(5)
    s_barrier
    v_mfma_f32_16x16x32_bf16 v[216:219], a[140:143], v[168:171], v[216:219]
    ds_read_b128 v[152:155], v20 offset:32768
    v_mfma_f32_16x16x32_bf16 v[232:235], a[156:159], v[168:171], v[232:235]
    ds_read_b128 v[156:159], v20 offset:34816
    v_mfma_f32_16x16x32_bf16 v[220:223], a[140:143], v[172:175], v[220:223]
    ds_read_b128 v[160:163], v20 offset:36864
    v_mfma_f32_16x16x32_bf16 v[236:239], a[156:159], v[172:175], v[236:239]
    ds_read_b128 v[164:167], v20 offset:38912
    v_mfma_f32_16x16x32_bf16 v[224:227], a[140:143], v[176:179], v[224:227]
    v_mfma_f32_16x16x32_bf16 v[240:243], a[156:159], v[176:179], v[240:243]
    v_mfma_f32_16x16x32_bf16 v[228:231], a[140:143], v[180:183], v[228:231]
    v_mfma_f32_16x16x32_bf16 v[244:247], a[156:159], v[180:183], v[244:247]
    s_waitcnt lgkmcnt(0) vmcnt(4)
    v_cmp_ne_u32 vcc, s98, v6
    s_nop 0
    s_cbranch_vccnz K_POLL6
K_POLL6_OK:
    s_barrier
    v_mfma_f32_16x16x32_bf16 v[216:219], a[160:163], v[152:155], v[216:219]
    ds_read_b128 v[168:171], v21 offset:32768
    buffer_load_dwordx4 v[112:115], v3, s[24:27], s54 offen offset:0 sc1 nt
    v_mfma_f32_16x16x32_bf16 v[232:235], a[176:179], v[152:155], v[232:235]
    ds_read_b128 v[172:175], v21 offset:34816
    v_mfma_f32_16x16x32_bf16 v[220:223], a[160:163], v[156:159], v[220:223]
    ds_read_b128 v[176:179], v21 offset:36864
    v_mfma_f32_16x16x32_bf16 v[236:239], a[176:179], v[156:159], v[236:239]
    ds_read_b128 v[180:183], v21 offset:38912
    v_mfma_f32_16x16x32_bf16 v[224:227], a[160:163], v[160:163], v[224:227]
    buffer_load_dwordx4 v[116:119], v3, s[24:27], s54 offen offset:1024 sc1 nt
    v_mfma_f32_16x16x32_bf16 v[240:243], a[176:179], v[160:163], v[240:243]
    v_mfma_f32_16x16x32_bf16 v[228:231], a[160:163], v[164:167], v[228:231]
    v_mfma_f32_16x16x32_bf16 v[244:247], a[176:179], v[164:167], v[244:247]
    s_waitcnt lgkmcnt(0)
    v_mfma_f32_16x16x32_bf16 v[216:219], a[164:167], v[168:171], v[216:219]
    ds_read_b128 v[152:155], v22 offset:32768
    buffer_load_dwordx4 v[120:123], v3, s[24:27], s54 offen offset:2048 sc1 nt
    v_mfma_f32_16x16x32_bf16 v[232:235], a[180:183], v[168:171], v[232:235]
    ds_read_b128 v[156:159], v22 offset:34816
    v_mfma_f32_16x16x32_bf16 v[220:223], a[164:167], v[172:175], v[220:223]
    ds_read_b128 v[160:163], v22 offset:36864
    v_mfma_f32_16x16x32_bf16 v[236:239], a[180:183], v[172:175], v[236:239]
    ds_read_b128 v[164:167], v22 offset:38912
    v_mfma_f32_16x16x32_bf16 v[224:227], a[164:167], v[176:179], v[224:227]
    buffer_load_dwordx4 v[124:127], v3, s[24:27], s54 offen offset:3072 sc1 nt
    v_mfma_f32_16x16x32_bf16 v[240:243], a[180:183], v[176:179], v[240:243]
    v_mfma_f32_16x16x32_bf16 v[228:231], a[164:167], v[180:183], v[228:231]
    v_mfma_f32_16x16x32_bf16 v[244:247], a[180:183], v[180:183], v[244:247]
    s_waitcnt lgkmcnt(0)
    v_mfma_f32_16x16x32_bf16 v[216:219], a[168:171], v[152:155], v[216:219]
    ds_read_b128 v[168:171], v23 offset:32768
    v_mfma_f32_16x16x32_bf16 v[232:235], a[184:187], v[152:155], v[232:235]
    ds_read_b128 v[172:175], v23 offset:34816
    v_mfma_f32_16x16x32_bf16 v[220:223], a[168:171], v[156:159], v[220:223]
    ds_read_b128 v[176:179], v23 offset:36864
    v_mfma_f32_16x16x32_bf16 v[236:239], a[184:187], v[156:159], v[236:239]
    ds_read_b128 v[180:183], v23 offset:38912
    v_mfma_f32_16x16x32_bf16 v[224:227], a[168:171], v[160:163], v[224:227]
    v_mfma_f32_16x16x32_bf16 v[240:243], a[184:187], v[160:163], v[240:243]
    v_mfma_f32_16x16x32_bf16 v[228:231], a[168:171], v[164:167], v[228:231]
    v_mfma_f32_16x16x32_bf16 v[244:247], a[184:187], v[164:167], v[244:247]
    s_waitcnt lgkmcnt(0)
    v_mfma_f32_16x16x32_bf16 v[216:219], a[172:175], v[168:171], v[216:219]
    ds_read_b128 v[152:155], v20 offset:49152
    s_waitcnt vmcnt(7)
    v_lshlrev_b32_e64 v184, 16, v96
    v_mfma_f32_16x16x32_bf16 v[232:235], a[188:191], v[168:171], v[232:235]
    ds_read_b128 v[156:159], v20 offset:51200
    v_and_b32 v185, 0xffff0000, v96
    v_mfma_f32_16x16x32_bf16 v[220:223], a[172:175], v[172:175], v[220:223]
    ds_read_b128 v[160:163], v20 offset:53248
    v_lshlrev_b32_e64 v186, 16, v97
    v_mfma_f32_16x16x32_bf16 v[236:239], a[188:191], v[172:175], v[236:239]
    ds_read_b128 v[164:167], v20 offset:55296
    v_and_b32 v187, 0xffff0000, v97
    v_mfma_f32_16x16x32_bf16 v[224:227], a[172:175], v[176:179], v[224:227]
    v_lshlrev_b32_e64 v188, 16, v98
    v_mfma_f32_16x16x32_bf16 v[240:243], a[188:191], v[176:179], v[240:243]
    v_and_b32 v189, 0xffff0000, v98
    v_mfma_f32_16x16x32_bf16 v[228:231], a[172:175], v[180:183], v[228:231]
    v_lshlrev_b32_e64 v190, 16, v99
    v_mfma_f32_16x16x32_bf16 v[244:247], a[188:191], v[180:183], v[244:247]
    v_and_b32 v191, 0xffff0000, v99
    s_waitcnt lgkmcnt(0)
    v_mfma_f32_16x16x32_bf16 v[216:219], a[192:195], v[152:155], v[216:219]
    ds_read_b128 v[168:171], v21 offset:49152
    s_waitcnt vmcnt(6)
    v_lshlrev_b32_e64 v192, 16, v100
    v_mfma_f32_16x16x32_bf16 v[232:235], a[208:211], v[152:155], v[232:235]
    ds_read_b128 v[172:175], v21 offset:51200
    v_and_b32 v193, 0xffff0000, v100
    v_mfma_f32_16x16x32_bf16 v[220:223], a[192:195], v[156:159], v[220:223]
    ds_read_b128 v[176:179], v21 offset:53248
    v_lshlrev_b32_e64 v194, 16, v101
    v_mfma_f32_16x16x32_bf16 v[236:239], a[208:211], v[156:159], v[236:239]
    ds_read_b128 v[180:183], v21 offset:55296
    v_and_b32 v195, 0xffff0000, v101
    v_mfma_f32_16x16x32_bf16 v[224:227], a[192:195], v[160:163], v[224:227]
    v_lshlrev_b32_e64 v196, 16, v102
    v_mfma_f32_16x16x32_bf16 v[240:243], a[208:211], v[160:163], v[240:243]
    v_and_b32 v197, 0xffff0000, v102
    v_mfma_f32_16x16x32_bf16 v[228:231], a[192:195], v[164:167], v[228:231]
    v_lshlrev_b32_e64 v198, 16, v103
    v_mfma_f32_16x16x32_bf16 v[244:247], a[208:211], v[164:167], v[244:247]
    v_and_b32 v199, 0xffff0000, v103
    s_waitcnt lgkmcnt(0)
    v_mfma_f32_16x16x32_bf16 v[216:219], a[196:199], v[168:171], v[216:219]
    ds_read_b128 v[152:155], v22 offset:49152
    s_waitcnt vmcnt(5)
    v_lshlrev_b32_e64 v200, 16, v104
    v_mfma_f32_16x16x32_bf16 v[232:235], a[212:215], v[168:171], v[232:235]
    ds_read_b128 v[156:159], v22 offset:51200
    v_and_b32 v201, 0xffff0000, v104
    v_mfma_f32_16x16x32_bf16 v[220:223], a[196:199], v[172:175], v[220:223]
    ds_read_b128 v[160:163], v22 offset:53248
    v_lshlrev_b32_e64 v202, 16, v105
    v_mfma_f32_16x16x32_bf16 v[236:239], a[212:215], v[172:175], v[236:239]
    ds_read_b128 v[164:167], v22 offset:55296
    v_and_b32 v203, 0xffff0000, v105
    v_mfma_f32_16x16x32_bf16 v[224:227], a[196:199], v[176:179], v[224:227]
    v_lshlrev_b32_e64 v204, 16, v106
    v_mfma_f32_16x16x32_bf16 v[240:243], a[212:215], v[176:179], v[240:243]
    v_and_b32 v205, 0xffff0000, v106
    v_mfma_f32_16x16x32_bf16 v[228:231], a[196:199], v[180:183], v[228:231]
    v_lshlrev_b32_e64 v206, 16, v107
    v_mfma_f32_16x16x32_bf16 v[244:247], a[212:215], v[180:183], v[244:247]
    v_and_b32 v207, 0xffff0000, v107
    s_waitcnt lgkmcnt(0)
    v_mfma_f32_16x16x32_bf16 v[216:219], a[200:203], v[152:155], v[216:219]
    ds_read_b128 v[168:171], v23 offset:49152
    s_waitcnt vmcnt(4)
    v_lshlrev_b32_e64 v208, 16, v108
    v_mfma_f32_16x16x32_bf16 v[232:235], a[216:219], v[152:155], v[232:235]
    ds_read_b128 v[172:175], v23 offset:51200
    v_and_b32 v209, 0xffff0000, v108
    v_mfma_f32_16x16x32_bf16 v[220:223], a[200:203], v[156:159], v[220:223]
    ds_read_b128 v[176:179], v23 offset:53248
    v_lshlrev_b32_e64 v210, 16, v109
    v_mfma_f32_16x16x32_bf16 v[236:239], a[216:219], v[156:159], v[236:239]
    ds_read_b128 v[180:183], v23 offset:55296
    v_and_b32 v211, 0xffff0000, v109
    v_mfma_f32_16x16x32_bf16 v[224:227], a[200:203], v[160:163], v[224:227]
    v_lshlrev_b32_e64 v212, 16, v110
    v_mfma_f32_16x16x32_bf16 v[240:243], a[216:219], v[160:163], v[240:243]
    v_and_b32 v213, 0xffff0000, v110
    v_mfma_f32_16x16x32_bf16 v[228:231], a[200:203], v[164:167], v[228:231]
    v_lshlrev_b32_e64 v214, 16, v111
    v_mfma_f32_16x16x32_bf16 v[244:247], a[216:219], v[164:167], v[244:247]
    v_and_b32 v215, 0xffff0000, v111
    s_waitcnt lgkmcnt(0)
    v_mfma_f32_16x16x32_bf16 v[216:219], a[204:207], v[168:171], v[216:219]
    s_waitcnt vmcnt(3)
    v_lshlrev_b32_e64 v32, 16, v112
    v_mfma_f32_16x16x32_bf16 v[232:235], a[220:223], v[168:171], v[232:235]
    v_and_b32 v33, 0xffff0000, v112
    v_mfma_f32_16x16x32_bf16 v[220:223], a[204:207], v[172:175], v[220:223]
    v_lshlrev_b32_e64 v34, 16, v113
    v_mfma_f32_16x16x32_bf16 v[236:239], a[220:223], v[172:175], v[236:239]
    v_and_b32 v35, 0xffff0000, v113
    v_mfma_f32_16x16x32_bf16 v[224:227], a[204:207], v[176:179], v[224:227]
    v_lshlrev_b32_e64 v36, 16, v114
    v_mfma_f32_16x16x32_bf16 v[240:243], a[220:223], v[176:179], v[240:243]
    v_and_b32 v37, 0xffff0000, v114
    v_mfma_f32_16x16x32_bf16 v[228:231], a[204:207], v[180:183], v[228:231]
    v_lshlrev_b32_e64 v38, 16, v115
    v_mfma_f32_16x16x32_bf16 v[244:247], a[220:223], v[180:183], v[244:247]
    v_and_b32 v39, 0xffff0000, v115
    v_add_f32 v32, v32, v216
    v_add_f32 v33, v33, v220
    v_add_f32 v34, v34, v224
    s_nop 1
    v_add_f32_e64 v35, v35, v228
    v_pk_fma_f32 v[184:185], v[32:33], v[128:129], v[184:185] op_sel_hi:[1,0,1]
    v_pk_fma_f32 v[186:187], v[34:35], v[128:129], v[186:187] op_sel_hi:[1,0,1]
    s_add_u32 s39, s56, 0
    buffer_store_dwordx4 v[184:187], v12, s[28:31], s39 offen nt
    v_add_f32 v36, v36, v232
    v_add_f32 v37, v37, v236
    v_add_f32 v38, v38, v240
    v_add_f32_e64 v39, v39, v244
    v_pk_fma_f32 v[188:189], v[36:37], v[128:129], v[188:189] op_sel:[0,1,0]
    v_pk_fma_f32 v[190:191], v[38:39], v[128:129], v[190:191] op_sel:[0,1,0]
    s_add_u32 s39, s56, 131072
    buffer_store_dwordx4 v[188:191], v12, s[28:31], s39 offen nt
    s_waitcnt vmcnt(4)
    v_lshlrev_b32 v40, 16, v116
    v_and_b32 v41, 0xffff0000, v116
    v_lshlrev_b32_e64 v42, 16, v117
    v_and_b32 v43, 0xffff0000, v117
    v_lshlrev_b32_e64 v44, 16, v118
    v_and_b32 v45, 0xffff0000, v118
    v_lshlrev_b32_e64 v46, 16, v119
    v_and_b32 v47, 0xffff0000, v119
    v_add_f32 v40, v40, v217
    v_add_f32 v41, v41, v221
    v_add_f32 v42, v42, v225
    v_add_f32 v43, v43, v229
    v_pk_fma_f32 v[192:193], v[40:41], v[130:131], v[192:193] op_sel_hi:[1,0,1]
    v_pk_fma_f32 v[194:195], v[42:43], v[130:131], v[194:195] op_sel_hi:[1,0,1]
    s_add_u32 s39, s56, 4096
    buffer_store_dwordx4 v[192:195], v12, s[28:31], s39 offen nt
    v_add_f32 v44, v44, v233
    v_add_f32 v45, v45, v237
    v_add_f32 v46, v46, v241
    v_add_f32 v47, v47, v245
    v_pk_fma_f32 v[196:197], v[44:45], v[130:131], v[196:197] op_sel:[0,1,0]
    v_pk_fma_f32 v[198:199], v[46:47], v[130:131], v[198:199] op_sel:[0,1,0]
    s_add_u32 s39, s56, 135168
    buffer_store_dwordx4 v[196:199], v12, s[28:31], s39 offen nt
    s_waitcnt vmcnt(5)
    v_lshlrev_b32 v48, 16, v120
    v_and_b32 v49, 0xffff0000, v120
    v_lshlrev_b32_e64 v50, 16, v121
    v_and_b32 v51, 0xffff0000, v121
    v_lshlrev_b32_e64 v52, 16, v122
    v_and_b32 v53, 0xffff0000, v122
    v_lshlrev_b32_e64 v54, 16, v123
    v_and_b32 v55, 0xffff0000, v123
    v_add_f32 v48, v48, v218
    v_add_f32 v49, v49, v222
    v_add_f32 v50, v50, v226
    v_add_f32 v51, v51, v230
    v_pk_fma_f32 v[200:201], v[48:49], v[132:133], v[200:201] op_sel_hi:[1,0,1]
    v_pk_fma_f32 v[202:203], v[50:51], v[132:133], v[202:203] op_sel_hi:[1,0,1]
    s_add_u32 s39, s56, 8192
    buffer_store_dwordx4 v[200:203], v12, s[28:31], s39 offen nt
    v_add_f32 v52, v52, v234
    v_add_f32 v53, v53, v238
    v_add_f32 v54, v54, v242
    v_add_f32 v55, v55, v246
    v_pk_fma_f32 v[204:205], v[52:53], v[132:133], v[204:205] op_sel:[0,1,0]
    v_pk_fma_f32 v[206:207], v[54:55], v[132:133], v[206:207] op_sel:[0,1,0]
    s_add_u32 s39, s56, 139264
    buffer_store_dwordx4 v[204:207], v12, s[28:31], s39 offen nt
    s_waitcnt vmcnt(6)
    v_lshlrev_b32 v56, 16, v124
    v_and_b32 v57, 0xffff0000, v124
    v_lshlrev_b32_e64 v58, 16, v125
    v_and_b32 v59, 0xffff0000, v125
    v_lshlrev_b32_e64 v60, 16, v126
    v_and_b32 v61, 0xffff0000, v126
    v_lshlrev_b32_e64 v62, 16, v127
    v_and_b32 v63, 0xffff0000, v127
    v_add_f32 v56, v56, v219
    v_add_f32 v57, v57, v223
    v_add_f32 v58, v58, v227
    v_add_f32 v59, v59, v231
    v_pk_fma_f32 v[208:209], v[56:57], v[134:135], v[208:209] op_sel_hi:[1,0,1]
    v_pk_fma_f32 v[210:211], v[58:59], v[134:135], v[210:211] op_sel_hi:[1,0,1]
    s_add_u32 s39, s56, 12288
    buffer_store_dwordx4 v[208:211], v12, s[28:31], s39 offen nt
    v_add_f32 v60, v60, v235
    v_add_f32 v61, v61, v239
    v_add_f32 v62, v62, v243
    v_add_f32 v63, v63, v247
    v_pk_fma_f32 v[212:213], v[60:61], v[134:135], v[212:213] op_sel:[0,1,0]
    v_pk_fma_f32 v[214:215], v[62:63], v[134:135], v[214:215] op_sel:[0,1,0]
    s_add_u32 s39, s56, 143360
    buffer_store_dwordx4 v[212:215], v12, s[28:31], s39 offen nt
K_END:
    s_endpgm
K_W256:
    buffer_load_dwordx4 a[120:123], v3, s[24:27], s37 offen offset:0 sc1
    buffer_load_dwordx4 a[124:127], v3, s[24:27], s37 offen offset:1024 sc1
    buffer_load_dwordx4 a[128:131], v3, s[24:27], s37 offen offset:2048 sc1
    buffer_load_dwordx4 a[132:135], v3, s[24:27], s37 offen offset:3072 sc1
    s_add_u32 s69, s62, 1
    v_mov_b32_e64 v28, s69
    s_mov_b32 s69, 22446080
    buffer_store_dword v28, v30, s[24:27], s69 offen sc1
    s_branch K_W256_RET
K_POLL1:
    s_mov_b32 s71, 0
K_POLL1_L:
    s_sleep 2
    buffer_load_dword v216, v217, s[24:27], s68 offen sc1
    s_add_u32 s71, s71, 1
    s_waitcnt vmcnt(0)
    v_cmp_ne_u32 vcc, s35, v216
    s_nop 0
    s_cbranch_vccz K_POLL1_OK
    s_cmp_lt_u32 s71, 200000
    s_cbranch_scc1 K_POLL1_L
    s_branch K_POLL1_OK
K_SPECIAL:
    v_add_u32 v14, s63, v1
    v_sub_u32 v13, 64, v14
    v_cmp_eq_u32 s[44:45], 0, v14
    v_and_b32_e64 v13, 63, v13
    v_mul_u32_u24 v14, 144, v14
    v_mul_u32_u24 v13, 144, v13
    v_add_u32 v14, 81920, v14
    v_lshl_add_u32 v12, v2, 4, v14
    v_lshl_add_u32 v14, v2, 2, v14
    v_sub_u32_e64 v15, 3, v2
    v_add_u32 v14, 128, v14
    v_lshl_add_u32 v13, v15, 4, v13
    v_add_u32 v13, 81920, v13
    v_accvgpr_read_b32 v8, a120
    v_accvgpr_read_b32 v9, a122
    v_lshlrev_b32 v4, 16, v8
    v_lshlrev_b32 v5, 16, v9
    v_and_b32 v6, 0xffff0000, v8
    v_and_b32 v7, 0xffff0000, v9
    v_pk_mul_f32 v[184:185], v[240:241], v[4:5]
    v_pk_mul_f32 v[188:189], v[244:245], v[4:5]
    v_pk_fma_f32 v[184:185], v[244:245], v[6:7], v[184:185] neg_lo:[1,0,0] neg_hi:[1,0,0]
    v_pk_fma_f32 v[188:189], v[240:241], v[6:7], v[188:189]
    ds_write_b128 v12, v[224:227] offset:0
    v_accvgpr_read_b32 v8, a124
    v_accvgpr_read_b32 v9, a126
    v_lshlrev_b32 v4, 16, v8
    v_lshlrev_b32 v5, 16, v9
    v_and_b32 v6, 0xffff0000, v8
    v_and_b32 v7, 0xffff0000, v9
    v_pk_mul_f32 v[186:187], v[242:243], v[4:5]
    v_pk_mul_f32 v[190:191], v[246:247], v[4:5]
    v_pk_fma_f32 v[186:187], v[246:247], v[6:7], v[186:187] neg_lo:[1,0,0] neg_hi:[1,0,0]
    v_pk_fma_f32 v[190:191], v[242:243], v[6:7], v[190:191]
    ds_write_b128 v12, v[228:231] offset:9216
    v_accvgpr_read_b32 v8, a128
    v_accvgpr_read_b32 v9, a130
    v_lshlrev_b32 v4, 16, v8
    v_lshlrev_b32 v5, 16, v9
    v_and_b32 v6, 0xffff0000, v8
    v_and_b32 v7, 0xffff0000, v9
    v_pk_mul_f32 v[192:193], v[248:249], v[4:5]
    v_pk_mul_f32 v[196:197], v[252:253], v[4:5]
    v_pk_fma_f32 v[192:193], v[252:253], v[6:7], v[192:193] neg_lo:[1,0,0] neg_hi:[1,0,0]
    v_pk_fma_f32 v[196:197], v[248:249], v[6:7], v[196:197]
    ds_write_b128 v12, v[232:235] offset:64
    v_accvgpr_read_b32 v8, a132
    v_accvgpr_read_b32 v9, a134
    v_lshlrev_b32 v4, 16, v8
    v_lshlrev_b32 v5, 16, v9
    v_and_b32 v6, 0xffff0000, v8
    v_and_b32 v7, 0xffff0000, v9
    v_pk_mul_f32 v[194:195], v[250:251], v[4:5]
    v_pk_mul_f32 v[198:199], v[254:255], v[4:5]
    v_pk_fma_f32 v[194:195], v[254:255], v[6:7], v[194:195] neg_lo:[1,0,0] neg_hi:[1,0,0]
    v_pk_fma_f32 v[198:199], v[250:251], v[6:7], v[198:199]
    ds_write_b128 v12, v[236:239] offset:9280
    ds_write2st64_b32 v14, v224, v228 offset0:0 offset1:36
    s_waitcnt lgkmcnt(0)
    s_barrier
    ds_read_b128 v[96:99], v13 offset:64
    ds_read_b128 v[100:103], v13 offset:9280
    ds_read_b128 v[104:107], v13 offset:0
    ds_read_b128 v[108:111], v13 offset:9216
    ds_read_b32 v4, v13 offset:80
    ds_read_b32 v5, v13 offset:9296
    ds_read_b32 v6, v13 offset:16
    ds_read_b32 v7, v13 offset:9232
    s_waitcnt lgkmcnt(0)
    s_nop 0
    v_cndmask_b32 v96, v96, v97, s[44:45]
    v_cndmask_b32 v97, v97, v98, s[44:45]
    v_cndmask_b32 v98, v98, v99, s[44:45]
    v_cndmask_b32 v99, v99, v4, s[44:45]
    v_cndmask_b32 v100, v100, v101, s[44:45]
    v_cndmask_b32 v101, v101, v102, s[44:45]
    v_cndmask_b32 v102, v102, v103, s[44:45]
    v_cndmask_b32 v103, v103, v5, s[44:45]
    v_cndmask_b32 v104, v104, v105, s[44:45]
    v_cndmask_b32 v105, v105, v106, s[44:45]
    v_cndmask_b32 v106, v106, v107, s[44:45]
    v_cndmask_b32 v107, v107, v6, s[44:45]
    v_cndmask_b32 v108, v108, v109, s[44:45]
    v_cndmask_b32 v109, v109, v110, s[44:45]
    v_cndmask_b32 v110, v110, v111, s[44:45]
    v_cndmask_b32 v111, v111, v7, s[44:45]
    v_pk_mul_f32 v[240:241], v[98:99], 1.0 op_sel:[1,0] op_sel_hi:[0,0]
    v_pk_mul_f32 v[242:243], v[96:97], 1.0 op_sel:[1,0] op_sel_hi:[0,0]
    v_pk_mul_f32 v[244:245], v[102:103], -1.0 op_sel:[1,0] op_sel_hi:[0,0]
    v_pk_mul_f32 v[246:247], v[100:101], -1.0 op_sel:[1,0] op_sel_hi:[0,0]
    v_pk_mul_f32 v[248:249], v[106:107], 1.0 op_sel:[1,0] op_sel_hi:[0,0]
    v_pk_mul_f32 v[250:251], v[104:105], 1.0 op_sel:[1,0] op_sel_hi:[0,0]
    v_pk_mul_f32 v[252:253], v[110:111], -1.0 op_sel:[1,0] op_sel_hi:[0,0]
    v_pk_mul_f32 v[254:255], v[108:109], -1.0 op_sel:[1,0] op_sel_hi:[0,0]
    v_pk_fma_f32 v[4:5], v[224:225], s[42:43], v[244:245] op_sel_hi:[1,0,1]
    v_pk_fma_f32 v[6:7], v[228:229], s[42:43], v[240:241] op_sel_hi:[1,0,1] neg_lo:[0,0,1] neg_hi:[0,0,1]
    v_pk_fma_f32 v[8:9], v[240:241], s[42:43], v[228:229] op_sel_hi:[1,0,1]
    v_pk_fma_f32 v[10:11], v[244:245], s[42:43], v[224:225] op_sel_hi:[1,0,1] neg_lo:[0,0,1] neg_hi:[0,0,1]
    v_pk_mul_f32 v[224:225], v[4:5], v[152:153]
    v_pk_mul_f32 v[228:229], v[6:7], v[152:153]
    v_pk_mul_f32 v[240:241], v[8:9], v[168:169]
    v_pk_mul_f32 v[244:245], v[10:11], v[168:169]
    v_pk_fma_f32 v[152:153], v[6:7], v[160:161], v[224:225] neg_lo:[1,0,0] neg_hi:[1,0,0]
    v_pk_fma_f32 v[160:161], v[4:5], v[160:161], v[228:229]
    v_pk_fma_f32 v[168:169], v[10:11], v[176:177], v[240:241]
    v_pk_fma_f32 v[176:177], v[8:9], v[176:177], v[244:245] neg_lo:[1,0,0] neg_hi:[1,0,0]
    v_pk_fma_f32 v[224:225], v[152:153], s[42:43], v[176:177] op_sel_hi:[1,0,1] neg_lo:[0,0,1] neg_hi:[0,0,1]
    v_pk_fma_f32 v[228:229], v[160:161], s[42:43], v[168:169] op_sel_hi:[1,0,1]
    v_pk_fma_f32 v[240:241], v[168:169], s[42:43], v[160:161] op_sel_hi:[1,0,1] neg_lo:[0,0,1] neg_hi:[0,0,1]
    v_pk_fma_f32 v[244:245], v[176:177], s[42:43], v[152:153] op_sel_hi:[1,0,1]
    v_pk_fma_f32 v[4:5], v[226:227], s[42:43], v[246:247] op_sel_hi:[1,0,1]
    v_pk_fma_f32 v[6:7], v[230:231], s[42:43], v[242:243] op_sel_hi:[1,0,1] neg_lo:[0,0,1] neg_hi:[0,0,1]
    v_pk_fma_f32 v[8:9], v[242:243], s[42:43], v[230:231] op_sel_hi:[1,0,1]
    v_pk_fma_f32 v[10:11], v[246:247], s[42:43], v[226:227] op_sel_hi:[1,0,1] neg_lo:[0,0,1] neg_hi:[0,0,1]
    v_pk_mul_f32 v[226:227], v[4:5], v[154:155]
    v_pk_mul_f32 v[230:231], v[6:7], v[154:155]
    v_pk_mul_f32 v[242:243], v[8:9], v[170:171]
    v_pk_mul_f32 v[246:247], v[10:11], v[170:171]
    v_pk_fma_f32 v[154:155], v[6:7], v[162:163], v[226:227] neg_lo:[1,0,0] neg_hi:[1,0,0]
    v_pk_fma_f32 v[162:163], v[4:5], v[162:163], v[230:231]
    v_pk_fma_f32 v[170:171], v[10:11], v[178:179], v[242:243]
    v_pk_fma_f32 v[178:179], v[8:9], v[178:179], v[246:247] neg_lo:[1,0,0] neg_hi:[1,0,0]
    v_pk_fma_f32 v[226:227], v[154:155], s[42:43], v[178:179] op_sel_hi:[1,0,1] neg_lo:[0,0,1] neg_hi:[0,0,1]
    v_pk_fma_f32 v[230:231], v[162:163], s[42:43], v[170:171] op_sel_hi:[1,0,1]
    v_pk_fma_f32 v[242:243], v[170:171], s[42:43], v[162:163] op_sel_hi:[1,0,1] neg_lo:[0,0,1] neg_hi:[0,0,1]
    v_pk_fma_f32 v[246:247], v[178:179], s[42:43], v[154:155] op_sel_hi:[1,0,1]
    v_pk_fma_f32 v[4:5], v[232:233], s[42:43], v[252:253] op_sel_hi:[1,0,1]
    v_pk_fma_f32 v[6:7], v[236:237], s[42:43], v[248:249] op_sel_hi:[1,0,1] neg_lo:[0,0,1] neg_hi:[0,0,1]
    v_pk_fma_f32 v[8:9], v[248:249], s[42:43], v[236:237] op_sel_hi:[1,0,1]
    v_pk_fma_f32 v[10:11], v[252:253], s[42:43], v[232:233] op_sel_hi:[1,0,1] neg_lo:[0,0,1] neg_hi:[0,0,1]
    v_pk_mul_f32 v[232:233], v[4:5], v[156:157]
    v_pk_mul_f32 v[236:237], v[6:7], v[156:157]
    v_pk_mul_f32 v[248:249], v[8:9], v[172:173]
    v_pk_mul_f32 v[252:253], v[10:11], v[172:173]
    v_pk_fma_f32 v[156:157], v[6:7], v[164:165], v[232:233] neg_lo:[1,0,0] neg_hi:[1,0,0]
    v_pk_fma_f32 v[164:165], v[4:5], v[164:165], v[236:237]
    v_pk_fma_f32 v[172:173], v[10:11], v[180:181], v[248:249]
    v_pk_fma_f32 v[180:181], v[8:9], v[180:181], v[252:253] neg_lo:[1,0,0] neg_hi:[1,0,0]
    v_pk_fma_f32 v[232:233], v[156:157], s[42:43], v[180:181] op_sel_hi:[1,0,1] neg_lo:[0,0,1] neg_hi:[0,0,1]
    v_pk_fma_f32 v[236:237], v[164:165], s[42:43], v[172:173] op_sel_hi:[1,0,1]
    v_pk_fma_f32 v[248:249], v[172:173], s[42:43], v[164:165] op_sel_hi:[1,0,1] neg_lo:[0,0,1] neg_hi:[0,0,1]
    v_pk_fma_f32 v[252:253], v[180:181], s[42:43], v[156:157] op_sel_hi:[1,0,1]
    v_pk_fma_f32 v[4:5], v[234:235], s[42:43], v[254:255] op_sel_hi:[1,0,1]
    v_pk_fma_f32 v[6:7], v[238:239], s[42:43], v[250:251] op_sel_hi:[1,0,1] neg_lo:[0,0,1] neg_hi:[0,0,1]
    v_pk_fma_f32 v[8:9], v[250:251], s[42:43], v[238:239] op_sel_hi:[1,0,1]
    v_pk_fma_f32 v[10:11], v[254:255], s[42:43], v[234:235] op_sel_hi:[1,0,1] neg_lo:[0,0,1] neg_hi:[0,0,1]
    v_pk_mul_f32 v[234:235], v[4:5], v[158:159]
    v_pk_mul_f32 v[238:239], v[6:7], v[158:159]
    v_pk_mul_f32 v[250:251], v[8:9], v[174:175]
    v_pk_mul_f32 v[254:255], v[10:11], v[174:175]
    v_pk_fma_f32 v[158:159], v[6:7], v[166:167], v[234:235] neg_lo:[1,0,0] neg_hi:[1,0,0]
    v_pk_fma_f32 v[166:167], v[4:5], v[166:167], v[238:239]
    v_pk_fma_f32 v[174:175], v[10:11], v[182:183], v[250:251]
    v_pk_fma_f32 v[182:183], v[8:9], v[182:183], v[254:255] neg_lo:[1,0,0] neg_hi:[1,0,0]
    v_pk_fma_f32 v[234:235], v[158:159], s[42:43], v[182:183] op_sel_hi:[1,0,1] neg_lo:[0,0,1] neg_hi:[0,0,1]
    v_pk_fma_f32 v[238:239], v[166:167], s[42:43], v[174:175] op_sel_hi:[1,0,1]
    v_pk_fma_f32 v[250:251], v[174:175], s[42:43], v[166:167] op_sel_hi:[1,0,1] neg_lo:[0,0,1] neg_hi:[0,0,1]
    v_pk_fma_f32 v[254:255], v[182:183], s[42:43], v[158:159] op_sel_hi:[1,0,1]
    ds_write_b128 v12, v[240:243] offset:18432
    ds_write_b128 v12, v[244:247] offset:27648
    ds_write_b128 v12, v[248:251] offset:18496
    ds_write_b128 v12, v[252:255] offset:27712
    ds_write2st64_b32 v14, v240, v244 offset0:72 offset1:108
    s_waitcnt lgkmcnt(0)
    s_barrier
    ds_read_b128 v[96:99], v13 offset:18496
    ds_read_b128 v[100:103], v13 offset:27712
    ds_read_b128 v[104:107], v13 offset:18432
    ds_read_b128 v[108:111], v13 offset:27648
    ds_read_b32 v4, v13 offset:18512
    ds_read_b32 v5, v13 offset:27728
    ds_read_b32 v6, v13 offset:18448
    ds_read_b32 v7, v13 offset:27664
    s_waitcnt lgkmcnt(0)
    s_nop 0
    v_cndmask_b32 v96, v96, v97, s[44:45]
    v_cndmask_b32 v97, v97, v98, s[44:45]
    v_cndmask_b32 v98, v98, v99, s[44:45]
    v_cndmask_b32 v99, v99, v4, s[44:45]
    v_cndmask_b32 v100, v100, v101, s[44:45]
    v_cndmask_b32 v101, v101, v102, s[44:45]
    v_cndmask_b32 v102, v102, v103, s[44:45]
    v_cndmask_b32 v103, v103, v5, s[44:45]
    v_cndmask_b32 v104, v104, v105, s[44:45]
    v_cndmask_b32 v105, v105, v106, s[44:45]
    v_cndmask_b32 v106, v106, v107, s[44:45]
    v_cndmask_b32 v107, v107, v6, s[44:45]
    v_cndmask_b32 v108, v108, v109, s[44:45]
    v_cndmask_b32 v109, v109, v110, s[44:45]
    v_cndmask_b32 v110, v110, v111, s[44:45]
    v_cndmask_b32 v111, v111, v7, s[44:45]
    v_pk_add_f32 v[224:225], v[224:225], v[98:99] op_sel:[0,1] op_sel_hi:[1,0]
    v_pk_mul_f32 v[240:241], v[184:185], 4.0 op_sel_hi:[1,0]
    v_pk_add_f32 v[226:227], v[226:227], v[96:97] op_sel:[0,1] op_sel_hi:[1,0]
    v_pk_mul_f32 v[242:243], v[186:187], 4.0 op_sel_hi:[1,0]
    v_pk_add_f32 v[228:229], v[228:229], v[102:103] op_sel:[0,1] op_sel_hi:[1,0] neg_lo:[0,1] neg_hi:[0,1]
    v_pk_mul_f32 v[244:245], v[188:189], 4.0 op_sel_hi:[1,0]
    v_pk_add_f32 v[230:231], v[230:231], v[100:101] op_sel:[0,1] op_sel_hi:[1,0] neg_lo:[0,1] neg_hi:[0,1]
    v_pk_mul_f32 v[246:247], v[190:191], 4.0 op_sel_hi:[1,0]
    v_pk_add_f32 v[232:233], v[232:233], v[106:107] op_sel:[0,1] op_sel_hi:[1,0]
    v_pk_mul_f32 v[248:249], v[192:193], 4.0 op_sel_hi:[1,0]
    v_pk_add_f32 v[234:235], v[234:235], v[104:105] op_sel:[0,1] op_sel_hi:[1,0]
    v_pk_mul_f32 v[250:251], v[194:195], 4.0 op_sel_hi:[1,0]
    v_pk_add_f32 v[236:237], v[236:237], v[110:111] op_sel:[0,1] op_sel_hi:[1,0] neg_lo:[0,1] neg_hi:[0,1]
    v_pk_mul_f32 v[252:253], v[196:197], 4.0 op_sel_hi:[1,0]
    v_pk_add_f32 v[238:239], v[238:239], v[108:109] op_sel:[0,1] op_sel_hi:[1,0] neg_lo:[0,1] neg_hi:[0,1]
    v_pk_mul_f32 v[254:255], v[198:199], 4.0 op_sel_hi:[1,0]
    s_barrier
    s_branch K_SPECIAL2_RET
K_POLL2:
    s_mov_b32 s71, 0
K_POLL2_L:
    buffer_load_dwordx4 v[96:99], v148, s[24:27], s93 offen sc1
    buffer_load_dwordx4 v[100:103], v149, s[24:27], s93 offen sc1
    buffer_load_dwordx4 v[104:107], v150, s[24:27], s93 offen sc1
    buffer_load_dwordx4 v[108:111], v151, s[24:27], s93 offen sc1
    s_add_u32 s71, s71, 1
    s_waitcnt vmcnt(0)
    v_xor_b32 v4, v200, v98
    v_xor_b32 v5, v201, v102
    v_xor_b32 v6, v202, v106
    v_xor_b32_e64 v7, v203, v110
    v_or3_b32 v4, v4, v5, v6
    v_or_b32 v4, v4, v7
    v_cmp_ne_u32 vcc, 0, v4
    s_nop 0
    s_cbranch_vccz K_POLL2_OK
    s_cmp_lt_u32 s71, 200000
    s_cbranch_scc1 K_POLL2_L
    s_branch K_POLL2_OK
K_POLL3:
    s_mov_b32 s71, 0
K_POLL3_L:
    s_sleep 0
    buffer_load_dword v4, v210, s[24:27], s51 offen offset:64 sc1
    s_add_u32 s71, s71, 1
    s_waitcnt vmcnt(0)
    v_cmp_ne_u32 vcc, s98, v4
    s_nop 0
    s_cbranch_vccz K_POLL3_OK
    s_cmp_lt_u32 s71, 200000
    s_cbranch_scc1 K_POLL3_L
    s_branch K_POLL3_OK
K_POLL4:
    s_mov_b32 s71, 0
K_POLL4_L:
    s_sleep 2
    buffer_load_dword v8, v13, s[24:27], s70 offen sc1
    s_add_u32 s71, s71, 1
    s_waitcnt vmcnt(0)
    v_cmp_ne_u32 vcc, s35, v8
    s_nop 0
    s_cbranch_vccz K_POLL4_OK
    s_cmp_lt_u32 s71, 200000
    s_cbranch_scc1 K_POLL4_L
    s_branch K_POLL4_OK
K_POLL5:
    s_mov_b32 s71, 0
K_POLL5_L:
    s_sleep 2
    buffer_load_dword v10, v5, s[24:27], s70 offen sc1
    s_add_u32 s71, s71, 1
    s_waitcnt vmcnt(0)
    v_cmp_ne_u32 vcc, s98, v10
    s_nop 0
    s_cbranch_vccz K_POLL5_OK
    s_cmp_lt_u32 s71, 200000
    s_cbranch_scc1 K_POLL5_L
    s_branch K_POLL5_OK
K_POLL6:
    s_mov_b32 s71, 0
K_POLL6_L:
    s_sleep 2
    buffer_load_dword v6, v9, s[24:27], s70 offen sc1
    s_add_u32 s71, s71, 1
    s_waitcnt vmcnt(0)
    v_cmp_ne_u32 vcc, s98, v6
    s_nop 0
    s_cbranch_vccz K_POLL6_OK
    s_cmp_lt_u32 s71, 200000
    s_cbranch_scc1 K_POLL6_L
    s_branch K_POLL6_OK
K_HFAR:
    buffer_store_dwordx4 v[64:67], v24, s[28:31], s68 offen sc1
    buffer_store_dwordx4 v[80:83], v24, s[28:31], s69 offen sc1
    v_mfma_f32_16x16x32_bf16 v[32:35], v[64:67], v[152:155], 0
    ds_read_b128 v[168:171], v21 offset:0
    buffer_store_dwordx4 v[68:71], v25, s[28:31], s68 offen sc1
    v_mfma_f32_16x16x32_bf16 v[48:51], v[80:83], v[152:155], 0
    ds_read_b128 v[172:175], v21 offset:2048
    v_mfma_f32_16x16x32_bf16 v[36:39], v[64:67], v[156:159], 0
    ds_read_b128 v[176:179], v21 offset:4096
    buffer_store_dwordx4 v[84:87], v25, s[28:31], s69 offen sc1
    v_mfma_f32_16x16x32_bf16 v[52:55], v[80:83], v[156:159], 0
    ds_read_b128 v[180:183], v21 offset:6144
    v_mfma_f32_16x16x32_bf16 v[40:43], v[64:67], v[160:163], 0
    v_mfma_f32_16x16x32_bf16 v[56:59], v[80:83], v[160:163], 0
    buffer_store_dwordx4 v[72:75], v26, s[28:31], s68 offen sc1
    v_mfma_f32_16x16x32_bf16 v[44:47], v[64:67], v[164:167], 0
    v_mfma_f32_16x16x32_bf16 v[60:63], v[80:83], v[164:167], 0
    s_waitcnt lgkmcnt(0)
    v_mfma_f32_16x16x32_bf16 v[32:35], v[68:71], v[168:171], v[32:35]
    ds_read_b128 v[152:155], v22 offset:0
    buffer_store_dwordx4 v[88:91], v26, s[28:31], s69 offen sc1
    v_mfma_f32_16x16x32_bf16 v[48:51], v[84:87], v[168:171], v[48:51]
    ds_read_b128 v[156:159], v22 offset:2048
    v_mfma_f32_16x16x32_bf16 v[36:39], v[68:71], v[172:175], v[36:39]
    ds_read_b128 v[160:163], v22 offset:4096
    buffer_store_dwordx4 v[76:79], v27, s[28:31], s68 offen sc1
    v_mfma_f32_16x16x32_bf16 v[52:55], v[84:87], v[172:175], v[52:55]
    ds_read_b128 v[164:167], v22 offset:6144
    v_mfma_f32_16x16x32_bf16 v[40:43], v[68:71], v[176:179], v[40:43]
    v_mfma_f32_16x16x32_bf16 v[56:59], v[84:87], v[176:179], v[56:59]
    buffer_store_dwordx4 v[92:95], v27, s[28:31], s69 offen sc1
    v_mfma_f32_16x16x32_bf16 v[44:47], v[68:71], v[180:183], v[44:47]
    v_mfma_f32_16x16x32_bf16 v[60:63], v[84:87], v[180:183], v[60:63]
    s_branch K_HFAR_RET
K_CODE_END:
.section .rodata,"a"
.p2align 6
.amdhsa_kernel gated_mix__spectral_gfnet__ssm_conv_s5__prompt_kernel
  .amdhsa_next_free_vgpr 512
  .amdhsa_next_free_sgpr 102
  .amdhsa_accum_offset 256
  .amdhsa_group_segment_fixed_size 0
  .amdhsa_kernarg_size 128
  .amdhsa_user_sgpr_count 2
  .amdhsa_user_sgpr_kernarg_segment_ptr 1
  .amdhsa_system_sgpr_workgroup_id_x 1
.end_amdhsa_kernel
```

```asm
; @launch grid=(256,1,1) block=(256,1,1) lds=163840
.amdgcn_target "amdgcn-amd-amdhsa--gfx950"
.text
.globl gated_mix__spectral_gfnet__ssm_conv_s5__prompt_kernel
.p2align 8
.type gated_mix__spectral_gfnet__ssm_conv_s5__prompt_kernel,@function
gated_mix__spectral_gfnet__ssm_conv_s5__prompt_kernel:
    s_load_dwordx2 s[8:9], s[0:1], 0
    s_load_dwordx2 s[60:61], s[0:1], 120
    s_cmp_ge_u32 s2, 256
    s_cbranch_scc1 K_END
    s_getpc_b64 s[28:29]
K_PC:
    s_mov_b32 s30, K_CODE_END-K_PC
    s_mov_b32 s31, 0x00020000
    s_lshr_b32 s38, s2, 3
    s_mul_i32 s38, s38, 1280
    v_lshl_add_u32 v4, v0, 3, s38
    v_lshrrev_b32 v3, 6, v0
    buffer_load_dword v255, v4, s[28:31], 0 offen
    s_load_dwordx8 s[52:59], s[0:1], 32
    s_load_dwordx4 s[44:47], s[0:1], 8
    s_load_dwordx8 s[80:87], s[0:1], 64
    s_load_dwordx4 s[88:91], s[0:1], 96
    v_readfirstlane_b32 s34, v3
    v_and_b32 v1, 15, v0
    v_bfe_u32 v2, v0, 4, 2
    s_and_b32 s38, s2, 3
    s_bfe_u32 s39, s2, 0x20003
    s_lshl2_add_u32 s32, s38, s39
    s_bfe_u32 s38, s2, 0x10002
    s_lshr_b32 s39, s2, 5
    s_lshl3_add_u32 s33, s38, s39
    s_and_b32 s6, s34, 1
    s_lshr_b32 s41, s34, 1
    s_lshl1_add_u32 s38, s32, s6
    s_lshl_b32 s38, s38, 5
    s_add_u32 s38, s38, s33
    s_lshl1_add_u32 s68, s38, s41
    s_lshl_b32 s68, s68, 11
    s_add_u32 s69, s68, 65536
    v_lshlrev_b32 v5, 9, v2
    v_lshl_add_u32 v29, v1, 3, v5
    s_mov_b32 s10, 0x400000
    s_mov_b32 s11, s31
    s_waitcnt lgkmcnt(0)
    buffer_load_dwordx2 v[96:97], v29, s[8:11], s68 offen offset:0
    buffer_load_dwordx2 v[98:99], v29, s[8:11], s68 offen offset:128
    v_cmp_gt_u32_e64 vcc, 16, v0
    buffer_load_dwordx2 v[100:101], v29, s[8:11], s68 offen offset:256
    v_lshlrev_b32 v30, 2, v0
    s_lshl4_add_u32 s4, s32, s33
    s_lshl_b32 s37, s34, 12
    v_cndmask_b32 v30, 2.0, v30, vcc
    v_and_b32 v0, 63, v0
    v_lshlrev_b32 v3, 4, v0
    buffer_load_dwordx2 v[102:103], v29, s[8:11], s68 offen offset:384
    s_lshl_b32 s63, s34, 4
    s_lshl2_add_u32 s94, s6, s41
    v_and_b32 v6, 7, v0
    v_xor_b32 v6, v6, v2
    v_lshlrev_b32 v6, 4, v6
    v_and_b32 v8, 32, v0
    v_bfe_u32 v9, v0, 3, 1
    buffer_load_dwordx2 v[104:105], v29, s[8:11], s69 offen offset:0
    v_lshl_add_u32 v8, v9, 4, v8
    v_bfe_u32 v9, v0, 4, 1
    s_lshl_b32 s38, s32, 5
    s_add_u32 s38, s38, s34
    s_lshl_b32 s38, s38, 2
    v_add3_u32 v8, v8, v9, s38
    v_lshl_add_u32 v16, v8, 11, v6
    buffer_load_dwordx2 v[106:107], v29, s[8:11], s69 offen offset:128
    v_lshrrev_b32 v9, 3, v0
    s_lshl1_add_u32 s38, s33, s6
    s_lshl_b32 s38, s38, 5
    v_add_u32_e64 v9, s38, v9
    v_lshl_add_u32 v20, v9, 11, v6
    v_xor_b32 v8, 64, v16
    v_xor_b32 v9, 64, v20
    buffer_load_dwordx2 v[108:109], v29, s[8:11], s69 offen offset:256
    v_add_u32 v17, 130048, v8
    v_add_u32 v18, 2048, v16
    v_add_u32 v19, 132096, v8
    v_add_u32 v21, 15360, v9
    v_add_u32 v22, 30720, v20
    v_add_u32 v23, 46080, v9
    s_add_u32 s38, s32, s33
    buffer_load_dwordx2 v[110:111], v29, s[8:11], s69 offen offset:384
    s_and_b32 s38, s38, 3
    s_mov_b32 s66, 2253603344
    s_mov_b32 s67, 4275817111
    s_cmp_eq_u32 s38, 1
    s_cselect_b32 s66, 2539672353, s66
    s_cselect_b32 s67, 3488144292, s67
    s_cmp_eq_u32 s38, 2
    s_cselect_b32 s66, 1417023538, s66
    s_cselect_b32 s67, 3707672762, s67
    s_cmp_eq_u32 s38, 3
    s_cselect_b32 s66, 1699160323, s66
    s_cselect_b32 s67, 3989809547, s67
    s_and_b32 s38, s2, 3
    s_mul_i32 s38, s38, 0x44444444
    s_xor_b32 s66, s66, s38
    s_xor_b32 s67, s67, s38
    s_mov_b32 s14, 0x200000
    s_mov_b32 s15, s31
    s_nop 0
    s_cmp_lt_u32 s34, 2
    s_cselect_b64 s[12:13], s[56:57], s[58:59]
    s_cselect_b64 s[28:29], s[88:89], s[86:87]
    s_mov_b32 s30, 2048
    s_lshl_b32 s39, s34, 10
    s_add_u32 m0, s39, 147712
    s_lshl_b32 s38, s6, 10
    buffer_load_dwordx4 v3, s[28:31], s38 offen lds
    v_cvt_f32_u32 v249, v1
    v_cvt_f32_u32_e64 v250, v2
    v_mul_f32 v251, 0x3d800000, v249
    v_mul_f32 v250, 4.0, v250
    v_mul_f32 v248, v250, v251
    v_fmamk_f32 v4, v251, 0x00000000, v248
    v_fmamk_f32 v5, v251, 0x3f800000, v248
    v_fmamk_f32 v6, v251, 0x40000000, v248
    s_bfe_u32 s36, s66, 262144
    s_add_u32 m0, s37, 16384
    s_lshl_b32 s36, s36, 7
    buffer_load_dwordx4 v20, s[12:15], s36 offen offset:0 lds
    buffer_load_dwordx4 v21, s[12:15], s36 offen offset:1024 lds
    buffer_load_dwordx4 v22, s[12:15], s36 offen offset:2048 lds
    buffer_load_dwordx4 v23, s[12:15], s36 offen offset:3072 lds
    v_fmamk_f32 v7, v251, 0x40400000, v248
    v_cos_f32 v8, v4
    v_cos_f32 v9, v5
    v_cos_f32 v10, v6
    v_cos_f32 v11, v7
    v_sin_f32 v12, v4
    v_sin_f32 v13, v5
    v_sin_f32 v14, v6
    v_sin_f32_e64 v15, v7
    v_cvt_pk_bf16_f32 v4, v8, v12
    v_cvt_pk_bf16_f32 v5, -v12, v8
    v_accvgpr_write_b32 a224, v4
    v_accvgpr_write_b32 a228, v5
    v_cvt_pk_bf16_f32 v4, v9, v13
    v_cvt_pk_bf16_f32 v5, -v13, v9
    v_accvgpr_write_b32 a225, v4
    v_accvgpr_write_b32 a229, v5
    v_cvt_pk_bf16_f32 v4, v10, v14
    v_cvt_pk_bf16_f32 v5, -v14, v10
    v_accvgpr_write_b32 a226, v4
    v_accvgpr_write_b32 a230, v5
    v_cvt_pk_bf16_f32 v4, v11, v15
    v_cvt_pk_bf16_f32 v5, -v15, v11
    v_accvgpr_write_b32 a227, v4
    v_accvgpr_write_b32 a231, v5
    v_fmamk_f32 v4, v251, 0x3f000000, v248
    v_fmamk_f32 v5, v251, 0x3fc00000, v248
    v_fmamk_f32 v6, v251, 0x40200000, v248
    v_fmamk_f32 v7, v251, 0x40600000, v248
    v_cos_f32 v8, v4
    v_cos_f32 v9, v5
    v_cos_f32_e64 v10, v6
    s_add_u32 s40, s60, 22446080
    s_addc_u32 s41, s61, 0
    s_load_dword s62, s[40:41], 0
    v_cos_f32 v11, v7
    v_sin_f32 v12, v4
    v_sin_f32 v13, v5
    v_sin_f32 v14, v6
    v_sin_f32 v15, v7
    v_cvt_pk_bf16_f32 v4, v8, v12
    v_cvt_pk_bf16_f32 v5, -v12, v8
    v_accvgpr_write_b32 a248, v4
    v_accvgpr_write_b32 a252, v5
    v_cvt_pk_bf16_f32 v4, v9, v13
    v_cvt_pk_bf16_f32 v5, -v13, v9
    v_accvgpr_write_b32 a249, v4
    v_accvgpr_write_b32 a253, v5
    v_cvt_pk_bf16_f32 v4, v10, v14
    v_cvt_pk_bf16_f32 v5, -v14, v10
    v_accvgpr_write_b32 a250, v4
    v_accvgpr_write_b32 a254, v5
    v_cvt_pk_bf16_f32 v4, v11, v15
    v_cvt_pk_bf16_f32 v5, -v15, v11
    v_accvgpr_write_b32 a251, v4
    v_accvgpr_write_b32 a255, v5
    v_mul_f32 v251, 0x3d800000, v251
    v_mul_f32 v248, 0x3d800000, v248
    v_fmamk_f32 v4, v251, 0x00000000, v248
    v_fmamk_f32 v5, v251, 0x3f800000, v248
    v_fmamk_f32 v6, v251, 0x40000000, v248
    v_fmamk_f32 v7, v251, 0x40400000, v248
    v_cos_f32 v232, v4
    v_cos_f32 v233, v5
    v_cos_f32 v234, v6
    v_cos_f32 v235, v7
    v_sin_f32 v240, v4
    v_sin_f32 v241, v5
    v_sin_f32 v242, v6
    v_sin_f32 v243, v7
    v_fmamk_f32 v4, v251, 0x3f000000, v248
    v_fmamk_f32 v5, v251, 0x3fc00000, v248
    v_fmamk_f32 v6, v251, 0x40200000, v248
    v_fmamk_f32 v7, v251, 0x40600000, v248
    v_cos_f32 v236, v4
    v_cos_f32 v237, v5
    v_cos_f32 v238, v6
    v_cos_f32 v239, v7
    v_sin_f32 v244, v4
    v_sin_f32 v245, v5
    v_sin_f32 v246, v6
    v_sin_f32 v247, v7
    s_mov_b64 s[24:25], s[60:61]
    s_mov_b32 s26, 33554432
    s_mov_b32 s27, 0x00020000
    v_lshrrev_b32 v15, 1, v1
    v_xor_b32 v15, v15, v2
    v_lshlrev_b32 v15, 4, v15
    v_lshl_add_u32 v24, v1, 7, v15
    v_xor_b32 v25, 64, v24
    s_lshl_b32 s76, s34, 11
    s_add_u32 s76, s76, 16384
    v_add_u32 v26, s76, v24
    v_add_u32 v27, s76, v25
    v_add_u32 v148, 0x10000, v24
    v_add_u32 v149, 0x10000, v25
    v_add_u32 v150, 0x10000, v26
    v_add_u32 v151, 0x10000, v27
    s_and_b32 s76, s34, 2
    s_lshl1_add_u32 s76, s76, s6
    s_mul_i32 s76, s76, 2080
    s_add_u32 s76, s76, 131072
    v_lshl_add_u32 v15, v2, 6, v1
    v_lshl_add_u32 v252, v15, 3, s76
    v_sub_u32 v15, 728, v15
    v_lshl_add_u32 v253, v15, 3, s76
    v_lshrrev_b32 v7, 2, v0
    v_add_u32 v7, s63, v7
    v_and_b32 v15, 3, v0
    v_lshlrev_b32 v12, 4, v15
    v_mul_u32_u24 v229, 4160, v15
    v_lshl_add_u32 v229, v7, 3, v229
    v_add_u32 v229, 131072, v229
    v_lshrrev_b32_e64 v14, 2, v0
    v_lshl_add_u32 v230, v14, 8, v12
    v_and_b32_e64 v14, 3, v14
    v_lshl_add_u32 v231, v14, 10, v12
    v_lshl_add_u32 v231, v2, 19, v231
    v_and_b32 v15, 1, v15
    v_lshlrev_b32 v15, 11, v15
    v_cmp_eq_u32_e64 vcc, 0, v7
    v_add_u32 v254, 147712, v29
    s_nop 0
    v_cndmask_b32 v15, 0, v15, vcc
    v_add_u32_e64 v228, v229, v15
    v_accvgpr_write_b32 a136, v232
    v_accvgpr_write_b32 a144, v240
    v_accvgpr_write_b32 a137, v233
    v_accvgpr_write_b32 a145, v241
    v_accvgpr_write_b32 a138, v234
    v_accvgpr_write_b32 a146, v242
    v_accvgpr_write_b32 a139, v235
    v_accvgpr_write_b32 a147, v243
    v_fma_f32 v251, v249, 2.0, 1.0
    v_mul_f32 v251, 0x3d000000, v251
    v_mul_f32_e64 v248, v250, v251
    v_fmamk_f32 v4, v251, 0x00000000, v248
    v_fmamk_f32 v5, v251, 0x3f800000, v248
    v_fmamk_f32 v6, v251, 0x40000000, v248
    v_fmamk_f32 v7, v251, 0x40400000, v248
    v_cos_f32 v8, v4
    v_cos_f32 v9, v5
    v_cos_f32 v10, v6
    v_cos_f32 v11, v7
    v_sin_f32 v12, v4
    v_sin_f32 v13, v5
    v_sin_f32 v14, v6
    v_sin_f32 v15, v7
    v_cvt_pk_bf16_f32 v4, v8, v12
    v_cvt_pk_bf16_f32 v5, -v12, v8
    v_accvgpr_write_b32 a232, v4
    v_accvgpr_write_b32 a236, v5
    v_cvt_pk_bf16_f32 v4, v9, v13
    v_cvt_pk_bf16_f32 v5, -v13, v9
    v_accvgpr_write_b32 a233, v4
    v_accvgpr_write_b32 a237, v5
    v_cvt_pk_bf16_f32 v4, v10, v14
    v_cvt_pk_bf16_f32 v5, -v14, v10
    v_accvgpr_write_b32 a234, v4
    v_accvgpr_write_b32 a238, v5
    v_cvt_pk_bf16_f32 v4, v11, v15
    v_cvt_pk_bf16_f32 v5, -v15, v11
    v_accvgpr_write_b32 a235, v4
    v_accvgpr_write_b32 a239, v5
    v_cvt_pk_bf16_f32 v4, -v8, -v12
    v_cvt_pk_bf16_f32 v5, v12, -v8
    v_accvgpr_write_b32 a240, v4
    v_accvgpr_write_b32 a244, v5
    v_cvt_pk_bf16_f32 v4, -v9, -v13
    v_cvt_pk_bf16_f32 v5, v13, -v9
    v_accvgpr_write_b32 a241, v4
    v_accvgpr_write_b32 a245, v5
    v_cvt_pk_bf16_f32 v4, -v10, -v14
    v_cvt_pk_bf16_f32 v5, v14, -v10
    v_accvgpr_write_b32 a242, v4
    v_accvgpr_write_b32 a246, v5
    v_cvt_pk_bf16_f32 v4, -v11, -v15
    v_cvt_pk_bf16_f32 v5, v15, -v11
    v_accvgpr_write_b32 a243, v4
    v_accvgpr_write_b32 a247, v5
    v_mul_f32 v251, 0x3d800000, v251
    v_mul_f32 v248, 0x3d800000, v248
    v_fmamk_f32 v4, v251, 0x00000000, v248
    v_fmamk_f32 v5, v251, 0x3f800000, v248
    v_fmamk_f32 v6, v251, 0x40000000, v248
    v_fmamk_f32 v7, v251, 0x40400000, v248
    v_cos_f32 v8, v4
    v_cos_f32 v9, v5
    v_cos_f32 v10, v6
    v_cos_f32 v11, v7
    v_sin_f32 v12, v4
    v_sin_f32 v13, v5
    v_sin_f32 v14, v6
    v_sin_f32 v15, v7
    v_accvgpr_write_b32 a140, v8
    v_accvgpr_write_b32 a148, v12
    v_accvgpr_write_b32 a141, v9
    v_accvgpr_write_b32 a149, v13
    v_accvgpr_write_b32 a142, v10
    v_accvgpr_write_b32 a150, v14
    v_accvgpr_write_b32 a143, v11
    v_accvgpr_write_b32 a151, v15
    v_add_u32 v251, s63, v1
    v_cvt_f32_u32 v251, v251
    v_and_b32_e64 v147, 1, v1
    v_mul_f32 v251, 0x3c800000, v251
    v_mul_u32_u24 v147, 0x8000, v147
    v_mul_f32_e64 v248, v250, v251
    v_lshl_or_b32 v147, v147, 16, v147
    v_fmamk_f32 v4, v251, 0x00000000, v248
    v_fmamk_f32 v5, v251, 0x3f800000, v248
    v_fmamk_f32 v6, v251, 0x40000000, v248
    v_fmamk_f32 v7, v251, 0x40400000, v248
    v_cos_f32 v8, v4
    v_cos_f32 v9, v5
    s_mov_b64 s[16:17], s[44:45]
    s_mov_b32 s18, 2101248
    s_mov_b32 s19, 0x00020000
    s_mov_b64 s[20:21], s[46:47]
    s_mov_b32 s22, 2101248
    s_mov_b32 s23, 0x00020000
    s_lshr_b32 s38, s2, 6
    s_and_b32 s39, s2, 3
    s_lshl2_add_u32 s38, s38, s39
    s_lshl2_add_u32 s38, s38, s34
    s_bfe_u32 s39, s2, 0x10005
    s_bfe_u32 s40, s2, 0x20002
    s_lshl2_add_u32 s39, s39, s40
    s_bfe_u32 s40, s2, 0x10004
    s_lshl1_add_u32 s39, s39, s40
    s_lshl_b32 s39, s39, 7
    s_add_u32 s38, s38, s39
    s_mul_i32 s44, s38, 1026
    s_andn2_b32 s44, s44, 3
    s_add_u32 s45, s44, 65664
    s_sub_u32 s38, 2048, s38
    s_and_b32 s39, s38, 2047
    s_mul_i32 s39, s39, 1026
    s_add_u32 s39, s39, 514
    s_andn2_b32 s46, s39, 3
    s_mul_i32 s39, s38, 1026
    s_sub_u32 s39, s39, 65150
    s_andn2_b32 s47, s39, 3
    v_lshlrev_b32 v192, 3, v0
    v_sub_u32 v193, 504, v192
    s_lshl_b32 s38, s34, 2
    v_add_u32 v184, s38, v1
    v_and_b32_e64 v184, 15, v184
    v_and_or_b32 v184, v0, 48, v184
    s_lshl_b32 s38, s34, 10
    s_add_u32 s38, s38, 131072
    v_lshl_add_u32 v194, v184, 4, s38
    v_lshrrev_b32 v185, 2, v0
    v_and_b32_e64 v186, 3, v0
    v_lshl_add_u32 v184, v186, 2, v185
    v_and_b32_e64 v184, 15, v184
    v_lshl_add_u32 v184, v186, 6, v184
    s_lshl_b32 s38, s34, 8
    s_add_u32 s38, s38, 131072
    v_lshl_add_u32 v195, v184, 4, s38
    s_mov_b64 s[28:29], s[90:91]
    s_mov_b32 s30, 0x800000
    s_waitcnt vmcnt(9)
    v_swap_b32 v97, v98
    v_swap_b32 v101, v102
    v_swap_b32 v98, v100
    v_swap_b32 v99, v101
    s_waitcnt vmcnt(5)
    v_swap_b32 v105, v106
    v_swap_b32 v109, v110
    v_swap_b32 v106, v108
    v_swap_b32 v107, v109
    v_mfma_f32_16x16x32_bf16 v[32:35], v[96:99], a[224:227], 0
    buffer_load_dwordx3 v[196:198], v192, s[16:19], s44 offen
    buffer_load_dwordx3 v[200:202], v192, s[20:23], s44 offen
    s_and_b32 s38, s33, 3
    s_lshr_b32 s39, s32, 2
    v_mfma_f32_16x16x32_bf16 v[36:39], v[96:99], a[228:231], 0
    s_lshl2_add_u32 s38, s38, s39
    s_and_b32 s39, s32, 3
    v_mfma_f32_16x16x32_bf16 v[40:43], v[100:103], a[224:227], 0
    s_lshl2_add_u32 s38, s38, s39
    s_lshl_b32 s39, s34, 7
    v_mfma_f32_16x16x32_bf16 v[44:47], v[100:103], a[228:231], 0
    s_add_u32 s38, s38, s39
    s_lshl_b32 s38, s38, 6
    v_mfma_f32_16x16x32_bf16 v[48:51], v[104:107], a[224:227], 0
    s_lshr_b32 s39, s33, 2
    s_add_u32 s38, s38, s39
    v_mfma_f32_16x16x32_bf16 v[52:55], v[104:107], a[228:231], 0
    s_lshl_b32 s68, s38, 6
    s_lshr_b32 s39, s34, 1
    v_mfma_f32_16x16x32_bf16 v[56:59], v[108:111], a[224:227], 0
    s_lshl1_add_u32 s38, s33, s39
    s_lshr_b32 s39, s38, 4
    v_mfma_f32_16x16x32_bf16 v[60:63], v[108:111], a[228:231], 0
    s_lshl1_add_u32 s39, s39, s6
    s_lshl2_add_u32 s41, s32, s39
    buffer_load_dwordx3 v[204:206], v193, s[16:19], s46 offen
    buffer_load_dwordx3 v[208:210], v193, s[20:23], s46 offen
    s_and_b32 s40, s38, 15
    s_lshl4_add_u32 s41, s41, s40
    s_lshl_b32 s41, s41, 6
    s_nop 0
    v_pk_mul_f32 v[184:185], v[32:33], v[232:233]
    v_pk_mul_f32 v[186:187], v[36:37], v[232:233]
    v_pk_fma_f32 v[184:185], v[36:37], v[240:241], v[184:185]
    v_pk_fma_f32 v[186:187], v[32:33], v[240:241], v[186:187] neg_lo:[1,0,0] neg_hi:[1,0,0]
    v_pk_mul_f32 v[188:189], v[34:35], v[234:235]
    v_pk_mul_f32 v[190:191], v[38:39], v[234:235]
    v_pk_fma_f32 v[188:189], v[38:39], v[242:243], v[188:189]
    v_pk_fma_f32 v[190:191], v[34:35], v[242:243], v[190:191] neg_lo:[1,0,0] neg_hi:[1,0,0]
    v_cvt_pk_bf16_f32 v152, v184, v186
    v_cvt_pk_bf16_f32 v153, v185, v187
    v_cvt_pk_bf16_f32 v154, v188, v190
    v_cvt_pk_bf16_f32 v155, v189, v191
    v_pk_mul_f32 v[184:185], v[40:41], v[236:237]
    v_pk_mul_f32 v[186:187], v[44:45], v[236:237]
    v_pk_fma_f32 v[184:185], v[44:45], v[244:245], v[184:185]
    v_pk_fma_f32 v[186:187], v[40:41], v[244:245], v[186:187] neg_lo:[1,0,0] neg_hi:[1,0,0]
    v_pk_mul_f32 v[188:189], v[42:43], v[238:239]
    v_pk_mul_f32 v[190:191], v[46:47], v[238:239]
    v_pk_fma_f32 v[188:189], v[46:47], v[246:247], v[188:189]
    v_pk_fma_f32 v[190:191], v[42:43], v[246:247], v[190:191] neg_lo:[1,0,0] neg_hi:[1,0,0]
    v_cvt_pk_bf16_f32 v156, v184, v186
    v_cvt_pk_bf16_f32 v157, v185, v187
    v_cvt_pk_bf16_f32 v158, v188, v190
    v_cvt_pk_bf16_f32 v159, v189, v191
    v_pk_mul_f32 v[184:185], v[48:49], v[232:233]
    v_pk_mul_f32 v[186:187], v[52:53], v[232:233]
    v_pk_fma_f32 v[184:185], v[52:53], v[240:241], v[184:185]
    buffer_load_dwordx3 v[212:214], v192, s[16:19], s45 offen
    buffer_load_dwordx3 v[216:218], v192, s[20:23], s45 offen
    v_pk_fma_f32 v[186:187], v[48:49], v[240:241], v[186:187] neg_lo:[1,0,0] neg_hi:[1,0,0]
    v_pk_mul_f32 v[188:189], v[50:51], v[234:235]
    v_pk_mul_f32 v[190:191], v[54:55], v[234:235]
    v_pk_fma_f32 v[188:189], v[54:55], v[242:243], v[188:189]
    v_pk_fma_f32 v[190:191], v[50:51], v[242:243], v[190:191] neg_lo:[1,0,0] neg_hi:[1,0,0]
    v_cvt_pk_bf16_f32 v160, v184, v186
    v_cvt_pk_bf16_f32 v161, v185, v187
    v_cvt_pk_bf16_f32 v162, v188, v190
    v_cvt_pk_bf16_f32 v163, v189, v191
    v_pk_mul_f32 v[184:185], v[56:57], v[236:237]
    v_pk_mul_f32 v[186:187], v[60:61], v[236:237]
    v_pk_fma_f32 v[184:185], v[60:61], v[244:245], v[184:185]
    v_pk_fma_f32 v[186:187], v[56:57], v[244:245], v[186:187] neg_lo:[1,0,0] neg_hi:[1,0,0]
    v_pk_mul_f32 v[188:189], v[58:59], v[238:239]
    v_pk_mul_f32 v[190:191], v[62:63], v[238:239]
    v_pk_fma_f32 v[188:189], v[62:63], v[246:247], v[188:189]
    v_pk_fma_f32 v[190:191], v[58:59], v[246:247], v[190:191] neg_lo:[1,0,0] neg_hi:[1,0,0]
    v_cvt_pk_bf16_f32 v164, v184, v186
    v_cvt_pk_bf16_f32 v165, v185, v187
    v_cvt_pk_bf16_f32 v166, v188, v190
    v_cvt_pk_bf16_f32 v167, v189, v191
    v_mfma_f32_16x16x32_bf16 v[64:67], a[224:227], v[152:155], 0
    s_add_u32 s69, s41, 22282240
    s_lshl_b32 s41, s32, 6
    v_mfma_f32_16x16x32_bf16 v[68:71], a[228:231], v[152:155], 0
    s_add_u32 s39, s39, s41
    buffer_load_dwordx3 v[220:222], v193, s[16:19], s47 offen
    buffer_load_dwordx3 v[224:226], v193, s[20:23], s47 offen
    s_and_b32 s40, s38, 3
    v_mfma_f32_16x16x32_bf16 v[72:75], a[248:251], v[156:159], 0
    s_lshl2_add_u32 s39, s39, s40
    s_bfe_u32 s40, s38, 0x20002
    v_mfma_f32_16x16x32_bf16 v[76:79], a[252:255], v[156:159], 0
    s_lshl2_add_u32 s39, s39, s40
    s_lshl_b32 s39, s39, 8
    v_mfma_f32_16x16x32_bf16 v[80:83], a[224:227], v[160:163], 0
    s_add_u32 s75, s39, 13631488
    s_getreg_b32 s96, hwreg(HW_REG_XCC_ID, 0, 4)
    v_mfma_f32_16x16x32_bf16 v[84:87], a[228:231], v[160:163], 0
    s_and_b32 s38, s2, 31
    s_lshl_b32 s38, s38, 10
    v_mfma_f32_16x16x32_bf16 v[88:91], a[248:251], v[164:167], 0
    s_add_u32 s51, s38, 22364160
    s_and_b32 s38, s2, 0xe0
    v_mfma_f32_16x16x32_bf16 v[92:95], a[252:255], v[164:167], 0
    s_lshl2_add_u32 s70, s38, s51
    v_pk_add_f32 v[32:33], v[64:65], v[72:73]
    v_pk_add_f32 v[40:41], v[64:65], v[72:73] neg_lo:[0,1] neg_hi:[0,1]
    v_pk_add_f32 v[34:35], v[66:67], v[74:75]
    v_pk_add_f32 v[42:43], v[66:67], v[74:75] neg_lo:[0,1] neg_hi:[0,1]
    v_pk_add_f32 v[36:37], v[68:69], v[76:77]
    v_pk_add_f32 v[44:45], v[68:69], v[76:77] neg_lo:[0,1] neg_hi:[0,1]
    v_pk_add_f32 v[38:39], v[70:71], v[78:79]
    v_pk_add_f32 v[46:47], v[70:71], v[78:79] neg_lo:[0,1] neg_hi:[0,1]
    v_pk_add_f32 v[48:49], v[80:81], v[88:89]
    v_pk_add_f32 v[56:57], v[80:81], v[88:89] neg_lo:[0,1] neg_hi:[0,1]
    v_pk_add_f32 v[50:51], v[82:83], v[90:91]
    v_pk_add_f32 v[58:59], v[82:83], v[90:91] neg_lo:[0,1] neg_hi:[0,1]
    v_pk_add_f32 v[52:53], v[84:85], v[92:93]
    v_pk_add_f32 v[60:61], v[84:85], v[92:93] neg_lo:[0,1] neg_hi:[0,1]
    v_pk_add_f32 v[54:55], v[86:87], v[94:95]
    v_pk_add_f32 v[62:63], v[86:87], v[94:95] neg_lo:[0,1] neg_hi:[0,1]
    v_cvt_pk_bf16_f32 v168, v32, v36
    v_cvt_pk_bf16_f32 v169, v48, v52
    ds_write_b64 v252, v[168:169] offset:0
    v_cvt_pk_bf16_f32 v170, v33, v37
    v_cvt_pk_bf16_f32 v171, v49, v53
    ds_write_b64 v252, v[170:171] offset:128
    v_cvt_pk_bf16_f32 v172, v34, v38
    v_cvt_pk_bf16_f32 v173, v50, v54
    ds_write_b64 v252, v[172:173] offset:256
    v_cvt_pk_bf16_f32 v174, v35, v39
    v_cvt_pk_bf16_f32 v175, v51, v55
    ds_write_b64 v252, v[174:175] offset:384
    v_cvt_pk_bf16_f32 v176, v40, -v44
    v_cvt_pk_bf16_f32 v177, v56, -v60
    ds_write_b64 v253, v[176:177] offset:384
    v_cvt_pk_bf16_f32 v178, v41, -v45
    v_cvt_pk_bf16_f32 v179, v57, -v61
    ds_write_b64 v253, v[178:179] offset:256
    v_cvt_pk_bf16_f32 v180, v42, -v46
    v_cvt_pk_bf16_f32 v181, v58, -v62
    ds_write_b64 v253, v[180:181] offset:128
    v_cvt_pk_bf16_f32 v182, v43, -v47
    v_cvt_pk_bf16_f32 v183, v59, -v63
    ds_write_b64 v253, v[182:183] offset:0
    v_lshlrev_b32_e64 v64, 16, v96
    v_and_b32 v68, 0xffff0000, v96
    v_lshlrev_b32_e64 v65, 16, v97
    v_and_b32 v69, 0xffff0000, v97
    v_lshlrev_b32_e64 v66, 16, v98
    v_and_b32 v70, 0xffff0000, v98
    v_lshlrev_b32_e64 v67, 16, v99
    v_and_b32 v71, 0xffff0000, v99
    v_lshlrev_b32_e64 v72, 16, v100
    v_and_b32 v76, 0xffff0000, v100
    v_lshlrev_b32_e64 v73, 16, v101
    v_and_b32 v77, 0xffff0000, v101
    v_lshlrev_b32_e64 v74, 16, v102
    v_and_b32 v78, 0xffff0000, v102
    v_lshlrev_b32_e64 v75, 16, v103
    v_and_b32 v79, 0xffff0000, v103
    v_lshlrev_b32_e64 v80, 16, v104
    v_and_b32 v84, 0xffff0000, v104
    v_lshlrev_b32_e64 v81, 16, v105
    v_and_b32 v85, 0xffff0000, v105
    v_lshlrev_b32_e64 v82, 16, v106
    v_and_b32 v86, 0xffff0000, v106
    v_lshlrev_b32_e64 v83, 16, v107
    v_and_b32 v87, 0xffff0000, v107
    v_lshlrev_b32_e64 v88, 16, v108
    v_and_b32 v92, 0xffff0000, v108
    v_lshlrev_b32_e64 v89, 16, v109
    v_and_b32 v93, 0xffff0000, v109
    v_lshlrev_b32_e64 v90, 16, v110
    v_and_b32 v94, 0xffff0000, v110
    v_lshlrev_b32_e64 v91, 16, v111
    v_and_b32 v95, 0xffff0000, v111
    s_waitcnt lgkmcnt(0) vmcnt(12)
    s_barrier
    ds_read_b64 v[112:113], v254 offset:0
    ds_read_b64 v[114:115], v254 offset:128
    ds_read_b64 v[116:117], v254 offset:256
    ds_read_b64 v[118:119], v254 offset:384
    ds_read_b64 v[120:121], v254 offset:2048
    ds_read_b64 v[122:123], v254 offset:2176
    ds_read_b64 v[124:125], v254 offset:2304
    ds_read_b64 v[126:127], v254 offset:2432
    ds_read_b64 v[232:233], v228 offset:0
    ds_read_b64 v[234:235], v228 offset:2080
    ds_read_b64 v[236:237], v229 offset:512
    ds_read_b64 v[238:239], v229 offset:2592
    ds_read_b64 v[240:241], v229 offset:1024
    ds_read_b64 v[242:243], v229 offset:3104
    ds_read_b64 v[244:245], v229 offset:1536
    ds_read_b64 v[246:247], v229 offset:3616
    s_mul_i32 s35, s62, 2654435761
    s_add_u32 s35, s35, 2135587861
    s_cmp_eq_u32 s34, 0
    s_cselect_b32 s98, s35, 0
    s_cselect_b32 s99, 0, 2.0
    s_waitcnt lgkmcnt(12)
    s_add_u32 m0, s37, 0
    s_nop 0
    buffer_load_dwordx4 v16, s[8:11], s36 offen offset:0 lds
    buffer_load_dwordx4 v17, s[8:11], s36 offen offset:1024 lds
    buffer_load_dwordx4 v18, s[8:11], s36 offen offset:2048 lds
    buffer_load_dwordx4 v19, s[8:11], s36 offen offset:3072 lds
    v_dot2_f32_bf16 v184, v96, v112, 0
    v_dot2_f32_bf16 v185, v104, v112, 0
    v_dot2_f32_bf16 v184, v100, v113, v184
    v_dot2_f32_bf16 v185, v108, v113, v185
    v_dot2_f32_bf16 v184, v97, v114, v184
    v_dot2_f32_bf16 v185, v105, v114, v185
    v_dot2_f32_bf16 v184, v101, v115, v184
    v_dot2_f32_bf16 v185, v109, v115, v185
    v_dot2_f32_bf16 v184, v98, v116, v184
    v_dot2_f32_bf16 v185, v106, v116, v185
    v_dot2_f32_bf16 v184, v102, v117, v184
    v_dot2_f32_bf16 v185, v110, v117, v185
    v_dot2_f32_bf16 v184, v99, v118, v184
    v_dot2_f32_bf16 v185, v107, v118, v185
    v_dot2_f32_bf16 v184, v103, v119, v184
    v_dot2_f32_bf16 v185, v111, v119, v185
    s_waitcnt lgkmcnt(8)
    v_lshlrev_b32 v32, 16, v120
    v_and_b32 v36, 0xffff0000, v120
    v_add_f32_dpp v184, v184, v184 row_ror:8 row_mask:0xf bank_mask:0xf
    v_add_f32_dpp v185, v185, v185 row_ror:8 row_mask:0xf bank_mask:0xf
    v_lshlrev_b32_e64 v40, 16, v121
    v_add_f32_dpp v184, v184, v184 row_ror:4 row_mask:0xf bank_mask:0xf
    v_and_b32 v44, 0xffff0000, v121
    v_add_f32_dpp v185, v185, v185 row_ror:4 row_mask:0xf bank_mask:0xf
    v_lshlrev_b32_e64 v33, 16, v122
    v_add_f32_dpp v184, v184, v184 row_ror:2 row_mask:0xf bank_mask:0xf
    v_and_b32 v37, 0xffff0000, v122
    v_add_f32_dpp v185, v185, v185 row_ror:2 row_mask:0xf bank_mask:0xf
    v_lshlrev_b32_e64 v41, 16, v123
    v_add_f32_dpp v184, v184, v184 row_ror:1 row_mask:0xf bank_mask:0xf
    v_and_b32 v45, 0xffff0000, v123
    v_add_f32_dpp v185, v185, v185 row_ror:1 row_mask:0xf bank_mask:0xf
    v_lshlrev_b32 v34, 16, v124
    s_nop 0
    v_permlane32_swap_b32 v184, v185
    v_and_b32 v38, 0xffff0000, v124
    v_add_f32 v184, v184, v185
    v_lshlrev_b32 v42, 16, v125
    v_mov_b32 v185, v184
    v_and_b32 v46, 0xffff0000, v125
    s_nop 0
    v_permlane16_swap_b32 v184, v185
    v_lshlrev_b32 v35, 16, v126
    v_add_f32 v184, v184, v185
    v_and_b32 v39, 0xffff0000, v126
    v_cvt_pk_bf16_f32 v184, v184, v184
    v_lshlrev_b32 v43, 16, v127
    v_lshlrev_b32 v184, 16, v184
    v_and_b32 v47, 0xffff0000, v127
    v_mul_f32 v184, 0xbfb8aa3b, v184
    v_pk_mul_f32 v[64:65], v[64:65], v[32:33]
    v_exp_f32 v184, v184
    s_nop 0
    v_add_f32_e64 v184, 1.0, v184
    v_pk_mul_f32 v[66:67], v[66:67], v[34:35]
    v_rcp_f32_e64 v184, v184
    s_bfe_u32 s36, s66, 262148
    s_add_u32 m0, s37, 32768
    s_lshl_b32 s36, s36, 7
    s_nop 0
    buffer_load_dwordx4 v16, s[8:11], s36 offen offset:0 lds
    buffer_load_dwordx4 v17, s[8:11], s36 offen offset:1024 lds
    buffer_load_dwordx4 v18, s[8:11], s36 offen offset:2048 lds
    buffer_load_dwordx4 v19, s[8:11], s36 offen offset:3072 lds
    v_pk_mul_f32 v[68:69], v[68:69], v[36:37]
    v_cvt_pk_bf16_f32 v184, v184, v184
    v_pk_mul_f32 v[70:71], v[70:71], v[38:39]
    v_lshlrev_b32_e64 v184, 16, v184
    v_pk_mul_f32 v[72:73], v[72:73], v[40:41]
    v_sub_f32_e64 v252, 1.0, v184
    v_pk_mul_f32 v[74:75], v[74:75], v[42:43]
    v_cvt_pk_bf16_f32 v252, v252, v252
    v_pk_mul_f32 v[76:77], v[76:77], v[44:45]
    v_lshlrev_b32_e64 v252, 16, v252
    v_pk_mul_f32 v[78:79], v[78:79], v[46:47]
    v_mov_b32_e64 v185, v184
    v_pk_mul_f32 v[80:81], v[80:81], v[32:33]
    v_mov_b32_e64 v253, v252
    v_pk_mul_f32 v[82:83], v[82:83], v[34:35]
    v_permlane32_swap_b32 v184, v185
    v_pk_mul_f32 v[84:85], v[84:85], v[36:37]
    v_permlane32_swap_b32 v252, v253
    v_pk_mul_f32 v[86:87], v[86:87], v[38:39]
    v_cmp_gt_u32_e64 vcc, 8, v0
    v_pk_mul_f32 v[88:89], v[88:89], v[40:41]
    v_lshlrev_b32_e64 v254, 3, v0
    v_pk_mul_f32 v[90:91], v[90:91], v[42:43]
    v_accvgpr_write_b32 a168, v184
    v_pk_mul_f32 v[92:93], v[92:93], v[44:45]
    v_accvgpr_write_b32 a169, v185
    v_pk_mul_f32 v[94:95], v[94:95], v[46:47]
    v_cndmask_b32_e64 v254, 2.0, v254, vcc
    v_pk_mul_f32 v[64:65], v[64:65], v[252:253] op_sel_hi:[1,0]
    v_pk_mul_f32 v[66:67], v[66:67], v[252:253] op_sel_hi:[1,0]
    v_pk_mul_f32 v[68:69], v[68:69], v[252:253] op_sel_hi:[1,0]
    v_pk_mul_f32 v[70:71], v[70:71], v[252:253] op_sel_hi:[1,0]
    v_cvt_pk_bf16_f32 v190, v64, v68
    v_accvgpr_write_b32 a152, v190
    v_cvt_pk_bf16_f32 v191, v65, v69
    v_accvgpr_write_b32 a153, v191
    v_cvt_pk_bf16_f32 v190, v66, v70
    v_accvgpr_write_b32 a154, v190
    v_cvt_pk_bf16_f32 v191, v67, v71
    v_accvgpr_write_b32 a155, v191
    v_pk_mul_f32 v[72:73], v[72:73], v[252:253] op_sel_hi:[1,0]
    v_pk_mul_f32 v[74:75], v[74:75], v[252:253] op_sel_hi:[1,0]
    v_pk_mul_f32 v[76:77], v[76:77], v[252:253] op_sel_hi:[1,0]
    v_pk_mul_f32 v[78:79], v[78:79], v[252:253] op_sel_hi:[1,0]
    v_cvt_pk_bf16_f32 v190, v72, v76
    v_accvgpr_write_b32 a156, v190
    v_cvt_pk_bf16_f32 v191, v73, v77
    v_accvgpr_write_b32 a157, v191
    v_cvt_pk_bf16_f32 v190, v74, v78
    v_accvgpr_write_b32 a158, v190
    v_cvt_pk_bf16_f32 v191, v75, v79
    v_accvgpr_write_b32 a159, v191
    v_pk_mul_f32 v[80:81], v[80:81], v[252:253] op_sel:[0,1]
    v_pk_mul_f32 v[82:83], v[82:83], v[252:253] op_sel:[0,1]
    v_pk_mul_f32 v[84:85], v[84:85], v[252:253] op_sel:[0,1]
    s_add_u32 m0, s37, 49152
    s_nop 0
    s_nop 0
    buffer_load_dwordx4 v20, s[12:15], s36 offen offset:0 lds
    buffer_load_dwordx4 v21, s[12:15], s36 offen offset:1024 lds
    buffer_load_dwordx4 v22, s[12:15], s36 offen offset:2048 lds
    buffer_load_dwordx4 v23, s[12:15], s36 offen offset:3072 lds
    v_pk_mul_f32 v[86:87], v[86:87], v[252:253] op_sel:[0,1]
    v_cvt_pk_bf16_f32 v190, v80, v84
    v_accvgpr_write_b32 a160, v190
    v_cvt_pk_bf16_f32 v191, v81, v85
    v_accvgpr_write_b32 a161, v191
    v_cvt_pk_bf16_f32 v190, v82, v86
    v_accvgpr_write_b32 a162, v190
    v_cvt_pk_bf16_f32 v191, v83, v87
    v_accvgpr_write_b32 a163, v191
    v_pk_mul_f32 v[88:89], v[88:89], v[252:253] op_sel:[0,1]
    v_pk_mul_f32 v[90:91], v[90:91], v[252:253] op_sel:[0,1]
    v_pk_mul_f32 v[92:93], v[92:93], v[252:253] op_sel:[0,1]
    v_pk_mul_f32 v[94:95], v[94:95], v[252:253] op_sel:[0,1]
    v_cvt_pk_bf16_f32 v190, v88, v92
    v_accvgpr_write_b32 a164, v190
    v_cvt_pk_bf16_f32 v191, v89, v93
    v_accvgpr_write_b32 a165, v191
    v_cvt_pk_bf16_f32 v190, v90, v94
    v_accvgpr_write_b32 a166, v190
    v_cvt_pk_bf16_f32 v191, v91, v95
    v_accvgpr_write_b32 a167, v191
    v_cos_f32 v10, v6
    v_cos_f32 v11, v7
    v_sin_f32 v12, v4
    v_sin_f32 v13, v5
    v_sin_f32 v14, v6
    v_sin_f32 v15, v7
    v_cvt_pk_bf16_f32 v4, v8, v12
    v_cvt_pk_bf16_f32 v5, -v12, v8
    v_accvgpr_write_b32 a0, v4
    v_accvgpr_write_b32 a4, v5
    v_xor_b32 v4, v147, v4
    v_xor_b32 v5, v147, v5
    v_accvgpr_write_b32 a16, v4
    v_accvgpr_write_b32 a20, v5
    v_cvt_pk_bf16_f32 v4, v9, v13
    v_cvt_pk_bf16_f32 v5, -v13, v9
    v_accvgpr_write_b32 a1, v4
    v_accvgpr_write_b32 a5, v5
    v_xor_b32 v4, v147, v4
    v_xor_b32 v5, v147, v5
    v_accvgpr_write_b32 a17, v4
    v_accvgpr_write_b32 a21, v5
    v_cvt_pk_bf16_f32 v4, v10, v14
    v_cvt_pk_bf16_f32 v5, -v14, v10
    v_accvgpr_write_b32 a2, v4
    v_accvgpr_write_b32 a6, v5
    v_xor_b32 v4, v147, v4
    v_xor_b32 v5, v147, v5
    v_accvgpr_write_b32 a18, v4
    v_accvgpr_write_b32 a22, v5
    v_cvt_pk_bf16_f32 v4, v11, v15
    s_lshl2_add_u32 s3, s33, s34
    s_lshl_b32 s3, s3, 4
    v_add_lshl_u32 v145, v1, s3, 1
    s_nop 0
    global_load_ushort v142, v145, s[52:53]
    global_load_ushort v143, v145, s[54:55]
    global_load_ushort v144, v145, s[84:85]
    v_cvt_pk_bf16_f32 v5, -v15, v11
    v_accvgpr_write_b32 a3, v4
    v_accvgpr_write_b32 a7, v5
    v_xor_b32 v4, v147, v4
    v_xor_b32_e64 v5, v147, v5
    v_accvgpr_write_b32 a19, v4
    v_accvgpr_write_b32 a23, v5
    v_fmamk_f32 v4, v251, 0x41800000, v248
    v_fmamk_f32 v5, v251, 0x41880000, v248
    v_fmamk_f32 v6, v251, 0x41900000, v248
    v_fmamk_f32 v7, v251, 0x41980000, v248
    v_cos_f32 v8, v4
    v_cos_f32 v9, v5
    v_cos_f32 v10, v6
    v_cos_f32 v11, v7
    v_sin_f32 v12, v4
    v_sin_f32 v13, v5
    v_sin_f32 v14, v6
    v_sin_f32 v15, v7
    v_cvt_pk_bf16_f32 v4, v8, v12
    v_cvt_pk_bf16_f32 v5, -v12, v8
    v_accvgpr_write_b32 a8, v4
    v_accvgpr_write_b32 a12, v5
    v_xor_b32 v4, v147, v4
    v_xor_b32 v5, v147, v5
    v_accvgpr_write_b32 a24, v4
    v_accvgpr_write_b32 a28, v5
    v_cvt_pk_bf16_f32 v4, v9, v13
    v_cvt_pk_bf16_f32 v5, -v13, v9
    v_accvgpr_write_b32 a9, v4
    v_accvgpr_write_b32 a13, v5
    v_xor_b32_e64 v4, v147, v4
    s_bfe_u32 s36, s66, 262152
    s_add_u32 m0, s37, 65536
    s_lshl_b32 s36, s36, 7
    buffer_load_dwordx4 v16, s[8:11], s36 offen offset:0 lds
    buffer_load_dwordx4 v17, s[8:11], s36 offen offset:1024 lds
    buffer_load_dwordx4 v18, s[8:11], s36 offen offset:2048 lds
    buffer_load_dwordx4 v19, s[8:11], s36 offen offset:3072 lds
    v_xor_b32 v5, v147, v5
    v_accvgpr_write_b32 a25, v4
    v_accvgpr_write_b32 a29, v5
    v_cvt_pk_bf16_f32 v4, v10, v14
    v_cvt_pk_bf16_f32 v5, -v14, v10
    v_accvgpr_write_b32 a10, v4
    v_accvgpr_write_b32 a14, v5
    v_xor_b32 v4, v147, v4
    v_xor_b32 v5, v147, v5
    v_accvgpr_write_b32 a26, v4
    v_accvgpr_write_b32 a30, v5
    v_cvt_pk_bf16_f32 v4, v11, v15
    v_cvt_pk_bf16_f32 v5, -v15, v11
    v_accvgpr_write_b32 a11, v4
    v_accvgpr_write_b32 a15, v5
    v_xor_b32 v4, v147, v4
    v_xor_b32 v5, v147, v5
    v_accvgpr_write_b32 a27, v4
    v_accvgpr_write_b32 a31, v5
    s_add_u32 m0, s37, 81920
    s_nop 0
    buffer_load_dwordx4 v20, s[12:15], s36 offen offset:0 lds
    buffer_load_dwordx4 v21, s[12:15], s36 offen offset:1024 lds
    buffer_load_dwordx4 v22, s[12:15], s36 offen offset:2048 lds
    buffer_load_dwordx4 v23, s[12:15], s36 offen offset:3072 lds
    s_waitcnt lgkmcnt(0) vmcnt(19)
    s_barrier
    s_nop 0
    ds_read_b128 a[64:67], v26 offset:0
    ds_read_b128 a[68:71], v26 offset:8192
    ds_read_b128 a[32:35], v24 offset:0
    ds_read_b128 a[36:39], v24 offset:2048
    ds_read_b128 a[40:43], v24 offset:4096
    ds_read_b128 a[44:47], v24 offset:6144
    ds_read_b128 a[48:51], v24 offset:8192
    ds_read_b128 a[52:55], v24 offset:10240
    ds_read_b128 a[56:59], v24 offset:12288
    ds_read_b128 a[60:63], v24 offset:14336
    s_bfe_u32 s36, s66, 262156
    s_add_u32 m0, s37, 98304
    s_lshl_b32 s36, s36, 7
    buffer_load_dwordx4 v16, s[8:11], s36 offen offset:0 lds
    buffer_load_dwordx4 v17, s[8:11], s36 offen offset:1024 lds
    buffer_load_dwordx4 v18, s[8:11], s36 offen offset:2048 lds
    s_waitcnt lgkmcnt(0)
    v_mfma_f32_16x16x32_bf16 v[32:35], a[32:35], a[64:67], 0
    ds_read_b128 a[104:107], v27 offset:0
    buffer_load_dwordx4 v19, s[8:11], s36 offen offset:3072 lds
    v_mfma_f32_16x16x32_bf16 v[36:39], a[32:35], a[68:71], 0
    ds_read_b128 a[108:111], v27 offset:8192
    v_mfma_f32_16x16x32_bf16 v[40:43], a[36:39], a[64:67], 0
    ds_read_b128 a[72:75], v25 offset:0
    s_add_u32 m0, s37, 114688
    v_mfma_f32_16x16x32_bf16 v[44:47], a[36:39], a[68:71], 0
    ds_read_b128 a[76:79], v25 offset:2048
    v_mfma_f32_16x16x32_bf16 v[48:51], a[40:43], a[64:67], 0
    ds_read_b128 a[80:83], v25 offset:4096
    v_mfma_f32_16x16x32_bf16 v[52:55], a[40:43], a[68:71], 0
    ds_read_b128 a[84:87], v25 offset:6144
    buffer_load_dwordx4 v20, s[12:15], s36 offen offset:0 lds
    v_mfma_f32_16x16x32_bf16 v[56:59], a[44:47], a[64:67], 0
    ds_read_b128 a[88:91], v25 offset:8192
    v_mov_b32_e64 v28, s96
    v_mfma_f32_16x16x32_bf16 v[60:63], a[44:47], a[68:71], 0
    ds_read_b128 a[92:95], v25 offset:10240
    buffer_store_dword v28, v30, s[24:27], s70 offen sc1
    v_mfma_f32_16x16x32_bf16 v[64:67], a[48:51], a[64:67], 0
    ds_read_b128 a[96:99], v25 offset:12288
    buffer_load_dwordx4 v21, s[12:15], s36 offen offset:1024 lds
    buffer_store_dwordx2 v[252:253], v254, s[24:27], s69 offen sc1
    v_mfma_f32_16x16x32_bf16 v[68:71], a[48:51], a[68:71], 0
    ds_read_b128 a[100:103], v25 offset:14336
    v_mfma_f32_16x16x32_bf16 v[72:75], a[52:55], a[64:67], 0
    buffer_load_dwordx4 v22, s[12:15], s36 offen offset:2048 lds
    v_mfma_f32_16x16x32_bf16 v[76:79], a[52:55], a[68:71], 0
    v_mfma_f32_16x16x32_bf16 v[80:83], a[56:59], a[64:67], 0
    v_mfma_f32_16x16x32_bf16 v[84:87], a[56:59], a[68:71], 0
    buffer_load_dwordx4 v23, s[12:15], s36 offen offset:3072 lds
    v_mfma_f32_16x16x32_bf16 v[88:91], a[60:63], a[64:67], 0
    v_mfma_f32_16x16x32_bf16 v[92:95], a[60:63], a[68:71], 0
    s_waitcnt lgkmcnt(0) vmcnt(21)
    s_barrier
    v_mfma_f32_16x16x32_bf16 v[32:35], a[72:75], a[104:107], v[32:35]
    ds_read_b128 a[64:67], v26 offset:32768
    s_bfe_u32 s36, s66, 262160
    s_mov_b32 s76, 0x05040100
    v_mfma_f32_16x16x32_bf16 v[36:39], a[72:75], a[108:111], v[36:39]
    ds_read_b128 a[68:71], v26 offset:40960
    s_mov_b32 s77, 0x07060302
    s_lshl_b32 s38, s6, 4
    v_mfma_f32_16x16x32_bf16 v[40:43], a[76:79], a[104:107], v[40:43]
    ds_read_b128 a[32:35], v24 offset:32768
    s_add_u32 m0, s37, 0
    s_xor_b32 s39, s38, 16
    v_alignbit_b32 v196, v197, v196, s38
    v_mfma_f32_16x16x32_bf16 v[44:47], a[76:79], a[108:111], v[44:47]
    ds_read_b128 a[36:39], v24 offset:34816
    v_alignbit_b32 v197, v198, v197, s38
    v_mfma_f32_16x16x32_bf16 v[48:51], a[80:83], a[104:107], v[48:51]
    ds_read_b128 a[40:43], v24 offset:36864
    v_lshrrev_b32 v198, s38, v198
    v_alignbit_b32 v200, v201, v200, s38
    v_mfma_f32_16x16x32_bf16 v[52:55], a[80:83], a[108:111], v[52:55]
    ds_read_b128 a[44:47], v24 offset:38912
    s_lshl_b32 s36, s36, 7
    v_alignbit_b32 v201, v202, v201, s38
    v_lshrrev_b32 v202, s38, v202
    v_mfma_f32_16x16x32_bf16 v[56:59], a[84:87], a[104:107], v[56:59]
    ds_read_b128 a[48:51], v24 offset:40960
    v_alignbit_b32 v204, v205, v204, s39
    v_alignbit_b32 v205, v206, v205, s39
    buffer_store_dwordx4 v[232:235], v230, s[28:31], s68 offen sc1
    v_mfma_f32_16x16x32_bf16 v[60:63], a[84:87], a[108:111], v[60:63]
    ds_read_b128 a[52:55], v24 offset:43008
    v_alignbit_b32 v208, v209, v208, s39
    v_mfma_f32_16x16x32_bf16 v[64:67], a[88:91], a[104:107], v[64:67]
    ds_read_b128 a[56:59], v24 offset:45056
    buffer_load_dwordx4 v16, s[8:11], s36 offen offset:0 lds
    v_alignbit_b32 v209, v210, v209, s39
    v_alignbit_b32 v212, v213, v212, s38
    s_add_u32 s68, s68, 2097152
    v_mfma_f32_16x16x32_bf16 v[68:71], a[88:91], a[108:111], v[68:71]
    ds_read_b128 a[60:63], v24 offset:47104
    v_alignbit_b32 v213, v214, v213, s38
    v_lshrrev_b32_e64 v214, s38, v214
    v_mfma_f32_16x16x32_bf16 v[72:75], a[92:95], a[104:107], v[72:75]
    buffer_load_dwordx4 v17, s[8:11], s36 offen offset:1024 lds
    v_alignbit_b32 v216, v217, v216, s38
    v_alignbit_b32 v217, v218, v217, s38
    v_mfma_f32_16x16x32_bf16 v[76:79], a[92:95], a[108:111], v[76:79]
    v_lshrrev_b32_e64 v218, s38, v218
    v_mfma_f32_16x16x32_bf16 v[80:83], a[96:99], a[104:107], v[80:83]
    v_alignbit_b32 v220, v221, v220, s39
    v_alignbit_b32 v221, v222, v221, s39
    v_mfma_f32_16x16x32_bf16 v[84:87], a[96:99], a[108:111], v[84:87]
    buffer_load_dwordx4 v18, s[8:11], s36 offen offset:2048 lds
    v_alignbit_b32 v224, v225, v224, s39
    v_alignbit_b32 v225, v226, v225, s39
    v_mfma_f32_16x16x32_bf16 v[88:91], a[100:103], a[104:107], v[88:91]
    v_perm_b32 v184, v202, v198, s76
    v_perm_b32 v186, v218, v214, s76
    v_mfma_f32_16x16x32_bf16 v[92:95], a[100:103], a[108:111], v[92:95]
    ds_write_b128 v194, v[184:187] offset:16384
    s_waitcnt lgkmcnt(1)
    v_mfma_f32_16x16x32_bf16 v[32:35], a[32:35], a[64:67], v[32:35]
    ds_read_b128 a[104:107], v27 offset:32768
    buffer_load_dwordx4 v19, s[8:11], s36 offen offset:3072 lds
    v_perm_b32 v152, v200, v196, s76
    v_perm_b32 v153, v209, v205, s77
    v_mfma_f32_16x16x32_bf16 v[36:39], a[32:35], a[68:71], v[36:39]
    ds_read_b128 a[108:111], v27 offset:40960
    v_perm_b32 v154, v216, v212, s76
    v_perm_b32 v155, v225, v221, s77
    v_mfma_f32_16x16x32_bf16 v[40:43], a[36:39], a[64:67], v[40:43]
    ds_read_b128 a[72:75], v25 offset:32768
    s_add_u32 m0, s37, 16384
    ds_write_b128 v194, v[152:155] offset:0
    v_perm_b32 v156, v200, v196, s77
    v_mfma_f32_16x16x32_bf16 v[44:47], a[36:39], a[68:71], v[44:47]
    ds_read_b128 a[76:79], v25 offset:34816
    v_perm_b32 v157, v209, v205, s76
    v_perm_b32 v158, v216, v212, s77
    v_mfma_f32_16x16x32_bf16 v[48:51], a[40:43], a[64:67], v[48:51]
    ds_read_b128 a[80:83], v25 offset:36864
    v_perm_b32 v159, v225, v221, s76
    ds_write_b128 v194, v[156:159] offset:4096
    v_mfma_f32_16x16x32_bf16 v[52:55], a[40:43], a[68:71], v[52:55]
    ds_read_b128 a[84:87], v25 offset:38912
    buffer_load_dwordx4 v20, s[12:15], s36 offen offset:0 lds
    v_perm_b32 v160, v201, v197, s76
    v_mfma_f32_16x16x32_bf16 v[56:59], a[44:47], a[64:67], v[56:59]
    ds_read_b128 a[88:91], v25 offset:40960
    v_perm_b32 v161, v208, v204, s77
    v_perm_b32 v162, v217, v213, s76
    buffer_store_dwordx4 v[236:239], v230, s[28:31], s68 offen sc1
    v_mfma_f32_16x16x32_bf16 v[60:63], a[44:47], a[68:71], v[60:63]
    ds_read_b128 a[92:95], v25 offset:43008
    v_perm_b32 v163, v224, v220, s77
    ds_write_b128 v194, v[160:163] offset:8192
    v_mfma_f32_16x16x32_bf16 v[64:67], a[48:51], a[64:67], v[64:67]
    ds_read_b128 a[96:99], v25 offset:45056
    buffer_load_dwordx4 v21, s[12:15], s36 offen offset:1024 lds
    v_perm_b32 v164, v201, v197, s77
    v_perm_b32 v165, v208, v204, s76
    s_add_u32 s68, s68, 2097152
    v_mfma_f32_16x16x32_bf16 v[68:71], a[48:51], a[68:71], v[68:71]
    ds_read_b128 a[100:103], v25 offset:47104
    v_perm_b32 v166, v217, v213, s77
    v_perm_b32 v167, v224, v220, s76
    v_mfma_f32_16x16x32_bf16 v[72:75], a[52:55], a[64:67], v[72:75]
    buffer_load_dwordx4 v22, s[12:15], s36 offen offset:2048 lds
    ds_write_b128 v194, v[164:167] offset:12288
    v_mfma_f32_16x16x32_bf16 v[76:79], a[52:55], a[68:71], v[76:79]
    v_bfe_u32 v189, v0, 2, 2
    v_lshl_add_u32 v228, v189, 8, v231
    v_mfma_f32_16x16x32_bf16 v[80:83], a[56:59], a[64:67], v[80:83]
    v_lshl_add_u32 v189, v189, 12, v195
    v_xor_b32 v190, 0x1000, v189
    v_mfma_f32_16x16x32_bf16 v[84:87], a[56:59], a[68:71], v[84:87]
    buffer_load_dwordx4 v23, s[12:15], s36 offen offset:3072 lds
    v_xor_b32 v191, 0x2000, v189
    v_xor_b32 v192, 0x3000, v189
    v_mfma_f32_16x16x32_bf16 v[88:91], a[60:63], a[64:67], v[88:91]
    v_xor_b32 v229, 0x100, v228
    v_xor_b32 v231, 0x200, v228
    v_mfma_f32_16x16x32_bf16 v[92:95], a[60:63], a[68:71], v[92:95]
    v_xor_b32 v193, 0x300, v228
    s_waitcnt lgkmcnt(0) vmcnt(20)
    s_barrier
    v_mfma_f32_16x16x32_bf16 v[32:35], a[72:75], a[104:107], v[32:35]
    ds_read_b128 a[64:67], v150 offset:0
    s_bfe_u32 s36, s66, 262164
    ds_read_b128 v[184:187], v195 offset:16384
    ds_read_b128 v[168:171], v189
    v_mfma_f32_16x16x32_bf16 v[36:39], a[72:75], a[108:111], v[36:39]
    ds_read_b128 a[68:71], v150 offset:8192
    ds_read_b128 v[172:175], v190
    v_mfma_f32_16x16x32_bf16 v[40:43], a[76:79], a[104:107], v[40:43]
    ds_read_b128 a[32:35], v148 offset:0
    s_add_u32 m0, s37, 32768
    ds_read_b128 v[176:179], v191
    v_mfma_f32_16x16x32_bf16 v[44:47], a[76:79], a[108:111], v[44:47]
    ds_read_b128 a[36:39], v148 offset:2048
    ds_read_b128 v[180:183], v192
    v_mfma_f32_16x16x32_bf16 v[48:51], a[80:83], a[104:107], v[48:51]
    ds_read_b128 a[40:43], v148 offset:4096
    s_lshr_b32 s40, s2, 2
    v_mfma_f32_16x16x32_bf16 v[52:55], a[80:83], a[108:111], v[52:55]
    ds_read_b128 a[44:47], v148 offset:6144
    s_lshl_b32 s36, s36, 7
    s_lshl_b32 s41, s34, 9
    v_mfma_f32_16x16x32_bf16 v[56:59], a[84:87], a[104:107], v[56:59]
    ds_read_b128 a[48:51], v148 offset:8192
    s_add_u32 s40, s40, s41
    v_mfma_f32_16x16x32_bf16 v[60:63], a[84:87], a[108:111], v[60:63]
    ds_read_b128 a[52:55], v148 offset:10240
    s_add_u32 s40, s40, 64
    v_mfma_f32_16x16x32_bf16 v[64:67], a[88:91], a[104:107], v[64:67]
    ds_read_b128 a[56:59], v148 offset:12288
    buffer_load_dwordx4 v16, s[8:11], s36 offen offset:0 lds
    s_lshl_b32 s40, s40, 6
    s_and_b32 s41, s2, 3
    v_mfma_f32_16x16x32_bf16 v[68:71], a[88:91], a[108:111], v[68:71]
    ds_read_b128 a[60:63], v148 offset:14336
    s_add_u32 s40, s40, s41
    v_mfma_f32_16x16x32_bf16 v[72:75], a[92:95], a[104:107], v[72:75]
    buffer_load_dwordx4 v17, s[8:11], s36 offen offset:1024 lds
    s_lshl_b32 s76, s40, 6
    v_mfma_f32_16x16x32_bf16 v[76:79], a[92:95], a[108:111], v[76:79]
    s_lshl_b32 s40, s34, 10
    v_mfma_f32_16x16x32_bf16 v[80:83], a[96:99], a[104:107], v[80:83]
    v_add_u32 v188, s40, v3
    v_mfma_f32_16x16x32_bf16 v[84:87], a[96:99], a[108:111], v[84:87]
    buffer_load_dwordx4 v18, s[8:11], s36 offen offset:2048 lds
    v_subrev_u32 v188, 4032, v188
    v_mfma_f32_16x16x32_bf16 v[88:91], a[100:103], a[104:107], v[88:91]
    v_min_u32_e64 v188, 2.0, v188
    v_mfma_f32_16x16x32_bf16 v[92:95], a[100:103], a[108:111], v[92:95]
    s_lshl_b32 s77, s2, 6
    s_waitcnt lgkmcnt(0)
    v_mfma_f32_16x16x32_bf16 v[32:35], a[32:35], a[64:67], v[32:35]
    ds_read_b128 a[104:107], v151 offset:0
    buffer_load_dwordx4 v19, s[8:11], s36 offen offset:3072 lds
    s_and_b32 s38, s32, 3
    v_mfma_f32_16x16x32_bf16 v[36:39], a[32:35], a[68:71], v[36:39]
    ds_read_b128 a[108:111], v151 offset:8192
    s_mov_b32 s97, 1985229328
    v_mfma_f32_16x16x32_bf16 v[40:43], a[36:39], a[64:67], v[40:43]
    ds_read_b128 a[72:75], v149 offset:0
    s_add_u32 m0, s37, 49152
    s_cmp_eq_u32 s38, 1
    s_cselect_b32 s97, 561402928, s97
    v_mfma_f32_16x16x32_bf16 v[44:47], a[36:39], a[68:71], v[44:47]
    ds_read_b128 a[76:79], v149 offset:2048
    v_mfma_f32_16x16x32_bf16 v[48:51], a[40:43], a[64:67], v[48:51]
    ds_read_b128 a[80:83], v149 offset:4096
    s_cmp_eq_u32 s38, 2
    s_cselect_b32 s97, 1126266448, s97
    v_mfma_f32_16x16x32_bf16 v[52:55], a[40:43], a[68:71], v[52:55]
    ds_read_b128 a[84:87], v149 offset:6144
    buffer_load_dwordx4 v20, s[12:15], s36 offen offset:0 lds
    s_cmp_eq_u32 s38, 3
    s_cselect_b32 s97, 1698898288, s97
    v_mfma_f32_16x16x32_bf16 v[56:59], a[44:47], a[64:67], v[56:59]
    ds_read_b128 a[88:91], v149 offset:8192
    buffer_store_dwordx4 v[240:243], v230, s[28:31], s68 offen sc1
    v_mfma_f32_16x16x32_bf16 v[60:63], a[44:47], a[68:71], v[60:63]
    ds_read_b128 a[92:95], v149 offset:10240
    s_lshr_b32 s38, s2, 5
    v_mfma_f32_16x16x32_bf16 v[64:67], a[48:51], a[64:67], v[64:67]
    ds_read_b128 a[96:99], v149 offset:12288
    buffer_load_dwordx4 v21, s[12:15], s36 offen offset:1024 lds
    s_mul_i32 s38, s38, 0x11111111
    s_add_u32 s68, s68, 2097152
    v_mfma_f32_16x16x32_bf16 v[68:71], a[48:51], a[68:71], v[68:71]
    ds_read_b128 a[100:103], v149 offset:14336
    v_mfma_f32_16x16x32_bf16 v[72:75], a[52:55], a[64:67], v[72:75]
    buffer_load_dwordx4 v22, s[12:15], s36 offen offset:2048 lds
    s_add_u32 s97, s97, s38
    v_mfma_f32_16x16x32_bf16 v[76:79], a[52:55], a[68:71], v[76:79]
    s_and_b32 s97, s97, 0x77777777
    v_mfma_f32_16x16x32_bf16 v[80:83], a[56:59], a[64:67], v[80:83]
    v_mfma_f32_16x16x32_bf16 v[84:87], a[56:59], a[68:71], v[84:87]
    buffer_load_dwordx4 v23, s[12:15], s36 offen offset:3072 lds
    s_lshl_b32 s38, s33, 6
    v_mfma_f32_16x16x32_bf16 v[88:91], a[60:63], a[64:67], v[88:91]
    s_add_u32 s38, s38, s34
    v_mfma_f32_16x16x32_bf16 v[92:95], a[60:63], a[68:71], v[92:95]
    s_waitcnt lgkmcnt(0) vmcnt(19)
    s_barrier
    v_mfma_f32_16x16x32_bf16 v[32:35], a[72:75], a[104:107], v[32:35]
    ds_read_b128 a[64:67], v150 offset:32768
    s_bfe_u32 s36, s66, 262168
    s_lshl_b32 s38, s38, 8
    v_mfma_f32_16x16x32_bf16 v[36:39], a[72:75], a[108:111], v[36:39]
    ds_read_b128 a[68:71], v150 offset:40960
    s_add_u32 s93, s38, 22020096
    v_mfma_f32_16x16x32_bf16 v[40:43], a[76:79], a[104:107], v[40:43]
    ds_read_b128 a[32:35], v148 offset:32768
    s_add_u32 m0, s37, 65536
    s_lshl_b32 s38, s32, 11
    v_mfma_f32_16x16x32_bf16 v[44:47], a[76:79], a[108:111], v[44:47]
    ds_read_b128 a[36:39], v148 offset:34816
    v_mfma_f32_16x16x32_bf16 v[48:51], a[80:83], a[104:107], v[48:51]
    ds_read_b128 a[40:43], v148 offset:36864
    s_add_u32 s38, s38, s33
    v_mfma_f32_16x16x32_bf16 v[52:55], a[80:83], a[108:111], v[52:55]
    ds_read_b128 a[44:47], v148 offset:38912
    s_lshl_b32 s36, s36, 7
    s_lshl_b32 s5, s38, 8
    v_mfma_f32_16x16x32_bf16 v[56:59], a[84:87], a[104:107], v[56:59]
    ds_read_b128 a[48:51], v148 offset:40960
    buffer_store_dwordx4 v[244:247], v230, s[28:31], s68 offen sc1
    v_mfma_f32_16x16x32_bf16 v[60:63], a[84:87], a[108:111], v[60:63]
    ds_read_b128 a[52:55], v148 offset:43008
    s_lshl_b32 s38, s94, 16
    v_mfma_f32_16x16x32_bf16 v[64:67], a[88:91], a[104:107], v[64:67]
    ds_read_b128 a[56:59], v148 offset:45056
    buffer_load_dwordx4 v16, s[8:11], s36 offen offset:0 lds
    s_andn2_b32 s95, s5, 0x700
    v_mfma_f32_16x16x32_bf16 v[68:71], a[88:91], a[108:111], v[68:71]
    ds_read_b128 a[60:63], v148 offset:47104
    v_mfma_f32_16x16x32_bf16 v[72:75], a[92:95], a[104:107], v[72:75]
    buffer_load_dwordx4 v17, s[8:11], s36 offen offset:1024 lds
    s_add_u32 s95, s95, s38
    v_mfma_f32_16x16x32_bf16 v[76:79], a[92:95], a[108:111], v[76:79]
    s_cmp_lt_u32 s34, 2
    s_cselect_b64 s[16:17], s[80:81], s[82:83]
    v_mfma_f32_16x16x32_bf16 v[80:83], a[96:99], a[104:107], v[80:83]
    v_mfma_f32_16x16x32_bf16 v[84:87], a[96:99], a[108:111], v[84:87]
    buffer_load_dwordx4 v18, s[8:11], s36 offen offset:2048 lds
    s_mov_b32 s18, 0x200000
    v_mfma_f32_16x16x32_bf16 v[88:91], a[100:103], a[104:107], v[88:91]
    v_mfma_f32_16x16x32_bf16 v[92:95], a[100:103], a[108:111], v[92:95]
    s_waitcnt lgkmcnt(0)
    v_mfma_f32_16x16x32_bf16 v[32:35], a[32:35], a[64:67], v[32:35]
    ds_read_b128 a[104:107], v151 offset:32768
    buffer_load_dwordx4 v19, s[8:11], s36 offen offset:3072 lds
    v_lshlrev_b32_e64 v144, 16, v144
    v_mfma_f32_16x16x32_bf16 v[36:39], a[32:35], a[68:71], v[36:39]
    ds_read_b128 a[108:111], v151 offset:40960
    v_lshlrev_b32_e64 v142, 16, v142
    v_mfma_f32_16x16x32_bf16 v[40:43], a[36:39], a[64:67], v[40:43]
    ds_read_b128 a[72:75], v149 offset:32768
    s_add_u32 m0, s37, 81920
    v_mul_f32 v144, 0x3fb8aa3b, v144
    v_mfma_f32_16x16x32_bf16 v[44:47], a[36:39], a[68:71], v[44:47]
    ds_read_b128 a[76:79], v149 offset:34816
    v_mfma_f32_16x16x32_bf16 v[48:51], a[40:43], a[64:67], v[48:51]
    ds_read_b128 a[80:83], v149 offset:36864
    v_exp_f32_e64 v144, v144
    v_mfma_f32_16x16x32_bf16 v[52:55], a[40:43], a[68:71], v[52:55]
    ds_read_b128 a[84:87], v149 offset:38912
    buffer_load_dwordx4 v20, s[12:15], s36 offen offset:0 lds
    v_lshlrev_b32_e64 v143, 16, v143
    v_mfma_f32_16x16x32_bf16 v[56:59], a[44:47], a[64:67], v[56:59]
    ds_read_b128 a[88:91], v149 offset:40960
    v_mfma_f32_16x16x32_bf16 v[60:63], a[44:47], a[68:71], v[60:63]
    ds_read_b128 a[92:95], v149 offset:43008
    v_cvt_pk_bf16_f32 v144, v144, v144
    v_mfma_f32_16x16x32_bf16 v[64:67], a[48:51], a[64:67], v[64:67]
    ds_read_b128 a[96:99], v149 offset:45056
    buffer_load_dwordx4 v21, s[12:15], s36 offen offset:1024 lds
    v_lshlrev_b32_e64 v144, 16, v144
    buffer_store_dwordx4 v[184:187], v188, s[24:27], s77 offen sc1
    v_mfma_f32_16x16x32_bf16 v[68:71], a[48:51], a[68:71], v[68:71]
    ds_read_b128 a[100:103], v149 offset:47104
    v_mfma_f32_16x16x32_bf16 v[72:75], a[52:55], a[64:67], v[72:75]
    buffer_load_dwordx4 v22, s[12:15], s36 offen offset:2048 lds
    v_mul_f32_e64 v14, v144, v142
    v_mfma_f32_16x16x32_bf16 v[76:79], a[52:55], a[68:71], v[76:79]
    v_mul_f32_e64 v4, v144, v143
    v_mfma_f32_16x16x32_bf16 v[80:83], a[56:59], a[64:67], v[80:83]
    v_mfma_f32_16x16x32_bf16 v[84:87], a[56:59], a[68:71], v[84:87]
    buffer_load_dwordx4 v23, s[12:15], s36 offen offset:3072 lds
    v_mul_f32 v14, 0x3fb8aa3b, v14
    v_mfma_f32_16x16x32_bf16 v[88:91], a[60:63], a[64:67], v[88:91]
    v_mul_f32_e64 v4, 0x3e22f983, v4
    v_mfma_f32_16x16x32_bf16 v[92:95], a[60:63], a[68:71], v[92:95]
    s_waitcnt lgkmcnt(0) vmcnt(19)
    s_barrier
    v_mfma_f32_16x16x32_bf16 v[32:35], a[72:75], a[104:107], v[32:35]
    ds_read_b128 a[64:67], v26 offset:0
    s_bfe_u32 s36, s66, 262172
    v_exp_f32_e64 v14, v14
    v_mfma_f32_16x16x32_bf16 v[36:39], a[72:75], a[108:111], v[36:39]
    ds_read_b128 a[68:71], v26 offset:8192
    v_fract_f32_e64 v4, v4
    v_mfma_f32_16x16x32_bf16 v[40:43], a[76:79], a[104:107], v[40:43]
    ds_read_b128 a[32:35], v24 offset:0
    s_add_u32 m0, s37, 98304
    v_cos_f32_e64 v5, v4
    v_mfma_f32_16x16x32_bf16 v[44:47], a[76:79], a[108:111], v[44:47]
    ds_read_b128 a[36:39], v24 offset:2048
    v_mfma_f32_16x16x32_bf16 v[48:51], a[80:83], a[104:107], v[48:51]
    ds_read_b128 a[40:43], v24 offset:4096
    v_sin_f32_e64 v6, v4
    v_mfma_f32_16x16x32_bf16 v[52:55], a[80:83], a[108:111], v[52:55]
    ds_read_b128 a[44:47], v24 offset:6144
    s_lshl_b32 s36, s36, 7
    v_mul_f32 v128, v14, v5
    v_mfma_f32_16x16x32_bf16 v[56:59], a[84:87], a[104:107], v[56:59]
    ds_read_b128 a[48:51], v24 offset:8192
    v_mfma_f32_16x16x32_bf16 v[60:63], a[84:87], a[108:111], v[60:63]
    ds_read_b128 a[52:55], v24 offset:10240
    v_mul_f32_e64 v129, v14, v6
    v_mfma_f32_16x16x32_bf16 v[64:67], a[88:91], a[104:107], v[64:67]
    ds_read_b128 a[56:59], v24 offset:12288
    buffer_load_dwordx4 v16, s[8:11], s36 offen offset:0 lds
    v_mul_f32_e64 v14, v142, v142
    v_mfma_f32_16x16x32_bf16 v[68:71], a[88:91], a[108:111], v[68:71]
    ds_read_b128 a[60:63], v24 offset:14336
    v_mfma_f32_16x16x32_bf16 v[72:75], a[92:95], a[104:107], v[72:75]
    buffer_load_dwordx4 v17, s[8:11], s36 offen offset:1024 lds
    v_fma_f32 v14, v143, v143, v14
    v_mfma_f32_16x16x32_bf16 v[76:79], a[92:95], a[108:111], v[76:79]
    v_rcp_f32_e64 v14, v14
    v_mfma_f32_16x16x32_bf16 v[80:83], a[96:99], a[104:107], v[80:83]
    v_mfma_f32_16x16x32_bf16 v[84:87], a[96:99], a[108:111], v[84:87]
    buffer_load_dwordx4 v18, s[8:11], s36 offen offset:2048 lds
    v_add_f32_e64 v4, -1.0, v128
    v_mfma_f32_16x16x32_bf16 v[88:91], a[100:103], a[104:107], v[88:91]
    v_add_f32_e64 v14, v14, v14
    v_mfma_f32_16x16x32_bf16 v[92:95], a[100:103], a[108:111], v[92:95]
    s_waitcnt lgkmcnt(0)
    v_mfma_f32_16x16x32_bf16 v[32:35], a[32:35], a[64:67], v[32:35]
    ds_read_b128 a[104:107], v27 offset:0
    buffer_load_dwordx4 v19, s[8:11], s36 offen offset:3072 lds
    v_mul_f32 v5, v4, v142
    v_mfma_f32_16x16x32_bf16 v[36:39], a[32:35], a[68:71], v[36:39]
    ds_read_b128 a[108:111], v27 offset:8192
    v_fma_f32 v5, v129, v143, v5
    v_mfma_f32_16x16x32_bf16 v[40:43], a[36:39], a[64:67], v[40:43]
    ds_read_b128 a[72:75], v25 offset:0
    s_add_u32 m0, s37, 114688
    v_mul_f32_e64 v6, v129, v142
    v_mfma_f32_16x16x32_bf16 v[44:47], a[36:39], a[68:71], v[44:47]
    ds_read_b128 a[76:79], v25 offset:2048
    v_mfma_f32_16x16x32_bf16 v[48:51], a[40:43], a[64:67], v[48:51]
    ds_read_b128 a[80:83], v25 offset:4096
    v_fma_f32 v6, -v4, v143, v6
    v_mfma_f32_16x16x32_bf16 v[52:55], a[40:43], a[68:71], v[52:55]
    ds_read_b128 a[84:87], v25 offset:6144
    buffer_load_dwordx4 v20, s[12:15], s36 offen offset:0 lds
    v_mul_f32_e64 v130, v5, v14
    v_mfma_f32_16x16x32_bf16 v[56:59], a[44:47], a[64:67], v[56:59]
    ds_read_b128 a[88:91], v25 offset:8192
    v_mfma_f32_16x16x32_bf16 v[60:63], a[44:47], a[68:71], v[60:63]
    ds_read_b128 a[92:95], v25 offset:10240
    v_mul_f32_e64 v131, v6, v14
    v_mfma_f32_16x16x32_bf16 v[64:67], a[48:51], a[64:67], v[64:67]
    ds_read_b128 a[96:99], v25 offset:12288
    buffer_load_dwordx4 v21, s[12:15], s36 offen offset:1024 lds
    v_mul_f32_e64 v4, v128, v128
    buffer_store_dwordx4 v[168:171], v228, s[28:31], s76 offen sc1
    v_mfma_f32_16x16x32_bf16 v[68:71], a[48:51], a[68:71], v[68:71]
    ds_read_b128 a[100:103], v25 offset:14336
    v_mfma_f32_16x16x32_bf16 v[72:75], a[52:55], a[64:67], v[72:75]
    buffer_load_dwordx4 v22, s[12:15], s36 offen offset:2048 lds
    v_mul_f32_e64 v5, v128, v129
    v_mfma_f32_16x16x32_bf16 v[76:79], a[52:55], a[68:71], v[76:79]
    v_fma_f32 v4, -v129, v129, v4
    v_mfma_f32_16x16x32_bf16 v[80:83], a[56:59], a[64:67], v[80:83]
    v_mfma_f32_16x16x32_bf16 v[84:87], a[56:59], a[68:71], v[84:87]
    buffer_load_dwordx4 v23, s[12:15], s36 offen offset:3072 lds
    v_add_f32_e64 v5, v5, v5
    v_mfma_f32_16x16x32_bf16 v[88:91], a[60:63], a[64:67], v[88:91]
    v_mul_f32_e64 v6, v4, v4
    v_mfma_f32_16x16x32_bf16 v[92:95], a[60:63], a[68:71], v[92:95]
    s_waitcnt lgkmcnt(0) vmcnt(19)
    s_barrier
    v_mfma_f32_16x16x32_bf16 v[32:35], a[72:75], a[104:107], v[32:35]
    ds_read_b128 a[64:67], v26 offset:32768
    s_bfe_u32 s36, s67, 262144
    v_mul_f32_e64 v7, v4, v5
    v_mfma_f32_16x16x32_bf16 v[36:39], a[72:75], a[108:111], v[36:39]
    ds_read_b128 a[68:71], v26 offset:40960
    v_fma_f32 v6, -v5, v5, v6
    v_mfma_f32_16x16x32_bf16 v[40:43], a[76:79], a[104:107], v[40:43]
    ds_read_b128 a[32:35], v24 offset:32768
    s_add_u32 m0, s37, 0
    v_add_f32 v7, v7, v7
    v_mfma_f32_16x16x32_bf16 v[44:47], a[76:79], a[108:111], v[44:47]
    ds_read_b128 a[36:39], v24 offset:34816
    v_mfma_f32_16x16x32_bf16 v[48:51], a[80:83], a[104:107], v[48:51]
    ds_read_b128 a[40:43], v24 offset:36864
    v_mul_f32_e64 v4, v6, v6
    v_mfma_f32_16x16x32_bf16 v[52:55], a[80:83], a[108:111], v[52:55]
    ds_read_b128 a[44:47], v24 offset:38912
    s_lshl_b32 s36, s36, 7
    v_mul_f32 v5, v6, v7
    v_mfma_f32_16x16x32_bf16 v[56:59], a[84:87], a[104:107], v[56:59]
    ds_read_b128 a[48:51], v24 offset:40960
    v_mfma_f32_16x16x32_bf16 v[60:63], a[84:87], a[108:111], v[60:63]
    ds_read_b128 a[52:55], v24 offset:43008
    v_fma_f32 v4, -v7, v7, v4
    v_mfma_f32_16x16x32_bf16 v[64:67], a[88:91], a[104:107], v[64:67]
    ds_read_b128 a[56:59], v24 offset:45056
    buffer_load_dwordx4 v16, s[8:11], s36 offen offset:0 lds
    v_add_f32_e64 v5, v5, v5
    buffer_store_dwordx4 v[172:175], v229, s[28:31], s76 offen sc1
    v_mfma_f32_16x16x32_bf16 v[68:71], a[88:91], a[108:111], v[68:71]
    ds_read_b128 a[60:63], v24 offset:47104
    v_mfma_f32_16x16x32_bf16 v[72:75], a[92:95], a[104:107], v[72:75]
    buffer_load_dwordx4 v17, s[8:11], s36 offen offset:1024 lds
    v_mul_f32_e64 v132, v4, v4
    v_mfma_f32_16x16x32_bf16 v[76:79], a[92:95], a[108:111], v[76:79]
    v_mul_f32_e64 v133, v4, v5
    v_mfma_f32_16x16x32_bf16 v[80:83], a[96:99], a[104:107], v[80:83]
    v_mfma_f32_16x16x32_bf16 v[84:87], a[96:99], a[108:111], v[84:87]
    buffer_load_dwordx4 v18, s[8:11], s36 offen offset:2048 lds
    v_fma_f32 v132, -v5, v5, v132
    v_mfma_f32_16x16x32_bf16 v[88:91], a[100:103], a[104:107], v[88:91]
    v_add_f32_e64 v133, v133, v133
    v_mfma_f32_16x16x32_bf16 v[92:95], a[100:103], a[108:111], v[92:95]
    s_waitcnt lgkmcnt(0)
    v_mfma_f32_16x16x32_bf16 v[32:35], a[32:35], a[64:67], v[32:35]
    ds_read_b128 a[104:107], v27 offset:32768
    buffer_load_dwordx4 v19, s[8:11], s36 offen offset:3072 lds
    v_mul_f32 v134, v132, v132
    v_mfma_f32_16x16x32_bf16 v[36:39], a[32:35], a[68:71], v[36:39]
    ds_read_b128 a[108:111], v27 offset:40960
    v_mul_f32_e64 v135, v132, v133
    v_mfma_f32_16x16x32_bf16 v[40:43], a[36:39], a[64:67], v[40:43]
    ds_read_b128 a[72:75], v25 offset:32768
    s_add_u32 m0, s37, 16384
    v_fma_f32 v134, -v133, v133, v134
    v_mfma_f32_16x16x32_bf16 v[44:47], a[36:39], a[68:71], v[44:47]
    ds_read_b128 a[76:79], v25 offset:34816
    v_mfma_f32_16x16x32_bf16 v[48:51], a[40:43], a[64:67], v[48:51]
    ds_read_b128 a[80:83], v25 offset:36864
    v_add_f32_e64 v135, v135, v135
    v_mfma_f32_16x16x32_bf16 v[52:55], a[40:43], a[68:71], v[52:55]
    ds_read_b128 a[84:87], v25 offset:38912
    buffer_load_dwordx4 v20, s[12:15], s36 offen offset:0 lds
    v_mul_f32_e64 v8, v134, v134
    v_mfma_f32_16x16x32_bf16 v[56:59], a[44:47], a[64:67], v[56:59]
    ds_read_b128 a[88:91], v25 offset:40960
    v_mfma_f32_16x16x32_bf16 v[60:63], a[44:47], a[68:71], v[60:63]
    ds_read_b128 a[92:95], v25 offset:43008
    v_mul_f32_e64 v9, v134, v135
    v_mfma_f32_16x16x32_bf16 v[64:67], a[48:51], a[64:67], v[64:67]
    ds_read_b128 a[96:99], v25 offset:45056
    buffer_load_dwordx4 v21, s[12:15], s36 offen offset:1024 lds
    v_fma_f32 v8, -v135, v135, v8
    buffer_store_dwordx4 v[176:179], v231, s[28:31], s76 offen sc1
    v_mfma_f32_16x16x32_bf16 v[68:71], a[48:51], a[68:71], v[68:71]
    ds_read_b128 a[100:103], v25 offset:47104
    v_mfma_f32_16x16x32_bf16 v[72:75], a[52:55], a[64:67], v[72:75]
    buffer_load_dwordx4 v22, s[12:15], s36 offen offset:2048 lds
    v_add_f32_e64 v9, v9, v9
    v_mfma_f32_16x16x32_bf16 v[76:79], a[52:55], a[68:71], v[76:79]
    v_mul_f32_e64 v136, v8, v8
    v_mfma_f32_16x16x32_bf16 v[80:83], a[56:59], a[64:67], v[80:83]
    v_mfma_f32_16x16x32_bf16 v[84:87], a[56:59], a[68:71], v[84:87]
    buffer_load_dwordx4 v23, s[12:15], s36 offen offset:3072 lds
    v_mul_f32_e64 v137, v8, v9
    v_mfma_f32_16x16x32_bf16 v[88:91], a[60:63], a[64:67], v[88:91]
    v_fma_f32 v136, -v9, v9, v136
    v_mfma_f32_16x16x32_bf16 v[92:95], a[60:63], a[68:71], v[92:95]
    s_waitcnt lgkmcnt(0) vmcnt(19)
    s_barrier
    v_mfma_f32_16x16x32_bf16 v[32:35], a[72:75], a[104:107], v[32:35]
    ds_read_b128 a[64:67], v150 offset:0
    s_bfe_u32 s36, s67, 262148
    v_add_f32_e64 v137, v137, v137
    v_mfma_f32_16x16x32_bf16 v[36:39], a[72:75], a[108:111], v[36:39]
    ds_read_b128 a[68:71], v150 offset:8192
    v_mul_f32_e64 v4, v136, v136
    v_mfma_f32_16x16x32_bf16 v[40:43], a[76:79], a[104:107], v[40:43]
    ds_read_b128 a[32:35], v148 offset:0
    s_add_u32 m0, s37, 32768
    v_mul_f32_e64 v5, v136, v137
    v_mfma_f32_16x16x32_bf16 v[44:47], a[76:79], a[108:111], v[44:47]
    ds_read_b128 a[36:39], v148 offset:2048
    v_mfma_f32_16x16x32_bf16 v[48:51], a[80:83], a[104:107], v[48:51]
    ds_read_b128 a[40:43], v148 offset:4096
    v_fma_f32 v4, -v137, v137, v4
    v_mfma_f32_16x16x32_bf16 v[52:55], a[80:83], a[108:111], v[52:55]
    ds_read_b128 a[44:47], v148 offset:6144
    s_lshl_b32 s36, s36, 7
    v_add_f32 v5, v5, v5
    v_mfma_f32_16x16x32_bf16 v[56:59], a[84:87], a[104:107], v[56:59]
    ds_read_b128 a[48:51], v148 offset:8192
    v_mfma_f32_16x16x32_bf16 v[60:63], a[84:87], a[108:111], v[60:63]
    ds_read_b128 a[52:55], v148 offset:10240
    v_mul_f32_e64 v10, v4, v4
    v_mfma_f32_16x16x32_bf16 v[64:67], a[88:91], a[104:107], v[64:67]
    ds_read_b128 a[56:59], v148 offset:12288
    buffer_load_dwordx4 v16, s[8:11], s36 offen offset:0 lds
    v_mul_f32_e64 v11, v4, v5
    v_mfma_f32_16x16x32_bf16 v[68:71], a[88:91], a[108:111], v[68:71]
    ds_read_b128 a[60:63], v148 offset:14336
    v_mfma_f32_16x16x32_bf16 v[72:75], a[92:95], a[104:107], v[72:75]
    buffer_load_dwordx4 v17, s[8:11], s36 offen offset:1024 lds
    v_fma_f32 v10, -v5, v5, v10
    v_mfma_f32_16x16x32_bf16 v[76:79], a[92:95], a[108:111], v[76:79]
    v_add_f32_e64 v11, v11, v11
    v_mfma_f32_16x16x32_bf16 v[80:83], a[96:99], a[104:107], v[80:83]
    v_mfma_f32_16x16x32_bf16 v[84:87], a[96:99], a[108:111], v[84:87]
    buffer_load_dwordx4 v18, s[8:11], s36 offen offset:2048 lds
    v_mul_f32_e64 v12, v10, v10
    v_mfma_f32_16x16x32_bf16 v[88:91], a[100:103], a[104:107], v[88:91]
    v_mul_f32_e64 v13, v10, v11
    v_mfma_f32_16x16x32_bf16 v[92:95], a[100:103], a[108:111], v[92:95]
    s_waitcnt lgkmcnt(0)
    v_mfma_f32_16x16x32_bf16 v[32:35], a[32:35], a[64:67], v[32:35]
    ds_read_b128 a[104:107], v151 offset:0
    buffer_load_dwordx4 v19, s[8:11], s36 offen offset:3072 lds
    v_fma_f32 v12, -v11, v11, v12
    v_mfma_f32_16x16x32_bf16 v[36:39], a[32:35], a[68:71], v[36:39]
    ds_read_b128 a[108:111], v151 offset:8192
    v_add_f32 v13, v13, v13
    v_mfma_f32_16x16x32_bf16 v[40:43], a[36:39], a[64:67], v[40:43]
    ds_read_b128 a[72:75], v149 offset:0
    s_add_u32 m0, s37, 49152
    v_and_b32_e64 v14, 1, v2
    v_mfma_f32_16x16x32_bf16 v[44:47], a[36:39], a[68:71], v[44:47]
    ds_read_b128 a[76:79], v149 offset:2048
    v_mfma_f32_16x16x32_bf16 v[48:51], a[40:43], a[64:67], v[48:51]
    ds_read_b128 a[80:83], v149 offset:4096
    v_cmp_eq_u32 s[78:79], 1, v14
    v_mfma_f32_16x16x32_bf16 v[52:55], a[40:43], a[68:71], v[52:55]
    ds_read_b128 a[84:87], v149 offset:6144
    buffer_load_dwordx4 v20, s[12:15], s36 offen offset:0 lds
    v_cndmask_b32 v4, 1.0, v134, s[78:79]
    v_mfma_f32_16x16x32_bf16 v[56:59], a[44:47], a[64:67], v[56:59]
    ds_read_b128 a[88:91], v149 offset:8192
    v_mfma_f32_16x16x32_bf16 v[60:63], a[44:47], a[68:71], v[60:63]
    ds_read_b128 a[92:95], v149 offset:10240
    v_cndmask_b32 v5, 0, v135, s[78:79]
    v_mfma_f32_16x16x32_bf16 v[64:67], a[48:51], a[64:67], v[64:67]
    ds_read_b128 a[96:99], v149 offset:12288
    buffer_load_dwordx4 v21, s[12:15], s36 offen offset:1024 lds
    v_cndmask_b32 v10, 1.0, v10, s[78:79]
    buffer_store_dwordx4 v[180:183], v193, s[28:31], s76 offen sc1
    v_mfma_f32_16x16x32_bf16 v[68:71], a[48:51], a[68:71], v[68:71]
    ds_read_b128 a[100:103], v149 offset:14336
    v_mfma_f32_16x16x32_bf16 v[72:75], a[52:55], a[64:67], v[72:75]
    buffer_load_dwordx4 v22, s[12:15], s36 offen offset:2048 lds
    v_cndmask_b32 v11, 0, v11, s[78:79]
    v_mfma_f32_16x16x32_bf16 v[76:79], a[52:55], a[68:71], v[76:79]
    v_cmp_lt_u32 s[78:79], 1, v2
    v_mfma_f32_16x16x32_bf16 v[80:83], a[56:59], a[64:67], v[80:83]
    v_mfma_f32_16x16x32_bf16 v[84:87], a[56:59], a[68:71], v[84:87]
    buffer_load_dwordx4 v23, s[12:15], s36 offen offset:3072 lds
    v_cndmask_b32 v8, 1.0, v8, s[78:79]
    v_mfma_f32_16x16x32_bf16 v[88:91], a[60:63], a[64:67], v[88:91]
    v_cndmask_b32 v9, 0, v9, s[78:79]
    v_mfma_f32_16x16x32_bf16 v[92:95], a[60:63], a[68:71], v[92:95]
    s_waitcnt lgkmcnt(0) vmcnt(19)
    s_barrier
    v_mfma_f32_16x16x32_bf16 v[32:35], a[72:75], a[104:107], v[32:35]
    ds_read_b128 a[64:67], v150 offset:32768
    s_bfe_u32 s36, s67, 262152
    v_cndmask_b32 v12, 1.0, v12, s[78:79]
    v_mfma_f32_16x16x32_bf16 v[36:39], a[72:75], a[108:111], v[36:39]
    ds_read_b128 a[68:71], v150 offset:40960
    v_cndmask_b32 v13, 0, v13, s[78:79]
    v_mfma_f32_16x16x32_bf16 v[40:43], a[76:79], a[104:107], v[40:43]
    ds_read_b128 a[32:35], v148 offset:32768
    s_add_u32 m0, s37, 65536
    v_mul_f32_e64 v138, v4, v8
    v_mfma_f32_16x16x32_bf16 v[44:47], a[76:79], a[108:111], v[44:47]
    ds_read_b128 a[36:39], v148 offset:34816
    v_mfma_f32_16x16x32_bf16 v[48:51], a[80:83], a[104:107], v[48:51]
    ds_read_b128 a[40:43], v148 offset:36864
    v_mul_f32_e64 v139, v4, v9
    v_mfma_f32_16x16x32_bf16 v[52:55], a[80:83], a[108:111], v[52:55]
    ds_read_b128 a[44:47], v148 offset:38912
    s_lshl_b32 s36, s36, 7
    v_fma_f32 v138, -v5, v9, v138
    v_mfma_f32_16x16x32_bf16 v[56:59], a[84:87], a[104:107], v[56:59]
    ds_read_b128 a[48:51], v148 offset:40960
    v_mfma_f32_16x16x32_bf16 v[60:63], a[84:87], a[108:111], v[60:63]
    ds_read_b128 a[52:55], v148 offset:43008
    v_fma_f32 v139, v5, v8, v139
    v_mfma_f32_16x16x32_bf16 v[64:67], a[88:91], a[104:107], v[64:67]
    ds_read_b128 a[56:59], v148 offset:45056
    buffer_load_dwordx4 v16, s[8:11], s36 offen offset:0 lds
    v_mul_f32 v140, v10, v12
    v_mfma_f32_16x16x32_bf16 v[68:71], a[88:91], a[108:111], v[68:71]
    ds_read_b128 a[60:63], v148 offset:47104
    v_mfma_f32_16x16x32_bf16 v[72:75], a[92:95], a[104:107], v[72:75]
    buffer_load_dwordx4 v17, s[8:11], s36 offen offset:1024 lds
    v_mul_f32_e64 v141, v10, v13
    v_mfma_f32_16x16x32_bf16 v[76:79], a[92:95], a[108:111], v[76:79]
    v_fma_f32 v140, -v11, v13, v140
    v_mfma_f32_16x16x32_bf16 v[80:83], a[96:99], a[104:107], v[80:83]
    v_mfma_f32_16x16x32_bf16 v[84:87], a[96:99], a[108:111], v[84:87]
    buffer_load_dwordx4 v18, s[8:11], s36 offen offset:2048 lds
    v_fma_f32 v141, v11, v12, v141
    v_mfma_f32_16x16x32_bf16 v[88:91], a[100:103], a[104:107], v[88:91]
    v_add_u32_e64 v251, s63, v1
    v_mfma_f32_16x16x32_bf16 v[92:95], a[100:103], a[108:111], v[92:95]
    s_waitcnt lgkmcnt(0)
    v_mfma_f32_16x16x32_bf16 v[32:35], a[32:35], a[64:67], v[32:35]
    ds_read_b128 a[104:107], v151 offset:32768
    buffer_load_dwordx4 v19, s[8:11], s36 offen offset:3072 lds
    v_cvt_f32_u32 v251, v251
    v_mfma_f32_16x16x32_bf16 v[36:39], a[32:35], a[68:71], v[36:39]
    ds_read_b128 a[108:111], v151 offset:40960
    v_mul_f32 v251, 0x3a800000, v251
    v_mfma_f32_16x16x32_bf16 v[40:43], a[36:39], a[64:67], v[40:43]
    ds_read_b128 a[72:75], v149 offset:32768
    s_add_u32 m0, s37, 81920
    v_mul_f32_e64 v248, v250, v251
    v_mfma_f32_16x16x32_bf16 v[44:47], a[36:39], a[68:71], v[44:47]
    ds_read_b128 a[76:79], v149 offset:34816
    v_mfma_f32_16x16x32_bf16 v[48:51], a[40:43], a[64:67], v[48:51]
    ds_read_b128 a[80:83], v149 offset:36864
    v_fmamk_f32 v4, v251, 0x00000000, v248
    v_mfma_f32_16x16x32_bf16 v[52:55], a[40:43], a[68:71], v[52:55]
    ds_read_b128 a[84:87], v149 offset:38912
    buffer_load_dwordx4 v20, s[12:15], s36 offen offset:0 lds
    v_fmamk_f32 v5, v251, 0x3f000000, v248
    v_mfma_f32_16x16x32_bf16 v[56:59], a[44:47], a[64:67], v[56:59]
    ds_read_b128 a[88:91], v149 offset:40960
    v_mfma_f32_16x16x32_bf16 v[60:63], a[44:47], a[68:71], v[60:63]
    ds_read_b128 a[92:95], v149 offset:43008
    v_fmamk_f32 v6, v251, 0x3f800000, v248
    v_mfma_f32_16x16x32_bf16 v[64:67], a[48:51], a[64:67], v[64:67]
    ds_read_b128 a[96:99], v149 offset:45056
    buffer_load_dwordx4 v21, s[12:15], s36 offen offset:1024 lds
    v_fmamk_f32 v7, v251, 0x3fc00000, v248
    v_mfma_f32_16x16x32_bf16 v[68:71], a[48:51], a[68:71], v[68:71]
    ds_read_b128 a[100:103], v149 offset:47104
    v_mfma_f32_16x16x32_bf16 v[72:75], a[52:55], a[64:67], v[72:75]
    buffer_load_dwordx4 v22, s[12:15], s36 offen offset:2048 lds
    v_cos_f32_e64 v96, v4
    v_mfma_f32_16x16x32_bf16 v[76:79], a[52:55], a[68:71], v[76:79]
    v_cos_f32_e64 v98, v5
    v_mfma_f32_16x16x32_bf16 v[80:83], a[56:59], a[64:67], v[80:83]
    v_mfma_f32_16x16x32_bf16 v[84:87], a[56:59], a[68:71], v[84:87]
    buffer_load_dwordx4 v23, s[12:15], s36 offen offset:3072 lds
    v_cos_f32_e64 v100, v6
    v_mfma_f32_16x16x32_bf16 v[88:91], a[60:63], a[64:67], v[88:91]
    v_cos_f32_e64 v102, v7
    v_mfma_f32_16x16x32_bf16 v[92:95], a[60:63], a[68:71], v[92:95]
    s_waitcnt lgkmcnt(0) vmcnt(10)
    s_barrier
    v_mfma_f32_16x16x32_bf16 v[32:35], a[72:75], a[104:107], v[32:35]
    ds_read_b128 a[64:67], v26 offset:0
    s_lshl_b32 s69, s2, 3
    v_sin_f32 v97, v4
    v_mfma_f32_16x16x32_bf16 v[36:39], a[72:75], a[108:111], v[36:39]
    ds_read_b128 a[68:71], v26 offset:8192
    s_add_u32 s69, s69, 22347776
    v_sin_f32_e64 v99, v5
    v_mfma_f32_16x16x32_bf16 v[40:43], a[76:79], a[104:107], v[40:43]
    ds_read_b128 a[32:35], v24 offset:0
    v_sin_f32_e64 v101, v6
    v_mfma_f32_16x16x32_bf16 v[44:47], a[76:79], a[108:111], v[44:47]
    ds_read_b128 a[36:39], v24 offset:2048
    v_mov_b32_e64 v28, s35
    v_mfma_f32_16x16x32_bf16 v[48:51], a[80:83], a[104:107], v[48:51]
    ds_read_b128 a[40:43], v24 offset:4096
    v_sin_f32_e64 v103, v7
    v_mfma_f32_16x16x32_bf16 v[52:55], a[80:83], a[108:111], v[52:55]
    ds_read_b128 a[44:47], v24 offset:6144
    v_and_b32 v255, 1073741831, v30
    v_fmamk_f32 v4, v251, 0x40000000, v248
    v_mfma_f32_16x16x32_bf16 v[56:59], a[84:87], a[104:107], v[56:59]
    ds_read_b128 a[48:51], v24 offset:8192
    v_mfma_f32_16x16x32_bf16 v[60:63], a[84:87], a[108:111], v[60:63]
    ds_read_b128 a[52:55], v24 offset:10240
    buffer_store_dword v28, v255, s[24:27], s69 offen sc1
    v_fmamk_f32 v5, v251, 0x40200000, v248
    v_mfma_f32_16x16x32_bf16 v[64:67], a[88:91], a[104:107], v[64:67]
    ds_read_b128 a[56:59], v24 offset:12288
    s_bfe_u32 s36, s67, 262156
    v_fmamk_f32 v6, v251, 0x40400000, v248
    v_mfma_f32_16x16x32_bf16 v[68:71], a[88:91], a[108:111], v[68:71]
    ds_read_b128 a[60:63], v24 offset:14336
    v_mfma_f32_16x16x32_bf16 v[72:75], a[92:95], a[104:107], v[72:75]
    s_add_u32 m0, s37, 98304
    v_fmamk_f32 v7, v251, 0x40600000, v248
    v_mfma_f32_16x16x32_bf16 v[76:79], a[92:95], a[108:111], v[76:79]
    v_cos_f32_e64 v104, v4
    v_mfma_f32_16x16x32_bf16 v[80:83], a[96:99], a[104:107], v[80:83]
    s_lshl_b32 s36, s36, 7
    v_mfma_f32_16x16x32_bf16 v[84:87], a[96:99], a[108:111], v[84:87]
    v_cos_f32 v106, v5
    v_mfma_f32_16x16x32_bf16 v[88:91], a[100:103], a[104:107], v[88:91]
    buffer_load_dwordx4 v16, s[8:11], s36 offen offset:0 lds
    v_cos_f32_e64 v108, v6
    v_mfma_f32_16x16x32_bf16 v[92:95], a[100:103], a[108:111], v[92:95]
    s_waitcnt lgkmcnt(0)
    v_mfma_f32_16x16x32_bf16 v[32:35], a[32:35], a[64:67], v[32:35]
    ds_read_b128 a[104:107], v27 offset:0
    buffer_load_dwordx4 v17, s[8:11], s36 offen offset:1024 lds
    v_cos_f32 v110, v7
    v_mfma_f32_16x16x32_bf16 v[36:39], a[32:35], a[68:71], v[36:39]
    ds_read_b128 a[108:111], v27 offset:8192
    v_sin_f32_e64 v105, v4
    v_mfma_f32_16x16x32_bf16 v[40:43], a[36:39], a[64:67], v[40:43]
    ds_read_b128 a[72:75], v25 offset:0
    buffer_load_dwordx4 v18, s[8:11], s36 offen offset:2048 lds
    v_sin_f32_e64 v107, v5
    v_mfma_f32_16x16x32_bf16 v[44:47], a[36:39], a[68:71], v[44:47]
    ds_read_b128 a[76:79], v25 offset:2048
    v_mfma_f32_16x16x32_bf16 v[48:51], a[40:43], a[64:67], v[48:51]
    ds_read_b128 a[80:83], v25 offset:4096
    buffer_load_dwordx4 v19, s[8:11], s36 offen offset:3072 lds
    v_sin_f32_e64 v109, v6
    v_mfma_f32_16x16x32_bf16 v[52:55], a[40:43], a[68:71], v[52:55]
    ds_read_b128 a[84:87], v25 offset:6144
    v_sin_f32_e64 v111, v7
    v_mfma_f32_16x16x32_bf16 v[56:59], a[44:47], a[64:67], v[56:59]
    ds_read_b128 a[88:91], v25 offset:8192
    s_add_u32 m0, s37, 114688
    v_mfma_f32_16x16x32_bf16 v[60:63], a[44:47], a[68:71], v[60:63]
    ds_read_b128 a[92:95], v25 offset:10240
    v_cvt_f32_u32_e64 v9, s4
    v_mfma_f32_16x16x32_bf16 v[64:67], a[48:51], a[64:67], v[64:67]
    ds_read_b128 a[96:99], v25 offset:12288
    buffer_load_dwordx4 v20, s[12:15], s36 offen offset:0 lds
    v_mul_f32 v9, 0x3a800000, v9
    v_mfma_f32_16x16x32_bf16 v[68:71], a[48:51], a[68:71], v[68:71]
    ds_read_b128 a[100:103], v25 offset:14336
    v_mfma_f32_16x16x32_bf16 v[72:75], a[52:55], a[64:67], v[72:75]
    buffer_load_dwordx4 v21, s[12:15], s36 offen offset:1024 lds
    v_sin_f32_e64 v11, v9
    v_mfma_f32_16x16x32_bf16 v[76:79], a[52:55], a[68:71], v[76:79]
    v_cos_f32_e64 v10, v9
    v_mfma_f32_16x16x32_bf16 v[80:83], a[56:59], a[64:67], v[80:83]
    buffer_load_dwordx4 v22, s[12:15], s36 offen offset:2048 lds
    v_mfma_f32_16x16x32_bf16 v[84:87], a[56:59], a[68:71], v[84:87]
    v_add_f32_e64 v11, 1.0, v11
    v_mfma_f32_16x16x32_bf16 v[88:91], a[60:63], a[64:67], v[88:91]
    buffer_load_dwordx4 v23, s[12:15], s36 offen offset:3072 lds
    v_rcp_f32_e64 v9, v11
    v_mfma_f32_16x16x32_bf16 v[92:95], a[60:63], a[68:71], v[92:95]
    s_waitcnt lgkmcnt(0) vmcnt(17)
    s_barrier
    v_mfma_f32_16x16x32_bf16 v[32:35], a[72:75], a[104:107], v[32:35]
    ds_read_b128 a[64:67], v26 offset:32768
    s_bfe_u32 s36, s67, 262160
    s_mov_b32 s39, 0x35000000
    v_mfma_f32_16x16x32_bf16 v[36:39], a[72:75], a[108:111], v[36:39]
    ds_read_b128 a[68:71], v26 offset:40960
    s_cmp_eq_u32 s2, 0
    s_cselect_b32 s39, 0x34800000, s39
    v_mfma_f32_16x16x32_bf16 v[40:43], a[76:79], a[104:107], v[40:43]
    ds_read_b128 a[32:35], v24 offset:32768
    s_add_u32 m0, s37, 0
    v_mul_f32_e64 v15, s39, v11
    v_mfma_f32_16x16x32_bf16 v[44:47], a[76:79], a[108:111], v[44:47]
    ds_read_b128 a[36:39], v24 offset:34816
    v_mfma_f32_16x16x32_bf16 v[48:51], a[80:83], a[104:107], v[48:51]
    ds_read_b128 a[40:43], v24 offset:36864
    v_mul_f32_e64 v10, -v10, v9
    v_mfma_f32_16x16x32_bf16 v[52:55], a[80:83], a[108:111], v[52:55]
    ds_read_b128 a[44:47], v24 offset:38912
    s_lshl_b32 s36, s36, 7
    v_cvt_f32_u32 v14, s63
    v_mfma_f32_16x16x32_bf16 v[56:59], a[84:87], a[104:107], v[56:59]
    ds_read_b128 a[48:51], v24 offset:40960
    v_mfma_f32_16x16x32_bf16 v[60:63], a[84:87], a[108:111], v[60:63]
    ds_read_b128 a[52:55], v24 offset:43008
    v_readfirstlane_b32 s42, v10
    v_mfma_f32_16x16x32_bf16 v[64:67], a[88:91], a[104:107], v[64:67]
    ds_read_b128 a[56:59], v24 offset:45056
    buffer_load_dwordx4 v16, s[8:11], s36 offen offset:0 lds
    v_add_f32 v14, v14, v250
    v_mfma_f32_16x16x32_bf16 v[68:71], a[88:91], a[108:111], v[68:71]
    ds_read_b128 a[60:63], v24 offset:47104
    v_mfma_f32_16x16x32_bf16 v[72:75], a[92:95], a[104:107], v[72:75]
    buffer_load_dwordx4 v17, s[8:11], s36 offen offset:1024 lds
    v_fma_f32 v251, v249, 2.0, 0
    v_mfma_f32_16x16x32_bf16 v[76:79], a[92:95], a[108:111], v[76:79]
    v_mul_f32 v251, 0x3a000000, v251
    v_mfma_f32_16x16x32_bf16 v[80:83], a[96:99], a[104:107], v[80:83]
    v_mfma_f32_16x16x32_bf16 v[84:87], a[96:99], a[108:111], v[84:87]
    buffer_load_dwordx4 v18, s[8:11], s36 offen offset:2048 lds
    v_mul_f32_e64 v248, v14, v251
    v_mfma_f32_16x16x32_bf16 v[88:91], a[100:103], a[104:107], v[88:91]
    v_fmamk_f32 v4, v251, 0x00000000, v248
    v_mfma_f32_16x16x32_bf16 v[92:95], a[100:103], a[108:111], v[92:95]
    s_waitcnt lgkmcnt(0)
    v_mfma_f32_16x16x32_bf16 v[32:35], a[32:35], a[64:67], v[32:35]
    ds_read_b128 a[104:107], v27 offset:32768
    buffer_load_dwordx4 v19, s[8:11], s36 offen offset:3072 lds
    v_fmamk_f32 v5, v251, 0x3f800000, v248
    v_mfma_f32_16x16x32_bf16 v[36:39], a[32:35], a[68:71], v[36:39]
    ds_read_b128 a[108:111], v27 offset:40960
    v_fmamk_f32 v6, v251, 0x40000000, v248
    v_mfma_f32_16x16x32_bf16 v[40:43], a[36:39], a[64:67], v[40:43]
    ds_read_b128 a[72:75], v25 offset:32768
    s_add_u32 m0, s37, 16384
    v_fmamk_f32 v7, v251, 0x40400000, v248
    v_mfma_f32_16x16x32_bf16 v[44:47], a[36:39], a[68:71], v[44:47]
    ds_read_b128 a[76:79], v25 offset:34816
    v_mfma_f32_16x16x32_bf16 v[48:51], a[40:43], a[64:67], v[48:51]
    ds_read_b128 a[80:83], v25 offset:36864
    v_cos_f32 v112, v4
    v_mfma_f32_16x16x32_bf16 v[52:55], a[40:43], a[68:71], v[52:55]
    ds_read_b128 a[84:87], v25 offset:38912
    buffer_load_dwordx4 v20, s[12:15], s36 offen offset:0 lds
    v_cos_f32_e64 v113, v5
    v_mfma_f32_16x16x32_bf16 v[56:59], a[44:47], a[64:67], v[56:59]
    ds_read_b128 a[88:91], v25 offset:40960
    v_mfma_f32_16x16x32_bf16 v[60:63], a[44:47], a[68:71], v[60:63]
    ds_read_b128 a[92:95], v25 offset:43008
    v_cos_f32_e64 v114, v6
    v_mfma_f32_16x16x32_bf16 v[64:67], a[48:51], a[64:67], v[64:67]
    ds_read_b128 a[96:99], v25 offset:45056
    buffer_load_dwordx4 v21, s[12:15], s36 offen offset:1024 lds
    v_cos_f32_e64 v115, v7
    v_mfma_f32_16x16x32_bf16 v[68:71], a[48:51], a[68:71], v[68:71]
    ds_read_b128 a[100:103], v25 offset:47104
    v_mfma_f32_16x16x32_bf16 v[72:75], a[52:55], a[64:67], v[72:75]
    buffer_load_dwordx4 v22, s[12:15], s36 offen offset:2048 lds
    v_sin_f32_e64 v116, v4
    v_mfma_f32_16x16x32_bf16 v[76:79], a[52:55], a[68:71], v[76:79]
    v_sin_f32_e64 v117, v5
    v_mfma_f32_16x16x32_bf16 v[80:83], a[56:59], a[64:67], v[80:83]
    v_mfma_f32_16x16x32_bf16 v[84:87], a[56:59], a[68:71], v[84:87]
    buffer_load_dwordx4 v23, s[12:15], s36 offen offset:3072 lds
    v_sin_f32_e64 v118, v6
    v_mfma_f32_16x16x32_bf16 v[88:91], a[60:63], a[64:67], v[88:91]
    v_sin_f32_e64 v119, v7
    v_mfma_f32_16x16x32_bf16 v[92:95], a[60:63], a[68:71], v[92:95]
    s_waitcnt lgkmcnt(0) vmcnt(17)
    s_barrier
    v_mfma_f32_16x16x32_bf16 v[32:35], a[72:75], a[104:107], v[32:35]
    ds_read_b128 a[64:67], v150 offset:0
    s_bfe_u32 s36, s67, 262164
    v_mul_f32_e64 v112, v15, v112
    v_mfma_f32_16x16x32_bf16 v[36:39], a[72:75], a[108:111], v[36:39]
    ds_read_b128 a[68:71], v150 offset:8192
    v_mul_f32_e64 v113, v15, v113
    v_mfma_f32_16x16x32_bf16 v[40:43], a[76:79], a[104:107], v[40:43]
    ds_read_b128 a[32:35], v148 offset:0
    s_add_u32 m0, s37, 32768
    v_mul_f32_e64 v114, v15, v114
    v_mfma_f32_16x16x32_bf16 v[44:47], a[76:79], a[108:111], v[44:47]
    ds_read_b128 a[36:39], v148 offset:2048
    v_mfma_f32_16x16x32_bf16 v[48:51], a[80:83], a[104:107], v[48:51]
    ds_read_b128 a[40:43], v148 offset:4096
    v_mul_f32_e64 v115, v15, v115
    v_mfma_f32_16x16x32_bf16 v[52:55], a[80:83], a[108:111], v[52:55]
    ds_read_b128 a[44:47], v148 offset:6144
    s_lshl_b32 s36, s36, 7
    v_mul_f32 v116, v15, v116
    v_mfma_f32_16x16x32_bf16 v[56:59], a[84:87], a[104:107], v[56:59]
    ds_read_b128 a[48:51], v148 offset:8192
    v_mfma_f32_16x16x32_bf16 v[60:63], a[84:87], a[108:111], v[60:63]
    ds_read_b128 a[52:55], v148 offset:10240
    v_mul_f32_e64 v117, v15, v117
    v_mfma_f32_16x16x32_bf16 v[64:67], a[88:91], a[104:107], v[64:67]
    ds_read_b128 a[56:59], v148 offset:12288
    buffer_load_dwordx4 v16, s[8:11], s36 offen offset:0 lds
    v_mul_f32_e64 v118, v15, v118
    v_mfma_f32_16x16x32_bf16 v[68:71], a[88:91], a[108:111], v[68:71]
    ds_read_b128 a[60:63], v148 offset:14336
    v_mfma_f32_16x16x32_bf16 v[72:75], a[92:95], a[104:107], v[72:75]
    buffer_load_dwordx4 v17, s[8:11], s36 offen offset:1024 lds
    v_mul_f32_e64 v119, v15, v119
    v_mfma_f32_16x16x32_bf16 v[76:79], a[92:95], a[108:111], v[76:79]
    v_fma_f32 v251, v249, 2.0, 1.0
    v_mfma_f32_16x16x32_bf16 v[80:83], a[96:99], a[104:107], v[80:83]
    v_mfma_f32_16x16x32_bf16 v[84:87], a[96:99], a[108:111], v[84:87]
    buffer_load_dwordx4 v18, s[8:11], s36 offen offset:2048 lds
    v_mul_f32 v251, 0x3a000000, v251
    v_mfma_f32_16x16x32_bf16 v[88:91], a[100:103], a[104:107], v[88:91]
    v_mul_f32_e64 v248, v14, v251
    v_mfma_f32_16x16x32_bf16 v[92:95], a[100:103], a[108:111], v[92:95]
    s_waitcnt lgkmcnt(0)
    v_mfma_f32_16x16x32_bf16 v[32:35], a[32:35], a[64:67], v[32:35]
    ds_read_b128 a[104:107], v151 offset:0
    buffer_load_dwordx4 v19, s[8:11], s36 offen offset:3072 lds
    v_fmamk_f32 v4, v251, 0x00000000, v248
    v_mfma_f32_16x16x32_bf16 v[36:39], a[32:35], a[68:71], v[36:39]
    ds_read_b128 a[108:111], v151 offset:8192
    v_fmamk_f32 v5, v251, 0x3f800000, v248
    v_mfma_f32_16x16x32_bf16 v[40:43], a[36:39], a[64:67], v[40:43]
    ds_read_b128 a[72:75], v149 offset:0
    s_add_u32 m0, s37, 49152
    v_fmamk_f32 v6, v251, 0x40000000, v248
    v_mfma_f32_16x16x32_bf16 v[44:47], a[36:39], a[68:71], v[44:47]
    ds_read_b128 a[76:79], v149 offset:2048
    v_mfma_f32_16x16x32_bf16 v[48:51], a[40:43], a[64:67], v[48:51]
    ds_read_b128 a[80:83], v149 offset:4096
    v_fmamk_f32 v7, v251, 0x40400000, v248
    v_mfma_f32_16x16x32_bf16 v[52:55], a[40:43], a[68:71], v[52:55]
    ds_read_b128 a[84:87], v149 offset:6144
    buffer_load_dwordx4 v20, s[12:15], s36 offen offset:0 lds
    v_cos_f32 v120, v4
    v_mfma_f32_16x16x32_bf16 v[56:59], a[44:47], a[64:67], v[56:59]
    ds_read_b128 a[88:91], v149 offset:8192
    v_mfma_f32_16x16x32_bf16 v[60:63], a[44:47], a[68:71], v[60:63]
    ds_read_b128 a[92:95], v149 offset:10240
    v_cos_f32_e64 v121, v5
    v_mfma_f32_16x16x32_bf16 v[64:67], a[48:51], a[64:67], v[64:67]
    ds_read_b128 a[96:99], v149 offset:12288
    buffer_load_dwordx4 v21, s[12:15], s36 offen offset:1024 lds
    v_cos_f32_e64 v122, v6
    v_mfma_f32_16x16x32_bf16 v[68:71], a[48:51], a[68:71], v[68:71]
    ds_read_b128 a[100:103], v149 offset:14336
    v_mfma_f32_16x16x32_bf16 v[72:75], a[52:55], a[64:67], v[72:75]
    buffer_load_dwordx4 v22, s[12:15], s36 offen offset:2048 lds
    v_cos_f32_e64 v123, v7
    v_mfma_f32_16x16x32_bf16 v[76:79], a[52:55], a[68:71], v[76:79]
    v_sin_f32_e64 v124, v4
    v_mfma_f32_16x16x32_bf16 v[80:83], a[56:59], a[64:67], v[80:83]
    v_mfma_f32_16x16x32_bf16 v[84:87], a[56:59], a[68:71], v[84:87]
    buffer_load_dwordx4 v23, s[12:15], s36 offen offset:3072 lds
    v_sin_f32_e64 v125, v5
    v_mfma_f32_16x16x32_bf16 v[88:91], a[60:63], a[64:67], v[88:91]
    v_sin_f32_e64 v126, v6
    v_mfma_f32_16x16x32_bf16 v[92:95], a[60:63], a[68:71], v[92:95]
    s_waitcnt lgkmcnt(0) vmcnt(16)
    s_barrier
    v_mfma_f32_16x16x32_bf16 v[32:35], a[72:75], a[104:107], v[32:35]
    ds_read_b128 a[64:67], v150 offset:32768
    s_bfe_u32 s36, s67, 262168
    v_sin_f32_e64 v127, v7
    v_mfma_f32_16x16x32_bf16 v[36:39], a[72:75], a[108:111], v[36:39]
    ds_read_b128 a[68:71], v150 offset:40960
    v_mul_f32_e64 v120, v15, v120
    v_mfma_f32_16x16x32_bf16 v[40:43], a[76:79], a[104:107], v[40:43]
    ds_read_b128 a[32:35], v148 offset:32768
    s_add_u32 m0, s37, 65536
    v_mfma_f32_16x16x32_bf16 v[44:47], a[76:79], a[108:111], v[44:47]
    ds_read_b128 a[36:39], v148 offset:34816
    v_mul_f32_e64 v121, v15, v121
    v_mfma_f32_16x16x32_bf16 v[48:51], a[80:83], a[104:107], v[48:51]
    ds_read_b128 a[40:43], v148 offset:36864
    v_mfma_f32_16x16x32_bf16 v[52:55], a[80:83], a[108:111], v[52:55]
    ds_read_b128 a[44:47], v148 offset:38912
    s_lshl_b32 s36, s36, 7
    v_mul_f32 v122, v15, v122
    v_mfma_f32_16x16x32_bf16 v[56:59], a[84:87], a[104:107], v[56:59]
    ds_read_b128 a[48:51], v148 offset:40960
    v_mfma_f32_16x16x32_bf16 v[60:63], a[84:87], a[108:111], v[60:63]
    ds_read_b128 a[52:55], v148 offset:43008
    v_mul_f32_e64 v123, v15, v123
    v_mfma_f32_16x16x32_bf16 v[64:67], a[88:91], a[104:107], v[64:67]
    ds_read_b128 a[56:59], v148 offset:45056
    buffer_load_dwordx4 v16, s[8:11], s36 offen offset:0 lds
    v_mul_f32_e64 v124, v15, v124
    v_mfma_f32_16x16x32_bf16 v[68:71], a[88:91], a[108:111], v[68:71]
    ds_read_b128 a[60:63], v148 offset:47104
    v_mfma_f32_16x16x32_bf16 v[72:75], a[92:95], a[104:107], v[72:75]
    buffer_load_dwordx4 v17, s[8:11], s36 offen offset:1024 lds
    v_mul_f32_e64 v125, v15, v125
    v_mfma_f32_16x16x32_bf16 v[76:79], a[92:95], a[108:111], v[76:79]
    v_mfma_f32_16x16x32_bf16 v[80:83], a[96:99], a[104:107], v[80:83]
    v_mul_f32_e64 v126, v15, v126
    v_mfma_f32_16x16x32_bf16 v[84:87], a[96:99], a[108:111], v[84:87]
    buffer_load_dwordx4 v18, s[8:11], s36 offen offset:2048 lds
    v_mfma_f32_16x16x32_bf16 v[88:91], a[100:103], a[104:107], v[88:91]
    v_mul_f32_e64 v127, v15, v127
    v_mfma_f32_16x16x32_bf16 v[92:95], a[100:103], a[108:111], v[92:95]
    s_waitcnt lgkmcnt(0)
    v_mfma_f32_16x16x32_bf16 v[32:35], a[32:35], a[64:67], v[32:35]
    ds_read_b128 a[104:107], v151 offset:32768
    buffer_load_dwordx4 v19, s[8:11], s36 offen offset:3072 lds
    v_mfma_f32_16x16x32_bf16 v[36:39], a[32:35], a[68:71], v[36:39]
    ds_read_b128 a[108:111], v151 offset:40960
    v_mfma_f32_16x16x32_bf16 v[40:43], a[36:39], a[64:67], v[40:43]
    ds_read_b128 a[72:75], v149 offset:32768
    s_add_u32 m0, s37, 81920
    v_mfma_f32_16x16x32_bf16 v[44:47], a[36:39], a[68:71], v[44:47]
    ds_read_b128 a[76:79], v149 offset:34816
    v_mfma_f32_16x16x32_bf16 v[48:51], a[40:43], a[64:67], v[48:51]
    ds_read_b128 a[80:83], v149 offset:36864
    v_mfma_f32_16x16x32_bf16 v[52:55], a[40:43], a[68:71], v[52:55]
    ds_read_b128 a[84:87], v149 offset:38912
    buffer_load_dwordx4 v20, s[12:15], s36 offen offset:0 lds
    v_mfma_f32_16x16x32_bf16 v[56:59], a[44:47], a[64:67], v[56:59]
    ds_read_b128 a[88:91], v149 offset:40960
    v_mfma_f32_16x16x32_bf16 v[60:63], a[44:47], a[68:71], v[60:63]
    ds_read_b128 a[92:95], v149 offset:43008
    v_mfma_f32_16x16x32_bf16 v[64:67], a[48:51], a[64:67], v[64:67]
    ds_read_b128 a[96:99], v149 offset:45056
    buffer_load_dwordx4 v21, s[12:15], s36 offen offset:1024 lds
    v_mfma_f32_16x16x32_bf16 v[68:71], a[48:51], a[68:71], v[68:71]
    ds_read_b128 a[100:103], v149 offset:47104
    v_mfma_f32_16x16x32_bf16 v[72:75], a[52:55], a[64:67], v[72:75]
    buffer_load_dwordx4 v22, s[12:15], s36 offen offset:2048 lds
    v_mfma_f32_16x16x32_bf16 v[76:79], a[52:55], a[68:71], v[76:79]
    v_mfma_f32_16x16x32_bf16 v[80:83], a[56:59], a[64:67], v[80:83]
    v_mfma_f32_16x16x32_bf16 v[84:87], a[56:59], a[68:71], v[84:87]
    buffer_load_dwordx4 v23, s[12:15], s36 offen offset:3072 lds
    v_mfma_f32_16x16x32_bf16 v[88:91], a[60:63], a[64:67], v[88:91]
    v_mfma_f32_16x16x32_bf16 v[92:95], a[60:63], a[68:71], v[92:95]
    s_waitcnt lgkmcnt(0) vmcnt(16)
    s_barrier
    v_mfma_f32_16x16x32_bf16 v[32:35], a[72:75], a[104:107], v[32:35]
    ds_read_b128 a[64:67], v26 offset:0
    v_lshlrev_b32 v217, 3, v0
    v_mfma_f32_16x16x32_bf16 v[36:39], a[72:75], a[108:111], v[36:39]
    ds_read_b128 a[68:71], v26 offset:8192
    s_lshl_b32 s68, s34, 9
    v_mfma_f32_16x16x32_bf16 v[40:43], a[76:79], a[104:107], v[40:43]
    ds_read_b128 a[32:35], v24 offset:0
    s_add_u32 s68, s68, 22347776
    v_mfma_f32_16x16x32_bf16 v[44:47], a[76:79], a[108:111], v[44:47]
    ds_read_b128 a[36:39], v24 offset:2048
    v_mfma_f32_16x16x32_bf16 v[48:51], a[80:83], a[104:107], v[48:51]
    ds_read_b128 a[40:43], v24 offset:4096
    buffer_load_dword v216, v217, s[24:27], s68 offen sc1
    v_mfma_f32_16x16x32_bf16 v[52:55], a[80:83], a[108:111], v[52:55]
    ds_read_b128 a[44:47], v24 offset:6144
    s_bfe_u32 s36, s67, 262172
    v_mfma_f32_16x16x32_bf16 v[56:59], a[84:87], a[104:107], v[56:59]
    ds_read_b128 a[48:51], v24 offset:8192
    v_mfma_f32_16x16x32_bf16 v[60:63], a[84:87], a[108:111], v[60:63]
    ds_read_b128 a[52:55], v24 offset:10240
    s_add_u32 m0, s37, 98304
    v_mfma_f32_16x16x32_bf16 v[64:67], a[88:91], a[104:107], v[64:67]
    ds_read_b128 a[56:59], v24 offset:12288
    s_lshl_b32 s36, s36, 7
    v_mfma_f32_16x16x32_bf16 v[68:71], a[88:91], a[108:111], v[68:71]
    ds_read_b128 a[60:63], v24 offset:14336
    v_mfma_f32_16x16x32_bf16 v[72:75], a[92:95], a[104:107], v[72:75]
    buffer_load_dwordx4 v16, s[8:11], s36 offen offset:0 lds
    v_mfma_f32_16x16x32_bf16 v[76:79], a[92:95], a[108:111], v[76:79]
    buffer_load_dwordx4 v17, s[8:11], s36 offen offset:1024 lds
    v_mfma_f32_16x16x32_bf16 v[80:83], a[96:99], a[104:107], v[80:83]
    v_mfma_f32_16x16x32_bf16 v[84:87], a[96:99], a[108:111], v[84:87]
    buffer_load_dwordx4 v18, s[8:11], s36 offen offset:2048 lds
    v_mfma_f32_16x16x32_bf16 v[88:91], a[100:103], a[104:107], v[88:91]
    buffer_load_dwordx4 v19, s[8:11], s36 offen offset:3072 lds
    v_mfma_f32_16x16x32_bf16 v[92:95], a[100:103], a[108:111], v[92:95]
    s_waitcnt lgkmcnt(0)
    v_mfma_f32_16x16x32_bf16 v[32:35], a[32:35], a[64:67], v[32:35]
    ds_read_b128 a[104:107], v27 offset:0
    s_add_u32 m0, s37, 114688
    v_and_b32 v6, 7, v0
    v_xor_b32_e64 v6, v6, v2
    v_mfma_f32_16x16x32_bf16 v[36:39], a[32:35], a[68:71], v[36:39]
    ds_read_b128 a[108:111], v27 offset:8192
    buffer_load_dwordx4 v20, s[12:15], s36 offen offset:0 lds
    s_and_b32 s38, s33, 8
    s_lshl_b32 s38, s38, 7
    v_mfma_f32_16x16x32_bf16 v[40:43], a[36:39], a[64:67], v[40:43]
    ds_read_b128 a[72:75], v25 offset:0
    buffer_load_dwordx4 v21, s[12:15], s36 offen offset:1024 lds
    v_lshl_add_u32 v6, v6, 4, s38
    v_lshrrev_b32_e64 v8, 3, v0
    v_mfma_f32_16x16x32_bf16 v[44:47], a[36:39], a[68:71], v[44:47]
    ds_read_b128 a[76:79], v25 offset:2048
    s_xor_b32 s38, s33, 8
    v_mfma_f32_16x16x32_bf16 v[48:51], a[40:43], a[64:67], v[48:51]
    ds_read_b128 a[80:83], v25 offset:4096
    buffer_load_dwordx4 v22, s[12:15], s36 offen offset:2048 lds
    s_lshl_b32 s38, s38, 5
    s_add_u32 s38, s38, s6
    v_mfma_f32_16x16x32_bf16 v[52:55], a[40:43], a[68:71], v[52:55]
    ds_read_b128 a[84:87], v25 offset:6144
    buffer_load_dwordx4 v23, s[12:15], s36 offen offset:3072 lds
    s_lshl_b32 s38, s38, 1
    v_lshl_add_u32 v8, v8, 2, s38
    v_mfma_f32_16x16x32_bf16 v[56:59], a[44:47], a[64:67], v[56:59]
    ds_read_b128 a[88:91], v25 offset:8192
    v_lshl_add_u32 v16, v8, 11, v6
    v_mfma_f32_16x16x32_bf16 v[60:63], a[44:47], a[68:71], v[60:63]
    ds_read_b128 a[92:95], v25 offset:10240
    s_getpc_b64 s[20:21]
K_PC2:
    s_mov_b32 s22, K_CODE_END-K_PC2
    v_xor_b32 v8, 64, v16
    v_add_u32 v17, 64512, v8
    v_mfma_f32_16x16x32_bf16 v[64:67], a[48:51], a[64:67], v[64:67]
    ds_read_b128 a[96:99], v25 offset:12288
    s_bfe_u32 s3, s2, 0x20003
    v_mov_b32_e64 v18, v16
    v_add_u32 v19, 64512, v8
    v_mfma_f32_16x16x32_bf16 v[68:71], a[48:51], a[68:71], v[68:71]
    ds_read_b128 a[100:103], v25 offset:14336
    s_lshl1_add_u32 s40, s33, s6
    v_mfma_f32_16x16x32_bf16 v[72:75], a[52:55], a[64:67], v[72:75]
    s_lshl2_add_u32 s3, s3, s34
    s_lshl_b32 s40, s40, 6
    s_lshr_b32 s41, s33, 3
    v_mfma_f32_16x16x32_bf16 v[76:79], a[52:55], a[68:71], v[76:79]
    s_lshl_b32 s3, s3, 11
    s_add_u32 s40, s40, s41
    s_and_b32 s41, s32, 3
    v_mfma_f32_16x16x32_bf16 v[80:83], a[56:59], a[64:67], v[80:83]
    s_lshl2_add_u32 s40, s40, s41
    v_mfma_f32_16x16x32_bf16 v[84:87], a[56:59], a[68:71], v[84:87]
    v_lshl_add_u32 v28, v0, 5, s3
    s_and_b32 s41, s2, 1
    s_lshl1_add_u32 s40, s40, s41
    v_mfma_f32_16x16x32_bf16 v[88:91], a[60:63], a[64:67], v[88:91]
    buffer_load_dword a221, v28, s[20:23], 0 offen
    s_lshl_b32 s92, s40, 7
    v_lshrrev_b32 v29, 1, v0
    v_mfma_f32_16x16x32_bf16 v[92:95], a[60:63], a[68:71], v[92:95]
    v_lshlrev_b32 v29, 11, v29
    s_waitcnt lgkmcnt(0) vmcnt(9)
    v_cmp_ne_u32 vcc, s35, v216
    s_nop 0
    s_cbranch_vccnz K_POLL1
K_POLL1_OK:
    s_barrier
    v_mfma_f32_16x16x32_bf16 v[32:35], a[72:75], a[104:107], v[32:35]
    ds_read_b128 a[64:67], v26 offset:32768
    v_lshlrev_b32_e64 v28, 12, v2
    v_mfma_f32_16x16x32_bf16 v[36:39], a[72:75], a[108:111], v[36:39]
    ds_read_b128 a[68:71], v26 offset:40960
    v_lshl_add_u32 v28, v1, 4, v28
    v_mfma_f32_16x16x32_bf16 v[40:43], a[76:79], a[104:107], v[40:43]
    ds_read_b128 a[32:35], v24 offset:32768
    s_lshl4_add_u32 s68, s37, s5
    v_mfma_f32_16x16x32_bf16 v[44:47], a[76:79], a[108:111], v[44:47]
    ds_read_b128 a[36:39], v24 offset:34816
    s_add_u32 m0, s37, 131072
    v_mfma_f32_16x16x32_bf16 v[48:51], a[80:83], a[104:107], v[48:51]
    ds_read_b128 a[40:43], v24 offset:36864
    s_add_u32 s69, s68, 0
    v_mfma_f32_16x16x32_bf16 v[52:55], a[80:83], a[108:111], v[52:55]
    ds_read_b128 a[44:47], v24 offset:38912
    v_mfma_f32_16x16x32_bf16 v[56:59], a[84:87], a[104:107], v[56:59]
    ds_read_b128 a[48:51], v24 offset:40960
    buffer_load_dwordx4 v28, s[28:31], s69 offen sc1 lds
    v_mfma_f32_16x16x32_bf16 v[60:63], a[84:87], a[108:111], v[60:63]
    ds_read_b128 a[52:55], v24 offset:43008
    s_add_u32 m0, s37, 132096
    v_mfma_f32_16x16x32_bf16 v[64:67], a[88:91], a[104:107], v[64:67]
    ds_read_b128 a[56:59], v24 offset:45056
    s_add_u32 s69, s68, 16384
    v_mfma_f32_16x16x32_bf16 v[68:71], a[88:91], a[108:111], v[68:71]
    ds_read_b128 a[60:63], v24 offset:47104
    buffer_load_dwordx4 v28, s[28:31], s69 offen sc1 lds
    v_mfma_f32_16x16x32_bf16 v[72:75], a[92:95], a[104:107], v[72:75]
    v_mfma_f32_16x16x32_bf16 v[76:79], a[92:95], a[108:111], v[76:79]
    s_add_u32 m0, s37, 133120
    v_mfma_f32_16x16x32_bf16 v[80:83], a[96:99], a[104:107], v[80:83]
    s_add_u32 s69, s68, 32768
    v_mfma_f32_16x16x32_bf16 v[84:87], a[96:99], a[108:111], v[84:87]
    buffer_load_dwordx4 v28, s[28:31], s69 offen sc1 lds
    v_mfma_f32_16x16x32_bf16 v[88:91], a[100:103], a[104:107], v[88:91]
    s_add_u32 m0, s37, 134144
    v_mfma_f32_16x16x32_bf16 v[92:95], a[100:103], a[108:111], v[92:95]
    s_waitcnt lgkmcnt(0)
    v_mfma_f32_16x16x32_bf16 v[32:35], a[32:35], a[64:67], v[32:35]
    ds_read_b128 a[104:107], v27 offset:32768
    s_add_u32 s69, s68, 49152
    v_mfma_f32_16x16x32_bf16 v[36:39], a[32:35], a[68:71], v[36:39]
    ds_read_b128 a[108:111], v27 offset:40960
    buffer_load_dwordx4 v28, s[28:31], s69 offen sc1 lds
    v_mfma_f32_16x16x32_bf16 v[40:43], a[36:39], a[64:67], v[40:43]
    ds_read_b128 a[72:75], v25 offset:32768
    s_add_u32 s69, s68, 262144
    v_mfma_f32_16x16x32_bf16 v[44:47], a[36:39], a[68:71], v[44:47]
    ds_read_b128 a[76:79], v25 offset:34816
    buffer_load_dwordx4 v[200:203], v28, s[28:31], s69 offen sc1
    v_mfma_f32_16x16x32_bf16 v[48:51], a[40:43], a[64:67], v[48:51]
    ds_read_b128 a[80:83], v25 offset:36864
    s_add_u32 s69, s68, 278528
    v_mfma_f32_16x16x32_bf16 v[52:55], a[40:43], a[68:71], v[52:55]
    ds_read_b128 a[84:87], v25 offset:38912
    v_mfma_f32_16x16x32_bf16 v[56:59], a[44:47], a[64:67], v[56:59]
    ds_read_b128 a[88:91], v25 offset:40960
    buffer_load_dwordx4 v[204:207], v28, s[28:31], s69 offen sc1
    v_mfma_f32_16x16x32_bf16 v[60:63], a[44:47], a[68:71], v[60:63]
    ds_read_b128 a[92:95], v25 offset:43008
    s_add_u32 s69, s68, 294912
    v_mfma_f32_16x16x32_bf16 v[64:67], a[48:51], a[64:67], v[64:67]
    ds_read_b128 a[96:99], v25 offset:45056
    buffer_load_dwordx4 v[208:211], v28, s[28:31], s69 offen sc1
    v_mfma_f32_16x16x32_bf16 v[68:71], a[48:51], a[68:71], v[68:71]
    ds_read_b128 a[100:103], v25 offset:47104
    s_add_u32 s69, s68, 311296
    v_mfma_f32_16x16x32_bf16 v[72:75], a[52:55], a[64:67], v[72:75]
    v_mfma_f32_16x16x32_bf16 v[76:79], a[52:55], a[68:71], v[76:79]
    buffer_load_dwordx4 v[212:215], v28, s[28:31], s69 offen sc1
    v_mfma_f32_16x16x32_bf16 v[80:83], a[56:59], a[64:67], v[80:83]
    s_cmp_eq_u32 s2, 0
    s_cbranch_scc1 K_W256
K_W256_RET:
    v_mfma_f32_16x16x32_bf16 v[84:87], a[56:59], a[68:71], v[84:87]
    v_lshlrev_b32 v28, 6, v1
    v_mfma_f32_16x16x32_bf16 v[88:91], a[60:63], a[64:67], v[88:91]
    buffer_load_dword a222, v28, s[24:27], s51 offen sc1
    v_mfma_f32_16x16x32_bf16 v[92:95], a[60:63], a[68:71], v[92:95]
    s_waitcnt lgkmcnt(0)
    s_barrier
    v_mfma_f32_16x16x32_bf16 v[32:35], a[72:75], a[104:107], v[32:35]
    ds_read_b128 a[64:67], v150 offset:0
    v_and_b32_e64 v14, 8, v1
    v_mfma_f32_16x16x32_bf16 v[36:39], a[72:75], a[108:111], v[36:39]
    ds_read_b128 a[68:71], v150 offset:8192
    v_and_b32_e64 v15, 3, v1
    v_mfma_f32_16x16x32_bf16 v[40:43], a[76:79], a[104:107], v[40:43]
    ds_read_b128 a[32:35], v148 offset:0
    v_lshl_or_b32 v14, v15, 1, v14
    v_mfma_f32_16x16x32_bf16 v[44:47], a[76:79], a[108:111], v[44:47]
    ds_read_b128 a[36:39], v148 offset:2048
    v_bfe_u32 v15, v1, 2, 1
    v_mfma_f32_16x16x32_bf16 v[48:51], a[80:83], a[104:107], v[48:51]
    ds_read_b128 a[40:43], v148 offset:4096
    v_lshlrev_b32_e64 v13, 2, v2
    v_mfma_f32_16x16x32_bf16 v[52:55], a[80:83], a[108:111], v[52:55]
    ds_read_b128 a[44:47], v148 offset:6144
    v_or_b32_e64 v14, v14, v15
    v_mfma_f32_16x16x32_bf16 v[56:59], a[84:87], a[104:107], v[56:59]
    ds_read_b128 a[48:51], v148 offset:8192
    v_xor_b32_e64 v14, v14, v13
    v_mfma_f32_16x16x32_bf16 v[60:63], a[84:87], a[108:111], v[60:63]
    ds_read_b128 a[52:55], v148 offset:10240
    v_lshl_add_u32 v14, v1, 4, v14
    v_mfma_f32_16x16x32_bf16 v[64:67], a[88:91], a[104:107], v[64:67]
    ds_read_b128 a[56:59], v148 offset:12288
    s_lshl1_add_u32 s38, s37, 131072
    v_mfma_f32_16x16x32_bf16 v[68:71], a[88:91], a[108:111], v[68:71]
    ds_read_b128 a[60:63], v148 offset:14336
    v_lshl_add_u32 v216, v14, 4, s38
    v_mfma_f32_16x16x32_bf16 v[72:75], a[92:95], a[104:107], v[72:75]
    v_xor_b32_e64 v217, 16, v216
    v_mfma_f32_16x16x32_bf16 v[76:79], a[92:95], a[108:111], v[76:79]
    v_xor_b32_e64 v218, 32, v216
    v_mfma_f32_16x16x32_bf16 v[80:83], a[96:99], a[104:107], v[80:83]
    v_xor_b32_e64 v219, 48, v216
    v_mfma_f32_16x16x32_bf16 v[84:87], a[96:99], a[108:111], v[84:87]
    v_and_b32_e64 v14, 1, v2
    v_mfma_f32_16x16x32_bf16 v[88:91], a[100:103], a[104:107], v[88:91]
    v_lshrrev_b32_e64 v15, 2, v1
    v_mfma_f32_16x16x32_bf16 v[92:95], a[100:103], a[108:111], v[92:95]
    s_waitcnt lgkmcnt(0)
    v_mfma_f32_16x16x32_bf16 v[32:35], a[32:35], a[64:67], v[32:35]
    ds_read_b128 a[104:107], v151 offset:0
    v_lshl_add_u32 v12, v2, 3, v15
    v_mfma_f32_16x16x32_bf16 v[36:39], a[32:35], a[68:71], v[36:39]
    ds_read_b128 a[108:111], v151 offset:8192
    v_lshlrev_b32 v14, 3, v14
    v_mfma_f32_16x16x32_bf16 v[40:43], a[36:39], a[64:67], v[40:43]
    ds_read_b128 a[72:75], v149 offset:0
    v_lshl_or_b32 v14, v15, 1, v14
    v_mfma_f32_16x16x32_bf16 v[44:47], a[36:39], a[68:71], v[44:47]
    ds_read_b128 a[76:79], v149 offset:2048
    v_bfe_u32 v15, v1, 1, 1
    v_mfma_f32_16x16x32_bf16 v[48:51], a[40:43], a[64:67], v[48:51]
    ds_read_b128 a[80:83], v149 offset:4096
    v_xor_b32_e64 v14, v14, v15
    v_mfma_f32_16x16x32_bf16 v[52:55], a[40:43], a[68:71], v[52:55]
    ds_read_b128 a[84:87], v149 offset:6144
    v_lshl_add_u32 v12, v12, 4, v14
    v_mfma_f32_16x16x32_bf16 v[56:59], a[44:47], a[64:67], v[56:59]
    ds_read_b128 a[88:91], v149 offset:8192
    v_and_b32_e64 v15, 1, v1
    v_mfma_f32_16x16x32_bf16 v[60:63], a[44:47], a[68:71], v[60:63]
    ds_read_b128 a[92:95], v149 offset:10240
    v_lshl_add_u32 v12, v12, 1, v15
    v_mfma_f32_16x16x32_bf16 v[64:67], a[48:51], a[64:67], v[64:67]
    ds_read_b128 a[96:99], v149 offset:12288
    s_lshl_b32 s38, s94, 5
    v_mfma_f32_16x16x32_bf16 v[68:71], a[48:51], a[68:71], v[68:71]
    ds_read_b128 a[100:103], v149 offset:14336
    s_add_u32 s38, s38, 131072
    v_mfma_f32_16x16x32_bf16 v[72:75], a[52:55], a[64:67], v[72:75]
    v_lshlrev_b32 v12, 3, v12
    v_mfma_f32_16x16x32_bf16 v[76:79], a[52:55], a[68:71], v[76:79]
    v_xor_b32_e64 v220, s38, v12
    v_mfma_f32_16x16x32_bf16 v[80:83], a[56:59], a[64:67], v[80:83]
    v_xor_b32_e64 v221, 16, v220
    v_mfma_f32_16x16x32_bf16 v[84:87], a[56:59], a[68:71], v[84:87]
    v_xor_b32_e64 v222, 64, v220
    v_mfma_f32_16x16x32_bf16 v[88:91], a[60:63], a[64:67], v[88:91]
    v_xor_b32 v223, 80, v220
    v_mfma_f32_16x16x32_bf16 v[92:95], a[60:63], a[68:71], v[92:95]
    s_waitcnt lgkmcnt(0) vmcnt(10)
    s_barrier
    v_mfma_f32_16x16x32_bf16 v[32:35], a[72:75], a[104:107], v[32:35]
    ds_read_b128 a[64:67], v150 offset:32768
    s_bfe_u32 s72, s97, 262148
    v_and_b32_e64 v8, 1, v2
    v_mfma_f32_16x16x32_bf16 v[36:39], a[72:75], a[108:111], v[36:39]
    ds_read_b128 a[68:71], v150 offset:40960
    v_lshrrev_b32_e64 v9, 1, v1
    v_mfma_f32_16x16x32_bf16 v[40:43], a[76:79], a[104:107], v[40:43]
    ds_read_b128 a[32:35], v148 offset:32768
    v_xor_b32_e64 v8, v8, v9
    v_mfma_f32_16x16x32_bf16 v[44:47], a[76:79], a[108:111], v[44:47]
    ds_read_b128 a[36:39], v148 offset:34816
    v_lshlrev_b32_e64 v8, 4, v8
    v_mfma_f32_16x16x32_bf16 v[48:51], a[80:83], a[104:107], v[48:51]
    ds_read_b128 a[40:43], v148 offset:36864
    s_add_u32 m0, s37, 16384
    v_lshl_add_u32 v8, v1, 7, v8
    v_mfma_f32_16x16x32_bf16 v[52:55], a[80:83], a[108:111], v[52:55]
    ds_read_b128 a[44:47], v148 offset:38912
    v_lshrrev_b32_e64 v9, 1, v2
    v_mfma_f32_16x16x32_bf16 v[56:59], a[84:87], a[104:107], v[56:59]
    ds_read_b128 a[48:51], v148 offset:40960
    v_lshl_add_u32 v20, v9, 13, v8
    v_mfma_f32_16x16x32_bf16 v[60:63], a[84:87], a[108:111], v[60:63]
    ds_read_b128 a[52:55], v148 offset:43008
    v_lshlrev_b32_e64 v9, 12, v2
    v_mfma_f32_16x16x32_bf16 v[64:67], a[88:91], a[104:107], v[64:67]
    ds_read_b128 a[56:59], v148 offset:45056
    s_lshl_b32 s72, s72, 7
    v_lshl_add_u32 v24, v1, 4, v9
    v_mfma_f32_16x16x32_bf16 v[68:71], a[88:91], a[108:111], v[68:71]
    ds_read_b128 a[60:63], v148 offset:47104
    v_xor_b32 v21, 32, v20
    v_mfma_f32_16x16x32_bf16 v[72:75], a[92:95], a[104:107], v[72:75]
    v_add_u32 v25, 16384, v24
    v_mfma_f32_16x16x32_bf16 v[76:79], a[92:95], a[108:111], v[76:79]
    v_xor_b32_e64 v22, 64, v20
    v_mfma_f32_16x16x32_bf16 v[80:83], a[96:99], a[104:107], v[80:83]
    buffer_load_dwordx4 v16, s[16:19], s72 offen offset:0  lds
    v_add_u32 v26, 32768, v24
    v_mfma_f32_16x16x32_bf16 v[84:87], a[96:99], a[108:111], v[84:87]
    v_xor_b32 v23, 96, v20
    v_mfma_f32_16x16x32_bf16 v[88:91], a[100:103], a[104:107], v[88:91]
    v_add_u32 v27, 49152, v24
    v_mfma_f32_16x16x32_bf16 v[92:95], a[100:103], a[108:111], v[92:95]
    s_waitcnt lgkmcnt(0)
    v_mfma_f32_16x16x32_bf16 v[32:35], a[32:35], a[64:67], v[32:35]
    ds_read_b128 a[104:107], v151 offset:32768
    buffer_load_dwordx4 v17, s[16:19], s72 offen offset:1024  lds
    v_add_u32 v28, 131072, v3
    v_mfma_f32_16x16x32_bf16 v[36:39], a[32:35], a[68:71], v[36:39]
    ds_read_b128 a[108:111], v151 offset:40960
    v_mfma_f32_16x16x32_bf16 v[40:43], a[36:39], a[64:67], v[40:43]
    ds_read_b128 a[72:75], v149 offset:32768
    v_mfma_f32_16x16x32_bf16 v[44:47], a[36:39], a[68:71], v[44:47]
    ds_read_b128 a[76:79], v149 offset:34816
    v_mfma_f32_16x16x32_bf16 v[48:51], a[40:43], a[64:67], v[48:51]
    ds_read_b128 a[80:83], v149 offset:36864
    v_mfma_f32_16x16x32_bf16 v[52:55], a[40:43], a[68:71], v[52:55]
    ds_read_b128 a[84:87], v149 offset:38912
    buffer_load_dwordx4 v18, s[16:19], s72 offen offset:2048  lds
    v_mfma_f32_16x16x32_bf16 v[56:59], a[44:47], a[64:67], v[56:59]
    ds_read_b128 a[88:91], v149 offset:40960
    v_mfma_f32_16x16x32_bf16 v[60:63], a[44:47], a[68:71], v[60:63]
    ds_read_b128 a[92:95], v149 offset:43008
    v_mfma_f32_16x16x32_bf16 v[64:67], a[48:51], a[64:67], v[64:67]
    ds_read_b128 a[96:99], v149 offset:45056
    v_mfma_f32_16x16x32_bf16 v[68:71], a[48:51], a[68:71], v[68:71]
    ds_read_b128 a[100:103], v149 offset:47104
    v_mfma_f32_16x16x32_bf16 v[72:75], a[52:55], a[64:67], v[72:75]
    buffer_load_dwordx4 v19, s[16:19], s72 offen offset:3072  lds
    v_mfma_f32_16x16x32_bf16 v[76:79], a[52:55], a[68:71], v[76:79]
    v_mfma_f32_16x16x32_bf16 v[80:83], a[56:59], a[64:67], v[80:83]
    v_mfma_f32_16x16x32_bf16 v[84:87], a[56:59], a[68:71], v[84:87]
    v_mfma_f32_16x16x32_bf16 v[88:91], a[60:63], a[64:67], v[88:91]
    v_mfma_f32_16x16x32_bf16 v[92:95], a[60:63], a[68:71], v[92:95]
    s_waitcnt lgkmcnt(0) vmcnt(9)
    s_barrier
    v_mfma_f32_16x16x32_bf16 v[32:35], a[72:75], a[104:107], v[32:35]
    ds_read_b128 a[32:35], v28 offset:0
    v_lshlrev_b32 v12, 2, v2
    v_sub_u32_e64 v12, s32, v12
    v_mfma_f32_16x16x32_bf16 v[36:39], a[72:75], a[108:111], v[36:39]
    ds_read_b128 a[36:39], v28 offset:1024
    v_lshlrev_b32_e64 v12, 10, v12
    v_mfma_f32_16x16x32_bf16 v[40:43], a[76:79], a[104:107], v[40:43]
    ds_read_b128 a[40:43], v28 offset:2048
    v_lshl_add_u32 v12, v1, 4, v12
    v_mfma_f32_16x16x32_bf16 v[44:47], a[76:79], a[108:111], v[44:47]
    v_subrev_u32 v148, 1024, v12
    v_mfma_f32_16x16x32_bf16 v[48:51], a[80:83], a[104:107], v[48:51]
    ds_read_b128 a[44:47], v28 offset:3072
    v_min_u32_e64 v148, 2.0, v148
    v_subrev_u32 v149, 2048, v12
    v_mfma_f32_16x16x32_bf16 v[52:55], a[80:83], a[108:111], v[52:55]
    ds_read_b128 a[48:51], v28 offset:4096
    v_min_u32_e64 v149, 2.0, v149
    v_mfma_f32_16x16x32_bf16 v[56:59], a[84:87], a[104:107], v[56:59]
    ds_read_b128 a[52:55], v28 offset:5120
    v_subrev_u32 v150, 3072, v12
    v_mfma_f32_16x16x32_bf16 v[60:63], a[84:87], a[108:111], v[60:63]
    v_min_u32_e64 v150, 2.0, v150
    v_mfma_f32_16x16x32_bf16 v[64:67], a[88:91], a[104:107], v[64:67]
    ds_read_b128 a[56:59], v28 offset:6144
    v_subrev_u32 v151, 4096, v12
    v_min_u32_e64 v151, 2.0, v151
    v_mfma_f32_16x16x32_bf16 v[68:71], a[88:91], a[108:111], v[68:71]
    ds_read_b128 a[60:63], v28 offset:7168
    v_mov_b32_e64 v186, s35
    v_mfma_f32_16x16x32_bf16 v[72:75], a[92:95], a[104:107], v[72:75]
    v_mov_b32_e64 v187, s35
    v_mfma_f32_16x16x32_bf16 v[76:79], a[92:95], a[108:111], v[76:79]
    s_lshl_b32 s38, s32, 10
    v_mfma_f32_16x16x32_bf16 v[80:83], a[96:99], a[104:107], v[80:83]
    s_add_u32 s38, s38, s93
    v_cmp_gt_u32 s[78:79], 16, v0
    v_mfma_f32_16x16x32_bf16 v[84:87], a[96:99], a[108:111], v[84:87]
    v_cmp_eq_u32 s[46:47], 2, v2
    v_mfma_f32_16x16x32_bf16 v[88:91], a[100:103], a[104:107], v[88:91]
    v_cmp_eq_u32 s[44:45], 3, v2
    v_mfma_f32_16x16x32_bf16 v[92:95], a[100:103], a[108:111], v[92:95]
    v_cndmask_b32 v188, 2.0, v3, s[78:79]
    v_pk_fma_f32 v[4:5], v[32:33], v[128:129], v[34:35] op_sel_hi:[1,0,1]
    v_pk_fma_f32 v[6:7], v[36:37], v[128:129], v[38:39] op_sel_hi:[1,0,1]
    v_pk_fma_f32 v[4:5], v[36:37], v[128:129], v[4:5] op_sel:[0,1,0] neg_lo:[1,0,0] neg_hi:[1,0,0]
    v_pk_fma_f32 v[6:7], v[32:33], v[128:129], v[6:7] op_sel:[0,1,0]
    v_pk_fma_f32 v[8:9], v[4:5], v[128:129], v[40:41] op_sel_hi:[1,0,1]
    v_pk_fma_f32 v[10:11], v[6:7], v[128:129], v[44:45] op_sel_hi:[1,0,1]
    v_pk_fma_f32 v[8:9], v[6:7], v[128:129], v[8:9] op_sel:[0,1,0] neg_lo:[1,0,0] neg_hi:[1,0,0]
    v_pk_fma_f32 v[10:11], v[4:5], v[128:129], v[10:11] op_sel:[0,1,0]
    v_pk_fma_f32 v[4:5], v[8:9], v[128:129], v[42:43] op_sel_hi:[1,0,1]
    v_pk_fma_f32 v[6:7], v[10:11], v[128:129], v[46:47] op_sel_hi:[1,0,1]
    v_pk_fma_f32 v[4:5], v[10:11], v[128:129], v[4:5] op_sel:[0,1,0] neg_lo:[1,0,0] neg_hi:[1,0,0]
    v_pk_fma_f32 v[6:7], v[8:9], v[128:129], v[6:7] op_sel:[0,1,0]
    v_pk_fma_f32 v[8:9], v[4:5], v[128:129], v[48:49] op_sel_hi:[1,0,1]
    v_pk_fma_f32 v[10:11], v[6:7], v[128:129], v[52:53] op_sel_hi:[1,0,1]
    v_pk_fma_f32 v[8:9], v[6:7], v[128:129], v[8:9] op_sel:[0,1,0] neg_lo:[1,0,0] neg_hi:[1,0,0]
    v_pk_fma_f32 v[10:11], v[4:5], v[128:129], v[10:11] op_sel:[0,1,0]
    v_pk_fma_f32 v[4:5], v[8:9], v[128:129], v[50:51] op_sel_hi:[1,0,1]
    v_pk_fma_f32 v[6:7], v[10:11], v[128:129], v[54:55] op_sel_hi:[1,0,1]
    v_pk_fma_f32 v[4:5], v[10:11], v[128:129], v[4:5] op_sel:[0,1,0] neg_lo:[1,0,0] neg_hi:[1,0,0]
    v_pk_fma_f32 v[6:7], v[8:9], v[128:129], v[6:7] op_sel:[0,1,0]
    v_pk_fma_f32 v[8:9], v[4:5], v[128:129], v[56:57] op_sel_hi:[1,0,1]
    v_pk_fma_f32 v[10:11], v[6:7], v[128:129], v[60:61] op_sel_hi:[1,0,1]
    v_pk_fma_f32 v[8:9], v[6:7], v[128:129], v[8:9] op_sel:[0,1,0] neg_lo:[1,0,0] neg_hi:[1,0,0]
    v_pk_fma_f32 v[10:11], v[4:5], v[128:129], v[10:11] op_sel:[0,1,0]
    v_pk_fma_f32 v[4:5], v[8:9], v[128:129], v[58:59] op_sel_hi:[1,0,1]
    v_pk_fma_f32 v[6:7], v[10:11], v[128:129], v[62:63] op_sel_hi:[1,0,1]
    v_pk_fma_f32 v[4:5], v[10:11], v[128:129], v[4:5] op_sel:[0,1,0] neg_lo:[1,0,0] neg_hi:[1,0,0]
    v_pk_fma_f32 v[6:7], v[8:9], v[128:129], v[6:7] op_sel:[0,1,0]
    v_pk_fma_f32 v[8:9], v[4:5], v[128:129], v[64:65] op_sel_hi:[1,0,1]
    v_pk_fma_f32 v[10:11], v[6:7], v[128:129], v[68:69] op_sel_hi:[1,0,1]
    v_pk_fma_f32 v[8:9], v[6:7], v[128:129], v[8:9] op_sel:[0,1,0] neg_lo:[1,0,0] neg_hi:[1,0,0]
    v_pk_fma_f32 v[10:11], v[4:5], v[128:129], v[10:11] op_sel:[0,1,0]
    v_pk_fma_f32 v[4:5], v[8:9], v[128:129], v[66:67] op_sel_hi:[1,0,1]
    v_pk_fma_f32 v[6:7], v[10:11], v[128:129], v[70:71] op_sel_hi:[1,0,1]
    v_pk_fma_f32 v[4:5], v[10:11], v[128:129], v[4:5] op_sel:[0,1,0] neg_lo:[1,0,0] neg_hi:[1,0,0]
    v_pk_fma_f32 v[6:7], v[8:9], v[128:129], v[6:7] op_sel:[0,1,0]
    v_pk_fma_f32 v[8:9], v[4:5], v[128:129], v[72:73] op_sel_hi:[1,0,1]
    v_pk_fma_f32 v[10:11], v[6:7], v[128:129], v[76:77] op_sel_hi:[1,0,1]
    v_pk_fma_f32 v[8:9], v[6:7], v[128:129], v[8:9] op_sel:[0,1,0] neg_lo:[1,0,0] neg_hi:[1,0,0]
    v_pk_fma_f32 v[10:11], v[4:5], v[128:129], v[10:11] op_sel:[0,1,0]
    v_pk_fma_f32 v[4:5], v[8:9], v[128:129], v[74:75] op_sel_hi:[1,0,1]
    v_pk_fma_f32 v[6:7], v[10:11], v[128:129], v[78:79] op_sel_hi:[1,0,1]
    v_pk_fma_f32 v[4:5], v[10:11], v[128:129], v[4:5] op_sel:[0,1,0] neg_lo:[1,0,0] neg_hi:[1,0,0]
    v_pk_fma_f32 v[6:7], v[8:9], v[128:129], v[6:7] op_sel:[0,1,0]
    v_pk_fma_f32 v[8:9], v[4:5], v[128:129], v[80:81] op_sel_hi:[1,0,1]
    v_pk_fma_f32 v[10:11], v[6:7], v[128:129], v[84:85] op_sel_hi:[1,0,1]
    v_pk_fma_f32 v[8:9], v[6:7], v[128:129], v[8:9] op_sel:[0,1,0] neg_lo:[1,0,0] neg_hi:[1,0,0]
    v_pk_fma_f32 v[10:11], v[4:5], v[128:129], v[10:11] op_sel:[0,1,0]
    v_pk_fma_f32 v[4:5], v[8:9], v[128:129], v[82:83] op_sel_hi:[1,0,1]
    v_pk_fma_f32 v[6:7], v[10:11], v[128:129], v[86:87] op_sel_hi:[1,0,1]
    v_pk_fma_f32 v[4:5], v[10:11], v[128:129], v[4:5] op_sel:[0,1,0] neg_lo:[1,0,0] neg_hi:[1,0,0]
    v_pk_fma_f32 v[6:7], v[8:9], v[128:129], v[6:7] op_sel:[0,1,0]
    v_pk_fma_f32 v[8:9], v[4:5], v[128:129], v[88:89] op_sel_hi:[1,0,1]
    v_pk_fma_f32 v[10:11], v[6:7], v[128:129], v[92:93] op_sel_hi:[1,0,1]
    v_pk_fma_f32 v[8:9], v[6:7], v[128:129], v[8:9] op_sel:[0,1,0] neg_lo:[1,0,0] neg_hi:[1,0,0]
    v_pk_fma_f32 v[10:11], v[4:5], v[128:129], v[10:11] op_sel:[0,1,0]
    v_pk_fma_f32 v[4:5], v[8:9], v[128:129], v[90:91] op_sel_hi:[1,0,1]
    v_pk_fma_f32 v[6:7], v[10:11], v[128:129], v[94:95] op_sel_hi:[1,0,1]
    v_pk_fma_f32 v[4:5], v[10:11], v[128:129], v[4:5] op_sel:[0,1,0] neg_lo:[1,0,0] neg_hi:[1,0,0]
    v_pk_fma_f32 v[6:7], v[8:9], v[128:129], v[6:7] op_sel:[0,1,0]
    v_pk_mul_f32 v[142:143], v[4:5], v[130:131] op_sel_hi:[1,0]
    v_pk_mul_f32 v[144:145], v[6:7], v[130:131] op_sel_hi:[1,0]
    v_pk_fma_f32 v[142:143], v[6:7], v[130:131], v[142:143] op_sel:[0,1,0] neg_lo:[1,0,0] neg_hi:[1,0,0]
    v_pk_fma_f32 v[144:145], v[4:5], v[130:131], v[144:145] op_sel:[0,1,0]
    s_waitcnt lgkmcnt(4)
    v_mfma_f32_16x16x32_bf16 v[224:227], a[32:35], a[0:3], 0
    ds_read_b128 a[64:67], v28 offset:8192
    v_fma_f32 v4, v142, v132, v143
    v_fma_f32 v8, v142, v133, v145
    v_mfma_f32_16x16x32_bf16 v[228:231], a[32:35], a[4:7], 0
    ds_read_b128 a[68:71], v28 offset:9216
    v_fma_f32 v4, -v144, v133, v4
    v_mfma_f32_16x16x32_bf16 v[224:227], a[36:39], a[8:11], v[224:227]
    ds_read_b128 a[72:75], v28 offset:10240
    v_fma_f32 v8, v144, v132, v8
    v_mov_b32 v6, v4
    v_mfma_f32_16x16x32_bf16 v[228:231], a[36:39], a[12:15], v[228:231]
    ds_read_b128 a[76:79], v28 offset:11264
    v_mov_b32_e64 v10, v8
    v_mfma_f32_16x16x32_bf16 v[224:227], a[40:43], a[16:19], v[224:227]
    ds_read_b128 a[80:83], v28 offset:12288
    v_permlane32_swap_b32 v4, v6
    v_mfma_f32_16x16x32_bf16 v[228:231], a[40:43], a[20:23], v[228:231]
    ds_read_b128 a[84:87], v28 offset:13312
    v_permlane32_swap_b32 v8, v10
    v_mov_b32_e64 v5, v4
    v_mfma_f32_16x16x32_bf16 v[224:227], a[44:47], a[24:27], v[224:227]
    ds_read_b128 a[88:91], v28 offset:14336
    v_mov_b32_e64 v7, v6
    v_mfma_f32_16x16x32_bf16 v[228:231], a[44:47], a[28:31], v[228:231]
    ds_read_b128 a[92:95], v28 offset:15360
    v_mov_b32 v9, v8
    v_mov_b32 v11, v10
    s_waitcnt lgkmcnt(8)
    s_bfe_u32 s72, s97, 262152
    v_permlane16_swap_b32 v4, v5
    v_mfma_f32_16x16x32_bf16 v[232:235], a[48:51], a[0:3], 0
    s_add_u32 m0, s37, 32768
    v_permlane16_swap_b32 v6, v7
    v_mfma_f32_16x16x32_bf16 v[236:239], a[48:51], a[4:7], 0
    v_permlane16_swap_b32 v8, v9
    v_permlane16_swap_b32 v10, v11
    v_mfma_f32_16x16x32_bf16 v[232:235], a[52:55], a[8:11], v[232:235]
    s_lshl_b32 s72, s72, 7
    v_fma_f32 v12, v4, v134, v5
    v_mfma_f32_16x16x32_bf16 v[236:239], a[52:55], a[12:15], v[236:239]
    v_fma_f32 v13, v4, v135, v9
    v_mfma_f32_16x16x32_bf16 v[232:235], a[56:59], a[16:19], v[232:235]
    buffer_load_dwordx4 v16, s[16:19], s72 offen offset:0  lds
    v_fma_f32 v12, -v8, v135, v12
    v_fma_f32 v13, v8, v134, v13
    v_mfma_f32_16x16x32_bf16 v[236:239], a[56:59], a[20:23], v[236:239]
    v_fma_f32 v14, v12, v134, v6
    v_mfma_f32_16x16x32_bf16 v[232:235], a[60:63], a[24:27], v[232:235]
    buffer_load_dwordx4 v17, s[16:19], s72 offen offset:1024  lds
    v_fma_f32 v15, v12, v135, v10
    v_fma_f32 v14, -v13, v135, v14
    v_mfma_f32_16x16x32_bf16 v[236:239], a[60:63], a[28:31], v[236:239]
    v_fma_f32 v15, v13, v134, v15
    s_waitcnt lgkmcnt(4)
    buffer_load_dwordx4 v18, s[16:19], s72 offen offset:2048  lds
    v_fma_f32 v184, v14, v134, v7
    v_mfma_f32_16x16x32_bf16 v[240:243], a[64:67], a[0:3], 0
    v_fma_f32 v185, v14, v135, v11
    v_fma_f32 v184, -v15, v135, v184
    v_mfma_f32_16x16x32_bf16 v[244:247], a[64:67], a[4:7], 0
    buffer_load_dwordx4 v19, s[16:19], s72 offen offset:3072  lds
    v_fma_f32 v185, v15, v134, v185
    v_mfma_f32_16x16x32_bf16 v[240:243], a[68:71], a[8:11], v[240:243]
    buffer_store_dwordx4 v[184:187], v188, s[24:27], s38 offen sc1
    v_mfma_f32_16x16x32_bf16 v[244:247], a[68:71], a[12:15], v[244:247]
    s_bfe_u32 s72, s97, 262144
    v_cndmask_b32 v146, v4, 0, s[78:79]
    v_mfma_f32_16x16x32_bf16 v[240:243], a[72:75], a[16:19], v[240:243]
    v_cndmask_b32 v147, v8, 0, s[78:79]
    v_mfma_f32_16x16x32_bf16 v[244:247], a[72:75], a[20:23], v[244:247]
    s_add_u32 m0, s37, 0
    v_cndmask_b32 v146, v146, v12, s[46:47]
    v_cndmask_b32 v147, v147, v13, s[46:47]
    v_mfma_f32_16x16x32_bf16 v[240:243], a[76:79], a[24:27], v[240:243]
    v_cndmask_b32 v146, v146, v14, s[44:45]
    v_mfma_f32_16x16x32_bf16 v[244:247], a[76:79], a[28:31], v[244:247]
    s_lshl_b32 s72, s72, 7
    v_cndmask_b32 v147, v147, v15, s[44:45]
    s_waitcnt lgkmcnt(0) vmcnt(9)
    v_lshlrev_b32_e64 v152, 16, v200
    v_mfma_f32_16x16x32_bf16 v[248:251], a[80:83], a[0:3], 0
    buffer_load_dwordx4 v16, s[16:19], s72 offen offset:0  lds
    v_and_b32 v160, 0xffff0000, v200
    v_lshlrev_b32_e64 v168, 16, v201
    v_mfma_f32_16x16x32_bf16 v[252:255], a[80:83], a[4:7], 0
    v_and_b32 v176, 0xffff0000, v201
    v_lshlrev_b32_e64 v153, 16, v202
    v_mfma_f32_16x16x32_bf16 v[248:251], a[84:87], a[8:11], v[248:251]
    buffer_load_dwordx4 v17, s[16:19], s72 offen offset:1024  lds
    v_and_b32 v161, 0xffff0000, v202
    v_lshlrev_b32_e64 v169, 16, v203
    v_mfma_f32_16x16x32_bf16 v[252:255], a[84:87], a[12:15], v[252:255]
    v_and_b32 v177, 0xffff0000, v203
    v_lshlrev_b32_e64 v154, 16, v204
    v_mfma_f32_16x16x32_bf16 v[248:251], a[88:91], a[16:19], v[248:251]
    buffer_load_dwordx4 v18, s[16:19], s72 offen offset:2048  lds
    v_and_b32 v162, 0xffff0000, v204
    v_lshlrev_b32_e64 v170, 16, v205
    v_mfma_f32_16x16x32_bf16 v[252:255], a[88:91], a[20:23], v[252:255]
    v_and_b32 v178, 0xffff0000, v205
    v_lshlrev_b32_e64 v155, 16, v206
    v_mfma_f32_16x16x32_bf16 v[248:251], a[92:95], a[24:27], v[248:251]
    buffer_load_dwordx4 v19, s[16:19], s72 offen offset:3072  lds
    v_and_b32 v163, 0xffff0000, v206
    v_lshlrev_b32_e64 v171, 16, v207
    v_mfma_f32_16x16x32_bf16 v[252:255], a[92:95], a[28:31], v[252:255]
    v_and_b32 v179, 0xffff0000, v207
    v_pk_mul_f32 v[4:5], v[224:225], v[96:97] op_sel_hi:[1,0]
    v_pk_mul_f32 v[6:7], v[228:229], v[96:97] op_sel_hi:[1,0]
    v_pk_fma_f32 v[4:5], v[228:229], v[96:97], v[4:5] op_sel:[0,1,0]
    v_pk_fma_f32 v[6:7], v[224:225], v[96:97], v[6:7] op_sel:[0,1,0] neg_lo:[1,0,0] neg_hi:[1,0,0]
    v_pk_mul_f32 v[8:9], v[226:227], v[98:99] op_sel_hi:[1,0]
    v_pk_mul_f32 v[10:11], v[230:231], v[98:99] op_sel_hi:[1,0]
    v_pk_fma_f32 v[8:9], v[230:231], v[98:99], v[8:9] op_sel:[0,1,0]
    v_pk_fma_f32 v[10:11], v[226:227], v[98:99], v[10:11] op_sel:[0,1,0] neg_lo:[1,0,0] neg_hi:[1,0,0]
    v_cvt_pk_bf16_f32 v184, v4, v6
    v_cvt_pk_bf16_f32 v192, v5, v7
    v_cvt_pk_bf16_f32 v188, v8, v10
    v_cvt_pk_bf16_f32 v196, v9, v11
    v_pk_mul_f32 v[4:5], v[232:233], v[100:101] op_sel_hi:[1,0]
    v_pk_mul_f32 v[6:7], v[236:237], v[100:101] op_sel_hi:[1,0]
    v_pk_fma_f32 v[4:5], v[236:237], v[100:101], v[4:5] op_sel:[0,1,0]
    v_pk_fma_f32 v[6:7], v[232:233], v[100:101], v[6:7] op_sel:[0,1,0] neg_lo:[1,0,0] neg_hi:[1,0,0]
    v_pk_mul_f32 v[8:9], v[234:235], v[102:103] op_sel_hi:[1,0]
    v_pk_mul_f32 v[10:11], v[238:239], v[102:103] op_sel_hi:[1,0]
    v_pk_fma_f32 v[8:9], v[238:239], v[102:103], v[8:9] op_sel:[0,1,0]
    v_pk_fma_f32 v[10:11], v[234:235], v[102:103], v[10:11] op_sel:[0,1,0] neg_lo:[1,0,0] neg_hi:[1,0,0]
    v_cvt_pk_bf16_f32 v185, v4, v6
    v_cvt_pk_bf16_f32 v193, v5, v7
    v_cvt_pk_bf16_f32 v189, v8, v10
    v_cvt_pk_bf16_f32 v197, v9, v11
    v_pk_mul_f32 v[4:5], v[240:241], v[104:105] op_sel_hi:[1,0]
    v_pk_mul_f32 v[6:7], v[244:245], v[104:105] op_sel_hi:[1,0]
    v_pk_fma_f32 v[4:5], v[244:245], v[104:105], v[4:5] op_sel:[0,1,0]
    v_pk_fma_f32 v[6:7], v[240:241], v[104:105], v[6:7] op_sel:[0,1,0] neg_lo:[1,0,0] neg_hi:[1,0,0]
    v_pk_mul_f32 v[8:9], v[242:243], v[106:107] op_sel_hi:[1,0]
    v_pk_mul_f32 v[10:11], v[246:247], v[106:107] op_sel_hi:[1,0]
    v_pk_fma_f32 v[8:9], v[246:247], v[106:107], v[8:9] op_sel:[0,1,0]
    v_pk_fma_f32 v[10:11], v[242:243], v[106:107], v[10:11] op_sel:[0,1,0] neg_lo:[1,0,0] neg_hi:[1,0,0]
    v_cvt_pk_bf16_f32 v186, v4, v6
    v_cvt_pk_bf16_f32 v194, v5, v7
    v_cvt_pk_bf16_f32 v190, v8, v10
    v_cvt_pk_bf16_f32 v198, v9, v11
    v_pk_mul_f32 v[4:5], v[248:249], v[108:109] op_sel_hi:[1,0]
    v_pk_mul_f32 v[6:7], v[252:253], v[108:109] op_sel_hi:[1,0]
    v_pk_fma_f32 v[4:5], v[252:253], v[108:109], v[4:5] op_sel:[0,1,0]
    v_pk_fma_f32 v[6:7], v[248:249], v[108:109], v[6:7] op_sel:[0,1,0] neg_lo:[1,0,0] neg_hi:[1,0,0]
    v_pk_mul_f32 v[8:9], v[250:251], v[110:111] op_sel_hi:[1,0]
    v_pk_mul_f32 v[10:11], v[254:255], v[110:111] op_sel_hi:[1,0]
    v_pk_fma_f32 v[8:9], v[254:255], v[110:111], v[8:9] op_sel:[0,1,0]
    v_pk_fma_f32 v[10:11], v[250:251], v[110:111], v[10:11] op_sel:[0,1,0] neg_lo:[1,0,0] neg_hi:[1,0,0]
    v_cvt_pk_bf16_f32 v187, v4, v6
    v_cvt_pk_bf16_f32 v195, v5, v7
    v_cvt_pk_bf16_f32 v191, v8, v10
    v_cvt_pk_bf16_f32 v199, v9, v11
    v_mfma_f32_16x16x32_bf16 v[224:227], a[224:227], v[184:187], 0
    s_xor_b32 s40, s92, 0
    v_lshlrev_b32 v156, 16, v208
    v_and_b32 v164, 0xffff0000, v208
    v_mfma_f32_16x16x32_bf16 v[228:231], a[228:231], v[184:187], 0
    v_lshlrev_b32_e64 v172, 16, v209
    v_and_b32 v180, 0xffff0000, v209
    v_mfma_f32_16x16x32_bf16 v[232:235], a[248:251], v[188:191], 0
    v_lshlrev_b32_e64 v157, 16, v210
    v_and_b32 v165, 0xffff0000, v210
    v_mfma_f32_16x16x32_bf16 v[236:239], a[252:255], v[188:191], 0
    v_lshlrev_b32_e64 v173, 16, v211
    v_and_b32 v181, 0xffff0000, v211
    v_mfma_f32_16x16x32_bf16 v[240:243], a[224:227], v[192:195], 0
    buffer_load_dword a223, v29, s[16:19], s40 offen
    v_lshlrev_b32_e64 v158, 16, v212
    v_and_b32 v166, 0xffff0000, v212
    v_mfma_f32_16x16x32_bf16 v[244:247], a[228:231], v[192:195], 0
    v_lshlrev_b32_e64 v174, 16, v213
    v_and_b32 v182, 0xffff0000, v213
    v_mfma_f32_16x16x32_bf16 v[248:251], a[248:251], v[196:199], 0
    v_lshlrev_b32_e64 v159, 16, v214
    v_and_b32 v167, 0xffff0000, v214
    v_mfma_f32_16x16x32_bf16 v[252:255], a[252:255], v[196:199], 0
    v_lshlrev_b32_e64 v175, 16, v215
    v_and_b32 v183, 0xffff0000, v215
    v_accvgpr_read_b32 v28, a222
    v_cmp_ne_u32 s[78:79], s96, v28
    s_nop 0
    s_and_b32 s78, s78, 0x5555
    s_cmp_eq_u32 s78, 0
    s_cselect_b32 s50, 0, 2.0
    s_cselect_b32 s7, 2.0, 0
    v_cmp_eq_u32 vcc, 2.0, v148
    v_mov_b32 v200, s35
    s_nop 0
    v_cndmask_b32 v200, v200, 0, vcc
    v_cmp_eq_u32 vcc, 2.0, v149
    v_mov_b32 v201, s35
    s_nop 0
    v_cndmask_b32 v201, v201, 0, vcc
    v_cmp_eq_u32 vcc, 2.0, v150
    v_mov_b32 v202, s35
    s_nop 0
    v_cndmask_b32 v202, v202, 0, vcc
    v_cmp_eq_u32 vcc, 2.0, v151
    v_mov_b32 v203, s35
    s_nop 0
    v_cndmask_b32 v203, v203, 0, vcc
    v_pk_add_f32 v[224:225], v[224:225], v[232:233]
    v_pk_add_f32 v[226:227], v[226:227], v[234:235]
    v_pk_add_f32 v[228:229], v[228:229], v[236:237]
    v_pk_add_f32 v[230:231], v[230:231], v[238:239]
    v_pk_fma_f32 v[232:233], v[232:233], -2.0, v[224:225] op_sel_hi:[1,0,1]
    v_pk_fma_f32 v[234:235], v[234:235], -2.0, v[226:227] op_sel_hi:[1,0,1]
    v_pk_fma_f32 v[236:237], v[236:237], -2.0, v[228:229] op_sel_hi:[1,0,1]
    v_pk_fma_f32 v[238:239], v[238:239], -2.0, v[230:231] op_sel_hi:[1,0,1]
    v_pk_add_f32 v[240:241], v[240:241], v[248:249]
    v_pk_add_f32 v[242:243], v[242:243], v[250:251]
    v_pk_add_f32 v[244:245], v[244:245], v[252:253]
    v_pk_add_f32 v[246:247], v[246:247], v[254:255]
    v_pk_fma_f32 v[248:249], v[248:249], -2.0, v[240:241] op_sel_hi:[1,0,1]
    v_pk_fma_f32 v[250:251], v[250:251], -2.0, v[242:243] op_sel_hi:[1,0,1]
    v_pk_fma_f32 v[252:253], v[252:253], -2.0, v[244:245] op_sel_hi:[1,0,1]
    v_pk_fma_f32 v[254:255], v[254:255], -2.0, v[246:247] op_sel_hi:[1,0,1]
    s_cmp_eq_u32 s2, 0
    s_cbranch_scc1 K_SPECIAL
    v_pk_fma_f32 v[4:5], v[224:225], s[42:43], v[244:245] op_sel_hi:[1,0,1]
    v_pk_fma_f32 v[6:7], v[228:229], s[42:43], v[240:241] op_sel_hi:[1,0,1] neg_lo:[0,0,1] neg_hi:[0,0,1]
    v_pk_fma_f32 v[8:9], v[240:241], s[42:43], v[228:229] op_sel_hi:[1,0,1]
    v_pk_fma_f32 v[10:11], v[244:245], s[42:43], v[224:225] op_sel_hi:[1,0,1] neg_lo:[0,0,1] neg_hi:[0,0,1]
    v_pk_mul_f32 v[224:225], v[4:5], v[152:153]
    v_pk_mul_f32 v[228:229], v[6:7], v[152:153]
    v_pk_mul_f32 v[240:241], v[8:9], v[168:169]
    v_pk_mul_f32 v[244:245], v[10:11], v[168:169]
    v_pk_fma_f32 v[152:153], v[6:7], v[160:161], v[224:225] neg_lo:[1,0,0] neg_hi:[1,0,0]
    v_pk_fma_f32 v[160:161], v[4:5], v[160:161], v[228:229]
    v_pk_fma_f32 v[168:169], v[10:11], v[176:177], v[240:241]
    v_pk_fma_f32 v[176:177], v[8:9], v[176:177], v[244:245] neg_lo:[1,0,0] neg_hi:[1,0,0]
    v_pk_fma_f32 v[224:225], v[152:153], s[42:43], v[176:177] op_sel_hi:[1,0,1] neg_lo:[0,0,1] neg_hi:[0,0,1]
    v_pk_fma_f32 v[228:229], v[160:161], s[42:43], v[168:169] op_sel_hi:[1,0,1]
    v_pk_fma_f32 v[240:241], v[168:169], s[42:43], v[160:161] op_sel_hi:[1,0,1] neg_lo:[0,0,1] neg_hi:[0,0,1]
    v_pk_fma_f32 v[244:245], v[176:177], s[42:43], v[152:153] op_sel_hi:[1,0,1]
    v_pk_fma_f32 v[4:5], v[226:227], s[42:43], v[246:247] op_sel_hi:[1,0,1]
    v_pk_fma_f32 v[6:7], v[230:231], s[42:43], v[242:243] op_sel_hi:[1,0,1] neg_lo:[0,0,1] neg_hi:[0,0,1]
    v_pk_fma_f32 v[8:9], v[242:243], s[42:43], v[230:231] op_sel_hi:[1,0,1]
    v_pk_fma_f32 v[10:11], v[246:247], s[42:43], v[226:227] op_sel_hi:[1,0,1] neg_lo:[0,0,1] neg_hi:[0,0,1]
    v_pk_mul_f32 v[226:227], v[4:5], v[154:155]
    v_pk_mul_f32 v[230:231], v[6:7], v[154:155]
    v_pk_mul_f32 v[242:243], v[8:9], v[170:171]
    v_pk_mul_f32 v[246:247], v[10:11], v[170:171]
    v_pk_fma_f32 v[154:155], v[6:7], v[162:163], v[226:227] neg_lo:[1,0,0] neg_hi:[1,0,0]
    v_pk_fma_f32 v[162:163], v[4:5], v[162:163], v[230:231]
    v_pk_fma_f32 v[170:171], v[10:11], v[178:179], v[242:243]
    v_pk_fma_f32 v[178:179], v[8:9], v[178:179], v[246:247] neg_lo:[1,0,0] neg_hi:[1,0,0]
    v_pk_fma_f32 v[226:227], v[154:155], s[42:43], v[178:179] op_sel_hi:[1,0,1] neg_lo:[0,0,1] neg_hi:[0,0,1]
    v_pk_fma_f32 v[230:231], v[162:163], s[42:43], v[170:171] op_sel_hi:[1,0,1]
    v_pk_fma_f32 v[242:243], v[170:171], s[42:43], v[162:163] op_sel_hi:[1,0,1] neg_lo:[0,0,1] neg_hi:[0,0,1]
    v_pk_fma_f32 v[246:247], v[178:179], s[42:43], v[154:155] op_sel_hi:[1,0,1]
    v_pk_fma_f32 v[4:5], v[232:233], s[42:43], v[252:253] op_sel_hi:[1,0,1]
    v_pk_fma_f32 v[6:7], v[236:237], s[42:43], v[248:249] op_sel_hi:[1,0,1] neg_lo:[0,0,1] neg_hi:[0,0,1]
    v_pk_fma_f32 v[8:9], v[248:249], s[42:43], v[236:237] op_sel_hi:[1,0,1]
    v_pk_fma_f32 v[10:11], v[252:253], s[42:43], v[232:233] op_sel_hi:[1,0,1] neg_lo:[0,0,1] neg_hi:[0,0,1]
    v_pk_mul_f32 v[232:233], v[4:5], v[156:157]
    v_pk_mul_f32 v[236:237], v[6:7], v[156:157]
    v_pk_mul_f32 v[248:249], v[8:9], v[172:173]
    v_pk_mul_f32 v[252:253], v[10:11], v[172:173]
    v_pk_fma_f32 v[156:157], v[6:7], v[164:165], v[232:233] neg_lo:[1,0,0] neg_hi:[1,0,0]
    v_pk_fma_f32 v[164:165], v[4:5], v[164:165], v[236:237]
    v_pk_fma_f32 v[172:173], v[10:11], v[180:181], v[248:249]
    v_pk_fma_f32 v[180:181], v[8:9], v[180:181], v[252:253] neg_lo:[1,0,0] neg_hi:[1,0,0]
    v_pk_fma_f32 v[232:233], v[156:157], s[42:43], v[180:181] op_sel_hi:[1,0,1] neg_lo:[0,0,1] neg_hi:[0,0,1]
    v_pk_fma_f32 v[236:237], v[164:165], s[42:43], v[172:173] op_sel_hi:[1,0,1]
    v_pk_fma_f32 v[248:249], v[172:173], s[42:43], v[164:165] op_sel_hi:[1,0,1] neg_lo:[0,0,1] neg_hi:[0,0,1]
    v_pk_fma_f32 v[252:253], v[180:181], s[42:43], v[156:157] op_sel_hi:[1,0,1]
    v_pk_fma_f32 v[4:5], v[234:235], s[42:43], v[254:255] op_sel_hi:[1,0,1]
    v_pk_fma_f32 v[6:7], v[238:239], s[42:43], v[250:251] op_sel_hi:[1,0,1] neg_lo:[0,0,1] neg_hi:[0,0,1]
    v_pk_fma_f32 v[8:9], v[250:251], s[42:43], v[238:239] op_sel_hi:[1,0,1]
    v_pk_fma_f32 v[10:11], v[254:255], s[42:43], v[234:235] op_sel_hi:[1,0,1] neg_lo:[0,0,1] neg_hi:[0,0,1]
    v_pk_mul_f32 v[234:235], v[4:5], v[158:159]
    v_pk_mul_f32 v[238:239], v[6:7], v[158:159]
    v_pk_mul_f32 v[250:251], v[8:9], v[174:175]
    v_pk_mul_f32 v[254:255], v[10:11], v[174:175]
    v_pk_fma_f32 v[158:159], v[6:7], v[166:167], v[234:235] neg_lo:[1,0,0] neg_hi:[1,0,0]
    v_pk_fma_f32 v[166:167], v[4:5], v[166:167], v[238:239]
    v_pk_fma_f32 v[174:175], v[10:11], v[182:183], v[250:251]
    v_pk_fma_f32 v[182:183], v[8:9], v[182:183], v[254:255] neg_lo:[1,0,0] neg_hi:[1,0,0]
    v_pk_fma_f32 v[234:235], v[158:159], s[42:43], v[182:183] op_sel_hi:[1,0,1] neg_lo:[0,0,1] neg_hi:[0,0,1]
    v_pk_fma_f32 v[238:239], v[166:167], s[42:43], v[174:175] op_sel_hi:[1,0,1]
    v_pk_fma_f32 v[250:251], v[174:175], s[42:43], v[166:167] op_sel_hi:[1,0,1] neg_lo:[0,0,1] neg_hi:[0,0,1]
    v_pk_fma_f32 v[254:255], v[182:183], s[42:43], v[158:159] op_sel_hi:[1,0,1]
K_SPECIAL2_RET:
    v_pk_add_f32 v[224:225], v[224:225], v[232:233]
    v_pk_add_f32 v[226:227], v[226:227], v[234:235]
    v_pk_add_f32 v[228:229], v[228:229], v[236:237]
    v_pk_add_f32 v[230:231], v[230:231], v[238:239]
    v_pk_fma_f32 v[232:233], v[232:233], -2.0, v[224:225] op_sel_hi:[1,0,1]
    v_pk_fma_f32 v[234:235], v[234:235], -2.0, v[226:227] op_sel_hi:[1,0,1]
    v_pk_fma_f32 v[236:237], v[236:237], -2.0, v[228:229] op_sel_hi:[1,0,1]
    v_pk_fma_f32 v[238:239], v[238:239], -2.0, v[230:231] op_sel_hi:[1,0,1]
    v_cvt_pk_bf16_f32 v184, v224, -v228
    v_cvt_pk_bf16_f32 v185, v225, -v229
    v_cvt_pk_bf16_f32 v186, v226, -v230
    v_cvt_pk_bf16_f32 v187, v227, -v231
    v_cvt_pk_bf16_f32 v188, v232, -v236
    v_cvt_pk_bf16_f32 v189, v233, -v237
    v_cvt_pk_bf16_f32 v190, v234, -v238
    v_cvt_pk_bf16_f32 v191, v235, -v239
    v_pk_add_f32 v[240:241], v[240:241], v[248:249]
    v_pk_add_f32 v[242:243], v[242:243], v[250:251]
    v_pk_add_f32 v[244:245], v[244:245], v[252:253]
    v_pk_add_f32 v[246:247], v[246:247], v[254:255]
    v_pk_fma_f32 v[248:249], v[248:249], -2.0, v[240:241] op_sel_hi:[1,0,1]
    v_pk_fma_f32 v[250:251], v[250:251], -2.0, v[242:243] op_sel_hi:[1,0,1]
    v_pk_fma_f32 v[252:253], v[252:253], -2.0, v[244:245] op_sel_hi:[1,0,1]
    v_pk_fma_f32 v[254:255], v[254:255], -2.0, v[246:247] op_sel_hi:[1,0,1]
    v_cvt_pk_bf16_f32 v192, v240, -v244
    v_cvt_pk_bf16_f32 v193, v241, -v245
    v_cvt_pk_bf16_f32 v194, v242, -v246
    v_cvt_pk_bf16_f32 v195, v243, -v247
    v_cvt_pk_bf16_f32 v196, v248, -v252
    v_cvt_pk_bf16_f32 v197, v249, -v253
    v_cvt_pk_bf16_f32 v198, v250, -v254
    v_cvt_pk_bf16_f32 v199, v251, -v255
    v_mfma_f32_16x16x32_bf16 v[224:227], v[184:187], a[224:227], 0
    v_and_b32_e64 v12, 3, v1
    v_mul_u32_u24 v13, 4112, v12
    v_mfma_f32_16x16x32_bf16 v[228:231], v[184:187], a[228:231], 0
    v_and_b32_e64 v14, 60, v0
    v_lshl_add_u32 v13, v14, 4, v13
    v_mfma_f32_16x16x32_bf16 v[232:235], v[188:191], a[232:235], 0
    s_lshl_b32 s38, s34, 10
    s_add_u32 s38, s38, 114624
    v_mfma_f32_16x16x32_bf16 v[236:239], v[188:191], a[236:239], 0
    v_add_u32 v204, s38, v13
    v_add_u32 v205, 114624, v3
    v_lshlrev_b32_e64 v12, 4, v12
    v_lshl_add_u32 v206, v14, 14, v12
    v_lshlrev_b32_e64 v207, 31, v1
    v_pk_mul_f32 v[4:5], v[36:37], v[130:131] op_sel:[0,1]
    v_pk_mul_f32 v[6:7], v[32:33], v[130:131] op_sel:[0,1]
    v_pk_fma_f32 v[32:33], v[32:33], v[130:131], v[4:5] op_sel_hi:[1,0,1] neg_lo:[0,0,1] neg_hi:[0,0,1]
    v_pk_fma_f32 v[36:37], v[36:37], v[130:131], v[6:7] op_sel_hi:[1,0,1]
    v_pk_mul_f32 v[8:9], v[38:39], v[130:131] op_sel:[0,1]
    v_pk_mul_f32 v[10:11], v[34:35], v[130:131] op_sel:[0,1]
    v_pk_fma_f32 v[34:35], v[34:35], v[130:131], v[8:9] op_sel_hi:[1,0,1] neg_lo:[0,0,1] neg_hi:[0,0,1]
    v_pk_fma_f32 v[38:39], v[38:39], v[130:131], v[10:11] op_sel_hi:[1,0,1]
    v_pk_mul_f32 v[4:5], v[44:45], v[130:131] op_sel:[0,1]
    v_pk_mul_f32 v[6:7], v[40:41], v[130:131] op_sel:[0,1]
    v_pk_fma_f32 v[40:41], v[40:41], v[130:131], v[4:5] op_sel_hi:[1,0,1] neg_lo:[0,0,1] neg_hi:[0,0,1]
    v_pk_fma_f32 v[44:45], v[44:45], v[130:131], v[6:7] op_sel_hi:[1,0,1]
    v_pk_mul_f32 v[8:9], v[46:47], v[130:131] op_sel:[0,1]
    v_pk_mul_f32 v[10:11], v[42:43], v[130:131] op_sel:[0,1]
    v_pk_fma_f32 v[42:43], v[42:43], v[130:131], v[8:9] op_sel_hi:[1,0,1] neg_lo:[0,0,1] neg_hi:[0,0,1]
    v_pk_fma_f32 v[46:47], v[46:47], v[130:131], v[10:11] op_sel_hi:[1,0,1]
    v_pk_mul_f32 v[4:5], v[52:53], v[130:131] op_sel:[0,1]
    v_pk_mul_f32 v[6:7], v[48:49], v[130:131] op_sel:[0,1]
    v_pk_fma_f32 v[48:49], v[48:49], v[130:131], v[4:5] op_sel_hi:[1,0,1] neg_lo:[0,0,1] neg_hi:[0,0,1]
    v_pk_fma_f32 v[52:53], v[52:53], v[130:131], v[6:7] op_sel_hi:[1,0,1]
    v_pk_mul_f32 v[8:9], v[54:55], v[130:131] op_sel:[0,1]
    v_pk_mul_f32 v[10:11], v[50:51], v[130:131] op_sel:[0,1]
    v_pk_fma_f32 v[50:51], v[50:51], v[130:131], v[8:9] op_sel_hi:[1,0,1] neg_lo:[0,0,1] neg_hi:[0,0,1]
    v_pk_fma_f32 v[54:55], v[54:55], v[130:131], v[10:11] op_sel_hi:[1,0,1]
    v_pk_mul_f32 v[4:5], v[60:61], v[130:131] op_sel:[0,1]
    v_pk_mul_f32 v[6:7], v[56:57], v[130:131] op_sel:[0,1]
    v_pk_fma_f32 v[56:57], v[56:57], v[130:131], v[4:5] op_sel_hi:[1,0,1] neg_lo:[0,0,1] neg_hi:[0,0,1]
    v_pk_fma_f32 v[60:61], v[60:61], v[130:131], v[6:7] op_sel_hi:[1,0,1]
    v_pk_mul_f32 v[8:9], v[62:63], v[130:131] op_sel:[0,1]
    v_pk_mul_f32 v[10:11], v[58:59], v[130:131] op_sel:[0,1]
    v_pk_fma_f32 v[58:59], v[58:59], v[130:131], v[8:9] op_sel_hi:[1,0,1] neg_lo:[0,0,1] neg_hi:[0,0,1]
    v_pk_fma_f32 v[62:63], v[62:63], v[130:131], v[10:11] op_sel_hi:[1,0,1]
    v_pk_mul_f32 v[4:5], v[68:69], v[130:131] op_sel:[0,1]
    v_pk_mul_f32 v[6:7], v[64:65], v[130:131] op_sel:[0,1]
    v_pk_fma_f32 v[64:65], v[64:65], v[130:131], v[4:5] op_sel_hi:[1,0,1] neg_lo:[0,0,1] neg_hi:[0,0,1]
    v_pk_fma_f32 v[68:69], v[68:69], v[130:131], v[6:7] op_sel_hi:[1,0,1]
    v_pk_mul_f32 v[8:9], v[70:71], v[130:131] op_sel:[0,1]
    v_pk_mul_f32 v[10:11], v[66:67], v[130:131] op_sel:[0,1]
    v_pk_fma_f32 v[66:67], v[66:67], v[130:131], v[8:9] op_sel_hi:[1,0,1] neg_lo:[0,0,1] neg_hi:[0,0,1]
    v_pk_fma_f32 v[70:71], v[70:71], v[130:131], v[10:11] op_sel_hi:[1,0,1]
    v_pk_mul_f32 v[4:5], v[76:77], v[130:131] op_sel:[0,1]
    v_pk_mul_f32 v[6:7], v[72:73], v[130:131] op_sel:[0,1]
    v_pk_fma_f32 v[72:73], v[72:73], v[130:131], v[4:5] op_sel_hi:[1,0,1] neg_lo:[0,0,1] neg_hi:[0,0,1]
    v_pk_fma_f32 v[76:77], v[76:77], v[130:131], v[6:7] op_sel_hi:[1,0,1]
    v_pk_mul_f32 v[8:9], v[78:79], v[130:131] op_sel:[0,1]
    v_pk_mul_f32 v[10:11], v[74:75], v[130:131] op_sel:[0,1]
    v_pk_fma_f32 v[74:75], v[74:75], v[130:131], v[8:9] op_sel_hi:[1,0,1] neg_lo:[0,0,1] neg_hi:[0,0,1]
    v_pk_fma_f32 v[78:79], v[78:79], v[130:131], v[10:11] op_sel_hi:[1,0,1]
    v_pk_mul_f32 v[4:5], v[84:85], v[130:131] op_sel:[0,1]
    v_pk_mul_f32 v[6:7], v[80:81], v[130:131] op_sel:[0,1]
    v_pk_fma_f32 v[80:81], v[80:81], v[130:131], v[4:5] op_sel_hi:[1,0,1] neg_lo:[0,0,1] neg_hi:[0,0,1]
    v_pk_fma_f32 v[84:85], v[84:85], v[130:131], v[6:7] op_sel_hi:[1,0,1]
    v_pk_mul_f32 v[8:9], v[86:87], v[130:131] op_sel:[0,1]
    v_pk_mul_f32 v[10:11], v[82:83], v[130:131] op_sel:[0,1]
    v_pk_fma_f32 v[82:83], v[82:83], v[130:131], v[8:9] op_sel_hi:[1,0,1] neg_lo:[0,0,1] neg_hi:[0,0,1]
    v_pk_fma_f32 v[86:87], v[86:87], v[130:131], v[10:11] op_sel_hi:[1,0,1]
    v_pk_mul_f32 v[4:5], v[92:93], v[130:131] op_sel:[0,1]
    v_pk_mul_f32 v[6:7], v[88:89], v[130:131] op_sel:[0,1]
    v_pk_fma_f32 v[88:89], v[88:89], v[130:131], v[4:5] op_sel_hi:[1,0,1] neg_lo:[0,0,1] neg_hi:[0,0,1]
    v_pk_fma_f32 v[92:93], v[92:93], v[130:131], v[6:7] op_sel_hi:[1,0,1]
    v_pk_mul_f32 v[8:9], v[94:95], v[130:131] op_sel:[0,1]
    v_pk_mul_f32 v[10:11], v[90:91], v[130:131] op_sel:[0,1]
    v_pk_fma_f32 v[90:91], v[90:91], v[130:131], v[8:9] op_sel_hi:[1,0,1] neg_lo:[0,0,1] neg_hi:[0,0,1]
    v_pk_fma_f32 v[94:95], v[94:95], v[130:131], v[10:11] op_sel_hi:[1,0,1]
    v_pk_mul_f32 v[4:5], v[224:225], v[112:113]
    v_pk_mul_f32 v[6:7], v[228:229], v[112:113]
    v_pk_fma_f32 v[4:5], v[228:229], v[116:117], v[4:5]
    v_pk_fma_f32 v[6:7], v[224:225], v[116:117], v[6:7] neg_lo:[1,0,0] neg_hi:[1,0,0]
    v_pk_mul_f32 v[8:9], v[226:227], v[114:115]
    v_pk_mul_f32 v[10:11], v[230:231], v[114:115]
    v_pk_fma_f32 v[8:9], v[230:231], v[118:119], v[8:9]
    v_pk_fma_f32 v[10:11], v[226:227], v[118:119], v[10:11] neg_lo:[1,0,0] neg_hi:[1,0,0]
    v_cvt_pk_bf16_f32 v184, v4, v6
    v_cvt_pk_bf16_f32 v185, v5, v7
    v_cvt_pk_bf16_f32 v186, v8, v10
    v_cvt_pk_bf16_f32 v187, v9, v11
    v_pk_mul_f32 v[4:5], v[232:233], v[120:121]
    v_pk_mul_f32 v[6:7], v[236:237], v[120:121]
    v_pk_fma_f32 v[4:5], v[236:237], v[124:125], v[4:5]
    v_pk_fma_f32 v[6:7], v[232:233], v[124:125], v[6:7] neg_lo:[1,0,0] neg_hi:[1,0,0]
    v_pk_mul_f32 v[8:9], v[234:235], v[122:123]
    v_pk_mul_f32 v[10:11], v[238:239], v[122:123]
    v_pk_fma_f32 v[8:9], v[238:239], v[126:127], v[8:9]
    v_pk_fma_f32 v[10:11], v[234:235], v[126:127], v[10:11] neg_lo:[1,0,0] neg_hi:[1,0,0]
    v_cvt_pk_bf16_f32 v188, v4, v6
    v_cvt_pk_bf16_f32 v189, v5, v7
    v_cvt_pk_bf16_f32 v190, v8, v10
    v_cvt_pk_bf16_f32 v191, v9, v11
    v_mfma_f32_16x16x32_bf16 v[240:243], v[192:195], a[224:227], 0
    ds_write_b128 v204, v[184:187] offset:0
    v_mfma_f32_16x16x32_bf16 v[244:247], v[192:195], a[228:231], 0
    ds_write_b128 v204, v[188:191] offset:32
    v_mfma_f32_16x16x32_bf16 v[248:251], v[196:199], a[232:235], 0
    v_mfma_f32_16x16x32_bf16 v[252:255], v[196:199], a[236:239], 0
    s_lshl_b32 s68, s94, 16
    s_add_u32 s68, s68, s5
    s_add_u32 s69, s68, 0x20000
    s_lshl_b32 s38, s34, 14
    s_nop 0
    v_pk_mul_f32 v[4:5], v[240:241], v[112:113]
    v_pk_mul_f32 v[6:7], v[244:245], v[112:113]
    v_pk_fma_f32 v[4:5], v[244:245], v[116:117], v[4:5]
    v_pk_fma_f32 v[6:7], v[240:241], v[116:117], v[6:7] neg_lo:[1,0,0] neg_hi:[1,0,0]
    v_pk_mul_f32 v[8:9], v[242:243], v[114:115]
    v_pk_mul_f32 v[10:11], v[246:247], v[114:115]
    v_pk_fma_f32 v[8:9], v[246:247], v[118:119], v[8:9]
    v_pk_fma_f32 v[10:11], v[242:243], v[118:119], v[10:11] neg_lo:[1,0,0] neg_hi:[1,0,0]
    v_cvt_pk_bf16_f32 v192, v4, v6
    v_cvt_pk_bf16_f32 v193, v5, v7
    v_cvt_pk_bf16_f32 v194, v8, v10
    v_cvt_pk_bf16_f32 v195, v9, v11
    v_pk_mul_f32 v[4:5], v[248:249], v[120:121]
    v_pk_mul_f32 v[6:7], v[252:253], v[120:121]
    v_pk_fma_f32 v[4:5], v[252:253], v[124:125], v[4:5]
    v_pk_fma_f32 v[6:7], v[248:249], v[124:125], v[6:7] neg_lo:[1,0,0] neg_hi:[1,0,0]
    v_pk_mul_f32 v[8:9], v[250:251], v[122:123]
    v_pk_mul_f32 v[10:11], v[254:255], v[122:123]
    v_pk_fma_f32 v[8:9], v[254:255], v[126:127], v[8:9]
    v_pk_fma_f32 v[10:11], v[250:251], v[126:127], v[10:11] neg_lo:[1,0,0] neg_hi:[1,0,0]
    v_cvt_pk_bf16_f32 v196, v4, v6
    v_cvt_pk_bf16_f32 v197, v5, v7
    v_cvt_pk_bf16_f32 v198, v8, v10
    v_cvt_pk_bf16_f32 v199, v9, v11
    s_add_u32 s38, s38, s4
    s_lshl_b32 s38, s38, 6
    ds_write_b128 v204, v[192:195] offset:16
    ds_write_b128 v204, v[196:199] offset:48
    s_add_u32 s38, s38, 9437184
    s_and_b32 s70, s2, 0xe0
    s_lshl2_add_u32 s70, s70, s51
    s_waitcnt lgkmcnt(0)
    s_barrier
    s_nop 0
    ds_read_b128 a[32:35], v205 offset:0
    ds_read_b128 a[36:39], v205 offset:1024
    ds_read_b128 a[40:43], v205 offset:2048
    ds_read_b128 a[44:47], v205 offset:3072
    buffer_load_dwordx4 v[96:99], v148, s[24:27], s93 offen sc1
    buffer_load_dwordx4 v[100:103], v149, s[24:27], s93 offen sc1
    buffer_load_dwordx4 v[104:107], v150, s[24:27], s93 offen sc1
    buffer_load_dwordx4 v[108:111], v151, s[24:27], s93 offen sc1
    s_bfe_u32 s72, s97, 262156
    s_add_u32 m0, s37, 49152
    s_lshl_b32 s72, s72, 7
    buffer_load_dwordx4 v16, s[16:19], s72 offen offset:0  lds
    buffer_load_dwordx4 v17, s[16:19], s72 offen offset:1024  lds
    buffer_load_dwordx4 v18, s[16:19], s72 offen offset:2048  lds
    buffer_load_dwordx4 v19, s[16:19], s72 offen offset:3072  lds
    s_waitcnt lgkmcnt(0)
    v_mfma_f32_16x16x32_bf16 v[224:227], a[0:3], a[32:35], 0
    ds_read_b128 a[48:51], v205 offset:4112
    v_accvgpr_read_b32 v112, a152
    v_mfma_f32_16x16x32_bf16 v[228:231], a[4:7], a[32:35], 0
    ds_read_b128 a[52:55], v205 offset:5136
    v_accvgpr_read_b32 v113, a153
    v_mfma_f32_16x16x32_bf16 v[224:227], a[8:11], a[36:39], v[224:227]
    ds_read_b128 a[56:59], v205 offset:6160
    v_accvgpr_read_b32 v114, a154
    v_mfma_f32_16x16x32_bf16 v[228:231], a[12:15], a[36:39], v[228:231]
    ds_read_b128 a[60:63], v205 offset:7184
    v_mfma_f32_16x16x32_bf16 v[224:227], a[16:19], a[40:43], v[224:227]
    ds_read_b128 a[64:67], v205 offset:8224
    v_accvgpr_read_b32 v115, a155
    v_mfma_f32_16x16x32_bf16 v[228:231], a[20:23], a[40:43], v[228:231]
    ds_read_b128 a[68:71], v205 offset:9248
    v_accvgpr_read_b32 v116, a156
    v_mfma_f32_16x16x32_bf16 v[224:227], a[24:27], a[44:47], v[224:227]
    ds_read_b128 a[72:75], v205 offset:10272
    v_accvgpr_read_b32 v117, a157
    v_mfma_f32_16x16x32_bf16 v[228:231], a[28:31], a[44:47], v[228:231]
    ds_read_b128 a[76:79], v205 offset:11296
    s_waitcnt lgkmcnt(4)
    v_mfma_f32_16x16x32_bf16 v[232:235], a[0:3], a[48:51], 0
    ds_read_b128 a[80:83], v205 offset:12336
    s_bfe_u32 s72, s97, 262160
    v_accvgpr_read_b32 v118, a158
    v_mfma_f32_16x16x32_bf16 v[236:239], a[4:7], a[48:51], 0
    ds_read_b128 a[84:87], v205 offset:13360
    v_accvgpr_read_b32 v119, a159
    v_mfma_f32_16x16x32_bf16 v[232:235], a[8:11], a[52:55], v[232:235]
    ds_read_b128 a[88:91], v205 offset:14384
    s_add_u32 m0, s37, 65536
    v_mfma_f32_16x16x32_bf16 v[236:239], a[12:15], a[52:55], v[236:239]
    ds_read_b128 a[92:95], v205 offset:15408
    v_cvt_pk_bf16_f32 v184, v224, v228
    v_cvt_pk_bf16_f32 v185, v225, v229
    v_mfma_f32_16x16x32_bf16 v[232:235], a[16:19], a[56:59], v[232:235]
    s_lshl_b32 s72, s72, 7
    v_cvt_pk_bf16_f32 v186, v226, v230
    v_cvt_pk_bf16_f32 v187, v227, v231
    v_mfma_f32_16x16x32_bf16 v[236:239], a[20:23], a[56:59], v[236:239]
    v_xor_b32 v184, v207, v184
    v_xor_b32 v185, v207, v185
    v_mfma_f32_16x16x32_bf16 v[232:235], a[24:27], a[60:63], v[232:235]
    v_xor_b32 v186, v207, v186
    v_xor_b32 v187, v207, v187
    v_mfma_f32_16x16x32_bf16 v[236:239], a[28:31], a[60:63], v[236:239]
    buffer_store_dwordx4 v[184:187], v206, s[24:27], s38 offen sc1
    s_add_u32 s38, s38, 16384
    s_waitcnt lgkmcnt(4)
    v_mfma_f32_16x16x32_bf16 v[240:243], a[0:3], a[64:67], 0
    buffer_load_dwordx4 v16, s[16:19], s72 offen offset:0  lds
    v_accvgpr_read_b32 v120, a160
    v_mfma_f32_16x16x32_bf16 v[244:247], a[4:7], a[64:67], 0
    v_accvgpr_read_b32 v121, a161
    v_mfma_f32_16x16x32_bf16 v[240:243], a[8:11], a[68:71], v[240:243]
    buffer_load_dwordx4 v17, s[16:19], s72 offen offset:1024  lds
    v_mfma_f32_16x16x32_bf16 v[244:247], a[12:15], a[68:71], v[244:247]
    v_cvt_pk_bf16_f32 v188, v232, v236
    v_cvt_pk_bf16_f32 v189, v233, v237
    v_mfma_f32_16x16x32_bf16 v[240:243], a[16:19], a[72:75], v[240:243]
    buffer_load_dwordx4 v18, s[16:19], s72 offen offset:2048  lds
    v_cvt_pk_bf16_f32 v190, v234, v238
    v_cvt_pk_bf16_f32 v191, v235, v239
    v_mfma_f32_16x16x32_bf16 v[244:247], a[20:23], a[72:75], v[244:247]
    v_xor_b32 v188, v207, v188
    v_xor_b32_e64 v189, v207, v189
    v_mfma_f32_16x16x32_bf16 v[240:243], a[24:27], a[76:79], v[240:243]
    v_xor_b32 v190, v207, v190
    v_xor_b32 v191, v207, v191
    v_mfma_f32_16x16x32_bf16 v[244:247], a[28:31], a[76:79], v[244:247]
    buffer_store_dwordx4 v[188:191], v206, s[24:27], s38 offen sc1
    s_add_u32 s38, s38, 16384
    s_waitcnt lgkmcnt(0)
    v_mfma_f32_16x16x32_bf16 v[248:251], a[0:3], a[80:83], 0
    buffer_load_dwordx4 v19, s[16:19], s72 offen offset:3072  lds
    v_accvgpr_read_b32 v122, a162
    v_mfma_f32_16x16x32_bf16 v[252:255], a[4:7], a[80:83], 0
    v_accvgpr_read_b32 v123, a163
    v_mfma_f32_16x16x32_bf16 v[248:251], a[8:11], a[84:87], v[248:251]
    v_mfma_f32_16x16x32_bf16 v[252:255], a[12:15], a[84:87], v[252:255]
    v_cvt_pk_bf16_f32 v192, v240, v244
    v_cvt_pk_bf16_f32 v193, v241, v245
    v_mfma_f32_16x16x32_bf16 v[248:251], a[16:19], a[88:91], v[248:251]
    v_cvt_pk_bf16_f32 v194, v242, v246
    v_cvt_pk_bf16_f32 v195, v243, v247
    v_mfma_f32_16x16x32_bf16 v[252:255], a[20:23], a[88:91], v[252:255]
    v_xor_b32 v192, v207, v192
    v_xor_b32_e64 v193, v207, v193
    v_mfma_f32_16x16x32_bf16 v[248:251], a[24:27], a[92:95], v[248:251]
    v_xor_b32 v194, v207, v194
    v_xor_b32 v195, v207, v195
    v_mfma_f32_16x16x32_bf16 v[252:255], a[28:31], a[92:95], v[252:255]
    buffer_store_dwordx4 v[192:195], v206, s[24:27], s38 offen sc1
    s_add_u32 s38, s38, 16384
    v_accvgpr_read_b32 v124, a164
    v_accvgpr_read_b32 v125, a165
    v_accvgpr_read_b32 v126, a166
    v_accvgpr_read_b32 v127, a167
    s_nop 1
    v_cvt_pk_bf16_f32 v196, v248, v252
    v_cvt_pk_bf16_f32 v197, v249, v253
    v_cvt_pk_bf16_f32 v198, v250, v254
    v_cvt_pk_bf16_f32 v199, v251, v255
    v_xor_b32 v196, v207, v196
    v_xor_b32 v197, v207, v197
    v_xor_b32 v198, v207, v198
    v_xor_b32_e64 v199, v207, v199
    buffer_store_dwordx4 v[196:199], v206, s[24:27], s38 offen sc1
    s_waitcnt vmcnt(12)
    v_xor_b32 v4, v200, v98
    v_xor_b32 v5, v201, v102
    v_xor_b32 v6, v202, v106
    v_xor_b32_e64 v7, v203, v110
    v_or3_b32 v4, v4, v5, v6
    v_or_b32 v4, v4, v7
    v_cmp_ne_u32 vcc, 0, v4
    s_nop 0
    s_cbranch_vccnz K_POLL2
K_POLL2_OK:
    s_xor_b32 s40, s92, 128
    buffer_load_dword a223, v29, s[16:19], s40 offen
    v_fma_f32 v4, v108, v136, v104
    v_fma_f32 v5, v108, v137, v105
    v_fma_f32 v4, -v109, v137, v4
    v_fma_f32 v5, v109, v136, v5
    v_fma_f32 v6, v4, v136, v100
    v_fma_f32 v7, v4, v137, v101
    v_fma_f32 v6, -v5, v137, v6
    v_fma_f32 v7, v5, v136, v7
    v_fma_f32 v4, v6, v136, v96
    v_fma_f32 v5, v6, v137, v97
    v_fma_f32 v4, -v7, v137, v4
    v_fma_f32 v5, v7, v136, v5
    v_mul_f32 v6, v4, v140
    v_mul_f32 v8, v4, v141
    v_fma_f32 v6, -v5, v141, v6
    v_fma_f32 v8, v5, v140, v8
    v_and_b32_e64 v210, 7, v0
    v_lshl_add_u32 v210, v210, 7, s99
    v_permlane32_swap_b32 v6, v8
    v_add_f32 v6, v6, v8
    v_mov_b32 v8, v6
    v_add_u32 v208, s50, v30
    v_add_u32 v209, s7, v30
    v_permlane16_swap_b32 v6, v8
    v_add_f32 v6, v6, v8
    v_mov_b32 v8, v6
    v_mov_b32 v28, s35
    s_nop 0
    v_permlane32_swap_b32 v6, v8
    s_nop 0
    v_fma_f32 v10, v6, v138, v146
    v_fma_f32 v12, v6, v139, v147
    v_fma_f32 v10, -v8, v139, v10
    v_fma_f32 v12, v8, v138, v12
    v_fma_f32 v11, v10, v132, v142
    v_fma_f32 v13, v10, v133, v144
    v_fma_f32 v11, -v12, v133, v11
    v_fma_f32 v13, v12, v132, v13
    v_pk_fma_f32 v[32:33], v[10:11], v[128:129], v[32:33] op_sel_hi:[1,0,1]
    v_pk_fma_f32 v[36:37], v[12:13], v[128:129], v[36:37] op_sel_hi:[1,0,1]
    v_pk_fma_f32 v[32:33], v[12:13], v[128:129], v[32:33] op_sel:[0,1,0] neg_lo:[1,0,0] neg_hi:[1,0,0]
    v_pk_fma_f32 v[36:37], v[10:11], v[128:129], v[36:37] op_sel:[0,1,0]
    v_pk_fma_f32 v[34:35], v[32:33], v[128:129], v[34:35] op_sel_hi:[1,0,1]
    v_pk_fma_f32 v[38:39], v[36:37], v[128:129], v[38:39] op_sel_hi:[1,0,1]
    v_pk_fma_f32 v[34:35], v[36:37], v[128:129], v[34:35] op_sel:[0,1,0] neg_lo:[1,0,0] neg_hi:[1,0,0]
    v_pk_fma_f32 v[38:39], v[32:33], v[128:129], v[38:39] op_sel:[0,1,0]
    v_cvt_pk_bf16_f32 v224, v32, v34
    v_cvt_pk_bf16_f32 v232, v33, v35
    v_cvt_pk_bf16_f32 v240, -v36, -v38
    v_cvt_pk_bf16_f32 v248, -v37, -v39
    v_pk_fma_f32 v[40:41], v[34:35], v[128:129], v[40:41] op_sel_hi:[1,0,1]
    v_pk_fma_f32 v[44:45], v[38:39], v[128:129], v[44:45] op_sel_hi:[1,0,1]
    v_pk_fma_f32 v[40:41], v[38:39], v[128:129], v[40:41] op_sel:[0,1,0] neg_lo:[1,0,0] neg_hi:[1,0,0]
    v_pk_fma_f32 v[44:45], v[34:35], v[128:129], v[44:45] op_sel:[0,1,0]
    v_pk_fma_f32 v[42:43], v[40:41], v[128:129], v[42:43] op_sel_hi:[1,0,1]
    v_pk_fma_f32 v[46:47], v[44:45], v[128:129], v[46:47] op_sel_hi:[1,0,1]
    v_pk_fma_f32 v[42:43], v[44:45], v[128:129], v[42:43] op_sel:[0,1,0] neg_lo:[1,0,0] neg_hi:[1,0,0]
    v_pk_fma_f32 v[46:47], v[40:41], v[128:129], v[46:47] op_sel:[0,1,0]
    v_cvt_pk_bf16_f32 v225, v40, v42
    v_cvt_pk_bf16_f32 v233, v41, v43
    v_cvt_pk_bf16_f32 v241, -v44, -v46
    v_cvt_pk_bf16_f32 v249, -v45, -v47
    v_pk_fma_f32 v[48:49], v[42:43], v[128:129], v[48:49] op_sel_hi:[1,0,1]
    v_pk_fma_f32 v[52:53], v[46:47], v[128:129], v[52:53] op_sel_hi:[1,0,1]
    v_pk_fma_f32 v[48:49], v[46:47], v[128:129], v[48:49] op_sel:[0,1,0] neg_lo:[1,0,0] neg_hi:[1,0,0]
    v_pk_fma_f32 v[52:53], v[42:43], v[128:129], v[52:53] op_sel:[0,1,0]
    v_pk_fma_f32 v[50:51], v[48:49], v[128:129], v[50:51] op_sel_hi:[1,0,1]
    v_pk_fma_f32 v[54:55], v[52:53], v[128:129], v[54:55] op_sel_hi:[1,0,1]
    v_pk_fma_f32 v[50:51], v[52:53], v[128:129], v[50:51] op_sel:[0,1,0] neg_lo:[1,0,0] neg_hi:[1,0,0]
    v_pk_fma_f32 v[54:55], v[48:49], v[128:129], v[54:55] op_sel:[0,1,0]
    v_cvt_pk_bf16_f32 v226, v48, v50
    v_cvt_pk_bf16_f32 v234, v49, v51
    v_cvt_pk_bf16_f32 v242, -v52, -v54
    v_cvt_pk_bf16_f32 v250, -v53, -v55
    v_pk_fma_f32 v[56:57], v[50:51], v[128:129], v[56:57] op_sel_hi:[1,0,1]
    v_pk_fma_f32 v[60:61], v[54:55], v[128:129], v[60:61] op_sel_hi:[1,0,1]
    v_pk_fma_f32 v[56:57], v[54:55], v[128:129], v[56:57] op_sel:[0,1,0] neg_lo:[1,0,0] neg_hi:[1,0,0]
    v_pk_fma_f32 v[60:61], v[50:51], v[128:129], v[60:61] op_sel:[0,1,0]
    v_pk_fma_f32 v[58:59], v[56:57], v[128:129], v[58:59] op_sel_hi:[1,0,1]
    v_pk_fma_f32 v[62:63], v[60:61], v[128:129], v[62:63] op_sel_hi:[1,0,1]
    v_pk_fma_f32 v[58:59], v[60:61], v[128:129], v[58:59] op_sel:[0,1,0] neg_lo:[1,0,0] neg_hi:[1,0,0]
    v_pk_fma_f32 v[62:63], v[56:57], v[128:129], v[62:63] op_sel:[0,1,0]
    v_cvt_pk_bf16_f32 v227, v56, v58
    v_cvt_pk_bf16_f32 v235, v57, v59
    v_cvt_pk_bf16_f32 v243, -v60, -v62
    v_cvt_pk_bf16_f32 v251, -v61, -v63
    v_pk_fma_f32 v[64:65], v[58:59], v[128:129], v[64:65] op_sel_hi:[1,0,1]
    ds_write_b128 v216, v[224:227] offset:0
    v_pk_fma_f32 v[68:69], v[62:63], v[128:129], v[68:69] op_sel_hi:[1,0,1]
    v_pk_fma_f32 v[64:65], v[62:63], v[128:129], v[64:65] op_sel:[0,1,0] neg_lo:[1,0,0] neg_hi:[1,0,0]
    v_pk_fma_f32 v[68:69], v[58:59], v[128:129], v[68:69] op_sel:[0,1,0]
    v_pk_fma_f32 v[66:67], v[64:65], v[128:129], v[66:67] op_sel_hi:[1,0,1]
    v_pk_fma_f32 v[70:71], v[68:69], v[128:129], v[70:71] op_sel_hi:[1,0,1]
    v_pk_fma_f32 v[66:67], v[68:69], v[128:129], v[66:67] op_sel:[0,1,0] neg_lo:[1,0,0] neg_hi:[1,0,0]
    v_pk_fma_f32 v[70:71], v[64:65], v[128:129], v[70:71] op_sel:[0,1,0]
    v_cvt_pk_bf16_f32 v228, v64, v66
    v_cvt_pk_bf16_f32 v236, v65, v67
    v_cvt_pk_bf16_f32 v244, -v68, -v70
    ds_write_b128 v218, v[232:235] offset:0
    v_cvt_pk_bf16_f32 v252, -v69, -v71
    v_pk_fma_f32 v[72:73], v[66:67], v[128:129], v[72:73] op_sel_hi:[1,0,1]
    v_pk_fma_f32 v[76:77], v[70:71], v[128:129], v[76:77] op_sel_hi:[1,0,1]
    v_pk_fma_f32 v[72:73], v[70:71], v[128:129], v[72:73] op_sel:[0,1,0] neg_lo:[1,0,0] neg_hi:[1,0,0]
    v_pk_fma_f32 v[76:77], v[66:67], v[128:129], v[76:77] op_sel:[0,1,0]
    v_pk_fma_f32 v[74:75], v[72:73], v[128:129], v[74:75] op_sel_hi:[1,0,1]
    v_pk_fma_f32 v[78:79], v[76:77], v[128:129], v[78:79] op_sel_hi:[1,0,1]
    v_pk_fma_f32 v[74:75], v[76:77], v[128:129], v[74:75] op_sel:[0,1,0] neg_lo:[1,0,0] neg_hi:[1,0,0]
    v_pk_fma_f32 v[78:79], v[72:73], v[128:129], v[78:79] op_sel:[0,1,0]
    v_cvt_pk_bf16_f32 v229, v72, v74
    ds_write_b128 v216, v[240:243] offset:4096
    v_cvt_pk_bf16_f32 v237, v73, v75
    v_cvt_pk_bf16_f32 v245, -v76, -v78
    v_cvt_pk_bf16_f32 v253, -v77, -v79
    v_pk_fma_f32 v[80:81], v[74:75], v[128:129], v[80:81] op_sel_hi:[1,0,1]
    v_pk_fma_f32 v[84:85], v[78:79], v[128:129], v[84:85] op_sel_hi:[1,0,1]
    v_pk_fma_f32 v[80:81], v[78:79], v[128:129], v[80:81] op_sel:[0,1,0] neg_lo:[1,0,0] neg_hi:[1,0,0]
    v_pk_fma_f32 v[84:85], v[74:75], v[128:129], v[84:85] op_sel:[0,1,0]
    v_pk_fma_f32 v[82:83], v[80:81], v[128:129], v[82:83] op_sel_hi:[1,0,1]
    v_pk_fma_f32 v[86:87], v[84:85], v[128:129], v[86:87] op_sel_hi:[1,0,1]
    v_pk_fma_f32 v[82:83], v[84:85], v[128:129], v[82:83] op_sel:[0,1,0] neg_lo:[1,0,0] neg_hi:[1,0,0]
    ds_write_b128 v218, v[248:251] offset:4096
    v_pk_fma_f32 v[86:87], v[80:81], v[128:129], v[86:87] op_sel:[0,1,0]
    v_cvt_pk_bf16_f32 v230, v80, v82
    v_cvt_pk_bf16_f32 v238, v81, v83
    v_cvt_pk_bf16_f32 v246, -v84, -v86
    v_cvt_pk_bf16_f32 v254, -v85, -v87
    v_pk_fma_f32 v[88:89], v[82:83], v[128:129], v[88:89] op_sel_hi:[1,0,1]
    v_pk_fma_f32 v[92:93], v[86:87], v[128:129], v[92:93] op_sel_hi:[1,0,1]
    v_pk_fma_f32 v[88:89], v[86:87], v[128:129], v[88:89] op_sel:[0,1,0] neg_lo:[1,0,0] neg_hi:[1,0,0]
    v_pk_fma_f32 v[92:93], v[82:83], v[128:129], v[92:93] op_sel:[0,1,0]
    v_pk_fma_f32 v[90:91], v[88:89], v[128:129], v[90:91] op_sel_hi:[1,0,1]
    v_pk_fma_f32 v[94:95], v[92:93], v[128:129], v[94:95] op_sel_hi:[1,0,1]
    v_pk_fma_f32 v[90:91], v[92:93], v[128:129], v[90:91] op_sel:[0,1,0] neg_lo:[1,0,0] neg_hi:[1,0,0]
    v_pk_fma_f32 v[94:95], v[88:89], v[128:129], v[94:95] op_sel:[0,1,0]
    v_cvt_pk_bf16_f32 v231, v88, v90
    v_cvt_pk_bf16_f32 v239, v89, v91
    v_cvt_pk_bf16_f32 v247, -v92, -v94
    v_cvt_pk_bf16_f32 v255, -v93, -v95
    ds_write_b128 v217, v[228:231] offset:0
    ds_write_b128 v219, v[236:239] offset:0
    ds_write_b128 v217, v[244:247] offset:4096
    ds_write_b128 v219, v[252:255] offset:4096
    v_accvgpr_read_b32 v96, a136
    v_accvgpr_read_b32 v97, a137
    v_accvgpr_read_b32 v98, a138
    v_accvgpr_read_b32 v99, a139
    v_accvgpr_read_b32 v100, a140
    v_accvgpr_read_b32 v101, a141
    v_accvgpr_read_b32 v102, a142
    v_accvgpr_read_b32 v103, a143
    v_accvgpr_read_b32 v104, a144
    v_accvgpr_read_b32 v105, a145
    v_accvgpr_read_b32 v106, a146
    v_accvgpr_read_b32 v107, a147
    v_accvgpr_read_b32 v108, a148
    v_accvgpr_read_b32 v109, a149
    v_accvgpr_read_b32 v110, a150
    v_accvgpr_read_b32 v111, a151
    v_accvgpr_read_b32 v128, a168
    v_accvgpr_read_b32 v129, a169
    s_waitcnt lgkmcnt(0) vmcnt(3)
    s_barrier
    ds_read_b64_tr_b16 v[64:65], v220 offset:0
    ds_read_b64_tr_b16 v[66:67], v221 offset:1024
    ds_read_b64_tr_b16 v[68:69], v220 offset:8192
    ds_read_b64_tr_b16 v[70:71], v221 offset:9216
    ds_read_b64_tr_b16 v[72:73], v220 offset:16384
    ds_read_b64_tr_b16 v[74:75], v221 offset:17408
    ds_read_b64_tr_b16 v[76:77], v220 offset:24576
    ds_read_b64_tr_b16 v[78:79], v221 offset:25600
    ds_read_b64_tr_b16 v[80:81], v222 offset:0
    ds_read_b64_tr_b16 v[82:83], v223 offset:1024
    ds_read_b64_tr_b16 v[84:85], v222 offset:8192
    ds_read_b64_tr_b16 v[86:87], v223 offset:9216
    ds_read_b64_tr_b16 v[88:89], v222 offset:16384
    ds_read_b64_tr_b16 v[90:91], v223 offset:17408
    ds_read_b64_tr_b16 v[92:93], v222 offset:24576
    ds_read_b64_tr_b16 v[94:95], v223 offset:25600
    ds_read_b128 v[152:155], v20 offset:0
    ds_read_b128 v[156:159], v20 offset:2048
    ds_read_b128 v[160:163], v20 offset:4096
    ds_read_b128 v[164:167], v20 offset:6144
    s_waitcnt lgkmcnt(0)
    s_cmp_lg_u32 s50, 0
    s_cbranch_scc1 K_HFAR
    buffer_store_dwordx4 v[64:67], v24, s[28:31], s68 offen
    buffer_store_dwordx4 v[80:83], v24, s[28:31], s69 offen
    v_mfma_f32_16x16x32_bf16 v[32:35], v[64:67], v[152:155], 0
    ds_read_b128 v[168:171], v21 offset:0
    buffer_store_dwordx4 v[68:71], v25, s[28:31], s68 offen
    v_mfma_f32_16x16x32_bf16 v[48:51], v[80:83], v[152:155], 0
    ds_read_b128 v[172:175], v21 offset:2048
    v_mfma_f32_16x16x32_bf16 v[36:39], v[64:67], v[156:159], 0
    ds_read_b128 v[176:179], v21 offset:4096
    buffer_store_dwordx4 v[84:87], v25, s[28:31], s69 offen
    v_mfma_f32_16x16x32_bf16 v[52:55], v[80:83], v[156:159], 0
    ds_read_b128 v[180:183], v21 offset:6144
    v_mfma_f32_16x16x32_bf16 v[40:43], v[64:67], v[160:163], 0
    v_mfma_f32_16x16x32_bf16 v[56:59], v[80:83], v[160:163], 0
    buffer_store_dwordx4 v[72:75], v26, s[28:31], s68 offen
    v_mfma_f32_16x16x32_bf16 v[44:47], v[64:67], v[164:167], 0
    v_mfma_f32_16x16x32_bf16 v[60:63], v[80:83], v[164:167], 0
    s_waitcnt lgkmcnt(0)
    v_mfma_f32_16x16x32_bf16 v[32:35], v[68:71], v[168:171], v[32:35]
    ds_read_b128 v[152:155], v22 offset:0
    buffer_store_dwordx4 v[88:91], v26, s[28:31], s69 offen
    v_mfma_f32_16x16x32_bf16 v[48:51], v[84:87], v[168:171], v[48:51]
    ds_read_b128 v[156:159], v22 offset:2048
    v_mfma_f32_16x16x32_bf16 v[36:39], v[68:71], v[172:175], v[36:39]
    ds_read_b128 v[160:163], v22 offset:4096
    buffer_store_dwordx4 v[76:79], v27, s[28:31], s68 offen
    v_mfma_f32_16x16x32_bf16 v[52:55], v[84:87], v[172:175], v[52:55]
    ds_read_b128 v[164:167], v22 offset:6144
    v_mfma_f32_16x16x32_bf16 v[40:43], v[68:71], v[176:179], v[40:43]
    v_mfma_f32_16x16x32_bf16 v[56:59], v[84:87], v[176:179], v[56:59]
    buffer_store_dwordx4 v[92:95], v27, s[28:31], s69 offen
    v_mfma_f32_16x16x32_bf16 v[44:47], v[68:71], v[180:183], v[44:47]
    v_mfma_f32_16x16x32_bf16 v[60:63], v[84:87], v[180:183], v[60:63]
K_HFAR_RET:
    s_bfe_u32 s72, s97, 262164
    s_add_u32 m0, s37, 81920
    s_lshl_b32 s72, s72, 7
    buffer_load_dwordx4 v16, s[16:19], s72 offen offset:0  lds
    buffer_load_dwordx4 v17, s[16:19], s72 offen offset:1024  lds
    buffer_load_dwordx4 v18, s[16:19], s72 offen offset:2048  lds
    buffer_load_dwordx4 v19, s[16:19], s72 offen offset:3072  lds
    s_bfe_u32 s72, s97, 262168
    s_add_u32 m0, s37, 98304
    s_lshl_b32 s72, s72, 7
    buffer_load_dwordx4 v16, s[16:19], s72 offen offset:0  lds
    buffer_load_dwordx4 v17, s[16:19], s72 offen offset:1024  lds
    buffer_load_dwordx4 v18, s[16:19], s72 offen offset:2048  lds
    buffer_load_dwordx4 v19, s[16:19], s72 offen offset:3072  lds
    s_waitcnt vmcnt(8)
    s_barrier
    buffer_store_dword v28, v208, s[24:27], s70 offen offset:64
    buffer_store_dword v28, v209, s[24:27], s70 offen offset:64 sc1
    s_waitcnt lgkmcnt(0)
    v_mfma_f32_16x16x32_bf16 v[32:35], v[72:75], v[152:155], v[32:35]
    ds_read_b128 v[168:171], v23 offset:0
    s_bfe_u32 s72, s97, 262172
    s_add_u32 m0, s37, 114688
    v_mfma_f32_16x16x32_bf16 v[48:51], v[88:91], v[152:155], v[48:51]
    ds_read_b128 v[172:175], v23 offset:2048
    s_lshl_b32 s72, s72, 7
    buffer_load_dwordx4 v16, s[16:19], s72 offen offset:0  lds
    v_mfma_f32_16x16x32_bf16 v[36:39], v[72:75], v[156:159], v[36:39]
    ds_read_b128 v[176:179], v23 offset:4096
    buffer_load_dwordx4 v17, s[16:19], s72 offen offset:1024  lds
    v_mfma_f32_16x16x32_bf16 v[52:55], v[88:91], v[156:159], v[52:55]
    ds_read_b128 v[180:183], v23 offset:6144
    buffer_load_dwordx4 v18, s[16:19], s72 offen offset:2048  lds
    buffer_load_dwordx4 v19, s[16:19], s72 offen offset:3072  lds
    v_mfma_f32_16x16x32_bf16 v[40:43], v[72:75], v[160:163], v[40:43]
    buffer_load_dword v4, v210, s[24:27], s51 offen offset:64 sc1
    s_lshl_b32 s3, s2, 3
    v_mfma_f32_16x16x32_bf16 v[56:59], v[88:91], v[160:163], v[56:59]
    s_add_u32 s3, s3, 22396928
    v_mfma_f32_16x16x32_bf16 v[44:47], v[72:75], v[164:167], v[44:47]
    v_mov_b32 v28, s35
    v_and_b32 v255, 1073741831, v30
    v_mfma_f32_16x16x32_bf16 v[60:63], v[88:91], v[164:167], v[60:63]
    buffer_store_dword v28, v255, s[24:27], s3 offen sc1
    s_waitcnt lgkmcnt(0) vmcnt(1)
    v_cmp_ne_u32 vcc, s98, v4
    s_nop 0
    s_cbranch_vccnz K_POLL3
K_POLL3_OK:
    s_barrier
    v_mfma_f32_16x16x32_bf16 v[32:35], v[76:79], v[168:171], v[32:35]
    ds_read_b128 v[152:155], v20 offset:16384
    s_bfe_u32 s73, s97, 262148
    s_lshl_b32 s73, s73, 8
    s_add_u32 s73, s73, s95
    v_mfma_f32_16x16x32_bf16 v[48:51], v[92:95], v[168:171], v[48:51]
    ds_read_b128 v[156:159], v20 offset:18432
    s_add_u32 s74, s73, 0x20000
    buffer_load_dwordx4 a[0:3], v24, s[28:31], s73 offen sc1
    buffer_load_dwordx4 a[16:19], v24, s[28:31], s74 offen sc1
    v_mfma_f32_16x16x32_bf16 v[36:39], v[76:79], v[172:175], v[36:39]
    ds_read_b128 v[160:163], v20 offset:20480
    buffer_load_dwordx4 a[4:7], v25, s[28:31], s73 offen sc1
    buffer_load_dwordx4 a[20:23], v25, s[28:31], s74 offen sc1
    buffer_load_dwordx4 a[8:11], v26, s[28:31], s73 offen sc1
    v_mfma_f32_16x16x32_bf16 v[52:55], v[92:95], v[172:175], v[52:55]
    ds_read_b128 v[164:167], v20 offset:22528
    buffer_load_dwordx4 a[24:27], v26, s[28:31], s74 offen sc1
    buffer_load_dwordx4 a[12:15], v27, s[28:31], s73 offen sc1
    v_mfma_f32_16x16x32_bf16 v[40:43], v[76:79], v[176:179], v[40:43]
    buffer_load_dwordx4 a[28:31], v27, s[28:31], s74 offen sc1
    s_bfe_u32 s73, s97, 262152
    s_lshl_b32 s73, s73, 8
    v_mfma_f32_16x16x32_bf16 v[56:59], v[92:95], v[176:179], v[56:59]
    s_add_u32 s73, s73, s95
    s_add_u32 s74, s73, 0x20000
    buffer_load_dwordx4 a[32:35], v24, s[28:31], s73 offen sc1
    v_mfma_f32_16x16x32_bf16 v[44:47], v[76:79], v[180:183], v[44:47]
    buffer_load_dwordx4 a[48:51], v24, s[28:31], s74 offen sc1
    buffer_load_dwordx4 a[36:39], v25, s[28:31], s73 offen sc1
    buffer_load_dwordx4 a[52:55], v25, s[28:31], s74 offen sc1
    v_mfma_f32_16x16x32_bf16 v[60:63], v[92:95], v[180:183], v[60:63]
    buffer_load_dwordx4 a[40:43], v26, s[28:31], s73 offen sc1
    buffer_load_dwordx4 a[56:59], v26, s[28:31], s74 offen sc1
    s_waitcnt lgkmcnt(0) vmcnt(12)
    v_mfma_f32_16x16x32_bf16 v[32:35], a[0:3], v[152:155], v[32:35]
    ds_read_b128 v[168:171], v21 offset:16384
    buffer_load_dwordx4 a[44:47], v27, s[28:31], s73 offen sc1
    v_mfma_f32_16x16x32_bf16 v[48:51], a[16:19], v[152:155], v[48:51]
    ds_read_b128 v[172:175], v21 offset:18432
    buffer_load_dwordx4 a[60:63], v27, s[28:31], s74 offen sc1
    v_mfma_f32_16x16x32_bf16 v[36:39], a[0:3], v[156:159], v[36:39]
    ds_read_b128 v[176:179], v21 offset:20480
    s_bfe_u32 s73, s97, 262156
    v_mfma_f32_16x16x32_bf16 v[52:55], a[16:19], v[156:159], v[52:55]
    ds_read_b128 v[180:183], v21 offset:22528
    s_lshl_b32 s73, s73, 8
    v_mfma_f32_16x16x32_bf16 v[40:43], a[0:3], v[160:163], v[40:43]
    s_add_u32 s73, s73, s95
    v_mfma_f32_16x16x32_bf16 v[56:59], a[16:19], v[160:163], v[56:59]
    s_add_u32 s74, s73, 0x20000
    v_mfma_f32_16x16x32_bf16 v[44:47], a[0:3], v[164:167], v[44:47]
    buffer_load_dwordx4 a[64:67], v24, s[28:31], s73 offen sc1
    v_mfma_f32_16x16x32_bf16 v[60:63], a[16:19], v[164:167], v[60:63]
    s_waitcnt lgkmcnt(0) vmcnt(13)
    v_mfma_f32_16x16x32_bf16 v[32:35], a[4:7], v[168:171], v[32:35]
    ds_read_b128 v[152:155], v22 offset:16384
    buffer_load_dwordx4 a[80:83], v24, s[28:31], s74 offen sc1
    v_mfma_f32_16x16x32_bf16 v[48:51], a[20:23], v[168:171], v[48:51]
    ds_read_b128 v[156:159], v22 offset:18432
    v_mfma_f32_16x16x32_bf16 v[36:39], a[4:7], v[172:175], v[36:39]
    ds_read_b128 v[160:163], v22 offset:20480
    buffer_load_dwordx4 a[68:71], v25, s[28:31], s73 offen sc1
    v_mfma_f32_16x16x32_bf16 v[52:55], a[20:23], v[172:175], v[52:55]
    ds_read_b128 v[164:167], v22 offset:22528
    v_mfma_f32_16x16x32_bf16 v[40:43], a[4:7], v[176:179], v[40:43]
    v_mfma_f32_16x16x32_bf16 v[56:59], a[20:23], v[176:179], v[56:59]
    buffer_load_dwordx4 a[84:87], v25, s[28:31], s74 offen sc1
    v_mfma_f32_16x16x32_bf16 v[44:47], a[4:7], v[180:183], v[44:47]
    v_mfma_f32_16x16x32_bf16 v[60:63], a[20:23], v[180:183], v[60:63]
    s_waitcnt lgkmcnt(0) vmcnt(14)
    v_mfma_f32_16x16x32_bf16 v[32:35], a[8:11], v[152:155], v[32:35]
    ds_read_b128 v[168:171], v23 offset:16384
    buffer_load_dwordx4 a[72:75], v26, s[28:31], s73 offen sc1
    v_mfma_f32_16x16x32_bf16 v[48:51], a[24:27], v[152:155], v[48:51]
    ds_read_b128 v[172:175], v23 offset:18432
    v_mfma_f32_16x16x32_bf16 v[36:39], a[8:11], v[156:159], v[36:39]
    ds_read_b128 v[176:179], v23 offset:20480
    v_mfma_f32_16x16x32_bf16 v[52:55], a[24:27], v[156:159], v[52:55]
    ds_read_b128 v[180:183], v23 offset:22528
    v_mfma_f32_16x16x32_bf16 v[40:43], a[8:11], v[160:163], v[40:43]
    buffer_load_dwordx4 a[88:91], v26, s[28:31], s74 offen sc1
    v_mfma_f32_16x16x32_bf16 v[56:59], a[24:27], v[160:163], v[56:59]
    v_mfma_f32_16x16x32_bf16 v[44:47], a[8:11], v[164:167], v[44:47]
    v_mfma_f32_16x16x32_bf16 v[60:63], a[24:27], v[164:167], v[60:63]
    s_waitcnt lgkmcnt(0) vmcnt(14)
    v_mfma_f32_16x16x32_bf16 v[32:35], a[12:15], v[168:171], v[32:35]
    ds_read_b128 v[152:155], v20 offset:32768
    buffer_load_dwordx4 a[76:79], v27, s[28:31], s73 offen sc1
    v_sub_u32 v14, v0, v2
    v_mfma_f32_16x16x32_bf16 v[48:51], a[28:31], v[168:171], v[48:51]
    ds_read_b128 v[156:159], v20 offset:34816
    v_and_b32_e64 v14, 3, v14
    v_mfma_f32_16x16x32_bf16 v[36:39], a[12:15], v[172:175], v[36:39]
    ds_read_b128 v[160:163], v20 offset:36864
    v_and_or_b32 v14, v0, 60, v14
    v_mfma_f32_16x16x32_bf16 v[52:55], a[28:31], v[172:175], v[52:55]
    ds_read_b128 v[164:167], v20 offset:38912
    v_lshlrev_b32_e64 v133, 4, v14
    v_mfma_f32_16x16x32_bf16 v[40:43], a[12:15], v[176:179], v[40:43]
    buffer_load_dwordx4 a[92:95], v27, s[28:31], s74 offen sc1
    s_and_b32 s38, s34, 2
    v_mfma_f32_16x16x32_bf16 v[56:59], a[28:31], v[176:179], v[56:59]
    s_lshl3_add_u32 s39, s6, 131072
    v_mfma_f32_16x16x32_bf16 v[44:47], a[12:15], v[180:183], v[44:47]
    v_lshl_add_u32 v14, v2, 6, v1
    v_mfma_f32_16x16x32_bf16 v[60:63], a[28:31], v[180:183], v[60:63]
    s_waitcnt lgkmcnt(0) vmcnt(14)
    v_mfma_f32_16x16x32_bf16 v[32:35], a[32:35], v[152:155], v[32:35]
    ds_read_b128 v[168:171], v21 offset:32768
    s_bfe_u32 s73, s97, 262160
    v_lshrrev_b32_e64 v15, 2, v1
    v_mfma_f32_16x16x32_bf16 v[48:51], a[48:51], v[152:155], v[48:51]
    ds_read_b128 v[172:175], v21 offset:34816
    s_lshl_b32 s73, s73, 8
    v_add_u32 v15, s38, v15
    v_mfma_f32_16x16x32_bf16 v[36:39], a[32:35], v[156:159], v[36:39]
    ds_read_b128 v[176:179], v21 offset:36864
    s_add_u32 s73, s73, s95
    v_and_b32 v15, 3, v15
    v_mfma_f32_16x16x32_bf16 v[52:55], a[48:51], v[156:159], v[52:55]
    ds_read_b128 v[180:183], v21 offset:38912
    v_lshl_add_u32 v15, v14, 2, v15
    v_mfma_f32_16x16x32_bf16 v[40:43], a[32:35], v[160:163], v[40:43]
    s_add_u32 s74, s73, 0x20000
    v_lshl_add_u32 v130, v15, 4, s39
    v_mfma_f32_16x16x32_bf16 v[56:59], a[48:51], v[160:163], v[56:59]
    buffer_load_dwordx4 a[96:99], v24, s[28:31], s73 offen sc1
    v_sub_u32 v14, 256, v14
    v_mfma_f32_16x16x32_bf16 v[44:47], a[32:35], v[164:167], v[44:47]
    buffer_load_dwordx4 a[112:115], v24, s[28:31], s74 offen sc1
    v_lshrrev_b32_e64 v15, 2, v14
    v_mfma_f32_16x16x32_bf16 v[60:63], a[48:51], v[164:167], v[60:63]
    s_waitcnt lgkmcnt(0) vmcnt(14)
    v_mfma_f32_16x16x32_bf16 v[32:35], a[36:39], v[168:171], v[32:35]
    ds_read_b128 v[152:155], v22 offset:32768
    buffer_load_dwordx4 a[100:103], v25, s[28:31], s73 offen sc1
    v_add3_u32 v15, v15, s38, 1
    v_mfma_f32_16x16x32_bf16 v[48:51], a[52:55], v[168:171], v[48:51]
    ds_read_b128 v[156:159], v22 offset:34816
    buffer_load_dwordx4 a[116:119], v25, s[28:31], s74 offen sc1
    v_and_b32 v15, 3, v15
    v_mfma_f32_16x16x32_bf16 v[36:39], a[36:39], v[172:175], v[36:39]
    ds_read_b128 v[160:163], v22 offset:36864
    s_getpc_b64 s[20:21]
K_PC3:
    s_mov_b32 s22, K_CODE_END-K_PC3
    v_lshl_add_u32 v15, v14, 2, v15
    v_mfma_f32_16x16x32_bf16 v[52:55], a[52:55], v[172:175], v[52:55]
    ds_read_b128 v[164:167], v22 offset:38912
    s_bfe_u32 s3, s2, 0x20003
    v_lshl_add_u32 v131, v15, 4, s39
    v_mfma_f32_16x16x32_bf16 v[40:43], a[36:39], v[176:179], v[40:43]
    s_lshl2_add_u32 s3, s3, s34
    v_and_b32 v15, 1023, v15
    v_mfma_f32_16x16x32_bf16 v[56:59], a[52:55], v[176:179], v[56:59]
    s_lshl_b32 s3, s3, 11
    v_lshl_add_u32 v132, v15, 4, s39
    v_mfma_f32_16x16x32_bf16 v[44:47], a[36:39], v[180:183], v[44:47]
    v_lshl_add_u32 v28, v0, 5, s3
    v_subrev_u32 v131, 3072, v131
    v_mfma_f32_16x16x32_bf16 v[60:63], a[52:55], v[180:183], v[60:63]
    buffer_load_dword v11, v28, s[20:23], 0 offen
    s_waitcnt lgkmcnt(0) vmcnt(15)
    v_mfma_f32_16x16x32_bf16 v[32:35], a[40:43], v[152:155], v[32:35]
    ds_read_b128 v[168:171], v23 offset:32768
    buffer_load_dwordx4 a[104:107], v26, s[28:31], s73 offen sc1
    v_lshlrev_b32_e64 v216, 16, v112
    v_mfma_f32_16x16x32_bf16 v[48:51], a[56:59], v[152:155], v[48:51]
    ds_read_b128 v[172:175], v23 offset:34816
    v_and_b32 v220, 0xffff0000, v112
    v_mfma_f32_16x16x32_bf16 v[36:39], a[40:43], v[156:159], v[36:39]
    ds_read_b128 v[176:179], v23 offset:36864
    v_lshlrev_b32_e64 v217, 16, v113
    v_mfma_f32_16x16x32_bf16 v[52:55], a[56:59], v[156:159], v[52:55]
    ds_read_b128 v[180:183], v23 offset:38912
    v_and_b32 v221, 0xffff0000, v113
    v_mfma_f32_16x16x32_bf16 v[40:43], a[40:43], v[160:163], v[40:43]
    buffer_load_dwordx4 a[120:123], v26, s[28:31], s74 offen sc1
    v_lshlrev_b32_e64 v218, 16, v114
    v_mfma_f32_16x16x32_bf16 v[56:59], a[56:59], v[160:163], v[56:59]
    v_and_b32 v222, 0xffff0000, v114
    v_mfma_f32_16x16x32_bf16 v[44:47], a[40:43], v[164:167], v[44:47]
    v_lshlrev_b32_e64 v219, 16, v115
    v_mfma_f32_16x16x32_bf16 v[60:63], a[56:59], v[164:167], v[60:63]
    s_waitcnt lgkmcnt(0) vmcnt(15)
    v_mfma_f32_16x16x32_bf16 v[32:35], a[44:47], v[168:171], v[32:35]
    ds_read_b128 v[152:155], v20 offset:49152
    v_lshlrev_b32 v13, 3, v0
    v_and_b32 v223, 0xffff0000, v115
    v_mfma_f32_16x16x32_bf16 v[48:51], a[60:63], v[168:171], v[48:51]
    ds_read_b128 v[156:159], v20 offset:51200
    s_lshl_b32 s70, s34, 9
    v_lshlrev_b32 v224, 16, v116
    v_mfma_f32_16x16x32_bf16 v[36:39], a[44:47], v[172:175], v[36:39]
    ds_read_b128 v[160:163], v20 offset:53248
    s_add_u32 s70, s70, 22396928
    v_and_b32 v228, 0xffff0000, v116
    v_mfma_f32_16x16x32_bf16 v[52:55], a[60:63], v[172:175], v[52:55]
    ds_read_b128 v[164:167], v20 offset:55296
    v_lshlrev_b32_e64 v225, 16, v117
    v_mfma_f32_16x16x32_bf16 v[40:43], a[44:47], v[176:179], v[40:43]
    buffer_load_dword v8, v13, s[24:27], s70 offen sc1
    v_and_b32 v229, 0xffff0000, v117
    v_mfma_f32_16x16x32_bf16 v[56:59], a[60:63], v[176:179], v[56:59]
    buffer_load_dwordx4 a[108:111], v27, s[28:31], s73 offen sc1
    v_lshlrev_b32_e64 v226, 16, v118
    v_mfma_f32_16x16x32_bf16 v[44:47], a[44:47], v[180:183], v[44:47]
    buffer_load_dwordx4 a[124:127], v27, s[28:31], s74 offen sc1
    v_and_b32 v230, 0xffff0000, v118
    v_xor_b32 v20, 0x10000, v20
    v_mfma_f32_16x16x32_bf16 v[60:63], a[60:63], v[180:183], v[60:63]
    s_waitcnt lgkmcnt(0) vmcnt(16)
    v_mfma_f32_16x16x32_bf16 v[32:35], a[64:67], v[152:155], v[32:35]
    ds_read_b128 v[168:171], v21 offset:49152
    s_bfe_u32 s73, s97, 262164
    v_lshlrev_b32 v227, 16, v119
    v_mfma_f32_16x16x32_bf16 v[48:51], a[80:83], v[152:155], v[48:51]
    ds_read_b128 v[172:175], v21 offset:51200
    s_lshl_b32 s73, s73, 8
    v_and_b32 v231, 0xffff0000, v119
    v_mfma_f32_16x16x32_bf16 v[36:39], a[64:67], v[156:159], v[36:39]
    ds_read_b128 v[176:179], v21 offset:53248
    s_add_u32 s73, s73, s95
    v_lshlrev_b32_e64 v232, 16, v120
    v_mfma_f32_16x16x32_bf16 v[52:55], a[80:83], v[156:159], v[52:55]
    ds_read_b128 v[180:183], v21 offset:55296
    v_and_b32 v236, 0xffff0000, v120
    v_mfma_f32_16x16x32_bf16 v[40:43], a[64:67], v[160:163], v[40:43]
    s_add_u32 s74, s73, 0x20000
    v_lshlrev_b32_e64 v233, 16, v121
    v_mfma_f32_16x16x32_bf16 v[56:59], a[80:83], v[160:163], v[56:59]
    buffer_load_dwordx4 a[128:131], v24, s[28:31], s73 offen sc1
    v_and_b32 v237, 0xffff0000, v121
    v_mfma_f32_16x16x32_bf16 v[44:47], a[64:67], v[164:167], v[44:47]
    buffer_load_dwordx4 a[144:147], v24, s[28:31], s74 offen sc1
    v_lshlrev_b32_e64 v234, 16, v122
    v_xor_b32 v21, 0x10000, v21
    v_mfma_f32_16x16x32_bf16 v[60:63], a[80:83], v[164:167], v[60:63]
    s_waitcnt lgkmcnt(0) vmcnt(16)
    v_mfma_f32_16x16x32_bf16 v[32:35], a[68:71], v[168:171], v[32:35]
    ds_read_b128 v[152:155], v22 offset:49152
    buffer_load_dwordx4 a[132:135], v25, s[28:31], s73 offen sc1
    v_and_b32 v238, 0xffff0000, v122
    v_mfma_f32_16x16x32_bf16 v[48:51], a[84:87], v[168:171], v[48:51]
    ds_read_b128 v[156:159], v22 offset:51200
    v_lshlrev_b32 v235, 16, v123
    v_mfma_f32_16x16x32_bf16 v[36:39], a[68:71], v[172:175], v[36:39]
    ds_read_b128 v[160:163], v22 offset:53248
    v_and_b32 v239, 0xffff0000, v123
    v_mfma_f32_16x16x32_bf16 v[52:55], a[84:87], v[172:175], v[52:55]
    ds_read_b128 v[164:167], v22 offset:55296
    v_lshlrev_b32_e64 v240, 16, v124
    v_mfma_f32_16x16x32_bf16 v[40:43], a[68:71], v[176:179], v[40:43]
    buffer_load_dwordx4 a[148:151], v25, s[28:31], s74 offen sc1
    v_and_b32 v244, 0xffff0000, v124
    v_mfma_f32_16x16x32_bf16 v[56:59], a[84:87], v[176:179], v[56:59]
    v_lshlrev_b32_e64 v241, 16, v125
    v_mfma_f32_16x16x32_bf16 v[44:47], a[68:71], v[180:183], v[44:47]
    v_and_b32 v245, 0xffff0000, v125
    v_xor_b32 v22, 0x10000, v22
    v_mfma_f32_16x16x32_bf16 v[60:63], a[84:87], v[180:183], v[60:63]
    s_waitcnt lgkmcnt(0) vmcnt(16)
    v_mfma_f32_16x16x32_bf16 v[32:35], a[72:75], v[152:155], v[32:35]
    ds_read_b128 v[168:171], v23 offset:49152
    buffer_load_dwordx4 a[136:139], v26, s[28:31], s73 offen sc1
    v_lshlrev_b32 v242, 16, v126
    v_mfma_f32_16x16x32_bf16 v[48:51], a[88:91], v[152:155], v[48:51]
    ds_read_b128 v[172:175], v23 offset:51200
    v_and_b32 v246, 0xffff0000, v126
    v_mfma_f32_16x16x32_bf16 v[36:39], a[72:75], v[156:159], v[36:39]
    ds_read_b128 v[176:179], v23 offset:53248
    v_lshlrev_b32_e64 v243, 16, v127
    v_mfma_f32_16x16x32_bf16 v[52:55], a[88:91], v[156:159], v[52:55]
    ds_read_b128 v[180:183], v23 offset:55296
    v_and_b32 v247, 0xffff0000, v127
    v_mfma_f32_16x16x32_bf16 v[40:43], a[72:75], v[160:163], v[40:43]
    buffer_load_dwordx4 a[152:155], v26, s[28:31], s74 offen sc1
    v_xor_b32 v16, 0x100000, v16
    v_mfma_f32_16x16x32_bf16 v[56:59], a[88:91], v[160:163], v[56:59]
    v_xor_b32 v17, 0x100000, v17
    v_mfma_f32_16x16x32_bf16 v[44:47], a[72:75], v[164:167], v[44:47]
    v_xor_b32 v18, 0x100000, v18
    v_xor_b32 v23, 0x10000, v23
    v_mfma_f32_16x16x32_bf16 v[60:63], a[88:91], v[164:167], v[60:63]
    s_waitcnt lgkmcnt(0) vmcnt(16)
    v_mfma_f32_16x16x32_bf16 v[32:35], a[76:79], v[168:171], v[32:35]
    ds_read_b128 v[152:155], v20 offset:0
    buffer_load_dwordx4 a[140:143], v27, s[28:31], s73 offen sc1
    v_xor_b32 v19, 0x100000, v19
    v_mfma_f32_16x16x32_bf16 v[48:51], a[92:95], v[168:171], v[48:51]
    ds_read_b128 v[156:159], v20 offset:2048
    v_lshlrev_b32 v4, 16, v2
    v_mfma_f32_16x16x32_bf16 v[36:39], a[76:79], v[172:175], v[36:39]
    ds_read_b128 v[160:163], v20 offset:4096
    v_lshl_add_u32 v4, v1, 4, v4
    v_mfma_f32_16x16x32_bf16 v[52:55], a[92:95], v[172:175], v[52:55]
    ds_read_b128 v[164:167], v20 offset:6144
    s_lshl_b32 s38, s2, 14
    v_mfma_f32_16x16x32_bf16 v[40:43], a[76:79], v[176:179], v[40:43]
    buffer_load_dwordx4 a[156:159], v27, s[28:31], s74 offen sc1
    s_add_u32 s38, s38, s37
    v_mfma_f32_16x16x32_bf16 v[56:59], a[92:95], v[176:179], v[56:59]
    s_add_u32 s52, s38, 17825792
    v_mfma_f32_16x16x32_bf16 v[44:47], a[76:79], v[180:183], v[44:47]
    s_xor_b32 s38, s38, 65536
    v_mfma_f32_16x16x32_bf16 v[60:63], a[92:95], v[180:183], v[60:63]
    s_waitcnt lgkmcnt(0) vmcnt(16)
    v_mfma_f32_16x16x32_bf16 v[32:35], a[96:99], v[152:155], v[32:35]
    ds_read_b128 v[168:171], v21 offset:0
    s_bfe_u32 s73, s97, 262168
    s_add_u32 s54, s38, 17825792
    v_mfma_f32_16x16x32_bf16 v[48:51], a[112:115], v[152:155], v[48:51]
    ds_read_b128 v[172:175], v21 offset:2048
    s_lshl_b32 s73, s73, 8
    s_lshl_b32 s38, s4, 14
    v_mfma_f32_16x16x32_bf16 v[36:39], a[96:99], v[156:159], v[36:39]
    ds_read_b128 v[176:179], v21 offset:4096
    s_add_u32 s73, s73, s95
    s_add_u32 s38, s38, s37
    v_mfma_f32_16x16x32_bf16 v[52:55], a[112:115], v[156:159], v[52:55]
    ds_read_b128 v[180:183], v21 offset:6144
    s_add_u32 s53, s38, 13631488
    v_mfma_f32_16x16x32_bf16 v[40:43], a[96:99], v[160:163], v[40:43]
    s_add_u32 s74, s73, 0x20000
    s_lshl2_add_u32 s38, s32, s34
    v_mfma_f32_16x16x32_bf16 v[56:59], a[112:115], v[160:163], v[56:59]
    buffer_load_dwordx4 a[160:163], v24, s[28:31], s73 offen sc1
    s_lshl_b32 s38, s38, 10
    v_mfma_f32_16x16x32_bf16 v[44:47], a[96:99], v[164:167], v[44:47]
    buffer_load_dwordx4 a[176:179], v24, s[28:31], s74 offen sc1
    s_add_u32 s55, s38, 22282240
    v_mfma_f32_16x16x32_bf16 v[60:63], a[112:115], v[164:167], v[60:63]
    s_waitcnt lgkmcnt(0) vmcnt(16)
    v_mfma_f32_16x16x32_bf16 v[32:35], a[100:103], v[168:171], v[32:35]
    ds_read_b128 v[152:155], v22 offset:0
    buffer_load_dwordx4 a[164:167], v25, s[28:31], s73 offen sc1
    v_lshlrev_b32_e64 v7, 8, v2
    v_mfma_f32_16x16x32_bf16 v[48:51], a[116:119], v[168:171], v[48:51]
    ds_read_b128 v[156:159], v22 offset:2048
    s_lshl_b32 s38, s94, 16
    v_mfma_f32_16x16x32_bf16 v[36:39], a[100:103], v[172:175], v[36:39]
    ds_read_b128 v[160:163], v22 offset:4096
    s_add_u32 s56, s38, s5
    v_mfma_f32_16x16x32_bf16 v[52:55], a[116:119], v[172:175], v[52:55]
    ds_read_b128 v[164:167], v22 offset:6144
    v_lshlrev_b32_e64 v12, 14, v2
    v_mfma_f32_16x16x32_bf16 v[40:43], a[100:103], v[176:179], v[40:43]
    buffer_load_dwordx4 a[180:183], v25, s[28:31], s74 offen sc1
    v_lshl_add_u32 v12, v1, 4, v12
    v_mfma_f32_16x16x32_bf16 v[56:59], a[116:119], v[176:179], v[56:59]
    s_lshl_b32 s38, s4, 6
    v_mfma_f32_16x16x32_bf16 v[44:47], a[100:103], v[180:183], v[44:47]
    s_add_u32 s58, s38, 22429696
    v_mfma_f32_16x16x32_bf16 v[60:63], a[116:119], v[180:183], v[60:63]
    s_waitcnt lgkmcnt(0) vmcnt(14)
    v_cmp_ne_u32 vcc, s35, v8
    s_nop 0
    s_cbranch_vccnz K_POLL4
K_POLL4_OK:
    s_barrier
    v_mfma_f32_16x16x32_bf16 v[32:35], a[104:107], v[152:155], v[32:35]
    ds_read_b128 v[168:171], v23 offset:0
    buffer_load_dwordx4 a[168:171], v26, s[28:31], s73 offen sc1
    s_add_u32 s57, s38, 22413312
    v_mfma_f32_16x16x32_bf16 v[48:51], a[120:123], v[152:155], v[48:51]
    ds_read_b128 v[172:175], v23 offset:2048
    v_lshl_add_u32 v5, v1, 6, s99
    v_mfma_f32_16x16x32_bf16 v[36:39], a[104:107], v[156:159], v[36:39]
    ds_read_b128 v[176:179], v23 offset:4096
    s_xor_b32 s38, s33, 264
    v_mfma_f32_16x16x32_bf16 v[52:55], a[120:123], v[156:159], v[52:55]
    ds_read_b128 v[180:183], v23 offset:6144
    v_mfma_f32_16x16x32_bf16 v[40:43], a[104:107], v[160:163], v[40:43]
    buffer_load_dwordx4 a[184:187], v26, s[28:31], s74 offen sc1
    s_lshl_b32 s38, s38, 6
    v_mfma_f32_16x16x32_bf16 v[56:59], a[120:123], v[160:163], v[56:59]
    s_add_u32 s38, s38, s99
    v_mfma_f32_16x16x32_bf16 v[44:47], a[104:107], v[164:167], v[44:47]
    v_mov_b32_e64 v9, s38
    v_mfma_f32_16x16x32_bf16 v[60:63], a[120:123], v[164:167], v[60:63]
    s_waitcnt lgkmcnt(0) vmcnt(14)
    v_mfma_f32_16x16x32_bf16 v[32:35], a[108:111], v[168:171], v[32:35]
    ds_read_b128 v[152:155], v20 offset:16384
    s_lshl2_add_u32 s70, s4, s34
    v_mfma_f32_16x16x32_bf16 v[48:51], a[124:127], v[168:171], v[48:51]
    ds_read_b128 v[156:159], v20 offset:18432
    s_lshl_b32 s70, s70, 12
    v_mfma_f32_16x16x32_bf16 v[36:39], a[108:111], v[172:175], v[36:39]
    ds_read_b128 v[160:163], v20 offset:20480
    s_add_u32 m0, s37, 131072
    v_mfma_f32_16x16x32_bf16 v[52:55], a[124:127], v[172:175], v[52:55]
    ds_read_b128 v[164:167], v20 offset:22528
    s_add_u32 s70, s70, 9437184
    v_mfma_f32_16x16x32_bf16 v[40:43], a[108:111], v[176:179], v[40:43]
    buffer_load_dwordx4 v133, s[24:27], s70 offen offset:0 sc1 lds
    v_mfma_f32_16x16x32_bf16 v[56:59], a[124:127], v[176:179], v[56:59]
    buffer_load_dwordx4 v133, s[24:27], s70 offen offset:1024 sc1 lds
    v_mfma_f32_16x16x32_bf16 v[44:47], a[108:111], v[180:183], v[44:47]
    buffer_load_dwordx4 a[172:175], v27, s[28:31], s73 offen sc1
    v_mfma_f32_16x16x32_bf16 v[60:63], a[124:127], v[180:183], v[60:63]
    buffer_load_dwordx4 a[188:191], v27, s[28:31], s74 offen sc1
    s_waitcnt lgkmcnt(0) vmcnt(16)
    v_mfma_f32_16x16x32_bf16 v[32:35], a[128:131], v[152:155], v[32:35]
    ds_read_b128 v[168:171], v21 offset:16384
    buffer_load_dwordx4 v133, s[24:27], s70 offen offset:2048 sc1 lds
    v_mfma_f32_16x16x32_bf16 v[48:51], a[144:147], v[152:155], v[48:51]
    ds_read_b128 v[172:175], v21 offset:18432
    buffer_load_dwordx4 v133, s[24:27], s70 offen offset:3072 sc1 lds
    v_mfma_f32_16x16x32_bf16 v[36:39], a[128:131], v[156:159], v[36:39]
    ds_read_b128 v[176:179], v21 offset:20480
    s_bfe_u32 s73, s97, 262172
    v_mfma_f32_16x16x32_bf16 v[52:55], a[144:147], v[156:159], v[52:55]
    ds_read_b128 v[180:183], v21 offset:22528
    s_lshl_b32 s73, s73, 8
    v_mfma_f32_16x16x32_bf16 v[40:43], a[128:131], v[160:163], v[40:43]
    s_add_u32 s73, s73, s95
    v_mfma_f32_16x16x32_bf16 v[56:59], a[144:147], v[160:163], v[56:59]
    s_add_u32 s74, s73, 0x20000
    v_mfma_f32_16x16x32_bf16 v[44:47], a[128:131], v[164:167], v[44:47]
    buffer_load_dwordx4 a[192:195], v24, s[28:31], s73 offen sc1 nt
    v_mfma_f32_16x16x32_bf16 v[60:63], a[144:147], v[164:167], v[60:63]
    buffer_load_dwordx4 a[208:211], v24, s[28:31], s74 offen sc1 nt
    s_waitcnt lgkmcnt(0) vmcnt(18)
    v_mfma_f32_16x16x32_bf16 v[32:35], a[132:135], v[168:171], v[32:35]
    ds_read_b128 v[152:155], v22 offset:16384
    buffer_load_dwordx4 a[196:199], v25, s[28:31], s73 offen sc1 nt
    v_mfma_f32_16x16x32_bf16 v[48:51], a[148:151], v[168:171], v[48:51]
    ds_read_b128 v[156:159], v22 offset:18432
    v_mfma_f32_16x16x32_bf16 v[36:39], a[132:135], v[172:175], v[36:39]
    ds_read_b128 v[160:163], v22 offset:20480
    v_mfma_f32_16x16x32_bf16 v[52:55], a[148:151], v[172:175], v[52:55]
    ds_read_b128 v[164:167], v22 offset:22528
    v_mfma_f32_16x16x32_bf16 v[40:43], a[132:135], v[176:179], v[40:43]
    buffer_load_dwordx4 a[212:215], v25, s[28:31], s74 offen sc1 nt
    v_mfma_f32_16x16x32_bf16 v[56:59], a[148:151], v[176:179], v[56:59]
    v_mfma_f32_16x16x32_bf16 v[44:47], a[132:135], v[180:183], v[44:47]
    v_mfma_f32_16x16x32_bf16 v[60:63], a[148:151], v[180:183], v[60:63]
    s_waitcnt lgkmcnt(0) vmcnt(18)
    v_mfma_f32_16x16x32_bf16 v[32:35], a[136:139], v[152:155], v[32:35]
    ds_read_b128 v[168:171], v23 offset:16384
    buffer_load_dwordx4 a[200:203], v26, s[28:31], s73 offen sc1 nt
    v_mfma_f32_16x16x32_bf16 v[48:51], a[152:155], v[152:155], v[48:51]
    ds_read_b128 v[172:175], v23 offset:18432
    v_mfma_f32_16x16x32_bf16 v[36:39], a[136:139], v[156:159], v[36:39]
    ds_read_b128 v[176:179], v23 offset:20480
    v_mfma_f32_16x16x32_bf16 v[52:55], a[152:155], v[156:159], v[52:55]
    ds_read_b128 v[180:183], v23 offset:22528
    v_mfma_f32_16x16x32_bf16 v[40:43], a[136:139], v[160:163], v[40:43]
    buffer_load_dwordx4 a[216:219], v26, s[28:31], s74 offen sc1 nt
    v_mfma_f32_16x16x32_bf16 v[56:59], a[152:155], v[160:163], v[56:59]
    v_mfma_f32_16x16x32_bf16 v[44:47], a[136:139], v[164:167], v[44:47]
    v_mfma_f32_16x16x32_bf16 v[60:63], a[152:155], v[164:167], v[60:63]
    s_waitcnt lgkmcnt(0) vmcnt(18)
    v_mfma_f32_16x16x32_bf16 v[32:35], a[140:143], v[168:171], v[32:35]
    ds_read_b128 v[152:155], v20 offset:32768
    buffer_load_dwordx4 a[204:207], v27, s[28:31], s73 offen sc1 nt
    v_mfma_f32_16x16x32_bf16 v[48:51], a[156:159], v[168:171], v[48:51]
    ds_read_b128 v[156:159], v20 offset:34816
    v_mfma_f32_16x16x32_bf16 v[36:39], a[140:143], v[172:175], v[36:39]
    ds_read_b128 v[160:163], v20 offset:36864
    v_mfma_f32_16x16x32_bf16 v[52:55], a[156:159], v[172:175], v[52:55]
    ds_read_b128 v[164:167], v20 offset:38912
    v_mfma_f32_16x16x32_bf16 v[40:43], a[140:143], v[176:179], v[40:43]
    buffer_load_dwordx4 a[220:223], v27, s[28:31], s74 offen sc1 nt
    v_mfma_f32_16x16x32_bf16 v[56:59], a[156:159], v[176:179], v[56:59]
    v_mfma_f32_16x16x32_bf16 v[44:47], a[140:143], v[180:183], v[44:47]
    v_mfma_f32_16x16x32_bf16 v[60:63], a[156:159], v[180:183], v[60:63]
    s_waitcnt lgkmcnt(0) vmcnt(18)
    v_mfma_f32_16x16x32_bf16 v[32:35], a[160:163], v[152:155], v[32:35]
    ds_read_b128 v[168:171], v21 offset:32768
    s_bfe_u32 s72, s97, 262144
    v_mfma_f32_16x16x32_bf16 v[48:51], a[176:179], v[152:155], v[48:51]
    ds_read_b128 v[172:175], v21 offset:34816
    s_add_u32 m0, s37, 0
    v_mfma_f32_16x16x32_bf16 v[36:39], a[160:163], v[156:159], v[36:39]
    ds_read_b128 v[176:179], v21 offset:36864
    v_mfma_f32_16x16x32_bf16 v[52:55], a[176:179], v[156:159], v[52:55]
    ds_read_b128 v[180:183], v21 offset:38912
    s_lshl_b32 s72, s72, 7
    v_mfma_f32_16x16x32_bf16 v[40:43], a[160:163], v[160:163], v[40:43]
    buffer_load_dwordx4 v16, s[16:19], s72 offen offset:0  lds
    v_mfma_f32_16x16x32_bf16 v[56:59], a[176:179], v[160:163], v[56:59]
    v_mfma_f32_16x16x32_bf16 v[44:47], a[160:163], v[164:167], v[44:47]
    buffer_load_dwordx4 v17, s[16:19], s72 offen offset:1024  lds
    v_mfma_f32_16x16x32_bf16 v[60:63], a[176:179], v[164:167], v[60:63]
    s_waitcnt lgkmcnt(0) vmcnt(18)
    v_mfma_f32_16x16x32_bf16 v[32:35], a[164:167], v[168:171], v[32:35]
    ds_read_b128 v[152:155], v22 offset:32768
    buffer_load_dwordx4 v18, s[16:19], s72 offen offset:2048  lds
    v_mfma_f32_16x16x32_bf16 v[48:51], a[180:183], v[168:171], v[48:51]
    ds_read_b128 v[156:159], v22 offset:34816
    v_mfma_f32_16x16x32_bf16 v[36:39], a[164:167], v[172:175], v[36:39]
    ds_read_b128 v[160:163], v22 offset:36864
    v_mfma_f32_16x16x32_bf16 v[52:55], a[180:183], v[172:175], v[52:55]
    ds_read_b128 v[164:167], v22 offset:38912
    v_mfma_f32_16x16x32_bf16 v[40:43], a[164:167], v[176:179], v[40:43]
    buffer_load_dwordx4 v19, s[16:19], s72 offen offset:3072  lds
    v_mfma_f32_16x16x32_bf16 v[56:59], a[180:183], v[176:179], v[56:59]
    v_mfma_f32_16x16x32_bf16 v[44:47], a[164:167], v[180:183], v[44:47]
    v_mfma_f32_16x16x32_bf16 v[60:63], a[180:183], v[180:183], v[60:63]
    s_waitcnt lgkmcnt(0) vmcnt(12)
    s_barrier
    v_mfma_f32_16x16x32_bf16 v[32:35], a[168:171], v[152:155], v[32:35]
    ds_read_b128 v[168:171], v23 offset:32768
    s_bfe_u32 s72, s97, 262148
    v_mfma_f32_16x16x32_bf16 v[48:51], a[184:187], v[152:155], v[48:51]
    ds_read_b128 v[172:175], v23 offset:34816
    s_add_u32 m0, s37, 16384
    v_mfma_f32_16x16x32_bf16 v[36:39], a[168:171], v[156:159], v[36:39]
    ds_read_b128 v[176:179], v23 offset:36864
    v_mfma_f32_16x16x32_bf16 v[52:55], a[184:187], v[156:159], v[52:55]
    ds_read_b128 v[180:183], v23 offset:38912
    s_lshl_b32 s72, s72, 7
    v_mfma_f32_16x16x32_bf16 v[40:43], a[168:171], v[160:163], v[40:43]
    ds_read_b64 v[184:185], v130 offset:0
    buffer_load_dwordx4 v16, s[16:19], s72 offen offset:0  lds
    v_mfma_f32_16x16x32_bf16 v[56:59], a[184:187], v[160:163], v[56:59]
    ds_read_b64 v[186:187], v130 offset:1024
    v_mfma_f32_16x16x32_bf16 v[44:47], a[168:171], v[164:167], v[44:47]
    ds_read_b64 v[188:189], v130 offset:2048
    buffer_load_dwordx4 v17, s[16:19], s72 offen offset:1024  lds
    v_mfma_f32_16x16x32_bf16 v[60:63], a[184:187], v[164:167], v[60:63]
    ds_read_b64 v[190:191], v130 offset:3072
    s_waitcnt lgkmcnt(4)
    v_mfma_f32_16x16x32_bf16 v[32:35], a[172:175], v[168:171], v[32:35]
    ds_read_b128 v[152:155], v20 offset:49152
    buffer_load_dwordx4 v18, s[16:19], s72 offen offset:2048  lds
    s_waitcnt lgkmcnt(1)
    v_mfma_f32_16x16x32_bf16 v[48:51], a[188:191], v[168:171], v[48:51]
    ds_read_b128 v[156:159], v20 offset:51200
    v_swap_b32 v185, v186
    v_mfma_f32_16x16x32_bf16 v[36:39], a[172:175], v[172:175], v[36:39]
    ds_read_b128 v[160:163], v20 offset:53248
    v_mfma_f32_16x16x32_bf16 v[52:55], a[188:191], v[172:175], v[52:55]
    ds_read_b128 v[164:167], v20 offset:55296
    v_swap_b32 v189, v190
    v_mfma_f32_16x16x32_bf16 v[40:43], a[172:175], v[176:179], v[40:43]
    ds_read_b64 v[192:193], v132 offset:0
    buffer_load_dwordx4 v19, s[16:19], s72 offen offset:3072  lds
    v_swap_b32 v186, v188
    v_mfma_f32_16x16x32_bf16 v[56:59], a[188:191], v[176:179], v[56:59]
    ds_read_b64 v[194:195], v131 offset:2048
    v_mfma_f32_16x16x32_bf16 v[44:47], a[172:175], v[180:183], v[44:47]
    ds_read_b64 v[196:197], v131 offset:1024
    v_swap_b32 v187, v189
    v_xor_b32 v20, 0x10000, v20
    v_mfma_f32_16x16x32_bf16 v[60:63], a[188:191], v[180:183], v[60:63]
    ds_read_b64 v[198:199], v131 offset:0
    v_mfma_f32_16x16x32_bf16 v[112:115], v[184:187], a[224:227], 0
    s_bfe_u32 s72, s97, 262152
    v_mfma_f32_16x16x32_bf16 v[116:119], v[184:187], a[228:231], 0
    s_add_u32 m0, s37, 32768
    s_waitcnt lgkmcnt(0)
    v_swap_b32 v193, v194
    v_mfma_f32_16x16x32_bf16 v[120:123], v[184:187], a[232:235], 0
    v_swap_b32 v197, v198
    v_swap_b32 v194, v196
    v_mfma_f32_16x16x32_bf16 v[124:127], v[184:187], a[236:239], 0
    s_lshl_b32 s72, s72, 7
    v_swap_b32 v195, v197
    v_mfma_f32_16x16x32_bf16 v[144:147], v[188:191], a[224:227], 0
    buffer_load_dwordx4 v16, s[16:19], s72 offen offset:0  lds
    v_mfma_f32_16x16x32_bf16 v[148:151], v[188:191], a[228:231], 0
    v_mfma_f32_16x16x32_bf16 v[248:251], v[188:191], a[232:235], 0
    buffer_load_dwordx4 v17, s[16:19], s72 offen offset:1024  lds
    v_mfma_f32_16x16x32_bf16 v[252:255], v[188:191], a[236:239], 0
    buffer_load_dwordx4 v18, s[16:19], s72 offen offset:2048  lds
    v_mfma_f32_16x16x32_bf16 v[112:115], v[192:195], a[224:227], v[112:115]
    v_mfma_f32_16x16x32_bf16 v[116:119], v[192:195], a[228:231], v[116:119]
    buffer_load_dwordx4 v19, s[16:19], s72 offen offset:3072  lds
    v_mfma_f32_16x16x32_bf16 v[120:123], v[192:195], a[240:243], v[120:123]
    s_bfe_u32 s72, s97, 262156
    v_mfma_f32_16x16x32_bf16 v[124:127], v[192:195], a[244:247], v[124:127]
    v_mfma_f32_16x16x32_bf16 v[144:147], v[196:199], a[224:227], v[144:147]
    s_add_u32 m0, s37, 49152
    v_mfma_f32_16x16x32_bf16 v[148:151], v[196:199], a[228:231], v[148:151]
    s_lshl_b32 s72, s72, 7
    s_nop 0
    v_mfma_f32_16x16x32_bf16 v[248:251], v[196:199], a[240:243], v[248:251]
    v_mfma_f32_16x16x32_bf16 v[252:255], v[196:199], a[244:247], v[252:255]
    v_pk_mul_f32 v[134:135], v[112:113], v[96:97]
    v_pk_mul_f32 v[136:137], v[116:117], v[96:97]
    v_pk_fma_f32 v[134:135], v[116:117], v[104:105], v[134:135]
    v_pk_fma_f32 v[136:137], v[112:113], v[104:105], v[136:137] neg_lo:[1,0,0] neg_hi:[1,0,0]
    v_pk_mul_f32 v[138:139], v[114:115], v[98:99]
    v_pk_mul_f32 v[140:141], v[118:119], v[98:99]
    v_pk_fma_f32 v[138:139], v[118:119], v[106:107], v[138:139]
    v_pk_fma_f32 v[140:141], v[114:115], v[106:107], v[140:141] neg_lo:[1,0,0] neg_hi:[1,0,0]
    v_cvt_pk_bf16_f32 v184, v134, v136
    v_cvt_pk_bf16_f32 v185, v135, v137
    v_cvt_pk_bf16_f32 v186, v138, v140
    v_cvt_pk_bf16_f32 v187, v139, v141
    v_pk_mul_f32 v[134:135], v[120:121], v[100:101]
    v_pk_mul_f32 v[136:137], v[124:125], v[100:101]
    v_pk_fma_f32 v[134:135], v[124:125], v[108:109], v[134:135]
    v_pk_fma_f32 v[136:137], v[120:121], v[108:109], v[136:137] neg_lo:[1,0,0] neg_hi:[1,0,0]
    v_pk_mul_f32 v[138:139], v[122:123], v[102:103]
    v_pk_mul_f32 v[140:141], v[126:127], v[102:103]
    v_pk_fma_f32 v[138:139], v[126:127], v[110:111], v[138:139]
    v_pk_fma_f32 v[140:141], v[122:123], v[110:111], v[140:141] neg_lo:[1,0,0] neg_hi:[1,0,0]
    v_cvt_pk_bf16_f32 v188, v134, v136
    v_cvt_pk_bf16_f32 v189, v135, v137
    v_cvt_pk_bf16_f32 v190, v138, v140
    v_cvt_pk_bf16_f32 v191, v139, v141
    v_pk_mul_f32 v[134:135], v[144:145], v[96:97]
    v_pk_mul_f32 v[136:137], v[148:149], v[96:97]
    v_pk_fma_f32 v[134:135], v[148:149], v[104:105], v[134:135]
    v_pk_fma_f32 v[136:137], v[144:145], v[104:105], v[136:137] neg_lo:[1,0,0] neg_hi:[1,0,0]
    v_pk_mul_f32 v[138:139], v[146:147], v[98:99]
    v_pk_mul_f32 v[140:141], v[150:151], v[98:99]
    v_pk_fma_f32 v[138:139], v[150:151], v[106:107], v[138:139]
    v_pk_fma_f32 v[140:141], v[146:147], v[106:107], v[140:141] neg_lo:[1,0,0] neg_hi:[1,0,0]
    v_cvt_pk_bf16_f32 v192, v134, v136
    v_cvt_pk_bf16_f32 v193, v135, v137
    v_cvt_pk_bf16_f32 v194, v138, v140
    v_cvt_pk_bf16_f32 v195, v139, v141
    v_pk_mul_f32 v[134:135], v[248:249], v[100:101]
    v_pk_mul_f32 v[136:137], v[252:253], v[100:101]
    v_pk_fma_f32 v[134:135], v[252:253], v[108:109], v[134:135]
    v_pk_fma_f32 v[136:137], v[248:249], v[108:109], v[136:137] neg_lo:[1,0,0] neg_hi:[1,0,0]
    v_pk_mul_f32 v[138:139], v[250:251], v[102:103]
    v_pk_mul_f32 v[140:141], v[254:255], v[102:103]
    v_pk_fma_f32 v[138:139], v[254:255], v[110:111], v[138:139]
    v_pk_fma_f32 v[140:141], v[250:251], v[110:111], v[140:141] neg_lo:[1,0,0] neg_hi:[1,0,0]
    v_cvt_pk_bf16_f32 v196, v134, v136
    v_cvt_pk_bf16_f32 v197, v135, v137
    v_cvt_pk_bf16_f32 v198, v138, v140
    v_cvt_pk_bf16_f32 v199, v139, v141
    v_mfma_f32_16x16x32_bf16 v[112:115], a[224:227], v[184:187], 0
    buffer_load_dwordx4 v16, s[16:19], s72 offen offset:0  lds
    v_mfma_f32_16x16x32_bf16 v[116:119], a[228:231], v[184:187], 0
    buffer_load_dwordx4 v17, s[16:19], s72 offen offset:1024  lds
    v_mfma_f32_16x16x32_bf16 v[120:123], a[224:227], v[188:191], 0
    v_mfma_f32_16x16x32_bf16 v[124:127], a[228:231], v[188:191], 0
    buffer_load_dwordx4 v18, s[16:19], s72 offen offset:2048  lds
    v_mfma_f32_16x16x32_bf16 v[144:147], a[224:227], v[192:195], 0
    buffer_load_dwordx4 v19, s[16:19], s72 offen offset:3072  lds
    v_mfma_f32_16x16x32_bf16 v[148:151], a[228:231], v[192:195], 0
    v_mfma_f32_16x16x32_bf16 v[248:251], a[224:227], v[196:199], 0
    v_mfma_f32_16x16x32_bf16 v[252:255], a[228:231], v[196:199], 0
    v_pk_fma_f32 v[216:217], v[112:113], v[128:129], v[216:217] op_sel_hi:[1,0,1]
    v_pk_fma_f32 v[218:219], v[114:115], v[128:129], v[218:219] op_sel_hi:[1,0,1]
    v_pk_fma_f32 v[220:221], v[116:117], v[128:129], v[220:221] op_sel_hi:[1,0,1] neg_lo:[1,0,0] neg_hi:[1,0,0]
    v_pk_fma_f32 v[222:223], v[118:119], v[128:129], v[222:223] op_sel_hi:[1,0,1] neg_lo:[1,0,0] neg_hi:[1,0,0]
    v_pk_fma_f32 v[224:225], v[120:121], v[128:129], v[224:225] op_sel_hi:[1,0,1]
    v_pk_fma_f32 v[226:227], v[122:123], v[128:129], v[226:227] op_sel_hi:[1,0,1]
    v_pk_fma_f32 v[228:229], v[124:125], v[128:129], v[228:229] op_sel_hi:[1,0,1] neg_lo:[1,0,0] neg_hi:[1,0,0]
    v_pk_fma_f32 v[230:231], v[126:127], v[128:129], v[230:231] op_sel_hi:[1,0,1] neg_lo:[1,0,0] neg_hi:[1,0,0]
    v_pk_fma_f32 v[232:233], v[144:145], v[128:129], v[232:233] op_sel:[0,1,0]
    v_pk_fma_f32 v[234:235], v[146:147], v[128:129], v[234:235] op_sel:[0,1,0]
    v_pk_fma_f32 v[236:237], v[148:149], v[128:129], v[236:237] op_sel:[0,1,0] neg_lo:[1,0,0] neg_hi:[1,0,0]
    v_pk_fma_f32 v[238:239], v[150:151], v[128:129], v[238:239] op_sel:[0,1,0] neg_lo:[1,0,0] neg_hi:[1,0,0]
    v_pk_fma_f32 v[240:241], v[248:249], v[128:129], v[240:241] op_sel:[0,1,0]
    v_pk_fma_f32 v[242:243], v[250:251], v[128:129], v[242:243] op_sel:[0,1,0]
    v_pk_fma_f32 v[244:245], v[252:253], v[128:129], v[244:245] op_sel:[0,1,0] neg_lo:[1,0,0] neg_hi:[1,0,0]
    v_pk_fma_f32 v[246:247], v[254:255], v[128:129], v[246:247] op_sel:[0,1,0] neg_lo:[1,0,0] neg_hi:[1,0,0]
    s_waitcnt vmcnt(22)
    v_mfma_f32_16x16x32_bf16 v[32:35], a[192:195], v[152:155], v[32:35]
    ds_read_b128 v[168:171], v21 offset:49152
    s_lshl_b32 s70, s32, 10
    v_cvt_pk_bf16_f32 v184, v216, v220
    v_mfma_f32_16x16x32_bf16 v[48:51], a[208:211], v[152:155], v[48:51]
    ds_read_b128 v[172:175], v21 offset:51200
    v_cvt_pk_bf16_f32 v185, v224, v228
    v_mfma_f32_16x16x32_bf16 v[36:39], a[192:195], v[156:159], v[36:39]
    ds_read_b128 v[176:179], v21 offset:53248
    v_cvt_pk_bf16_f32 v186, v232, v236
    v_mfma_f32_16x16x32_bf16 v[52:55], a[208:211], v[156:159], v[52:55]
    ds_read_b128 v[180:183], v21 offset:55296
    v_cvt_pk_bf16_f32 v187, v240, v244
    v_mfma_f32_16x16x32_bf16 v[40:43], a[192:195], v[160:163], v[40:43]
    s_add_u32 s70, s70, 22413312
    v_cvt_pk_bf16_f32 v188, v217, v221
    v_mfma_f32_16x16x32_bf16 v[56:59], a[208:211], v[160:163], v[56:59]
    v_cvt_pk_bf16_f32 v189, v225, v229
    v_mfma_f32_16x16x32_bf16 v[44:47], a[192:195], v[164:167], v[44:47]
    v_cvt_pk_bf16_f32 v190, v233, v237
    v_xor_b32 v21, 0x10000, v21
    v_mfma_f32_16x16x32_bf16 v[60:63], a[208:211], v[164:167], v[60:63]
    v_cvt_pk_bf16_f32 v191, v241, v245
    s_waitcnt lgkmcnt(0) vmcnt(20)
    v_mfma_f32_16x16x32_bf16 v[32:35], a[196:199], v[168:171], v[32:35]
    ds_read_b128 v[152:155], v22 offset:49152
    buffer_store_dwordx4 v[184:187], v4, s[24:27], s75 offen sc1
    v_cvt_pk_bf16_f32 v192, v218, v222
    v_mfma_f32_16x16x32_bf16 v[48:51], a[212:215], v[168:171], v[48:51]
    ds_read_b128 v[156:159], v22 offset:51200
    v_cvt_pk_bf16_f32 v193, v226, v230
    v_mfma_f32_16x16x32_bf16 v[36:39], a[196:199], v[172:175], v[36:39]
    ds_read_b128 v[160:163], v22 offset:53248
    v_cvt_pk_bf16_f32 v194, v234, v238
    v_mfma_f32_16x16x32_bf16 v[52:55], a[212:215], v[172:175], v[52:55]
    ds_read_b128 v[164:167], v22 offset:55296
    v_cvt_pk_bf16_f32 v195, v242, v246
    v_mfma_f32_16x16x32_bf16 v[40:43], a[196:199], v[176:179], v[40:43]
    s_add_u32 s75, s75, 16384
    v_cvt_pk_bf16_f32 v196, v219, v223
    v_mfma_f32_16x16x32_bf16 v[56:59], a[212:215], v[176:179], v[56:59]
    v_cvt_pk_bf16_f32 v197, v227, v231
    v_mfma_f32_16x16x32_bf16 v[44:47], a[196:199], v[180:183], v[44:47]
    v_cvt_pk_bf16_f32 v198, v235, v239
    v_xor_b32 v22, 0x10000, v22
    v_mfma_f32_16x16x32_bf16 v[60:63], a[212:215], v[180:183], v[60:63]
    v_cvt_pk_bf16_f32 v199, v243, v247
    s_waitcnt lgkmcnt(0) vmcnt(19)
    v_mfma_f32_16x16x32_bf16 v[32:35], a[200:203], v[152:155], v[32:35]
    ds_read_b128 v[168:171], v23 offset:49152
    buffer_store_dwordx4 v[188:191], v4, s[24:27], s75 offen sc1
    v_mfma_f32_16x16x32_bf16 v[48:51], a[216:219], v[152:155], v[48:51]
    ds_read_b128 v[172:175], v23 offset:51200
    v_mfma_f32_16x16x32_bf16 v[36:39], a[200:203], v[156:159], v[36:39]
    ds_read_b128 v[176:179], v23 offset:53248
    v_mfma_f32_16x16x32_bf16 v[52:55], a[216:219], v[156:159], v[52:55]
    ds_read_b128 v[180:183], v23 offset:55296
    v_mfma_f32_16x16x32_bf16 v[40:43], a[200:203], v[160:163], v[40:43]
    s_add_u32 s75, s75, 16384
    v_mfma_f32_16x16x32_bf16 v[56:59], a[216:219], v[160:163], v[56:59]
    v_mfma_f32_16x16x32_bf16 v[44:47], a[200:203], v[164:167], v[44:47]
    v_xor_b32 v23, 0x10000, v23
    v_mfma_f32_16x16x32_bf16 v[60:63], a[216:219], v[164:167], v[60:63]
    s_waitcnt lgkmcnt(0) vmcnt(14)
    s_barrier
    v_mfma_f32_16x16x32_bf16 v[32:35], a[204:207], v[168:171], v[32:35]
    ds_read_b128 v[152:155], v20 offset:0
    v_mfma_f32_16x16x32_bf16 v[48:51], a[220:223], v[168:171], v[48:51]
    ds_read_b128 v[156:159], v20 offset:2048
    v_mfma_f32_16x16x32_bf16 v[36:39], a[204:207], v[172:175], v[36:39]
    ds_read_b128 v[160:163], v20 offset:4096
    v_mfma_f32_16x16x32_bf16 v[52:55], a[220:223], v[172:175], v[52:55]
    ds_read_b128 v[164:167], v20 offset:6144
    v_mfma_f32_16x16x32_bf16 v[40:43], a[204:207], v[176:179], v[40:43]
    v_mfma_f32_16x16x32_bf16 v[56:59], a[220:223], v[176:179], v[56:59]
    v_mfma_f32_16x16x32_bf16 v[44:47], a[204:207], v[180:183], v[44:47]
    v_mfma_f32_16x16x32_bf16 v[60:63], a[220:223], v[180:183], v[60:63]
    s_waitcnt lgkmcnt(0)
    v_mfma_f32_16x16x32_bf16 v[216:219], v[64:67], v[152:155], 0
    ds_read_b128 v[168:171], v21 offset:0
    buffer_store_dwordx4 v[192:195], v4, s[24:27], s75 offen sc1
    v_mfma_f32_16x16x32_bf16 v[232:235], v[80:83], v[152:155], 0
    ds_read_b128 v[172:175], v21 offset:2048
    v_mfma_f32_16x16x32_bf16 v[220:223], v[64:67], v[156:159], 0
    ds_read_b128 v[176:179], v21 offset:4096
    v_cvt_pk_bf16_f32 v200, v32, v36
    v_cvt_pk_bf16_f32 v201, v40, v44
    v_mfma_f32_16x16x32_bf16 v[236:239], v[80:83], v[156:159], 0
    ds_read_b128 v[180:183], v21 offset:6144
    v_cvt_pk_bf16_f32 v202, v48, v52
    v_mfma_f32_16x16x32_bf16 v[224:227], v[64:67], v[160:163], 0
    s_add_u32 s75, s75, 16384
    v_cvt_pk_bf16_f32 v203, v56, v60
    v_mfma_f32_16x16x32_bf16 v[240:243], v[80:83], v[160:163], 0
    v_cvt_pk_bf16_f32 v204, v33, v37
    v_cvt_pk_bf16_f32 v205, v41, v45
    v_mfma_f32_16x16x32_bf16 v[228:231], v[64:67], v[164:167], 0
    v_cvt_pk_bf16_f32 v206, v49, v53
    v_mfma_f32_16x16x32_bf16 v[244:247], v[80:83], v[164:167], 0
    v_cvt_pk_bf16_f32 v207, v57, v61
    s_waitcnt lgkmcnt(0)
    v_mfma_f32_16x16x32_bf16 v[216:219], v[68:71], v[168:171], v[216:219]
    ds_read_b128 v[152:155], v22 offset:0
    buffer_store_dwordx4 v[196:199], v4, s[24:27], s75 offen sc1
    v_cvt_pk_bf16_f32 v208, v34, v38
    v_mfma_f32_16x16x32_bf16 v[232:235], v[84:87], v[168:171], v[232:235]
    ds_read_b128 v[156:159], v22 offset:2048
    v_cvt_pk_bf16_f32 v209, v42, v46
    v_mfma_f32_16x16x32_bf16 v[220:223], v[68:71], v[172:175], v[220:223]
    ds_read_b128 v[160:163], v22 offset:4096
    buffer_store_dwordx4 v[200:203], v3, s[24:27], s52 offen offset:0 sc1
    v_cvt_pk_bf16_f32 v210, v50, v54
    v_mfma_f32_16x16x32_bf16 v[236:239], v[84:87], v[172:175], v[236:239]
    ds_read_b128 v[164:167], v22 offset:6144
    v_cvt_pk_bf16_f32 v211, v58, v62
    v_mfma_f32_16x16x32_bf16 v[224:227], v[68:71], v[176:179], v[224:227]
    v_cvt_pk_bf16_f32 v212, v35, v39
    v_mfma_f32_16x16x32_bf16 v[240:243], v[84:87], v[176:179], v[240:243]
    buffer_store_dwordx4 v[204:207], v3, s[24:27], s52 offen offset:1024 sc1
    v_cvt_pk_bf16_f32 v213, v43, v47
    v_mfma_f32_16x16x32_bf16 v[228:231], v[68:71], v[180:183], v[228:231]
    v_cvt_pk_bf16_f32 v214, v51, v55
    v_mfma_f32_16x16x32_bf16 v[244:247], v[84:87], v[180:183], v[244:247]
    v_cvt_pk_bf16_f32 v215, v59, v63
    s_waitcnt lgkmcnt(0)
    v_mfma_f32_16x16x32_bf16 v[216:219], v[72:75], v[152:155], v[216:219]
    ds_read_b128 v[168:171], v23 offset:0
    buffer_store_dwordx4 v[208:211], v3, s[24:27], s52 offen offset:2048 sc1
    v_mfma_f32_16x16x32_bf16 v[232:235], v[88:91], v[152:155], v[232:235]
    ds_read_b128 v[172:175], v23 offset:2048
    v_mfma_f32_16x16x32_bf16 v[220:223], v[72:75], v[156:159], v[220:223]
    ds_read_b128 v[176:179], v23 offset:4096
    v_mfma_f32_16x16x32_bf16 v[236:239], v[88:91], v[156:159], v[236:239]
    ds_read_b128 v[180:183], v23 offset:6144
    v_mfma_f32_16x16x32_bf16 v[224:227], v[72:75], v[160:163], v[224:227]
    buffer_store_dwordx4 v[212:215], v3, s[24:27], s52 offen offset:3072 sc1
    v_mfma_f32_16x16x32_bf16 v[240:243], v[88:91], v[160:163], v[240:243]
    v_mfma_f32_16x16x32_bf16 v[228:231], v[72:75], v[164:167], v[228:231]
    v_mfma_f32_16x16x32_bf16 v[244:247], v[88:91], v[164:167], v[244:247]
    s_waitcnt lgkmcnt(0) vmcnt(8)
    s_barrier
    v_mfma_f32_16x16x32_bf16 v[216:219], v[76:79], v[168:171], v[216:219]
    ds_read_b128 v[152:155], v20 offset:16384
    v_mfma_f32_16x16x32_bf16 v[232:235], v[92:95], v[168:171], v[232:235]
    ds_read_b128 v[156:159], v20 offset:18432
    v_mfma_f32_16x16x32_bf16 v[220:223], v[76:79], v[172:175], v[220:223]
    ds_read_b128 v[160:163], v20 offset:20480
    v_mfma_f32_16x16x32_bf16 v[236:239], v[92:95], v[172:175], v[236:239]
    ds_read_b128 v[164:167], v20 offset:22528
    v_mfma_f32_16x16x32_bf16 v[224:227], v[76:79], v[176:179], v[224:227]
    v_mfma_f32_16x16x32_bf16 v[240:243], v[92:95], v[176:179], v[240:243]
    v_mfma_f32_16x16x32_bf16 v[228:231], v[76:79], v[180:183], v[228:231]
    v_mfma_f32_16x16x32_bf16 v[244:247], v[92:95], v[180:183], v[244:247]
    s_waitcnt lgkmcnt(0)
    v_mfma_f32_16x16x32_bf16 v[216:219], a[0:3], v[152:155], v[216:219]
    ds_read_b128 v[168:171], v21 offset:16384
    v_mfma_f32_16x16x32_bf16 v[232:235], a[16:19], v[152:155], v[232:235]
    ds_read_b128 v[172:175], v21 offset:18432
    v_mfma_f32_16x16x32_bf16 v[220:223], a[0:3], v[156:159], v[220:223]
    ds_read_b128 v[176:179], v21 offset:20480
    v_mfma_f32_16x16x32_bf16 v[236:239], a[16:19], v[156:159], v[236:239]
    ds_read_b128 v[180:183], v21 offset:22528
    v_mfma_f32_16x16x32_bf16 v[224:227], a[0:3], v[160:163], v[224:227]
    v_mfma_f32_16x16x32_bf16 v[240:243], a[16:19], v[160:163], v[240:243]
    v_mfma_f32_16x16x32_bf16 v[228:231], a[0:3], v[164:167], v[228:231]
    v_mfma_f32_16x16x32_bf16 v[244:247], a[16:19], v[164:167], v[244:247]
    s_waitcnt lgkmcnt(0)
    v_mfma_f32_16x16x32_bf16 v[216:219], a[4:7], v[168:171], v[216:219]
    ds_read_b128 v[152:155], v22 offset:16384
    v_mfma_f32_16x16x32_bf16 v[232:235], a[20:23], v[168:171], v[232:235]
    ds_read_b128 v[156:159], v22 offset:18432
    v_mfma_f32_16x16x32_bf16 v[220:223], a[4:7], v[172:175], v[220:223]
    ds_read_b128 v[160:163], v22 offset:20480
    v_mfma_f32_16x16x32_bf16 v[236:239], a[20:23], v[172:175], v[236:239]
    ds_read_b128 v[164:167], v22 offset:22528
    v_mfma_f32_16x16x32_bf16 v[224:227], a[4:7], v[176:179], v[224:227]
    v_mfma_f32_16x16x32_bf16 v[240:243], a[20:23], v[176:179], v[240:243]
    v_mfma_f32_16x16x32_bf16 v[228:231], a[4:7], v[180:183], v[228:231]
    v_mfma_f32_16x16x32_bf16 v[244:247], a[20:23], v[180:183], v[244:247]
    s_waitcnt lgkmcnt(0) vmcnt(4)
    s_barrier
    v_mfma_f32_16x16x32_bf16 v[216:219], a[8:11], v[152:155], v[216:219]
    ds_read_b128 v[168:171], v23 offset:16384
    v_mov_b32 v28, s35
    v_mfma_f32_16x16x32_bf16 v[232:235], a[24:27], v[152:155], v[232:235]
    ds_read_b128 v[172:175], v23 offset:18432
    v_mfma_f32_16x16x32_bf16 v[220:223], a[8:11], v[156:159], v[220:223]
    ds_read_b128 v[176:179], v23 offset:20480
    v_mfma_f32_16x16x32_bf16 v[236:239], a[24:27], v[156:159], v[236:239]
    ds_read_b128 v[180:183], v23 offset:22528
    v_mfma_f32_16x16x32_bf16 v[224:227], a[8:11], v[160:163], v[224:227]
    buffer_store_dword v28, v30, s[24:27], s57 offen sc1
    v_mfma_f32_16x16x32_bf16 v[240:243], a[24:27], v[160:163], v[240:243]
    v_mfma_f32_16x16x32_bf16 v[228:231], a[8:11], v[164:167], v[228:231]
    v_mfma_f32_16x16x32_bf16 v[244:247], a[24:27], v[164:167], v[244:247]
    s_waitcnt lgkmcnt(0)
    v_mfma_f32_16x16x32_bf16 v[216:219], a[12:15], v[168:171], v[216:219]
    ds_read_b128 v[152:155], v20 offset:32768
    v_mfma_f32_16x16x32_bf16 v[232:235], a[28:31], v[168:171], v[232:235]
    ds_read_b128 v[156:159], v20 offset:34816
    v_mfma_f32_16x16x32_bf16 v[220:223], a[12:15], v[172:175], v[220:223]
    ds_read_b128 v[160:163], v20 offset:36864
    v_mfma_f32_16x16x32_bf16 v[236:239], a[28:31], v[172:175], v[236:239]
    ds_read_b128 v[164:167], v20 offset:38912
    v_mfma_f32_16x16x32_bf16 v[224:227], a[12:15], v[176:179], v[224:227]
    v_mfma_f32_16x16x32_bf16 v[240:243], a[28:31], v[176:179], v[240:243]
    v_mfma_f32_16x16x32_bf16 v[228:231], a[12:15], v[180:183], v[228:231]
    v_mfma_f32_16x16x32_bf16 v[244:247], a[28:31], v[180:183], v[244:247]
    s_waitcnt lgkmcnt(0)
    v_mfma_f32_16x16x32_bf16 v[216:219], a[32:35], v[152:155], v[216:219]
    ds_read_b128 v[168:171], v21 offset:32768
    buffer_load_dwordx2 v[128:129], v7, s[24:27], s55 offen offset:0 sc1
    v_mfma_f32_16x16x32_bf16 v[232:235], a[48:51], v[152:155], v[232:235]
    ds_read_b128 v[172:175], v21 offset:34816
    v_mfma_f32_16x16x32_bf16 v[220:223], a[32:35], v[156:159], v[220:223]
    ds_read_b128 v[176:179], v21 offset:36864
    v_mfma_f32_16x16x32_bf16 v[236:239], a[48:51], v[156:159], v[236:239]
    ds_read_b128 v[180:183], v21 offset:38912
    v_mfma_f32_16x16x32_bf16 v[224:227], a[32:35], v[160:163], v[224:227]
    buffer_load_dwordx2 v[130:131], v7, s[24:27], s55 offen offset:64 sc1
    v_mfma_f32_16x16x32_bf16 v[240:243], a[48:51], v[160:163], v[240:243]
    v_mfma_f32_16x16x32_bf16 v[228:231], a[32:35], v[164:167], v[228:231]
    v_mfma_f32_16x16x32_bf16 v[244:247], a[48:51], v[164:167], v[244:247]
    s_waitcnt lgkmcnt(0)
    v_mfma_f32_16x16x32_bf16 v[216:219], a[36:39], v[168:171], v[216:219]
    ds_read_b128 v[152:155], v22 offset:32768
    buffer_load_dwordx2 v[132:133], v7, s[24:27], s55 offen offset:128 sc1
    v_mfma_f32_16x16x32_bf16 v[232:235], a[52:55], v[168:171], v[232:235]
    ds_read_b128 v[156:159], v22 offset:34816
    v_mfma_f32_16x16x32_bf16 v[220:223], a[36:39], v[172:175], v[220:223]
    ds_read_b128 v[160:163], v22 offset:36864
    v_mfma_f32_16x16x32_bf16 v[236:239], a[52:55], v[172:175], v[236:239]
    ds_read_b128 v[164:167], v22 offset:38912
    v_mfma_f32_16x16x32_bf16 v[224:227], a[36:39], v[176:179], v[224:227]
    buffer_load_dwordx2 v[134:135], v7, s[24:27], s55 offen offset:192 sc1
    v_mfma_f32_16x16x32_bf16 v[240:243], a[52:55], v[176:179], v[240:243]
    v_mfma_f32_16x16x32_bf16 v[228:231], a[36:39], v[180:183], v[228:231]
    v_mfma_f32_16x16x32_bf16 v[244:247], a[52:55], v[180:183], v[244:247]
    s_waitcnt lgkmcnt(0) vmcnt(5)
    s_barrier
    v_mfma_f32_16x16x32_bf16 v[216:219], a[40:43], v[152:155], v[216:219]
    ds_read_b128 v[168:171], v23 offset:32768
    v_mov_b32 v28, s35
    v_mfma_f32_16x16x32_bf16 v[232:235], a[56:59], v[152:155], v[232:235]
    ds_read_b128 v[172:175], v23 offset:34816
    buffer_store_dword v28, v30, s[24:27], s58 offen sc1
    v_mfma_f32_16x16x32_bf16 v[220:223], a[40:43], v[156:159], v[220:223]
    ds_read_b128 v[176:179], v23 offset:36864
    s_bfe_u32 s72, s97, 262160
    v_mfma_f32_16x16x32_bf16 v[236:239], a[56:59], v[156:159], v[236:239]
    ds_read_b128 v[180:183], v23 offset:38912
    s_add_u32 m0, s37, 65536
    v_mfma_f32_16x16x32_bf16 v[224:227], a[40:43], v[160:163], v[224:227]
    s_lshl_b32 s72, s72, 7
    v_mfma_f32_16x16x32_bf16 v[240:243], a[56:59], v[160:163], v[240:243]
    buffer_load_dwordx4 v16, s[16:19], s72 offen offset:0  lds
    v_mfma_f32_16x16x32_bf16 v[228:231], a[40:43], v[164:167], v[228:231]
    buffer_load_dwordx4 v17, s[16:19], s72 offen offset:1024  lds
    v_mfma_f32_16x16x32_bf16 v[244:247], a[56:59], v[164:167], v[244:247]
    s_waitcnt lgkmcnt(0)
    v_mfma_f32_16x16x32_bf16 v[216:219], a[44:47], v[168:171], v[216:219]
    ds_read_b128 v[152:155], v20 offset:49152
    buffer_load_dwordx4 v18, s[16:19], s72 offen offset:2048  lds
    v_mfma_f32_16x16x32_bf16 v[232:235], a[60:63], v[168:171], v[232:235]
    ds_read_b128 v[156:159], v20 offset:51200
    v_mfma_f32_16x16x32_bf16 v[220:223], a[44:47], v[172:175], v[220:223]
    ds_read_b128 v[160:163], v20 offset:53248
    v_mfma_f32_16x16x32_bf16 v[236:239], a[60:63], v[172:175], v[236:239]
    ds_read_b128 v[164:167], v20 offset:55296
    v_mfma_f32_16x16x32_bf16 v[224:227], a[44:47], v[176:179], v[224:227]
    buffer_load_dwordx4 v19, s[16:19], s72 offen offset:3072  lds
    v_mfma_f32_16x16x32_bf16 v[240:243], a[60:63], v[176:179], v[240:243]
    v_mfma_f32_16x16x32_bf16 v[228:231], a[44:47], v[180:183], v[228:231]
    v_xor_b32 v20, 0x10000, v20
    v_mfma_f32_16x16x32_bf16 v[244:247], a[60:63], v[180:183], v[244:247]
    s_waitcnt lgkmcnt(0)
    v_mfma_f32_16x16x32_bf16 v[216:219], a[64:67], v[152:155], v[216:219]
    ds_read_b128 v[168:171], v21 offset:49152
    s_bfe_u32 s72, s97, 262164
    v_mfma_f32_16x16x32_bf16 v[232:235], a[80:83], v[152:155], v[232:235]
    ds_read_b128 v[172:175], v21 offset:51200
    s_add_u32 m0, s37, 81920
    v_mfma_f32_16x16x32_bf16 v[220:223], a[64:67], v[156:159], v[220:223]
    ds_read_b128 v[176:179], v21 offset:53248
    v_mfma_f32_16x16x32_bf16 v[236:239], a[80:83], v[156:159], v[236:239]
    ds_read_b128 v[180:183], v21 offset:55296
    s_lshl_b32 s72, s72, 7
    v_mfma_f32_16x16x32_bf16 v[224:227], a[64:67], v[160:163], v[224:227]
    buffer_load_dwordx4 v16, s[16:19], s72 offen offset:0  lds
    v_mfma_f32_16x16x32_bf16 v[240:243], a[80:83], v[160:163], v[240:243]
    v_mfma_f32_16x16x32_bf16 v[228:231], a[64:67], v[164:167], v[228:231]
    buffer_load_dwordx4 v17, s[16:19], s72 offen offset:1024  lds
    v_xor_b32 v21, 0x10000, v21
    v_mfma_f32_16x16x32_bf16 v[244:247], a[80:83], v[164:167], v[244:247]
    s_waitcnt lgkmcnt(0)
    v_mfma_f32_16x16x32_bf16 v[216:219], a[68:71], v[168:171], v[216:219]
    ds_read_b128 v[152:155], v22 offset:49152
    buffer_load_dwordx4 v18, s[16:19], s72 offen offset:2048  lds
    v_mfma_f32_16x16x32_bf16 v[232:235], a[84:87], v[168:171], v[232:235]
    ds_read_b128 v[156:159], v22 offset:51200
    v_mfma_f32_16x16x32_bf16 v[220:223], a[68:71], v[172:175], v[220:223]
    ds_read_b128 v[160:163], v22 offset:53248
    v_mfma_f32_16x16x32_bf16 v[236:239], a[84:87], v[172:175], v[236:239]
    ds_read_b128 v[164:167], v22 offset:55296
    v_mfma_f32_16x16x32_bf16 v[224:227], a[68:71], v[176:179], v[224:227]
    buffer_load_dwordx4 v19, s[16:19], s72 offen offset:3072  lds
    v_mfma_f32_16x16x32_bf16 v[240:243], a[84:87], v[176:179], v[240:243]
    v_mfma_f32_16x16x32_bf16 v[228:231], a[68:71], v[180:183], v[228:231]
    v_xor_b32 v22, 0x10000, v22
    v_mfma_f32_16x16x32_bf16 v[244:247], a[84:87], v[180:183], v[244:247]
    s_waitcnt lgkmcnt(0)
    v_mfma_f32_16x16x32_bf16 v[216:219], a[72:75], v[152:155], v[216:219]
    ds_read_b128 v[168:171], v23 offset:49152
    s_bfe_u32 s72, s97, 262168
    v_mfma_f32_16x16x32_bf16 v[232:235], a[88:91], v[152:155], v[232:235]
    ds_read_b128 v[172:175], v23 offset:51200
    s_add_u32 m0, s37, 98304
    v_mfma_f32_16x16x32_bf16 v[220:223], a[72:75], v[156:159], v[220:223]
    ds_read_b128 v[176:179], v23 offset:53248
    v_mfma_f32_16x16x32_bf16 v[236:239], a[88:91], v[156:159], v[236:239]
    ds_read_b128 v[180:183], v23 offset:55296
    s_lshl_b32 s72, s72, 7
    v_mfma_f32_16x16x32_bf16 v[224:227], a[72:75], v[160:163], v[224:227]
    buffer_load_dwordx4 v16, s[16:19], s72 offen offset:0  lds
    v_mfma_f32_16x16x32_bf16 v[240:243], a[88:91], v[160:163], v[240:243]
    v_mfma_f32_16x16x32_bf16 v[228:231], a[72:75], v[164:167], v[228:231]
    buffer_load_dwordx4 v17, s[16:19], s72 offen offset:1024  lds
    v_xor_b32 v23, 0x10000, v23
    v_mfma_f32_16x16x32_bf16 v[244:247], a[88:91], v[164:167], v[244:247]
    s_waitcnt lgkmcnt(0) vmcnt(6)
    s_barrier
    v_mfma_f32_16x16x32_bf16 v[216:219], a[76:79], v[168:171], v[216:219]
    ds_read_b128 v[152:155], v20 offset:0
    buffer_load_dwordx4 v18, s[16:19], s72 offen offset:2048  lds
    v_mfma_f32_16x16x32_bf16 v[232:235], a[92:95], v[168:171], v[232:235]
    ds_read_b128 v[156:159], v20 offset:2048
    v_mfma_f32_16x16x32_bf16 v[220:223], a[76:79], v[172:175], v[220:223]
    ds_read_b128 v[160:163], v20 offset:4096
    buffer_load_dwordx4 v19, s[16:19], s72 offen offset:3072  lds
    v_mfma_f32_16x16x32_bf16 v[236:239], a[92:95], v[172:175], v[236:239]
    ds_read_b128 v[164:167], v20 offset:6144
    v_mfma_f32_16x16x32_bf16 v[224:227], a[76:79], v[176:179], v[224:227]
    v_mfma_f32_16x16x32_bf16 v[240:243], a[92:95], v[176:179], v[240:243]
    buffer_load_dword v10, v5, s[24:27], s70 offen sc1
    v_mfma_f32_16x16x32_bf16 v[228:231], a[76:79], v[180:183], v[228:231]
    v_mfma_f32_16x16x32_bf16 v[244:247], a[92:95], v[180:183], v[244:247]
    s_waitcnt lgkmcnt(0)
    v_mfma_f32_16x16x32_bf16 v[216:219], a[96:99], v[152:155], v[216:219]
    ds_read_b128 v[168:171], v21 offset:0
    s_bfe_u32 s72, s97, 262172
    v_mfma_f32_16x16x32_bf16 v[232:235], a[112:115], v[152:155], v[232:235]
    ds_read_b128 v[172:175], v21 offset:2048
    s_add_u32 m0, s37, 114688
    v_mfma_f32_16x16x32_bf16 v[220:223], a[96:99], v[156:159], v[220:223]
    ds_read_b128 v[176:179], v21 offset:4096
    v_mfma_f32_16x16x32_bf16 v[236:239], a[112:115], v[156:159], v[236:239]
    ds_read_b128 v[180:183], v21 offset:6144
    s_lshl_b32 s72, s72, 7
    v_mfma_f32_16x16x32_bf16 v[224:227], a[96:99], v[160:163], v[224:227]
    buffer_load_dwordx4 v16, s[16:19], s72 offen offset:0  lds
    v_mfma_f32_16x16x32_bf16 v[240:243], a[112:115], v[160:163], v[240:243]
    v_mfma_f32_16x16x32_bf16 v[228:231], a[96:99], v[164:167], v[228:231]
    buffer_load_dwordx4 v17, s[16:19], s72 offen offset:1024  lds
    v_mfma_f32_16x16x32_bf16 v[244:247], a[112:115], v[164:167], v[244:247]
    s_waitcnt lgkmcnt(0)
    v_mfma_f32_16x16x32_bf16 v[216:219], a[100:103], v[168:171], v[216:219]
    ds_read_b128 v[152:155], v22 offset:0
    buffer_load_dwordx4 v18, s[16:19], s72 offen offset:2048  lds
    v_mfma_f32_16x16x32_bf16 v[232:235], a[116:119], v[168:171], v[232:235]
    ds_read_b128 v[156:159], v22 offset:2048
    v_mfma_f32_16x16x32_bf16 v[220:223], a[100:103], v[172:175], v[220:223]
    ds_read_b128 v[160:163], v22 offset:4096
    v_mfma_f32_16x16x32_bf16 v[236:239], a[116:119], v[172:175], v[236:239]
    ds_read_b128 v[164:167], v22 offset:6144
    v_mfma_f32_16x16x32_bf16 v[224:227], a[100:103], v[176:179], v[224:227]
    buffer_load_dwordx4 v19, s[16:19], s72 offen offset:3072  lds
    v_mfma_f32_16x16x32_bf16 v[240:243], a[116:119], v[176:179], v[240:243]
    v_mfma_f32_16x16x32_bf16 v[228:231], a[100:103], v[180:183], v[228:231]
    v_mfma_f32_16x16x32_bf16 v[244:247], a[116:119], v[180:183], v[244:247]
    s_waitcnt lgkmcnt(0)
    v_mfma_f32_16x16x32_bf16 v[216:219], a[104:107], v[152:155], v[216:219]
    ds_read_b128 v[168:171], v23 offset:0
    v_mfma_f32_16x16x32_bf16 v[232:235], a[120:123], v[152:155], v[232:235]
    ds_read_b128 v[172:175], v23 offset:2048
    v_mfma_f32_16x16x32_bf16 v[220:223], a[104:107], v[156:159], v[220:223]
    ds_read_b128 v[176:179], v23 offset:4096
    v_mfma_f32_16x16x32_bf16 v[236:239], a[120:123], v[156:159], v[236:239]
    ds_read_b128 v[180:183], v23 offset:6144
    v_mfma_f32_16x16x32_bf16 v[224:227], a[104:107], v[160:163], v[224:227]
    v_mfma_f32_16x16x32_bf16 v[240:243], a[120:123], v[160:163], v[240:243]
    v_mfma_f32_16x16x32_bf16 v[228:231], a[104:107], v[164:167], v[228:231]
    v_mfma_f32_16x16x32_bf16 v[244:247], a[120:123], v[164:167], v[244:247]
    s_waitcnt lgkmcnt(0) vmcnt(4)
    v_cmp_ne_u32 vcc, s98, v10
    s_nop 0
    s_cbranch_vccnz K_POLL5
K_POLL5_OK:
    s_barrier
    v_mfma_f32_16x16x32_bf16 v[216:219], a[108:111], v[168:171], v[216:219]
    ds_read_b128 v[152:155], v20 offset:16384
    buffer_load_dword v6, v9, s[24:27], s70 offen sc1
    v_mfma_f32_16x16x32_bf16 v[232:235], a[124:127], v[168:171], v[232:235]
    ds_read_b128 v[156:159], v20 offset:18432
    v_mfma_f32_16x16x32_bf16 v[220:223], a[108:111], v[172:175], v[220:223]
    ds_read_b128 v[160:163], v20 offset:20480
    buffer_load_dwordx4 v[96:99], v3, s[24:27], s53 offen offset:0 sc1
    v_mfma_f32_16x16x32_bf16 v[236:239], a[124:127], v[172:175], v[236:239]
    ds_read_b128 v[164:167], v20 offset:22528
    v_mfma_f32_16x16x32_bf16 v[224:227], a[108:111], v[176:179], v[224:227]
    v_mfma_f32_16x16x32_bf16 v[240:243], a[124:127], v[176:179], v[240:243]
    buffer_load_dwordx4 v[100:103], v3, s[24:27], s53 offen offset:1024 sc1
    v_mfma_f32_16x16x32_bf16 v[228:231], a[108:111], v[180:183], v[228:231]
    v_mfma_f32_16x16x32_bf16 v[244:247], a[124:127], v[180:183], v[244:247]
    s_waitcnt lgkmcnt(0)
    v_mfma_f32_16x16x32_bf16 v[216:219], a[128:131], v[152:155], v[216:219]
    ds_read_b128 v[168:171], v21 offset:16384
    buffer_load_dwordx4 v[104:107], v3, s[24:27], s53 offen offset:2048 sc1
    v_mfma_f32_16x16x32_bf16 v[232:235], a[144:147], v[152:155], v[232:235]
    ds_read_b128 v[172:175], v21 offset:18432
    v_mfma_f32_16x16x32_bf16 v[220:223], a[128:131], v[156:159], v[220:223]
    ds_read_b128 v[176:179], v21 offset:20480
    v_mfma_f32_16x16x32_bf16 v[236:239], a[144:147], v[156:159], v[236:239]
    ds_read_b128 v[180:183], v21 offset:22528
    v_mfma_f32_16x16x32_bf16 v[224:227], a[128:131], v[160:163], v[224:227]
    buffer_load_dwordx4 v[108:111], v3, s[24:27], s53 offen offset:3072 sc1
    v_mfma_f32_16x16x32_bf16 v[240:243], a[144:147], v[160:163], v[240:243]
    v_mfma_f32_16x16x32_bf16 v[228:231], a[128:131], v[164:167], v[228:231]
    v_mfma_f32_16x16x32_bf16 v[244:247], a[144:147], v[164:167], v[244:247]
    s_waitcnt lgkmcnt(0)
    v_mfma_f32_16x16x32_bf16 v[216:219], a[132:135], v[168:171], v[216:219]
    ds_read_b128 v[152:155], v22 offset:16384
    v_mfma_f32_16x16x32_bf16 v[232:235], a[148:151], v[168:171], v[232:235]
    ds_read_b128 v[156:159], v22 offset:18432
    v_mfma_f32_16x16x32_bf16 v[220:223], a[132:135], v[172:175], v[220:223]
    ds_read_b128 v[160:163], v22 offset:20480
    v_mfma_f32_16x16x32_bf16 v[236:239], a[148:151], v[172:175], v[236:239]
    ds_read_b128 v[164:167], v22 offset:22528
    v_mfma_f32_16x16x32_bf16 v[224:227], a[132:135], v[176:179], v[224:227]
    v_mfma_f32_16x16x32_bf16 v[240:243], a[148:151], v[176:179], v[240:243]
    v_mfma_f32_16x16x32_bf16 v[228:231], a[132:135], v[180:183], v[228:231]
    v_mfma_f32_16x16x32_bf16 v[244:247], a[148:151], v[180:183], v[244:247]
    s_waitcnt lgkmcnt(0)
    v_mfma_f32_16x16x32_bf16 v[216:219], a[136:139], v[152:155], v[216:219]
    ds_read_b128 v[168:171], v23 offset:16384
    v_mfma_f32_16x16x32_bf16 v[232:235], a[152:155], v[152:155], v[232:235]
    ds_read_b128 v[172:175], v23 offset:18432
    v_mfma_f32_16x16x32_bf16 v[220:223], a[136:139], v[156:159], v[220:223]
    ds_read_b128 v[176:179], v23 offset:20480
    v_mfma_f32_16x16x32_bf16 v[236:239], a[152:155], v[156:159], v[236:239]
    ds_read_b128 v[180:183], v23 offset:22528
    v_mfma_f32_16x16x32_bf16 v[224:227], a[136:139], v[160:163], v[224:227]
    v_mfma_f32_16x16x32_bf16 v[240:243], a[152:155], v[160:163], v[240:243]
    v_mfma_f32_16x16x32_bf16 v[228:231], a[136:139], v[164:167], v[228:231]
    v_mfma_f32_16x16x32_bf16 v[244:247], a[152:155], v[164:167], v[244:247]
    s_waitcnt lgkmcnt(0) vmcnt(5)
    s_barrier
    v_mfma_f32_16x16x32_bf16 v[216:219], a[140:143], v[168:171], v[216:219]
    ds_read_b128 v[152:155], v20 offset:32768
    v_mfma_f32_16x16x32_bf16 v[232:235], a[156:159], v[168:171], v[232:235]
    ds_read_b128 v[156:159], v20 offset:34816
    v_mfma_f32_16x16x32_bf16 v[220:223], a[140:143], v[172:175], v[220:223]
    ds_read_b128 v[160:163], v20 offset:36864
    v_mfma_f32_16x16x32_bf16 v[236:239], a[156:159], v[172:175], v[236:239]
    ds_read_b128 v[164:167], v20 offset:38912
    v_mfma_f32_16x16x32_bf16 v[224:227], a[140:143], v[176:179], v[224:227]
    v_mfma_f32_16x16x32_bf16 v[240:243], a[156:159], v[176:179], v[240:243]
    v_mfma_f32_16x16x32_bf16 v[228:231], a[140:143], v[180:183], v[228:231]
    v_mfma_f32_16x16x32_bf16 v[244:247], a[156:159], v[180:183], v[244:247]
    s_waitcnt lgkmcnt(0) vmcnt(4)
    v_cmp_ne_u32 vcc, s98, v6
    s_nop 0
    s_cbranch_vccnz K_POLL6
K_POLL6_OK:
    s_barrier
    v_mfma_f32_16x16x32_bf16 v[216:219], a[160:163], v[152:155], v[216:219]
    ds_read_b128 v[168:171], v21 offset:32768
    buffer_load_dwordx4 v[112:115], v3, s[24:27], s54 offen offset:0 sc1
    v_mfma_f32_16x16x32_bf16 v[232:235], a[176:179], v[152:155], v[232:235]
    ds_read_b128 v[172:175], v21 offset:34816
    v_mfma_f32_16x16x32_bf16 v[220:223], a[160:163], v[156:159], v[220:223]
    ds_read_b128 v[176:179], v21 offset:36864
    v_mfma_f32_16x16x32_bf16 v[236:239], a[176:179], v[156:159], v[236:239]
    ds_read_b128 v[180:183], v21 offset:38912
    v_mfma_f32_16x16x32_bf16 v[224:227], a[160:163], v[160:163], v[224:227]
    buffer_load_dwordx4 v[116:119], v3, s[24:27], s54 offen offset:1024 sc1
    v_mfma_f32_16x16x32_bf16 v[240:243], a[176:179], v[160:163], v[240:243]
    v_mfma_f32_16x16x32_bf16 v[228:231], a[160:163], v[164:167], v[228:231]
    v_mfma_f32_16x16x32_bf16 v[244:247], a[176:179], v[164:167], v[244:247]
    s_waitcnt lgkmcnt(0)
    v_mfma_f32_16x16x32_bf16 v[216:219], a[164:167], v[168:171], v[216:219]
    ds_read_b128 v[152:155], v22 offset:32768
    buffer_load_dwordx4 v[120:123], v3, s[24:27], s54 offen offset:2048 sc1
    v_mfma_f32_16x16x32_bf16 v[232:235], a[180:183], v[168:171], v[232:235]
    ds_read_b128 v[156:159], v22 offset:34816
    v_mfma_f32_16x16x32_bf16 v[220:223], a[164:167], v[172:175], v[220:223]
    ds_read_b128 v[160:163], v22 offset:36864
    v_mfma_f32_16x16x32_bf16 v[236:239], a[180:183], v[172:175], v[236:239]
    ds_read_b128 v[164:167], v22 offset:38912
    v_mfma_f32_16x16x32_bf16 v[224:227], a[164:167], v[176:179], v[224:227]
    buffer_load_dwordx4 v[124:127], v3, s[24:27], s54 offen offset:3072 sc1
    v_mfma_f32_16x16x32_bf16 v[240:243], a[180:183], v[176:179], v[240:243]
    v_mfma_f32_16x16x32_bf16 v[228:231], a[164:167], v[180:183], v[228:231]
    v_mfma_f32_16x16x32_bf16 v[244:247], a[180:183], v[180:183], v[244:247]
    s_waitcnt lgkmcnt(0)
    v_mfma_f32_16x16x32_bf16 v[216:219], a[168:171], v[152:155], v[216:219]
    ds_read_b128 v[168:171], v23 offset:32768
    v_mfma_f32_16x16x32_bf16 v[232:235], a[184:187], v[152:155], v[232:235]
    ds_read_b128 v[172:175], v23 offset:34816
    v_mfma_f32_16x16x32_bf16 v[220:223], a[168:171], v[156:159], v[220:223]
    ds_read_b128 v[176:179], v23 offset:36864
    v_mfma_f32_16x16x32_bf16 v[236:239], a[184:187], v[156:159], v[236:239]
    ds_read_b128 v[180:183], v23 offset:38912
    v_mfma_f32_16x16x32_bf16 v[224:227], a[168:171], v[160:163], v[224:227]
    v_mfma_f32_16x16x32_bf16 v[240:243], a[184:187], v[160:163], v[240:243]
    v_mfma_f32_16x16x32_bf16 v[228:231], a[168:171], v[164:167], v[228:231]
    v_mfma_f32_16x16x32_bf16 v[244:247], a[184:187], v[164:167], v[244:247]
    s_waitcnt lgkmcnt(0)
    v_mfma_f32_16x16x32_bf16 v[216:219], a[172:175], v[168:171], v[216:219]
    ds_read_b128 v[152:155], v20 offset:49152
    s_waitcnt vmcnt(7)
    v_lshlrev_b32_e64 v184, 16, v96
    v_mfma_f32_16x16x32_bf16 v[232:235], a[188:191], v[168:171], v[232:235]
    ds_read_b128 v[156:159], v20 offset:51200
    v_and_b32 v185, 0xffff0000, v96
    v_mfma_f32_16x16x32_bf16 v[220:223], a[172:175], v[172:175], v[220:223]
    ds_read_b128 v[160:163], v20 offset:53248
    v_lshlrev_b32_e64 v186, 16, v97
    v_mfma_f32_16x16x32_bf16 v[236:239], a[188:191], v[172:175], v[236:239]
    ds_read_b128 v[164:167], v20 offset:55296
    v_and_b32 v187, 0xffff0000, v97
    v_mfma_f32_16x16x32_bf16 v[224:227], a[172:175], v[176:179], v[224:227]
    v_lshlrev_b32_e64 v188, 16, v98
    v_mfma_f32_16x16x32_bf16 v[240:243], a[188:191], v[176:179], v[240:243]
    v_and_b32 v189, 0xffff0000, v98
    v_mfma_f32_16x16x32_bf16 v[228:231], a[172:175], v[180:183], v[228:231]
    v_lshlrev_b32_e64 v190, 16, v99
    v_mfma_f32_16x16x32_bf16 v[244:247], a[188:191], v[180:183], v[244:247]
    v_and_b32 v191, 0xffff0000, v99
    s_waitcnt lgkmcnt(0)
    v_mfma_f32_16x16x32_bf16 v[216:219], a[192:195], v[152:155], v[216:219]
    ds_read_b128 v[168:171], v21 offset:49152
    s_waitcnt vmcnt(6)
    v_lshlrev_b32_e64 v192, 16, v100
    v_mfma_f32_16x16x32_bf16 v[232:235], a[208:211], v[152:155], v[232:235]
    ds_read_b128 v[172:175], v21 offset:51200
    v_and_b32 v193, 0xffff0000, v100
    v_mfma_f32_16x16x32_bf16 v[220:223], a[192:195], v[156:159], v[220:223]
    ds_read_b128 v[176:179], v21 offset:53248
    v_lshlrev_b32_e64 v194, 16, v101
    v_mfma_f32_16x16x32_bf16 v[236:239], a[208:211], v[156:159], v[236:239]
    ds_read_b128 v[180:183], v21 offset:55296
    v_and_b32 v195, 0xffff0000, v101
    v_mfma_f32_16x16x32_bf16 v[224:227], a[192:195], v[160:163], v[224:227]
    v_lshlrev_b32_e64 v196, 16, v102
    v_mfma_f32_16x16x32_bf16 v[240:243], a[208:211], v[160:163], v[240:243]
    v_and_b32 v197, 0xffff0000, v102
    v_mfma_f32_16x16x32_bf16 v[228:231], a[192:195], v[164:167], v[228:231]
    v_lshlrev_b32_e64 v198, 16, v103
    v_mfma_f32_16x16x32_bf16 v[244:247], a[208:211], v[164:167], v[244:247]
    v_and_b32 v199, 0xffff0000, v103
    s_waitcnt lgkmcnt(0)
    v_mfma_f32_16x16x32_bf16 v[216:219], a[196:199], v[168:171], v[216:219]
    ds_read_b128 v[152:155], v22 offset:49152
    s_waitcnt vmcnt(5)
    v_lshlrev_b32_e64 v200, 16, v104
    v_mfma_f32_16x16x32_bf16 v[232:235], a[212:215], v[168:171], v[232:235]
    ds_read_b128 v[156:159], v22 offset:51200
    v_and_b32 v201, 0xffff0000, v104
    v_mfma_f32_16x16x32_bf16 v[220:223], a[196:199], v[172:175], v[220:223]
    ds_read_b128 v[160:163], v22 offset:53248
    v_lshlrev_b32_e64 v202, 16, v105
    v_mfma_f32_16x16x32_bf16 v[236:239], a[212:215], v[172:175], v[236:239]
    ds_read_b128 v[164:167], v22 offset:55296
    v_and_b32 v203, 0xffff0000, v105
    v_mfma_f32_16x16x32_bf16 v[224:227], a[196:199], v[176:179], v[224:227]
    v_lshlrev_b32_e64 v204, 16, v106
    v_mfma_f32_16x16x32_bf16 v[240:243], a[212:215], v[176:179], v[240:243]
    v_and_b32 v205, 0xffff0000, v106
    v_mfma_f32_16x16x32_bf16 v[228:231], a[196:199], v[180:183], v[228:231]
    v_lshlrev_b32_e64 v206, 16, v107
    v_mfma_f32_16x16x32_bf16 v[244:247], a[212:215], v[180:183], v[244:247]
    v_and_b32 v207, 0xffff0000, v107
    s_waitcnt lgkmcnt(0)
    v_mfma_f32_16x16x32_bf16 v[216:219], a[200:203], v[152:155], v[216:219]
    ds_read_b128 v[168:171], v23 offset:49152
    s_waitcnt vmcnt(4)
    v_lshlrev_b32_e64 v208, 16, v108
    v_mfma_f32_16x16x32_bf16 v[232:235], a[216:219], v[152:155], v[232:235]
    ds_read_b128 v[172:175], v23 offset:51200
    v_and_b32 v209, 0xffff0000, v108
    v_mfma_f32_16x16x32_bf16 v[220:223], a[200:203], v[156:159], v[220:223]
    ds_read_b128 v[176:179], v23 offset:53248
    v_lshlrev_b32_e64 v210, 16, v109
    v_mfma_f32_16x16x32_bf16 v[236:239], a[216:219], v[156:159], v[236:239]
    ds_read_b128 v[180:183], v23 offset:55296
    v_and_b32 v211, 0xffff0000, v109
    v_mfma_f32_16x16x32_bf16 v[224:227], a[200:203], v[160:163], v[224:227]
    v_lshlrev_b32_e64 v212, 16, v110
    v_mfma_f32_16x16x32_bf16 v[240:243], a[216:219], v[160:163], v[240:243]
    v_and_b32 v213, 0xffff0000, v110
    v_mfma_f32_16x16x32_bf16 v[228:231], a[200:203], v[164:167], v[228:231]
    v_lshlrev_b32_e64 v214, 16, v111
    v_mfma_f32_16x16x32_bf16 v[244:247], a[216:219], v[164:167], v[244:247]
    v_and_b32 v215, 0xffff0000, v111
    s_waitcnt lgkmcnt(0)
    v_mfma_f32_16x16x32_bf16 v[216:219], a[204:207], v[168:171], v[216:219]
    s_waitcnt vmcnt(3)
    v_lshlrev_b32_e64 v32, 16, v112
    v_mfma_f32_16x16x32_bf16 v[232:235], a[220:223], v[168:171], v[232:235]
    v_and_b32 v33, 0xffff0000, v112
    v_mfma_f32_16x16x32_bf16 v[220:223], a[204:207], v[172:175], v[220:223]
    v_lshlrev_b32_e64 v34, 16, v113
    v_mfma_f32_16x16x32_bf16 v[236:239], a[220:223], v[172:175], v[236:239]
    v_and_b32 v35, 0xffff0000, v113
    v_mfma_f32_16x16x32_bf16 v[224:227], a[204:207], v[176:179], v[224:227]
    v_lshlrev_b32_e64 v36, 16, v114
    v_mfma_f32_16x16x32_bf16 v[240:243], a[220:223], v[176:179], v[240:243]
    v_and_b32 v37, 0xffff0000, v114
    v_mfma_f32_16x16x32_bf16 v[228:231], a[204:207], v[180:183], v[228:231]
    v_lshlrev_b32_e64 v38, 16, v115
    v_mfma_f32_16x16x32_bf16 v[244:247], a[220:223], v[180:183], v[244:247]
    v_and_b32 v39, 0xffff0000, v115
    v_add_f32 v32, v32, v216
    v_add_f32 v33, v33, v220
    v_add_f32 v34, v34, v224
    s_nop 1
    v_add_f32_e64 v35, v35, v228
    v_pk_fma_f32 v[184:185], v[32:33], v[128:129], v[184:185] op_sel_hi:[1,0,1]
    v_pk_fma_f32 v[186:187], v[34:35], v[128:129], v[186:187] op_sel_hi:[1,0,1]
    s_add_u32 s39, s56, 0
    buffer_store_dwordx4 v[184:187], v12, s[28:31], s39 offen nt
    v_add_f32 v36, v36, v232
    v_add_f32 v37, v37, v236
    v_add_f32 v38, v38, v240
    v_add_f32_e64 v39, v39, v244
    v_pk_fma_f32 v[188:189], v[36:37], v[128:129], v[188:189] op_sel:[0,1,0]
    v_pk_fma_f32 v[190:191], v[38:39], v[128:129], v[190:191] op_sel:[0,1,0]
    s_add_u32 s39, s56, 131072
    buffer_store_dwordx4 v[188:191], v12, s[28:31], s39 offen nt
    s_waitcnt vmcnt(4)
    v_lshlrev_b32 v40, 16, v116
    v_and_b32 v41, 0xffff0000, v116
    v_lshlrev_b32_e64 v42, 16, v117
    v_and_b32 v43, 0xffff0000, v117
    v_lshlrev_b32_e64 v44, 16, v118
    v_and_b32 v45, 0xffff0000, v118
    v_lshlrev_b32_e64 v46, 16, v119
    v_and_b32 v47, 0xffff0000, v119
    v_add_f32 v40, v40, v217
    v_add_f32 v41, v41, v221
    v_add_f32 v42, v42, v225
    v_add_f32 v43, v43, v229
    v_pk_fma_f32 v[192:193], v[40:41], v[130:131], v[192:193] op_sel_hi:[1,0,1]
    v_pk_fma_f32 v[194:195], v[42:43], v[130:131], v[194:195] op_sel_hi:[1,0,1]
    s_add_u32 s39, s56, 4096
    buffer_store_dwordx4 v[192:195], v12, s[28:31], s39 offen nt
    v_add_f32 v44, v44, v233
    v_add_f32 v45, v45, v237
    v_add_f32 v46, v46, v241
    v_add_f32 v47, v47, v245
    v_pk_fma_f32 v[196:197], v[44:45], v[130:131], v[196:197] op_sel:[0,1,0]
    v_pk_fma_f32 v[198:199], v[46:47], v[130:131], v[198:199] op_sel:[0,1,0]
    s_add_u32 s39, s56, 135168
    buffer_store_dwordx4 v[196:199], v12, s[28:31], s39 offen nt
    s_waitcnt vmcnt(5)
    v_lshlrev_b32 v48, 16, v120
    v_and_b32 v49, 0xffff0000, v120
    v_lshlrev_b32_e64 v50, 16, v121
    v_and_b32 v51, 0xffff0000, v121
    v_lshlrev_b32_e64 v52, 16, v122
    v_and_b32 v53, 0xffff0000, v122
    v_lshlrev_b32_e64 v54, 16, v123
    v_and_b32 v55, 0xffff0000, v123
    v_add_f32 v48, v48, v218
    v_add_f32 v49, v49, v222
    v_add_f32 v50, v50, v226
    v_add_f32 v51, v51, v230
    v_pk_fma_f32 v[200:201], v[48:49], v[132:133], v[200:201] op_sel_hi:[1,0,1]
    v_pk_fma_f32 v[202:203], v[50:51], v[132:133], v[202:203] op_sel_hi:[1,0,1]
    s_add_u32 s39, s56, 8192
    buffer_store_dwordx4 v[200:203], v12, s[28:31], s39 offen nt
    v_add_f32 v52, v52, v234
    v_add_f32 v53, v53, v238
    v_add_f32 v54, v54, v242
    v_add_f32 v55, v55, v246
    v_pk_fma_f32 v[204:205], v[52:53], v[132:133], v[204:205] op_sel:[0,1,0]
    v_pk_fma_f32 v[206:207], v[54:55], v[132:133], v[206:207] op_sel:[0,1,0]
    s_add_u32 s39, s56, 139264
    buffer_store_dwordx4 v[204:207], v12, s[28:31], s39 offen nt
    s_waitcnt vmcnt(6)
    v_lshlrev_b32 v56, 16, v124
    v_and_b32 v57, 0xffff0000, v124
    v_lshlrev_b32_e64 v58, 16, v125
    v_and_b32 v59, 0xffff0000, v125
    v_lshlrev_b32_e64 v60, 16, v126
    v_and_b32 v61, 0xffff0000, v126
    v_lshlrev_b32_e64 v62, 16, v127
    v_and_b32 v63, 0xffff0000, v127
    v_add_f32 v56, v56, v219
    v_add_f32 v57, v57, v223
    v_add_f32 v58, v58, v227
    v_add_f32 v59, v59, v231
    v_pk_fma_f32 v[208:209], v[56:57], v[134:135], v[208:209] op_sel_hi:[1,0,1]
    v_pk_fma_f32 v[210:211], v[58:59], v[134:135], v[210:211] op_sel_hi:[1,0,1]
    s_add_u32 s39, s56, 12288
    buffer_store_dwordx4 v[208:211], v12, s[28:31], s39 offen nt
    v_add_f32 v60, v60, v235
    v_add_f32 v61, v61, v239
    v_add_f32 v62, v62, v243
    v_add_f32 v63, v63, v247
    v_pk_fma_f32 v[212:213], v[60:61], v[134:135], v[212:213] op_sel:[0,1,0]
    v_pk_fma_f32 v[214:215], v[62:63], v[134:135], v[214:215] op_sel:[0,1,0]
    s_add_u32 s39, s56, 143360
    buffer_store_dwordx4 v[212:215], v12, s[28:31], s39 offen nt
K_END:
    s_endpgm
K_W256:
    buffer_load_dwordx4 a[120:123], v3, s[24:27], s37 offen offset:0 sc1
    buffer_load_dwordx4 a[124:127], v3, s[24:27], s37 offen offset:1024 sc1
    buffer_load_dwordx4 a[128:131], v3, s[24:27], s37 offen offset:2048 sc1
    buffer_load_dwordx4 a[132:135], v3, s[24:27], s37 offen offset:3072 sc1
    s_add_u32 s69, s62, 1
    v_mov_b32_e64 v28, s69
    s_mov_b32 s69, 22446080
    buffer_store_dword v28, v30, s[24:27], s69 offen sc1
    s_branch K_W256_RET
K_POLL1:
    s_mov_b32 s71, 0
K_POLL1_L:
    s_sleep 2
    buffer_load_dword v216, v217, s[24:27], s68 offen sc1
    s_add_u32 s71, s71, 1
    s_waitcnt vmcnt(0)
    v_cmp_ne_u32 vcc, s35, v216
    s_nop 0
    s_cbranch_vccz K_POLL1_OK
    s_cmp_lt_u32 s71, 200000
    s_cbranch_scc1 K_POLL1_L
    s_branch K_POLL1_OK
K_SPECIAL:
    v_add_u32 v14, s63, v1
    v_sub_u32 v13, 64, v14
    v_cmp_eq_u32 s[44:45], 0, v14
    v_and_b32_e64 v13, 63, v13
    v_mul_u32_u24 v14, 144, v14
    v_mul_u32_u24 v13, 144, v13
    v_add_u32 v14, 81920, v14
    v_lshl_add_u32 v12, v2, 4, v14
    v_lshl_add_u32 v14, v2, 2, v14
    v_sub_u32_e64 v15, 3, v2
    v_add_u32 v14, 128, v14
    v_lshl_add_u32 v13, v15, 4, v13
    v_add_u32 v13, 81920, v13
    v_accvgpr_read_b32 v8, a120
    v_accvgpr_read_b32 v9, a122
    v_lshlrev_b32 v4, 16, v8
    v_lshlrev_b32 v5, 16, v9
    v_and_b32 v6, 0xffff0000, v8
    v_and_b32 v7, 0xffff0000, v9
    v_pk_mul_f32 v[184:185], v[240:241], v[4:5]
    v_pk_mul_f32 v[188:189], v[244:245], v[4:5]
    v_pk_fma_f32 v[184:185], v[244:245], v[6:7], v[184:185] neg_lo:[1,0,0] neg_hi:[1,0,0]
    v_pk_fma_f32 v[188:189], v[240:241], v[6:7], v[188:189]
    ds_write_b128 v12, v[224:227] offset:0
    v_accvgpr_read_b32 v8, a124
    v_accvgpr_read_b32 v9, a126
    v_lshlrev_b32 v4, 16, v8
    v_lshlrev_b32 v5, 16, v9
    v_and_b32 v6, 0xffff0000, v8
    v_and_b32 v7, 0xffff0000, v9
    v_pk_mul_f32 v[186:187], v[242:243], v[4:5]
    v_pk_mul_f32 v[190:191], v[246:247], v[4:5]
    v_pk_fma_f32 v[186:187], v[246:247], v[6:7], v[186:187] neg_lo:[1,0,0] neg_hi:[1,0,0]
    v_pk_fma_f32 v[190:191], v[242:243], v[6:7], v[190:191]
    ds_write_b128 v12, v[228:231] offset:9216
    v_accvgpr_read_b32 v8, a128
    v_accvgpr_read_b32 v9, a130
    v_lshlrev_b32 v4, 16, v8
    v_lshlrev_b32 v5, 16, v9
    v_and_b32 v6, 0xffff0000, v8
    v_and_b32 v7, 0xffff0000, v9
    v_pk_mul_f32 v[192:193], v[248:249], v[4:5]
    v_pk_mul_f32 v[196:197], v[252:253], v[4:5]
    v_pk_fma_f32 v[192:193], v[252:253], v[6:7], v[192:193] neg_lo:[1,0,0] neg_hi:[1,0,0]
    v_pk_fma_f32 v[196:197], v[248:249], v[6:7], v[196:197]
    ds_write_b128 v12, v[232:235] offset:64
    v_accvgpr_read_b32 v8, a132
    v_accvgpr_read_b32 v9, a134
    v_lshlrev_b32 v4, 16, v8
    v_lshlrev_b32 v5, 16, v9
    v_and_b32 v6, 0xffff0000, v8
    v_and_b32 v7, 0xffff0000, v9
    v_pk_mul_f32 v[194:195], v[250:251], v[4:5]
    v_pk_mul_f32 v[198:199], v[254:255], v[4:5]
    v_pk_fma_f32 v[194:195], v[254:255], v[6:7], v[194:195] neg_lo:[1,0,0] neg_hi:[1,0,0]
    v_pk_fma_f32 v[198:199], v[250:251], v[6:7], v[198:199]
    ds_write_b128 v12, v[236:239] offset:9280
    ds_write2st64_b32 v14, v224, v228 offset0:0 offset1:36
    s_waitcnt lgkmcnt(0)
    s_barrier
    ds_read_b128 v[96:99], v13 offset:64
    ds_read_b128 v[100:103], v13 offset:9280
    ds_read_b128 v[104:107], v13 offset:0
    ds_read_b128 v[108:111], v13 offset:9216
    ds_read_b32 v4, v13 offset:80
    ds_read_b32 v5, v13 offset:9296
    ds_read_b32 v6, v13 offset:16
    ds_read_b32 v7, v13 offset:9232
    s_waitcnt lgkmcnt(0)
    s_nop 0
    v_cndmask_b32 v96, v96, v97, s[44:45]
    v_cndmask_b32 v97, v97, v98, s[44:45]
    v_cndmask_b32 v98, v98, v99, s[44:45]
    v_cndmask_b32 v99, v99, v4, s[44:45]
    v_cndmask_b32 v100, v100, v101, s[44:45]
    v_cndmask_b32 v101, v101, v102, s[44:45]
    v_cndmask_b32 v102, v102, v103, s[44:45]
    v_cndmask_b32 v103, v103, v5, s[44:45]
    v_cndmask_b32 v104, v104, v105, s[44:45]
    v_cndmask_b32 v105, v105, v106, s[44:45]
    v_cndmask_b32 v106, v106, v107, s[44:45]
    v_cndmask_b32 v107, v107, v6, s[44:45]
    v_cndmask_b32 v108, v108, v109, s[44:45]
    v_cndmask_b32 v109, v109, v110, s[44:45]
    v_cndmask_b32 v110, v110, v111, s[44:45]
    v_cndmask_b32 v111, v111, v7, s[44:45]
    v_pk_mul_f32 v[240:241], v[98:99], 1.0 op_sel:[1,0] op_sel_hi:[0,0]
    v_pk_mul_f32 v[242:243], v[96:97], 1.0 op_sel:[1,0] op_sel_hi:[0,0]
    v_pk_mul_f32 v[244:245], v[102:103], -1.0 op_sel:[1,0] op_sel_hi:[0,0]
    v_pk_mul_f32 v[246:247], v[100:101], -1.0 op_sel:[1,0] op_sel_hi:[0,0]
    v_pk_mul_f32 v[248:249], v[106:107], 1.0 op_sel:[1,0] op_sel_hi:[0,0]
    v_pk_mul_f32 v[250:251], v[104:105], 1.0 op_sel:[1,0] op_sel_hi:[0,0]
    v_pk_mul_f32 v[252:253], v[110:111], -1.0 op_sel:[1,0] op_sel_hi:[0,0]
    v_pk_mul_f32 v[254:255], v[108:109], -1.0 op_sel:[1,0] op_sel_hi:[0,0]
    v_pk_fma_f32 v[4:5], v[224:225], s[42:43], v[244:245] op_sel_hi:[1,0,1]
    v_pk_fma_f32 v[6:7], v[228:229], s[42:43], v[240:241] op_sel_hi:[1,0,1] neg_lo:[0,0,1] neg_hi:[0,0,1]
    v_pk_fma_f32 v[8:9], v[240:241], s[42:43], v[228:229] op_sel_hi:[1,0,1]
    v_pk_fma_f32 v[10:11], v[244:245], s[42:43], v[224:225] op_sel_hi:[1,0,1] neg_lo:[0,0,1] neg_hi:[0,0,1]
    v_pk_mul_f32 v[224:225], v[4:5], v[152:153]
    v_pk_mul_f32 v[228:229], v[6:7], v[152:153]
    v_pk_mul_f32 v[240:241], v[8:9], v[168:169]
    v_pk_mul_f32 v[244:245], v[10:11], v[168:169]
    v_pk_fma_f32 v[152:153], v[6:7], v[160:161], v[224:225] neg_lo:[1,0,0] neg_hi:[1,0,0]
    v_pk_fma_f32 v[160:161], v[4:5], v[160:161], v[228:229]
    v_pk_fma_f32 v[168:169], v[10:11], v[176:177], v[240:241]
    v_pk_fma_f32 v[176:177], v[8:9], v[176:177], v[244:245] neg_lo:[1,0,0] neg_hi:[1,0,0]
    v_pk_fma_f32 v[224:225], v[152:153], s[42:43], v[176:177] op_sel_hi:[1,0,1] neg_lo:[0,0,1] neg_hi:[0,0,1]
    v_pk_fma_f32 v[228:229], v[160:161], s[42:43], v[168:169] op_sel_hi:[1,0,1]
    v_pk_fma_f32 v[240:241], v[168:169], s[42:43], v[160:161] op_sel_hi:[1,0,1] neg_lo:[0,0,1] neg_hi:[0,0,1]
    v_pk_fma_f32 v[244:245], v[176:177], s[42:43], v[152:153] op_sel_hi:[1,0,1]
    v_pk_fma_f32 v[4:5], v[226:227], s[42:43], v[246:247] op_sel_hi:[1,0,1]
    v_pk_fma_f32 v[6:7], v[230:231], s[42:43], v[242:243] op_sel_hi:[1,0,1] neg_lo:[0,0,1] neg_hi:[0,0,1]
    v_pk_fma_f32 v[8:9], v[242:243], s[42:43], v[230:231] op_sel_hi:[1,0,1]
    v_pk_fma_f32 v[10:11], v[246:247], s[42:43], v[226:227] op_sel_hi:[1,0,1] neg_lo:[0,0,1] neg_hi:[0,0,1]
    v_pk_mul_f32 v[226:227], v[4:5], v[154:155]
    v_pk_mul_f32 v[230:231], v[6:7], v[154:155]
    v_pk_mul_f32 v[242:243], v[8:9], v[170:171]
    v_pk_mul_f32 v[246:247], v[10:11], v[170:171]
    v_pk_fma_f32 v[154:155], v[6:7], v[162:163], v[226:227] neg_lo:[1,0,0] neg_hi:[1,0,0]
    v_pk_fma_f32 v[162:163], v[4:5], v[162:163], v[230:231]
    v_pk_fma_f32 v[170:171], v[10:11], v[178:179], v[242:243]
    v_pk_fma_f32 v[178:179], v[8:9], v[178:179], v[246:247] neg_lo:[1,0,0] neg_hi:[1,0,0]
    v_pk_fma_f32 v[226:227], v[154:155], s[42:43], v[178:179] op_sel_hi:[1,0,1] neg_lo:[0,0,1] neg_hi:[0,0,1]
    v_pk_fma_f32 v[230:231], v[162:163], s[42:43], v[170:171] op_sel_hi:[1,0,1]
    v_pk_fma_f32 v[242:243], v[170:171], s[42:43], v[162:163] op_sel_hi:[1,0,1] neg_lo:[0,0,1] neg_hi:[0,0,1]
    v_pk_fma_f32 v[246:247], v[178:179], s[42:43], v[154:155] op_sel_hi:[1,0,1]
    v_pk_fma_f32 v[4:5], v[232:233], s[42:43], v[252:253] op_sel_hi:[1,0,1]
    v_pk_fma_f32 v[6:7], v[236:237], s[42:43], v[248:249] op_sel_hi:[1,0,1] neg_lo:[0,0,1] neg_hi:[0,0,1]
    v_pk_fma_f32 v[8:9], v[248:249], s[42:43], v[236:237] op_sel_hi:[1,0,1]
    v_pk_fma_f32 v[10:11], v[252:253], s[42:43], v[232:233] op_sel_hi:[1,0,1] neg_lo:[0,0,1] neg_hi:[0,0,1]
    v_pk_mul_f32 v[232:233], v[4:5], v[156:157]
    v_pk_mul_f32 v[236:237], v[6:7], v[156:157]
    v_pk_mul_f32 v[248:249], v[8:9], v[172:173]
    v_pk_mul_f32 v[252:253], v[10:11], v[172:173]
    v_pk_fma_f32 v[156:157], v[6:7], v[164:165], v[232:233] neg_lo:[1,0,0] neg_hi:[1,0,0]
    v_pk_fma_f32 v[164:165], v[4:5], v[164:165], v[236:237]
    v_pk_fma_f32 v[172:173], v[10:11], v[180:181], v[248:249]
    v_pk_fma_f32 v[180:181], v[8:9], v[180:181], v[252:253] neg_lo:[1,0,0] neg_hi:[1,0,0]
    v_pk_fma_f32 v[232:233], v[156:157], s[42:43], v[180:181] op_sel_hi:[1,0,1] neg_lo:[0,0,1] neg_hi:[0,0,1]
    v_pk_fma_f32 v[236:237], v[164:165], s[42:43], v[172:173] op_sel_hi:[1,0,1]
    v_pk_fma_f32 v[248:249], v[172:173], s[42:43], v[164:165] op_sel_hi:[1,0,1] neg_lo:[0,0,1] neg_hi:[0,0,1]
    v_pk_fma_f32 v[252:253], v[180:181], s[42:43], v[156:157] op_sel_hi:[1,0,1]
    v_pk_fma_f32 v[4:5], v[234:235], s[42:43], v[254:255] op_sel_hi:[1,0,1]
    v_pk_fma_f32 v[6:7], v[238:239], s[42:43], v[250:251] op_sel_hi:[1,0,1] neg_lo:[0,0,1] neg_hi:[0,0,1]
    v_pk_fma_f32 v[8:9], v[250:251], s[42:43], v[238:239] op_sel_hi:[1,0,1]
    v_pk_fma_f32 v[10:11], v[254:255], s[42:43], v[234:235] op_sel_hi:[1,0,1] neg_lo:[0,0,1] neg_hi:[0,0,1]
    v_pk_mul_f32 v[234:235], v[4:5], v[158:159]
    v_pk_mul_f32 v[238:239], v[6:7], v[158:159]
    v_pk_mul_f32 v[250:251], v[8:9], v[174:175]
    v_pk_mul_f32 v[254:255], v[10:11], v[174:175]
    v_pk_fma_f32 v[158:159], v[6:7], v[166:167], v[234:235] neg_lo:[1,0,0] neg_hi:[1,0,0]
    v_pk_fma_f32 v[166:167], v[4:5], v[166:167], v[238:239]
    v_pk_fma_f32 v[174:175], v[10:11], v[182:183], v[250:251]
    v_pk_fma_f32 v[182:183], v[8:9], v[182:183], v[254:255] neg_lo:[1,0,0] neg_hi:[1,0,0]
    v_pk_fma_f32 v[234:235], v[158:159], s[42:43], v[182:183] op_sel_hi:[1,0,1] neg_lo:[0,0,1] neg_hi:[0,0,1]
    v_pk_fma_f32 v[238:239], v[166:167], s[42:43], v[174:175] op_sel_hi:[1,0,1]
    v_pk_fma_f32 v[250:251], v[174:175], s[42:43], v[166:167] op_sel_hi:[1,0,1] neg_lo:[0,0,1] neg_hi:[0,0,1]
    v_pk_fma_f32 v[254:255], v[182:183], s[42:43], v[158:159] op_sel_hi:[1,0,1]
    ds_write_b128 v12, v[240:243] offset:18432
    ds_write_b128 v12, v[244:247] offset:27648
    ds_write_b128 v12, v[248:251] offset:18496
    ds_write_b128 v12, v[252:255] offset:27712
    ds_write2st64_b32 v14, v240, v244 offset0:72 offset1:108
    s_waitcnt lgkmcnt(0)
    s_barrier
    ds_read_b128 v[96:99], v13 offset:18496
    ds_read_b128 v[100:103], v13 offset:27712
    ds_read_b128 v[104:107], v13 offset:18432
    ds_read_b128 v[108:111], v13 offset:27648
    ds_read_b32 v4, v13 offset:18512
    ds_read_b32 v5, v13 offset:27728
    ds_read_b32 v6, v13 offset:18448
    ds_read_b32 v7, v13 offset:27664
    s_waitcnt lgkmcnt(0)
    s_nop 0
    v_cndmask_b32 v96, v96, v97, s[44:45]
    v_cndmask_b32 v97, v97, v98, s[44:45]
    v_cndmask_b32 v98, v98, v99, s[44:45]
    v_cndmask_b32 v99, v99, v4, s[44:45]
    v_cndmask_b32 v100, v100, v101, s[44:45]
    v_cndmask_b32 v101, v101, v102, s[44:45]
    v_cndmask_b32 v102, v102, v103, s[44:45]
    v_cndmask_b32 v103, v103, v5, s[44:45]
    v_cndmask_b32 v104, v104, v105, s[44:45]
    v_cndmask_b32 v105, v105, v106, s[44:45]
    v_cndmask_b32 v106, v106, v107, s[44:45]
    v_cndmask_b32 v107, v107, v6, s[44:45]
    v_cndmask_b32 v108, v108, v109, s[44:45]
    v_cndmask_b32 v109, v109, v110, s[44:45]
    v_cndmask_b32 v110, v110, v111, s[44:45]
    v_cndmask_b32 v111, v111, v7, s[44:45]
    v_pk_add_f32 v[224:225], v[224:225], v[98:99] op_sel:[0,1] op_sel_hi:[1,0]
    v_pk_mul_f32 v[240:241], v[184:185], 4.0 op_sel_hi:[1,0]
    v_pk_add_f32 v[226:227], v[226:227], v[96:97] op_sel:[0,1] op_sel_hi:[1,0]
    v_pk_mul_f32 v[242:243], v[186:187], 4.0 op_sel_hi:[1,0]
    v_pk_add_f32 v[228:229], v[228:229], v[102:103] op_sel:[0,1] op_sel_hi:[1,0] neg_lo:[0,1] neg_hi:[0,1]
    v_pk_mul_f32 v[244:245], v[188:189], 4.0 op_sel_hi:[1,0]
    v_pk_add_f32 v[230:231], v[230:231], v[100:101] op_sel:[0,1] op_sel_hi:[1,0] neg_lo:[0,1] neg_hi:[0,1]
    v_pk_mul_f32 v[246:247], v[190:191], 4.0 op_sel_hi:[1,0]
    v_pk_add_f32 v[232:233], v[232:233], v[106:107] op_sel:[0,1] op_sel_hi:[1,0]
    v_pk_mul_f32 v[248:249], v[192:193], 4.0 op_sel_hi:[1,0]
    v_pk_add_f32 v[234:235], v[234:235], v[104:105] op_sel:[0,1] op_sel_hi:[1,0]
    v_pk_mul_f32 v[250:251], v[194:195], 4.0 op_sel_hi:[1,0]
    v_pk_add_f32 v[236:237], v[236:237], v[110:111] op_sel:[0,1] op_sel_hi:[1,0] neg_lo:[0,1] neg_hi:[0,1]
    v_pk_mul_f32 v[252:253], v[196:197], 4.0 op_sel_hi:[1,0]
    v_pk_add_f32 v[238:239], v[238:239], v[108:109] op_sel:[0,1] op_sel_hi:[1,0] neg_lo:[0,1] neg_hi:[0,1]
    v_pk_mul_f32 v[254:255], v[198:199], 4.0 op_sel_hi:[1,0]
    s_barrier
    s_branch K_SPECIAL2_RET
K_POLL2:
    s_mov_b32 s71, 0
K_POLL2_L:
    buffer_load_dwordx4 v[96:99], v148, s[24:27], s93 offen sc1
    buffer_load_dwordx4 v[100:103], v149, s[24:27], s93 offen sc1
    buffer_load_dwordx4 v[104:107], v150, s[24:27], s93 offen sc1
    buffer_load_dwordx4 v[108:111], v151, s[24:27], s93 offen sc1
    s_add_u32 s71, s71, 1
    s_waitcnt vmcnt(0)
    v_xor_b32 v4, v200, v98
    v_xor_b32 v5, v201, v102
    v_xor_b32 v6, v202, v106
    v_xor_b32_e64 v7, v203, v110
    v_or3_b32 v4, v4, v5, v6
    v_or_b32 v4, v4, v7
    v_cmp_ne_u32 vcc, 0, v4
    s_nop 0
    s_cbranch_vccz K_POLL2_OK
    s_cmp_lt_u32 s71, 200000
    s_cbranch_scc1 K_POLL2_L
    s_branch K_POLL2_OK
K_POLL3:
    s_mov_b32 s71, 0
K_POLL3_L:
    s_sleep 0
    buffer_load_dword v4, v210, s[24:27], s51 offen offset:64 sc1
    s_add_u32 s71, s71, 1
    s_waitcnt vmcnt(0)
    v_cmp_ne_u32 vcc, s98, v4
    s_nop 0
    s_cbranch_vccz K_POLL3_OK
    s_cmp_lt_u32 s71, 200000
    s_cbranch_scc1 K_POLL3_L
    s_branch K_POLL3_OK
K_POLL4:
    s_mov_b32 s71, 0
K_POLL4_L:
    s_sleep 2
    buffer_load_dword v8, v13, s[24:27], s70 offen sc1
    s_add_u32 s71, s71, 1
    s_waitcnt vmcnt(0)
    v_cmp_ne_u32 vcc, s35, v8
    s_nop 0
    s_cbranch_vccz K_POLL4_OK
    s_cmp_lt_u32 s71, 200000
    s_cbranch_scc1 K_POLL4_L
    s_branch K_POLL4_OK
K_POLL5:
    s_mov_b32 s71, 0
K_POLL5_L:
    s_sleep 2
    buffer_load_dword v10, v5, s[24:27], s70 offen sc1
    s_add_u32 s71, s71, 1
    s_waitcnt vmcnt(0)
    v_cmp_ne_u32 vcc, s98, v10
    s_nop 0
    s_cbranch_vccz K_POLL5_OK
    s_cmp_lt_u32 s71, 200000
    s_cbranch_scc1 K_POLL5_L
    s_branch K_POLL5_OK
K_POLL6:
    s_mov_b32 s71, 0
K_POLL6_L:
    s_sleep 2
    buffer_load_dword v6, v9, s[24:27], s70 offen sc1
    s_add_u32 s71, s71, 1
    s_waitcnt vmcnt(0)
    v_cmp_ne_u32 vcc, s98, v6
    s_nop 0
    s_cbranch_vccz K_POLL6_OK
    s_cmp_lt_u32 s71, 200000
    s_cbranch_scc1 K_POLL6_L
    s_branch K_POLL6_OK
K_HFAR:
    buffer_store_dwordx4 v[64:67], v24, s[28:31], s68 offen sc1
    buffer_store_dwordx4 v[80:83], v24, s[28:31], s69 offen sc1
    v_mfma_f32_16x16x32_bf16 v[32:35], v[64:67], v[152:155], 0
    ds_read_b128 v[168:171], v21 offset:0
    buffer_store_dwordx4 v[68:71], v25, s[28:31], s68 offen sc1
    v_mfma_f32_16x16x32_bf16 v[48:51], v[80:83], v[152:155], 0
    ds_read_b128 v[172:175], v21 offset:2048
    v_mfma_f32_16x16x32_bf16 v[36:39], v[64:67], v[156:159], 0
    ds_read_b128 v[176:179], v21 offset:4096
    buffer_store_dwordx4 v[84:87], v25, s[28:31], s69 offen sc1
    v_mfma_f32_16x16x32_bf16 v[52:55], v[80:83], v[156:159], 0
    ds_read_b128 v[180:183], v21 offset:6144
    v_mfma_f32_16x16x32_bf16 v[40:43], v[64:67], v[160:163], 0
    v_mfma_f32_16x16x32_bf16 v[56:59], v[80:83], v[160:163], 0
    buffer_store_dwordx4 v[72:75], v26, s[28:31], s68 offen sc1
    v_mfma_f32_16x16x32_bf16 v[44:47], v[64:67], v[164:167], 0
    v_mfma_f32_16x16x32_bf16 v[60:63], v[80:83], v[164:167], 0
    s_waitcnt lgkmcnt(0)
    v_mfma_f32_16x16x32_bf16 v[32:35], v[68:71], v[168:171], v[32:35]
    ds_read_b128 v[152:155], v22 offset:0
    buffer_store_dwordx4 v[88:91], v26, s[28:31], s69 offen sc1
    v_mfma_f32_16x16x32_bf16 v[48:51], v[84:87], v[168:171], v[48:51]
    ds_read_b128 v[156:159], v22 offset:2048
    v_mfma_f32_16x16x32_bf16 v[36:39], v[68:71], v[172:175], v[36:39]
    ds_read_b128 v[160:163], v22 offset:4096
    buffer_store_dwordx4 v[76:79], v27, s[28:31], s68 offen sc1
    v_mfma_f32_16x16x32_bf16 v[52:55], v[84:87], v[172:175], v[52:55]
    ds_read_b128 v[164:167], v22 offset:6144
    v_mfma_f32_16x16x32_bf16 v[40:43], v[68:71], v[176:179], v[40:43]
    v_mfma_f32_16x16x32_bf16 v[56:59], v[84:87], v[176:179], v[56:59]
    buffer_store_dwordx4 v[92:95], v27, s[28:31], s69 offen sc1
    v_mfma_f32_16x16x32_bf16 v[44:47], v[68:71], v[180:183], v[44:47]
    v_mfma_f32_16x16x32_bf16 v[60:63], v[84:87], v[180:183], v[60:63]
    s_branch K_HFAR_RET
K_CODE_END:
.section .rodata,"a"
.p2align 6
.amdhsa_kernel gated_mix__spectral_gfnet__ssm_conv_s5__prompt_kernel
  .amdhsa_next_free_vgpr 512
  .amdhsa_next_free_sgpr 102
  .amdhsa_accum_offset 256
  .amdhsa_group_segment_fixed_size 0
  .amdhsa_kernarg_size 128
  .amdhsa_user_sgpr_count 2
  .amdhsa_user_sgpr_kernarg_segment_ptr 1
  .amdhsa_system_sgpr_workgroup_id_x 1
.end_amdhsa_kernel
```

```asm
; @launch grid=(256,1,1) block=(256,1,1) lds=163840
.amdgcn_target "amdgcn-amd-amdhsa--gfx950"
.text
.globl gated_mix__spectral_gfnet__ssm_conv_s5__prompt_kernel
.p2align 8
.type gated_mix__spectral_gfnet__ssm_conv_s5__prompt_kernel,@function
gated_mix__spectral_gfnet__ssm_conv_s5__prompt_kernel:
    s_load_dwordx2 s[8:9], s[0:1], 0
    s_load_dwordx2 s[60:61], s[0:1], 120
    s_cmp_ge_u32 s2, 256
    s_cbranch_scc1 K_END
    s_getpc_b64 s[28:29]
K_PC:
    s_mov_b32 s30, K_CODE_END-K_PC
    s_mov_b32 s31, 0x00020000
    s_lshr_b32 s38, s2, 3
    s_mul_i32 s38, s38, 1280
    v_lshl_add_u32 v4, v0, 3, s38
    v_lshrrev_b32 v3, 6, v0
    buffer_load_dword v255, v4, s[28:31], 0 offen
    s_load_dwordx8 s[52:59], s[0:1], 32
    s_load_dwordx4 s[44:47], s[0:1], 8
    s_load_dwordx8 s[80:87], s[0:1], 64
    s_load_dwordx4 s[88:91], s[0:1], 96
    v_readfirstlane_b32 s34, v3
    v_and_b32 v1, 15, v0
    v_bfe_u32 v2, v0, 4, 2
    s_and_b32 s38, s2, 3
    s_bfe_u32 s39, s2, 0x20003
    s_lshl2_add_u32 s32, s38, s39
    s_bfe_u32 s38, s2, 0x10002
    s_lshr_b32 s39, s2, 5
    s_lshl3_add_u32 s33, s38, s39
    s_and_b32 s6, s34, 1
    s_lshr_b32 s41, s34, 1
    s_lshl1_add_u32 s38, s32, s6
    s_lshl_b32 s38, s38, 5
    s_add_u32 s38, s38, s33
    s_lshl1_add_u32 s68, s38, s41
    s_lshl_b32 s68, s68, 11
    s_add_u32 s69, s68, 65536
    v_lshlrev_b32 v5, 9, v2
    v_lshl_add_u32 v29, v1, 3, v5
    s_mov_b32 s10, 0x400000
    s_mov_b32 s11, s31
    s_waitcnt lgkmcnt(0)
    buffer_load_dwordx2 v[96:97], v29, s[8:11], s68 offen offset:0
    buffer_load_dwordx2 v[98:99], v29, s[8:11], s68 offen offset:128
    v_cmp_gt_u32_e64 vcc, 16, v0
    buffer_load_dwordx2 v[100:101], v29, s[8:11], s68 offen offset:256
    v_lshlrev_b32 v30, 2, v0
    s_lshl4_add_u32 s4, s32, s33
    s_lshl_b32 s37, s34, 12
    v_cndmask_b32 v30, 2.0, v30, vcc
    v_and_b32 v0, 63, v0
    v_lshlrev_b32 v3, 4, v0
    buffer_load_dwordx2 v[102:103], v29, s[8:11], s68 offen offset:384
    s_lshl_b32 s63, s34, 4
    s_lshl2_add_u32 s94, s6, s41
    v_and_b32 v6, 7, v0
    v_xor_b32 v6, v6, v2
    v_lshlrev_b32 v6, 4, v6
    v_and_b32 v8, 32, v0
    v_bfe_u32 v9, v0, 3, 1
    buffer_load_dwordx2 v[104:105], v29, s[8:11], s69 offen offset:0
    v_lshl_add_u32 v8, v9, 4, v8
    v_bfe_u32 v9, v0, 4, 1
    s_lshl_b32 s38, s32, 5
    s_add_u32 s38, s38, s34
    s_lshl_b32 s38, s38, 2
    v_add3_u32 v8, v8, v9, s38
    v_lshl_add_u32 v16, v8, 11, v6
    buffer_load_dwordx2 v[106:107], v29, s[8:11], s69 offen offset:128
    v_lshrrev_b32 v9, 3, v0
    s_lshl1_add_u32 s38, s33, s6
    s_lshl_b32 s38, s38, 5
    v_add_u32_e64 v9, s38, v9
    v_lshl_add_u32 v20, v9, 11, v6
    v_xor_b32 v8, 64, v16
    v_xor_b32 v9, 64, v20
    buffer_load_dwordx2 v[108:109], v29, s[8:11], s69 offen offset:256
    v_add_u32 v17, 130048, v8
    v_add_u32 v18, 2048, v16
    v_add_u32 v19, 132096, v8
    v_add_u32 v21, 15360, v9
    v_add_u32 v22, 30720, v20
    v_add_u32 v23, 46080, v9
    s_add_u32 s38, s32, s33
    buffer_load_dwordx2 v[110:111], v29, s[8:11], s69 offen offset:384
    s_and_b32 s38, s38, 3
    s_mov_b32 s66, 2253603344
    s_mov_b32 s67, 4275817111
    s_cmp_eq_u32 s38, 1
    s_cselect_b32 s66, 2539672353, s66
    s_cselect_b32 s67, 3488144292, s67
    s_cmp_eq_u32 s38, 2
    s_cselect_b32 s66, 1417023538, s66
    s_cselect_b32 s67, 3707672762, s67
    s_cmp_eq_u32 s38, 3
    s_cselect_b32 s66, 1699160323, s66
    s_cselect_b32 s67, 3989809547, s67
    s_and_b32 s38, s2, 3
    s_mul_i32 s38, s38, 0x44444444
    s_xor_b32 s66, s66, s38
    s_xor_b32 s67, s67, s38
    s_mov_b32 s14, 0x200000
    s_mov_b32 s15, s31
    s_nop 0
    s_cmp_lt_u32 s34, 2
    s_cselect_b64 s[12:13], s[56:57], s[58:59]
    s_cselect_b64 s[28:29], s[88:89], s[86:87]
    s_mov_b32 s30, 2048
    s_lshl_b32 s39, s34, 10
    s_add_u32 m0, s39, 147712
    s_lshl_b32 s38, s6, 10
    buffer_load_dwordx4 v3, s[28:31], s38 offen lds
    v_cvt_f32_u32 v249, v1
    v_cvt_f32_u32_e64 v250, v2
    v_mul_f32 v251, 0x3d800000, v249
    v_mul_f32 v250, 4.0, v250
    v_mul_f32 v248, v250, v251
    v_fmamk_f32 v4, v251, 0x00000000, v248
    v_fmamk_f32 v5, v251, 0x3f800000, v248
    v_fmamk_f32 v6, v251, 0x40000000, v248
    s_bfe_u32 s36, s66, 262144
    s_add_u32 m0, s37, 16384
    s_lshl_b32 s36, s36, 7
    buffer_load_dwordx4 v20, s[12:15], s36 offen offset:0  lds
    buffer_load_dwordx4 v21, s[12:15], s36 offen offset:1024  lds
    buffer_load_dwordx4 v22, s[12:15], s36 offen offset:2048  lds
    buffer_load_dwordx4 v23, s[12:15], s36 offen offset:3072  lds
    v_fmamk_f32 v7, v251, 0x40400000, v248
    v_cos_f32 v8, v4
    v_cos_f32 v9, v5
    v_cos_f32 v10, v6
    v_cos_f32 v11, v7
    v_sin_f32 v12, v4
    v_sin_f32 v13, v5
    v_sin_f32 v14, v6
    v_sin_f32_e64 v15, v7
    v_cvt_pk_bf16_f32 v4, v8, v12
    v_cvt_pk_bf16_f32 v5, -v12, v8
    v_accvgpr_write_b32 a224, v4
    v_accvgpr_write_b32 a228, v5
    v_cvt_pk_bf16_f32 v4, v9, v13
    v_cvt_pk_bf16_f32 v5, -v13, v9
    v_accvgpr_write_b32 a225, v4
    v_accvgpr_write_b32 a229, v5
    v_cvt_pk_bf16_f32 v4, v10, v14
    v_cvt_pk_bf16_f32 v5, -v14, v10
    v_accvgpr_write_b32 a226, v4
    v_accvgpr_write_b32 a230, v5
    v_cvt_pk_bf16_f32 v4, v11, v15
    v_cvt_pk_bf16_f32 v5, -v15, v11
    v_accvgpr_write_b32 a227, v4
    v_accvgpr_write_b32 a231, v5
    v_fmamk_f32 v4, v251, 0x3f000000, v248
    v_fmamk_f32 v5, v251, 0x3fc00000, v248
    v_fmamk_f32 v6, v251, 0x40200000, v248
    v_fmamk_f32 v7, v251, 0x40600000, v248
    v_cos_f32 v8, v4
    v_cos_f32 v9, v5
    v_cos_f32_e64 v10, v6
    s_add_u32 s40, s60, 22446080
    s_addc_u32 s41, s61, 0
    s_load_dword s62, s[40:41], 0
    v_cos_f32 v11, v7
    v_sin_f32 v12, v4
    v_sin_f32 v13, v5
    v_sin_f32 v14, v6
    v_sin_f32 v15, v7
    v_cvt_pk_bf16_f32 v4, v8, v12
    v_cvt_pk_bf16_f32 v5, -v12, v8
    v_accvgpr_write_b32 a248, v4
    v_accvgpr_write_b32 a252, v5
    v_cvt_pk_bf16_f32 v4, v9, v13
    v_cvt_pk_bf16_f32 v5, -v13, v9
    v_accvgpr_write_b32 a249, v4
    v_accvgpr_write_b32 a253, v5
    v_cvt_pk_bf16_f32 v4, v10, v14
    v_cvt_pk_bf16_f32 v5, -v14, v10
    v_accvgpr_write_b32 a250, v4
    v_accvgpr_write_b32 a254, v5
    v_cvt_pk_bf16_f32 v4, v11, v15
    v_cvt_pk_bf16_f32 v5, -v15, v11
    v_accvgpr_write_b32 a251, v4
    v_accvgpr_write_b32 a255, v5
    v_mul_f32 v251, 0x3d800000, v251
    v_mul_f32 v248, 0x3d800000, v248
    v_fmamk_f32 v4, v251, 0x00000000, v248
    v_fmamk_f32 v5, v251, 0x3f800000, v248
    v_fmamk_f32 v6, v251, 0x40000000, v248
    v_fmamk_f32 v7, v251, 0x40400000, v248
    v_cos_f32 v232, v4
    v_cos_f32 v233, v5
    v_cos_f32 v234, v6
    v_cos_f32 v235, v7
    v_sin_f32 v240, v4
    v_sin_f32 v241, v5
    v_sin_f32 v242, v6
    v_sin_f32 v243, v7
    v_fmamk_f32 v4, v251, 0x3f000000, v248
    v_fmamk_f32 v5, v251, 0x3fc00000, v248
    v_fmamk_f32 v6, v251, 0x40200000, v248
    v_fmamk_f32 v7, v251, 0x40600000, v248
    v_cos_f32 v236, v4
    v_cos_f32 v237, v5
    v_cos_f32 v238, v6
    v_cos_f32 v239, v7
    v_sin_f32 v244, v4
    v_sin_f32 v245, v5
    v_sin_f32 v246, v6
    v_sin_f32 v247, v7
    s_mov_b64 s[24:25], s[60:61]
    s_mov_b32 s26, 33554432
    s_mov_b32 s27, 0x00020000
    v_lshrrev_b32 v15, 1, v1
    v_xor_b32 v15, v15, v2
    v_lshlrev_b32 v15, 4, v15
    v_lshl_add_u32 v24, v1, 7, v15
    v_xor_b32 v25, 64, v24
    s_lshl_b32 s76, s34, 11
    s_add_u32 s76, s76, 16384
    v_add_u32 v26, s76, v24
    v_add_u32 v27, s76, v25
    v_add_u32 v148, 0x10000, v24
    v_add_u32 v149, 0x10000, v25
    v_add_u32 v150, 0x10000, v26
    v_add_u32 v151, 0x10000, v27
    s_and_b32 s76, s34, 2
    s_lshl1_add_u32 s76, s76, s6
    s_mul_i32 s76, s76, 2080
    s_add_u32 s76, s76, 131072
    v_lshl_add_u32 v15, v2, 6, v1
    v_lshl_add_u32 v252, v15, 3, s76
    v_sub_u32 v15, 728, v15
    v_lshl_add_u32 v253, v15, 3, s76
    v_lshrrev_b32 v7, 2, v0
    v_add_u32 v7, s63, v7
    v_and_b32 v15, 3, v0
    v_lshlrev_b32 v12, 4, v15
    v_mul_u32_u24 v229, 4160, v15
    v_lshl_add_u32 v229, v7, 3, v229
    v_add_u32 v229, 131072, v229
    v_lshrrev_b32_e64 v14, 2, v0
    v_lshl_add_u32 v230, v14, 8, v12
    v_and_b32_e64 v14, 3, v14
    v_lshl_add_u32 v231, v14, 10, v12
    v_lshl_add_u32 v231, v2, 19, v231
    v_and_b32 v15, 1, v15
    v_lshlrev_b32 v15, 11, v15
    v_cmp_eq_u32_e64 vcc, 0, v7
    v_add_u32 v254, 147712, v29
    s_nop 0
    v_cndmask_b32 v15, 0, v15, vcc
    v_add_u32_e64 v228, v229, v15
    v_accvgpr_write_b32 a136, v232
    v_accvgpr_write_b32 a144, v240
    v_accvgpr_write_b32 a137, v233
    v_accvgpr_write_b32 a145, v241
    v_accvgpr_write_b32 a138, v234
    v_accvgpr_write_b32 a146, v242
    v_accvgpr_write_b32 a139, v235
    v_accvgpr_write_b32 a147, v243
    v_fma_f32 v251, v249, 2.0, 1.0
    v_mul_f32 v251, 0x3d000000, v251
    v_mul_f32_e64 v248, v250, v251
    v_fmamk_f32 v4, v251, 0x00000000, v248
    v_fmamk_f32 v5, v251, 0x3f800000, v248
    v_fmamk_f32 v6, v251, 0x40000000, v248
    v_fmamk_f32 v7, v251, 0x40400000, v248
    v_cos_f32 v8, v4
    v_cos_f32 v9, v5
    v_cos_f32 v10, v6
    v_cos_f32 v11, v7
    v_sin_f32 v12, v4
    v_sin_f32 v13, v5
    v_sin_f32 v14, v6
    v_sin_f32 v15, v7
    v_cvt_pk_bf16_f32 v4, v8, v12
    v_cvt_pk_bf16_f32 v5, -v12, v8
    v_accvgpr_write_b32 a232, v4
    v_accvgpr_write_b32 a236, v5
    v_cvt_pk_bf16_f32 v4, v9, v13
    v_cvt_pk_bf16_f32 v5, -v13, v9
    v_accvgpr_write_b32 a233, v4
    v_accvgpr_write_b32 a237, v5
    v_cvt_pk_bf16_f32 v4, v10, v14
    v_cvt_pk_bf16_f32 v5, -v14, v10
    v_accvgpr_write_b32 a234, v4
    v_accvgpr_write_b32 a238, v5
    v_cvt_pk_bf16_f32 v4, v11, v15
    v_cvt_pk_bf16_f32 v5, -v15, v11
    v_accvgpr_write_b32 a235, v4
    v_accvgpr_write_b32 a239, v5
    v_cvt_pk_bf16_f32 v4, -v8, -v12
    v_cvt_pk_bf16_f32 v5, v12, -v8
    v_accvgpr_write_b32 a240, v4
    v_accvgpr_write_b32 a244, v5
    v_cvt_pk_bf16_f32 v4, -v9, -v13
    v_cvt_pk_bf16_f32 v5, v13, -v9
    v_accvgpr_write_b32 a241, v4
    v_accvgpr_write_b32 a245, v5
    v_cvt_pk_bf16_f32 v4, -v10, -v14
    v_cvt_pk_bf16_f32 v5, v14, -v10
    v_accvgpr_write_b32 a242, v4
    v_accvgpr_write_b32 a246, v5
    v_cvt_pk_bf16_f32 v4, -v11, -v15
    v_cvt_pk_bf16_f32 v5, v15, -v11
    v_accvgpr_write_b32 a243, v4
    v_accvgpr_write_b32 a247, v5
    v_mul_f32 v251, 0x3d800000, v251
    v_mul_f32 v248, 0x3d800000, v248
    v_fmamk_f32 v4, v251, 0x00000000, v248
    v_fmamk_f32 v5, v251, 0x3f800000, v248
    v_fmamk_f32 v6, v251, 0x40000000, v248
    v_fmamk_f32 v7, v251, 0x40400000, v248
    v_cos_f32 v8, v4
    v_cos_f32 v9, v5
    v_cos_f32 v10, v6
    v_cos_f32 v11, v7
    v_sin_f32 v12, v4
    v_sin_f32 v13, v5
    v_sin_f32 v14, v6
    v_sin_f32 v15, v7
    v_accvgpr_write_b32 a140, v8
    v_accvgpr_write_b32 a148, v12
    v_accvgpr_write_b32 a141, v9
    v_accvgpr_write_b32 a149, v13
    v_accvgpr_write_b32 a142, v10
    v_accvgpr_write_b32 a150, v14
    v_accvgpr_write_b32 a143, v11
    v_accvgpr_write_b32 a151, v15
    v_add_u32 v251, s63, v1
    v_cvt_f32_u32 v251, v251
    v_and_b32_e64 v147, 1, v1
    v_mul_f32 v251, 0x3c800000, v251
    v_mul_u32_u24 v147, 0x8000, v147
    v_mul_f32_e64 v248, v250, v251
    v_lshl_or_b32 v147, v147, 16, v147
    v_fmamk_f32 v4, v251, 0x00000000, v248
    v_fmamk_f32 v5, v251, 0x3f800000, v248
    v_fmamk_f32 v6, v251, 0x40000000, v248
    v_fmamk_f32 v7, v251, 0x40400000, v248
    v_cos_f32 v8, v4
    v_cos_f32 v9, v5
    s_mov_b64 s[16:17], s[44:45]
    s_mov_b32 s18, 2101248
    s_mov_b32 s19, 0x00020000
    s_mov_b64 s[20:21], s[46:47]
    s_mov_b32 s22, 2101248
    s_mov_b32 s23, 0x00020000
    s_lshr_b32 s38, s2, 6
    s_and_b32 s39, s2, 3
    s_lshl2_add_u32 s38, s38, s39
    s_lshl2_add_u32 s38, s38, s34
    s_bfe_u32 s39, s2, 0x10005
    s_bfe_u32 s40, s2, 0x20002
    s_lshl2_add_u32 s39, s39, s40
    s_bfe_u32 s40, s2, 0x10004
    s_lshl1_add_u32 s39, s39, s40
    s_lshl_b32 s39, s39, 7
    s_add_u32 s38, s38, s39
    s_mul_i32 s44, s38, 1026
    s_andn2_b32 s44, s44, 3
    s_add_u32 s45, s44, 65664
    s_sub_u32 s38, 2048, s38
    s_and_b32 s39, s38, 2047
    s_mul_i32 s39, s39, 1026
    s_add_u32 s39, s39, 514
    s_andn2_b32 s46, s39, 3
    s_mul_i32 s39, s38, 1026
    s_sub_u32 s39, s39, 65150
    s_andn2_b32 s47, s39, 3
    v_lshlrev_b32 v192, 3, v0
    v_sub_u32 v193, 504, v192
    s_lshl_b32 s38, s34, 2
    v_add_u32 v184, s38, v1
    v_and_b32_e64 v184, 15, v184
    v_and_or_b32 v184, v0, 48, v184
    s_lshl_b32 s38, s34, 10
    s_add_u32 s38, s38, 131072
    v_lshl_add_u32 v194, v184, 4, s38
    v_lshrrev_b32 v185, 2, v0
    v_and_b32_e64 v186, 3, v0
    v_lshl_add_u32 v184, v186, 2, v185
    v_and_b32_e64 v184, 15, v184
    v_lshl_add_u32 v184, v186, 6, v184
    s_lshl_b32 s38, s34, 8
    s_add_u32 s38, s38, 131072
    v_lshl_add_u32 v195, v184, 4, s38
    s_mov_b32 s30, 0x800000
    s_add_u32 s28, s60, 25165824
    s_addc_u32 s29, s61, 0
    s_waitcnt vmcnt(9)
    v_swap_b32 v97, v98
    v_swap_b32 v101, v102
    v_swap_b32 v98, v100
    v_swap_b32 v99, v101
    s_waitcnt vmcnt(5)
    v_swap_b32 v105, v106
    v_swap_b32 v109, v110
    v_swap_b32 v106, v108
    v_swap_b32 v107, v109
    v_mfma_f32_16x16x32_bf16 v[32:35], v[96:99], a[224:227], 0
    buffer_load_dwordx3 v[196:198], v192, s[16:19], s44 offen
    buffer_load_dwordx3 v[200:202], v192, s[20:23], s44 offen
    s_and_b32 s38, s33, 3
    s_lshr_b32 s39, s32, 2
    v_mfma_f32_16x16x32_bf16 v[36:39], v[96:99], a[228:231], 0
    s_lshl2_add_u32 s38, s38, s39
    s_and_b32 s39, s32, 3
    v_mfma_f32_16x16x32_bf16 v[40:43], v[100:103], a[224:227], 0
    s_lshl2_add_u32 s38, s38, s39
    s_lshl_b32 s39, s34, 7
    v_mfma_f32_16x16x32_bf16 v[44:47], v[100:103], a[228:231], 0
    s_add_u32 s38, s38, s39
    s_lshl_b32 s38, s38, 6
    v_mfma_f32_16x16x32_bf16 v[48:51], v[104:107], a[224:227], 0
    s_lshr_b32 s39, s33, 2
    s_add_u32 s38, s38, s39
    v_mfma_f32_16x16x32_bf16 v[52:55], v[104:107], a[228:231], 0
    s_lshl_b32 s68, s38, 6
    s_lshr_b32 s39, s34, 1
    v_mfma_f32_16x16x32_bf16 v[56:59], v[108:111], a[224:227], 0
    s_lshl1_add_u32 s38, s33, s39
    s_lshr_b32 s39, s38, 4
    v_mfma_f32_16x16x32_bf16 v[60:63], v[108:111], a[228:231], 0
    s_lshl1_add_u32 s39, s39, s6
    s_lshl2_add_u32 s41, s32, s39
    buffer_load_dwordx3 v[204:206], v193, s[16:19], s46 offen
    buffer_load_dwordx3 v[208:210], v193, s[20:23], s46 offen
    s_and_b32 s40, s38, 15
    s_lshl4_add_u32 s41, s41, s40
    s_lshl_b32 s41, s41, 6
    s_nop 0
    v_pk_mul_f32 v[184:185], v[32:33], v[232:233]
    v_pk_mul_f32 v[186:187], v[36:37], v[232:233]
    v_pk_fma_f32 v[184:185], v[36:37], v[240:241], v[184:185]
    v_pk_fma_f32 v[186:187], v[32:33], v[240:241], v[186:187] neg_lo:[1,0,0] neg_hi:[1,0,0]
    v_pk_mul_f32 v[188:189], v[34:35], v[234:235]
    v_pk_mul_f32 v[190:191], v[38:39], v[234:235]
    v_pk_fma_f32 v[188:189], v[38:39], v[242:243], v[188:189]
    v_pk_fma_f32 v[190:191], v[34:35], v[242:243], v[190:191] neg_lo:[1,0,0] neg_hi:[1,0,0]
    v_cvt_pk_bf16_f32 v152, v184, v186
    v_cvt_pk_bf16_f32 v153, v185, v187
    v_cvt_pk_bf16_f32 v154, v188, v190
    v_cvt_pk_bf16_f32 v155, v189, v191
    v_pk_mul_f32 v[184:185], v[40:41], v[236:237]
    v_pk_mul_f32 v[186:187], v[44:45], v[236:237]
    v_pk_fma_f32 v[184:185], v[44:45], v[244:245], v[184:185]
    v_pk_fma_f32 v[186:187], v[40:41], v[244:245], v[186:187] neg_lo:[1,0,0] neg_hi:[1,0,0]
    v_pk_mul_f32 v[188:189], v[42:43], v[238:239]
    v_pk_mul_f32 v[190:191], v[46:47], v[238:239]
    v_pk_fma_f32 v[188:189], v[46:47], v[246:247], v[188:189]
    v_pk_fma_f32 v[190:191], v[42:43], v[246:247], v[190:191] neg_lo:[1,0,0] neg_hi:[1,0,0]
    v_cvt_pk_bf16_f32 v156, v184, v186
    v_cvt_pk_bf16_f32 v157, v185, v187
    v_cvt_pk_bf16_f32 v158, v188, v190
    v_cvt_pk_bf16_f32 v159, v189, v191
    v_pk_mul_f32 v[184:185], v[48:49], v[232:233]
    v_pk_mul_f32 v[186:187], v[52:53], v[232:233]
    v_pk_fma_f32 v[184:185], v[52:53], v[240:241], v[184:185]
    buffer_load_dwordx3 v[212:214], v192, s[16:19], s45 offen
    buffer_load_dwordx3 v[216:218], v192, s[20:23], s45 offen
    v_pk_fma_f32 v[186:187], v[48:49], v[240:241], v[186:187] neg_lo:[1,0,0] neg_hi:[1,0,0]
    v_pk_mul_f32 v[188:189], v[50:51], v[234:235]
    v_pk_mul_f32 v[190:191], v[54:55], v[234:235]
    v_pk_fma_f32 v[188:189], v[54:55], v[242:243], v[188:189]
    v_pk_fma_f32 v[190:191], v[50:51], v[242:243], v[190:191] neg_lo:[1,0,0] neg_hi:[1,0,0]
    v_cvt_pk_bf16_f32 v160, v184, v186
    v_cvt_pk_bf16_f32 v161, v185, v187
    v_cvt_pk_bf16_f32 v162, v188, v190
    v_cvt_pk_bf16_f32 v163, v189, v191
    v_pk_mul_f32 v[184:185], v[56:57], v[236:237]
    v_pk_mul_f32 v[186:187], v[60:61], v[236:237]
    v_pk_fma_f32 v[184:185], v[60:61], v[244:245], v[184:185]
    v_pk_fma_f32 v[186:187], v[56:57], v[244:245], v[186:187] neg_lo:[1,0,0] neg_hi:[1,0,0]
    v_pk_mul_f32 v[188:189], v[58:59], v[238:239]
    v_pk_mul_f32 v[190:191], v[62:63], v[238:239]
    v_pk_fma_f32 v[188:189], v[62:63], v[246:247], v[188:189]
    v_pk_fma_f32 v[190:191], v[58:59], v[246:247], v[190:191] neg_lo:[1,0,0] neg_hi:[1,0,0]
    v_cvt_pk_bf16_f32 v164, v184, v186
    v_cvt_pk_bf16_f32 v165, v185, v187
    v_cvt_pk_bf16_f32 v166, v188, v190
    v_cvt_pk_bf16_f32 v167, v189, v191
    v_mfma_f32_16x16x32_bf16 v[64:67], a[224:227], v[152:155], 0
    s_add_u32 s69, s41, 22282240
    s_lshl_b32 s41, s32, 6
    v_mfma_f32_16x16x32_bf16 v[68:71], a[228:231], v[152:155], 0
    s_add_u32 s39, s39, s41
    buffer_load_dwordx3 v[220:222], v193, s[16:19], s47 offen
    buffer_load_dwordx3 v[224:226], v193, s[20:23], s47 offen
    s_and_b32 s40, s38, 3
    v_mfma_f32_16x16x32_bf16 v[72:75], a[248:251], v[156:159], 0
    s_lshl2_add_u32 s39, s39, s40
    s_bfe_u32 s40, s38, 0x20002
    v_mfma_f32_16x16x32_bf16 v[76:79], a[252:255], v[156:159], 0
    s_lshl2_add_u32 s39, s39, s40
    s_lshl_b32 s39, s39, 8
    v_mfma_f32_16x16x32_bf16 v[80:83], a[224:227], v[160:163], 0
    s_add_u32 s75, s39, 13631488
    s_getreg_b32 s96, hwreg(HW_REG_XCC_ID, 0, 4)
    v_mfma_f32_16x16x32_bf16 v[84:87], a[228:231], v[160:163], 0
    s_and_b32 s38, s2, 31
    s_lshl_b32 s38, s38, 10
    v_mfma_f32_16x16x32_bf16 v[88:91], a[248:251], v[164:167], 0
    s_add_u32 s51, s38, 22364160
    s_and_b32 s38, s2, 0xe0
    v_mfma_f32_16x16x32_bf16 v[92:95], a[252:255], v[164:167], 0
    s_lshl2_add_u32 s70, s38, s51
    v_pk_add_f32 v[32:33], v[64:65], v[72:73]
    v_pk_add_f32 v[40:41], v[64:65], v[72:73] neg_lo:[0,1] neg_hi:[0,1]
    v_pk_add_f32 v[34:35], v[66:67], v[74:75]
    v_pk_add_f32 v[42:43], v[66:67], v[74:75] neg_lo:[0,1] neg_hi:[0,1]
    v_pk_add_f32 v[36:37], v[68:69], v[76:77]
    v_pk_add_f32 v[44:45], v[68:69], v[76:77] neg_lo:[0,1] neg_hi:[0,1]
    v_pk_add_f32 v[38:39], v[70:71], v[78:79]
    v_pk_add_f32 v[46:47], v[70:71], v[78:79] neg_lo:[0,1] neg_hi:[0,1]
    v_pk_add_f32 v[48:49], v[80:81], v[88:89]
    v_pk_add_f32 v[56:57], v[80:81], v[88:89] neg_lo:[0,1] neg_hi:[0,1]
    v_pk_add_f32 v[50:51], v[82:83], v[90:91]
    v_pk_add_f32 v[58:59], v[82:83], v[90:91] neg_lo:[0,1] neg_hi:[0,1]
    v_pk_add_f32 v[52:53], v[84:85], v[92:93]
    v_pk_add_f32 v[60:61], v[84:85], v[92:93] neg_lo:[0,1] neg_hi:[0,1]
    v_pk_add_f32 v[54:55], v[86:87], v[94:95]
    v_pk_add_f32 v[62:63], v[86:87], v[94:95] neg_lo:[0,1] neg_hi:[0,1]
    v_cvt_pk_bf16_f32 v168, v32, v36
    v_cvt_pk_bf16_f32 v169, v48, v52
    ds_write_b64 v252, v[168:169] offset:0
    v_cvt_pk_bf16_f32 v170, v33, v37
    v_cvt_pk_bf16_f32 v171, v49, v53
    ds_write_b64 v252, v[170:171] offset:128
    v_cvt_pk_bf16_f32 v172, v34, v38
    v_cvt_pk_bf16_f32 v173, v50, v54
    ds_write_b64 v252, v[172:173] offset:256
    v_cvt_pk_bf16_f32 v174, v35, v39
    v_cvt_pk_bf16_f32 v175, v51, v55
    ds_write_b64 v252, v[174:175] offset:384
    v_cvt_pk_bf16_f32 v176, v40, -v44
    v_cvt_pk_bf16_f32 v177, v56, -v60
    ds_write_b64 v253, v[176:177] offset:384
    v_cvt_pk_bf16_f32 v178, v41, -v45
    v_cvt_pk_bf16_f32 v179, v57, -v61
    ds_write_b64 v253, v[178:179] offset:256
    v_cvt_pk_bf16_f32 v180, v42, -v46
    v_cvt_pk_bf16_f32 v181, v58, -v62
    ds_write_b64 v253, v[180:181] offset:128
    v_cvt_pk_bf16_f32 v182, v43, -v47
    v_cvt_pk_bf16_f32 v183, v59, -v63
    ds_write_b64 v253, v[182:183] offset:0
    v_lshlrev_b32_e64 v64, 16, v96
    v_and_b32 v68, 0xffff0000, v96
    v_lshlrev_b32_e64 v65, 16, v97
    v_and_b32 v69, 0xffff0000, v97
    v_lshlrev_b32_e64 v66, 16, v98
    v_and_b32 v70, 0xffff0000, v98
    v_lshlrev_b32_e64 v67, 16, v99
    v_and_b32 v71, 0xffff0000, v99
    v_lshlrev_b32_e64 v72, 16, v100
    v_and_b32 v76, 0xffff0000, v100
    v_lshlrev_b32_e64 v73, 16, v101
    v_and_b32 v77, 0xffff0000, v101
    v_lshlrev_b32_e64 v74, 16, v102
    v_and_b32 v78, 0xffff0000, v102
    v_lshlrev_b32_e64 v75, 16, v103
    v_and_b32 v79, 0xffff0000, v103
    v_lshlrev_b32_e64 v80, 16, v104
    v_and_b32 v84, 0xffff0000, v104
    v_lshlrev_b32_e64 v81, 16, v105
    v_and_b32 v85, 0xffff0000, v105
    v_lshlrev_b32_e64 v82, 16, v106
    v_and_b32 v86, 0xffff0000, v106
    v_lshlrev_b32_e64 v83, 16, v107
    v_and_b32 v87, 0xffff0000, v107
    v_lshlrev_b32_e64 v88, 16, v108
    v_and_b32 v92, 0xffff0000, v108
    v_lshlrev_b32_e64 v89, 16, v109
    v_and_b32 v93, 0xffff0000, v109
    v_lshlrev_b32_e64 v90, 16, v110
    v_and_b32 v94, 0xffff0000, v110
    v_lshlrev_b32_e64 v91, 16, v111
    v_and_b32 v95, 0xffff0000, v111
    s_waitcnt lgkmcnt(0) vmcnt(12)
    s_barrier
    ds_read_b64 v[112:113], v254 offset:0
    ds_read_b64 v[114:115], v254 offset:128
    ds_read_b64 v[116:117], v254 offset:256
    ds_read_b64 v[118:119], v254 offset:384
    ds_read_b64 v[120:121], v254 offset:2048
    ds_read_b64 v[122:123], v254 offset:2176
    ds_read_b64 v[124:125], v254 offset:2304
    ds_read_b64 v[126:127], v254 offset:2432
    ds_read_b64 v[232:233], v228 offset:0
    ds_read_b64 v[234:235], v228 offset:2080
    ds_read_b64 v[236:237], v229 offset:512
    ds_read_b64 v[238:239], v229 offset:2592
    ds_read_b64 v[240:241], v229 offset:1024
    ds_read_b64 v[242:243], v229 offset:3104
    ds_read_b64 v[244:245], v229 offset:1536
    ds_read_b64 v[246:247], v229 offset:3616
    s_mul_i32 s35, s62, 2654435761
    s_add_u32 s35, s35, 2135587861
    s_cmp_eq_u32 s34, 0
    s_cselect_b32 s98, s35, 0
    s_cselect_b32 s99, 0, 2.0
    s_waitcnt lgkmcnt(12)
    s_add_u32 m0, s37, 0
    s_nop 0
    buffer_load_dwordx4 v16, s[8:11], s36 offen offset:0  lds
    buffer_load_dwordx4 v17, s[8:11], s36 offen offset:1024  lds
    buffer_load_dwordx4 v18, s[8:11], s36 offen offset:2048  lds
    buffer_load_dwordx4 v19, s[8:11], s36 offen offset:3072  lds
    v_dot2_f32_bf16 v184, v96, v112, 0
    v_dot2_f32_bf16 v185, v104, v112, 0
    v_dot2_f32_bf16 v184, v100, v113, v184
    v_dot2_f32_bf16 v185, v108, v113, v185
    v_dot2_f32_bf16 v184, v97, v114, v184
    v_dot2_f32_bf16 v185, v105, v114, v185
    v_dot2_f32_bf16 v184, v101, v115, v184
    v_dot2_f32_bf16 v185, v109, v115, v185
    v_dot2_f32_bf16 v184, v98, v116, v184
    v_dot2_f32_bf16 v185, v106, v116, v185
    v_dot2_f32_bf16 v184, v102, v117, v184
    v_dot2_f32_bf16 v185, v110, v117, v185
    v_dot2_f32_bf16 v184, v99, v118, v184
    v_dot2_f32_bf16 v185, v107, v118, v185
    v_dot2_f32_bf16 v184, v103, v119, v184
    v_dot2_f32_bf16 v185, v111, v119, v185
    s_waitcnt lgkmcnt(8)
    v_lshlrev_b32 v32, 16, v120
    v_and_b32 v36, 0xffff0000, v120
    v_add_f32_dpp v184, v184, v184 row_ror:8 row_mask:0xf bank_mask:0xf
    v_add_f32_dpp v185, v185, v185 row_ror:8 row_mask:0xf bank_mask:0xf
    v_lshlrev_b32_e64 v40, 16, v121
    v_add_f32_dpp v184, v184, v184 row_ror:4 row_mask:0xf bank_mask:0xf
    v_and_b32 v44, 0xffff0000, v121
    v_add_f32_dpp v185, v185, v185 row_ror:4 row_mask:0xf bank_mask:0xf
    v_lshlrev_b32_e64 v33, 16, v122
    v_add_f32_dpp v184, v184, v184 row_ror:2 row_mask:0xf bank_mask:0xf
    v_and_b32 v37, 0xffff0000, v122
    v_add_f32_dpp v185, v185, v185 row_ror:2 row_mask:0xf bank_mask:0xf
    v_lshlrev_b32_e64 v41, 16, v123
    v_add_f32_dpp v184, v184, v184 row_ror:1 row_mask:0xf bank_mask:0xf
    v_and_b32 v45, 0xffff0000, v123
    v_add_f32_dpp v185, v185, v185 row_ror:1 row_mask:0xf bank_mask:0xf
    v_lshlrev_b32 v34, 16, v124
    s_nop 0
    v_permlane32_swap_b32 v184, v185
    v_and_b32 v38, 0xffff0000, v124
    v_add_f32 v184, v184, v185
    v_lshlrev_b32 v42, 16, v125
    v_mov_b32 v185, v184
    v_and_b32 v46, 0xffff0000, v125
    s_nop 0
    v_permlane16_swap_b32 v184, v185
    v_lshlrev_b32 v35, 16, v126
    v_add_f32 v184, v184, v185
    v_and_b32 v39, 0xffff0000, v126
    v_cvt_pk_bf16_f32 v184, v184, v184
    v_lshlrev_b32 v43, 16, v127
    v_lshlrev_b32 v184, 16, v184
    v_and_b32 v47, 0xffff0000, v127
    v_mul_f32 v184, 0xbfb8aa3b, v184
    v_pk_mul_f32 v[64:65], v[64:65], v[32:33]
    v_exp_f32 v184, v184
    s_nop 0
    v_add_f32_e64 v184, 1.0, v184
    v_pk_mul_f32 v[66:67], v[66:67], v[34:35]
    v_rcp_f32_e64 v184, v184
    s_bfe_u32 s36, s66, 262148
    s_add_u32 m0, s37, 32768
    s_lshl_b32 s36, s36, 7
    s_nop 0
    buffer_load_dwordx4 v16, s[8:11], s36 offen offset:0  lds
    buffer_load_dwordx4 v17, s[8:11], s36 offen offset:1024  lds
    buffer_load_dwordx4 v18, s[8:11], s36 offen offset:2048  lds
    buffer_load_dwordx4 v19, s[8:11], s36 offen offset:3072  lds
    v_pk_mul_f32 v[68:69], v[68:69], v[36:37]
    v_cvt_pk_bf16_f32 v184, v184, v184
    v_pk_mul_f32 v[70:71], v[70:71], v[38:39]
    v_lshlrev_b32_e64 v184, 16, v184
    v_pk_mul_f32 v[72:73], v[72:73], v[40:41]
    v_sub_f32_e64 v252, 1.0, v184
    v_pk_mul_f32 v[74:75], v[74:75], v[42:43]
    v_cvt_pk_bf16_f32 v252, v252, v252
    v_pk_mul_f32 v[76:77], v[76:77], v[44:45]
    v_lshlrev_b32_e64 v252, 16, v252
    v_pk_mul_f32 v[78:79], v[78:79], v[46:47]
    v_mov_b32_e64 v185, v184
    v_pk_mul_f32 v[80:81], v[80:81], v[32:33]
    v_mov_b32_e64 v253, v252
    v_pk_mul_f32 v[82:83], v[82:83], v[34:35]
    v_permlane32_swap_b32 v184, v185
    v_pk_mul_f32 v[84:85], v[84:85], v[36:37]
    v_permlane32_swap_b32 v252, v253
    v_pk_mul_f32 v[86:87], v[86:87], v[38:39]
    v_cmp_gt_u32_e64 vcc, 8, v0
    v_pk_mul_f32 v[88:89], v[88:89], v[40:41]
    v_lshlrev_b32_e64 v254, 3, v0
    v_pk_mul_f32 v[90:91], v[90:91], v[42:43]
    v_accvgpr_write_b32 a168, v184
    v_pk_mul_f32 v[92:93], v[92:93], v[44:45]
    v_accvgpr_write_b32 a169, v185
    v_pk_mul_f32 v[94:95], v[94:95], v[46:47]
    v_cndmask_b32_e64 v254, 2.0, v254, vcc
    v_pk_mul_f32 v[64:65], v[64:65], v[252:253] op_sel_hi:[1,0]
    v_pk_mul_f32 v[66:67], v[66:67], v[252:253] op_sel_hi:[1,0]
    v_pk_mul_f32 v[68:69], v[68:69], v[252:253] op_sel_hi:[1,0]
    v_pk_mul_f32 v[70:71], v[70:71], v[252:253] op_sel_hi:[1,0]
    v_cvt_pk_bf16_f32 v190, v64, v68
    v_accvgpr_write_b32 a152, v190
    v_cvt_pk_bf16_f32 v191, v65, v69
    v_accvgpr_write_b32 a153, v191
    v_cvt_pk_bf16_f32 v190, v66, v70
    v_accvgpr_write_b32 a154, v190
    v_cvt_pk_bf16_f32 v191, v67, v71
    v_accvgpr_write_b32 a155, v191
    v_pk_mul_f32 v[72:73], v[72:73], v[252:253] op_sel_hi:[1,0]
    v_pk_mul_f32 v[74:75], v[74:75], v[252:253] op_sel_hi:[1,0]
    v_pk_mul_f32 v[76:77], v[76:77], v[252:253] op_sel_hi:[1,0]
    v_pk_mul_f32 v[78:79], v[78:79], v[252:253] op_sel_hi:[1,0]
    v_cvt_pk_bf16_f32 v190, v72, v76
    v_accvgpr_write_b32 a156, v190
    v_cvt_pk_bf16_f32 v191, v73, v77
    v_accvgpr_write_b32 a157, v191
    v_cvt_pk_bf16_f32 v190, v74, v78
    v_accvgpr_write_b32 a158, v190
    v_cvt_pk_bf16_f32 v191, v75, v79
    v_accvgpr_write_b32 a159, v191
    v_pk_mul_f32 v[80:81], v[80:81], v[252:253] op_sel:[0,1]
    v_pk_mul_f32 v[82:83], v[82:83], v[252:253] op_sel:[0,1]
    v_pk_mul_f32 v[84:85], v[84:85], v[252:253] op_sel:[0,1]
    s_add_u32 m0, s37, 49152
    s_nop 0
    s_nop 0
    buffer_load_dwordx4 v20, s[12:15], s36 offen offset:0  lds
    buffer_load_dwordx4 v21, s[12:15], s36 offen offset:1024  lds
    buffer_load_dwordx4 v22, s[12:15], s36 offen offset:2048  lds
    buffer_load_dwordx4 v23, s[12:15], s36 offen offset:3072  lds
    v_pk_mul_f32 v[86:87], v[86:87], v[252:253] op_sel:[0,1]
    v_cvt_pk_bf16_f32 v190, v80, v84
    v_accvgpr_write_b32 a160, v190
    v_cvt_pk_bf16_f32 v191, v81, v85
    v_accvgpr_write_b32 a161, v191
    v_cvt_pk_bf16_f32 v190, v82, v86
    v_accvgpr_write_b32 a162, v190
    v_cvt_pk_bf16_f32 v191, v83, v87
    v_accvgpr_write_b32 a163, v191
    v_pk_mul_f32 v[88:89], v[88:89], v[252:253] op_sel:[0,1]
    v_pk_mul_f32 v[90:91], v[90:91], v[252:253] op_sel:[0,1]
    v_pk_mul_f32 v[92:93], v[92:93], v[252:253] op_sel:[0,1]
    v_pk_mul_f32 v[94:95], v[94:95], v[252:253] op_sel:[0,1]
    v_cvt_pk_bf16_f32 v190, v88, v92
    v_accvgpr_write_b32 a164, v190
    v_cvt_pk_bf16_f32 v191, v89, v93
    v_accvgpr_write_b32 a165, v191
    v_cvt_pk_bf16_f32 v190, v90, v94
    v_accvgpr_write_b32 a166, v190
    v_cvt_pk_bf16_f32 v191, v91, v95
    v_accvgpr_write_b32 a167, v191
    v_cos_f32 v10, v6
    v_cos_f32 v11, v7
    v_sin_f32 v12, v4
    v_sin_f32 v13, v5
    v_sin_f32 v14, v6
    v_sin_f32 v15, v7
    v_cvt_pk_bf16_f32 v4, v8, v12
    v_cvt_pk_bf16_f32 v5, -v12, v8
    v_accvgpr_write_b32 a0, v4
    v_accvgpr_write_b32 a4, v5
    v_xor_b32 v4, v147, v4
    v_xor_b32 v5, v147, v5
    v_accvgpr_write_b32 a16, v4
    v_accvgpr_write_b32 a20, v5
    v_cvt_pk_bf16_f32 v4, v9, v13
    v_cvt_pk_bf16_f32 v5, -v13, v9
    v_accvgpr_write_b32 a1, v4
    v_accvgpr_write_b32 a5, v5
    v_xor_b32 v4, v147, v4
    v_xor_b32 v5, v147, v5
    v_accvgpr_write_b32 a17, v4
    v_accvgpr_write_b32 a21, v5
    v_cvt_pk_bf16_f32 v4, v10, v14
    v_cvt_pk_bf16_f32 v5, -v14, v10
    v_accvgpr_write_b32 a2, v4
    v_accvgpr_write_b32 a6, v5
    v_xor_b32 v4, v147, v4
    v_xor_b32 v5, v147, v5
    v_accvgpr_write_b32 a18, v4
    v_accvgpr_write_b32 a22, v5
    v_cvt_pk_bf16_f32 v4, v11, v15
    s_lshl2_add_u32 s3, s33, s34
    s_lshl_b32 s3, s3, 4
    v_add_lshl_u32 v145, v1, s3, 1
    s_nop 0
    global_load_ushort v142, v145, s[52:53]
    global_load_ushort v143, v145, s[54:55]
    global_load_ushort v144, v145, s[84:85]
    v_cvt_pk_bf16_f32 v5, -v15, v11
    v_accvgpr_write_b32 a3, v4
    v_accvgpr_write_b32 a7, v5
    v_xor_b32 v4, v147, v4
    v_xor_b32_e64 v5, v147, v5
    v_accvgpr_write_b32 a19, v4
    v_accvgpr_write_b32 a23, v5
    v_fmamk_f32 v4, v251, 0x41800000, v248
    v_fmamk_f32 v5, v251, 0x41880000, v248
    v_fmamk_f32 v6, v251, 0x41900000, v248
    v_fmamk_f32 v7, v251, 0x41980000, v248
    v_cos_f32 v8, v4
    v_cos_f32 v9, v5
    v_cos_f32 v10, v6
    v_cos_f32 v11, v7
    v_sin_f32 v12, v4
    v_sin_f32 v13, v5
    v_sin_f32 v14, v6
    v_sin_f32 v15, v7
    v_cvt_pk_bf16_f32 v4, v8, v12
    v_cvt_pk_bf16_f32 v5, -v12, v8
    v_accvgpr_write_b32 a8, v4
    v_accvgpr_write_b32 a12, v5
    v_xor_b32 v4, v147, v4
    v_xor_b32 v5, v147, v5
    v_accvgpr_write_b32 a24, v4
    v_accvgpr_write_b32 a28, v5
    v_cvt_pk_bf16_f32 v4, v9, v13
    v_cvt_pk_bf16_f32 v5, -v13, v9
    v_accvgpr_write_b32 a9, v4
    v_accvgpr_write_b32 a13, v5
    v_xor_b32_e64 v4, v147, v4
    s_bfe_u32 s36, s66, 262152
    s_add_u32 m0, s37, 65536
    s_lshl_b32 s36, s36, 7
    buffer_load_dwordx4 v16, s[8:11], s36 offen offset:0  lds
    buffer_load_dwordx4 v17, s[8:11], s36 offen offset:1024  lds
    buffer_load_dwordx4 v18, s[8:11], s36 offen offset:2048  lds
    buffer_load_dwordx4 v19, s[8:11], s36 offen offset:3072  lds
    v_xor_b32 v5, v147, v5
    v_accvgpr_write_b32 a25, v4
    v_accvgpr_write_b32 a29, v5
    v_cvt_pk_bf16_f32 v4, v10, v14
    v_cvt_pk_bf16_f32 v5, -v14, v10
    v_accvgpr_write_b32 a10, v4
    v_accvgpr_write_b32 a14, v5
    v_xor_b32 v4, v147, v4
    v_xor_b32 v5, v147, v5
    v_accvgpr_write_b32 a26, v4
    v_accvgpr_write_b32 a30, v5
    v_cvt_pk_bf16_f32 v4, v11, v15
    v_cvt_pk_bf16_f32 v5, -v15, v11
    v_accvgpr_write_b32 a11, v4
    v_accvgpr_write_b32 a15, v5
    v_xor_b32 v4, v147, v4
    v_xor_b32 v5, v147, v5
    v_accvgpr_write_b32 a27, v4
    v_accvgpr_write_b32 a31, v5
    s_add_u32 m0, s37, 81920
    s_nop 0
    buffer_load_dwordx4 v20, s[12:15], s36 offen offset:0  lds
    buffer_load_dwordx4 v21, s[12:15], s36 offen offset:1024  lds
    buffer_load_dwordx4 v22, s[12:15], s36 offen offset:2048  lds
    buffer_load_dwordx4 v23, s[12:15], s36 offen offset:3072  lds
    s_waitcnt lgkmcnt(0) vmcnt(19)
    s_barrier
    s_nop 0
    ds_read_b128 a[64:67], v26 offset:0
    ds_read_b128 a[68:71], v26 offset:8192
    ds_read_b128 a[32:35], v24 offset:0
    ds_read_b128 a[36:39], v24 offset:2048
    ds_read_b128 a[40:43], v24 offset:4096
    ds_read_b128 a[44:47], v24 offset:6144
    ds_read_b128 a[48:51], v24 offset:8192
    ds_read_b128 a[52:55], v24 offset:10240
    ds_read_b128 a[56:59], v24 offset:12288
    ds_read_b128 a[60:63], v24 offset:14336
    s_bfe_u32 s36, s66, 262156
    s_add_u32 m0, s37, 98304
    s_lshl_b32 s36, s36, 7
    buffer_load_dwordx4 v16, s[8:11], s36 offen offset:0  lds
    buffer_load_dwordx4 v17, s[8:11], s36 offen offset:1024  lds
    buffer_load_dwordx4 v18, s[8:11], s36 offen offset:2048  lds
    s_waitcnt lgkmcnt(0)
    v_mfma_f32_16x16x32_bf16 v[32:35], a[32:35], a[64:67], 0
    ds_read_b128 a[104:107], v27 offset:0
    buffer_load_dwordx4 v19, s[8:11], s36 offen offset:3072  lds
    v_mfma_f32_16x16x32_bf16 v[36:39], a[32:35], a[68:71], 0
    ds_read_b128 a[108:111], v27 offset:8192
    v_mfma_f32_16x16x32_bf16 v[40:43], a[36:39], a[64:67], 0
    ds_read_b128 a[72:75], v25 offset:0
    s_add_u32 m0, s37, 114688
    v_mfma_f32_16x16x32_bf16 v[44:47], a[36:39], a[68:71], 0
    v_mfma_f32_16x16x32_bf16 v[48:51], a[40:43], a[64:67], 0
    ds_read_b128 a[76:79], v25 offset:2048
    v_mfma_f32_16x16x32_bf16 v[52:55], a[40:43], a[68:71], 0
    ds_read_b128 a[80:83], v25 offset:4096
    buffer_load_dwordx4 v20, s[12:15], s36 offen offset:0  lds
    v_mfma_f32_16x16x32_bf16 v[56:59], a[44:47], a[64:67], 0
    v_mfma_f32_16x16x32_bf16 v[60:63], a[44:47], a[68:71], 0
    ds_read_b128 a[84:87], v25 offset:6144
    v_mfma_f32_16x16x32_bf16 v[64:67], a[48:51], a[64:67], 0
    ds_read_b128 a[88:91], v25 offset:8192
    buffer_load_dwordx4 v21, s[12:15], s36 offen offset:1024  lds
    v_mfma_f32_16x16x32_bf16 v[68:71], a[48:51], a[68:71], 0
    ds_read_b128 a[92:95], v25 offset:10240
    v_mov_b32_e64 v28, s96
    v_mfma_f32_16x16x32_bf16 v[72:75], a[52:55], a[64:67], 0
    buffer_load_dwordx4 v22, s[12:15], s36 offen offset:2048  lds
    buffer_store_dword v28, v30, s[24:27], s70 offen sc1
    v_mfma_f32_16x16x32_bf16 v[76:79], a[52:55], a[68:71], 0
    ds_read_b128 a[96:99], v25 offset:12288
    buffer_store_dwordx2 v[252:253], v254, s[24:27], s69 offen sc1
    v_mfma_f32_16x16x32_bf16 v[80:83], a[56:59], a[64:67], 0
    ds_read_b128 a[100:103], v25 offset:14336
    v_mfma_f32_16x16x32_bf16 v[84:87], a[56:59], a[68:71], 0
    buffer_load_dwordx4 v23, s[12:15], s36 offen offset:3072  lds
    v_mfma_f32_16x16x32_bf16 v[88:91], a[60:63], a[64:67], 0
    v_mfma_f32_16x16x32_bf16 v[92:95], a[60:63], a[68:71], 0
    s_waitcnt lgkmcnt(0) vmcnt(21)
    s_barrier
    v_mfma_f32_16x16x32_bf16 v[32:35], a[72:75], a[104:107], v[32:35]
    ds_read_b128 a[64:67], v26 offset:32768
    s_bfe_u32 s36, s66, 262160
    s_mov_b32 s76, 0x05040100
    v_mfma_f32_16x16x32_bf16 v[36:39], a[72:75], a[108:111], v[36:39]
    ds_read_b128 a[68:71], v26 offset:40960
    s_mov_b32 s77, 0x07060302
    s_lshl_b32 s38, s6, 4
    v_mfma_f32_16x16x32_bf16 v[40:43], a[76:79], a[104:107], v[40:43]
    ds_read_b128 a[32:35], v24 offset:32768
    s_add_u32 m0, s37, 0
    s_xor_b32 s39, s38, 16
    v_alignbit_b32 v196, v197, v196, s38
    v_mfma_f32_16x16x32_bf16 v[44:47], a[76:79], a[108:111], v[44:47]
    v_alignbit_b32 v197, v198, v197, s38
    v_mfma_f32_16x16x32_bf16 v[48:51], a[80:83], a[104:107], v[48:51]
    ds_read_b128 a[36:39], v24 offset:34816
    v_lshrrev_b32 v198, s38, v198
    v_alignbit_b32 v200, v201, v200, s38
    v_mfma_f32_16x16x32_bf16 v[52:55], a[80:83], a[108:111], v[52:55]
    ds_read_b128 a[40:43], v24 offset:36864
    s_lshl_b32 s36, s36, 7
    v_alignbit_b32 v201, v202, v201, s38
    v_lshrrev_b32 v202, s38, v202
    v_mfma_f32_16x16x32_bf16 v[56:59], a[84:87], a[104:107], v[56:59]
    v_alignbit_b32 v204, v205, v204, s39
    v_alignbit_b32 v205, v206, v205, s39
    v_mfma_f32_16x16x32_bf16 v[60:63], a[84:87], a[108:111], v[60:63]
    ds_read_b128 a[44:47], v24 offset:38912
    v_alignbit_b32 v208, v209, v208, s39
    v_mfma_f32_16x16x32_bf16 v[64:67], a[88:91], a[104:107], v[64:67]
    ds_read_b128 a[48:51], v24 offset:40960
    buffer_load_dwordx4 v16, s[8:11], s36 offen offset:0  lds
    v_alignbit_b32 v209, v210, v209, s39
    v_alignbit_b32 v212, v213, v212, s38
    v_mfma_f32_16x16x32_bf16 v[68:71], a[88:91], a[108:111], v[68:71]
    ds_read_b128 a[52:55], v24 offset:43008
    buffer_store_dwordx4 v[232:235], v230, s[28:31], s68 offen sc1
    v_alignbit_b32 v213, v214, v213, s38
    v_lshrrev_b32_e64 v214, s38, v214
    v_mfma_f32_16x16x32_bf16 v[72:75], a[92:95], a[104:107], v[72:75]
    buffer_load_dwordx4 v17, s[8:11], s36 offen offset:1024  lds
    s_add_u32 s68, s68, 2097152
    v_alignbit_b32 v216, v217, v216, s38
    v_alignbit_b32 v217, v218, v217, s38
    v_mfma_f32_16x16x32_bf16 v[76:79], a[92:95], a[108:111], v[76:79]
    ds_read_b128 a[56:59], v24 offset:45056
    v_lshrrev_b32_e64 v218, s38, v218
    v_mfma_f32_16x16x32_bf16 v[80:83], a[96:99], a[104:107], v[80:83]
    ds_read_b128 a[60:63], v24 offset:47104
    v_alignbit_b32 v220, v221, v220, s39
    v_alignbit_b32 v221, v222, v221, s39
    v_mfma_f32_16x16x32_bf16 v[84:87], a[96:99], a[108:111], v[84:87]
    buffer_load_dwordx4 v18, s[8:11], s36 offen offset:2048  lds
    v_alignbit_b32 v224, v225, v224, s39
    v_alignbit_b32 v225, v226, v225, s39
    v_mfma_f32_16x16x32_bf16 v[88:91], a[100:103], a[104:107], v[88:91]
    v_perm_b32 v184, v202, v198, s76
    v_perm_b32 v186, v218, v214, s76
    v_mfma_f32_16x16x32_bf16 v[92:95], a[100:103], a[108:111], v[92:95]
    ds_write_b128 v194, v[184:187] offset:16384
    s_waitcnt lgkmcnt(1)
    v_mfma_f32_16x16x32_bf16 v[32:35], a[32:35], a[64:67], v[32:35]
    ds_read_b128 a[104:107], v27 offset:32768
    buffer_load_dwordx4 v19, s[8:11], s36 offen offset:3072  lds
    v_perm_b32 v152, v200, v196, s76
    v_perm_b32 v153, v209, v205, s77
    v_mfma_f32_16x16x32_bf16 v[36:39], a[32:35], a[68:71], v[36:39]
    ds_read_b128 a[108:111], v27 offset:40960
    v_perm_b32 v154, v216, v212, s76
    v_perm_b32 v155, v225, v221, s77
    v_mfma_f32_16x16x32_bf16 v[40:43], a[36:39], a[64:67], v[40:43]
    ds_read_b128 a[72:75], v25 offset:32768
    s_add_u32 m0, s37, 16384
    ds_write_b128 v194, v[152:155] offset:0
    v_perm_b32 v156, v200, v196, s77
    v_mfma_f32_16x16x32_bf16 v[44:47], a[36:39], a[68:71], v[44:47]
    v_perm_b32 v157, v209, v205, s76
    v_perm_b32 v158, v216, v212, s77
    v_mfma_f32_16x16x32_bf16 v[48:51], a[40:43], a[64:67], v[48:51]
    ds_read_b128 a[76:79], v25 offset:34816
    v_perm_b32 v159, v225, v221, s76
    ds_write_b128 v194, v[156:159] offset:4096
    v_mfma_f32_16x16x32_bf16 v[52:55], a[40:43], a[68:71], v[52:55]
    ds_read_b128 a[80:83], v25 offset:36864
    buffer_load_dwordx4 v20, s[12:15], s36 offen offset:0  lds
    v_perm_b32 v160, v201, v197, s76
    v_mfma_f32_16x16x32_bf16 v[56:59], a[44:47], a[64:67], v[56:59]
    v_perm_b32 v161, v208, v204, s77
    v_perm_b32 v162, v217, v213, s76
    v_mfma_f32_16x16x32_bf16 v[60:63], a[44:47], a[68:71], v[60:63]
    ds_read_b128 a[84:87], v25 offset:38912
    v_perm_b32 v163, v224, v220, s77
    ds_write_b128 v194, v[160:163] offset:8192
    v_mfma_f32_16x16x32_bf16 v[64:67], a[48:51], a[64:67], v[64:67]
    ds_read_b128 a[88:91], v25 offset:40960
    buffer_load_dwordx4 v21, s[12:15], s36 offen offset:1024  lds
    v_perm_b32 v164, v201, v197, s77
    v_perm_b32 v165, v208, v204, s76
    v_mfma_f32_16x16x32_bf16 v[68:71], a[48:51], a[68:71], v[68:71]
    ds_read_b128 a[92:95], v25 offset:43008
    buffer_store_dwordx4 v[236:239], v230, s[28:31], s68 offen sc1
    v_perm_b32 v166, v217, v213, s77
    v_perm_b32 v167, v224, v220, s76
    v_mfma_f32_16x16x32_bf16 v[72:75], a[52:55], a[64:67], v[72:75]
    buffer_load_dwordx4 v22, s[12:15], s36 offen offset:2048  lds
    s_add_u32 s68, s68, 2097152
    ds_write_b128 v194, v[164:167] offset:12288
    v_mfma_f32_16x16x32_bf16 v[76:79], a[52:55], a[68:71], v[76:79]
    ds_read_b128 a[96:99], v25 offset:45056
    v_bfe_u32 v189, v0, 2, 2
    v_lshl_add_u32 v228, v189, 8, v231
    v_mfma_f32_16x16x32_bf16 v[80:83], a[56:59], a[64:67], v[80:83]
    ds_read_b128 a[100:103], v25 offset:47104
    v_lshl_add_u32 v189, v189, 12, v195
    v_xor_b32 v190, 0x1000, v189
    v_mfma_f32_16x16x32_bf16 v[84:87], a[56:59], a[68:71], v[84:87]
    buffer_load_dwordx4 v23, s[12:15], s36 offen offset:3072  lds
    v_xor_b32 v191, 0x2000, v189
    v_xor_b32 v192, 0x3000, v189
    v_mfma_f32_16x16x32_bf16 v[88:91], a[60:63], a[64:67], v[88:91]
    v_xor_b32 v229, 0x100, v228
    v_xor_b32 v231, 0x200, v228
    v_mfma_f32_16x16x32_bf16 v[92:95], a[60:63], a[68:71], v[92:95]
    v_xor_b32 v193, 0x300, v228
    s_waitcnt lgkmcnt(0) vmcnt(20)
    s_barrier
    v_mfma_f32_16x16x32_bf16 v[32:35], a[72:75], a[104:107], v[32:35]
    ds_read_b128 a[64:67], v150 offset:0
    s_bfe_u32 s36, s66, 262164
    ds_read_b128 v[184:187], v195 offset:16384
    ds_read_b128 v[168:171], v189
    v_mfma_f32_16x16x32_bf16 v[36:39], a[72:75], a[108:111], v[36:39]
    ds_read_b128 a[68:71], v150 offset:8192
    ds_read_b128 v[172:175], v190
    v_mfma_f32_16x16x32_bf16 v[40:43], a[76:79], a[104:107], v[40:43]
    ds_read_b128 a[32:35], v148 offset:0
    s_add_u32 m0, s37, 32768
    ds_read_b128 v[176:179], v191
    v_mfma_f32_16x16x32_bf16 v[44:47], a[76:79], a[108:111], v[44:47]
    ds_read_b128 v[180:183], v192
    v_mfma_f32_16x16x32_bf16 v[48:51], a[80:83], a[104:107], v[48:51]
    ds_read_b128 a[36:39], v148 offset:2048
    s_lshr_b32 s40, s2, 2
    v_mfma_f32_16x16x32_bf16 v[52:55], a[80:83], a[108:111], v[52:55]
    ds_read_b128 a[40:43], v148 offset:4096
    s_lshl_b32 s36, s36, 7
    s_lshl_b32 s41, s34, 9
    v_mfma_f32_16x16x32_bf16 v[56:59], a[84:87], a[104:107], v[56:59]
    s_add_u32 s40, s40, s41
    v_mfma_f32_16x16x32_bf16 v[60:63], a[84:87], a[108:111], v[60:63]
    ds_read_b128 a[44:47], v148 offset:6144
    s_add_u32 s40, s40, 64
    v_mfma_f32_16x16x32_bf16 v[64:67], a[88:91], a[104:107], v[64:67]
    ds_read_b128 a[48:51], v148 offset:8192
    buffer_load_dwordx4 v16, s[8:11], s36 offen offset:0  lds
    s_lshl_b32 s40, s40, 6
    s_and_b32 s41, s2, 3
    v_mfma_f32_16x16x32_bf16 v[68:71], a[88:91], a[108:111], v[68:71]
    ds_read_b128 a[52:55], v148 offset:10240
    s_add_u32 s40, s40, s41
    v_mfma_f32_16x16x32_bf16 v[72:75], a[92:95], a[104:107], v[72:75]
    buffer_load_dwordx4 v17, s[8:11], s36 offen offset:1024  lds
    s_lshl_b32 s76, s40, 6
    v_mfma_f32_16x16x32_bf16 v[76:79], a[92:95], a[108:111], v[76:79]
    ds_read_b128 a[56:59], v148 offset:12288
    s_lshl_b32 s40, s34, 10
    v_mfma_f32_16x16x32_bf16 v[80:83], a[96:99], a[104:107], v[80:83]
    ds_read_b128 a[60:63], v148 offset:14336
    v_add_u32 v188, s40, v3
    v_mfma_f32_16x16x32_bf16 v[84:87], a[96:99], a[108:111], v[84:87]
    buffer_load_dwordx4 v18, s[8:11], s36 offen offset:2048  lds
    v_subrev_u32 v188, 4032, v188
    v_mfma_f32_16x16x32_bf16 v[88:91], a[100:103], a[104:107], v[88:91]
    v_min_u32_e64 v188, 2.0, v188
    v_mfma_f32_16x16x32_bf16 v[92:95], a[100:103], a[108:111], v[92:95]
    s_lshl_b32 s77, s2, 6
    s_waitcnt lgkmcnt(0)
    v_mfma_f32_16x16x32_bf16 v[32:35], a[32:35], a[64:67], v[32:35]
    ds_read_b128 a[104:107], v151 offset:0
    buffer_load_dwordx4 v19, s[8:11], s36 offen offset:3072  lds
    s_and_b32 s38, s32, 3
    v_mfma_f32_16x16x32_bf16 v[36:39], a[32:35], a[68:71], v[36:39]
    ds_read_b128 a[108:111], v151 offset:8192
    s_mov_b32 s97, 1985229328
    v_mfma_f32_16x16x32_bf16 v[40:43], a[36:39], a[64:67], v[40:43]
    ds_read_b128 a[72:75], v149 offset:0
    s_add_u32 m0, s37, 49152
    s_cmp_eq_u32 s38, 1
    s_cselect_b32 s97, 561402928, s97
    v_mfma_f32_16x16x32_bf16 v[44:47], a[36:39], a[68:71], v[44:47]
    v_mfma_f32_16x16x32_bf16 v[48:51], a[40:43], a[64:67], v[48:51]
    ds_read_b128 a[76:79], v149 offset:2048
    s_cmp_eq_u32 s38, 2
    s_cselect_b32 s97, 1126266448, s97
    v_mfma_f32_16x16x32_bf16 v[52:55], a[40:43], a[68:71], v[52:55]
    ds_read_b128 a[80:83], v149 offset:4096
    buffer_load_dwordx4 v20, s[12:15], s36 offen offset:0  lds
    s_cmp_eq_u32 s38, 3
    s_cselect_b32 s97, 1698898288, s97
    v_mfma_f32_16x16x32_bf16 v[56:59], a[44:47], a[64:67], v[56:59]
    v_mfma_f32_16x16x32_bf16 v[60:63], a[44:47], a[68:71], v[60:63]
    ds_read_b128 a[84:87], v149 offset:6144
    s_lshr_b32 s38, s2, 5
    v_mfma_f32_16x16x32_bf16 v[64:67], a[48:51], a[64:67], v[64:67]
    ds_read_b128 a[88:91], v149 offset:8192
    buffer_load_dwordx4 v21, s[12:15], s36 offen offset:1024  lds
    s_mul_i32 s38, s38, 0x11111111
    v_mfma_f32_16x16x32_bf16 v[68:71], a[48:51], a[68:71], v[68:71]
    ds_read_b128 a[92:95], v149 offset:10240
    buffer_store_dwordx4 v[240:243], v230, s[28:31], s68 offen sc1
    v_mfma_f32_16x16x32_bf16 v[72:75], a[52:55], a[64:67], v[72:75]
    buffer_load_dwordx4 v22, s[12:15], s36 offen offset:2048  lds
    s_add_u32 s68, s68, 2097152
    s_add_u32 s97, s97, s38
    v_mfma_f32_16x16x32_bf16 v[76:79], a[52:55], a[68:71], v[76:79]
    ds_read_b128 a[96:99], v149 offset:12288
    s_and_b32 s97, s97, 0x77777777
    v_mfma_f32_16x16x32_bf16 v[80:83], a[56:59], a[64:67], v[80:83]
    ds_read_b128 a[100:103], v149 offset:14336
    v_mfma_f32_16x16x32_bf16 v[84:87], a[56:59], a[68:71], v[84:87]
    buffer_load_dwordx4 v23, s[12:15], s36 offen offset:3072  lds
    s_lshl_b32 s38, s33, 6
    v_mfma_f32_16x16x32_bf16 v[88:91], a[60:63], a[64:67], v[88:91]
    s_add_u32 s38, s38, s34
    v_mfma_f32_16x16x32_bf16 v[92:95], a[60:63], a[68:71], v[92:95]
    s_waitcnt lgkmcnt(0) vmcnt(19)
    s_barrier
    v_mfma_f32_16x16x32_bf16 v[32:35], a[72:75], a[104:107], v[32:35]
    ds_read_b128 a[64:67], v150 offset:32768
    s_bfe_u32 s36, s66, 262168
    s_lshl_b32 s38, s38, 8
    v_mfma_f32_16x16x32_bf16 v[36:39], a[72:75], a[108:111], v[36:39]
    ds_read_b128 a[68:71], v150 offset:40960
    s_add_u32 s93, s38, 22020096
    v_mfma_f32_16x16x32_bf16 v[40:43], a[76:79], a[104:107], v[40:43]
    ds_read_b128 a[32:35], v148 offset:32768
    s_add_u32 m0, s37, 65536
    s_lshl_b32 s38, s32, 11
    v_mfma_f32_16x16x32_bf16 v[44:47], a[76:79], a[108:111], v[44:47]
    v_mfma_f32_16x16x32_bf16 v[48:51], a[80:83], a[104:107], v[48:51]
    ds_read_b128 a[36:39], v148 offset:34816
    s_add_u32 s38, s38, s33
    v_mfma_f32_16x16x32_bf16 v[52:55], a[80:83], a[108:111], v[52:55]
    ds_read_b128 a[40:43], v148 offset:36864
    s_lshl_b32 s36, s36, 7
    s_lshl_b32 s5, s38, 8
    v_mfma_f32_16x16x32_bf16 v[56:59], a[84:87], a[104:107], v[56:59]
    v_mfma_f32_16x16x32_bf16 v[60:63], a[84:87], a[108:111], v[60:63]
    ds_read_b128 a[44:47], v148 offset:38912
    s_lshl_b32 s38, s94, 16
    v_mfma_f32_16x16x32_bf16 v[64:67], a[88:91], a[104:107], v[64:67]
    ds_read_b128 a[48:51], v148 offset:40960
    buffer_load_dwordx4 v16, s[8:11], s36 offen offset:0  lds
    s_andn2_b32 s95, s5, 0x700
    v_mfma_f32_16x16x32_bf16 v[68:71], a[88:91], a[108:111], v[68:71]
    ds_read_b128 a[52:55], v148 offset:43008
    buffer_store_dwordx4 v[244:247], v230, s[28:31], s68 offen sc1
    v_mfma_f32_16x16x32_bf16 v[72:75], a[92:95], a[104:107], v[72:75]
    buffer_load_dwordx4 v17, s[8:11], s36 offen offset:1024  lds
    s_add_u32 s95, s95, s38
    v_mfma_f32_16x16x32_bf16 v[76:79], a[92:95], a[108:111], v[76:79]
    ds_read_b128 a[56:59], v148 offset:45056
    s_cmp_lt_u32 s34, 2
    s_cselect_b64 s[16:17], s[80:81], s[82:83]
    v_mfma_f32_16x16x32_bf16 v[80:83], a[96:99], a[104:107], v[80:83]
    ds_read_b128 a[60:63], v148 offset:47104
    v_mfma_f32_16x16x32_bf16 v[84:87], a[96:99], a[108:111], v[84:87]
    buffer_load_dwordx4 v18, s[8:11], s36 offen offset:2048  lds
    s_mov_b32 s18, 0x200000
    v_mfma_f32_16x16x32_bf16 v[88:91], a[100:103], a[104:107], v[88:91]
    v_mfma_f32_16x16x32_bf16 v[92:95], a[100:103], a[108:111], v[92:95]
    s_waitcnt lgkmcnt(0)
    v_mfma_f32_16x16x32_bf16 v[32:35], a[32:35], a[64:67], v[32:35]
    ds_read_b128 a[104:107], v151 offset:32768
    buffer_load_dwordx4 v19, s[8:11], s36 offen offset:3072  lds
    v_lshlrev_b32_e64 v144, 16, v144
    v_mfma_f32_16x16x32_bf16 v[36:39], a[32:35], a[68:71], v[36:39]
    ds_read_b128 a[108:111], v151 offset:40960
    v_lshlrev_b32_e64 v142, 16, v142
    v_mfma_f32_16x16x32_bf16 v[40:43], a[36:39], a[64:67], v[40:43]
    ds_read_b128 a[72:75], v149 offset:32768
    s_add_u32 m0, s37, 81920
    v_mul_f32 v144, 0x3fb8aa3b, v144
    v_mfma_f32_16x16x32_bf16 v[44:47], a[36:39], a[68:71], v[44:47]
    v_mfma_f32_16x16x32_bf16 v[48:51], a[40:43], a[64:67], v[48:51]
    ds_read_b128 a[76:79], v149 offset:34816
    v_exp_f32_e64 v144, v144
    v_mfma_f32_16x16x32_bf16 v[52:55], a[40:43], a[68:71], v[52:55]
    ds_read_b128 a[80:83], v149 offset:36864
    buffer_load_dwordx4 v20, s[12:15], s36 offen offset:0  lds
    v_lshlrev_b32_e64 v143, 16, v143
    v_mfma_f32_16x16x32_bf16 v[56:59], a[44:47], a[64:67], v[56:59]
    v_mfma_f32_16x16x32_bf16 v[60:63], a[44:47], a[68:71], v[60:63]
    ds_read_b128 a[84:87], v149 offset:38912
    v_cvt_pk_bf16_f32 v144, v144, v144
    v_mfma_f32_16x16x32_bf16 v[64:67], a[48:51], a[64:67], v[64:67]
    ds_read_b128 a[88:91], v149 offset:40960
    buffer_load_dwordx4 v21, s[12:15], s36 offen offset:1024  lds
    v_lshlrev_b32_e64 v144, 16, v144
    v_mfma_f32_16x16x32_bf16 v[68:71], a[48:51], a[68:71], v[68:71]
    ds_read_b128 a[92:95], v149 offset:43008
    v_mfma_f32_16x16x32_bf16 v[72:75], a[52:55], a[64:67], v[72:75]
    buffer_load_dwordx4 v22, s[12:15], s36 offen offset:2048  lds
    buffer_store_dwordx4 v[184:187], v188, s[24:27], s77 offen sc1
    v_mul_f32_e64 v14, v144, v142
    v_mfma_f32_16x16x32_bf16 v[76:79], a[52:55], a[68:71], v[76:79]
    ds_read_b128 a[96:99], v149 offset:45056
    v_mul_f32_e64 v4, v144, v143
    v_mfma_f32_16x16x32_bf16 v[80:83], a[56:59], a[64:67], v[80:83]
    ds_read_b128 a[100:103], v149 offset:47104
    v_mfma_f32_16x16x32_bf16 v[84:87], a[56:59], a[68:71], v[84:87]
    buffer_load_dwordx4 v23, s[12:15], s36 offen offset:3072  lds
    v_mul_f32 v14, 0x3fb8aa3b, v14
    v_mfma_f32_16x16x32_bf16 v[88:91], a[60:63], a[64:67], v[88:91]
    v_mul_f32_e64 v4, 0x3e22f983, v4
    v_mfma_f32_16x16x32_bf16 v[92:95], a[60:63], a[68:71], v[92:95]
    s_waitcnt lgkmcnt(0) vmcnt(19)
    s_barrier
    v_mfma_f32_16x16x32_bf16 v[32:35], a[72:75], a[104:107], v[32:35]
    ds_read_b128 a[64:67], v26 offset:0
    s_bfe_u32 s36, s66, 262172
    v_exp_f32_e64 v14, v14
    v_mfma_f32_16x16x32_bf16 v[36:39], a[72:75], a[108:111], v[36:39]
    ds_read_b128 a[68:71], v26 offset:8192
    v_fract_f32_e64 v4, v4
    v_mfma_f32_16x16x32_bf16 v[40:43], a[76:79], a[104:107], v[40:43]
    ds_read_b128 a[32:35], v24 offset:0
    s_add_u32 m0, s37, 98304
    v_cos_f32_e64 v5, v4
    v_mfma_f32_16x16x32_bf16 v[44:47], a[76:79], a[108:111], v[44:47]
    v_mfma_f32_16x16x32_bf16 v[48:51], a[80:83], a[104:107], v[48:51]
    ds_read_b128 a[36:39], v24 offset:2048
    v_sin_f32_e64 v6, v4
    v_mfma_f32_16x16x32_bf16 v[52:55], a[80:83], a[108:111], v[52:55]
    ds_read_b128 a[40:43], v24 offset:4096
    s_lshl_b32 s36, s36, 7
    v_mul_f32 v128, v14, v5
    v_mfma_f32_16x16x32_bf16 v[56:59], a[84:87], a[104:107], v[56:59]
    v_mfma_f32_16x16x32_bf16 v[60:63], a[84:87], a[108:111], v[60:63]
    ds_read_b128 a[44:47], v24 offset:6144
    v_mul_f32_e64 v129, v14, v6
    v_mfma_f32_16x16x32_bf16 v[64:67], a[88:91], a[104:107], v[64:67]
    ds_read_b128 a[48:51], v24 offset:8192
    buffer_load_dwordx4 v16, s[8:11], s36 offen offset:0  lds
    v_mul_f32_e64 v14, v142, v142
    v_mfma_f32_16x16x32_bf16 v[68:71], a[88:91], a[108:111], v[68:71]
    ds_read_b128 a[52:55], v24 offset:10240
    v_mfma_f32_16x16x32_bf16 v[72:75], a[92:95], a[104:107], v[72:75]
    buffer_load_dwordx4 v17, s[8:11], s36 offen offset:1024  lds
    v_fma_f32 v14, v143, v143, v14
    v_mfma_f32_16x16x32_bf16 v[76:79], a[92:95], a[108:111], v[76:79]
    ds_read_b128 a[56:59], v24 offset:12288
    v_rcp_f32_e64 v14, v14
    v_mfma_f32_16x16x32_bf16 v[80:83], a[96:99], a[104:107], v[80:83]
    ds_read_b128 a[60:63], v24 offset:14336
    v_mfma_f32_16x16x32_bf16 v[84:87], a[96:99], a[108:111], v[84:87]
    buffer_load_dwordx4 v18, s[8:11], s36 offen offset:2048  lds
    v_add_f32_e64 v4, -1.0, v128
    v_mfma_f32_16x16x32_bf16 v[88:91], a[100:103], a[104:107], v[88:91]
    v_add_f32_e64 v14, v14, v14
    v_mfma_f32_16x16x32_bf16 v[92:95], a[100:103], a[108:111], v[92:95]
    s_waitcnt lgkmcnt(0)
    v_mfma_f32_16x16x32_bf16 v[32:35], a[32:35], a[64:67], v[32:35]
    ds_read_b128 a[104:107], v27 offset:0
    buffer_load_dwordx4 v19, s[8:11], s36 offen offset:3072  lds
    v_mul_f32 v5, v4, v142
    v_mfma_f32_16x16x32_bf16 v[36:39], a[32:35], a[68:71], v[36:39]
    ds_read_b128 a[108:111], v27 offset:8192
    v_fma_f32 v5, v129, v143, v5
    v_mfma_f32_16x16x32_bf16 v[40:43], a[36:39], a[64:67], v[40:43]
    ds_read_b128 a[72:75], v25 offset:0
    s_add_u32 m0, s37, 114688
    v_mul_f32_e64 v6, v129, v142
    v_mfma_f32_16x16x32_bf16 v[44:47], a[36:39], a[68:71], v[44:47]
    v_mfma_f32_16x16x32_bf16 v[48:51], a[40:43], a[64:67], v[48:51]
    ds_read_b128 a[76:79], v25 offset:2048
    v_fma_f32 v6, -v4, v143, v6
    v_mfma_f32_16x16x32_bf16 v[52:55], a[40:43], a[68:71], v[52:55]
    ds_read_b128 a[80:83], v25 offset:4096
    buffer_load_dwordx4 v20, s[12:15], s36 offen offset:0  lds
    v_mul_f32_e64 v130, v5, v14
    v_mfma_f32_16x16x32_bf16 v[56:59], a[44:47], a[64:67], v[56:59]
    v_mfma_f32_16x16x32_bf16 v[60:63], a[44:47], a[68:71], v[60:63]
    ds_read_b128 a[84:87], v25 offset:6144
    v_mul_f32_e64 v131, v6, v14
    v_mfma_f32_16x16x32_bf16 v[64:67], a[48:51], a[64:67], v[64:67]
    ds_read_b128 a[88:91], v25 offset:8192
    buffer_load_dwordx4 v21, s[12:15], s36 offen offset:1024  lds
    v_mul_f32_e64 v4, v128, v128
    v_mfma_f32_16x16x32_bf16 v[68:71], a[48:51], a[68:71], v[68:71]
    ds_read_b128 a[92:95], v25 offset:10240
    v_mfma_f32_16x16x32_bf16 v[72:75], a[52:55], a[64:67], v[72:75]
    buffer_load_dwordx4 v22, s[12:15], s36 offen offset:2048  lds
    buffer_store_dwordx4 v[168:171], v228, s[28:31], s76 offen sc1
    v_mul_f32_e64 v5, v128, v129
    v_mfma_f32_16x16x32_bf16 v[76:79], a[52:55], a[68:71], v[76:79]
    ds_read_b128 a[96:99], v25 offset:12288
    v_fma_f32 v4, -v129, v129, v4
    v_mfma_f32_16x16x32_bf16 v[80:83], a[56:59], a[64:67], v[80:83]
    ds_read_b128 a[100:103], v25 offset:14336
    v_mfma_f32_16x16x32_bf16 v[84:87], a[56:59], a[68:71], v[84:87]
    buffer_load_dwordx4 v23, s[12:15], s36 offen offset:3072  lds
    v_add_f32_e64 v5, v5, v5
    v_mfma_f32_16x16x32_bf16 v[88:91], a[60:63], a[64:67], v[88:91]
    v_mul_f32_e64 v6, v4, v4
    v_mfma_f32_16x16x32_bf16 v[92:95], a[60:63], a[68:71], v[92:95]
    s_waitcnt lgkmcnt(0) vmcnt(19)
    s_barrier
    v_mfma_f32_16x16x32_bf16 v[32:35], a[72:75], a[104:107], v[32:35]
    ds_read_b128 a[64:67], v26 offset:32768
    s_bfe_u32 s36, s67, 262144
    v_mul_f32_e64 v7, v4, v5
    v_mfma_f32_16x16x32_bf16 v[36:39], a[72:75], a[108:111], v[36:39]
    ds_read_b128 a[68:71], v26 offset:40960
    v_fma_f32 v6, -v5, v5, v6
    v_mfma_f32_16x16x32_bf16 v[40:43], a[76:79], a[104:107], v[40:43]
    ds_read_b128 a[32:35], v24 offset:32768
    s_add_u32 m0, s37, 0
    v_add_f32 v7, v7, v7
    v_mfma_f32_16x16x32_bf16 v[44:47], a[76:79], a[108:111], v[44:47]
    v_mfma_f32_16x16x32_bf16 v[48:51], a[80:83], a[104:107], v[48:51]
    ds_read_b128 a[36:39], v24 offset:34816
    v_mul_f32_e64 v4, v6, v6
    v_mfma_f32_16x16x32_bf16 v[52:55], a[80:83], a[108:111], v[52:55]
    ds_read_b128 a[40:43], v24 offset:36864
    s_lshl_b32 s36, s36, 7
    v_mul_f32 v5, v6, v7
    v_mfma_f32_16x16x32_bf16 v[56:59], a[84:87], a[104:107], v[56:59]
    v_mfma_f32_16x16x32_bf16 v[60:63], a[84:87], a[108:111], v[60:63]
    ds_read_b128 a[44:47], v24 offset:38912
    v_fma_f32 v4, -v7, v7, v4
    v_mfma_f32_16x16x32_bf16 v[64:67], a[88:91], a[104:107], v[64:67]
    ds_read_b128 a[48:51], v24 offset:40960
    buffer_load_dwordx4 v16, s[8:11], s36 offen offset:0  lds
    v_add_f32_e64 v5, v5, v5
    v_mfma_f32_16x16x32_bf16 v[68:71], a[88:91], a[108:111], v[68:71]
    ds_read_b128 a[52:55], v24 offset:43008
    v_mfma_f32_16x16x32_bf16 v[72:75], a[92:95], a[104:107], v[72:75]
    buffer_load_dwordx4 v17, s[8:11], s36 offen offset:1024  lds
    buffer_store_dwordx4 v[172:175], v229, s[28:31], s76 offen sc1
    v_mul_f32_e64 v132, v4, v4
    v_mfma_f32_16x16x32_bf16 v[76:79], a[92:95], a[108:111], v[76:79]
    ds_read_b128 a[56:59], v24 offset:45056
    v_mul_f32_e64 v133, v4, v5
    v_mfma_f32_16x16x32_bf16 v[80:83], a[96:99], a[104:107], v[80:83]
    ds_read_b128 a[60:63], v24 offset:47104
    v_mfma_f32_16x16x32_bf16 v[84:87], a[96:99], a[108:111], v[84:87]
    buffer_load_dwordx4 v18, s[8:11], s36 offen offset:2048  lds
    v_fma_f32 v132, -v5, v5, v132
    v_mfma_f32_16x16x32_bf16 v[88:91], a[100:103], a[104:107], v[88:91]
    v_add_f32_e64 v133, v133, v133
    v_mfma_f32_16x16x32_bf16 v[92:95], a[100:103], a[108:111], v[92:95]
    s_waitcnt lgkmcnt(0)
    v_mfma_f32_16x16x32_bf16 v[32:35], a[32:35], a[64:67], v[32:35]
    ds_read_b128 a[104:107], v27 offset:32768
    buffer_load_dwordx4 v19, s[8:11], s36 offen offset:3072  lds
    v_mul_f32 v134, v132, v132
    v_mfma_f32_16x16x32_bf16 v[36:39], a[32:35], a[68:71], v[36:39]
    ds_read_b128 a[108:111], v27 offset:40960
    v_mul_f32_e64 v135, v132, v133
    v_mfma_f32_16x16x32_bf16 v[40:43], a[36:39], a[64:67], v[40:43]
    ds_read_b128 a[72:75], v25 offset:32768
    s_add_u32 m0, s37, 16384
    v_fma_f32 v134, -v133, v133, v134
    v_mfma_f32_16x16x32_bf16 v[44:47], a[36:39], a[68:71], v[44:47]
    v_mfma_f32_16x16x32_bf16 v[48:51], a[40:43], a[64:67], v[48:51]
    ds_read_b128 a[76:79], v25 offset:34816
    v_add_f32_e64 v135, v135, v135
    v_mfma_f32_16x16x32_bf16 v[52:55], a[40:43], a[68:71], v[52:55]
    ds_read_b128 a[80:83], v25 offset:36864
    buffer_load_dwordx4 v20, s[12:15], s36 offen offset:0  lds
    v_mul_f32_e64 v8, v134, v134
    v_mfma_f32_16x16x32_bf16 v[56:59], a[44:47], a[64:67], v[56:59]
    v_mfma_f32_16x16x32_bf16 v[60:63], a[44:47], a[68:71], v[60:63]
    ds_read_b128 a[84:87], v25 offset:38912
    v_mul_f32_e64 v9, v134, v135
    v_mfma_f32_16x16x32_bf16 v[64:67], a[48:51], a[64:67], v[64:67]
    ds_read_b128 a[88:91], v25 offset:40960
    buffer_load_dwordx4 v21, s[12:15], s36 offen offset:1024  lds
    v_fma_f32 v8, -v135, v135, v8
    v_mfma_f32_16x16x32_bf16 v[68:71], a[48:51], a[68:71], v[68:71]
    ds_read_b128 a[92:95], v25 offset:43008
    v_mfma_f32_16x16x32_bf16 v[72:75], a[52:55], a[64:67], v[72:75]
    buffer_load_dwordx4 v22, s[12:15], s36 offen offset:2048  lds
    buffer_store_dwordx4 v[176:179], v231, s[28:31], s76 offen sc1
    v_add_f32_e64 v9, v9, v9
    v_mfma_f32_16x16x32_bf16 v[76:79], a[52:55], a[68:71], v[76:79]
    ds_read_b128 a[96:99], v25 offset:45056
    v_mul_f32_e64 v136, v8, v8
    v_mfma_f32_16x16x32_bf16 v[80:83], a[56:59], a[64:67], v[80:83]
    ds_read_b128 a[100:103], v25 offset:47104
    v_mfma_f32_16x16x32_bf16 v[84:87], a[56:59], a[68:71], v[84:87]
    buffer_load_dwordx4 v23, s[12:15], s36 offen offset:3072  lds
    v_mul_f32_e64 v137, v8, v9
    v_mfma_f32_16x16x32_bf16 v[88:91], a[60:63], a[64:67], v[88:91]
    v_fma_f32 v136, -v9, v9, v136
    v_mfma_f32_16x16x32_bf16 v[92:95], a[60:63], a[68:71], v[92:95]
    s_waitcnt lgkmcnt(0) vmcnt(19)
    s_barrier
    v_mfma_f32_16x16x32_bf16 v[32:35], a[72:75], a[104:107], v[32:35]
    ds_read_b128 a[64:67], v150 offset:0
    s_bfe_u32 s36, s67, 262148
    v_add_f32_e64 v137, v137, v137
    v_mfma_f32_16x16x32_bf16 v[36:39], a[72:75], a[108:111], v[36:39]
    ds_read_b128 a[68:71], v150 offset:8192
    v_mul_f32_e64 v4, v136, v136
    v_mfma_f32_16x16x32_bf16 v[40:43], a[76:79], a[104:107], v[40:43]
    ds_read_b128 a[32:35], v148 offset:0
    s_add_u32 m0, s37, 32768
    v_mul_f32_e64 v5, v136, v137
    v_mfma_f32_16x16x32_bf16 v[44:47], a[76:79], a[108:111], v[44:47]
    v_mfma_f32_16x16x32_bf16 v[48:51], a[80:83], a[104:107], v[48:51]
    ds_read_b128 a[36:39], v148 offset:2048
    v_fma_f32 v4, -v137, v137, v4
    v_mfma_f32_16x16x32_bf16 v[52:55], a[80:83], a[108:111], v[52:55]
    ds_read_b128 a[40:43], v148 offset:4096
    s_lshl_b32 s36, s36, 7
    v_add_f32 v5, v5, v5
    v_mfma_f32_16x16x32_bf16 v[56:59], a[84:87], a[104:107], v[56:59]
    v_mfma_f32_16x16x32_bf16 v[60:63], a[84:87], a[108:111], v[60:63]
    ds_read_b128 a[44:47], v148 offset:6144
    v_mul_f32_e64 v10, v4, v4
    v_mfma_f32_16x16x32_bf16 v[64:67], a[88:91], a[104:107], v[64:67]
    ds_read_b128 a[48:51], v148 offset:8192
    buffer_load_dwordx4 v16, s[8:11], s36 offen offset:0  lds
    v_mul_f32_e64 v11, v4, v5
    v_mfma_f32_16x16x32_bf16 v[68:71], a[88:91], a[108:111], v[68:71]
    ds_read_b128 a[52:55], v148 offset:10240
    v_mfma_f32_16x16x32_bf16 v[72:75], a[92:95], a[104:107], v[72:75]
    buffer_load_dwordx4 v17, s[8:11], s36 offen offset:1024  lds
    v_fma_f32 v10, -v5, v5, v10
    v_mfma_f32_16x16x32_bf16 v[76:79], a[92:95], a[108:111], v[76:79]
    ds_read_b128 a[56:59], v148 offset:12288
    v_add_f32_e64 v11, v11, v11
    v_mfma_f32_16x16x32_bf16 v[80:83], a[96:99], a[104:107], v[80:83]
    ds_read_b128 a[60:63], v148 offset:14336
    v_mfma_f32_16x16x32_bf16 v[84:87], a[96:99], a[108:111], v[84:87]
    buffer_load_dwordx4 v18, s[8:11], s36 offen offset:2048  lds
    v_mul_f32_e64 v12, v10, v10
    v_mfma_f32_16x16x32_bf16 v[88:91], a[100:103], a[104:107], v[88:91]
    v_mul_f32_e64 v13, v10, v11
    v_mfma_f32_16x16x32_bf16 v[92:95], a[100:103], a[108:111], v[92:95]
    s_waitcnt lgkmcnt(0)
    v_mfma_f32_16x16x32_bf16 v[32:35], a[32:35], a[64:67], v[32:35]
    ds_read_b128 a[104:107], v151 offset:0
    buffer_load_dwordx4 v19, s[8:11], s36 offen offset:3072  lds
    v_fma_f32 v12, -v11, v11, v12
    v_mfma_f32_16x16x32_bf16 v[36:39], a[32:35], a[68:71], v[36:39]
    ds_read_b128 a[108:111], v151 offset:8192
    v_add_f32 v13, v13, v13
    v_mfma_f32_16x16x32_bf16 v[40:43], a[36:39], a[64:67], v[40:43]
    ds_read_b128 a[72:75], v149 offset:0
    s_add_u32 m0, s37, 49152
    v_and_b32_e64 v14, 1, v2
    v_mfma_f32_16x16x32_bf16 v[44:47], a[36:39], a[68:71], v[44:47]
    v_mfma_f32_16x16x32_bf16 v[48:51], a[40:43], a[64:67], v[48:51]
    ds_read_b128 a[76:79], v149 offset:2048
    v_cmp_eq_u32 s[78:79], 1, v14
    v_mfma_f32_16x16x32_bf16 v[52:55], a[40:43], a[68:71], v[52:55]
    ds_read_b128 a[80:83], v149 offset:4096
    buffer_load_dwordx4 v20, s[12:15], s36 offen offset:0  lds
    v_cndmask_b32 v4, 1.0, v134, s[78:79]
    v_mfma_f32_16x16x32_bf16 v[56:59], a[44:47], a[64:67], v[56:59]
    v_mfma_f32_16x16x32_bf16 v[60:63], a[44:47], a[68:71], v[60:63]
    ds_read_b128 a[84:87], v149 offset:6144
    v_cndmask_b32 v5, 0, v135, s[78:79]
    v_mfma_f32_16x16x32_bf16 v[64:67], a[48:51], a[64:67], v[64:67]
    ds_read_b128 a[88:91], v149 offset:8192
    buffer_load_dwordx4 v21, s[12:15], s36 offen offset:1024  lds
    v_cndmask_b32 v10, 1.0, v10, s[78:79]
    v_mfma_f32_16x16x32_bf16 v[68:71], a[48:51], a[68:71], v[68:71]
    ds_read_b128 a[92:95], v149 offset:10240
    v_mfma_f32_16x16x32_bf16 v[72:75], a[52:55], a[64:67], v[72:75]
    buffer_load_dwordx4 v22, s[12:15], s36 offen offset:2048  lds
    buffer_store_dwordx4 v[180:183], v193, s[28:31], s76 offen sc1
    v_cndmask_b32 v11, 0, v11, s[78:79]
    v_mfma_f32_16x16x32_bf16 v[76:79], a[52:55], a[68:71], v[76:79]
    ds_read_b128 a[96:99], v149 offset:12288
    v_cmp_lt_u32 s[78:79], 1, v2
    v_mfma_f32_16x16x32_bf16 v[80:83], a[56:59], a[64:67], v[80:83]
    ds_read_b128 a[100:103], v149 offset:14336
    v_mfma_f32_16x16x32_bf16 v[84:87], a[56:59], a[68:71], v[84:87]
    buffer_load_dwordx4 v23, s[12:15], s36 offen offset:3072  lds
    v_cndmask_b32 v8, 1.0, v8, s[78:79]
    v_mfma_f32_16x16x32_bf16 v[88:91], a[60:63], a[64:67], v[88:91]
    v_cndmask_b32 v9, 0, v9, s[78:79]
    v_mfma_f32_16x16x32_bf16 v[92:95], a[60:63], a[68:71], v[92:95]
    s_waitcnt lgkmcnt(0) vmcnt(19)
    s_barrier
    v_mfma_f32_16x16x32_bf16 v[32:35], a[72:75], a[104:107], v[32:35]
    ds_read_b128 a[64:67], v150 offset:32768
    s_bfe_u32 s36, s67, 262152
    v_cndmask_b32 v12, 1.0, v12, s[78:79]
    v_mfma_f32_16x16x32_bf16 v[36:39], a[72:75], a[108:111], v[36:39]
    ds_read_b128 a[68:71], v150 offset:40960
    v_cndmask_b32 v13, 0, v13, s[78:79]
    v_mfma_f32_16x16x32_bf16 v[40:43], a[76:79], a[104:107], v[40:43]
    ds_read_b128 a[32:35], v148 offset:32768
    s_add_u32 m0, s37, 65536
    v_mul_f32_e64 v138, v4, v8
    v_mfma_f32_16x16x32_bf16 v[44:47], a[76:79], a[108:111], v[44:47]
    v_mfma_f32_16x16x32_bf16 v[48:51], a[80:83], a[104:107], v[48:51]
    ds_read_b128 a[36:39], v148 offset:34816
    v_mul_f32_e64 v139, v4, v9
    v_mfma_f32_16x16x32_bf16 v[52:55], a[80:83], a[108:111], v[52:55]
    ds_read_b128 a[40:43], v148 offset:36864
    s_lshl_b32 s36, s36, 7
    v_fma_f32 v138, -v5, v9, v138
    v_mfma_f32_16x16x32_bf16 v[56:59], a[84:87], a[104:107], v[56:59]
    v_mfma_f32_16x16x32_bf16 v[60:63], a[84:87], a[108:111], v[60:63]
    ds_read_b128 a[44:47], v148 offset:38912
    v_fma_f32 v139, v5, v8, v139
    v_mfma_f32_16x16x32_bf16 v[64:67], a[88:91], a[104:107], v[64:67]
    ds_read_b128 a[48:51], v148 offset:40960
    buffer_load_dwordx4 v16, s[8:11], s36 offen offset:0  lds
    v_mul_f32 v140, v10, v12
    v_mfma_f32_16x16x32_bf16 v[68:71], a[88:91], a[108:111], v[68:71]
    ds_read_b128 a[52:55], v148 offset:43008
    v_mfma_f32_16x16x32_bf16 v[72:75], a[92:95], a[104:107], v[72:75]
    buffer_load_dwordx4 v17, s[8:11], s36 offen offset:1024  lds
    v_mul_f32_e64 v141, v10, v13
    v_mfma_f32_16x16x32_bf16 v[76:79], a[92:95], a[108:111], v[76:79]
    ds_read_b128 a[56:59], v148 offset:45056
    v_fma_f32 v140, -v11, v13, v140
    v_mfma_f32_16x16x32_bf16 v[80:83], a[96:99], a[104:107], v[80:83]
    ds_read_b128 a[60:63], v148 offset:47104
    v_mfma_f32_16x16x32_bf16 v[84:87], a[96:99], a[108:111], v[84:87]
    buffer_load_dwordx4 v18, s[8:11], s36 offen offset:2048  lds
    v_fma_f32 v141, v11, v12, v141
    v_mfma_f32_16x16x32_bf16 v[88:91], a[100:103], a[104:107], v[88:91]
    v_add_u32_e64 v251, s63, v1
    v_mfma_f32_16x16x32_bf16 v[92:95], a[100:103], a[108:111], v[92:95]
    s_waitcnt lgkmcnt(0)
    v_mfma_f32_16x16x32_bf16 v[32:35], a[32:35], a[64:67], v[32:35]
    ds_read_b128 a[104:107], v151 offset:32768
    buffer_load_dwordx4 v19, s[8:11], s36 offen offset:3072  lds
    v_cvt_f32_u32 v251, v251
    v_mfma_f32_16x16x32_bf16 v[36:39], a[32:35], a[68:71], v[36:39]
    ds_read_b128 a[108:111], v151 offset:40960
    v_mul_f32 v251, 0x3a800000, v251
    v_mfma_f32_16x16x32_bf16 v[40:43], a[36:39], a[64:67], v[40:43]
    ds_read_b128 a[72:75], v149 offset:32768
    s_add_u32 m0, s37, 81920
    v_mul_f32_e64 v248, v250, v251
    v_mfma_f32_16x16x32_bf16 v[44:47], a[36:39], a[68:71], v[44:47]
    v_mfma_f32_16x16x32_bf16 v[48:51], a[40:43], a[64:67], v[48:51]
    ds_read_b128 a[76:79], v149 offset:34816
    v_fmamk_f32 v4, v251, 0x00000000, v248
    v_mfma_f32_16x16x32_bf16 v[52:55], a[40:43], a[68:71], v[52:55]
    ds_read_b128 a[80:83], v149 offset:36864
    buffer_load_dwordx4 v20, s[12:15], s36 offen offset:0  lds
    v_fmamk_f32 v5, v251, 0x3f000000, v248
    v_mfma_f32_16x16x32_bf16 v[56:59], a[44:47], a[64:67], v[56:59]
    v_mfma_f32_16x16x32_bf16 v[60:63], a[44:47], a[68:71], v[60:63]
    ds_read_b128 a[84:87], v149 offset:38912
    v_fmamk_f32 v6, v251, 0x3f800000, v248
    v_mfma_f32_16x16x32_bf16 v[64:67], a[48:51], a[64:67], v[64:67]
    ds_read_b128 a[88:91], v149 offset:40960
    buffer_load_dwordx4 v21, s[12:15], s36 offen offset:1024  lds
    v_fmamk_f32 v7, v251, 0x3fc00000, v248
    v_mfma_f32_16x16x32_bf16 v[68:71], a[48:51], a[68:71], v[68:71]
    ds_read_b128 a[92:95], v149 offset:43008
    v_mfma_f32_16x16x32_bf16 v[72:75], a[52:55], a[64:67], v[72:75]
    buffer_load_dwordx4 v22, s[12:15], s36 offen offset:2048  lds
    v_cos_f32_e64 v96, v4
    v_mfma_f32_16x16x32_bf16 v[76:79], a[52:55], a[68:71], v[76:79]
    ds_read_b128 a[96:99], v149 offset:45056
    v_cos_f32_e64 v98, v5
    v_mfma_f32_16x16x32_bf16 v[80:83], a[56:59], a[64:67], v[80:83]
    ds_read_b128 a[100:103], v149 offset:47104
    v_mfma_f32_16x16x32_bf16 v[84:87], a[56:59], a[68:71], v[84:87]
    buffer_load_dwordx4 v23, s[12:15], s36 offen offset:3072  lds
    v_cos_f32_e64 v100, v6
    v_mfma_f32_16x16x32_bf16 v[88:91], a[60:63], a[64:67], v[88:91]
    v_cos_f32_e64 v102, v7
    v_mfma_f32_16x16x32_bf16 v[92:95], a[60:63], a[68:71], v[92:95]
    s_waitcnt lgkmcnt(0) vmcnt(9)
    s_barrier
    v_mfma_f32_16x16x32_bf16 v[32:35], a[72:75], a[104:107], v[32:35]
    ds_read_b128 a[64:67], v26 offset:0
    s_lshl_b32 s69, s2, 3
    v_sin_f32 v97, v4
    v_mfma_f32_16x16x32_bf16 v[36:39], a[72:75], a[108:111], v[36:39]
    ds_read_b128 a[68:71], v26 offset:8192
    s_add_u32 s69, s69, 22347776
    v_sin_f32_e64 v99, v5
    v_mfma_f32_16x16x32_bf16 v[40:43], a[76:79], a[104:107], v[40:43]
    ds_read_b128 a[32:35], v24 offset:0
    v_sin_f32_e64 v101, v6
    v_mfma_f32_16x16x32_bf16 v[44:47], a[76:79], a[108:111], v[44:47]
    v_mov_b32_e64 v28, s35
    v_mfma_f32_16x16x32_bf16 v[48:51], a[80:83], a[104:107], v[48:51]
    ds_read_b128 a[36:39], v24 offset:2048
    v_sin_f32_e64 v103, v7
    v_mfma_f32_16x16x32_bf16 v[52:55], a[80:83], a[108:111], v[52:55]
    ds_read_b128 a[40:43], v24 offset:4096
    v_and_b32 v255, 1073741831, v30
    v_fmamk_f32 v4, v251, 0x40000000, v248
    v_mfma_f32_16x16x32_bf16 v[56:59], a[84:87], a[104:107], v[56:59]
    v_mfma_f32_16x16x32_bf16 v[60:63], a[84:87], a[108:111], v[60:63]
    ds_read_b128 a[44:47], v24 offset:6144
    buffer_store_dword v28, v255, s[24:27], s69 offen sc1
    v_fmamk_f32 v5, v251, 0x40200000, v248
    v_mfma_f32_16x16x32_bf16 v[64:67], a[88:91], a[104:107], v[64:67]
    ds_read_b128 a[48:51], v24 offset:8192
    s_bfe_u32 s36, s67, 262156
    v_fmamk_f32 v6, v251, 0x40400000, v248
    v_mfma_f32_16x16x32_bf16 v[68:71], a[88:91], a[108:111], v[68:71]
    ds_read_b128 a[52:55], v24 offset:10240
    v_mfma_f32_16x16x32_bf16 v[72:75], a[92:95], a[104:107], v[72:75]
    s_add_u32 m0, s37, 98304
    v_fmamk_f32 v7, v251, 0x40600000, v248
    v_mfma_f32_16x16x32_bf16 v[76:79], a[92:95], a[108:111], v[76:79]
    ds_read_b128 a[56:59], v24 offset:12288
    v_cos_f32_e64 v104, v4
    v_mfma_f32_16x16x32_bf16 v[80:83], a[96:99], a[104:107], v[80:83]
    ds_read_b128 a[60:63], v24 offset:14336
    s_lshl_b32 s36, s36, 7
    v_mfma_f32_16x16x32_bf16 v[84:87], a[96:99], a[108:111], v[84:87]
    v_cos_f32 v106, v5
    v_mfma_f32_16x16x32_bf16 v[88:91], a[100:103], a[104:107], v[88:91]
    buffer_load_dwordx4 v16, s[8:11], s36 offen offset:0  lds
    v_cos_f32_e64 v108, v6
    v_mfma_f32_16x16x32_bf16 v[92:95], a[100:103], a[108:111], v[92:95]
    s_waitcnt lgkmcnt(0)
    v_mfma_f32_16x16x32_bf16 v[32:35], a[32:35], a[64:67], v[32:35]
    ds_read_b128 a[104:107], v27 offset:0
    buffer_load_dwordx4 v17, s[8:11], s36 offen offset:1024  lds
    v_cos_f32 v110, v7
    v_mfma_f32_16x16x32_bf16 v[36:39], a[32:35], a[68:71], v[36:39]
    ds_read_b128 a[108:111], v27 offset:8192
    v_sin_f32_e64 v105, v4
    v_mfma_f32_16x16x32_bf16 v[40:43], a[36:39], a[64:67], v[40:43]
    ds_read_b128 a[72:75], v25 offset:0
    buffer_load_dwordx4 v18, s[8:11], s36 offen offset:2048  lds
    v_sin_f32_e64 v107, v5
    v_mfma_f32_16x16x32_bf16 v[44:47], a[36:39], a[68:71], v[44:47]
    v_mfma_f32_16x16x32_bf16 v[48:51], a[40:43], a[64:67], v[48:51]
    ds_read_b128 a[76:79], v25 offset:2048
    buffer_load_dwordx4 v19, s[8:11], s36 offen offset:3072  lds
    v_sin_f32_e64 v109, v6
    v_mfma_f32_16x16x32_bf16 v[52:55], a[40:43], a[68:71], v[52:55]
    ds_read_b128 a[80:83], v25 offset:4096
    v_sin_f32_e64 v111, v7
    v_mfma_f32_16x16x32_bf16 v[56:59], a[44:47], a[64:67], v[56:59]
    s_add_u32 m0, s37, 114688
    v_mfma_f32_16x16x32_bf16 v[60:63], a[44:47], a[68:71], v[60:63]
    ds_read_b128 a[84:87], v25 offset:6144
    v_cvt_f32_u32_e64 v9, s4
    v_mfma_f32_16x16x32_bf16 v[64:67], a[48:51], a[64:67], v[64:67]
    ds_read_b128 a[88:91], v25 offset:8192
    buffer_load_dwordx4 v20, s[12:15], s36 offen offset:0  lds
    v_mul_f32 v9, 0x3a800000, v9
    v_mfma_f32_16x16x32_bf16 v[68:71], a[48:51], a[68:71], v[68:71]
    ds_read_b128 a[92:95], v25 offset:10240
    v_mfma_f32_16x16x32_bf16 v[72:75], a[52:55], a[64:67], v[72:75]
    buffer_load_dwordx4 v21, s[12:15], s36 offen offset:1024  lds
    v_sin_f32_e64 v11, v9
    v_mfma_f32_16x16x32_bf16 v[76:79], a[52:55], a[68:71], v[76:79]
    ds_read_b128 a[96:99], v25 offset:12288
    v_cos_f32_e64 v10, v9
    v_mfma_f32_16x16x32_bf16 v[80:83], a[56:59], a[64:67], v[80:83]
    ds_read_b128 a[100:103], v25 offset:14336
    buffer_load_dwordx4 v22, s[12:15], s36 offen offset:2048  lds
    v_mfma_f32_16x16x32_bf16 v[84:87], a[56:59], a[68:71], v[84:87]
    v_add_f32_e64 v11, 1.0, v11
    v_mfma_f32_16x16x32_bf16 v[88:91], a[60:63], a[64:67], v[88:91]
    buffer_load_dwordx4 v23, s[12:15], s36 offen offset:3072  lds
    v_rcp_f32_e64 v9, v11
    v_mfma_f32_16x16x32_bf16 v[92:95], a[60:63], a[68:71], v[92:95]
    s_waitcnt lgkmcnt(0) vmcnt(17)
    s_barrier
    v_mfma_f32_16x16x32_bf16 v[32:35], a[72:75], a[104:107], v[32:35]
    ds_read_b128 a[64:67], v26 offset:32768
    s_bfe_u32 s36, s67, 262160
    s_mov_b32 s39, 0x35000000
    v_mfma_f32_16x16x32_bf16 v[36:39], a[72:75], a[108:111], v[36:39]
    ds_read_b128 a[68:71], v26 offset:40960
    s_cmp_eq_u32 s2, 0
    s_cselect_b32 s39, 0x34800000, s39
    v_mfma_f32_16x16x32_bf16 v[40:43], a[76:79], a[104:107], v[40:43]
    ds_read_b128 a[32:35], v24 offset:32768
    s_add_u32 m0, s37, 0
    v_mul_f32_e64 v15, s39, v11
    v_mfma_f32_16x16x32_bf16 v[44:47], a[76:79], a[108:111], v[44:47]
    v_mfma_f32_16x16x32_bf16 v[48:51], a[80:83], a[104:107], v[48:51]
    ds_read_b128 a[36:39], v24 offset:34816
    v_mul_f32_e64 v10, -v10, v9
    v_mfma_f32_16x16x32_bf16 v[52:55], a[80:83], a[108:111], v[52:55]
    ds_read_b128 a[40:43], v24 offset:36864
    s_lshl_b32 s36, s36, 7
    v_cvt_f32_u32 v14, s63
    v_mfma_f32_16x16x32_bf16 v[56:59], a[84:87], a[104:107], v[56:59]
    v_mfma_f32_16x16x32_bf16 v[60:63], a[84:87], a[108:111], v[60:63]
    ds_read_b128 a[44:47], v24 offset:38912
    v_readfirstlane_b32 s42, v10
    v_mfma_f32_16x16x32_bf16 v[64:67], a[88:91], a[104:107], v[64:67]
    ds_read_b128 a[48:51], v24 offset:40960
    buffer_load_dwordx4 v16, s[8:11], s36 offen offset:0  lds
    v_add_f32 v14, v14, v250
    v_mfma_f32_16x16x32_bf16 v[68:71], a[88:91], a[108:111], v[68:71]
    ds_read_b128 a[52:55], v24 offset:43008
    v_mfma_f32_16x16x32_bf16 v[72:75], a[92:95], a[104:107], v[72:75]
    buffer_load_dwordx4 v17, s[8:11], s36 offen offset:1024  lds
    v_fma_f32 v251, v249, 2.0, 0
    v_mfma_f32_16x16x32_bf16 v[76:79], a[92:95], a[108:111], v[76:79]
    ds_read_b128 a[56:59], v24 offset:45056
    v_mul_f32 v251, 0x3a000000, v251
    v_mfma_f32_16x16x32_bf16 v[80:83], a[96:99], a[104:107], v[80:83]
    ds_read_b128 a[60:63], v24 offset:47104
    v_mfma_f32_16x16x32_bf16 v[84:87], a[96:99], a[108:111], v[84:87]
    buffer_load_dwordx4 v18, s[8:11], s36 offen offset:2048  lds
    v_mul_f32_e64 v248, v14, v251
    v_mfma_f32_16x16x32_bf16 v[88:91], a[100:103], a[104:107], v[88:91]
    v_fmamk_f32 v4, v251, 0x00000000, v248
    v_mfma_f32_16x16x32_bf16 v[92:95], a[100:103], a[108:111], v[92:95]
    s_waitcnt lgkmcnt(0)
    v_mfma_f32_16x16x32_bf16 v[32:35], a[32:35], a[64:67], v[32:35]
    ds_read_b128 a[104:107], v27 offset:32768
    buffer_load_dwordx4 v19, s[8:11], s36 offen offset:3072  lds
    v_fmamk_f32 v5, v251, 0x3f800000, v248
    v_mfma_f32_16x16x32_bf16 v[36:39], a[32:35], a[68:71], v[36:39]
    ds_read_b128 a[108:111], v27 offset:40960
    v_fmamk_f32 v6, v251, 0x40000000, v248
    v_mfma_f32_16x16x32_bf16 v[40:43], a[36:39], a[64:67], v[40:43]
    ds_read_b128 a[72:75], v25 offset:32768
    s_add_u32 m0, s37, 16384
    v_fmamk_f32 v7, v251, 0x40400000, v248
    v_mfma_f32_16x16x32_bf16 v[44:47], a[36:39], a[68:71], v[44:47]
    v_mfma_f32_16x16x32_bf16 v[48:51], a[40:43], a[64:67], v[48:51]
    ds_read_b128 a[76:79], v25 offset:34816
    v_cos_f32 v112, v4
    v_mfma_f32_16x16x32_bf16 v[52:55], a[40:43], a[68:71], v[52:55]
    ds_read_b128 a[80:83], v25 offset:36864
    buffer_load_dwordx4 v20, s[12:15], s36 offen offset:0  lds
    v_cos_f32_e64 v113, v5
    v_mfma_f32_16x16x32_bf16 v[56:59], a[44:47], a[64:67], v[56:59]
    v_mfma_f32_16x16x32_bf16 v[60:63], a[44:47], a[68:71], v[60:63]
    ds_read_b128 a[84:87], v25 offset:38912
    v_cos_f32_e64 v114, v6
    v_mfma_f32_16x16x32_bf16 v[64:67], a[48:51], a[64:67], v[64:67]
    ds_read_b128 a[88:91], v25 offset:40960
    buffer_load_dwordx4 v21, s[12:15], s36 offen offset:1024  lds
    v_cos_f32_e64 v115, v7
    v_mfma_f32_16x16x32_bf16 v[68:71], a[48:51], a[68:71], v[68:71]
    ds_read_b128 a[92:95], v25 offset:43008
    v_mfma_f32_16x16x32_bf16 v[72:75], a[52:55], a[64:67], v[72:75]
    buffer_load_dwordx4 v22, s[12:15], s36 offen offset:2048  lds
    v_sin_f32_e64 v116, v4
    v_mfma_f32_16x16x32_bf16 v[76:79], a[52:55], a[68:71], v[76:79]
    ds_read_b128 a[96:99], v25 offset:45056
    v_sin_f32_e64 v117, v5
    v_mfma_f32_16x16x32_bf16 v[80:83], a[56:59], a[64:67], v[80:83]
    ds_read_b128 a[100:103], v25 offset:47104
    v_mfma_f32_16x16x32_bf16 v[84:87], a[56:59], a[68:71], v[84:87]
    buffer_load_dwordx4 v23, s[12:15], s36 offen offset:3072  lds
    v_sin_f32_e64 v118, v6
    v_mfma_f32_16x16x32_bf16 v[88:91], a[60:63], a[64:67], v[88:91]
    v_sin_f32_e64 v119, v7
    v_mfma_f32_16x16x32_bf16 v[92:95], a[60:63], a[68:71], v[92:95]
    s_waitcnt lgkmcnt(0) vmcnt(17)
    s_barrier
    v_mfma_f32_16x16x32_bf16 v[32:35], a[72:75], a[104:107], v[32:35]
    ds_read_b128 a[64:67], v150 offset:0
    s_bfe_u32 s36, s67, 262164
    v_mul_f32_e64 v112, v15, v112
    v_mfma_f32_16x16x32_bf16 v[36:39], a[72:75], a[108:111], v[36:39]
    ds_read_b128 a[68:71], v150 offset:8192
    v_mul_f32_e64 v113, v15, v113
    v_mfma_f32_16x16x32_bf16 v[40:43], a[76:79], a[104:107], v[40:43]
    ds_read_b128 a[32:35], v148 offset:0
    s_add_u32 m0, s37, 32768
    v_mul_f32_e64 v114, v15, v114
    v_mfma_f32_16x16x32_bf16 v[44:47], a[76:79], a[108:111], v[44:47]
    v_mfma_f32_16x16x32_bf16 v[48:51], a[80:83], a[104:107], v[48:51]
    ds_read_b128 a[36:39], v148 offset:2048
    v_mul_f32_e64 v115, v15, v115
    v_mfma_f32_16x16x32_bf16 v[52:55], a[80:83], a[108:111], v[52:55]
    ds_read_b128 a[40:43], v148 offset:4096
    s_lshl_b32 s36, s36, 7
    v_mul_f32 v116, v15, v116
    v_mfma_f32_16x16x32_bf16 v[56:59], a[84:87], a[104:107], v[56:59]
    v_mfma_f32_16x16x32_bf16 v[60:63], a[84:87], a[108:111], v[60:63]
    ds_read_b128 a[44:47], v148 offset:6144
    v_mul_f32_e64 v117, v15, v117
    v_mfma_f32_16x16x32_bf16 v[64:67], a[88:91], a[104:107], v[64:67]
    ds_read_b128 a[48:51], v148 offset:8192
    buffer_load_dwordx4 v16, s[8:11], s36 offen offset:0  lds
    v_mul_f32_e64 v118, v15, v118
    v_mfma_f32_16x16x32_bf16 v[68:71], a[88:91], a[108:111], v[68:71]
    ds_read_b128 a[52:55], v148 offset:10240
    v_mfma_f32_16x16x32_bf16 v[72:75], a[92:95], a[104:107], v[72:75]
    buffer_load_dwordx4 v17, s[8:11], s36 offen offset:1024  lds
    v_mul_f32_e64 v119, v15, v119
    v_mfma_f32_16x16x32_bf16 v[76:79], a[92:95], a[108:111], v[76:79]
    ds_read_b128 a[56:59], v148 offset:12288
    v_fma_f32 v251, v249, 2.0, 1.0
    v_mfma_f32_16x16x32_bf16 v[80:83], a[96:99], a[104:107], v[80:83]
    ds_read_b128 a[60:63], v148 offset:14336
    v_mfma_f32_16x16x32_bf16 v[84:87], a[96:99], a[108:111], v[84:87]
    buffer_load_dwordx4 v18, s[8:11], s36 offen offset:2048  lds
    v_mul_f32 v251, 0x3a000000, v251
    v_mfma_f32_16x16x32_bf16 v[88:91], a[100:103], a[104:107], v[88:91]
    v_mul_f32_e64 v248, v14, v251
    v_mfma_f32_16x16x32_bf16 v[92:95], a[100:103], a[108:111], v[92:95]
    s_waitcnt lgkmcnt(0)
    v_mfma_f32_16x16x32_bf16 v[32:35], a[32:35], a[64:67], v[32:35]
    ds_read_b128 a[104:107], v151 offset:0
    buffer_load_dwordx4 v19, s[8:11], s36 offen offset:3072  lds
    v_fmamk_f32 v4, v251, 0x00000000, v248
    v_mfma_f32_16x16x32_bf16 v[36:39], a[32:35], a[68:71], v[36:39]
    ds_read_b128 a[108:111], v151 offset:8192
    v_fmamk_f32 v5, v251, 0x3f800000, v248
    v_mfma_f32_16x16x32_bf16 v[40:43], a[36:39], a[64:67], v[40:43]
    ds_read_b128 a[72:75], v149 offset:0
    s_add_u32 m0, s37, 49152
    v_fmamk_f32 v6, v251, 0x40000000, v248
    v_mfma_f32_16x16x32_bf16 v[44:47], a[36:39], a[68:71], v[44:47]
    v_mfma_f32_16x16x32_bf16 v[48:51], a[40:43], a[64:67], v[48:51]
    ds_read_b128 a[76:79], v149 offset:2048
    v_fmamk_f32 v7, v251, 0x40400000, v248
    v_mfma_f32_16x16x32_bf16 v[52:55], a[40:43], a[68:71], v[52:55]
    ds_read_b128 a[80:83], v149 offset:4096
    buffer_load_dwordx4 v20, s[12:15], s36 offen offset:0  lds
    v_cos_f32 v120, v4
    v_mfma_f32_16x16x32_bf16 v[56:59], a[44:47], a[64:67], v[56:59]
    v_mfma_f32_16x16x32_bf16 v[60:63], a[44:47], a[68:71], v[60:63]
    ds_read_b128 a[84:87], v149 offset:6144
    v_cos_f32_e64 v121, v5
    v_mfma_f32_16x16x32_bf16 v[64:67], a[48:51], a[64:67], v[64:67]
    ds_read_b128 a[88:91], v149 offset:8192
    buffer_load_dwordx4 v21, s[12:15], s36 offen offset:1024  lds
    v_cos_f32_e64 v122, v6
    v_mfma_f32_16x16x32_bf16 v[68:71], a[48:51], a[68:71], v[68:71]
    ds_read_b128 a[92:95], v149 offset:10240
    v_mfma_f32_16x16x32_bf16 v[72:75], a[52:55], a[64:67], v[72:75]
    buffer_load_dwordx4 v22, s[12:15], s36 offen offset:2048  lds
    v_cos_f32_e64 v123, v7
    v_mfma_f32_16x16x32_bf16 v[76:79], a[52:55], a[68:71], v[76:79]
    ds_read_b128 a[96:99], v149 offset:12288
    v_sin_f32_e64 v124, v4
    v_mfma_f32_16x16x32_bf16 v[80:83], a[56:59], a[64:67], v[80:83]
    ds_read_b128 a[100:103], v149 offset:14336
    v_mfma_f32_16x16x32_bf16 v[84:87], a[56:59], a[68:71], v[84:87]
    buffer_load_dwordx4 v23, s[12:15], s36 offen offset:3072  lds
    v_sin_f32_e64 v125, v5
    v_mfma_f32_16x16x32_bf16 v[88:91], a[60:63], a[64:67], v[88:91]
    v_sin_f32_e64 v126, v6
    v_mfma_f32_16x16x32_bf16 v[92:95], a[60:63], a[68:71], v[92:95]
    s_waitcnt lgkmcnt(0) vmcnt(16)
    s_barrier
    v_mfma_f32_16x16x32_bf16 v[32:35], a[72:75], a[104:107], v[32:35]
    ds_read_b128 a[64:67], v150 offset:32768
    s_bfe_u32 s36, s67, 262168
    v_sin_f32_e64 v127, v7
    v_mfma_f32_16x16x32_bf16 v[36:39], a[72:75], a[108:111], v[36:39]
    ds_read_b128 a[68:71], v150 offset:40960
    v_mul_f32_e64 v120, v15, v120
    v_mfma_f32_16x16x32_bf16 v[40:43], a[76:79], a[104:107], v[40:43]
    ds_read_b128 a[32:35], v148 offset:32768
    s_add_u32 m0, s37, 65536
    v_mfma_f32_16x16x32_bf16 v[44:47], a[76:79], a[108:111], v[44:47]
    v_mul_f32_e64 v121, v15, v121
    v_mfma_f32_16x16x32_bf16 v[48:51], a[80:83], a[104:107], v[48:51]
    ds_read_b128 a[36:39], v148 offset:34816
    v_mfma_f32_16x16x32_bf16 v[52:55], a[80:83], a[108:111], v[52:55]
    ds_read_b128 a[40:43], v148 offset:36864
    s_lshl_b32 s36, s36, 7
    v_mul_f32 v122, v15, v122
    v_mfma_f32_16x16x32_bf16 v[56:59], a[84:87], a[104:107], v[56:59]
    v_mfma_f32_16x16x32_bf16 v[60:63], a[84:87], a[108:111], v[60:63]
    ds_read_b128 a[44:47], v148 offset:38912
    v_mul_f32_e64 v123, v15, v123
    v_mfma_f32_16x16x32_bf16 v[64:67], a[88:91], a[104:107], v[64:67]
    ds_read_b128 a[48:51], v148 offset:40960
    buffer_load_dwordx4 v16, s[8:11], s36 offen offset:0  lds
    v_mul_f32_e64 v124, v15, v124
    v_mfma_f32_16x16x32_bf16 v[68:71], a[88:91], a[108:111], v[68:71]
    ds_read_b128 a[52:55], v148 offset:43008
    v_mfma_f32_16x16x32_bf16 v[72:75], a[92:95], a[104:107], v[72:75]
    buffer_load_dwordx4 v17, s[8:11], s36 offen offset:1024  lds
    v_mul_f32_e64 v125, v15, v125
    v_mfma_f32_16x16x32_bf16 v[76:79], a[92:95], a[108:111], v[76:79]
    ds_read_b128 a[56:59], v148 offset:45056
    v_mfma_f32_16x16x32_bf16 v[80:83], a[96:99], a[104:107], v[80:83]
    ds_read_b128 a[60:63], v148 offset:47104
    v_mul_f32_e64 v126, v15, v126
    v_mfma_f32_16x16x32_bf16 v[84:87], a[96:99], a[108:111], v[84:87]
    buffer_load_dwordx4 v18, s[8:11], s36 offen offset:2048  lds
    v_mfma_f32_16x16x32_bf16 v[88:91], a[100:103], a[104:107], v[88:91]
    v_mul_f32_e64 v127, v15, v127
    v_mfma_f32_16x16x32_bf16 v[92:95], a[100:103], a[108:111], v[92:95]
    s_waitcnt lgkmcnt(0)
    v_mfma_f32_16x16x32_bf16 v[32:35], a[32:35], a[64:67], v[32:35]
    ds_read_b128 a[104:107], v151 offset:32768
    buffer_load_dwordx4 v19, s[8:11], s36 offen offset:3072  lds
    v_mfma_f32_16x16x32_bf16 v[36:39], a[32:35], a[68:71], v[36:39]
    ds_read_b128 a[108:111], v151 offset:40960
    v_mfma_f32_16x16x32_bf16 v[40:43], a[36:39], a[64:67], v[40:43]
    ds_read_b128 a[72:75], v149 offset:32768
    s_add_u32 m0, s37, 81920
    v_mfma_f32_16x16x32_bf16 v[44:47], a[36:39], a[68:71], v[44:47]
    v_mfma_f32_16x16x32_bf16 v[48:51], a[40:43], a[64:67], v[48:51]
    ds_read_b128 a[76:79], v149 offset:34816
    v_mfma_f32_16x16x32_bf16 v[52:55], a[40:43], a[68:71], v[52:55]
    ds_read_b128 a[80:83], v149 offset:36864
    buffer_load_dwordx4 v20, s[12:15], s36 offen offset:0  lds
    v_mfma_f32_16x16x32_bf16 v[56:59], a[44:47], a[64:67], v[56:59]
    v_mfma_f32_16x16x32_bf16 v[60:63], a[44:47], a[68:71], v[60:63]
    ds_read_b128 a[84:87], v149 offset:38912
    v_mfma_f32_16x16x32_bf16 v[64:67], a[48:51], a[64:67], v[64:67]
    ds_read_b128 a[88:91], v149 offset:40960
    buffer_load_dwordx4 v21, s[12:15], s36 offen offset:1024  lds
    v_mfma_f32_16x16x32_bf16 v[68:71], a[48:51], a[68:71], v[68:71]
    ds_read_b128 a[92:95], v149 offset:43008
    v_mfma_f32_16x16x32_bf16 v[72:75], a[52:55], a[64:67], v[72:75]
    buffer_load_dwordx4 v22, s[12:15], s36 offen offset:2048  lds
    v_mfma_f32_16x16x32_bf16 v[76:79], a[52:55], a[68:71], v[76:79]
    ds_read_b128 a[96:99], v149 offset:45056
    v_mfma_f32_16x16x32_bf16 v[80:83], a[56:59], a[64:67], v[80:83]
    ds_read_b128 a[100:103], v149 offset:47104
    v_mfma_f32_16x16x32_bf16 v[84:87], a[56:59], a[68:71], v[84:87]
    buffer_load_dwordx4 v23, s[12:15], s36 offen offset:3072  lds
    v_mfma_f32_16x16x32_bf16 v[88:91], a[60:63], a[64:67], v[88:91]
    v_mfma_f32_16x16x32_bf16 v[92:95], a[60:63], a[68:71], v[92:95]
    s_waitcnt lgkmcnt(0) vmcnt(16)
    s_barrier
    v_mfma_f32_16x16x32_bf16 v[32:35], a[72:75], a[104:107], v[32:35]
    ds_read_b128 a[64:67], v26 offset:0
    v_lshlrev_b32 v217, 3, v0
    v_mfma_f32_16x16x32_bf16 v[36:39], a[72:75], a[108:111], v[36:39]
    ds_read_b128 a[68:71], v26 offset:8192
    s_lshl_b32 s68, s34, 9
    v_mfma_f32_16x16x32_bf16 v[40:43], a[76:79], a[104:107], v[40:43]
    ds_read_b128 a[32:35], v24 offset:0
    s_add_u32 s68, s68, 22347776
    v_mfma_f32_16x16x32_bf16 v[44:47], a[76:79], a[108:111], v[44:47]
    v_mfma_f32_16x16x32_bf16 v[48:51], a[80:83], a[104:107], v[48:51]
    ds_read_b128 a[36:39], v24 offset:2048
    buffer_load_dword v216, v217, s[24:27], s68 offen sc1
    v_mfma_f32_16x16x32_bf16 v[52:55], a[80:83], a[108:111], v[52:55]
    ds_read_b128 a[40:43], v24 offset:4096
    s_bfe_u32 s36, s67, 262172
    v_mfma_f32_16x16x32_bf16 v[56:59], a[84:87], a[104:107], v[56:59]
    v_mfma_f32_16x16x32_bf16 v[60:63], a[84:87], a[108:111], v[60:63]
    ds_read_b128 a[44:47], v24 offset:6144
    s_add_u32 m0, s37, 98304
    v_mfma_f32_16x16x32_bf16 v[64:67], a[88:91], a[104:107], v[64:67]
    ds_read_b128 a[48:51], v24 offset:8192
    s_lshl_b32 s36, s36, 7
    v_mfma_f32_16x16x32_bf16 v[68:71], a[88:91], a[108:111], v[68:71]
    ds_read_b128 a[52:55], v24 offset:10240
    v_mfma_f32_16x16x32_bf16 v[72:75], a[92:95], a[104:107], v[72:75]
    buffer_load_dwordx4 v16, s[8:11], s36 offen offset:0  lds
    v_mfma_f32_16x16x32_bf16 v[76:79], a[92:95], a[108:111], v[76:79]
    ds_read_b128 a[56:59], v24 offset:12288
    buffer_load_dwordx4 v17, s[8:11], s36 offen offset:1024  lds
    v_mfma_f32_16x16x32_bf16 v[80:83], a[96:99], a[104:107], v[80:83]
    ds_read_b128 a[60:63], v24 offset:14336
    v_mfma_f32_16x16x32_bf16 v[84:87], a[96:99], a[108:111], v[84:87]
    buffer_load_dwordx4 v18, s[8:11], s36 offen offset:2048  lds
    v_mfma_f32_16x16x32_bf16 v[88:91], a[100:103], a[104:107], v[88:91]
    buffer_load_dwordx4 v19, s[8:11], s36 offen offset:3072  lds
    v_mfma_f32_16x16x32_bf16 v[92:95], a[100:103], a[108:111], v[92:95]
    s_waitcnt lgkmcnt(0)
    v_mfma_f32_16x16x32_bf16 v[32:35], a[32:35], a[64:67], v[32:35]
    ds_read_b128 a[104:107], v27 offset:0
    s_add_u32 m0, s37, 114688
    v_and_b32 v6, 7, v0
    v_xor_b32_e64 v6, v6, v2
    v_mfma_f32_16x16x32_bf16 v[36:39], a[32:35], a[68:71], v[36:39]
    ds_read_b128 a[108:111], v27 offset:8192
    buffer_load_dwordx4 v20, s[12:15], s36 offen offset:0  lds
    s_and_b32 s38, s33, 8
    s_lshl_b32 s38, s38, 7
    v_mfma_f32_16x16x32_bf16 v[40:43], a[36:39], a[64:67], v[40:43]
    ds_read_b128 a[72:75], v25 offset:0
    buffer_load_dwordx4 v21, s[12:15], s36 offen offset:1024  lds
    v_lshl_add_u32 v6, v6, 4, s38
    v_lshrrev_b32_e64 v8, 3, v0
    v_mfma_f32_16x16x32_bf16 v[44:47], a[36:39], a[68:71], v[44:47]
    s_xor_b32 s38, s33, 8
    v_mfma_f32_16x16x32_bf16 v[48:51], a[40:43], a[64:67], v[48:51]
    ds_read_b128 a[76:79], v25 offset:2048
    buffer_load_dwordx4 v22, s[12:15], s36 offen offset:2048  lds
    s_lshl_b32 s38, s38, 5
    s_add_u32 s38, s38, s6
    v_mfma_f32_16x16x32_bf16 v[52:55], a[40:43], a[68:71], v[52:55]
    ds_read_b128 a[80:83], v25 offset:4096
    buffer_load_dwordx4 v23, s[12:15], s36 offen offset:3072  lds
    s_lshl_b32 s38, s38, 1
    v_lshl_add_u32 v8, v8, 2, s38
    v_mfma_f32_16x16x32_bf16 v[56:59], a[44:47], a[64:67], v[56:59]
    v_lshl_add_u32 v16, v8, 11, v6
    v_mfma_f32_16x16x32_bf16 v[60:63], a[44:47], a[68:71], v[60:63]
    ds_read_b128 a[84:87], v25 offset:6144
    s_getpc_b64 s[20:21]
K_PC2:
    s_mov_b32 s22, K_CODE_END-K_PC2
    v_xor_b32 v8, 64, v16
    v_add_u32 v17, 64512, v8
    v_mfma_f32_16x16x32_bf16 v[64:67], a[48:51], a[64:67], v[64:67]
    ds_read_b128 a[88:91], v25 offset:8192
    s_bfe_u32 s3, s2, 0x20003
    v_mov_b32_e64 v18, v16
    v_add_u32 v19, 64512, v8
    v_mfma_f32_16x16x32_bf16 v[68:71], a[48:51], a[68:71], v[68:71]
    ds_read_b128 a[92:95], v25 offset:10240
    s_lshl1_add_u32 s40, s33, s6
    v_mfma_f32_16x16x32_bf16 v[72:75], a[52:55], a[64:67], v[72:75]
    s_lshl2_add_u32 s3, s3, s34
    s_lshl_b32 s40, s40, 6
    s_lshr_b32 s41, s33, 3
    v_mfma_f32_16x16x32_bf16 v[76:79], a[52:55], a[68:71], v[76:79]
    ds_read_b128 a[96:99], v25 offset:12288
    s_lshl_b32 s3, s3, 11
    s_add_u32 s40, s40, s41
    s_and_b32 s41, s32, 3
    v_mfma_f32_16x16x32_bf16 v[80:83], a[56:59], a[64:67], v[80:83]
    ds_read_b128 a[100:103], v25 offset:14336
    s_lshl2_add_u32 s40, s40, s41
    v_mfma_f32_16x16x32_bf16 v[84:87], a[56:59], a[68:71], v[84:87]
    v_lshl_add_u32 v28, v0, 5, s3
    s_and_b32 s41, s2, 1
    s_lshl1_add_u32 s40, s40, s41
    v_mfma_f32_16x16x32_bf16 v[88:91], a[60:63], a[64:67], v[88:91]
    buffer_load_dword a221, v28, s[20:23], 0 offen
    s_lshl_b32 s92, s40, 7
    v_lshrrev_b32 v29, 1, v0
    v_mfma_f32_16x16x32_bf16 v[92:95], a[60:63], a[68:71], v[92:95]
    v_lshlrev_b32 v29, 11, v29
    s_waitcnt lgkmcnt(0) vmcnt(9)
    v_cmp_ne_u32 vcc, s35, v216
    s_nop 0
    s_cbranch_vccnz K_POLL1
K_POLL1_OK:
    s_barrier
    v_mfma_f32_16x16x32_bf16 v[32:35], a[72:75], a[104:107], v[32:35]
    ds_read_b128 a[64:67], v26 offset:32768
    v_lshlrev_b32_e64 v28, 12, v2
    v_mfma_f32_16x16x32_bf16 v[36:39], a[72:75], a[108:111], v[36:39]
    ds_read_b128 a[68:71], v26 offset:40960
    v_lshl_add_u32 v28, v1, 4, v28
    v_mfma_f32_16x16x32_bf16 v[40:43], a[76:79], a[104:107], v[40:43]
    ds_read_b128 a[32:35], v24 offset:32768
    s_lshl4_add_u32 s68, s37, s5
    v_mfma_f32_16x16x32_bf16 v[44:47], a[76:79], a[108:111], v[44:47]
    s_add_u32 m0, s37, 131072
    v_mfma_f32_16x16x32_bf16 v[48:51], a[80:83], a[104:107], v[48:51]
    ds_read_b128 a[36:39], v24 offset:34816
    s_add_u32 s69, s68, 0
    v_mfma_f32_16x16x32_bf16 v[52:55], a[80:83], a[108:111], v[52:55]
    ds_read_b128 a[40:43], v24 offset:36864
    v_mfma_f32_16x16x32_bf16 v[56:59], a[84:87], a[104:107], v[56:59]
    buffer_load_dwordx4 v28, s[28:31], s69 offen sc1 lds
    v_mfma_f32_16x16x32_bf16 v[60:63], a[84:87], a[108:111], v[60:63]
    ds_read_b128 a[44:47], v24 offset:38912
    s_add_u32 m0, s37, 132096
    v_mfma_f32_16x16x32_bf16 v[64:67], a[88:91], a[104:107], v[64:67]
    ds_read_b128 a[48:51], v24 offset:40960
    s_add_u32 s69, s68, 16384
    v_mfma_f32_16x16x32_bf16 v[68:71], a[88:91], a[108:111], v[68:71]
    ds_read_b128 a[52:55], v24 offset:43008
    buffer_load_dwordx4 v28, s[28:31], s69 offen sc1 lds
    v_mfma_f32_16x16x32_bf16 v[72:75], a[92:95], a[104:107], v[72:75]
    v_mfma_f32_16x16x32_bf16 v[76:79], a[92:95], a[108:111], v[76:79]
    ds_read_b128 a[56:59], v24 offset:45056
    s_add_u32 m0, s37, 133120
    v_mfma_f32_16x16x32_bf16 v[80:83], a[96:99], a[104:107], v[80:83]
    ds_read_b128 a[60:63], v24 offset:47104
    s_add_u32 s69, s68, 32768
    v_mfma_f32_16x16x32_bf16 v[84:87], a[96:99], a[108:111], v[84:87]
    buffer_load_dwordx4 v28, s[28:31], s69 offen sc1 lds
    v_mfma_f32_16x16x32_bf16 v[88:91], a[100:103], a[104:107], v[88:91]
    s_add_u32 m0, s37, 134144
    v_mfma_f32_16x16x32_bf16 v[92:95], a[100:103], a[108:111], v[92:95]
    s_waitcnt lgkmcnt(0)
    v_mfma_f32_16x16x32_bf16 v[32:35], a[32:35], a[64:67], v[32:35]
    ds_read_b128 a[104:107], v27 offset:32768
    s_add_u32 s69, s68, 49152
    v_mfma_f32_16x16x32_bf16 v[36:39], a[32:35], a[68:71], v[36:39]
    ds_read_b128 a[108:111], v27 offset:40960
    buffer_load_dwordx4 v28, s[28:31], s69 offen sc1 lds
    v_mfma_f32_16x16x32_bf16 v[40:43], a[36:39], a[64:67], v[40:43]
    ds_read_b128 a[72:75], v25 offset:32768
    s_add_u32 s69, s68, 262144
    v_mfma_f32_16x16x32_bf16 v[44:47], a[36:39], a[68:71], v[44:47]
    buffer_load_dwordx4 v[200:203], v28, s[28:31], s69 offen sc1
    v_mfma_f32_16x16x32_bf16 v[48:51], a[40:43], a[64:67], v[48:51]
    ds_read_b128 a[76:79], v25 offset:34816
    s_add_u32 s69, s68, 278528
    v_mfma_f32_16x16x32_bf16 v[52:55], a[40:43], a[68:71], v[52:55]
    ds_read_b128 a[80:83], v25 offset:36864
    v_mfma_f32_16x16x32_bf16 v[56:59], a[44:47], a[64:67], v[56:59]
    buffer_load_dwordx4 v[204:207], v28, s[28:31], s69 offen sc1
    v_mfma_f32_16x16x32_bf16 v[60:63], a[44:47], a[68:71], v[60:63]
    ds_read_b128 a[84:87], v25 offset:38912
    s_add_u32 s69, s68, 294912
    v_mfma_f32_16x16x32_bf16 v[64:67], a[48:51], a[64:67], v[64:67]
    ds_read_b128 a[88:91], v25 offset:40960
    buffer_load_dwordx4 v[208:211], v28, s[28:31], s69 offen sc1
    v_mfma_f32_16x16x32_bf16 v[68:71], a[48:51], a[68:71], v[68:71]
    ds_read_b128 a[92:95], v25 offset:43008
    s_add_u32 s69, s68, 311296
    v_mfma_f32_16x16x32_bf16 v[72:75], a[52:55], a[64:67], v[72:75]
    v_mfma_f32_16x16x32_bf16 v[76:79], a[52:55], a[68:71], v[76:79]
    ds_read_b128 a[96:99], v25 offset:45056
    buffer_load_dwordx4 v[212:215], v28, s[28:31], s69 offen sc1
    v_mfma_f32_16x16x32_bf16 v[80:83], a[56:59], a[64:67], v[80:83]
    ds_read_b128 a[100:103], v25 offset:47104
    s_cmp_eq_u32 s2, 0
    s_cbranch_scc1 K_W256
K_W256_RET:
    v_mfma_f32_16x16x32_bf16 v[84:87], a[56:59], a[68:71], v[84:87]
    v_lshlrev_b32 v28, 6, v1
    v_mfma_f32_16x16x32_bf16 v[88:91], a[60:63], a[64:67], v[88:91]
    buffer_load_dword a222, v28, s[24:27], s51 offen sc1
    v_mfma_f32_16x16x32_bf16 v[92:95], a[60:63], a[68:71], v[92:95]
    s_waitcnt lgkmcnt(0)
    s_barrier
    v_mfma_f32_16x16x32_bf16 v[32:35], a[72:75], a[104:107], v[32:35]
    ds_read_b128 a[64:67], v150 offset:0
    v_and_b32_e64 v14, 8, v1
    v_mfma_f32_16x16x32_bf16 v[36:39], a[72:75], a[108:111], v[36:39]
    ds_read_b128 a[68:71], v150 offset:8192
    v_and_b32_e64 v15, 3, v1
    v_mfma_f32_16x16x32_bf16 v[40:43], a[76:79], a[104:107], v[40:43]
    ds_read_b128 a[32:35], v148 offset:0
    v_lshl_or_b32 v14, v15, 1, v14
    v_mfma_f32_16x16x32_bf16 v[44:47], a[76:79], a[108:111], v[44:47]
    v_bfe_u32 v15, v1, 2, 1
    v_mfma_f32_16x16x32_bf16 v[48:51], a[80:83], a[104:107], v[48:51]
    ds_read_b128 a[36:39], v148 offset:2048
    v_lshlrev_b32_e64 v13, 2, v2
    v_mfma_f32_16x16x32_bf16 v[52:55], a[80:83], a[108:111], v[52:55]
    ds_read_b128 a[40:43], v148 offset:4096
    v_or_b32_e64 v14, v14, v15
    v_mfma_f32_16x16x32_bf16 v[56:59], a[84:87], a[104:107], v[56:59]
    v_xor_b32_e64 v14, v14, v13
    v_mfma_f32_16x16x32_bf16 v[60:63], a[84:87], a[108:111], v[60:63]
    ds_read_b128 a[44:47], v148 offset:6144
    v_lshl_add_u32 v14, v1, 4, v14
    v_mfma_f32_16x16x32_bf16 v[64:67], a[88:91], a[104:107], v[64:67]
    ds_read_b128 a[48:51], v148 offset:8192
    s_lshl1_add_u32 s38, s37, 131072
    v_mfma_f32_16x16x32_bf16 v[68:71], a[88:91], a[108:111], v[68:71]
    ds_read_b128 a[52:55], v148 offset:10240
    v_lshl_add_u32 v216, v14, 4, s38
    v_mfma_f32_16x16x32_bf16 v[72:75], a[92:95], a[104:107], v[72:75]
    v_xor_b32_e64 v217, 16, v216
    v_mfma_f32_16x16x32_bf16 v[76:79], a[92:95], a[108:111], v[76:79]
    ds_read_b128 a[56:59], v148 offset:12288
    v_xor_b32_e64 v218, 32, v216
    v_mfma_f32_16x16x32_bf16 v[80:83], a[96:99], a[104:107], v[80:83]
    ds_read_b128 a[60:63], v148 offset:14336
    v_xor_b32_e64 v219, 48, v216
    v_mfma_f32_16x16x32_bf16 v[84:87], a[96:99], a[108:111], v[84:87]
    v_and_b32_e64 v14, 1, v2
    v_mfma_f32_16x16x32_bf16 v[88:91], a[100:103], a[104:107], v[88:91]
    v_lshrrev_b32_e64 v15, 2, v1
    v_mfma_f32_16x16x32_bf16 v[92:95], a[100:103], a[108:111], v[92:95]
    s_waitcnt lgkmcnt(0)
    v_mfma_f32_16x16x32_bf16 v[32:35], a[32:35], a[64:67], v[32:35]
    ds_read_b128 a[104:107], v151 offset:0
    v_lshl_add_u32 v12, v2, 3, v15
    v_mfma_f32_16x16x32_bf16 v[36:39], a[32:35], a[68:71], v[36:39]
    ds_read_b128 a[108:111], v151 offset:8192
    v_lshlrev_b32 v14, 3, v14
    v_mfma_f32_16x16x32_bf16 v[40:43], a[36:39], a[64:67], v[40:43]
    ds_read_b128 a[72:75], v149 offset:0
    v_lshl_or_b32 v14, v15, 1, v14
    v_mfma_f32_16x16x32_bf16 v[44:47], a[36:39], a[68:71], v[44:47]
    v_bfe_u32 v15, v1, 1, 1
    v_mfma_f32_16x16x32_bf16 v[48:51], a[40:43], a[64:67], v[48:51]
    ds_read_b128 a[76:79], v149 offset:2048
    v_xor_b32_e64 v14, v14, v15
    v_mfma_f32_16x16x32_bf16 v[52:55], a[40:43], a[68:71], v[52:55]
    ds_read_b128 a[80:83], v149 offset:4096
    v_lshl_add_u32 v12, v12, 4, v14
    v_mfma_f32_16x16x32_bf16 v[56:59], a[44:47], a[64:67], v[56:59]
    v_and_b32_e64 v15, 1, v1
    v_mfma_f32_16x16x32_bf16 v[60:63], a[44:47], a[68:71], v[60:63]
    ds_read_b128 a[84:87], v149 offset:6144
    v_lshl_add_u32 v12, v12, 1, v15
    v_mfma_f32_16x16x32_bf16 v[64:67], a[48:51], a[64:67], v[64:67]
    ds_read_b128 a[88:91], v149 offset:8192
    s_lshl_b32 s38, s94, 5
    v_mfma_f32_16x16x32_bf16 v[68:71], a[48:51], a[68:71], v[68:71]
    ds_read_b128 a[92:95], v149 offset:10240
    s_add_u32 s38, s38, 131072
    v_mfma_f32_16x16x32_bf16 v[72:75], a[52:55], a[64:67], v[72:75]
    v_lshlrev_b32 v12, 3, v12
    v_mfma_f32_16x16x32_bf16 v[76:79], a[52:55], a[68:71], v[76:79]
    ds_read_b128 a[96:99], v149 offset:12288
    v_xor_b32_e64 v220, s38, v12
    v_mfma_f32_16x16x32_bf16 v[80:83], a[56:59], a[64:67], v[80:83]
    ds_read_b128 a[100:103], v149 offset:14336
    v_xor_b32_e64 v221, 16, v220
    v_mfma_f32_16x16x32_bf16 v[84:87], a[56:59], a[68:71], v[84:87]
    v_xor_b32_e64 v222, 64, v220
    v_mfma_f32_16x16x32_bf16 v[88:91], a[60:63], a[64:67], v[88:91]
    v_xor_b32 v223, 80, v220
    v_mfma_f32_16x16x32_bf16 v[92:95], a[60:63], a[68:71], v[92:95]
    s_waitcnt lgkmcnt(0) vmcnt(10)
    s_barrier
    v_mfma_f32_16x16x32_bf16 v[32:35], a[72:75], a[104:107], v[32:35]
    ds_read_b128 a[64:67], v150 offset:32768
    s_bfe_u32 s72, s97, 262148
    v_and_b32_e64 v8, 1, v2
    v_mfma_f32_16x16x32_bf16 v[36:39], a[72:75], a[108:111], v[36:39]
    ds_read_b128 a[68:71], v150 offset:40960
    v_lshrrev_b32_e64 v9, 1, v1
    v_mfma_f32_16x16x32_bf16 v[40:43], a[76:79], a[104:107], v[40:43]
    ds_read_b128 a[32:35], v148 offset:32768
    v_xor_b32_e64 v8, v8, v9
    v_mfma_f32_16x16x32_bf16 v[44:47], a[76:79], a[108:111], v[44:47]
    v_lshlrev_b32_e64 v8, 4, v8
    v_mfma_f32_16x16x32_bf16 v[48:51], a[80:83], a[104:107], v[48:51]
    ds_read_b128 a[36:39], v148 offset:34816
    s_add_u32 m0, s37, 16384
    v_lshl_add_u32 v8, v1, 7, v8
    v_mfma_f32_16x16x32_bf16 v[52:55], a[80:83], a[108:111], v[52:55]
    ds_read_b128 a[40:43], v148 offset:36864
    v_lshrrev_b32_e64 v9, 1, v2
    v_mfma_f32_16x16x32_bf16 v[56:59], a[84:87], a[104:107], v[56:59]
    v_lshl_add_u32 v20, v9, 13, v8
    v_mfma_f32_16x16x32_bf16 v[60:63], a[84:87], a[108:111], v[60:63]
    ds_read_b128 a[44:47], v148 offset:38912
    v_lshlrev_b32_e64 v9, 12, v2
    v_mfma_f32_16x16x32_bf16 v[64:67], a[88:91], a[104:107], v[64:67]
    ds_read_b128 a[48:51], v148 offset:40960
    s_lshl_b32 s72, s72, 7
    v_lshl_add_u32 v24, v1, 4, v9
    v_mfma_f32_16x16x32_bf16 v[68:71], a[88:91], a[108:111], v[68:71]
    ds_read_b128 a[52:55], v148 offset:43008
    v_xor_b32 v21, 32, v20
    v_mfma_f32_16x16x32_bf16 v[72:75], a[92:95], a[104:107], v[72:75]
    v_add_u32 v25, 16384, v24
    v_mfma_f32_16x16x32_bf16 v[76:79], a[92:95], a[108:111], v[76:79]
    ds_read_b128 a[56:59], v148 offset:45056
    v_xor_b32_e64 v22, 64, v20
    v_mfma_f32_16x16x32_bf16 v[80:83], a[96:99], a[104:107], v[80:83]
    ds_read_b128 a[60:63], v148 offset:47104
    buffer_load_dwordx4 v16, s[16:19], s72 offen offset:0  lds
    v_add_u32 v26, 32768, v24
    v_mfma_f32_16x16x32_bf16 v[84:87], a[96:99], a[108:111], v[84:87]
    v_xor_b32 v23, 96, v20
    v_mfma_f32_16x16x32_bf16 v[88:91], a[100:103], a[104:107], v[88:91]
    v_add_u32 v27, 49152, v24
    v_mfma_f32_16x16x32_bf16 v[92:95], a[100:103], a[108:111], v[92:95]
    s_waitcnt lgkmcnt(0)
    v_mfma_f32_16x16x32_bf16 v[32:35], a[32:35], a[64:67], v[32:35]
    ds_read_b128 a[104:107], v151 offset:32768
    buffer_load_dwordx4 v17, s[16:19], s72 offen offset:1024  lds
    v_add_u32 v28, 131072, v3
    v_mfma_f32_16x16x32_bf16 v[36:39], a[32:35], a[68:71], v[36:39]
    ds_read_b128 a[108:111], v151 offset:40960
    v_mfma_f32_16x16x32_bf16 v[40:43], a[36:39], a[64:67], v[40:43]
    ds_read_b128 a[72:75], v149 offset:32768
    v_mfma_f32_16x16x32_bf16 v[44:47], a[36:39], a[68:71], v[44:47]
    v_mfma_f32_16x16x32_bf16 v[48:51], a[40:43], a[64:67], v[48:51]
    ds_read_b128 a[76:79], v149 offset:34816
    v_mfma_f32_16x16x32_bf16 v[52:55], a[40:43], a[68:71], v[52:55]
    ds_read_b128 a[80:83], v149 offset:36864
    buffer_load_dwordx4 v18, s[16:19], s72 offen offset:2048  lds
    v_mfma_f32_16x16x32_bf16 v[56:59], a[44:47], a[64:67], v[56:59]
    v_mfma_f32_16x16x32_bf16 v[60:63], a[44:47], a[68:71], v[60:63]
    ds_read_b128 a[84:87], v149 offset:38912
    v_mfma_f32_16x16x32_bf16 v[64:67], a[48:51], a[64:67], v[64:67]
    ds_read_b128 a[88:91], v149 offset:40960
    v_mfma_f32_16x16x32_bf16 v[68:71], a[48:51], a[68:71], v[68:71]
    ds_read_b128 a[92:95], v149 offset:43008
    v_mfma_f32_16x16x32_bf16 v[72:75], a[52:55], a[64:67], v[72:75]
    buffer_load_dwordx4 v19, s[16:19], s72 offen offset:3072  lds
    v_mfma_f32_16x16x32_bf16 v[76:79], a[52:55], a[68:71], v[76:79]
    ds_read_b128 a[96:99], v149 offset:45056
    v_mfma_f32_16x16x32_bf16 v[80:83], a[56:59], a[64:67], v[80:83]
    ds_read_b128 a[100:103], v149 offset:47104
    v_mfma_f32_16x16x32_bf16 v[84:87], a[56:59], a[68:71], v[84:87]
    v_mfma_f32_16x16x32_bf16 v[88:91], a[60:63], a[64:67], v[88:91]
    v_mfma_f32_16x16x32_bf16 v[92:95], a[60:63], a[68:71], v[92:95]
    s_waitcnt lgkmcnt(0) vmcnt(9)
    s_barrier
    v_mfma_f32_16x16x32_bf16 v[32:35], a[72:75], a[104:107], v[32:35]
    ds_read_b128 a[32:35], v28 offset:0
    v_lshlrev_b32 v12, 2, v2
    v_sub_u32_e64 v12, s32, v12
    v_mfma_f32_16x16x32_bf16 v[36:39], a[72:75], a[108:111], v[36:39]
    ds_read_b128 a[36:39], v28 offset:1024
    v_lshlrev_b32_e64 v12, 10, v12
    v_mfma_f32_16x16x32_bf16 v[40:43], a[76:79], a[104:107], v[40:43]
    ds_read_b128 a[40:43], v28 offset:2048
    v_lshl_add_u32 v12, v1, 4, v12
    v_subrev_u32 v148, 1024, v12
    v_mfma_f32_16x16x32_bf16 v[44:47], a[76:79], a[108:111], v[44:47]
    v_min_u32_e64 v148, 2.0, v148
    v_mfma_f32_16x16x32_bf16 v[48:51], a[80:83], a[104:107], v[48:51]
    ds_read_b128 a[44:47], v28 offset:3072
    v_subrev_u32 v149, 2048, v12
    v_min_u32_e64 v149, 2.0, v149
    v_mfma_f32_16x16x32_bf16 v[52:55], a[80:83], a[108:111], v[52:55]
    ds_read_b128 a[48:51], v28 offset:4096
    v_subrev_u32 v150, 3072, v12
    v_mfma_f32_16x16x32_bf16 v[56:59], a[84:87], a[104:107], v[56:59]
    ds_read_b128 a[52:55], v28 offset:5120
    v_min_u32_e64 v150, 2.0, v150
    v_subrev_u32 v151, 4096, v12
    v_mfma_f32_16x16x32_bf16 v[60:63], a[84:87], a[108:111], v[60:63]
    v_min_u32_e64 v151, 2.0, v151
    v_mfma_f32_16x16x32_bf16 v[64:67], a[88:91], a[104:107], v[64:67]
    ds_read_b128 a[56:59], v28 offset:6144
    v_mov_b32 v186, s35
    v_mov_b32 v187, s35
    v_mfma_f32_16x16x32_bf16 v[68:71], a[88:91], a[108:111], v[68:71]
    ds_read_b128 a[60:63], v28 offset:7168
    s_lshl_b32 s38, s32, 10
    v_mfma_f32_16x16x32_bf16 v[72:75], a[92:95], a[104:107], v[72:75]
    s_add_u32 s38, s38, s93
    v_cmp_gt_u32 s[78:79], 16, v0
    v_mfma_f32_16x16x32_bf16 v[76:79], a[92:95], a[108:111], v[76:79]
    v_cmp_eq_u32 s[46:47], 2, v2
    v_mfma_f32_16x16x32_bf16 v[80:83], a[96:99], a[104:107], v[80:83]
    v_cmp_eq_u32 s[44:45], 3, v2
    v_cndmask_b32 v188, 2.0, v3, s[78:79]
    v_mfma_f32_16x16x32_bf16 v[84:87], a[96:99], a[108:111], v[84:87]
    v_cmp_ne_u32 s[80:81], 2.0, v148
    v_mfma_f32_16x16x32_bf16 v[88:91], a[100:103], a[104:107], v[88:91]
    v_cmp_ne_u32 s[82:83], 2.0, v149
    v_cmp_ne_u32 s[84:85], 2.0, v150
    v_mfma_f32_16x16x32_bf16 v[92:95], a[100:103], a[108:111], v[92:95]
    v_cmp_ne_u32 s[86:87], 2.0, v151
    v_pk_fma_f32 v[4:5], v[32:33], v[128:129], v[34:35] op_sel_hi:[1,0,1]
    v_pk_fma_f32 v[6:7], v[36:37], v[128:129], v[38:39] op_sel_hi:[1,0,1]
    v_pk_fma_f32 v[4:5], v[36:37], v[128:129], v[4:5] op_sel:[0,1,0] neg_lo:[1,0,0] neg_hi:[1,0,0]
    v_pk_fma_f32 v[6:7], v[32:33], v[128:129], v[6:7] op_sel:[0,1,0]
    v_pk_fma_f32 v[8:9], v[4:5], v[128:129], v[40:41] op_sel_hi:[1,0,1]
    v_pk_fma_f32 v[10:11], v[6:7], v[128:129], v[44:45] op_sel_hi:[1,0,1]
    v_pk_fma_f32 v[8:9], v[6:7], v[128:129], v[8:9] op_sel:[0,1,0] neg_lo:[1,0,0] neg_hi:[1,0,0]
    v_pk_fma_f32 v[10:11], v[4:5], v[128:129], v[10:11] op_sel:[0,1,0]
    v_pk_fma_f32 v[4:5], v[8:9], v[128:129], v[42:43] op_sel_hi:[1,0,1]
    v_pk_fma_f32 v[6:7], v[10:11], v[128:129], v[46:47] op_sel_hi:[1,0,1]
    v_pk_fma_f32 v[4:5], v[10:11], v[128:129], v[4:5] op_sel:[0,1,0] neg_lo:[1,0,0] neg_hi:[1,0,0]
    v_pk_fma_f32 v[6:7], v[8:9], v[128:129], v[6:7] op_sel:[0,1,0]
    v_pk_fma_f32 v[8:9], v[4:5], v[128:129], v[48:49] op_sel_hi:[1,0,1]
    v_pk_fma_f32 v[10:11], v[6:7], v[128:129], v[52:53] op_sel_hi:[1,0,1]
    v_pk_fma_f32 v[8:9], v[6:7], v[128:129], v[8:9] op_sel:[0,1,0] neg_lo:[1,0,0] neg_hi:[1,0,0]
    v_pk_fma_f32 v[10:11], v[4:5], v[128:129], v[10:11] op_sel:[0,1,0]
    v_pk_fma_f32 v[4:5], v[8:9], v[128:129], v[50:51] op_sel_hi:[1,0,1]
    v_pk_fma_f32 v[6:7], v[10:11], v[128:129], v[54:55] op_sel_hi:[1,0,1]
    v_pk_fma_f32 v[4:5], v[10:11], v[128:129], v[4:5] op_sel:[0,1,0] neg_lo:[1,0,0] neg_hi:[1,0,0]
    v_pk_fma_f32 v[6:7], v[8:9], v[128:129], v[6:7] op_sel:[0,1,0]
    v_pk_fma_f32 v[8:9], v[4:5], v[128:129], v[56:57] op_sel_hi:[1,0,1]
    v_pk_fma_f32 v[10:11], v[6:7], v[128:129], v[60:61] op_sel_hi:[1,0,1]
    v_pk_fma_f32 v[8:9], v[6:7], v[128:129], v[8:9] op_sel:[0,1,0] neg_lo:[1,0,0] neg_hi:[1,0,0]
    v_pk_fma_f32 v[10:11], v[4:5], v[128:129], v[10:11] op_sel:[0,1,0]
    v_pk_fma_f32 v[4:5], v[8:9], v[128:129], v[58:59] op_sel_hi:[1,0,1]
    v_pk_fma_f32 v[6:7], v[10:11], v[128:129], v[62:63] op_sel_hi:[1,0,1]
    v_pk_fma_f32 v[4:5], v[10:11], v[128:129], v[4:5] op_sel:[0,1,0] neg_lo:[1,0,0] neg_hi:[1,0,0]
    v_pk_fma_f32 v[6:7], v[8:9], v[128:129], v[6:7] op_sel:[0,1,0]
    v_pk_fma_f32 v[8:9], v[4:5], v[128:129], v[64:65] op_sel_hi:[1,0,1]
    v_pk_fma_f32 v[10:11], v[6:7], v[128:129], v[68:69] op_sel_hi:[1,0,1]
    v_pk_fma_f32 v[8:9], v[6:7], v[128:129], v[8:9] op_sel:[0,1,0] neg_lo:[1,0,0] neg_hi:[1,0,0]
    v_pk_fma_f32 v[10:11], v[4:5], v[128:129], v[10:11] op_sel:[0,1,0]
    v_pk_fma_f32 v[4:5], v[8:9], v[128:129], v[66:67] op_sel_hi:[1,0,1]
    v_pk_fma_f32 v[6:7], v[10:11], v[128:129], v[70:71] op_sel_hi:[1,0,1]
    v_pk_fma_f32 v[4:5], v[10:11], v[128:129], v[4:5] op_sel:[0,1,0] neg_lo:[1,0,0] neg_hi:[1,0,0]
    v_pk_fma_f32 v[6:7], v[8:9], v[128:129], v[6:7] op_sel:[0,1,0]
    v_pk_fma_f32 v[8:9], v[4:5], v[128:129], v[72:73] op_sel_hi:[1,0,1]
    v_pk_fma_f32 v[10:11], v[6:7], v[128:129], v[76:77] op_sel_hi:[1,0,1]
    v_pk_fma_f32 v[8:9], v[6:7], v[128:129], v[8:9] op_sel:[0,1,0] neg_lo:[1,0,0] neg_hi:[1,0,0]
    v_pk_fma_f32 v[10:11], v[4:5], v[128:129], v[10:11] op_sel:[0,1,0]
    v_pk_fma_f32 v[4:5], v[8:9], v[128:129], v[74:75] op_sel_hi:[1,0,1]
    v_pk_fma_f32 v[6:7], v[10:11], v[128:129], v[78:79] op_sel_hi:[1,0,1]
    v_pk_fma_f32 v[4:5], v[10:11], v[128:129], v[4:5] op_sel:[0,1,0] neg_lo:[1,0,0] neg_hi:[1,0,0]
    v_pk_fma_f32 v[6:7], v[8:9], v[128:129], v[6:7] op_sel:[0,1,0]
    v_pk_fma_f32 v[8:9], v[4:5], v[128:129], v[80:81] op_sel_hi:[1,0,1]
    v_pk_fma_f32 v[10:11], v[6:7], v[128:129], v[84:85] op_sel_hi:[1,0,1]
    v_pk_fma_f32 v[8:9], v[6:7], v[128:129], v[8:9] op_sel:[0,1,0] neg_lo:[1,0,0] neg_hi:[1,0,0]
    v_pk_fma_f32 v[10:11], v[4:5], v[128:129], v[10:11] op_sel:[0,1,0]
    v_pk_fma_f32 v[4:5], v[8:9], v[128:129], v[82:83] op_sel_hi:[1,0,1]
    v_pk_fma_f32 v[6:7], v[10:11], v[128:129], v[86:87] op_sel_hi:[1,0,1]
    v_pk_fma_f32 v[4:5], v[10:11], v[128:129], v[4:5] op_sel:[0,1,0] neg_lo:[1,0,0] neg_hi:[1,0,0]
    v_pk_fma_f32 v[6:7], v[8:9], v[128:129], v[6:7] op_sel:[0,1,0]
    v_pk_fma_f32 v[8:9], v[4:5], v[128:129], v[88:89] op_sel_hi:[1,0,1]
    v_pk_fma_f32 v[10:11], v[6:7], v[128:129], v[92:93] op_sel_hi:[1,0,1]
    v_pk_fma_f32 v[8:9], v[6:7], v[128:129], v[8:9] op_sel:[0,1,0] neg_lo:[1,0,0] neg_hi:[1,0,0]
    v_pk_fma_f32 v[10:11], v[4:5], v[128:129], v[10:11] op_sel:[0,1,0]
    v_pk_fma_f32 v[4:5], v[8:9], v[128:129], v[90:91] op_sel_hi:[1,0,1]
    v_pk_fma_f32 v[6:7], v[10:11], v[128:129], v[94:95] op_sel_hi:[1,0,1]
    v_pk_fma_f32 v[4:5], v[10:11], v[128:129], v[4:5] op_sel:[0,1,0] neg_lo:[1,0,0] neg_hi:[1,0,0]
    v_pk_fma_f32 v[6:7], v[8:9], v[128:129], v[6:7] op_sel:[0,1,0]
    v_pk_mul_f32 v[142:143], v[4:5], v[130:131] op_sel_hi:[1,0]
    v_pk_mul_f32 v[144:145], v[6:7], v[130:131] op_sel_hi:[1,0]
    v_pk_fma_f32 v[142:143], v[6:7], v[130:131], v[142:143] op_sel:[0,1,0] neg_lo:[1,0,0] neg_hi:[1,0,0]
    v_pk_fma_f32 v[144:145], v[4:5], v[130:131], v[144:145] op_sel:[0,1,0]
    s_waitcnt lgkmcnt(4)
    v_mfma_f32_16x16x32_bf16 v[224:227], a[32:35], a[0:3], 0
    ds_read_b128 a[64:67], v28 offset:8192
    v_fma_f32 v4, v142, v132, v143
    v_fma_f32 v8, v142, v133, v145
    v_mfma_f32_16x16x32_bf16 v[228:231], a[32:35], a[4:7], 0
    ds_read_b128 a[68:71], v28 offset:9216
    v_fma_f32 v4, -v144, v133, v4
    v_mfma_f32_16x16x32_bf16 v[224:227], a[36:39], a[8:11], v[224:227]
    ds_read_b128 a[72:75], v28 offset:10240
    v_fma_f32 v8, v144, v132, v8
    v_mov_b32 v6, v4
    v_mfma_f32_16x16x32_bf16 v[228:231], a[36:39], a[12:15], v[228:231]
    ds_read_b128 a[76:79], v28 offset:11264
    v_mov_b32_e64 v10, v8
    v_mfma_f32_16x16x32_bf16 v[224:227], a[40:43], a[16:19], v[224:227]
    ds_read_b128 a[80:83], v28 offset:12288
    v_permlane32_swap_b32 v4, v6
    v_mfma_f32_16x16x32_bf16 v[228:231], a[40:43], a[20:23], v[228:231]
    ds_read_b128 a[84:87], v28 offset:13312
    v_permlane32_swap_b32 v8, v10
    v_mov_b32_e64 v5, v4
    v_mfma_f32_16x16x32_bf16 v[224:227], a[44:47], a[24:27], v[224:227]
    ds_read_b128 a[88:91], v28 offset:14336
    v_mov_b32_e64 v7, v6
    v_mfma_f32_16x16x32_bf16 v[228:231], a[44:47], a[28:31], v[228:231]
    ds_read_b128 a[92:95], v28 offset:15360
    v_mov_b32 v9, v8
    v_mov_b32 v11, v10
    s_waitcnt lgkmcnt(8)
    s_bfe_u32 s72, s97, 262152
    v_permlane16_swap_b32 v4, v5
    v_mfma_f32_16x16x32_bf16 v[232:235], a[48:51], a[0:3], 0
    s_add_u32 m0, s37, 32768
    v_permlane16_swap_b32 v6, v7
    v_mfma_f32_16x16x32_bf16 v[236:239], a[48:51], a[4:7], 0
    v_permlane16_swap_b32 v8, v9
    v_permlane16_swap_b32 v10, v11
    v_mfma_f32_16x16x32_bf16 v[232:235], a[52:55], a[8:11], v[232:235]
    s_lshl_b32 s72, s72, 7
    v_fma_f32 v12, v4, v134, v5
    v_mfma_f32_16x16x32_bf16 v[236:239], a[52:55], a[12:15], v[236:239]
    v_fma_f32 v13, v4, v135, v9
    v_mfma_f32_16x16x32_bf16 v[232:235], a[56:59], a[16:19], v[232:235]
    buffer_load_dwordx4 v16, s[16:19], s72 offen offset:0  lds
    v_fma_f32 v12, -v8, v135, v12
    v_fma_f32 v13, v8, v134, v13
    v_mfma_f32_16x16x32_bf16 v[236:239], a[56:59], a[20:23], v[236:239]
    v_fma_f32 v14, v12, v134, v6
    v_mfma_f32_16x16x32_bf16 v[232:235], a[60:63], a[24:27], v[232:235]
    buffer_load_dwordx4 v17, s[16:19], s72 offen offset:1024  lds
    v_fma_f32 v15, v12, v135, v10
    v_fma_f32 v14, -v13, v135, v14
    v_mfma_f32_16x16x32_bf16 v[236:239], a[60:63], a[28:31], v[236:239]
    v_fma_f32 v15, v13, v134, v15
    s_waitcnt lgkmcnt(4)
    buffer_load_dwordx4 v18, s[16:19], s72 offen offset:2048  lds
    v_fma_f32 v184, v14, v134, v7
    v_mfma_f32_16x16x32_bf16 v[240:243], a[64:67], a[0:3], 0
    v_fma_f32 v185, v14, v135, v11
    v_fma_f32 v184, -v15, v135, v184
    v_mfma_f32_16x16x32_bf16 v[244:247], a[64:67], a[4:7], 0
    buffer_load_dwordx4 v19, s[16:19], s72 offen offset:3072  lds
    v_fma_f32 v185, v15, v134, v185
    v_mfma_f32_16x16x32_bf16 v[240:243], a[68:71], a[8:11], v[240:243]
    buffer_store_dwordx4 v[184:187], v188, s[24:27], s38 offen sc1
    v_mfma_f32_16x16x32_bf16 v[244:247], a[68:71], a[12:15], v[244:247]
    s_bfe_u32 s72, s97, 262144
    v_cndmask_b32 v146, v4, 0, s[78:79]
    v_mfma_f32_16x16x32_bf16 v[240:243], a[72:75], a[16:19], v[240:243]
    v_cndmask_b32 v147, v8, 0, s[78:79]
    v_mfma_f32_16x16x32_bf16 v[244:247], a[72:75], a[20:23], v[244:247]
    s_add_u32 m0, s37, 0
    v_cndmask_b32 v146, v146, v12, s[46:47]
    v_cndmask_b32 v147, v147, v13, s[46:47]
    v_mfma_f32_16x16x32_bf16 v[240:243], a[76:79], a[24:27], v[240:243]
    v_cndmask_b32 v146, v146, v14, s[44:45]
    v_mfma_f32_16x16x32_bf16 v[244:247], a[76:79], a[28:31], v[244:247]
    s_lshl_b32 s72, s72, 7
    v_cndmask_b32 v147, v147, v15, s[44:45]
    s_waitcnt lgkmcnt(0) vmcnt(9)
    v_lshlrev_b32_e64 v152, 16, v200
    v_mfma_f32_16x16x32_bf16 v[248:251], a[80:83], a[0:3], 0
    buffer_load_dwordx4 v16, s[16:19], s72 offen offset:0  lds
    v_and_b32 v160, 0xffff0000, v200
    v_lshlrev_b32_e64 v168, 16, v201
    v_mfma_f32_16x16x32_bf16 v[252:255], a[80:83], a[4:7], 0
    v_and_b32 v176, 0xffff0000, v201
    v_lshlrev_b32_e64 v153, 16, v202
    v_mfma_f32_16x16x32_bf16 v[248:251], a[84:87], a[8:11], v[248:251]
    buffer_load_dwordx4 v17, s[16:19], s72 offen offset:1024  lds
    v_and_b32 v161, 0xffff0000, v202
    v_lshlrev_b32_e64 v169, 16, v203
    v_mfma_f32_16x16x32_bf16 v[252:255], a[84:87], a[12:15], v[252:255]
    v_and_b32 v177, 0xffff0000, v203
    v_lshlrev_b32_e64 v154, 16, v204
    v_mfma_f32_16x16x32_bf16 v[248:251], a[88:91], a[16:19], v[248:251]
    buffer_load_dwordx4 v18, s[16:19], s72 offen offset:2048  lds
    v_and_b32 v162, 0xffff0000, v204
    v_lshlrev_b32_e64 v170, 16, v205
    v_mfma_f32_16x16x32_bf16 v[252:255], a[88:91], a[20:23], v[252:255]
    v_and_b32 v178, 0xffff0000, v205
    v_lshlrev_b32_e64 v155, 16, v206
    v_mfma_f32_16x16x32_bf16 v[248:251], a[92:95], a[24:27], v[248:251]
    buffer_load_dwordx4 v19, s[16:19], s72 offen offset:3072  lds
    v_and_b32 v163, 0xffff0000, v206
    v_lshlrev_b32_e64 v171, 16, v207
    v_mfma_f32_16x16x32_bf16 v[252:255], a[92:95], a[28:31], v[252:255]
    v_and_b32 v179, 0xffff0000, v207
    v_pk_mul_f32 v[4:5], v[224:225], v[96:97] op_sel_hi:[1,0]
    v_pk_mul_f32 v[6:7], v[228:229], v[96:97] op_sel_hi:[1,0]
    v_pk_fma_f32 v[4:5], v[228:229], v[96:97], v[4:5] op_sel:[0,1,0]
    v_pk_fma_f32 v[6:7], v[224:225], v[96:97], v[6:7] op_sel:[0,1,0] neg_lo:[1,0,0] neg_hi:[1,0,0]
    v_pk_mul_f32 v[8:9], v[226:227], v[98:99] op_sel_hi:[1,0]
    v_pk_mul_f32 v[10:11], v[230:231], v[98:99] op_sel_hi:[1,0]
    v_pk_fma_f32 v[8:9], v[230:231], v[98:99], v[8:9] op_sel:[0,1,0]
    v_pk_fma_f32 v[10:11], v[226:227], v[98:99], v[10:11] op_sel:[0,1,0] neg_lo:[1,0,0] neg_hi:[1,0,0]
    v_cvt_pk_bf16_f32 v184, v4, v6
    v_cvt_pk_bf16_f32 v192, v5, v7
    v_cvt_pk_bf16_f32 v188, v8, v10
    v_cvt_pk_bf16_f32 v196, v9, v11
    v_pk_mul_f32 v[4:5], v[232:233], v[100:101] op_sel_hi:[1,0]
    v_pk_mul_f32 v[6:7], v[236:237], v[100:101] op_sel_hi:[1,0]
    v_pk_fma_f32 v[4:5], v[236:237], v[100:101], v[4:5] op_sel:[0,1,0]
    v_pk_fma_f32 v[6:7], v[232:233], v[100:101], v[6:7] op_sel:[0,1,0] neg_lo:[1,0,0] neg_hi:[1,0,0]
    v_pk_mul_f32 v[8:9], v[234:235], v[102:103] op_sel_hi:[1,0]
    v_pk_mul_f32 v[10:11], v[238:239], v[102:103] op_sel_hi:[1,0]
    v_pk_fma_f32 v[8:9], v[238:239], v[102:103], v[8:9] op_sel:[0,1,0]
    v_pk_fma_f32 v[10:11], v[234:235], v[102:103], v[10:11] op_sel:[0,1,0] neg_lo:[1,0,0] neg_hi:[1,0,0]
    v_cvt_pk_bf16_f32 v185, v4, v6
    v_cvt_pk_bf16_f32 v193, v5, v7
    v_cvt_pk_bf16_f32 v189, v8, v10
    v_cvt_pk_bf16_f32 v197, v9, v11
    v_pk_mul_f32 v[4:5], v[240:241], v[104:105] op_sel_hi:[1,0]
    v_pk_mul_f32 v[6:7], v[244:245], v[104:105] op_sel_hi:[1,0]
    v_pk_fma_f32 v[4:5], v[244:245], v[104:105], v[4:5] op_sel:[0,1,0]
    v_pk_fma_f32 v[6:7], v[240:241], v[104:105], v[6:7] op_sel:[0,1,0] neg_lo:[1,0,0] neg_hi:[1,0,0]
    v_pk_mul_f32 v[8:9], v[242:243], v[106:107] op_sel_hi:[1,0]
    v_pk_mul_f32 v[10:11], v[246:247], v[106:107] op_sel_hi:[1,0]
    v_pk_fma_f32 v[8:9], v[246:247], v[106:107], v[8:9] op_sel:[0,1,0]
    v_pk_fma_f32 v[10:11], v[242:243], v[106:107], v[10:11] op_sel:[0,1,0] neg_lo:[1,0,0] neg_hi:[1,0,0]
    v_cvt_pk_bf16_f32 v186, v4, v6
    v_cvt_pk_bf16_f32 v194, v5, v7
    v_cvt_pk_bf16_f32 v190, v8, v10
    v_cvt_pk_bf16_f32 v198, v9, v11
    v_pk_mul_f32 v[4:5], v[248:249], v[108:109] op_sel_hi:[1,0]
    v_pk_mul_f32 v[6:7], v[252:253], v[108:109] op_sel_hi:[1,0]
    v_pk_fma_f32 v[4:5], v[252:253], v[108:109], v[4:5] op_sel:[0,1,0]
    v_pk_fma_f32 v[6:7], v[248:249], v[108:109], v[6:7] op_sel:[0,1,0] neg_lo:[1,0,0] neg_hi:[1,0,0]
    v_pk_mul_f32 v[8:9], v[250:251], v[110:111] op_sel_hi:[1,0]
    v_pk_mul_f32 v[10:11], v[254:255], v[110:111] op_sel_hi:[1,0]
    v_pk_fma_f32 v[8:9], v[254:255], v[110:111], v[8:9] op_sel:[0,1,0]
    v_pk_fma_f32 v[10:11], v[250:251], v[110:111], v[10:11] op_sel:[0,1,0] neg_lo:[1,0,0] neg_hi:[1,0,0]
    v_cvt_pk_bf16_f32 v187, v4, v6
    v_cvt_pk_bf16_f32 v195, v5, v7
    v_cvt_pk_bf16_f32 v191, v8, v10
    v_cvt_pk_bf16_f32 v199, v9, v11
    v_mfma_f32_16x16x32_bf16 v[224:227], a[224:227], v[184:187], 0
    s_xor_b32 s40, s92, 0
    v_lshlrev_b32 v156, 16, v208
    v_and_b32 v164, 0xffff0000, v208
    v_mfma_f32_16x16x32_bf16 v[228:231], a[228:231], v[184:187], 0
    v_lshlrev_b32_e64 v172, 16, v209
    v_and_b32 v180, 0xffff0000, v209
    v_mfma_f32_16x16x32_bf16 v[232:235], a[248:251], v[188:191], 0
    v_lshlrev_b32_e64 v157, 16, v210
    v_and_b32 v165, 0xffff0000, v210
    v_mfma_f32_16x16x32_bf16 v[236:239], a[252:255], v[188:191], 0
    v_lshlrev_b32_e64 v173, 16, v211
    v_and_b32 v181, 0xffff0000, v211
    v_mfma_f32_16x16x32_bf16 v[240:243], a[224:227], v[192:195], 0
    buffer_load_dword a223, v29, s[16:19], s40 offen
    v_lshlrev_b32_e64 v158, 16, v212
    v_and_b32 v166, 0xffff0000, v212
    v_mfma_f32_16x16x32_bf16 v[244:247], a[228:231], v[192:195], 0
    v_lshlrev_b32_e64 v174, 16, v213
    v_and_b32 v182, 0xffff0000, v213
    v_mfma_f32_16x16x32_bf16 v[248:251], a[248:251], v[196:199], 0
    v_lshlrev_b32_e64 v159, 16, v214
    v_and_b32 v167, 0xffff0000, v214
    v_mfma_f32_16x16x32_bf16 v[252:255], a[252:255], v[196:199], 0
    v_lshlrev_b32_e64 v175, 16, v215
    v_and_b32 v183, 0xffff0000, v215
    v_accvgpr_read_b32 v28, a222
    v_cmp_ne_u32 s[78:79], s96, v28
    s_nop 0
    s_and_b32 s78, s78, 0x5555
    s_cmp_eq_u32 s78, 0
    s_cselect_b32 s50, 0, 2.0
    s_cselect_b32 s7, 2.0, 0
    v_pk_add_f32 v[224:225], v[224:225], v[232:233]
    v_pk_add_f32 v[226:227], v[226:227], v[234:235]
    v_pk_add_f32 v[228:229], v[228:229], v[236:237]
    v_pk_add_f32 v[230:231], v[230:231], v[238:239]
    v_pk_fma_f32 v[232:233], v[232:233], -2.0, v[224:225] op_sel_hi:[1,0,1]
    v_pk_fma_f32 v[234:235], v[234:235], -2.0, v[226:227] op_sel_hi:[1,0,1]
    v_pk_fma_f32 v[236:237], v[236:237], -2.0, v[228:229] op_sel_hi:[1,0,1]
    v_pk_fma_f32 v[238:239], v[238:239], -2.0, v[230:231] op_sel_hi:[1,0,1]
    v_pk_add_f32 v[240:241], v[240:241], v[248:249]
    v_pk_add_f32 v[242:243], v[242:243], v[250:251]
    v_pk_add_f32 v[244:245], v[244:245], v[252:253]
    v_pk_add_f32 v[246:247], v[246:247], v[254:255]
    v_pk_fma_f32 v[248:249], v[248:249], -2.0, v[240:241] op_sel_hi:[1,0,1]
    v_pk_fma_f32 v[250:251], v[250:251], -2.0, v[242:243] op_sel_hi:[1,0,1]
    v_pk_fma_f32 v[252:253], v[252:253], -2.0, v[244:245] op_sel_hi:[1,0,1]
    v_pk_fma_f32 v[254:255], v[254:255], -2.0, v[246:247] op_sel_hi:[1,0,1]
    s_cmp_eq_u32 s2, 0
    s_cbranch_scc1 K_SPECIAL
    v_pk_fma_f32 v[4:5], v[224:225], s[42:43], v[244:245] op_sel_hi:[1,0,1]
    v_pk_fma_f32 v[6:7], v[228:229], s[42:43], v[240:241] op_sel_hi:[1,0,1] neg_lo:[0,0,1] neg_hi:[0,0,1]
    v_pk_fma_f32 v[8:9], v[240:241], s[42:43], v[228:229] op_sel_hi:[1,0,1]
    v_pk_fma_f32 v[10:11], v[244:245], s[42:43], v[224:225] op_sel_hi:[1,0,1] neg_lo:[0,0,1] neg_hi:[0,0,1]
    v_pk_mul_f32 v[224:225], v[4:5], v[152:153]
    v_pk_mul_f32 v[228:229], v[6:7], v[152:153]
    v_pk_mul_f32 v[240:241], v[8:9], v[168:169]
    v_pk_mul_f32 v[244:245], v[10:11], v[168:169]
    v_pk_fma_f32 v[152:153], v[6:7], v[160:161], v[224:225] neg_lo:[1,0,0] neg_hi:[1,0,0]
    v_pk_fma_f32 v[160:161], v[4:5], v[160:161], v[228:229]
    v_pk_fma_f32 v[168:169], v[10:11], v[176:177], v[240:241]
    v_pk_fma_f32 v[176:177], v[8:9], v[176:177], v[244:245] neg_lo:[1,0,0] neg_hi:[1,0,0]
    v_pk_fma_f32 v[224:225], v[152:153], s[42:43], v[176:177] op_sel_hi:[1,0,1] neg_lo:[0,0,1] neg_hi:[0,0,1]
    v_pk_fma_f32 v[228:229], v[160:161], s[42:43], v[168:169] op_sel_hi:[1,0,1]
    v_pk_fma_f32 v[240:241], v[168:169], s[42:43], v[160:161] op_sel_hi:[1,0,1] neg_lo:[0,0,1] neg_hi:[0,0,1]
    v_pk_fma_f32 v[244:245], v[176:177], s[42:43], v[152:153] op_sel_hi:[1,0,1]
    v_pk_fma_f32 v[4:5], v[226:227], s[42:43], v[246:247] op_sel_hi:[1,0,1]
    v_pk_fma_f32 v[6:7], v[230:231], s[42:43], v[242:243] op_sel_hi:[1,0,1] neg_lo:[0,0,1] neg_hi:[0,0,1]
    v_pk_fma_f32 v[8:9], v[242:243], s[42:43], v[230:231] op_sel_hi:[1,0,1]
    v_pk_fma_f32 v[10:11], v[246:247], s[42:43], v[226:227] op_sel_hi:[1,0,1] neg_lo:[0,0,1] neg_hi:[0,0,1]
    v_pk_mul_f32 v[226:227], v[4:5], v[154:155]
    v_pk_mul_f32 v[230:231], v[6:7], v[154:155]
    v_pk_mul_f32 v[242:243], v[8:9], v[170:171]
    v_pk_mul_f32 v[246:247], v[10:11], v[170:171]
    v_pk_fma_f32 v[154:155], v[6:7], v[162:163], v[226:227] neg_lo:[1,0,0] neg_hi:[1,0,0]
    v_pk_fma_f32 v[162:163], v[4:5], v[162:163], v[230:231]
    v_pk_fma_f32 v[170:171], v[10:11], v[178:179], v[242:243]
    v_pk_fma_f32 v[178:179], v[8:9], v[178:179], v[246:247] neg_lo:[1,0,0] neg_hi:[1,0,0]
    v_pk_fma_f32 v[226:227], v[154:155], s[42:43], v[178:179] op_sel_hi:[1,0,1] neg_lo:[0,0,1] neg_hi:[0,0,1]
    v_pk_fma_f32 v[230:231], v[162:163], s[42:43], v[170:171] op_sel_hi:[1,0,1]
    v_pk_fma_f32 v[242:243], v[170:171], s[42:43], v[162:163] op_sel_hi:[1,0,1] neg_lo:[0,0,1] neg_hi:[0,0,1]
    v_pk_fma_f32 v[246:247], v[178:179], s[42:43], v[154:155] op_sel_hi:[1,0,1]
    v_pk_fma_f32 v[4:5], v[232:233], s[42:43], v[252:253] op_sel_hi:[1,0,1]
    v_pk_fma_f32 v[6:7], v[236:237], s[42:43], v[248:249] op_sel_hi:[1,0,1] neg_lo:[0,0,1] neg_hi:[0,0,1]
    v_pk_fma_f32 v[8:9], v[248:249], s[42:43], v[236:237] op_sel_hi:[1,0,1]
    v_pk_fma_f32 v[10:11], v[252:253], s[42:43], v[232:233] op_sel_hi:[1,0,1] neg_lo:[0,0,1] neg_hi:[0,0,1]
    v_pk_mul_f32 v[232:233], v[4:5], v[156:157]
    v_pk_mul_f32 v[236:237], v[6:7], v[156:157]
    v_pk_mul_f32 v[248:249], v[8:9], v[172:173]
    v_pk_mul_f32 v[252:253], v[10:11], v[172:173]
    v_pk_fma_f32 v[156:157], v[6:7], v[164:165], v[232:233] neg_lo:[1,0,0] neg_hi:[1,0,0]
    v_pk_fma_f32 v[164:165], v[4:5], v[164:165], v[236:237]
    v_pk_fma_f32 v[172:173], v[10:11], v[180:181], v[248:249]
    v_pk_fma_f32 v[180:181], v[8:9], v[180:181], v[252:253] neg_lo:[1,0,0] neg_hi:[1,0,0]
    v_pk_fma_f32 v[232:233], v[156:157], s[42:43], v[180:181] op_sel_hi:[1,0,1] neg_lo:[0,0,1] neg_hi:[0,0,1]
    v_pk_fma_f32 v[236:237], v[164:165], s[42:43], v[172:173] op_sel_hi:[1,0,1]
    v_pk_fma_f32 v[248:249], v[172:173], s[42:43], v[164:165] op_sel_hi:[1,0,1] neg_lo:[0,0,1] neg_hi:[0,0,1]
    v_pk_fma_f32 v[252:253], v[180:181], s[42:43], v[156:157] op_sel_hi:[1,0,1]
    v_pk_fma_f32 v[4:5], v[234:235], s[42:43], v[254:255] op_sel_hi:[1,0,1]
    v_pk_fma_f32 v[6:7], v[238:239], s[42:43], v[250:251] op_sel_hi:[1,0,1] neg_lo:[0,0,1] neg_hi:[0,0,1]
    v_pk_fma_f32 v[8:9], v[250:251], s[42:43], v[238:239] op_sel_hi:[1,0,1]
    v_pk_fma_f32 v[10:11], v[254:255], s[42:43], v[234:235] op_sel_hi:[1,0,1] neg_lo:[0,0,1] neg_hi:[0,0,1]
    v_pk_mul_f32 v[234:235], v[4:5], v[158:159]
    v_pk_mul_f32 v[238:239], v[6:7], v[158:159]
    v_pk_mul_f32 v[250:251], v[8:9], v[174:175]
    v_pk_mul_f32 v[254:255], v[10:11], v[174:175]
    v_pk_fma_f32 v[158:159], v[6:7], v[166:167], v[234:235] neg_lo:[1,0,0] neg_hi:[1,0,0]
    v_pk_fma_f32 v[166:167], v[4:5], v[166:167], v[238:239]
    v_pk_fma_f32 v[174:175], v[10:11], v[182:183], v[250:251]
    v_pk_fma_f32 v[182:183], v[8:9], v[182:183], v[254:255] neg_lo:[1,0,0] neg_hi:[1,0,0]
    v_pk_fma_f32 v[234:235], v[158:159], s[42:43], v[182:183] op_sel_hi:[1,0,1] neg_lo:[0,0,1] neg_hi:[0,0,1]
    v_pk_fma_f32 v[238:239], v[166:167], s[42:43], v[174:175] op_sel_hi:[1,0,1]
    v_pk_fma_f32 v[250:251], v[174:175], s[42:43], v[166:167] op_sel_hi:[1,0,1] neg_lo:[0,0,1] neg_hi:[0,0,1]
    v_pk_fma_f32 v[254:255], v[182:183], s[42:43], v[158:159] op_sel_hi:[1,0,1]
K_SPECIAL2_RET:
    v_pk_add_f32 v[224:225], v[224:225], v[232:233]
    v_pk_add_f32 v[226:227], v[226:227], v[234:235]
    v_pk_add_f32 v[228:229], v[228:229], v[236:237]
    v_pk_add_f32 v[230:231], v[230:231], v[238:239]
    v_pk_fma_f32 v[232:233], v[232:233], -2.0, v[224:225] op_sel_hi:[1,0,1]
    v_pk_fma_f32 v[234:235], v[234:235], -2.0, v[226:227] op_sel_hi:[1,0,1]
    v_pk_fma_f32 v[236:237], v[236:237], -2.0, v[228:229] op_sel_hi:[1,0,1]
    v_pk_fma_f32 v[238:239], v[238:239], -2.0, v[230:231] op_sel_hi:[1,0,1]
    v_cvt_pk_bf16_f32 v184, v224, -v228
    v_cvt_pk_bf16_f32 v185, v225, -v229
    v_cvt_pk_bf16_f32 v186, v226, -v230
    v_cvt_pk_bf16_f32 v187, v227, -v231
    v_cvt_pk_bf16_f32 v188, v232, -v236
    v_cvt_pk_bf16_f32 v189, v233, -v237
    v_cvt_pk_bf16_f32 v190, v234, -v238
    v_cvt_pk_bf16_f32 v191, v235, -v239
    v_pk_add_f32 v[240:241], v[240:241], v[248:249]
    v_pk_add_f32 v[242:243], v[242:243], v[250:251]
    v_pk_add_f32 v[244:245], v[244:245], v[252:253]
    v_pk_add_f32 v[246:247], v[246:247], v[254:255]
    v_pk_fma_f32 v[248:249], v[248:249], -2.0, v[240:241] op_sel_hi:[1,0,1]
    v_pk_fma_f32 v[250:251], v[250:251], -2.0, v[242:243] op_sel_hi:[1,0,1]
    v_pk_fma_f32 v[252:253], v[252:253], -2.0, v[244:245] op_sel_hi:[1,0,1]
    v_pk_fma_f32 v[254:255], v[254:255], -2.0, v[246:247] op_sel_hi:[1,0,1]
    v_cvt_pk_bf16_f32 v192, v240, -v244
    v_cvt_pk_bf16_f32 v193, v241, -v245
    v_cvt_pk_bf16_f32 v194, v242, -v246
    v_cvt_pk_bf16_f32 v195, v243, -v247
    v_cvt_pk_bf16_f32 v196, v248, -v252
    v_cvt_pk_bf16_f32 v197, v249, -v253
    v_cvt_pk_bf16_f32 v198, v250, -v254
    v_cvt_pk_bf16_f32 v199, v251, -v255
    v_mfma_f32_16x16x32_bf16 v[224:227], v[184:187], a[224:227], 0
    v_and_b32_e64 v12, 3, v1
    v_mul_u32_u24 v13, 4112, v12
    v_mfma_f32_16x16x32_bf16 v[228:231], v[184:187], a[228:231], 0
    v_and_b32_e64 v14, 60, v0
    v_lshl_add_u32 v13, v14, 4, v13
    v_mfma_f32_16x16x32_bf16 v[232:235], v[188:191], a[232:235], 0
    s_lshl_b32 s38, s34, 10
    s_add_u32 s38, s38, 114624
    v_mfma_f32_16x16x32_bf16 v[236:239], v[188:191], a[236:239], 0
    v_add_u32 v204, s38, v13
    v_add_u32 v205, 114624, v3
    v_lshlrev_b32_e64 v12, 4, v12
    v_lshl_add_u32 v206, v14, 14, v12
    v_lshlrev_b32_e64 v207, 31, v1
    v_pk_mul_f32 v[4:5], v[36:37], v[130:131] op_sel:[0,1]
    v_pk_mul_f32 v[6:7], v[32:33], v[130:131] op_sel:[0,1]
    v_pk_fma_f32 v[32:33], v[32:33], v[130:131], v[4:5] op_sel_hi:[1,0,1] neg_lo:[0,0,1] neg_hi:[0,0,1]
    v_pk_fma_f32 v[36:37], v[36:37], v[130:131], v[6:7] op_sel_hi:[1,0,1]
    v_pk_mul_f32 v[8:9], v[38:39], v[130:131] op_sel:[0,1]
    v_pk_mul_f32 v[10:11], v[34:35], v[130:131] op_sel:[0,1]
    v_pk_fma_f32 v[34:35], v[34:35], v[130:131], v[8:9] op_sel_hi:[1,0,1] neg_lo:[0,0,1] neg_hi:[0,0,1]
    v_pk_fma_f32 v[38:39], v[38:39], v[130:131], v[10:11] op_sel_hi:[1,0,1]
    v_pk_mul_f32 v[4:5], v[44:45], v[130:131] op_sel:[0,1]
    v_pk_mul_f32 v[6:7], v[40:41], v[130:131] op_sel:[0,1]
    v_pk_fma_f32 v[40:41], v[40:41], v[130:131], v[4:5] op_sel_hi:[1,0,1] neg_lo:[0,0,1] neg_hi:[0,0,1]
    v_pk_fma_f32 v[44:45], v[44:45], v[130:131], v[6:7] op_sel_hi:[1,0,1]
    v_pk_mul_f32 v[8:9], v[46:47], v[130:131] op_sel:[0,1]
    v_pk_mul_f32 v[10:11], v[42:43], v[130:131] op_sel:[0,1]
    v_pk_fma_f32 v[42:43], v[42:43], v[130:131], v[8:9] op_sel_hi:[1,0,1] neg_lo:[0,0,1] neg_hi:[0,0,1]
    v_pk_fma_f32 v[46:47], v[46:47], v[130:131], v[10:11] op_sel_hi:[1,0,1]
    v_pk_mul_f32 v[4:5], v[52:53], v[130:131] op_sel:[0,1]
    v_pk_mul_f32 v[6:7], v[48:49], v[130:131] op_sel:[0,1]
    v_pk_fma_f32 v[48:49], v[48:49], v[130:131], v[4:5] op_sel_hi:[1,0,1] neg_lo:[0,0,1] neg_hi:[0,0,1]
    v_pk_fma_f32 v[52:53], v[52:53], v[130:131], v[6:7] op_sel_hi:[1,0,1]
    v_pk_mul_f32 v[8:9], v[54:55], v[130:131] op_sel:[0,1]
    v_pk_mul_f32 v[10:11], v[50:51], v[130:131] op_sel:[0,1]
    v_pk_fma_f32 v[50:51], v[50:51], v[130:131], v[8:9] op_sel_hi:[1,0,1] neg_lo:[0,0,1] neg_hi:[0,0,1]
    v_pk_fma_f32 v[54:55], v[54:55], v[130:131], v[10:11] op_sel_hi:[1,0,1]
    v_pk_mul_f32 v[4:5], v[60:61], v[130:131] op_sel:[0,1]
    v_pk_mul_f32 v[6:7], v[56:57], v[130:131] op_sel:[0,1]
    v_pk_fma_f32 v[56:57], v[56:57], v[130:131], v[4:5] op_sel_hi:[1,0,1] neg_lo:[0,0,1] neg_hi:[0,0,1]
    v_pk_fma_f32 v[60:61], v[60:61], v[130:131], v[6:7] op_sel_hi:[1,0,1]
    v_pk_mul_f32 v[8:9], v[62:63], v[130:131] op_sel:[0,1]
    v_pk_mul_f32 v[10:11], v[58:59], v[130:131] op_sel:[0,1]
    v_pk_fma_f32 v[58:59], v[58:59], v[130:131], v[8:9] op_sel_hi:[1,0,1] neg_lo:[0,0,1] neg_hi:[0,0,1]
    v_pk_fma_f32 v[62:63], v[62:63], v[130:131], v[10:11] op_sel_hi:[1,0,1]
    v_pk_mul_f32 v[4:5], v[68:69], v[130:131] op_sel:[0,1]
    v_pk_mul_f32 v[6:7], v[64:65], v[130:131] op_sel:[0,1]
    v_pk_fma_f32 v[64:65], v[64:65], v[130:131], v[4:5] op_sel_hi:[1,0,1] neg_lo:[0,0,1] neg_hi:[0,0,1]
    v_pk_fma_f32 v[68:69], v[68:69], v[130:131], v[6:7] op_sel_hi:[1,0,1]
    v_pk_mul_f32 v[8:9], v[70:71], v[130:131] op_sel:[0,1]
    v_pk_mul_f32 v[10:11], v[66:67], v[130:131] op_sel:[0,1]
    v_pk_fma_f32 v[66:67], v[66:67], v[130:131], v[8:9] op_sel_hi:[1,0,1] neg_lo:[0,0,1] neg_hi:[0,0,1]
    v_pk_fma_f32 v[70:71], v[70:71], v[130:131], v[10:11] op_sel_hi:[1,0,1]
    v_pk_mul_f32 v[4:5], v[76:77], v[130:131] op_sel:[0,1]
    v_pk_mul_f32 v[6:7], v[72:73], v[130:131] op_sel:[0,1]
    v_pk_fma_f32 v[72:73], v[72:73], v[130:131], v[4:5] op_sel_hi:[1,0,1] neg_lo:[0,0,1] neg_hi:[0,0,1]
    v_pk_fma_f32 v[76:77], v[76:77], v[130:131], v[6:7] op_sel_hi:[1,0,1]
    v_pk_mul_f32 v[8:9], v[78:79], v[130:131] op_sel:[0,1]
    v_pk_mul_f32 v[10:11], v[74:75], v[130:131] op_sel:[0,1]
    v_pk_fma_f32 v[74:75], v[74:75], v[130:131], v[8:9] op_sel_hi:[1,0,1] neg_lo:[0,0,1] neg_hi:[0,0,1]
    v_pk_fma_f32 v[78:79], v[78:79], v[130:131], v[10:11] op_sel_hi:[1,0,1]
    v_pk_mul_f32 v[4:5], v[84:85], v[130:131] op_sel:[0,1]
    v_pk_mul_f32 v[6:7], v[80:81], v[130:131] op_sel:[0,1]
    v_pk_fma_f32 v[80:81], v[80:81], v[130:131], v[4:5] op_sel_hi:[1,0,1] neg_lo:[0,0,1] neg_hi:[0,0,1]
    v_pk_fma_f32 v[84:85], v[84:85], v[130:131], v[6:7] op_sel_hi:[1,0,1]
    v_pk_mul_f32 v[8:9], v[86:87], v[130:131] op_sel:[0,1]
    v_pk_mul_f32 v[10:11], v[82:83], v[130:131] op_sel:[0,1]
    v_pk_fma_f32 v[82:83], v[82:83], v[130:131], v[8:9] op_sel_hi:[1,0,1] neg_lo:[0,0,1] neg_hi:[0,0,1]
    v_pk_fma_f32 v[86:87], v[86:87], v[130:131], v[10:11] op_sel_hi:[1,0,1]
    v_pk_mul_f32 v[4:5], v[92:93], v[130:131] op_sel:[0,1]
    v_pk_mul_f32 v[6:7], v[88:89], v[130:131] op_sel:[0,1]
    v_pk_fma_f32 v[88:89], v[88:89], v[130:131], v[4:5] op_sel_hi:[1,0,1] neg_lo:[0,0,1] neg_hi:[0,0,1]
    v_pk_fma_f32 v[92:93], v[92:93], v[130:131], v[6:7] op_sel_hi:[1,0,1]
    v_pk_mul_f32 v[8:9], v[94:95], v[130:131] op_sel:[0,1]
    v_pk_mul_f32 v[10:11], v[90:91], v[130:131] op_sel:[0,1]
    v_pk_fma_f32 v[90:91], v[90:91], v[130:131], v[8:9] op_sel_hi:[1,0,1] neg_lo:[0,0,1] neg_hi:[0,0,1]
    v_pk_fma_f32 v[94:95], v[94:95], v[130:131], v[10:11] op_sel_hi:[1,0,1]
    v_pk_mul_f32 v[4:5], v[224:225], v[112:113]
    v_pk_mul_f32 v[6:7], v[228:229], v[112:113]
    v_pk_fma_f32 v[4:5], v[228:229], v[116:117], v[4:5]
    v_pk_fma_f32 v[6:7], v[224:225], v[116:117], v[6:7] neg_lo:[1,0,0] neg_hi:[1,0,0]
    v_pk_mul_f32 v[8:9], v[226:227], v[114:115]
    v_pk_mul_f32 v[10:11], v[230:231], v[114:115]
    v_pk_fma_f32 v[8:9], v[230:231], v[118:119], v[8:9]
    v_pk_fma_f32 v[10:11], v[226:227], v[118:119], v[10:11] neg_lo:[1,0,0] neg_hi:[1,0,0]
    v_cvt_pk_bf16_f32 v184, v4, v6
    v_cvt_pk_bf16_f32 v185, v5, v7
    v_cvt_pk_bf16_f32 v186, v8, v10
    v_cvt_pk_bf16_f32 v187, v9, v11
    v_pk_mul_f32 v[4:5], v[232:233], v[120:121]
    v_pk_mul_f32 v[6:7], v[236:237], v[120:121]
    v_pk_fma_f32 v[4:5], v[236:237], v[124:125], v[4:5]
    v_pk_fma_f32 v[6:7], v[232:233], v[124:125], v[6:7] neg_lo:[1,0,0] neg_hi:[1,0,0]
    v_pk_mul_f32 v[8:9], v[234:235], v[122:123]
    v_pk_mul_f32 v[10:11], v[238:239], v[122:123]
    v_pk_fma_f32 v[8:9], v[238:239], v[126:127], v[8:9]
    v_pk_fma_f32 v[10:11], v[234:235], v[126:127], v[10:11] neg_lo:[1,0,0] neg_hi:[1,0,0]
    v_cvt_pk_bf16_f32 v188, v4, v6
    v_cvt_pk_bf16_f32 v189, v5, v7
    v_cvt_pk_bf16_f32 v190, v8, v10
    v_cvt_pk_bf16_f32 v191, v9, v11
    v_mfma_f32_16x16x32_bf16 v[240:243], v[192:195], a[224:227], 0
    ds_write_b128 v204, v[184:187] offset:0
    v_mfma_f32_16x16x32_bf16 v[244:247], v[192:195], a[228:231], 0
    ds_write_b128 v204, v[188:191] offset:32
    v_mfma_f32_16x16x32_bf16 v[248:251], v[196:199], a[232:235], 0
    v_mfma_f32_16x16x32_bf16 v[252:255], v[196:199], a[236:239], 0
    s_lshl_b32 s68, s94, 16
    s_add_u32 s68, s68, s5
    s_add_u32 s69, s68, 0x20000
    s_lshl_b32 s38, s34, 14
    s_nop 0
    v_pk_mul_f32 v[4:5], v[240:241], v[112:113]
    v_pk_mul_f32 v[6:7], v[244:245], v[112:113]
    v_pk_fma_f32 v[4:5], v[244:245], v[116:117], v[4:5]
    v_pk_fma_f32 v[6:7], v[240:241], v[116:117], v[6:7] neg_lo:[1,0,0] neg_hi:[1,0,0]
    v_pk_mul_f32 v[8:9], v[242:243], v[114:115]
    v_pk_mul_f32 v[10:11], v[246:247], v[114:115]
    v_pk_fma_f32 v[8:9], v[246:247], v[118:119], v[8:9]
    v_pk_fma_f32 v[10:11], v[242:243], v[118:119], v[10:11] neg_lo:[1,0,0] neg_hi:[1,0,0]
    v_cvt_pk_bf16_f32 v192, v4, v6
    v_cvt_pk_bf16_f32 v193, v5, v7
    v_cvt_pk_bf16_f32 v194, v8, v10
    v_cvt_pk_bf16_f32 v195, v9, v11
    v_pk_mul_f32 v[4:5], v[248:249], v[120:121]
    v_pk_mul_f32 v[6:7], v[252:253], v[120:121]
    v_pk_fma_f32 v[4:5], v[252:253], v[124:125], v[4:5]
    v_pk_fma_f32 v[6:7], v[248:249], v[124:125], v[6:7] neg_lo:[1,0,0] neg_hi:[1,0,0]
    v_pk_mul_f32 v[8:9], v[250:251], v[122:123]
    v_pk_mul_f32 v[10:11], v[254:255], v[122:123]
    v_pk_fma_f32 v[8:9], v[254:255], v[126:127], v[8:9]
    v_pk_fma_f32 v[10:11], v[250:251], v[126:127], v[10:11] neg_lo:[1,0,0] neg_hi:[1,0,0]
    v_cvt_pk_bf16_f32 v196, v4, v6
    v_cvt_pk_bf16_f32 v197, v5, v7
    v_cvt_pk_bf16_f32 v198, v8, v10
    v_cvt_pk_bf16_f32 v199, v9, v11
    s_add_u32 s38, s38, s4
    s_lshl_b32 s38, s38, 6
    ds_write_b128 v204, v[192:195] offset:16
    ds_write_b128 v204, v[196:199] offset:48
    s_add_u32 s38, s38, 9437184
    s_and_b32 s70, s2, 0xe0
    s_lshl2_add_u32 s70, s70, s51
    s_waitcnt lgkmcnt(0)
    s_barrier
    s_nop 0
    ds_read_b128 a[32:35], v205 offset:0
    ds_read_b128 a[36:39], v205 offset:1024
    ds_read_b128 a[40:43], v205 offset:2048
    ds_read_b128 a[44:47], v205 offset:3072
    buffer_load_dwordx4 v[96:99], v148, s[24:27], s93 offen sc1
    buffer_load_dwordx4 v[100:103], v149, s[24:27], s93 offen sc1
    buffer_load_dwordx4 v[104:107], v150, s[24:27], s93 offen sc1
    buffer_load_dwordx4 v[108:111], v151, s[24:27], s93 offen sc1
    s_bfe_u32 s72, s97, 262156
    s_add_u32 m0, s37, 49152
    s_lshl_b32 s72, s72, 7
    buffer_load_dwordx4 v16, s[16:19], s72 offen offset:0  lds
    buffer_load_dwordx4 v17, s[16:19], s72 offen offset:1024  lds
    buffer_load_dwordx4 v18, s[16:19], s72 offen offset:2048  lds
    buffer_load_dwordx4 v19, s[16:19], s72 offen offset:3072  lds
    s_waitcnt lgkmcnt(0)
    v_mfma_f32_16x16x32_bf16 v[224:227], a[0:3], a[32:35], 0
    ds_read_b128 a[48:51], v205 offset:4112
    v_accvgpr_read_b32 v112, a152
    v_mfma_f32_16x16x32_bf16 v[228:231], a[4:7], a[32:35], 0
    ds_read_b128 a[52:55], v205 offset:5136
    v_accvgpr_read_b32 v113, a153
    v_mfma_f32_16x16x32_bf16 v[224:227], a[8:11], a[36:39], v[224:227]
    ds_read_b128 a[56:59], v205 offset:6160
    v_accvgpr_read_b32 v114, a154
    v_mfma_f32_16x16x32_bf16 v[228:231], a[12:15], a[36:39], v[228:231]
    ds_read_b128 a[60:63], v205 offset:7184
    v_mfma_f32_16x16x32_bf16 v[224:227], a[16:19], a[40:43], v[224:227]
    ds_read_b128 a[64:67], v205 offset:8224
    v_accvgpr_read_b32 v115, a155
    v_mfma_f32_16x16x32_bf16 v[228:231], a[20:23], a[40:43], v[228:231]
    ds_read_b128 a[68:71], v205 offset:9248
    v_accvgpr_read_b32 v116, a156
    v_mfma_f32_16x16x32_bf16 v[224:227], a[24:27], a[44:47], v[224:227]
    ds_read_b128 a[72:75], v205 offset:10272
    v_accvgpr_read_b32 v117, a157
    v_mfma_f32_16x16x32_bf16 v[228:231], a[28:31], a[44:47], v[228:231]
    ds_read_b128 a[76:79], v205 offset:11296
    s_waitcnt lgkmcnt(4)
    v_mfma_f32_16x16x32_bf16 v[232:235], a[0:3], a[48:51], 0
    ds_read_b128 a[80:83], v205 offset:12336
    s_bfe_u32 s72, s97, 262160
    v_accvgpr_read_b32 v118, a158
    v_mfma_f32_16x16x32_bf16 v[236:239], a[4:7], a[48:51], 0
    ds_read_b128 a[84:87], v205 offset:13360
    v_accvgpr_read_b32 v119, a159
    v_mfma_f32_16x16x32_bf16 v[232:235], a[8:11], a[52:55], v[232:235]
    ds_read_b128 a[88:91], v205 offset:14384
    s_add_u32 m0, s37, 65536
    v_mfma_f32_16x16x32_bf16 v[236:239], a[12:15], a[52:55], v[236:239]
    ds_read_b128 a[92:95], v205 offset:15408
    v_cvt_pk_bf16_f32 v184, v224, v228
    v_cvt_pk_bf16_f32 v185, v225, v229
    v_mfma_f32_16x16x32_bf16 v[232:235], a[16:19], a[56:59], v[232:235]
    s_lshl_b32 s72, s72, 7
    v_cvt_pk_bf16_f32 v186, v226, v230
    v_cvt_pk_bf16_f32 v187, v227, v231
    v_mfma_f32_16x16x32_bf16 v[236:239], a[20:23], a[56:59], v[236:239]
    v_xor_b32 v184, v207, v184
    v_xor_b32 v185, v207, v185
    v_mfma_f32_16x16x32_bf16 v[232:235], a[24:27], a[60:63], v[232:235]
    v_xor_b32 v186, v207, v186
    v_xor_b32 v187, v207, v187
    v_mfma_f32_16x16x32_bf16 v[236:239], a[28:31], a[60:63], v[236:239]
    buffer_store_dwordx4 v[184:187], v206, s[24:27], s38 offen sc1
    s_add_u32 s38, s38, 16384
    s_waitcnt lgkmcnt(4)
    v_mfma_f32_16x16x32_bf16 v[240:243], a[0:3], a[64:67], 0
    buffer_load_dwordx4 v16, s[16:19], s72 offen offset:0  lds
    v_accvgpr_read_b32 v120, a160
    v_mfma_f32_16x16x32_bf16 v[244:247], a[4:7], a[64:67], 0
    v_accvgpr_read_b32 v121, a161
    v_mfma_f32_16x16x32_bf16 v[240:243], a[8:11], a[68:71], v[240:243]
    buffer_load_dwordx4 v17, s[16:19], s72 offen offset:1024  lds
    v_mfma_f32_16x16x32_bf16 v[244:247], a[12:15], a[68:71], v[244:247]
    v_cvt_pk_bf16_f32 v188, v232, v236
    v_cvt_pk_bf16_f32 v189, v233, v237
    v_mfma_f32_16x16x32_bf16 v[240:243], a[16:19], a[72:75], v[240:243]
    buffer_load_dwordx4 v18, s[16:19], s72 offen offset:2048  lds
    v_cvt_pk_bf16_f32 v190, v234, v238
    v_cvt_pk_bf16_f32 v191, v235, v239
    v_mfma_f32_16x16x32_bf16 v[244:247], a[20:23], a[72:75], v[244:247]
    v_xor_b32 v188, v207, v188
    v_xor_b32_e64 v189, v207, v189
    v_mfma_f32_16x16x32_bf16 v[240:243], a[24:27], a[76:79], v[240:243]
    v_xor_b32 v190, v207, v190
    v_xor_b32 v191, v207, v191
    v_mfma_f32_16x16x32_bf16 v[244:247], a[28:31], a[76:79], v[244:247]
    buffer_store_dwordx4 v[188:191], v206, s[24:27], s38 offen sc1
    s_add_u32 s38, s38, 16384
    s_waitcnt lgkmcnt(0)
    v_mfma_f32_16x16x32_bf16 v[248:251], a[0:3], a[80:83], 0
    buffer_load_dwordx4 v19, s[16:19], s72 offen offset:3072  lds
    v_accvgpr_read_b32 v122, a162
    v_mfma_f32_16x16x32_bf16 v[252:255], a[4:7], a[80:83], 0
    v_accvgpr_read_b32 v123, a163
    v_mfma_f32_16x16x32_bf16 v[248:251], a[8:11], a[84:87], v[248:251]
    v_mfma_f32_16x16x32_bf16 v[252:255], a[12:15], a[84:87], v[252:255]
    v_cvt_pk_bf16_f32 v192, v240, v244
    v_cvt_pk_bf16_f32 v193, v241, v245
    v_mfma_f32_16x16x32_bf16 v[248:251], a[16:19], a[88:91], v[248:251]
    v_cvt_pk_bf16_f32 v194, v242, v246
    v_cvt_pk_bf16_f32 v195, v243, v247
    v_mfma_f32_16x16x32_bf16 v[252:255], a[20:23], a[88:91], v[252:255]
    v_xor_b32 v192, v207, v192
    v_xor_b32_e64 v193, v207, v193
    v_mfma_f32_16x16x32_bf16 v[248:251], a[24:27], a[92:95], v[248:251]
    v_xor_b32 v194, v207, v194
    v_xor_b32 v195, v207, v195
    v_mfma_f32_16x16x32_bf16 v[252:255], a[28:31], a[92:95], v[252:255]
    buffer_store_dwordx4 v[192:195], v206, s[24:27], s38 offen sc1
    s_add_u32 s38, s38, 16384
    v_accvgpr_read_b32 v124, a164
    v_accvgpr_read_b32 v125, a165
    v_accvgpr_read_b32 v126, a166
    v_accvgpr_read_b32 v127, a167
    s_nop 1
    v_cvt_pk_bf16_f32 v196, v248, v252
    v_cvt_pk_bf16_f32 v197, v249, v253
    v_cvt_pk_bf16_f32 v198, v250, v254
    v_cvt_pk_bf16_f32 v199, v251, v255
    v_xor_b32 v196, v207, v196
    v_xor_b32 v197, v207, v197
    v_xor_b32 v198, v207, v198
    v_xor_b32_e64 v199, v207, v199
    buffer_store_dwordx4 v[196:199], v206, s[24:27], s38 offen sc1
    s_waitcnt vmcnt(12)
    v_cmp_ne_u32 s[52:53], s35, v98
    v_cmp_ne_u32 s[54:55], s35, v102
    v_cmp_ne_u32 s[56:57], s35, v106
    v_cmp_ne_u32 s[58:59], s35, v110
    s_and_b64 s[52:53], s[52:53], s[80:81]
    s_and_b64 s[54:55], s[54:55], s[82:83]
    s_and_b64 s[56:57], s[56:57], s[84:85]
    s_and_b64 s[58:59], s[58:59], s[86:87]
    s_or_b64 s[52:53], s[52:53], s[54:55]
    s_or_b64 s[56:57], s[56:57], s[58:59]
    s_or_b64 vcc, s[52:53], s[56:57]
    s_cbranch_vccnz K_POLL2
K_POLL2_OK:
    s_nop 0
    s_xor_b32 s40, s92, 128
    buffer_load_dword a223, v29, s[16:19], s40 offen
    v_fma_f32 v4, v108, v136, v104
    v_fma_f32 v5, v108, v137, v105
    v_fma_f32 v4, -v109, v137, v4
    v_fma_f32 v5, v109, v136, v5
    v_fma_f32 v6, v4, v136, v100
    v_fma_f32 v7, v4, v137, v101
    v_fma_f32 v6, -v5, v137, v6
    v_fma_f32 v7, v5, v136, v7
    v_fma_f32 v4, v6, v136, v96
    v_fma_f32 v5, v6, v137, v97
    v_fma_f32 v4, -v7, v137, v4
    v_fma_f32 v5, v7, v136, v5
    v_mul_f32 v6, v4, v140
    v_mul_f32 v8, v4, v141
    v_fma_f32 v6, -v5, v141, v6
    v_fma_f32 v8, v5, v140, v8
    v_and_b32 v210, 7, v0
    v_lshlrev_b32 v210, 2, v210
    v_permlane32_swap_b32 v6, v8
    v_add_f32 v6, v6, v8
    v_mov_b32_e64 v8, v6
    v_bfe_u32 v210, s97, v210, 3
    v_lshl_add_u32 v210, v210, 7, s63
    v_permlane16_swap_b32 v6, v8
    v_add_f32 v6, v6, v8
    v_mov_b32 v8, v6
    v_mov_b32 v28, s35
    v_cmp_gt_u32 s[44:45], 4, v0
    v_permlane32_swap_b32 v6, v8
    s_nop 0
    v_fma_f32 v10, v6, v138, v146
    v_fma_f32 v12, v6, v139, v147
    v_fma_f32 v10, -v8, v139, v10
    v_fma_f32 v12, v8, v138, v12
    v_fma_f32 v11, v10, v132, v142
    v_fma_f32 v13, v10, v133, v144
    v_fma_f32 v11, -v12, v133, v11
    v_fma_f32 v13, v12, v132, v13
    v_pk_fma_f32 v[32:33], v[10:11], v[128:129], v[32:33] op_sel_hi:[1,0,1]
    v_pk_fma_f32 v[36:37], v[12:13], v[128:129], v[36:37] op_sel_hi:[1,0,1]
    v_pk_fma_f32 v[32:33], v[12:13], v[128:129], v[32:33] op_sel:[0,1,0] neg_lo:[1,0,0] neg_hi:[1,0,0]
    v_pk_fma_f32 v[36:37], v[10:11], v[128:129], v[36:37] op_sel:[0,1,0]
    v_pk_fma_f32 v[34:35], v[32:33], v[128:129], v[34:35] op_sel_hi:[1,0,1]
    v_pk_fma_f32 v[38:39], v[36:37], v[128:129], v[38:39] op_sel_hi:[1,0,1]
    v_pk_fma_f32 v[34:35], v[36:37], v[128:129], v[34:35] op_sel:[0,1,0] neg_lo:[1,0,0] neg_hi:[1,0,0]
    v_pk_fma_f32 v[38:39], v[32:33], v[128:129], v[38:39] op_sel:[0,1,0]
    v_cvt_pk_bf16_f32 v224, v32, v34
    v_cvt_pk_bf16_f32 v232, v33, v35
    v_cvt_pk_bf16_f32 v240, -v36, -v38
    v_cvt_pk_bf16_f32 v248, -v37, -v39
    v_pk_fma_f32 v[40:41], v[34:35], v[128:129], v[40:41] op_sel_hi:[1,0,1]
    v_pk_fma_f32 v[44:45], v[38:39], v[128:129], v[44:45] op_sel_hi:[1,0,1]
    v_pk_fma_f32 v[40:41], v[38:39], v[128:129], v[40:41] op_sel:[0,1,0] neg_lo:[1,0,0] neg_hi:[1,0,0]
    v_pk_fma_f32 v[44:45], v[34:35], v[128:129], v[44:45] op_sel:[0,1,0]
    v_pk_fma_f32 v[42:43], v[40:41], v[128:129], v[42:43] op_sel_hi:[1,0,1]
    v_pk_fma_f32 v[46:47], v[44:45], v[128:129], v[46:47] op_sel_hi:[1,0,1]
    v_pk_fma_f32 v[42:43], v[44:45], v[128:129], v[42:43] op_sel:[0,1,0] neg_lo:[1,0,0] neg_hi:[1,0,0]
    v_pk_fma_f32 v[46:47], v[40:41], v[128:129], v[46:47] op_sel:[0,1,0]
    v_cvt_pk_bf16_f32 v225, v40, v42
    v_cvt_pk_bf16_f32 v233, v41, v43
    v_cvt_pk_bf16_f32 v241, -v44, -v46
    v_cvt_pk_bf16_f32 v249, -v45, -v47
    v_pk_fma_f32 v[48:49], v[42:43], v[128:129], v[48:49] op_sel_hi:[1,0,1]
    v_pk_fma_f32 v[52:53], v[46:47], v[128:129], v[52:53] op_sel_hi:[1,0,1]
    v_pk_fma_f32 v[48:49], v[46:47], v[128:129], v[48:49] op_sel:[0,1,0] neg_lo:[1,0,0] neg_hi:[1,0,0]
    v_pk_fma_f32 v[52:53], v[42:43], v[128:129], v[52:53] op_sel:[0,1,0]
    v_pk_fma_f32 v[50:51], v[48:49], v[128:129], v[50:51] op_sel_hi:[1,0,1]
    v_pk_fma_f32 v[54:55], v[52:53], v[128:129], v[54:55] op_sel_hi:[1,0,1]
    v_pk_fma_f32 v[50:51], v[52:53], v[128:129], v[50:51] op_sel:[0,1,0] neg_lo:[1,0,0] neg_hi:[1,0,0]
    v_pk_fma_f32 v[54:55], v[48:49], v[128:129], v[54:55] op_sel:[0,1,0]
    v_cvt_pk_bf16_f32 v226, v48, v50
    v_cvt_pk_bf16_f32 v234, v49, v51
    v_cvt_pk_bf16_f32 v242, -v52, -v54
    v_cvt_pk_bf16_f32 v250, -v53, -v55
    v_pk_fma_f32 v[56:57], v[50:51], v[128:129], v[56:57] op_sel_hi:[1,0,1]
    v_pk_fma_f32 v[60:61], v[54:55], v[128:129], v[60:61] op_sel_hi:[1,0,1]
    v_pk_fma_f32 v[56:57], v[54:55], v[128:129], v[56:57] op_sel:[0,1,0] neg_lo:[1,0,0] neg_hi:[1,0,0]
    v_pk_fma_f32 v[60:61], v[50:51], v[128:129], v[60:61] op_sel:[0,1,0]
    v_pk_fma_f32 v[58:59], v[56:57], v[128:129], v[58:59] op_sel_hi:[1,0,1]
    v_pk_fma_f32 v[62:63], v[60:61], v[128:129], v[62:63] op_sel_hi:[1,0,1]
    v_pk_fma_f32 v[58:59], v[60:61], v[128:129], v[58:59] op_sel:[0,1,0] neg_lo:[1,0,0] neg_hi:[1,0,0]
    v_pk_fma_f32 v[62:63], v[56:57], v[128:129], v[62:63] op_sel:[0,1,0]
    v_cvt_pk_bf16_f32 v227, v56, v58
    v_cvt_pk_bf16_f32 v235, v57, v59
    v_cvt_pk_bf16_f32 v243, -v60, -v62
    v_cvt_pk_bf16_f32 v251, -v61, -v63
    v_pk_fma_f32 v[64:65], v[58:59], v[128:129], v[64:65] op_sel_hi:[1,0,1]
    ds_write_b128 v216, v[224:227] offset:0
    v_pk_fma_f32 v[68:69], v[62:63], v[128:129], v[68:69] op_sel_hi:[1,0,1]
    v_pk_fma_f32 v[64:65], v[62:63], v[128:129], v[64:65] op_sel:[0,1,0] neg_lo:[1,0,0] neg_hi:[1,0,0]
    v_pk_fma_f32 v[68:69], v[58:59], v[128:129], v[68:69] op_sel:[0,1,0]
    v_pk_fma_f32 v[66:67], v[64:65], v[128:129], v[66:67] op_sel_hi:[1,0,1]
    v_pk_fma_f32 v[70:71], v[68:69], v[128:129], v[70:71] op_sel_hi:[1,0,1]
    v_pk_fma_f32 v[66:67], v[68:69], v[128:129], v[66:67] op_sel:[0,1,0] neg_lo:[1,0,0] neg_hi:[1,0,0]
    v_pk_fma_f32 v[70:71], v[64:65], v[128:129], v[70:71] op_sel:[0,1,0]
    v_cvt_pk_bf16_f32 v228, v64, v66
    v_cvt_pk_bf16_f32 v236, v65, v67
    v_cvt_pk_bf16_f32 v244, -v68, -v70
    ds_write_b128 v218, v[232:235] offset:0
    v_cvt_pk_bf16_f32 v252, -v69, -v71
    v_pk_fma_f32 v[72:73], v[66:67], v[128:129], v[72:73] op_sel_hi:[1,0,1]
    v_pk_fma_f32 v[76:77], v[70:71], v[128:129], v[76:77] op_sel_hi:[1,0,1]
    v_pk_fma_f32 v[72:73], v[70:71], v[128:129], v[72:73] op_sel:[0,1,0] neg_lo:[1,0,0] neg_hi:[1,0,0]
    v_pk_fma_f32 v[76:77], v[66:67], v[128:129], v[76:77] op_sel:[0,1,0]
    v_pk_fma_f32 v[74:75], v[72:73], v[128:129], v[74:75] op_sel_hi:[1,0,1]
    v_pk_fma_f32 v[78:79], v[76:77], v[128:129], v[78:79] op_sel_hi:[1,0,1]
    v_pk_fma_f32 v[74:75], v[76:77], v[128:129], v[74:75] op_sel:[0,1,0] neg_lo:[1,0,0] neg_hi:[1,0,0]
    v_pk_fma_f32 v[78:79], v[72:73], v[128:129], v[78:79] op_sel:[0,1,0]
    v_cvt_pk_bf16_f32 v229, v72, v74
    ds_write_b128 v216, v[240:243] offset:4096
    v_cvt_pk_bf16_f32 v237, v73, v75
    v_cvt_pk_bf16_f32 v245, -v76, -v78
    v_cvt_pk_bf16_f32 v253, -v77, -v79
    v_pk_fma_f32 v[80:81], v[74:75], v[128:129], v[80:81] op_sel_hi:[1,0,1]
    v_pk_fma_f32 v[84:85], v[78:79], v[128:129], v[84:85] op_sel_hi:[1,0,1]
    v_pk_fma_f32 v[80:81], v[78:79], v[128:129], v[80:81] op_sel:[0,1,0] neg_lo:[1,0,0] neg_hi:[1,0,0]
    v_pk_fma_f32 v[84:85], v[74:75], v[128:129], v[84:85] op_sel:[0,1,0]
    v_pk_fma_f32 v[82:83], v[80:81], v[128:129], v[82:83] op_sel_hi:[1,0,1]
    v_pk_fma_f32 v[86:87], v[84:85], v[128:129], v[86:87] op_sel_hi:[1,0,1]
    v_pk_fma_f32 v[82:83], v[84:85], v[128:129], v[82:83] op_sel:[0,1,0] neg_lo:[1,0,0] neg_hi:[1,0,0]
    ds_write_b128 v218, v[248:251] offset:4096
    v_pk_fma_f32 v[86:87], v[80:81], v[128:129], v[86:87] op_sel:[0,1,0]
    v_cvt_pk_bf16_f32 v230, v80, v82
    v_cvt_pk_bf16_f32 v238, v81, v83
    v_cvt_pk_bf16_f32 v246, -v84, -v86
    v_cvt_pk_bf16_f32 v254, -v85, -v87
    v_pk_fma_f32 v[88:89], v[82:83], v[128:129], v[88:89] op_sel_hi:[1,0,1]
    v_pk_fma_f32 v[92:93], v[86:87], v[128:129], v[92:93] op_sel_hi:[1,0,1]
    v_pk_fma_f32 v[88:89], v[86:87], v[128:129], v[88:89] op_sel:[0,1,0] neg_lo:[1,0,0] neg_hi:[1,0,0]
    v_pk_fma_f32 v[92:93], v[82:83], v[128:129], v[92:93] op_sel:[0,1,0]
    v_pk_fma_f32 v[90:91], v[88:89], v[128:129], v[90:91] op_sel_hi:[1,0,1]
    v_pk_fma_f32 v[94:95], v[92:93], v[128:129], v[94:95] op_sel_hi:[1,0,1]
    v_pk_fma_f32 v[90:91], v[92:93], v[128:129], v[90:91] op_sel:[0,1,0] neg_lo:[1,0,0] neg_hi:[1,0,0]
    v_pk_fma_f32 v[94:95], v[88:89], v[128:129], v[94:95] op_sel:[0,1,0]
    v_cvt_pk_bf16_f32 v231, v88, v90
    v_cvt_pk_bf16_f32 v239, v89, v91
    v_cvt_pk_bf16_f32 v247, -v92, -v94
    v_cvt_pk_bf16_f32 v255, -v93, -v95
    ds_write_b128 v217, v[228:231] offset:0
    ds_write_b128 v219, v[236:239] offset:0
    ds_write_b128 v217, v[244:247] offset:4096
    ds_write_b128 v219, v[252:255] offset:4096
    v_lshl_add_u32 v209, v0, 2, s63
    v_cndmask_b32 v209, 2.0, v209, s[44:45]
    v_add_u32 v208, s50, v209
    v_add_u32 v209, s7, v209
    v_accvgpr_read_b32 v96, a136
    v_accvgpr_read_b32 v97, a137
    v_accvgpr_read_b32 v98, a138
    v_accvgpr_read_b32 v99, a139
    v_accvgpr_read_b32 v100, a140
    v_accvgpr_read_b32 v101, a141
    v_accvgpr_read_b32 v102, a142
    v_accvgpr_read_b32 v103, a143
    v_accvgpr_read_b32 v104, a144
    v_accvgpr_read_b32 v105, a145
    v_accvgpr_read_b32 v106, a146
    v_accvgpr_read_b32 v107, a147
    v_accvgpr_read_b32 v108, a148
    v_accvgpr_read_b32 v109, a149
    v_accvgpr_read_b32 v110, a150
    v_accvgpr_read_b32 v111, a151
    v_accvgpr_read_b32 v128, a168
    v_accvgpr_read_b32 v129, a169
    s_waitcnt lgkmcnt(0) vmcnt(3)
    s_barrier
    s_cmp_lg_u32 s50, 0
    s_cbranch_scc1 K_HFAR
    ds_read_b64_tr_b16 v[64:65], v220 offset:0
    ds_read_b64_tr_b16 v[66:67], v221 offset:1024
    ds_read_b64_tr_b16 v[80:81], v222 offset:0
    ds_read_b64_tr_b16 v[82:83], v223 offset:1024
    ds_read_b64_tr_b16 v[68:69], v220 offset:8192
    ds_read_b64_tr_b16 v[70:71], v221 offset:9216
    ds_read_b64_tr_b16 v[84:85], v222 offset:8192
    ds_read_b64_tr_b16 v[86:87], v223 offset:9216
    ds_read_b64_tr_b16 v[72:73], v220 offset:16384
    ds_read_b64_tr_b16 v[74:75], v221 offset:17408
    ds_read_b64_tr_b16 v[88:89], v222 offset:16384
    ds_read_b64_tr_b16 v[90:91], v223 offset:17408
    s_waitcnt lgkmcnt(8)
    s_nop 0
    buffer_store_dwordx4 v[64:67], v24, s[28:31], s68 offen
    buffer_store_dwordx4 v[80:83], v24, s[28:31], s69 offen
    ds_read_b64_tr_b16 v[76:77], v220 offset:24576
    ds_read_b64_tr_b16 v[78:79], v221 offset:25600
    ds_read_b64_tr_b16 v[92:93], v222 offset:24576
    ds_read_b64_tr_b16 v[94:95], v223 offset:25600
    ds_read_b128 v[152:155], v20 offset:0
    ds_read_b128 v[156:159], v20 offset:2048
    ds_read_b128 v[160:163], v20 offset:4096
    ds_read_b128 v[164:167], v20 offset:6144
    s_waitcnt lgkmcnt(12)
    buffer_store_dwordx4 v[68:71], v25, s[28:31], s68 offen
    s_waitcnt lgkmcnt(0)
    v_mfma_f32_16x16x32_bf16 v[32:35], v[64:67], v[152:155], 0
    ds_read_b128 v[168:171], v21 offset:0
    buffer_store_dwordx4 v[84:87], v25, s[28:31], s69 offen
    v_mfma_f32_16x16x32_bf16 v[48:51], v[80:83], v[152:155], 0
    ds_read_b128 v[172:175], v21 offset:2048
    v_mfma_f32_16x16x32_bf16 v[36:39], v[64:67], v[156:159], 0
    ds_read_b128 v[176:179], v21 offset:4096
    buffer_store_dwordx4 v[72:75], v26, s[28:31], s68 offen
    v_mfma_f32_16x16x32_bf16 v[52:55], v[80:83], v[156:159], 0
    ds_read_b128 v[180:183], v21 offset:6144
    v_mfma_f32_16x16x32_bf16 v[40:43], v[64:67], v[160:163], 0
    v_mfma_f32_16x16x32_bf16 v[56:59], v[80:83], v[160:163], 0
    buffer_store_dwordx4 v[88:91], v26, s[28:31], s69 offen
    v_mfma_f32_16x16x32_bf16 v[44:47], v[64:67], v[164:167], 0
    v_mfma_f32_16x16x32_bf16 v[60:63], v[80:83], v[164:167], 0
    s_waitcnt lgkmcnt(0)
    v_mfma_f32_16x16x32_bf16 v[32:35], v[68:71], v[168:171], v[32:35]
    ds_read_b128 v[152:155], v22 offset:0
    buffer_store_dwordx4 v[76:79], v27, s[28:31], s68 offen
    v_mfma_f32_16x16x32_bf16 v[48:51], v[84:87], v[168:171], v[48:51]
    ds_read_b128 v[156:159], v22 offset:2048
    v_mfma_f32_16x16x32_bf16 v[36:39], v[68:71], v[172:175], v[36:39]
    ds_read_b128 v[160:163], v22 offset:4096
    v_mfma_f32_16x16x32_bf16 v[52:55], v[84:87], v[172:175], v[52:55]
    ds_read_b128 v[164:167], v22 offset:6144
    v_mfma_f32_16x16x32_bf16 v[40:43], v[68:71], v[176:179], v[40:43]
    buffer_store_dwordx4 v[92:95], v27, s[28:31], s69 offen
    v_mfma_f32_16x16x32_bf16 v[56:59], v[84:87], v[176:179], v[56:59]
    v_mfma_f32_16x16x32_bf16 v[44:47], v[68:71], v[180:183], v[44:47]
    v_mfma_f32_16x16x32_bf16 v[60:63], v[84:87], v[180:183], v[60:63]
K_HFAR_RET:
    s_bfe_u32 s72, s97, 262164
    s_add_u32 m0, s37, 81920
    s_lshl_b32 s72, s72, 7
    buffer_load_dwordx4 v16, s[16:19], s72 offen offset:0  lds
    buffer_load_dwordx4 v17, s[16:19], s72 offen offset:1024  lds
    buffer_load_dwordx4 v18, s[16:19], s72 offen offset:2048  lds
    buffer_load_dwordx4 v19, s[16:19], s72 offen offset:3072  lds
    s_bfe_u32 s72, s97, 262168
    s_add_u32 m0, s37, 98304
    s_lshl_b32 s72, s72, 7
    buffer_load_dwordx4 v16, s[16:19], s72 offen offset:0  lds
    buffer_load_dwordx4 v17, s[16:19], s72 offen offset:1024  lds
    buffer_load_dwordx4 v18, s[16:19], s72 offen offset:2048  lds
    buffer_load_dwordx4 v19, s[16:19], s72 offen offset:3072  lds
    v_sub_u32 v14, v0, v2
    v_and_b32_e64 v14, 3, v14
    v_and_or_b32 v14, v0, 60, v14
    v_lshlrev_b32 v133, 4, v14
    s_and_b32 s38, s34, 2
    s_lshl3_add_u32 s39, s6, 131072
    v_lshl_add_u32 v14, v2, 6, v1
    v_lshrrev_b32 v15, 2, v1
    v_add_u32 v15, s38, v15
    v_and_b32_e64 v15, 3, v15
    v_lshl_add_u32 v15, v14, 2, v15
    v_lshl_add_u32 v130, v15, 4, s39
    v_sub_u32 v14, 256, v14
    v_lshrrev_b32_e64 v15, 2, v14
    v_add3_u32 v15, v15, s38, 1
    v_and_b32_e64 v15, 3, v15
    v_lshl_add_u32 v15, v14, 2, v15
    v_lshl_add_u32 v131, v15, 4, s39
    v_and_b32 v15, 1023, v15
    v_lshl_add_u32 v132, v15, 4, s39
    v_subrev_u32 v131, 3072, v131
    s_waitcnt vmcnt(8)
    buffer_store_dword v28, v208, s[24:27], s70 offen offset:64
    buffer_store_dword v28, v209, s[24:27], s70 offen offset:64 sc1
    s_barrier
    s_waitcnt lgkmcnt(0)
    v_mfma_f32_16x16x32_bf16 v[32:35], v[72:75], v[152:155], v[32:35]
    ds_read_b128 v[168:171], v23 offset:0
    s_bfe_u32 s72, s97, 262172
    s_add_u32 m0, s37, 114688
    v_mfma_f32_16x16x32_bf16 v[48:51], v[88:91], v[152:155], v[48:51]
    ds_read_b128 v[172:175], v23 offset:2048
    s_lshl_b32 s72, s72, 7
    buffer_load_dwordx4 v16, s[16:19], s72 offen offset:0  lds
    v_mfma_f32_16x16x32_bf16 v[36:39], v[72:75], v[156:159], v[36:39]
    ds_read_b128 v[176:179], v23 offset:4096
    buffer_load_dwordx4 v17, s[16:19], s72 offen offset:1024  lds
    v_mfma_f32_16x16x32_bf16 v[52:55], v[88:91], v[156:159], v[52:55]
    ds_read_b128 v[180:183], v23 offset:6144
    buffer_load_dwordx4 v18, s[16:19], s72 offen offset:2048  lds
    buffer_load_dwordx4 v19, s[16:19], s72 offen offset:3072  lds
    v_mfma_f32_16x16x32_bf16 v[40:43], v[72:75], v[160:163], v[40:43]
    buffer_load_dword v4, v210, s[24:27], s51 offen offset:64 sc1
    s_lshl_b32 s3, s2, 3
    v_mfma_f32_16x16x32_bf16 v[56:59], v[88:91], v[160:163], v[56:59]
    s_add_u32 s3, s3, 22396928
    v_mfma_f32_16x16x32_bf16 v[44:47], v[72:75], v[164:167], v[44:47]
    v_mov_b32 v28, s35
    v_and_b32 v255, 1073741831, v30
    v_mfma_f32_16x16x32_bf16 v[60:63], v[88:91], v[164:167], v[60:63]
    buffer_store_dword v28, v255, s[24:27], s3 offen sc1
    s_waitcnt lgkmcnt(0) vmcnt(1)
    v_cmp_ne_u32 vcc, s35, v4
    s_nop 0
    s_and_b32 s59, vcc_lo, 254
    s_cmp_lg_u32 s59, 0
    s_cbranch_scc1 K_POLL31
K_POLL31_OK:
    v_mfma_f32_16x16x32_bf16 v[32:35], v[76:79], v[168:171], v[32:35]
    ds_read_b128 v[152:155], v20 offset:16384
    s_bfe_u32 s73, s97, 262148
    s_lshl_b32 s73, s73, 8
    s_add_u32 s73, s73, s95
    s_add_u32 s74, s73, 0x20000
    v_mfma_f32_16x16x32_bf16 v[48:51], v[92:95], v[168:171], v[48:51]
    ds_read_b128 v[156:159], v20 offset:18432
    buffer_load_dwordx4 a[0:3], v24, s[28:31], s73 offen sc1
    buffer_load_dwordx4 a[16:19], v24, s[28:31], s74 offen sc1
    buffer_load_dwordx4 a[4:7], v25, s[28:31], s73 offen sc1
    v_mfma_f32_16x16x32_bf16 v[36:39], v[76:79], v[172:175], v[36:39]
    ds_read_b128 v[160:163], v20 offset:20480
    buffer_load_dwordx4 a[20:23], v25, s[28:31], s74 offen sc1
    buffer_load_dwordx4 a[8:11], v26, s[28:31], s73 offen sc1
    buffer_load_dwordx4 a[24:27], v26, s[28:31], s74 offen sc1
    buffer_load_dwordx4 a[12:15], v27, s[28:31], s73 offen sc1
    v_mfma_f32_16x16x32_bf16 v[52:55], v[92:95], v[172:175], v[52:55]
    ds_read_b128 v[164:167], v20 offset:22528
    buffer_load_dwordx4 a[28:31], v27, s[28:31], s74 offen sc1
    s_bfe_u32 s73, s97, 262152
    s_lshl_b32 s73, s73, 8
    v_mfma_f32_16x16x32_bf16 v[40:43], v[76:79], v[176:179], v[40:43]
    s_add_u32 s73, s73, s95
    s_add_u32 s74, s73, 0x20000
    buffer_load_dwordx4 a[32:35], v24, s[28:31], s73 offen sc1
    buffer_load_dwordx4 a[48:51], v24, s[28:31], s74 offen sc1
    v_mfma_f32_16x16x32_bf16 v[56:59], v[92:95], v[176:179], v[56:59]
    buffer_load_dwordx4 a[36:39], v25, s[28:31], s73 offen sc1
    buffer_load_dwordx4 a[52:55], v25, s[28:31], s74 offen sc1
    buffer_load_dwordx4 a[40:43], v26, s[28:31], s73 offen sc1
    v_mfma_f32_16x16x32_bf16 v[44:47], v[76:79], v[180:183], v[44:47]
    buffer_load_dwordx4 a[56:59], v26, s[28:31], s74 offen sc1
    buffer_load_dwordx4 a[44:47], v27, s[28:31], s73 offen sc1
    buffer_load_dwordx4 a[60:63], v27, s[28:31], s74 offen sc1
    s_bfe_u32 s73, s97, 262156
    v_mfma_f32_16x16x32_bf16 v[60:63], v[92:95], v[180:183], v[60:63]
    s_lshl_b32 s73, s73, 8
    s_add_u32 s73, s73, s95
    s_add_u32 s74, s73, 0x20000
    s_waitcnt lgkmcnt(0) vmcnt(14)
    v_mfma_f32_16x16x32_bf16 v[32:35], a[0:3], v[152:155], v[32:35]
    ds_read_b128 v[168:171], v21 offset:16384
    buffer_load_dwordx4 a[64:67], v24, s[28:31], s73 offen sc1
    v_mfma_f32_16x16x32_bf16 v[48:51], a[16:19], v[152:155], v[48:51]
    ds_read_b128 v[172:175], v21 offset:18432
    v_mfma_f32_16x16x32_bf16 v[36:39], a[0:3], v[156:159], v[36:39]
    ds_read_b128 v[176:179], v21 offset:20480
    buffer_load_dwordx4 a[80:83], v24, s[28:31], s74 offen sc1
    v_mfma_f32_16x16x32_bf16 v[52:55], a[16:19], v[156:159], v[52:55]
    ds_read_b128 v[180:183], v21 offset:22528
    v_mfma_f32_16x16x32_bf16 v[40:43], a[0:3], v[160:163], v[40:43]
    v_mfma_f32_16x16x32_bf16 v[56:59], a[16:19], v[160:163], v[56:59]
    buffer_load_dwordx4 a[68:71], v25, s[28:31], s73 offen sc1
    v_mfma_f32_16x16x32_bf16 v[44:47], a[0:3], v[164:167], v[44:47]
    v_mfma_f32_16x16x32_bf16 v[60:63], a[16:19], v[164:167], v[60:63]
    s_waitcnt lgkmcnt(0) vmcnt(15)
    v_mfma_f32_16x16x32_bf16 v[32:35], a[4:7], v[168:171], v[32:35]
    ds_read_b128 v[152:155], v22 offset:16384
    buffer_load_dwordx4 a[84:87], v25, s[28:31], s74 offen sc1
    v_mfma_f32_16x16x32_bf16 v[48:51], a[20:23], v[168:171], v[48:51]
    ds_read_b128 v[156:159], v22 offset:18432
    v_mfma_f32_16x16x32_bf16 v[36:39], a[4:7], v[172:175], v[36:39]
    ds_read_b128 v[160:163], v22 offset:20480
    buffer_load_dwordx4 a[72:75], v26, s[28:31], s73 offen sc1
    v_mfma_f32_16x16x32_bf16 v[52:55], a[20:23], v[172:175], v[52:55]
    ds_read_b128 v[164:167], v22 offset:22528
    v_mfma_f32_16x16x32_bf16 v[40:43], a[4:7], v[176:179], v[40:43]
    v_mfma_f32_16x16x32_bf16 v[56:59], a[20:23], v[176:179], v[56:59]
    buffer_load_dwordx4 a[88:91], v26, s[28:31], s74 offen sc1
    v_mfma_f32_16x16x32_bf16 v[44:47], a[4:7], v[180:183], v[44:47]
    v_mfma_f32_16x16x32_bf16 v[60:63], a[20:23], v[180:183], v[60:63]
    s_waitcnt lgkmcnt(0) vmcnt(16)
    v_mfma_f32_16x16x32_bf16 v[32:35], a[8:11], v[152:155], v[32:35]
    ds_read_b128 v[168:171], v23 offset:16384
    buffer_load_dwordx4 a[76:79], v27, s[28:31], s73 offen sc1
    v_mfma_f32_16x16x32_bf16 v[48:51], a[24:27], v[152:155], v[48:51]
    ds_read_b128 v[172:175], v23 offset:18432
    v_mfma_f32_16x16x32_bf16 v[36:39], a[8:11], v[156:159], v[36:39]
    ds_read_b128 v[176:179], v23 offset:20480
    v_mfma_f32_16x16x32_bf16 v[52:55], a[24:27], v[156:159], v[52:55]
    ds_read_b128 v[180:183], v23 offset:22528
    v_mfma_f32_16x16x32_bf16 v[40:43], a[8:11], v[160:163], v[40:43]
    buffer_load_dwordx4 a[92:95], v27, s[28:31], s74 offen sc1
    v_mfma_f32_16x16x32_bf16 v[56:59], a[24:27], v[160:163], v[56:59]
    v_mfma_f32_16x16x32_bf16 v[44:47], a[8:11], v[164:167], v[44:47]
    v_mfma_f32_16x16x32_bf16 v[60:63], a[24:27], v[164:167], v[60:63]
    s_waitcnt lgkmcnt(0) vmcnt(16)
    v_mfma_f32_16x16x32_bf16 v[32:35], a[12:15], v[168:171], v[32:35]
    ds_read_b128 v[152:155], v20 offset:32768
    s_bfe_u32 s73, s97, 262160
    v_lshlrev_b32 v216, 16, v112
    v_mfma_f32_16x16x32_bf16 v[48:51], a[28:31], v[168:171], v[48:51]
    ds_read_b128 v[156:159], v20 offset:34816
    s_lshl_b32 s73, s73, 8
    v_and_b32 v220, 0xffff0000, v112
    v_mfma_f32_16x16x32_bf16 v[36:39], a[12:15], v[172:175], v[36:39]
    ds_read_b128 v[160:163], v20 offset:36864
    s_add_u32 s73, s73, s95
    v_lshlrev_b32_e64 v217, 16, v113
    v_mfma_f32_16x16x32_bf16 v[52:55], a[28:31], v[172:175], v[52:55]
    ds_read_b128 v[164:167], v20 offset:38912
    v_and_b32 v221, 0xffff0000, v113
    v_mfma_f32_16x16x32_bf16 v[40:43], a[12:15], v[176:179], v[40:43]
    s_add_u32 s74, s73, 0x20000
    v_lshlrev_b32_e64 v218, 16, v114
    v_mfma_f32_16x16x32_bf16 v[56:59], a[28:31], v[176:179], v[56:59]
    buffer_load_dwordx4 a[96:99], v24, s[28:31], s73 offen sc1
    v_and_b32 v222, 0xffff0000, v114
    v_mfma_f32_16x16x32_bf16 v[44:47], a[12:15], v[180:183], v[44:47]
    buffer_load_dwordx4 a[112:115], v24, s[28:31], s74 offen sc1
    v_lshlrev_b32_e64 v219, 16, v115
    v_mfma_f32_16x16x32_bf16 v[60:63], a[28:31], v[180:183], v[60:63]
    s_waitcnt lgkmcnt(0) vmcnt(16)
    v_mfma_f32_16x16x32_bf16 v[32:35], a[32:35], v[152:155], v[32:35]
    ds_read_b128 v[168:171], v21 offset:32768
    buffer_load_dwordx4 a[100:103], v25, s[28:31], s73 offen sc1
    v_and_b32 v223, 0xffff0000, v115
    v_mfma_f32_16x16x32_bf16 v[48:51], a[48:51], v[152:155], v[48:51]
    ds_read_b128 v[172:175], v21 offset:34816
    v_lshlrev_b32 v224, 16, v116
    v_mfma_f32_16x16x32_bf16 v[36:39], a[32:35], v[156:159], v[36:39]
    ds_read_b128 v[176:179], v21 offset:36864
    v_and_b32 v228, 0xffff0000, v116
    v_mfma_f32_16x16x32_bf16 v[52:55], a[48:51], v[156:159], v[52:55]
    ds_read_b128 v[180:183], v21 offset:38912
    v_lshlrev_b32_e64 v225, 16, v117
    v_mfma_f32_16x16x32_bf16 v[40:43], a[32:35], v[160:163], v[40:43]
    buffer_load_dwordx4 a[116:119], v25, s[28:31], s74 offen sc1
    v_and_b32 v229, 0xffff0000, v117
    v_mfma_f32_16x16x32_bf16 v[56:59], a[48:51], v[160:163], v[56:59]
    v_lshlrev_b32_e64 v226, 16, v118
    v_mfma_f32_16x16x32_bf16 v[44:47], a[32:35], v[164:167], v[44:47]
    v_and_b32 v230, 0xffff0000, v118
    v_mfma_f32_16x16x32_bf16 v[60:63], a[48:51], v[164:167], v[60:63]
    s_waitcnt lgkmcnt(0) vmcnt(16)
    v_mfma_f32_16x16x32_bf16 v[32:35], a[36:39], v[168:171], v[32:35]
    ds_read_b128 v[152:155], v22 offset:32768
    buffer_load_dwordx4 a[104:107], v26, s[28:31], s73 offen sc1
    v_lshlrev_b32 v227, 16, v119
    v_mfma_f32_16x16x32_bf16 v[48:51], a[52:55], v[168:171], v[48:51]
    ds_read_b128 v[156:159], v22 offset:34816
    buffer_load_dwordx4 a[120:123], v26, s[28:31], s74 offen sc1
    v_and_b32 v231, 0xffff0000, v119
    v_mfma_f32_16x16x32_bf16 v[36:39], a[36:39], v[172:175], v[36:39]
    ds_read_b128 v[160:163], v22 offset:36864
    s_getpc_b64 s[20:21]
K_PC3:
    s_mov_b32 s22, K_CODE_END-K_PC3
    v_lshlrev_b32 v232, 16, v120
    v_mfma_f32_16x16x32_bf16 v[52:55], a[52:55], v[172:175], v[52:55]
    ds_read_b128 v[164:167], v22 offset:38912
    s_bfe_u32 s3, s2, 0x20003
    v_and_b32 v236, 0xffff0000, v120
    v_mfma_f32_16x16x32_bf16 v[40:43], a[36:39], v[176:179], v[40:43]
    s_lshl2_add_u32 s3, s3, s34
    v_lshlrev_b32 v233, 16, v121
    v_mfma_f32_16x16x32_bf16 v[56:59], a[52:55], v[176:179], v[56:59]
    s_lshl_b32 s3, s3, 11
    v_and_b32 v237, 0xffff0000, v121
    v_mfma_f32_16x16x32_bf16 v[44:47], a[36:39], v[180:183], v[44:47]
    v_lshl_add_u32 v28, v0, 5, s3
    v_lshlrev_b32 v234, 16, v122
    v_mfma_f32_16x16x32_bf16 v[60:63], a[52:55], v[180:183], v[60:63]
    buffer_load_dword v11, v28, s[20:23], 0 offen
    s_waitcnt lgkmcnt(0) vmcnt(17)
    v_mfma_f32_16x16x32_bf16 v[32:35], a[40:43], v[152:155], v[32:35]
    ds_read_b128 v[168:171], v23 offset:32768
    buffer_load_dwordx4 a[108:111], v27, s[28:31], s73 offen sc1
    v_and_b32 v238, 0xffff0000, v122
    v_mfma_f32_16x16x32_bf16 v[48:51], a[56:59], v[152:155], v[48:51]
    ds_read_b128 v[172:175], v23 offset:34816
    v_lshlrev_b32 v235, 16, v123
    v_mfma_f32_16x16x32_bf16 v[36:39], a[40:43], v[156:159], v[36:39]
    ds_read_b128 v[176:179], v23 offset:36864
    v_and_b32 v239, 0xffff0000, v123
    v_mfma_f32_16x16x32_bf16 v[52:55], a[56:59], v[156:159], v[52:55]
    ds_read_b128 v[180:183], v23 offset:38912
    v_lshlrev_b32_e64 v240, 16, v124
    v_mfma_f32_16x16x32_bf16 v[40:43], a[40:43], v[160:163], v[40:43]
    buffer_load_dwordx4 a[124:127], v27, s[28:31], s74 offen sc1
    v_and_b32 v244, 0xffff0000, v124
    v_mfma_f32_16x16x32_bf16 v[56:59], a[56:59], v[160:163], v[56:59]
    v_lshlrev_b32_e64 v241, 16, v125
    v_mfma_f32_16x16x32_bf16 v[44:47], a[40:43], v[164:167], v[44:47]
    v_and_b32 v245, 0xffff0000, v125
    v_mfma_f32_16x16x32_bf16 v[60:63], a[56:59], v[164:167], v[60:63]
    s_waitcnt lgkmcnt(0) vmcnt(17)
    v_mfma_f32_16x16x32_bf16 v[32:35], a[44:47], v[168:171], v[32:35]
    ds_read_b128 v[152:155], v20 offset:49152
    s_bfe_u32 s73, s97, 262164
    v_lshlrev_b32 v242, 16, v126
    v_mfma_f32_16x16x32_bf16 v[48:51], a[60:63], v[168:171], v[48:51]
    ds_read_b128 v[156:159], v20 offset:51200
    s_lshl_b32 s73, s73, 8
    v_and_b32 v246, 0xffff0000, v126
    v_mfma_f32_16x16x32_bf16 v[36:39], a[44:47], v[172:175], v[36:39]
    ds_read_b128 v[160:163], v20 offset:53248
    s_add_u32 s73, s73, s95
    v_lshlrev_b32_e64 v243, 16, v127
    v_mfma_f32_16x16x32_bf16 v[52:55], a[60:63], v[172:175], v[52:55]
    ds_read_b128 v[164:167], v20 offset:55296
    v_and_b32 v247, 0xffff0000, v127
    v_mfma_f32_16x16x32_bf16 v[40:43], a[44:47], v[176:179], v[40:43]
    s_add_u32 s74, s73, 0x20000
    v_xor_b32 v16, 0x100000, v16
    v_mfma_f32_16x16x32_bf16 v[56:59], a[60:63], v[176:179], v[56:59]
    buffer_load_dwordx4 a[128:131], v24, s[28:31], s73 offen sc1
    v_xor_b32 v17, 0x100000, v17
    v_mfma_f32_16x16x32_bf16 v[44:47], a[44:47], v[180:183], v[44:47]
    buffer_load_dwordx4 a[144:147], v24, s[28:31], s74 offen sc1
    v_xor_b32 v18, 0x100000, v18
    v_xor_b32 v20, 0x10000, v20
    v_mfma_f32_16x16x32_bf16 v[60:63], a[60:63], v[180:183], v[60:63]
    s_waitcnt lgkmcnt(0) vmcnt(17)
    v_mfma_f32_16x16x32_bf16 v[32:35], a[64:67], v[152:155], v[32:35]
    ds_read_b128 v[168:171], v21 offset:49152
    buffer_load_dwordx4 a[132:135], v25, s[28:31], s73 offen sc1
    v_xor_b32 v19, 0x100000, v19
    v_mfma_f32_16x16x32_bf16 v[48:51], a[80:83], v[152:155], v[48:51]
    ds_read_b128 v[172:175], v21 offset:51200
    v_lshlrev_b32 v29, 16, v2
    v_mfma_f32_16x16x32_bf16 v[36:39], a[64:67], v[156:159], v[36:39]
    ds_read_b128 v[176:179], v21 offset:53248
    v_lshl_add_u32 v29, v1, 4, v29
    v_mfma_f32_16x16x32_bf16 v[52:55], a[80:83], v[156:159], v[52:55]
    ds_read_b128 v[180:183], v21 offset:55296
    s_lshl_b32 s38, s2, 14
    v_mfma_f32_16x16x32_bf16 v[40:43], a[64:67], v[160:163], v[40:43]
    buffer_load_dwordx4 a[148:151], v25, s[28:31], s74 offen sc1
    s_add_u32 s38, s38, s37
    v_mfma_f32_16x16x32_bf16 v[56:59], a[80:83], v[160:163], v[56:59]
    s_add_u32 s52, s38, 17825792
    v_mfma_f32_16x16x32_bf16 v[44:47], a[64:67], v[164:167], v[44:47]
    s_xor_b32 s38, s38, 65536
    v_xor_b32 v21, 0x10000, v21
    v_mfma_f32_16x16x32_bf16 v[60:63], a[80:83], v[164:167], v[60:63]
    s_waitcnt lgkmcnt(0) vmcnt(17)
    v_mfma_f32_16x16x32_bf16 v[32:35], a[68:71], v[168:171], v[32:35]
    ds_read_b128 v[152:155], v22 offset:49152
    v_lshlrev_b32 v13, 3, v0
    s_add_u32 s54, s38, 17825792
    v_mfma_f32_16x16x32_bf16 v[48:51], a[84:87], v[168:171], v[48:51]
    ds_read_b128 v[156:159], v22 offset:51200
    s_lshl_b32 s70, s34, 9
    s_lshl_b32 s38, s4, 14
    v_mfma_f32_16x16x32_bf16 v[36:39], a[68:71], v[172:175], v[36:39]
    ds_read_b128 v[160:163], v22 offset:53248
    s_add_u32 s70, s70, 22396928
    s_add_u32 s38, s38, s37
    v_mfma_f32_16x16x32_bf16 v[52:55], a[84:87], v[172:175], v[52:55]
    ds_read_b128 v[164:167], v22 offset:55296
    s_add_u32 s53, s38, 13631488
    v_mfma_f32_16x16x32_bf16 v[40:43], a[68:71], v[176:179], v[40:43]
    buffer_load_dword v8, v13, s[24:27], s70 offen sc1
    s_lshl2_add_u32 s38, s32, s34
    v_mfma_f32_16x16x32_bf16 v[56:59], a[84:87], v[176:179], v[56:59]
    buffer_load_dwordx4 a[136:139], v26, s[28:31], s73 offen sc1
    s_lshl_b32 s38, s38, 10
    v_mfma_f32_16x16x32_bf16 v[44:47], a[68:71], v[180:183], v[44:47]
    buffer_load_dwordx4 a[152:155], v26, s[28:31], s74 offen sc1
    s_add_u32 s55, s38, 22282240
    v_xor_b32 v22, 0x10000, v22
    v_mfma_f32_16x16x32_bf16 v[60:63], a[84:87], v[180:183], v[60:63]
    s_waitcnt lgkmcnt(0) vmcnt(18)
    v_mfma_f32_16x16x32_bf16 v[32:35], a[72:75], v[152:155], v[32:35]
    ds_read_b128 v[168:171], v23 offset:49152
    buffer_load_dwordx4 a[140:143], v27, s[28:31], s73 offen sc1
    v_lshlrev_b32_e64 v7, 8, v2
    v_mfma_f32_16x16x32_bf16 v[48:51], a[88:91], v[152:155], v[48:51]
    ds_read_b128 v[172:175], v23 offset:51200
    s_lshl_b32 s38, s94, 16
    v_mfma_f32_16x16x32_bf16 v[36:39], a[72:75], v[156:159], v[36:39]
    ds_read_b128 v[176:179], v23 offset:53248
    s_add_u32 s56, s38, s5
    v_mfma_f32_16x16x32_bf16 v[52:55], a[88:91], v[156:159], v[52:55]
    ds_read_b128 v[180:183], v23 offset:55296
    v_lshlrev_b32_e64 v12, 14, v2
    v_mfma_f32_16x16x32_bf16 v[40:43], a[72:75], v[160:163], v[40:43]
    buffer_load_dwordx4 a[156:159], v27, s[28:31], s74 offen sc1
    v_lshl_add_u32 v12, v1, 4, v12
    v_mfma_f32_16x16x32_bf16 v[56:59], a[88:91], v[160:163], v[56:59]
    s_lshl_b32 s38, s4, 6
    v_mfma_f32_16x16x32_bf16 v[44:47], a[72:75], v[164:167], v[44:47]
    s_add_u32 s58, s38, 22429696
    v_xor_b32 v23, 0x10000, v23
    v_mfma_f32_16x16x32_bf16 v[60:63], a[88:91], v[164:167], v[60:63]
    s_waitcnt lgkmcnt(0) vmcnt(18)
    v_mfma_f32_16x16x32_bf16 v[32:35], a[76:79], v[168:171], v[32:35]
    ds_read_b128 v[152:155], v20 offset:0
    s_bfe_u32 s73, s97, 262168
    s_add_u32 s57, s38, 22413312
    v_mfma_f32_16x16x32_bf16 v[48:51], a[92:95], v[168:171], v[48:51]
    ds_read_b128 v[156:159], v20 offset:2048
    s_lshl_b32 s73, s73, 8
    v_lshl_add_u32 v5, v1, 6, s99
    v_mfma_f32_16x16x32_bf16 v[36:39], a[76:79], v[172:175], v[36:39]
    ds_read_b128 v[160:163], v20 offset:4096
    s_add_u32 s73, s73, s95
    s_xor_b32 s38, s33, 264
    v_mfma_f32_16x16x32_bf16 v[52:55], a[92:95], v[172:175], v[52:55]
    ds_read_b128 v[164:167], v20 offset:6144
    v_mfma_f32_16x16x32_bf16 v[40:43], a[76:79], v[176:179], v[40:43]
    s_add_u32 s74, s73, 0x20000
    s_lshl_b32 s38, s38, 6
    v_mfma_f32_16x16x32_bf16 v[56:59], a[92:95], v[176:179], v[56:59]
    buffer_load_dwordx4 a[160:163], v24, s[28:31], s73 offen sc1
    s_add_u32 s38, s38, s99
    v_mfma_f32_16x16x32_bf16 v[44:47], a[76:79], v[180:183], v[44:47]
    buffer_load_dwordx4 a[176:179], v24, s[28:31], s74 offen sc1
    v_mov_b32_e64 v9, s38
    v_mfma_f32_16x16x32_bf16 v[60:63], a[92:95], v[180:183], v[60:63]
    s_waitcnt lgkmcnt(0) vmcnt(18)
    v_mfma_f32_16x16x32_bf16 v[32:35], a[96:99], v[152:155], v[32:35]
    ds_read_b128 v[168:171], v21 offset:0
    buffer_load_dwordx4 a[164:167], v25, s[28:31], s73 offen sc1
    v_mfma_f32_16x16x32_bf16 v[48:51], a[112:115], v[152:155], v[48:51]
    ds_read_b128 v[172:175], v21 offset:2048
    v_mfma_f32_16x16x32_bf16 v[36:39], a[96:99], v[156:159], v[36:39]
    ds_read_b128 v[176:179], v21 offset:4096
    v_mfma_f32_16x16x32_bf16 v[52:55], a[112:115], v[156:159], v[52:55]
    ds_read_b128 v[180:183], v21 offset:6144
    v_mfma_f32_16x16x32_bf16 v[40:43], a[96:99], v[160:163], v[40:43]
    buffer_load_dwordx4 a[180:183], v25, s[28:31], s74 offen sc1
    v_mfma_f32_16x16x32_bf16 v[56:59], a[112:115], v[160:163], v[56:59]
    v_mfma_f32_16x16x32_bf16 v[44:47], a[96:99], v[164:167], v[44:47]
    v_mfma_f32_16x16x32_bf16 v[60:63], a[112:115], v[164:167], v[60:63]
    s_waitcnt lgkmcnt(0) vmcnt(18)
    v_mfma_f32_16x16x32_bf16 v[32:35], a[100:103], v[168:171], v[32:35]
    ds_read_b128 v[152:155], v22 offset:0
    buffer_load_dwordx4 a[168:171], v26, s[28:31], s73 offen sc1
    v_mfma_f32_16x16x32_bf16 v[48:51], a[116:119], v[168:171], v[48:51]
    ds_read_b128 v[156:159], v22 offset:2048
    v_mfma_f32_16x16x32_bf16 v[36:39], a[100:103], v[172:175], v[36:39]
    ds_read_b128 v[160:163], v22 offset:4096
    v_mfma_f32_16x16x32_bf16 v[52:55], a[116:119], v[172:175], v[52:55]
    ds_read_b128 v[164:167], v22 offset:6144
    v_mfma_f32_16x16x32_bf16 v[40:43], a[100:103], v[176:179], v[40:43]
    buffer_load_dwordx4 a[184:187], v26, s[28:31], s74 offen sc1
    v_mfma_f32_16x16x32_bf16 v[56:59], a[116:119], v[176:179], v[56:59]
    v_mfma_f32_16x16x32_bf16 v[44:47], a[100:103], v[180:183], v[44:47]
    v_mfma_f32_16x16x32_bf16 v[60:63], a[116:119], v[180:183], v[60:63]
    s_waitcnt lgkmcnt(0) vmcnt(18)
    v_mfma_f32_16x16x32_bf16 v[32:35], a[104:107], v[152:155], v[32:35]
    ds_read_b128 v[168:171], v23 offset:0
    buffer_load_dwordx4 a[172:175], v27, s[28:31], s73 offen sc1
    v_mfma_f32_16x16x32_bf16 v[48:51], a[120:123], v[152:155], v[48:51]
    ds_read_b128 v[172:175], v23 offset:2048
    v_mfma_f32_16x16x32_bf16 v[36:39], a[104:107], v[156:159], v[36:39]
    ds_read_b128 v[176:179], v23 offset:4096
    v_mfma_f32_16x16x32_bf16 v[52:55], a[120:123], v[156:159], v[52:55]
    ds_read_b128 v[180:183], v23 offset:6144
    v_mfma_f32_16x16x32_bf16 v[40:43], a[104:107], v[160:163], v[40:43]
    buffer_load_dwordx4 a[188:191], v27, s[28:31], s74 offen sc1
    v_mfma_f32_16x16x32_bf16 v[56:59], a[120:123], v[160:163], v[56:59]
    v_mfma_f32_16x16x32_bf16 v[44:47], a[104:107], v[164:167], v[44:47]
    v_mfma_f32_16x16x32_bf16 v[60:63], a[120:123], v[164:167], v[60:63]
    s_waitcnt lgkmcnt(0) vmcnt(12)
    v_cmp_ne_u32 vcc, s35, v8
    s_nop 0
    s_cbranch_vccnz K_POLL4
K_POLL4_OK:
    s_barrier
    v_mfma_f32_16x16x32_bf16 v[32:35], a[108:111], v[168:171], v[32:35]
    ds_read_b128 v[152:155], v20 offset:16384
    s_bfe_u32 s73, s97, 262172
    v_mfma_f32_16x16x32_bf16 v[48:51], a[124:127], v[168:171], v[48:51]
    ds_read_b128 v[156:159], v20 offset:18432
    s_lshl_b32 s73, s73, 8
    v_mfma_f32_16x16x32_bf16 v[36:39], a[108:111], v[172:175], v[36:39]
    ds_read_b128 v[160:163], v20 offset:20480
    s_add_u32 s73, s73, s95
    v_mfma_f32_16x16x32_bf16 v[52:55], a[124:127], v[172:175], v[52:55]
    ds_read_b128 v[164:167], v20 offset:22528
    v_mfma_f32_16x16x32_bf16 v[40:43], a[108:111], v[176:179], v[40:43]
    s_add_u32 s74, s73, 0x20000
    v_mfma_f32_16x16x32_bf16 v[56:59], a[124:127], v[176:179], v[56:59]
    buffer_load_dwordx4 a[192:195], v24, s[28:31], s73 offen sc1 nt
    v_mfma_f32_16x16x32_bf16 v[44:47], a[108:111], v[180:183], v[44:47]
    buffer_load_dwordx4 a[208:211], v24, s[28:31], s74 offen sc1 nt
    v_mfma_f32_16x16x32_bf16 v[60:63], a[124:127], v[180:183], v[60:63]
    s_waitcnt lgkmcnt(0)
    v_mfma_f32_16x16x32_bf16 v[32:35], a[128:131], v[152:155], v[32:35]
    ds_read_b128 v[168:171], v21 offset:16384
    s_lshl2_add_u32 s70, s4, s34
    v_mfma_f32_16x16x32_bf16 v[48:51], a[144:147], v[152:155], v[48:51]
    ds_read_b128 v[172:175], v21 offset:18432
    s_lshl_b32 s70, s70, 12
    v_mfma_f32_16x16x32_bf16 v[36:39], a[128:131], v[156:159], v[36:39]
    ds_read_b128 v[176:179], v21 offset:20480
    s_add_u32 m0, s37, 131072
    v_mfma_f32_16x16x32_bf16 v[52:55], a[144:147], v[156:159], v[52:55]
    ds_read_b128 v[180:183], v21 offset:22528
    s_add_u32 s70, s70, 9437184
    v_mfma_f32_16x16x32_bf16 v[40:43], a[128:131], v[160:163], v[40:43]
    buffer_load_dwordx4 v133, s[24:27], s70 offen offset:0 sc1 lds
    v_mfma_f32_16x16x32_bf16 v[56:59], a[144:147], v[160:163], v[56:59]
    buffer_load_dwordx4 v133, s[24:27], s70 offen offset:1024 sc1 lds
    v_mfma_f32_16x16x32_bf16 v[44:47], a[128:131], v[164:167], v[44:47]
    buffer_load_dwordx4 a[196:199], v25, s[28:31], s73 offen sc1 nt
    v_mfma_f32_16x16x32_bf16 v[60:63], a[144:147], v[164:167], v[60:63]
    buffer_load_dwordx4 a[212:215], v25, s[28:31], s74 offen sc1 nt
    s_waitcnt lgkmcnt(0)
    v_mfma_f32_16x16x32_bf16 v[32:35], a[132:135], v[168:171], v[32:35]
    ds_read_b128 v[152:155], v22 offset:16384
    buffer_load_dwordx4 v133, s[24:27], s70 offen offset:2048 sc1 lds
    v_mfma_f32_16x16x32_bf16 v[48:51], a[148:151], v[168:171], v[48:51]
    ds_read_b128 v[156:159], v22 offset:18432
    v_mfma_f32_16x16x32_bf16 v[36:39], a[132:135], v[172:175], v[36:39]
    ds_read_b128 v[160:163], v22 offset:20480
    buffer_load_dwordx4 v133, s[24:27], s70 offen offset:3072 sc1 lds
    v_mfma_f32_16x16x32_bf16 v[52:55], a[148:151], v[172:175], v[52:55]
    ds_read_b128 v[164:167], v22 offset:22528
    v_mfma_f32_16x16x32_bf16 v[40:43], a[132:135], v[176:179], v[40:43]
    buffer_load_dwordx4 a[200:203], v26, s[28:31], s73 offen sc1 nt
    v_mfma_f32_16x16x32_bf16 v[56:59], a[148:151], v[176:179], v[56:59]
    v_mfma_f32_16x16x32_bf16 v[44:47], a[132:135], v[180:183], v[44:47]
    buffer_load_dwordx4 a[216:219], v26, s[28:31], s74 offen sc1 nt
    v_mfma_f32_16x16x32_bf16 v[60:63], a[148:151], v[180:183], v[60:63]
    s_waitcnt lgkmcnt(0) vmcnt(20)
    v_mfma_f32_16x16x32_bf16 v[32:35], a[136:139], v[152:155], v[32:35]
    ds_read_b128 v[168:171], v23 offset:16384
    buffer_load_dwordx4 a[204:207], v27, s[28:31], s73 offen sc1 nt
    v_mfma_f32_16x16x32_bf16 v[48:51], a[152:155], v[152:155], v[48:51]
    ds_read_b128 v[172:175], v23 offset:18432
    v_mfma_f32_16x16x32_bf16 v[36:39], a[136:139], v[156:159], v[36:39]
    ds_read_b128 v[176:179], v23 offset:20480
    v_mfma_f32_16x16x32_bf16 v[52:55], a[152:155], v[156:159], v[52:55]
    ds_read_b128 v[180:183], v23 offset:22528
    v_mfma_f32_16x16x32_bf16 v[40:43], a[136:139], v[160:163], v[40:43]
    buffer_load_dwordx4 a[220:223], v27, s[28:31], s74 offen sc1 nt
    v_mfma_f32_16x16x32_bf16 v[56:59], a[152:155], v[160:163], v[56:59]
    v_mfma_f32_16x16x32_bf16 v[44:47], a[136:139], v[164:167], v[44:47]
    v_mfma_f32_16x16x32_bf16 v[60:63], a[152:155], v[164:167], v[60:63]
    s_waitcnt lgkmcnt(0) vmcnt(20)
    v_mfma_f32_16x16x32_bf16 v[32:35], a[140:143], v[168:171], v[32:35]
    ds_read_b128 v[152:155], v20 offset:32768
    v_mfma_f32_16x16x32_bf16 v[48:51], a[156:159], v[168:171], v[48:51]
    ds_read_b128 v[156:159], v20 offset:34816
    v_mfma_f32_16x16x32_bf16 v[36:39], a[140:143], v[172:175], v[36:39]
    ds_read_b128 v[160:163], v20 offset:36864
    v_mfma_f32_16x16x32_bf16 v[52:55], a[156:159], v[172:175], v[52:55]
    ds_read_b128 v[164:167], v20 offset:38912
    v_mfma_f32_16x16x32_bf16 v[40:43], a[140:143], v[176:179], v[40:43]
    v_mfma_f32_16x16x32_bf16 v[56:59], a[156:159], v[176:179], v[56:59]
    v_mfma_f32_16x16x32_bf16 v[44:47], a[140:143], v[180:183], v[44:47]
    v_mfma_f32_16x16x32_bf16 v[60:63], a[156:159], v[180:183], v[60:63]
    s_waitcnt lgkmcnt(0) vmcnt(18)
    v_mfma_f32_16x16x32_bf16 v[32:35], a[160:163], v[152:155], v[32:35]
    ds_read_b128 v[168:171], v21 offset:32768
    s_bfe_u32 s72, s97, 262144
    v_mfma_f32_16x16x32_bf16 v[48:51], a[176:179], v[152:155], v[48:51]
    ds_read_b128 v[172:175], v21 offset:34816
    s_add_u32 m0, s37, 0
    v_mfma_f32_16x16x32_bf16 v[36:39], a[160:163], v[156:159], v[36:39]
    ds_read_b128 v[176:179], v21 offset:36864
    v_mfma_f32_16x16x32_bf16 v[52:55], a[176:179], v[156:159], v[52:55]
    ds_read_b128 v[180:183], v21 offset:38912
    s_lshl_b32 s72, s72, 7
    v_mfma_f32_16x16x32_bf16 v[40:43], a[160:163], v[160:163], v[40:43]
    buffer_load_dwordx4 v16, s[16:19], s72 offen offset:0  lds
    v_mfma_f32_16x16x32_bf16 v[56:59], a[176:179], v[160:163], v[56:59]
    v_mfma_f32_16x16x32_bf16 v[44:47], a[160:163], v[164:167], v[44:47]
    buffer_load_dwordx4 v17, s[16:19], s72 offen offset:1024  lds
    v_mfma_f32_16x16x32_bf16 v[60:63], a[176:179], v[164:167], v[60:63]
    s_waitcnt lgkmcnt(0) vmcnt(18)
    v_mfma_f32_16x16x32_bf16 v[32:35], a[164:167], v[168:171], v[32:35]
    ds_read_b128 v[152:155], v22 offset:32768
    buffer_load_dwordx4 v18, s[16:19], s72 offen offset:2048  lds
    v_mfma_f32_16x16x32_bf16 v[48:51], a[180:183], v[168:171], v[48:51]
    ds_read_b128 v[156:159], v22 offset:34816
    v_mfma_f32_16x16x32_bf16 v[36:39], a[164:167], v[172:175], v[36:39]
    ds_read_b128 v[160:163], v22 offset:36864
    v_mfma_f32_16x16x32_bf16 v[52:55], a[180:183], v[172:175], v[52:55]
    ds_read_b128 v[164:167], v22 offset:38912
    v_mfma_f32_16x16x32_bf16 v[40:43], a[164:167], v[176:179], v[40:43]
    buffer_load_dwordx4 v19, s[16:19], s72 offen offset:3072  lds
    v_mfma_f32_16x16x32_bf16 v[56:59], a[180:183], v[176:179], v[56:59]
    v_mfma_f32_16x16x32_bf16 v[44:47], a[164:167], v[180:183], v[44:47]
    v_mfma_f32_16x16x32_bf16 v[60:63], a[180:183], v[180:183], v[60:63]
    s_waitcnt lgkmcnt(0) vmcnt(8)
    s_barrier
    v_mfma_f32_16x16x32_bf16 v[32:35], a[168:171], v[152:155], v[32:35]
    ds_read_b128 v[168:171], v23 offset:32768
    s_bfe_u32 s72, s97, 262148
    v_mfma_f32_16x16x32_bf16 v[48:51], a[184:187], v[152:155], v[48:51]
    ds_read_b128 v[172:175], v23 offset:34816
    s_add_u32 m0, s37, 16384
    v_mfma_f32_16x16x32_bf16 v[36:39], a[168:171], v[156:159], v[36:39]
    ds_read_b128 v[176:179], v23 offset:36864
    v_mfma_f32_16x16x32_bf16 v[52:55], a[184:187], v[156:159], v[52:55]
    ds_read_b128 v[180:183], v23 offset:38912
    s_lshl_b32 s72, s72, 7
    v_mfma_f32_16x16x32_bf16 v[40:43], a[168:171], v[160:163], v[40:43]
    ds_read_b64 v[184:185], v130 offset:0
    buffer_load_dwordx4 v16, s[16:19], s72 offen offset:0  lds
    v_mfma_f32_16x16x32_bf16 v[56:59], a[184:187], v[160:163], v[56:59]
    ds_read_b64 v[186:187], v130 offset:1024
    v_mfma_f32_16x16x32_bf16 v[44:47], a[168:171], v[164:167], v[44:47]
    ds_read_b64 v[188:189], v130 offset:2048
    buffer_load_dwordx4 v17, s[16:19], s72 offen offset:1024  lds
    v_mfma_f32_16x16x32_bf16 v[60:63], a[184:187], v[164:167], v[60:63]
    ds_read_b64 v[190:191], v130 offset:3072
    s_waitcnt lgkmcnt(4)
    v_mfma_f32_16x16x32_bf16 v[32:35], a[172:175], v[168:171], v[32:35]
    ds_read_b128 v[152:155], v20 offset:49152
    buffer_load_dwordx4 v18, s[16:19], s72 offen offset:2048  lds
    s_waitcnt lgkmcnt(1)
    v_mfma_f32_16x16x32_bf16 v[48:51], a[188:191], v[168:171], v[48:51]
    ds_read_b128 v[156:159], v20 offset:51200
    v_swap_b32 v185, v186
    v_mfma_f32_16x16x32_bf16 v[36:39], a[172:175], v[172:175], v[36:39]
    ds_read_b128 v[160:163], v20 offset:53248
    v_mfma_f32_16x16x32_bf16 v[52:55], a[188:191], v[172:175], v[52:55]
    ds_read_b128 v[164:167], v20 offset:55296
    v_swap_b32 v189, v190
    v_mfma_f32_16x16x32_bf16 v[40:43], a[172:175], v[176:179], v[40:43]
    ds_read_b64 v[192:193], v132 offset:0
    buffer_load_dwordx4 v19, s[16:19], s72 offen offset:3072  lds
    v_swap_b32 v186, v188
    v_mfma_f32_16x16x32_bf16 v[56:59], a[188:191], v[176:179], v[56:59]
    ds_read_b64 v[194:195], v131 offset:2048
    v_mfma_f32_16x16x32_bf16 v[44:47], a[172:175], v[180:183], v[44:47]
    ds_read_b64 v[196:197], v131 offset:1024
    v_swap_b32 v187, v189
    v_xor_b32 v20, 0x10000, v20
    v_mfma_f32_16x16x32_bf16 v[60:63], a[188:191], v[180:183], v[60:63]
    ds_read_b64 v[198:199], v131 offset:0
    v_mfma_f32_16x16x32_bf16 v[112:115], v[184:187], a[224:227], 0
    s_bfe_u32 s72, s97, 262152
    v_mfma_f32_16x16x32_bf16 v[116:119], v[184:187], a[228:231], 0
    s_add_u32 m0, s37, 32768
    s_waitcnt lgkmcnt(0)
    v_swap_b32 v193, v194
    v_mfma_f32_16x16x32_bf16 v[120:123], v[184:187], a[232:235], 0
    v_swap_b32 v197, v198
    v_swap_b32 v194, v196
    v_mfma_f32_16x16x32_bf16 v[124:127], v[184:187], a[236:239], 0
    s_lshl_b32 s72, s72, 7
    v_swap_b32 v195, v197
    v_mfma_f32_16x16x32_bf16 v[144:147], v[188:191], a[224:227], 0
    buffer_load_dwordx4 v16, s[16:19], s72 offen offset:0  lds
    v_mfma_f32_16x16x32_bf16 v[148:151], v[188:191], a[228:231], 0
    v_mfma_f32_16x16x32_bf16 v[248:251], v[188:191], a[232:235], 0
    buffer_load_dwordx4 v17, s[16:19], s72 offen offset:1024  lds
    v_mfma_f32_16x16x32_bf16 v[252:255], v[188:191], a[236:239], 0
    buffer_load_dwordx4 v18, s[16:19], s72 offen offset:2048  lds
    v_mfma_f32_16x16x32_bf16 v[112:115], v[192:195], a[224:227], v[112:115]
    v_mfma_f32_16x16x32_bf16 v[116:119], v[192:195], a[228:231], v[116:119]
    buffer_load_dwordx4 v19, s[16:19], s72 offen offset:3072  lds
    v_mfma_f32_16x16x32_bf16 v[120:123], v[192:195], a[240:243], v[120:123]
    s_bfe_u32 s72, s97, 262156
    v_mfma_f32_16x16x32_bf16 v[124:127], v[192:195], a[244:247], v[124:127]
    v_mfma_f32_16x16x32_bf16 v[144:147], v[196:199], a[224:227], v[144:147]
    s_add_u32 m0, s37, 49152
    v_mfma_f32_16x16x32_bf16 v[148:151], v[196:199], a[228:231], v[148:151]
    s_lshl_b32 s72, s72, 7
    v_mfma_f32_16x16x32_bf16 v[248:251], v[196:199], a[240:243], v[248:251]
    v_mfma_f32_16x16x32_bf16 v[252:255], v[196:199], a[244:247], v[252:255]
    v_pk_mul_f32 v[134:135], v[112:113], v[96:97]
    v_pk_mul_f32 v[136:137], v[116:117], v[96:97]
    v_pk_fma_f32 v[134:135], v[116:117], v[104:105], v[134:135]
    v_pk_fma_f32 v[136:137], v[112:113], v[104:105], v[136:137] neg_lo:[1,0,0] neg_hi:[1,0,0]
    v_pk_mul_f32 v[138:139], v[114:115], v[98:99]
    v_pk_mul_f32 v[140:141], v[118:119], v[98:99]
    v_pk_fma_f32 v[138:139], v[118:119], v[106:107], v[138:139]
    v_pk_fma_f32 v[140:141], v[114:115], v[106:107], v[140:141] neg_lo:[1,0,0] neg_hi:[1,0,0]
    v_cvt_pk_bf16_f32 v184, v134, v136
    v_cvt_pk_bf16_f32 v185, v135, v137
    v_cvt_pk_bf16_f32 v186, v138, v140
    v_cvt_pk_bf16_f32 v187, v139, v141
    v_pk_mul_f32 v[134:135], v[120:121], v[100:101]
    v_pk_mul_f32 v[136:137], v[124:125], v[100:101]
    v_pk_fma_f32 v[134:135], v[124:125], v[108:109], v[134:135]
    v_pk_fma_f32 v[136:137], v[120:121], v[108:109], v[136:137] neg_lo:[1,0,0] neg_hi:[1,0,0]
    v_pk_mul_f32 v[138:139], v[122:123], v[102:103]
    v_pk_mul_f32 v[140:141], v[126:127], v[102:103]
    v_pk_fma_f32 v[138:139], v[126:127], v[110:111], v[138:139]
    v_pk_fma_f32 v[140:141], v[122:123], v[110:111], v[140:141] neg_lo:[1,0,0] neg_hi:[1,0,0]
    v_cvt_pk_bf16_f32 v188, v134, v136
    v_cvt_pk_bf16_f32 v189, v135, v137
    v_cvt_pk_bf16_f32 v190, v138, v140
    v_cvt_pk_bf16_f32 v191, v139, v141
    v_pk_mul_f32 v[134:135], v[144:145], v[96:97]
    v_pk_mul_f32 v[136:137], v[148:149], v[96:97]
    v_pk_fma_f32 v[134:135], v[148:149], v[104:105], v[134:135]
    v_pk_fma_f32 v[136:137], v[144:145], v[104:105], v[136:137] neg_lo:[1,0,0] neg_hi:[1,0,0]
    v_pk_mul_f32 v[138:139], v[146:147], v[98:99]
    v_pk_mul_f32 v[140:141], v[150:151], v[98:99]
    v_pk_fma_f32 v[138:139], v[150:151], v[106:107], v[138:139]
    v_pk_fma_f32 v[140:141], v[146:147], v[106:107], v[140:141] neg_lo:[1,0,0] neg_hi:[1,0,0]
    v_cvt_pk_bf16_f32 v192, v134, v136
    v_cvt_pk_bf16_f32 v193, v135, v137
    v_cvt_pk_bf16_f32 v194, v138, v140
    v_cvt_pk_bf16_f32 v195, v139, v141
    v_pk_mul_f32 v[134:135], v[248:249], v[100:101]
    v_pk_mul_f32 v[136:137], v[252:253], v[100:101]
    v_pk_fma_f32 v[134:135], v[252:253], v[108:109], v[134:135]
    v_pk_fma_f32 v[136:137], v[248:249], v[108:109], v[136:137] neg_lo:[1,0,0] neg_hi:[1,0,0]
    v_pk_mul_f32 v[138:139], v[250:251], v[102:103]
    v_pk_mul_f32 v[140:141], v[254:255], v[102:103]
    v_pk_fma_f32 v[138:139], v[254:255], v[110:111], v[138:139]
    v_pk_fma_f32 v[140:141], v[250:251], v[110:111], v[140:141] neg_lo:[1,0,0] neg_hi:[1,0,0]
    v_cvt_pk_bf16_f32 v196, v134, v136
    v_cvt_pk_bf16_f32 v197, v135, v137
    v_cvt_pk_bf16_f32 v198, v138, v140
    v_cvt_pk_bf16_f32 v199, v139, v141
    v_mfma_f32_16x16x32_bf16 v[112:115], a[224:227], v[184:187], 0
    buffer_load_dwordx4 v16, s[16:19], s72 offen offset:0  lds
    v_mfma_f32_16x16x32_bf16 v[116:119], a[228:231], v[184:187], 0
    buffer_load_dwordx4 v17, s[16:19], s72 offen offset:1024  lds
    v_mfma_f32_16x16x32_bf16 v[120:123], a[224:227], v[188:191], 0
    v_mfma_f32_16x16x32_bf16 v[124:127], a[228:231], v[188:191], 0
    buffer_load_dwordx4 v18, s[16:19], s72 offen offset:2048  lds
    v_mfma_f32_16x16x32_bf16 v[144:147], a[224:227], v[192:195], 0
    buffer_load_dwordx4 v19, s[16:19], s72 offen offset:3072  lds
    v_mfma_f32_16x16x32_bf16 v[148:151], a[228:231], v[192:195], 0
    v_mfma_f32_16x16x32_bf16 v[248:251], a[224:227], v[196:199], 0
    v_mfma_f32_16x16x32_bf16 v[252:255], a[228:231], v[196:199], 0
    v_pk_fma_f32 v[216:217], v[112:113], v[128:129], v[216:217] op_sel_hi:[1,0,1]
    v_pk_fma_f32 v[218:219], v[114:115], v[128:129], v[218:219] op_sel_hi:[1,0,1]
    v_pk_fma_f32 v[220:221], v[116:117], v[128:129], v[220:221] op_sel_hi:[1,0,1] neg_lo:[1,0,0] neg_hi:[1,0,0]
    v_pk_fma_f32 v[222:223], v[118:119], v[128:129], v[222:223] op_sel_hi:[1,0,1] neg_lo:[1,0,0] neg_hi:[1,0,0]
    v_pk_fma_f32 v[224:225], v[120:121], v[128:129], v[224:225] op_sel_hi:[1,0,1]
    v_pk_fma_f32 v[226:227], v[122:123], v[128:129], v[226:227] op_sel_hi:[1,0,1]
    v_pk_fma_f32 v[228:229], v[124:125], v[128:129], v[228:229] op_sel_hi:[1,0,1] neg_lo:[1,0,0] neg_hi:[1,0,0]
    v_pk_fma_f32 v[230:231], v[126:127], v[128:129], v[230:231] op_sel_hi:[1,0,1] neg_lo:[1,0,0] neg_hi:[1,0,0]
    v_pk_fma_f32 v[232:233], v[144:145], v[128:129], v[232:233] op_sel:[0,1,0]
    v_pk_fma_f32 v[234:235], v[146:147], v[128:129], v[234:235] op_sel:[0,1,0]
    v_pk_fma_f32 v[236:237], v[148:149], v[128:129], v[236:237] op_sel:[0,1,0] neg_lo:[1,0,0] neg_hi:[1,0,0]
    v_pk_fma_f32 v[238:239], v[150:151], v[128:129], v[238:239] op_sel:[0,1,0] neg_lo:[1,0,0] neg_hi:[1,0,0]
    v_pk_fma_f32 v[240:241], v[248:249], v[128:129], v[240:241] op_sel:[0,1,0]
    v_pk_fma_f32 v[242:243], v[250:251], v[128:129], v[242:243] op_sel:[0,1,0]
    v_pk_fma_f32 v[244:245], v[252:253], v[128:129], v[244:245] op_sel:[0,1,0] neg_lo:[1,0,0] neg_hi:[1,0,0]
    v_pk_fma_f32 v[246:247], v[254:255], v[128:129], v[246:247] op_sel:[0,1,0] neg_lo:[1,0,0] neg_hi:[1,0,0]
    v_mfma_f32_16x16x32_bf16 v[32:35], a[192:195], v[152:155], v[32:35]
    ds_read_b128 v[168:171], v21 offset:49152
    s_lshl_b32 s70, s32, 10
    v_cvt_pk_bf16_f32 v184, v216, v220
    v_mfma_f32_16x16x32_bf16 v[48:51], a[208:211], v[152:155], v[48:51]
    ds_read_b128 v[172:175], v21 offset:51200
    v_cvt_pk_bf16_f32 v185, v224, v228
    v_mfma_f32_16x16x32_bf16 v[36:39], a[192:195], v[156:159], v[36:39]
    ds_read_b128 v[176:179], v21 offset:53248
    v_cvt_pk_bf16_f32 v186, v232, v236
    v_mfma_f32_16x16x32_bf16 v[52:55], a[208:211], v[156:159], v[52:55]
    ds_read_b128 v[180:183], v21 offset:55296
    v_cvt_pk_bf16_f32 v187, v240, v244
    v_mfma_f32_16x16x32_bf16 v[40:43], a[192:195], v[160:163], v[40:43]
    s_add_u32 s70, s70, 22413312
    v_cvt_pk_bf16_f32 v188, v217, v221
    v_mfma_f32_16x16x32_bf16 v[56:59], a[208:211], v[160:163], v[56:59]
    v_cvt_pk_bf16_f32 v189, v225, v229
    v_mfma_f32_16x16x32_bf16 v[44:47], a[192:195], v[164:167], v[44:47]
    v_cvt_pk_bf16_f32 v190, v233, v237
    v_xor_b32 v21, 0x10000, v21
    v_mfma_f32_16x16x32_bf16 v[60:63], a[208:211], v[164:167], v[60:63]
    v_cvt_pk_bf16_f32 v191, v241, v245
    s_waitcnt lgkmcnt(0)
    v_mfma_f32_16x16x32_bf16 v[32:35], a[196:199], v[168:171], v[32:35]
    ds_read_b128 v[152:155], v22 offset:49152
    buffer_store_dwordx4 v[184:187], v29, s[24:27], s75 offen sc1
    v_cvt_pk_bf16_f32 v192, v218, v222
    v_mfma_f32_16x16x32_bf16 v[48:51], a[212:215], v[168:171], v[48:51]
    ds_read_b128 v[156:159], v22 offset:51200
    v_cvt_pk_bf16_f32 v193, v226, v230
    v_mfma_f32_16x16x32_bf16 v[36:39], a[196:199], v[172:175], v[36:39]
    ds_read_b128 v[160:163], v22 offset:53248
    v_cvt_pk_bf16_f32 v194, v234, v238
    v_mfma_f32_16x16x32_bf16 v[52:55], a[212:215], v[172:175], v[52:55]
    ds_read_b128 v[164:167], v22 offset:55296
    v_cvt_pk_bf16_f32 v195, v242, v246
    v_mfma_f32_16x16x32_bf16 v[40:43], a[196:199], v[176:179], v[40:43]
    s_add_u32 s75, s75, 16384
    v_cvt_pk_bf16_f32 v196, v219, v223
    v_mfma_f32_16x16x32_bf16 v[56:59], a[212:215], v[176:179], v[56:59]
    v_cvt_pk_bf16_f32 v197, v227, v231
    v_mfma_f32_16x16x32_bf16 v[44:47], a[196:199], v[180:183], v[44:47]
    v_cvt_pk_bf16_f32 v198, v235, v239
    v_xor_b32 v22, 0x10000, v22
    v_mfma_f32_16x16x32_bf16 v[60:63], a[212:215], v[180:183], v[60:63]
    v_cvt_pk_bf16_f32 v199, v243, v247
    s_waitcnt lgkmcnt(0) vmcnt(19)
    v_mfma_f32_16x16x32_bf16 v[32:35], a[200:203], v[152:155], v[32:35]
    ds_read_b128 v[168:171], v23 offset:49152
    buffer_store_dwordx4 v[188:191], v29, s[24:27], s75 offen sc1
    v_mfma_f32_16x16x32_bf16 v[48:51], a[216:219], v[152:155], v[48:51]
    ds_read_b128 v[172:175], v23 offset:51200
    v_mfma_f32_16x16x32_bf16 v[36:39], a[200:203], v[156:159], v[36:39]
    ds_read_b128 v[176:179], v23 offset:53248
    v_mfma_f32_16x16x32_bf16 v[52:55], a[216:219], v[156:159], v[52:55]
    ds_read_b128 v[180:183], v23 offset:55296
    v_mfma_f32_16x16x32_bf16 v[40:43], a[200:203], v[160:163], v[40:43]
    s_add_u32 s75, s75, 16384
    v_mfma_f32_16x16x32_bf16 v[56:59], a[216:219], v[160:163], v[56:59]
    v_mfma_f32_16x16x32_bf16 v[44:47], a[200:203], v[164:167], v[44:47]
    v_xor_b32 v23, 0x10000, v23
    v_mfma_f32_16x16x32_bf16 v[60:63], a[216:219], v[164:167], v[60:63]
    s_waitcnt lgkmcnt(0) vmcnt(14)
    s_barrier
    v_mfma_f32_16x16x32_bf16 v[32:35], a[204:207], v[168:171], v[32:35]
    ds_read_b128 v[152:155], v20 offset:0
    buffer_store_dwordx4 v[192:195], v29, s[24:27], s75 offen sc1
    v_mfma_f32_16x16x32_bf16 v[48:51], a[220:223], v[168:171], v[48:51]
    ds_read_b128 v[156:159], v20 offset:2048
    v_mfma_f32_16x16x32_bf16 v[36:39], a[204:207], v[172:175], v[36:39]
    ds_read_b128 v[160:163], v20 offset:4096
    v_mfma_f32_16x16x32_bf16 v[52:55], a[220:223], v[172:175], v[52:55]
    ds_read_b128 v[164:167], v20 offset:6144
    v_mfma_f32_16x16x32_bf16 v[40:43], a[204:207], v[176:179], v[40:43]
    s_add_u32 s75, s75, 16384
    v_mfma_f32_16x16x32_bf16 v[56:59], a[220:223], v[176:179], v[56:59]
    v_mfma_f32_16x16x32_bf16 v[44:47], a[204:207], v[180:183], v[44:47]
    v_mfma_f32_16x16x32_bf16 v[60:63], a[220:223], v[180:183], v[60:63]
    s_waitcnt lgkmcnt(0)
    v_mfma_f32_16x16x32_bf16 v[216:219], v[64:67], v[152:155], 0
    ds_read_b128 v[168:171], v21 offset:0
    buffer_store_dwordx4 v[196:199], v29, s[24:27], s75 offen sc1
    v_mfma_f32_16x16x32_bf16 v[232:235], v[80:83], v[152:155], 0
    ds_read_b128 v[172:175], v21 offset:2048
    v_mfma_f32_16x16x32_bf16 v[220:223], v[64:67], v[156:159], 0
    ds_read_b128 v[176:179], v21 offset:4096
    v_cvt_pk_bf16_f32 v200, v32, v36
    v_cvt_pk_bf16_f32 v201, v40, v44
    v_mfma_f32_16x16x32_bf16 v[236:239], v[80:83], v[156:159], 0
    ds_read_b128 v[180:183], v21 offset:6144
    v_cvt_pk_bf16_f32 v202, v48, v52
    v_mfma_f32_16x16x32_bf16 v[224:227], v[64:67], v[160:163], 0
    v_cvt_pk_bf16_f32 v203, v56, v60
    v_mfma_f32_16x16x32_bf16 v[240:243], v[80:83], v[160:163], 0
    v_cvt_pk_bf16_f32 v204, v33, v37
    v_cvt_pk_bf16_f32 v205, v41, v45
    v_mfma_f32_16x16x32_bf16 v[228:231], v[64:67], v[164:167], 0
    v_cvt_pk_bf16_f32 v206, v49, v53
    v_mfma_f32_16x16x32_bf16 v[244:247], v[80:83], v[164:167], 0
    v_cvt_pk_bf16_f32 v207, v57, v61
    s_waitcnt lgkmcnt(0)
    v_mfma_f32_16x16x32_bf16 v[216:219], v[68:71], v[168:171], v[216:219]
    ds_read_b128 v[152:155], v22 offset:0
    buffer_store_dwordx4 v[200:203], v3, s[24:27], s52 offen offset:0 sc1
    v_cvt_pk_bf16_f32 v208, v34, v38
    v_mfma_f32_16x16x32_bf16 v[232:235], v[84:87], v[168:171], v[232:235]
    ds_read_b128 v[156:159], v22 offset:2048
    v_cvt_pk_bf16_f32 v209, v42, v46
    v_mfma_f32_16x16x32_bf16 v[220:223], v[68:71], v[172:175], v[220:223]
    ds_read_b128 v[160:163], v22 offset:4096
    v_cvt_pk_bf16_f32 v210, v50, v54
    v_mfma_f32_16x16x32_bf16 v[236:239], v[84:87], v[172:175], v[236:239]
    ds_read_b128 v[164:167], v22 offset:6144
    v_cvt_pk_bf16_f32 v211, v58, v62
    v_mfma_f32_16x16x32_bf16 v[224:227], v[68:71], v[176:179], v[224:227]
    buffer_store_dwordx4 v[204:207], v3, s[24:27], s52 offen offset:1024 sc1
    v_cvt_pk_bf16_f32 v212, v35, v39
    v_mfma_f32_16x16x32_bf16 v[240:243], v[84:87], v[176:179], v[240:243]
    v_cvt_pk_bf16_f32 v213, v43, v47
    v_mfma_f32_16x16x32_bf16 v[228:231], v[68:71], v[180:183], v[228:231]
    v_cvt_pk_bf16_f32 v214, v51, v55
    v_mfma_f32_16x16x32_bf16 v[244:247], v[84:87], v[180:183], v[244:247]
    v_cvt_pk_bf16_f32 v215, v59, v63
    s_waitcnt lgkmcnt(0)
    v_mfma_f32_16x16x32_bf16 v[216:219], v[72:75], v[152:155], v[216:219]
    ds_read_b128 v[168:171], v23 offset:0
    buffer_store_dwordx4 v[208:211], v3, s[24:27], s52 offen offset:2048 sc1
    v_mfma_f32_16x16x32_bf16 v[232:235], v[88:91], v[152:155], v[232:235]
    ds_read_b128 v[172:175], v23 offset:2048
    v_mfma_f32_16x16x32_bf16 v[220:223], v[72:75], v[156:159], v[220:223]
    ds_read_b128 v[176:179], v23 offset:4096
    v_mfma_f32_16x16x32_bf16 v[236:239], v[88:91], v[156:159], v[236:239]
    ds_read_b128 v[180:183], v23 offset:6144
    v_mfma_f32_16x16x32_bf16 v[224:227], v[72:75], v[160:163], v[224:227]
    buffer_store_dwordx4 v[212:215], v3, s[24:27], s52 offen offset:3072 sc1
    v_mfma_f32_16x16x32_bf16 v[240:243], v[88:91], v[160:163], v[240:243]
    v_mfma_f32_16x16x32_bf16 v[228:231], v[72:75], v[164:167], v[228:231]
    v_mfma_f32_16x16x32_bf16 v[244:247], v[88:91], v[164:167], v[244:247]
    s_waitcnt lgkmcnt(0) vmcnt(8)
    s_barrier
    v_mfma_f32_16x16x32_bf16 v[216:219], v[76:79], v[168:171], v[216:219]
    ds_read_b128 v[152:155], v20 offset:16384
    v_mfma_f32_16x16x32_bf16 v[232:235], v[92:95], v[168:171], v[232:235]
    ds_read_b128 v[156:159], v20 offset:18432
    v_mfma_f32_16x16x32_bf16 v[220:223], v[76:79], v[172:175], v[220:223]
    ds_read_b128 v[160:163], v20 offset:20480
    v_mfma_f32_16x16x32_bf16 v[236:239], v[92:95], v[172:175], v[236:239]
    ds_read_b128 v[164:167], v20 offset:22528
    v_mfma_f32_16x16x32_bf16 v[224:227], v[76:79], v[176:179], v[224:227]
    v_mfma_f32_16x16x32_bf16 v[240:243], v[92:95], v[176:179], v[240:243]
    v_mfma_f32_16x16x32_bf16 v[228:231], v[76:79], v[180:183], v[228:231]
    v_mfma_f32_16x16x32_bf16 v[244:247], v[92:95], v[180:183], v[244:247]
    s_waitcnt lgkmcnt(0)
    v_mfma_f32_16x16x32_bf16 v[216:219], a[0:3], v[152:155], v[216:219]
    ds_read_b128 v[168:171], v21 offset:16384
    v_mfma_f32_16x16x32_bf16 v[232:235], a[16:19], v[152:155], v[232:235]
    ds_read_b128 v[172:175], v21 offset:18432
    v_mfma_f32_16x16x32_bf16 v[220:223], a[0:3], v[156:159], v[220:223]
    ds_read_b128 v[176:179], v21 offset:20480
    v_mfma_f32_16x16x32_bf16 v[236:239], a[16:19], v[156:159], v[236:239]
    ds_read_b128 v[180:183], v21 offset:22528
    v_mfma_f32_16x16x32_bf16 v[224:227], a[0:3], v[160:163], v[224:227]
    v_mfma_f32_16x16x32_bf16 v[240:243], a[16:19], v[160:163], v[240:243]
    v_mfma_f32_16x16x32_bf16 v[228:231], a[0:3], v[164:167], v[228:231]
    v_mfma_f32_16x16x32_bf16 v[244:247], a[16:19], v[164:167], v[244:247]
    s_waitcnt lgkmcnt(0)
    v_mfma_f32_16x16x32_bf16 v[216:219], a[4:7], v[168:171], v[216:219]
    ds_read_b128 v[152:155], v22 offset:16384
    v_mfma_f32_16x16x32_bf16 v[232:235], a[20:23], v[168:171], v[232:235]
    ds_read_b128 v[156:159], v22 offset:18432
    v_mfma_f32_16x16x32_bf16 v[220:223], a[4:7], v[172:175], v[220:223]
    ds_read_b128 v[160:163], v22 offset:20480
    v_mfma_f32_16x16x32_bf16 v[236:239], a[20:23], v[172:175], v[236:239]
    ds_read_b128 v[164:167], v22 offset:22528
    v_mfma_f32_16x16x32_bf16 v[224:227], a[4:7], v[176:179], v[224:227]
    v_mfma_f32_16x16x32_bf16 v[240:243], a[20:23], v[176:179], v[240:243]
    v_mfma_f32_16x16x32_bf16 v[228:231], a[4:7], v[180:183], v[228:231]
    v_mfma_f32_16x16x32_bf16 v[244:247], a[20:23], v[180:183], v[244:247]
    s_waitcnt lgkmcnt(0)
    v_mfma_f32_16x16x32_bf16 v[216:219], a[8:11], v[152:155], v[216:219]
    ds_read_b128 v[168:171], v23 offset:16384
    v_mfma_f32_16x16x32_bf16 v[232:235], a[24:27], v[152:155], v[232:235]
    ds_read_b128 v[172:175], v23 offset:18432
    v_mfma_f32_16x16x32_bf16 v[220:223], a[8:11], v[156:159], v[220:223]
    ds_read_b128 v[176:179], v23 offset:20480
    v_mfma_f32_16x16x32_bf16 v[236:239], a[24:27], v[156:159], v[236:239]
    ds_read_b128 v[180:183], v23 offset:22528
    v_mfma_f32_16x16x32_bf16 v[224:227], a[8:11], v[160:163], v[224:227]
    v_mfma_f32_16x16x32_bf16 v[240:243], a[24:27], v[160:163], v[240:243]
    v_mfma_f32_16x16x32_bf16 v[228:231], a[8:11], v[164:167], v[228:231]
    v_mfma_f32_16x16x32_bf16 v[244:247], a[24:27], v[164:167], v[244:247]
    s_waitcnt lgkmcnt(0) vmcnt(4)
    s_barrier
    v_mfma_f32_16x16x32_bf16 v[216:219], a[12:15], v[168:171], v[216:219]
    ds_read_b128 v[152:155], v20 offset:32768
    v_mov_b32 v28, s35
    v_mfma_f32_16x16x32_bf16 v[232:235], a[28:31], v[168:171], v[232:235]
    ds_read_b128 v[156:159], v20 offset:34816
    v_mfma_f32_16x16x32_bf16 v[220:223], a[12:15], v[172:175], v[220:223]
    ds_read_b128 v[160:163], v20 offset:36864
    buffer_store_dword v28, v30, s[24:27], s57 offen sc1
    v_mfma_f32_16x16x32_bf16 v[236:239], a[28:31], v[172:175], v[236:239]
    ds_read_b128 v[164:167], v20 offset:38912
    v_mfma_f32_16x16x32_bf16 v[224:227], a[12:15], v[176:179], v[224:227]
    v_mfma_f32_16x16x32_bf16 v[240:243], a[28:31], v[176:179], v[240:243]
    s_mov_b64 s[28:29], s[90:91]
    v_mfma_f32_16x16x32_bf16 v[228:231], a[12:15], v[180:183], v[228:231]
    v_mfma_f32_16x16x32_bf16 v[244:247], a[28:31], v[180:183], v[244:247]
    s_waitcnt lgkmcnt(0)
    v_mfma_f32_16x16x32_bf16 v[216:219], a[32:35], v[152:155], v[216:219]
    ds_read_b128 v[168:171], v21 offset:32768
    v_mfma_f32_16x16x32_bf16 v[232:235], a[48:51], v[152:155], v[232:235]
    ds_read_b128 v[172:175], v21 offset:34816
    v_mfma_f32_16x16x32_bf16 v[220:223], a[32:35], v[156:159], v[220:223]
    ds_read_b128 v[176:179], v21 offset:36864
    v_mfma_f32_16x16x32_bf16 v[236:239], a[48:51], v[156:159], v[236:239]
    ds_read_b128 v[180:183], v21 offset:38912
    v_mfma_f32_16x16x32_bf16 v[224:227], a[32:35], v[160:163], v[224:227]
    v_mfma_f32_16x16x32_bf16 v[240:243], a[48:51], v[160:163], v[240:243]
    v_mfma_f32_16x16x32_bf16 v[228:231], a[32:35], v[164:167], v[228:231]
    v_mfma_f32_16x16x32_bf16 v[244:247], a[48:51], v[164:167], v[244:247]
    s_waitcnt lgkmcnt(0) vmcnt(1)
    s_barrier
    v_mfma_f32_16x16x32_bf16 v[216:219], a[36:39], v[168:171], v[216:219]
    ds_read_b128 v[152:155], v22 offset:32768
    v_mov_b32_e64 v28, s35
    v_mfma_f32_16x16x32_bf16 v[232:235], a[52:55], v[168:171], v[232:235]
    ds_read_b128 v[156:159], v22 offset:34816
    v_mfma_f32_16x16x32_bf16 v[220:223], a[36:39], v[172:175], v[220:223]
    ds_read_b128 v[160:163], v22 offset:36864
    v_mfma_f32_16x16x32_bf16 v[236:239], a[52:55], v[172:175], v[236:239]
    ds_read_b128 v[164:167], v22 offset:38912
    v_mfma_f32_16x16x32_bf16 v[224:227], a[36:39], v[176:179], v[224:227]
    buffer_store_dword v28, v30, s[24:27], s58 offen sc1
    v_mfma_f32_16x16x32_bf16 v[240:243], a[52:55], v[176:179], v[240:243]
    v_mfma_f32_16x16x32_bf16 v[228:231], a[36:39], v[180:183], v[228:231]
    v_mfma_f32_16x16x32_bf16 v[244:247], a[52:55], v[180:183], v[244:247]
    s_waitcnt lgkmcnt(0)
    v_mfma_f32_16x16x32_bf16 v[216:219], a[40:43], v[152:155], v[216:219]
    ds_read_b128 v[168:171], v23 offset:32768
    s_bfe_u32 s72, s97, 262160
    v_mfma_f32_16x16x32_bf16 v[232:235], a[56:59], v[152:155], v[232:235]
    ds_read_b128 v[172:175], v23 offset:34816
    s_add_u32 m0, s37, 65536
    v_mfma_f32_16x16x32_bf16 v[220:223], a[40:43], v[156:159], v[220:223]
    ds_read_b128 v[176:179], v23 offset:36864
    v_mfma_f32_16x16x32_bf16 v[236:239], a[56:59], v[156:159], v[236:239]
    ds_read_b128 v[180:183], v23 offset:38912
    s_lshl_b32 s72, s72, 7
    v_mfma_f32_16x16x32_bf16 v[224:227], a[40:43], v[160:163], v[224:227]
    buffer_load_dwordx4 v16, s[16:19], s72 offen offset:0  lds
    v_mfma_f32_16x16x32_bf16 v[240:243], a[56:59], v[160:163], v[240:243]
    v_mfma_f32_16x16x32_bf16 v[228:231], a[40:43], v[164:167], v[228:231]
    buffer_load_dwordx4 v17, s[16:19], s72 offen offset:1024  lds
    v_mfma_f32_16x16x32_bf16 v[244:247], a[56:59], v[164:167], v[244:247]
    s_waitcnt lgkmcnt(0)
    v_mfma_f32_16x16x32_bf16 v[216:219], a[44:47], v[168:171], v[216:219]
    ds_read_b128 v[152:155], v20 offset:49152
    buffer_load_dwordx4 v18, s[16:19], s72 offen offset:2048  lds
    v_mfma_f32_16x16x32_bf16 v[232:235], a[60:63], v[168:171], v[232:235]
    ds_read_b128 v[156:159], v20 offset:51200
    v_mfma_f32_16x16x32_bf16 v[220:223], a[44:47], v[172:175], v[220:223]
    ds_read_b128 v[160:163], v20 offset:53248
    v_mfma_f32_16x16x32_bf16 v[236:239], a[60:63], v[172:175], v[236:239]
    ds_read_b128 v[164:167], v20 offset:55296
    v_mfma_f32_16x16x32_bf16 v[224:227], a[44:47], v[176:179], v[224:227]
    buffer_load_dwordx4 v19, s[16:19], s72 offen offset:3072  lds
    v_mfma_f32_16x16x32_bf16 v[240:243], a[60:63], v[176:179], v[240:243]
    v_mfma_f32_16x16x32_bf16 v[228:231], a[44:47], v[180:183], v[228:231]
    v_xor_b32 v20, 0x10000, v20
    v_mfma_f32_16x16x32_bf16 v[244:247], a[60:63], v[180:183], v[244:247]
    s_waitcnt lgkmcnt(0)
    v_mfma_f32_16x16x32_bf16 v[216:219], a[64:67], v[152:155], v[216:219]
    ds_read_b128 v[168:171], v21 offset:49152
    s_bfe_u32 s72, s97, 262164
    v_mfma_f32_16x16x32_bf16 v[232:235], a[80:83], v[152:155], v[232:235]
    ds_read_b128 v[172:175], v21 offset:51200
    s_add_u32 m0, s37, 81920
    v_mfma_f32_16x16x32_bf16 v[220:223], a[64:67], v[156:159], v[220:223]
    ds_read_b128 v[176:179], v21 offset:53248
    s_lshl_b32 s72, s72, 7
    v_mfma_f32_16x16x32_bf16 v[236:239], a[80:83], v[156:159], v[236:239]
    ds_read_b128 v[180:183], v21 offset:55296
    buffer_load_dwordx4 v16, s[16:19], s72 offen offset:0  lds
    v_mfma_f32_16x16x32_bf16 v[224:227], a[64:67], v[160:163], v[224:227]
    buffer_load_dwordx4 v17, s[16:19], s72 offen offset:1024  lds
    v_mfma_f32_16x16x32_bf16 v[240:243], a[80:83], v[160:163], v[240:243]
    buffer_load_dwordx2 v[128:129], v7, s[24:27], s55 offen offset:0 sc1
    v_mfma_f32_16x16x32_bf16 v[228:231], a[64:67], v[164:167], v[228:231]
    buffer_load_dwordx2 v[130:131], v7, s[24:27], s55 offen offset:64 sc1
    v_xor_b32 v21, 0x10000, v21
    v_mfma_f32_16x16x32_bf16 v[244:247], a[80:83], v[164:167], v[244:247]
    s_waitcnt lgkmcnt(0)
    v_mfma_f32_16x16x32_bf16 v[216:219], a[68:71], v[168:171], v[216:219]
    ds_read_b128 v[152:155], v22 offset:49152
    buffer_load_dwordx4 v18, s[16:19], s72 offen offset:2048  lds
    v_mfma_f32_16x16x32_bf16 v[232:235], a[84:87], v[168:171], v[232:235]
    ds_read_b128 v[156:159], v22 offset:51200
    v_mfma_f32_16x16x32_bf16 v[220:223], a[68:71], v[172:175], v[220:223]
    ds_read_b128 v[160:163], v22 offset:53248
    buffer_load_dwordx4 v19, s[16:19], s72 offen offset:3072  lds
    v_mfma_f32_16x16x32_bf16 v[236:239], a[84:87], v[172:175], v[236:239]
    ds_read_b128 v[164:167], v22 offset:55296
    v_mfma_f32_16x16x32_bf16 v[224:227], a[68:71], v[176:179], v[224:227]
    buffer_load_dwordx2 v[132:133], v7, s[24:27], s55 offen offset:128 sc1
    v_mfma_f32_16x16x32_bf16 v[240:243], a[84:87], v[176:179], v[240:243]
    v_mfma_f32_16x16x32_bf16 v[228:231], a[68:71], v[180:183], v[228:231]
    buffer_load_dwordx2 v[134:135], v7, s[24:27], s55 offen offset:192 sc1
    v_xor_b32 v22, 0x10000, v22
    v_mfma_f32_16x16x32_bf16 v[244:247], a[84:87], v[180:183], v[244:247]
    s_waitcnt lgkmcnt(0)
    v_mfma_f32_16x16x32_bf16 v[216:219], a[72:75], v[152:155], v[216:219]
    ds_read_b128 v[168:171], v23 offset:49152
    s_bfe_u32 s72, s97, 262168
    v_mfma_f32_16x16x32_bf16 v[232:235], a[88:91], v[152:155], v[232:235]
    ds_read_b128 v[172:175], v23 offset:51200
    s_add_u32 m0, s37, 98304
    v_mfma_f32_16x16x32_bf16 v[220:223], a[72:75], v[156:159], v[220:223]
    ds_read_b128 v[176:179], v23 offset:53248
    s_lshl_b32 s72, s72, 7
    v_mfma_f32_16x16x32_bf16 v[236:239], a[88:91], v[156:159], v[236:239]
    ds_read_b128 v[180:183], v23 offset:55296
    v_mfma_f32_16x16x32_bf16 v[224:227], a[72:75], v[160:163], v[224:227]
    buffer_load_dwordx4 v16, s[16:19], s72 offen offset:0  lds
    v_mfma_f32_16x16x32_bf16 v[240:243], a[88:91], v[160:163], v[240:243]
    buffer_load_dwordx4 v17, s[16:19], s72 offen offset:1024  lds
    v_mfma_f32_16x16x32_bf16 v[228:231], a[72:75], v[164:167], v[228:231]
    buffer_load_dword v10, v5, s[24:27], s70 offen sc1
    v_xor_b32 v23, 0x10000, v23
    v_mfma_f32_16x16x32_bf16 v[244:247], a[88:91], v[164:167], v[244:247]
    s_waitcnt lgkmcnt(0) vmcnt(11)
    s_barrier
    v_mfma_f32_16x16x32_bf16 v[216:219], a[76:79], v[168:171], v[216:219]
    ds_read_b128 v[152:155], v20 offset:0
    buffer_load_dwordx4 v18, s[16:19], s72 offen offset:2048  lds
    v_mfma_f32_16x16x32_bf16 v[232:235], a[92:95], v[168:171], v[232:235]
    ds_read_b128 v[156:159], v20 offset:2048
    v_mfma_f32_16x16x32_bf16 v[220:223], a[76:79], v[172:175], v[220:223]
    ds_read_b128 v[160:163], v20 offset:4096
    v_mfma_f32_16x16x32_bf16 v[236:239], a[92:95], v[172:175], v[236:239]
    ds_read_b128 v[164:167], v20 offset:6144
    v_mfma_f32_16x16x32_bf16 v[224:227], a[76:79], v[176:179], v[224:227]
    buffer_load_dwordx4 v19, s[16:19], s72 offen offset:3072  lds
    v_mfma_f32_16x16x32_bf16 v[240:243], a[92:95], v[176:179], v[240:243]
    v_mfma_f32_16x16x32_bf16 v[228:231], a[76:79], v[180:183], v[228:231]
    v_mfma_f32_16x16x32_bf16 v[244:247], a[92:95], v[180:183], v[244:247]
    s_waitcnt lgkmcnt(0)
    v_mfma_f32_16x16x32_bf16 v[216:219], a[96:99], v[152:155], v[216:219]
    ds_read_b128 v[168:171], v21 offset:0
    s_bfe_u32 s72, s97, 262172
    v_mfma_f32_16x16x32_bf16 v[232:235], a[112:115], v[152:155], v[232:235]
    ds_read_b128 v[172:175], v21 offset:2048
    s_add_u32 m0, s37, 114688
    v_mfma_f32_16x16x32_bf16 v[220:223], a[96:99], v[156:159], v[220:223]
    ds_read_b128 v[176:179], v21 offset:4096
    v_mfma_f32_16x16x32_bf16 v[236:239], a[112:115], v[156:159], v[236:239]
    ds_read_b128 v[180:183], v21 offset:6144
    s_lshl_b32 s72, s72, 7
    v_mfma_f32_16x16x32_bf16 v[224:227], a[96:99], v[160:163], v[224:227]
    buffer_load_dwordx4 v16, s[16:19], s72 offen offset:0  lds
    v_mfma_f32_16x16x32_bf16 v[240:243], a[112:115], v[160:163], v[240:243]
    v_mfma_f32_16x16x32_bf16 v[228:231], a[96:99], v[164:167], v[228:231]
    buffer_load_dwordx4 v17, s[16:19], s72 offen offset:1024  lds
    v_mfma_f32_16x16x32_bf16 v[244:247], a[112:115], v[164:167], v[244:247]
    s_waitcnt lgkmcnt(0)
    v_mfma_f32_16x16x32_bf16 v[216:219], a[100:103], v[168:171], v[216:219]
    ds_read_b128 v[152:155], v22 offset:0
    buffer_load_dwordx4 v18, s[16:19], s72 offen offset:2048  lds
    v_mfma_f32_16x16x32_bf16 v[232:235], a[116:119], v[168:171], v[232:235]
    ds_read_b128 v[156:159], v22 offset:2048
    v_mfma_f32_16x16x32_bf16 v[220:223], a[100:103], v[172:175], v[220:223]
    ds_read_b128 v[160:163], v22 offset:4096
    v_mfma_f32_16x16x32_bf16 v[236:239], a[116:119], v[172:175], v[236:239]
    ds_read_b128 v[164:167], v22 offset:6144
    v_mfma_f32_16x16x32_bf16 v[224:227], a[100:103], v[176:179], v[224:227]
    buffer_load_dwordx4 v19, s[16:19], s72 offen offset:3072  lds
    v_mfma_f32_16x16x32_bf16 v[240:243], a[116:119], v[176:179], v[240:243]
    v_mfma_f32_16x16x32_bf16 v[228:231], a[100:103], v[180:183], v[228:231]
    v_mfma_f32_16x16x32_bf16 v[244:247], a[116:119], v[180:183], v[244:247]
    s_waitcnt lgkmcnt(0)
    v_mfma_f32_16x16x32_bf16 v[216:219], a[104:107], v[152:155], v[216:219]
    ds_read_b128 v[168:171], v23 offset:0
    v_mfma_f32_16x16x32_bf16 v[232:235], a[120:123], v[152:155], v[232:235]
    ds_read_b128 v[172:175], v23 offset:2048
    v_mfma_f32_16x16x32_bf16 v[220:223], a[104:107], v[156:159], v[220:223]
    ds_read_b128 v[176:179], v23 offset:4096
    v_mfma_f32_16x16x32_bf16 v[236:239], a[120:123], v[156:159], v[236:239]
    ds_read_b128 v[180:183], v23 offset:6144
    v_mfma_f32_16x16x32_bf16 v[224:227], a[104:107], v[160:163], v[224:227]
    v_mfma_f32_16x16x32_bf16 v[240:243], a[120:123], v[160:163], v[240:243]
    v_mfma_f32_16x16x32_bf16 v[228:231], a[104:107], v[164:167], v[228:231]
    v_mfma_f32_16x16x32_bf16 v[244:247], a[120:123], v[164:167], v[244:247]
    s_waitcnt lgkmcnt(0) vmcnt(6)
    v_cmp_ne_u32 vcc, s98, v10
    s_nop 0
    s_cbranch_vccnz K_POLL5
K_POLL5_OK:
    s_barrier
    v_mfma_f32_16x16x32_bf16 v[216:219], a[108:111], v[168:171], v[216:219]
    ds_read_b128 v[152:155], v20 offset:16384
    buffer_load_dword v6, v9, s[24:27], s70 offen sc1
    v_mfma_f32_16x16x32_bf16 v[232:235], a[124:127], v[168:171], v[232:235]
    ds_read_b128 v[156:159], v20 offset:18432
    v_mfma_f32_16x16x32_bf16 v[220:223], a[108:111], v[172:175], v[220:223]
    ds_read_b128 v[160:163], v20 offset:20480
    buffer_load_dwordx4 v[96:99], v3, s[24:27], s53 offen offset:0 sc1
    v_mfma_f32_16x16x32_bf16 v[236:239], a[124:127], v[172:175], v[236:239]
    ds_read_b128 v[164:167], v20 offset:22528
    v_mfma_f32_16x16x32_bf16 v[224:227], a[108:111], v[176:179], v[224:227]
    v_mfma_f32_16x16x32_bf16 v[240:243], a[124:127], v[176:179], v[240:243]
    buffer_load_dwordx4 v[100:103], v3, s[24:27], s53 offen offset:1024 sc1
    v_mfma_f32_16x16x32_bf16 v[228:231], a[108:111], v[180:183], v[228:231]
    v_mfma_f32_16x16x32_bf16 v[244:247], a[124:127], v[180:183], v[244:247]
    s_waitcnt lgkmcnt(0)
    v_mfma_f32_16x16x32_bf16 v[216:219], a[128:131], v[152:155], v[216:219]
    ds_read_b128 v[168:171], v21 offset:16384
    buffer_load_dwordx4 v[104:107], v3, s[24:27], s53 offen offset:2048 sc1
    v_mfma_f32_16x16x32_bf16 v[232:235], a[144:147], v[152:155], v[232:235]
    ds_read_b128 v[172:175], v21 offset:18432
    v_mfma_f32_16x16x32_bf16 v[220:223], a[128:131], v[156:159], v[220:223]
    ds_read_b128 v[176:179], v21 offset:20480
    v_mfma_f32_16x16x32_bf16 v[236:239], a[144:147], v[156:159], v[236:239]
    ds_read_b128 v[180:183], v21 offset:22528
    v_mfma_f32_16x16x32_bf16 v[224:227], a[128:131], v[160:163], v[224:227]
    buffer_load_dwordx4 v[108:111], v3, s[24:27], s53 offen offset:3072 sc1
    v_mfma_f32_16x16x32_bf16 v[240:243], a[144:147], v[160:163], v[240:243]
    v_mfma_f32_16x16x32_bf16 v[228:231], a[128:131], v[164:167], v[228:231]
    v_mfma_f32_16x16x32_bf16 v[244:247], a[144:147], v[164:167], v[244:247]
    s_waitcnt lgkmcnt(0)
    v_mfma_f32_16x16x32_bf16 v[216:219], a[132:135], v[168:171], v[216:219]
    ds_read_b128 v[152:155], v22 offset:16384
    v_mfma_f32_16x16x32_bf16 v[232:235], a[148:151], v[168:171], v[232:235]
    ds_read_b128 v[156:159], v22 offset:18432
    v_mfma_f32_16x16x32_bf16 v[220:223], a[132:135], v[172:175], v[220:223]
    ds_read_b128 v[160:163], v22 offset:20480
    v_mfma_f32_16x16x32_bf16 v[236:239], a[148:151], v[172:175], v[236:239]
    ds_read_b128 v[164:167], v22 offset:22528
    v_mfma_f32_16x16x32_bf16 v[224:227], a[132:135], v[176:179], v[224:227]
    v_mfma_f32_16x16x32_bf16 v[240:243], a[148:151], v[176:179], v[240:243]
    v_mfma_f32_16x16x32_bf16 v[228:231], a[132:135], v[180:183], v[228:231]
    v_mfma_f32_16x16x32_bf16 v[244:247], a[148:151], v[180:183], v[244:247]
    s_waitcnt lgkmcnt(0) vmcnt(4)
    v_cmp_ne_u32 vcc, s98, v6
    s_nop 0
    s_cbranch_vccnz K_POLL6
K_POLL6_OK:
    s_barrier
    v_mfma_f32_16x16x32_bf16 v[216:219], a[136:139], v[152:155], v[216:219]
    ds_read_b128 v[168:171], v23 offset:16384
    buffer_load_dwordx4 v[112:115], v3, s[24:27], s54 offen offset:0 sc1
    v_mfma_f32_16x16x32_bf16 v[232:235], a[152:155], v[152:155], v[232:235]
    ds_read_b128 v[172:175], v23 offset:18432
    v_mfma_f32_16x16x32_bf16 v[220:223], a[136:139], v[156:159], v[220:223]
    ds_read_b128 v[176:179], v23 offset:20480
    v_mfma_f32_16x16x32_bf16 v[236:239], a[152:155], v[156:159], v[236:239]
    ds_read_b128 v[180:183], v23 offset:22528
    v_mfma_f32_16x16x32_bf16 v[224:227], a[136:139], v[160:163], v[224:227]
    buffer_load_dwordx4 v[116:119], v3, s[24:27], s54 offen offset:1024 sc1
    v_mfma_f32_16x16x32_bf16 v[240:243], a[152:155], v[160:163], v[240:243]
    v_mfma_f32_16x16x32_bf16 v[228:231], a[136:139], v[164:167], v[228:231]
    v_mfma_f32_16x16x32_bf16 v[244:247], a[152:155], v[164:167], v[244:247]
    s_waitcnt lgkmcnt(0)
    s_barrier
    v_mfma_f32_16x16x32_bf16 v[216:219], a[140:143], v[168:171], v[216:219]
    ds_read_b128 v[152:155], v20 offset:32768
    buffer_load_dwordx4 v[120:123], v3, s[24:27], s54 offen offset:2048 sc1
    v_mfma_f32_16x16x32_bf16 v[232:235], a[156:159], v[168:171], v[232:235]
    ds_read_b128 v[156:159], v20 offset:34816
    v_mfma_f32_16x16x32_bf16 v[220:223], a[140:143], v[172:175], v[220:223]
    ds_read_b128 v[160:163], v20 offset:36864
    v_mfma_f32_16x16x32_bf16 v[236:239], a[156:159], v[172:175], v[236:239]
    ds_read_b128 v[164:167], v20 offset:38912
    v_mfma_f32_16x16x32_bf16 v[224:227], a[140:143], v[176:179], v[224:227]
    buffer_load_dwordx4 v[124:127], v3, s[24:27], s54 offen offset:3072 sc1
    v_mfma_f32_16x16x32_bf16 v[240:243], a[156:159], v[176:179], v[240:243]
    v_mfma_f32_16x16x32_bf16 v[228:231], a[140:143], v[180:183], v[228:231]
    v_mfma_f32_16x16x32_bf16 v[244:247], a[156:159], v[180:183], v[244:247]
    s_waitcnt lgkmcnt(0)
    v_mfma_f32_16x16x32_bf16 v[216:219], a[160:163], v[152:155], v[216:219]
    ds_read_b128 v[168:171], v21 offset:32768
    v_mfma_f32_16x16x32_bf16 v[232:235], a[176:179], v[152:155], v[232:235]
    ds_read_b128 v[172:175], v21 offset:34816
    v_mfma_f32_16x16x32_bf16 v[220:223], a[160:163], v[156:159], v[220:223]
    ds_read_b128 v[176:179], v21 offset:36864
    v_mfma_f32_16x16x32_bf16 v[236:239], a[176:179], v[156:159], v[236:239]
    ds_read_b128 v[180:183], v21 offset:38912
    v_mfma_f32_16x16x32_bf16 v[224:227], a[160:163], v[160:163], v[224:227]
    v_mfma_f32_16x16x32_bf16 v[240:243], a[176:179], v[160:163], v[240:243]
    v_mfma_f32_16x16x32_bf16 v[228:231], a[160:163], v[164:167], v[228:231]
    v_mfma_f32_16x16x32_bf16 v[244:247], a[176:179], v[164:167], v[244:247]
    s_waitcnt lgkmcnt(0)
    v_mfma_f32_16x16x32_bf16 v[216:219], a[164:167], v[168:171], v[216:219]
    ds_read_b128 v[152:155], v22 offset:32768
    v_mfma_f32_16x16x32_bf16 v[232:235], a[180:183], v[168:171], v[232:235]
    ds_read_b128 v[156:159], v22 offset:34816
    v_mfma_f32_16x16x32_bf16 v[220:223], a[164:167], v[172:175], v[220:223]
    ds_read_b128 v[160:163], v22 offset:36864
    v_mfma_f32_16x16x32_bf16 v[236:239], a[180:183], v[172:175], v[236:239]
    ds_read_b128 v[164:167], v22 offset:38912
    v_mfma_f32_16x16x32_bf16 v[224:227], a[164:167], v[176:179], v[224:227]
    v_mfma_f32_16x16x32_bf16 v[240:243], a[180:183], v[176:179], v[240:243]
    v_mfma_f32_16x16x32_bf16 v[228:231], a[164:167], v[180:183], v[228:231]
    v_mfma_f32_16x16x32_bf16 v[244:247], a[180:183], v[180:183], v[244:247]
    s_waitcnt lgkmcnt(0)
    v_mfma_f32_16x16x32_bf16 v[216:219], a[168:171], v[152:155], v[216:219]
    ds_read_b128 v[168:171], v23 offset:32768
    v_mfma_f32_16x16x32_bf16 v[232:235], a[184:187], v[152:155], v[232:235]
    ds_read_b128 v[172:175], v23 offset:34816
    v_mfma_f32_16x16x32_bf16 v[220:223], a[168:171], v[156:159], v[220:223]
    ds_read_b128 v[176:179], v23 offset:36864
    v_mfma_f32_16x16x32_bf16 v[236:239], a[184:187], v[156:159], v[236:239]
    ds_read_b128 v[180:183], v23 offset:38912
    v_mfma_f32_16x16x32_bf16 v[224:227], a[168:171], v[160:163], v[224:227]
    v_mfma_f32_16x16x32_bf16 v[240:243], a[184:187], v[160:163], v[240:243]
    v_mfma_f32_16x16x32_bf16 v[228:231], a[168:171], v[164:167], v[228:231]
    v_mfma_f32_16x16x32_bf16 v[244:247], a[184:187], v[164:167], v[244:247]
    s_waitcnt lgkmcnt(0)
    v_mfma_f32_16x16x32_bf16 v[216:219], a[172:175], v[168:171], v[216:219]
    ds_read_b128 v[152:155], v20 offset:49152
    v_mfma_f32_16x16x32_bf16 v[232:235], a[188:191], v[168:171], v[232:235]
    ds_read_b128 v[156:159], v20 offset:51200
    v_mfma_f32_16x16x32_bf16 v[220:223], a[172:175], v[172:175], v[220:223]
    ds_read_b128 v[160:163], v20 offset:53248
    v_mfma_f32_16x16x32_bf16 v[236:239], a[188:191], v[172:175], v[236:239]
    ds_read_b128 v[164:167], v20 offset:55296
    v_mfma_f32_16x16x32_bf16 v[224:227], a[172:175], v[176:179], v[224:227]
    v_mfma_f32_16x16x32_bf16 v[240:243], a[188:191], v[176:179], v[240:243]
    v_mfma_f32_16x16x32_bf16 v[228:231], a[172:175], v[180:183], v[228:231]
    v_mfma_f32_16x16x32_bf16 v[244:247], a[188:191], v[180:183], v[244:247]
    s_waitcnt lgkmcnt(0)
    v_mfma_f32_16x16x32_bf16 v[216:219], a[192:195], v[152:155], v[216:219]
    ds_read_b128 v[168:171], v21 offset:49152
    s_waitcnt vmcnt(7)
    v_lshlrev_b32_e64 v184, 16, v96
    v_mfma_f32_16x16x32_bf16 v[232:235], a[208:211], v[152:155], v[232:235]
    ds_read_b128 v[172:175], v21 offset:51200
    v_and_b32 v185, 0xffff0000, v96
    v_mfma_f32_16x16x32_bf16 v[220:223], a[192:195], v[156:159], v[220:223]
    ds_read_b128 v[176:179], v21 offset:53248
    v_lshlrev_b32_e64 v186, 16, v97
    v_mfma_f32_16x16x32_bf16 v[236:239], a[208:211], v[156:159], v[236:239]
    ds_read_b128 v[180:183], v21 offset:55296
    v_and_b32 v187, 0xffff0000, v97
    v_mfma_f32_16x16x32_bf16 v[224:227], a[192:195], v[160:163], v[224:227]
    v_lshlrev_b32_e64 v188, 16, v98
    v_mfma_f32_16x16x32_bf16 v[240:243], a[208:211], v[160:163], v[240:243]
    v_and_b32 v189, 0xffff0000, v98
    v_mfma_f32_16x16x32_bf16 v[228:231], a[192:195], v[164:167], v[228:231]
    v_lshlrev_b32_e64 v190, 16, v99
    v_mfma_f32_16x16x32_bf16 v[244:247], a[208:211], v[164:167], v[244:247]
    v_and_b32 v191, 0xffff0000, v99
    s_waitcnt lgkmcnt(0)
    v_mfma_f32_16x16x32_bf16 v[216:219], a[196:199], v[168:171], v[216:219]
    ds_read_b128 v[152:155], v22 offset:49152
    s_waitcnt vmcnt(6)
    v_lshlrev_b32_e64 v192, 16, v100
    v_mfma_f32_16x16x32_bf16 v[232:235], a[212:215], v[168:171], v[232:235]
    ds_read_b128 v[156:159], v22 offset:51200
    v_and_b32 v193, 0xffff0000, v100
    v_mfma_f32_16x16x32_bf16 v[220:223], a[196:199], v[172:175], v[220:223]
    ds_read_b128 v[160:163], v22 offset:53248
    v_lshlrev_b32_e64 v194, 16, v101
    v_mfma_f32_16x16x32_bf16 v[236:239], a[212:215], v[172:175], v[236:239]
    ds_read_b128 v[164:167], v22 offset:55296
    v_and_b32 v195, 0xffff0000, v101
    v_mfma_f32_16x16x32_bf16 v[224:227], a[196:199], v[176:179], v[224:227]
    v_lshlrev_b32_e64 v196, 16, v102
    v_mfma_f32_16x16x32_bf16 v[240:243], a[212:215], v[176:179], v[240:243]
    v_and_b32 v197, 0xffff0000, v102
    v_mfma_f32_16x16x32_bf16 v[228:231], a[196:199], v[180:183], v[228:231]
    v_lshlrev_b32_e64 v198, 16, v103
    v_mfma_f32_16x16x32_bf16 v[244:247], a[212:215], v[180:183], v[244:247]
    v_and_b32 v199, 0xffff0000, v103
    s_waitcnt lgkmcnt(0)
    v_mfma_f32_16x16x32_bf16 v[216:219], a[200:203], v[152:155], v[216:219]
    ds_read_b128 v[168:171], v23 offset:49152
    s_waitcnt vmcnt(5)
    v_lshlrev_b32_e64 v200, 16, v104
    v_mfma_f32_16x16x32_bf16 v[232:235], a[216:219], v[152:155], v[232:235]
    ds_read_b128 v[172:175], v23 offset:51200
    v_and_b32 v201, 0xffff0000, v104
    v_mfma_f32_16x16x32_bf16 v[220:223], a[200:203], v[156:159], v[220:223]
    ds_read_b128 v[176:179], v23 offset:53248
    v_lshlrev_b32_e64 v202, 16, v105
    v_mfma_f32_16x16x32_bf16 v[236:239], a[216:219], v[156:159], v[236:239]
    ds_read_b128 v[180:183], v23 offset:55296
    v_and_b32 v203, 0xffff0000, v105
    v_mfma_f32_16x16x32_bf16 v[224:227], a[200:203], v[160:163], v[224:227]
    v_lshlrev_b32_e64 v204, 16, v106
    v_mfma_f32_16x16x32_bf16 v[240:243], a[216:219], v[160:163], v[240:243]
    v_and_b32 v205, 0xffff0000, v106
    v_mfma_f32_16x16x32_bf16 v[228:231], a[200:203], v[164:167], v[228:231]
    v_lshlrev_b32_e64 v206, 16, v107
    v_mfma_f32_16x16x32_bf16 v[244:247], a[216:219], v[164:167], v[244:247]
    v_and_b32 v207, 0xffff0000, v107
    s_waitcnt lgkmcnt(0)
    v_mfma_f32_16x16x32_bf16 v[216:219], a[204:207], v[168:171], v[216:219]
    s_waitcnt vmcnt(4)
    v_lshlrev_b32_e64 v208, 16, v108
    v_mfma_f32_16x16x32_bf16 v[232:235], a[220:223], v[168:171], v[232:235]
    v_and_b32 v209, 0xffff0000, v108
    v_mfma_f32_16x16x32_bf16 v[220:223], a[204:207], v[172:175], v[220:223]
    v_lshlrev_b32_e64 v210, 16, v109
    v_mfma_f32_16x16x32_bf16 v[236:239], a[220:223], v[172:175], v[236:239]
    v_and_b32 v211, 0xffff0000, v109
    v_mfma_f32_16x16x32_bf16 v[224:227], a[204:207], v[176:179], v[224:227]
    v_lshlrev_b32_e64 v212, 16, v110
    v_mfma_f32_16x16x32_bf16 v[240:243], a[220:223], v[176:179], v[240:243]
    v_and_b32 v213, 0xffff0000, v110
    v_mfma_f32_16x16x32_bf16 v[228:231], a[204:207], v[180:183], v[228:231]
    v_lshlrev_b32_e64 v214, 16, v111
    v_mfma_f32_16x16x32_bf16 v[244:247], a[220:223], v[180:183], v[244:247]
    v_and_b32 v215, 0xffff0000, v111
    s_waitcnt vmcnt(3)
    v_lshlrev_b32 v32, 16, v112
    v_and_b32 v33, 0xffff0000, v112
    v_lshlrev_b32_e64 v34, 16, v113
    v_and_b32 v35, 0xffff0000, v113
    v_lshlrev_b32_e64 v36, 16, v114
    v_and_b32 v37, 0xffff0000, v114
    v_lshlrev_b32_e64 v38, 16, v115
    v_and_b32 v39, 0xffff0000, v115
    v_add_f32 v32, v32, v216
    v_add_f32 v33, v33, v220
    v_add_f32 v34, v34, v224
    v_add_f32 v35, v35, v228
    v_pk_fma_f32 v[184:185], v[32:33], v[128:129], v[184:185] op_sel_hi:[1,0,1]
    v_pk_fma_f32 v[186:187], v[34:35], v[128:129], v[186:187] op_sel_hi:[1,0,1]
    s_add_u32 s39, s56, 0
    buffer_store_dwordx4 v[184:187], v12, s[28:31], s39 offen nt
    v_add_f32 v36, v36, v232
    v_add_f32 v37, v37, v236
    v_add_f32 v38, v38, v240
    v_add_f32_e64 v39, v39, v244
    v_pk_fma_f32 v[188:189], v[36:37], v[128:129], v[188:189] op_sel:[0,1,0]
    v_pk_fma_f32 v[190:191], v[38:39], v[128:129], v[190:191] op_sel:[0,1,0]
    s_add_u32 s39, s56, 131072
    buffer_store_dwordx4 v[188:191], v12, s[28:31], s39 offen nt
    s_waitcnt vmcnt(4)
    v_lshlrev_b32 v40, 16, v116
    v_and_b32 v41, 0xffff0000, v116
    v_lshlrev_b32_e64 v42, 16, v117
    v_and_b32 v43, 0xffff0000, v117
    v_lshlrev_b32_e64 v44, 16, v118
    v_and_b32 v45, 0xffff0000, v118
    v_lshlrev_b32_e64 v46, 16, v119
    v_and_b32 v47, 0xffff0000, v119
    v_add_f32 v40, v40, v217
    v_add_f32 v41, v41, v221
    v_add_f32 v42, v42, v225
    v_add_f32 v43, v43, v229
    v_pk_fma_f32 v[192:193], v[40:41], v[130:131], v[192:193] op_sel_hi:[1,0,1]
    v_pk_fma_f32 v[194:195], v[42:43], v[130:131], v[194:195] op_sel_hi:[1,0,1]
    s_add_u32 s39, s56, 4096
    buffer_store_dwordx4 v[192:195], v12, s[28:31], s39 offen nt
    v_add_f32 v44, v44, v233
    v_add_f32 v45, v45, v237
    v_add_f32 v46, v46, v241
    v_add_f32 v47, v47, v245
    v_pk_fma_f32 v[196:197], v[44:45], v[130:131], v[196:197] op_sel:[0,1,0]
    v_pk_fma_f32 v[198:199], v[46:47], v[130:131], v[198:199] op_sel:[0,1,0]
    s_add_u32 s39, s56, 135168
    buffer_store_dwordx4 v[196:199], v12, s[28:31], s39 offen nt
    s_waitcnt vmcnt(5)
    v_lshlrev_b32 v48, 16, v120
    v_and_b32 v49, 0xffff0000, v120
    v_lshlrev_b32_e64 v50, 16, v121
    v_and_b32 v51, 0xffff0000, v121
    v_lshlrev_b32_e64 v52, 16, v122
    v_and_b32 v53, 0xffff0000, v122
    v_lshlrev_b32_e64 v54, 16, v123
    v_and_b32 v55, 0xffff0000, v123
    v_add_f32 v48, v48, v218
    v_add_f32 v49, v49, v222
    v_add_f32 v50, v50, v226
    v_add_f32 v51, v51, v230
    v_pk_fma_f32 v[200:201], v[48:49], v[132:133], v[200:201] op_sel_hi:[1,0,1]
    v_pk_fma_f32 v[202:203], v[50:51], v[132:133], v[202:203] op_sel_hi:[1,0,1]
    s_add_u32 s39, s56, 8192
    buffer_store_dwordx4 v[200:203], v12, s[28:31], s39 offen nt
    v_add_f32 v52, v52, v234
    v_add_f32 v53, v53, v238
    v_add_f32 v54, v54, v242
    v_add_f32 v55, v55, v246
    v_pk_fma_f32 v[204:205], v[52:53], v[132:133], v[204:205] op_sel:[0,1,0]
    v_pk_fma_f32 v[206:207], v[54:55], v[132:133], v[206:207] op_sel:[0,1,0]
    s_add_u32 s39, s56, 139264
    buffer_store_dwordx4 v[204:207], v12, s[28:31], s39 offen nt
    s_waitcnt vmcnt(6)
    v_lshlrev_b32 v56, 16, v124
    v_and_b32 v57, 0xffff0000, v124
    v_lshlrev_b32_e64 v58, 16, v125
    v_and_b32 v59, 0xffff0000, v125
    v_lshlrev_b32_e64 v60, 16, v126
    v_and_b32 v61, 0xffff0000, v126
    v_lshlrev_b32_e64 v62, 16, v127
    v_and_b32 v63, 0xffff0000, v127
    v_add_f32 v56, v56, v219
    v_add_f32 v57, v57, v223
    v_add_f32 v58, v58, v227
    v_add_f32 v59, v59, v231
    v_pk_fma_f32 v[208:209], v[56:57], v[134:135], v[208:209] op_sel_hi:[1,0,1]
    v_pk_fma_f32 v[210:211], v[58:59], v[134:135], v[210:211] op_sel_hi:[1,0,1]
    s_add_u32 s39, s56, 12288
    buffer_store_dwordx4 v[208:211], v12, s[28:31], s39 offen nt
    v_add_f32 v60, v60, v235
    v_add_f32 v61, v61, v239
    v_add_f32 v62, v62, v243
    v_add_f32 v63, v63, v247
    v_pk_fma_f32 v[212:213], v[60:61], v[134:135], v[212:213] op_sel:[0,1,0]
    v_pk_fma_f32 v[214:215], v[62:63], v[134:135], v[214:215] op_sel:[0,1,0]
    s_add_u32 s39, s56, 143360
    buffer_store_dwordx4 v[212:215], v12, s[28:31], s39 offen nt
K_END:
    s_endpgm
K_W256:
    buffer_load_dwordx4 a[120:123], v3, s[24:27], s37 offen offset:0 sc1
    buffer_load_dwordx4 a[124:127], v3, s[24:27], s37 offen offset:1024 sc1
    buffer_load_dwordx4 a[128:131], v3, s[24:27], s37 offen offset:2048 sc1
    buffer_load_dwordx4 a[132:135], v3, s[24:27], s37 offen offset:3072 sc1
    s_add_u32 s69, s62, 1
    v_mov_b32_e64 v28, s69
    s_mov_b32 s69, 22446080
    buffer_store_dword v28, v30, s[24:27], s69 offen sc1
    s_branch K_W256_RET
K_POLL1:
    s_mov_b32 s71, 0
K_POLL1_L:
    s_sleep 1
    buffer_load_dword v216, v217, s[24:27], s68 offen sc1
    s_add_u32 s71, s71, 1
    s_waitcnt vmcnt(0)
    v_cmp_ne_u32 vcc, s35, v216
    s_nop 0
    s_cbranch_vccz K_POLL1_OK
    s_cmp_lt_u32 s71, 200000
    s_cbranch_scc1 K_POLL1_L
    s_branch K_POLL1_OK
K_SPECIAL:
    v_add_u32 v14, s63, v1
    v_sub_u32 v13, 64, v14
    v_cmp_eq_u32 s[44:45], 0, v14
    v_and_b32_e64 v13, 63, v13
    v_mul_u32_u24 v14, 144, v14
    v_mul_u32_u24 v13, 144, v13
    v_add_u32 v14, 81920, v14
    v_lshl_add_u32 v12, v2, 4, v14
    v_lshl_add_u32 v14, v2, 2, v14
    v_sub_u32_e64 v15, 3, v2
    v_add_u32 v14, 128, v14
    v_lshl_add_u32 v13, v15, 4, v13
    v_add_u32 v13, 81920, v13
    v_accvgpr_read_b32 v8, a120
    v_accvgpr_read_b32 v9, a122
    v_lshlrev_b32 v4, 16, v8
    v_lshlrev_b32 v5, 16, v9
    v_and_b32 v6, 0xffff0000, v8
    v_and_b32 v7, 0xffff0000, v9
    v_pk_mul_f32 v[184:185], v[240:241], v[4:5]
    v_pk_mul_f32 v[188:189], v[244:245], v[4:5]
    v_pk_fma_f32 v[184:185], v[244:245], v[6:7], v[184:185] neg_lo:[1,0,0] neg_hi:[1,0,0]
    v_pk_fma_f32 v[188:189], v[240:241], v[6:7], v[188:189]
    ds_write_b128 v12, v[224:227] offset:0
    v_accvgpr_read_b32 v8, a124
    v_accvgpr_read_b32 v9, a126
    v_lshlrev_b32 v4, 16, v8
    v_lshlrev_b32 v5, 16, v9
    v_and_b32 v6, 0xffff0000, v8
    v_and_b32 v7, 0xffff0000, v9
    v_pk_mul_f32 v[186:187], v[242:243], v[4:5]
    v_pk_mul_f32 v[190:191], v[246:247], v[4:5]
    v_pk_fma_f32 v[186:187], v[246:247], v[6:7], v[186:187] neg_lo:[1,0,0] neg_hi:[1,0,0]
    v_pk_fma_f32 v[190:191], v[242:243], v[6:7], v[190:191]
    ds_write_b128 v12, v[228:231] offset:9216
    v_accvgpr_read_b32 v8, a128
    v_accvgpr_read_b32 v9, a130
    v_lshlrev_b32 v4, 16, v8
    v_lshlrev_b32 v5, 16, v9
    v_and_b32 v6, 0xffff0000, v8
    v_and_b32 v7, 0xffff0000, v9
    v_pk_mul_f32 v[192:193], v[248:249], v[4:5]
    v_pk_mul_f32 v[196:197], v[252:253], v[4:5]
    v_pk_fma_f32 v[192:193], v[252:253], v[6:7], v[192:193] neg_lo:[1,0,0] neg_hi:[1,0,0]
    v_pk_fma_f32 v[196:197], v[248:249], v[6:7], v[196:197]
    ds_write_b128 v12, v[232:235] offset:64
    v_accvgpr_read_b32 v8, a132
    v_accvgpr_read_b32 v9, a134
    v_lshlrev_b32 v4, 16, v8
    v_lshlrev_b32 v5, 16, v9
    v_and_b32 v6, 0xffff0000, v8
    v_and_b32 v7, 0xffff0000, v9
    v_pk_mul_f32 v[194:195], v[250:251], v[4:5]
    v_pk_mul_f32 v[198:199], v[254:255], v[4:5]
    v_pk_fma_f32 v[194:195], v[254:255], v[6:7], v[194:195] neg_lo:[1,0,0] neg_hi:[1,0,0]
    v_pk_fma_f32 v[198:199], v[250:251], v[6:7], v[198:199]
    ds_write_b128 v12, v[236:239] offset:9280
    ds_write2st64_b32 v14, v224, v228 offset0:0 offset1:36
    s_waitcnt lgkmcnt(0)
    s_barrier
    ds_read_b128 v[96:99], v13 offset:64
    ds_read_b128 v[100:103], v13 offset:9280
    ds_read_b128 v[104:107], v13 offset:0
    ds_read_b128 v[108:111], v13 offset:9216
    ds_read_b32 v4, v13 offset:80
    ds_read_b32 v5, v13 offset:9296
    ds_read_b32 v6, v13 offset:16
    ds_read_b32 v7, v13 offset:9232
    s_waitcnt lgkmcnt(0)
    s_nop 0
    v_cndmask_b32 v96, v96, v97, s[44:45]
    v_cndmask_b32 v97, v97, v98, s[44:45]
    v_cndmask_b32 v98, v98, v99, s[44:45]
    v_cndmask_b32 v99, v99, v4, s[44:45]
    v_cndmask_b32 v100, v100, v101, s[44:45]
    v_cndmask_b32 v101, v101, v102, s[44:45]
    v_cndmask_b32 v102, v102, v103, s[44:45]
    v_cndmask_b32 v103, v103, v5, s[44:45]
    v_cndmask_b32 v104, v104, v105, s[44:45]
    v_cndmask_b32 v105, v105, v106, s[44:45]
    v_cndmask_b32 v106, v106, v107, s[44:45]
    v_cndmask_b32 v107, v107, v6, s[44:45]
    v_cndmask_b32 v108, v108, v109, s[44:45]
    v_cndmask_b32 v109, v109, v110, s[44:45]
    v_cndmask_b32 v110, v110, v111, s[44:45]
    v_cndmask_b32 v111, v111, v7, s[44:45]
    v_pk_mul_f32 v[240:241], v[98:99], 1.0 op_sel:[1,0] op_sel_hi:[0,0]
    v_pk_mul_f32 v[242:243], v[96:97], 1.0 op_sel:[1,0] op_sel_hi:[0,0]
    v_pk_mul_f32 v[244:245], v[102:103], -1.0 op_sel:[1,0] op_sel_hi:[0,0]
    v_pk_mul_f32 v[246:247], v[100:101], -1.0 op_sel:[1,0] op_sel_hi:[0,0]
    v_pk_mul_f32 v[248:249], v[106:107], 1.0 op_sel:[1,0] op_sel_hi:[0,0]
    v_pk_mul_f32 v[250:251], v[104:105], 1.0 op_sel:[1,0] op_sel_hi:[0,0]
    v_pk_mul_f32 v[252:253], v[110:111], -1.0 op_sel:[1,0] op_sel_hi:[0,0]
    v_pk_mul_f32 v[254:255], v[108:109], -1.0 op_sel:[1,0] op_sel_hi:[0,0]
    v_pk_fma_f32 v[4:5], v[224:225], s[42:43], v[244:245] op_sel_hi:[1,0,1]
    v_pk_fma_f32 v[6:7], v[228:229], s[42:43], v[240:241] op_sel_hi:[1,0,1] neg_lo:[0,0,1] neg_hi:[0,0,1]
    v_pk_fma_f32 v[8:9], v[240:241], s[42:43], v[228:229] op_sel_hi:[1,0,1]
    v_pk_fma_f32 v[10:11], v[244:245], s[42:43], v[224:225] op_sel_hi:[1,0,1] neg_lo:[0,0,1] neg_hi:[0,0,1]
    v_pk_mul_f32 v[224:225], v[4:5], v[152:153]
    v_pk_mul_f32 v[228:229], v[6:7], v[152:153]
    v_pk_mul_f32 v[240:241], v[8:9], v[168:169]
    v_pk_mul_f32 v[244:245], v[10:11], v[168:169]
    v_pk_fma_f32 v[152:153], v[6:7], v[160:161], v[224:225] neg_lo:[1,0,0] neg_hi:[1,0,0]
    v_pk_fma_f32 v[160:161], v[4:5], v[160:161], v[228:229]
    v_pk_fma_f32 v[168:169], v[10:11], v[176:177], v[240:241]
    v_pk_fma_f32 v[176:177], v[8:9], v[176:177], v[244:245] neg_lo:[1,0,0] neg_hi:[1,0,0]
    v_pk_fma_f32 v[224:225], v[152:153], s[42:43], v[176:177] op_sel_hi:[1,0,1] neg_lo:[0,0,1] neg_hi:[0,0,1]
    v_pk_fma_f32 v[228:229], v[160:161], s[42:43], v[168:169] op_sel_hi:[1,0,1]
    v_pk_fma_f32 v[240:241], v[168:169], s[42:43], v[160:161] op_sel_hi:[1,0,1] neg_lo:[0,0,1] neg_hi:[0,0,1]
    v_pk_fma_f32 v[244:245], v[176:177], s[42:43], v[152:153] op_sel_hi:[1,0,1]
    v_pk_fma_f32 v[4:5], v[226:227], s[42:43], v[246:247] op_sel_hi:[1,0,1]
    v_pk_fma_f32 v[6:7], v[230:231], s[42:43], v[242:243] op_sel_hi:[1,0,1] neg_lo:[0,0,1] neg_hi:[0,0,1]
    v_pk_fma_f32 v[8:9], v[242:243], s[42:43], v[230:231] op_sel_hi:[1,0,1]
    v_pk_fma_f32 v[10:11], v[246:247], s[42:43], v[226:227] op_sel_hi:[1,0,1] neg_lo:[0,0,1] neg_hi:[0,0,1]
    v_pk_mul_f32 v[226:227], v[4:5], v[154:155]
    v_pk_mul_f32 v[230:231], v[6:7], v[154:155]
    v_pk_mul_f32 v[242:243], v[8:9], v[170:171]
    v_pk_mul_f32 v[246:247], v[10:11], v[170:171]
    v_pk_fma_f32 v[154:155], v[6:7], v[162:163], v[226:227] neg_lo:[1,0,0] neg_hi:[1,0,0]
    v_pk_fma_f32 v[162:163], v[4:5], v[162:163], v[230:231]
    v_pk_fma_f32 v[170:171], v[10:11], v[178:179], v[242:243]
    v_pk_fma_f32 v[178:179], v[8:9], v[178:179], v[246:247] neg_lo:[1,0,0] neg_hi:[1,0,0]
    v_pk_fma_f32 v[226:227], v[154:155], s[42:43], v[178:179] op_sel_hi:[1,0,1] neg_lo:[0,0,1] neg_hi:[0,0,1]
    v_pk_fma_f32 v[230:231], v[162:163], s[42:43], v[170:171] op_sel_hi:[1,0,1]
    v_pk_fma_f32 v[242:243], v[170:171], s[42:43], v[162:163] op_sel_hi:[1,0,1] neg_lo:[0,0,1] neg_hi:[0,0,1]
    v_pk_fma_f32 v[246:247], v[178:179], s[42:43], v[154:155] op_sel_hi:[1,0,1]
    v_pk_fma_f32 v[4:5], v[232:233], s[42:43], v[252:253] op_sel_hi:[1,0,1]
    v_pk_fma_f32 v[6:7], v[236:237], s[42:43], v[248:249] op_sel_hi:[1,0,1] neg_lo:[0,0,1] neg_hi:[0,0,1]
    v_pk_fma_f32 v[8:9], v[248:249], s[42:43], v[236:237] op_sel_hi:[1,0,1]
    v_pk_fma_f32 v[10:11], v[252:253], s[42:43], v[232:233] op_sel_hi:[1,0,1] neg_lo:[0,0,1] neg_hi:[0,0,1]
    v_pk_mul_f32 v[232:233], v[4:5], v[156:157]
    v_pk_mul_f32 v[236:237], v[6:7], v[156:157]
    v_pk_mul_f32 v[248:249], v[8:9], v[172:173]
    v_pk_mul_f32 v[252:253], v[10:11], v[172:173]
    v_pk_fma_f32 v[156:157], v[6:7], v[164:165], v[232:233] neg_lo:[1,0,0] neg_hi:[1,0,0]
    v_pk_fma_f32 v[164:165], v[4:5], v[164:165], v[236:237]
    v_pk_fma_f32 v[172:173], v[10:11], v[180:181], v[248:249]
    v_pk_fma_f32 v[180:181], v[8:9], v[180:181], v[252:253] neg_lo:[1,0,0] neg_hi:[1,0,0]
    v_pk_fma_f32 v[232:233], v[156:157], s[42:43], v[180:181] op_sel_hi:[1,0,1] neg_lo:[0,0,1] neg_hi:[0,0,1]
    v_pk_fma_f32 v[236:237], v[164:165], s[42:43], v[172:173] op_sel_hi:[1,0,1]
    v_pk_fma_f32 v[248:249], v[172:173], s[42:43], v[164:165] op_sel_hi:[1,0,1] neg_lo:[0,0,1] neg_hi:[0,0,1]
    v_pk_fma_f32 v[252:253], v[180:181], s[42:43], v[156:157] op_sel_hi:[1,0,1]
    v_pk_fma_f32 v[4:5], v[234:235], s[42:43], v[254:255] op_sel_hi:[1,0,1]
    v_pk_fma_f32 v[6:7], v[238:239], s[42:43], v[250:251] op_sel_hi:[1,0,1] neg_lo:[0,0,1] neg_hi:[0,0,1]
    v_pk_fma_f32 v[8:9], v[250:251], s[42:43], v[238:239] op_sel_hi:[1,0,1]
    v_pk_fma_f32 v[10:11], v[254:255], s[42:43], v[234:235] op_sel_hi:[1,0,1] neg_lo:[0,0,1] neg_hi:[0,0,1]
    v_pk_mul_f32 v[234:235], v[4:5], v[158:159]
    v_pk_mul_f32 v[238:239], v[6:7], v[158:159]
    v_pk_mul_f32 v[250:251], v[8:9], v[174:175]
    v_pk_mul_f32 v[254:255], v[10:11], v[174:175]
    v_pk_fma_f32 v[158:159], v[6:7], v[166:167], v[234:235] neg_lo:[1,0,0] neg_hi:[1,0,0]
    v_pk_fma_f32 v[166:167], v[4:5], v[166:167], v[238:239]
    v_pk_fma_f32 v[174:175], v[10:11], v[182:183], v[250:251]
    v_pk_fma_f32 v[182:183], v[8:9], v[182:183], v[254:255] neg_lo:[1,0,0] neg_hi:[1,0,0]
    v_pk_fma_f32 v[234:235], v[158:159], s[42:43], v[182:183] op_sel_hi:[1,0,1] neg_lo:[0,0,1] neg_hi:[0,0,1]
    v_pk_fma_f32 v[238:239], v[166:167], s[42:43], v[174:175] op_sel_hi:[1,0,1]
    v_pk_fma_f32 v[250:251], v[174:175], s[42:43], v[166:167] op_sel_hi:[1,0,1] neg_lo:[0,0,1] neg_hi:[0,0,1]
    v_pk_fma_f32 v[254:255], v[182:183], s[42:43], v[158:159] op_sel_hi:[1,0,1]
    ds_write_b128 v12, v[240:243] offset:18432
    ds_write_b128 v12, v[244:247] offset:27648
    ds_write_b128 v12, v[248:251] offset:18496
    ds_write_b128 v12, v[252:255] offset:27712
    ds_write2st64_b32 v14, v240, v244 offset0:72 offset1:108
    s_waitcnt lgkmcnt(0)
    s_barrier
    ds_read_b128 v[96:99], v13 offset:18496
    ds_read_b128 v[100:103], v13 offset:27712
    ds_read_b128 v[104:107], v13 offset:18432
    ds_read_b128 v[108:111], v13 offset:27648
    ds_read_b32 v4, v13 offset:18512
    ds_read_b32 v5, v13 offset:27728
    ds_read_b32 v6, v13 offset:18448
    ds_read_b32 v7, v13 offset:27664
    s_waitcnt lgkmcnt(0)
    s_nop 0
    v_cndmask_b32 v96, v96, v97, s[44:45]
    v_cndmask_b32 v97, v97, v98, s[44:45]
    v_cndmask_b32 v98, v98, v99, s[44:45]
    v_cndmask_b32 v99, v99, v4, s[44:45]
    v_cndmask_b32 v100, v100, v101, s[44:45]
    v_cndmask_b32 v101, v101, v102, s[44:45]
    v_cndmask_b32 v102, v102, v103, s[44:45]
    v_cndmask_b32 v103, v103, v5, s[44:45]
    v_cndmask_b32 v104, v104, v105, s[44:45]
    v_cndmask_b32 v105, v105, v106, s[44:45]
    v_cndmask_b32 v106, v106, v107, s[44:45]
    v_cndmask_b32 v107, v107, v6, s[44:45]
    v_cndmask_b32 v108, v108, v109, s[44:45]
    v_cndmask_b32 v109, v109, v110, s[44:45]
    v_cndmask_b32 v110, v110, v111, s[44:45]
    v_cndmask_b32 v111, v111, v7, s[44:45]
    v_pk_add_f32 v[224:225], v[224:225], v[98:99] op_sel:[0,1] op_sel_hi:[1,0]
    v_pk_mul_f32 v[240:241], v[184:185], 4.0 op_sel_hi:[1,0]
    v_pk_add_f32 v[226:227], v[226:227], v[96:97] op_sel:[0,1] op_sel_hi:[1,0]
    v_pk_mul_f32 v[242:243], v[186:187], 4.0 op_sel_hi:[1,0]
    v_pk_add_f32 v[228:229], v[228:229], v[102:103] op_sel:[0,1] op_sel_hi:[1,0] neg_lo:[0,1] neg_hi:[0,1]
    v_pk_mul_f32 v[244:245], v[188:189], 4.0 op_sel_hi:[1,0]
    v_pk_add_f32 v[230:231], v[230:231], v[100:101] op_sel:[0,1] op_sel_hi:[1,0] neg_lo:[0,1] neg_hi:[0,1]
    v_pk_mul_f32 v[246:247], v[190:191], 4.0 op_sel_hi:[1,0]
    v_pk_add_f32 v[232:233], v[232:233], v[106:107] op_sel:[0,1] op_sel_hi:[1,0]
    v_pk_mul_f32 v[248:249], v[192:193], 4.0 op_sel_hi:[1,0]
    v_pk_add_f32 v[234:235], v[234:235], v[104:105] op_sel:[0,1] op_sel_hi:[1,0]
    v_pk_mul_f32 v[250:251], v[194:195], 4.0 op_sel_hi:[1,0]
    v_pk_add_f32 v[236:237], v[236:237], v[110:111] op_sel:[0,1] op_sel_hi:[1,0] neg_lo:[0,1] neg_hi:[0,1]
    v_pk_mul_f32 v[252:253], v[196:197], 4.0 op_sel_hi:[1,0]
    v_pk_add_f32 v[238:239], v[238:239], v[108:109] op_sel:[0,1] op_sel_hi:[1,0] neg_lo:[0,1] neg_hi:[0,1]
    v_pk_mul_f32 v[254:255], v[198:199], 4.0 op_sel_hi:[1,0]
    s_barrier
    s_branch K_SPECIAL2_RET
K_POLL2:
    s_mov_b32 s71, 0
K_POLL2_L:
    buffer_load_dwordx4 v[96:99], v148, s[24:27], s93 offen sc1
    buffer_load_dwordx4 v[100:103], v149, s[24:27], s93 offen sc1
    buffer_load_dwordx4 v[104:107], v150, s[24:27], s93 offen sc1
    buffer_load_dwordx4 v[108:111], v151, s[24:27], s93 offen sc1
    s_add_u32 s71, s71, 1
    s_waitcnt vmcnt(0)
    v_cmp_ne_u32 s[52:53], s35, v98
    v_cmp_ne_u32 s[54:55], s35, v102
    v_cmp_ne_u32 s[56:57], s35, v106
    v_cmp_ne_u32 s[58:59], s35, v110
    s_and_b64 s[52:53], s[52:53], s[80:81]
    s_and_b64 s[54:55], s[54:55], s[82:83]
    s_and_b64 s[56:57], s[56:57], s[84:85]
    s_and_b64 s[58:59], s[58:59], s[86:87]
    s_or_b64 s[52:53], s[52:53], s[54:55]
    s_or_b64 s[56:57], s[56:57], s[58:59]
    s_or_b64 vcc, s[52:53], s[56:57]
    s_cbranch_vccz K_POLL2_OK
    s_cmp_lt_u32 s71, 200000
    s_cbranch_scc1 K_POLL2_L
    s_branch K_POLL2_OK
K_POLL31:
    s_mov_b32 s71, 0
K_POLL31_L:
    s_sleep 0
    buffer_load_dword v4, v210, s[24:27], s51 offen offset:64 sc1
    s_add_u32 s71, s71, 1
    s_waitcnt vmcnt(0)
    v_cmp_ne_u32 vcc, s35, v4
    s_nop 0
    s_and_b32 s59, vcc_lo, 254
    s_cmp_lg_u32 s59, 0
    s_cbranch_scc0 K_POLL31_OK
    s_cmp_lt_u32 s71, 200000
    s_cbranch_scc1 K_POLL31_L
    s_branch K_POLL31_OK
K_POLL4:
    s_mov_b32 s71, 0
K_POLL4_L:
    s_sleep 1
    buffer_load_dword v8, v13, s[24:27], s70 offen sc1
    s_add_u32 s71, s71, 1
    s_waitcnt vmcnt(0)
    v_cmp_ne_u32 vcc, s35, v8
    s_nop 0
    s_cbranch_vccz K_POLL4_OK
    s_cmp_lt_u32 s71, 200000
    s_cbranch_scc1 K_POLL4_L
    s_branch K_POLL4_OK
K_POLL5:
    s_mov_b32 s71, 0
K_POLL5_L:
    s_sleep 1
    buffer_load_dword v10, v5, s[24:27], s70 offen sc1
    s_add_u32 s71, s71, 1
    s_waitcnt vmcnt(0)
    v_cmp_ne_u32 vcc, s98, v10
    s_nop 0
    s_cbranch_vccz K_POLL5_OK
    s_cmp_lt_u32 s71, 200000
    s_cbranch_scc1 K_POLL5_L
    s_branch K_POLL5_OK
K_POLL6:
    s_mov_b32 s71, 0
K_POLL6_L:
    s_sleep 1
    buffer_load_dword v6, v9, s[24:27], s70 offen sc1
    s_add_u32 s71, s71, 1
    s_waitcnt vmcnt(0)
    v_cmp_ne_u32 vcc, s98, v6
    s_nop 0
    s_cbranch_vccz K_POLL6_OK
    s_cmp_lt_u32 s71, 200000
    s_cbranch_scc1 K_POLL6_L
    s_branch K_POLL6_OK
K_HFAR:
    ds_read_b64_tr_b16 v[64:65], v220 offset:0
    ds_read_b64_tr_b16 v[66:67], v221 offset:1024
    ds_read_b64_tr_b16 v[80:81], v222 offset:0
    ds_read_b64_tr_b16 v[82:83], v223 offset:1024
    ds_read_b64_tr_b16 v[68:69], v220 offset:8192
    ds_read_b64_tr_b16 v[70:71], v221 offset:9216
    ds_read_b64_tr_b16 v[84:85], v222 offset:8192
    ds_read_b64_tr_b16 v[86:87], v223 offset:9216
    ds_read_b64_tr_b16 v[72:73], v220 offset:16384
    ds_read_b64_tr_b16 v[74:75], v221 offset:17408
    ds_read_b64_tr_b16 v[88:89], v222 offset:16384
    ds_read_b64_tr_b16 v[90:91], v223 offset:17408
    s_waitcnt lgkmcnt(8)
    s_nop 0
    buffer_store_dwordx4 v[64:67], v24, s[28:31], s68 offen sc1
    buffer_store_dwordx4 v[80:83], v24, s[28:31], s69 offen sc1
    ds_read_b64_tr_b16 v[76:77], v220 offset:24576
    ds_read_b64_tr_b16 v[78:79], v221 offset:25600
    ds_read_b64_tr_b16 v[92:93], v222 offset:24576
    ds_read_b64_tr_b16 v[94:95], v223 offset:25600
    ds_read_b128 v[152:155], v20 offset:0
    ds_read_b128 v[156:159], v20 offset:2048
    ds_read_b128 v[160:163], v20 offset:4096
    ds_read_b128 v[164:167], v20 offset:6144
    s_waitcnt lgkmcnt(12)
    buffer_store_dwordx4 v[68:71], v25, s[28:31], s68 offen sc1
    s_waitcnt lgkmcnt(0)
    v_mfma_f32_16x16x32_bf16 v[32:35], v[64:67], v[152:155], 0
    ds_read_b128 v[168:171], v21 offset:0
    buffer_store_dwordx4 v[84:87], v25, s[28:31], s69 offen sc1
    v_mfma_f32_16x16x32_bf16 v[48:51], v[80:83], v[152:155], 0
    ds_read_b128 v[172:175], v21 offset:2048
    v_mfma_f32_16x16x32_bf16 v[36:39], v[64:67], v[156:159], 0
    ds_read_b128 v[176:179], v21 offset:4096
    buffer_store_dwordx4 v[72:75], v26, s[28:31], s68 offen sc1
    v_mfma_f32_16x16x32_bf16 v[52:55], v[80:83], v[156:159], 0
    ds_read_b128 v[180:183], v21 offset:6144
    v_mfma_f32_16x16x32_bf16 v[40:43], v[64:67], v[160:163], 0
    v_mfma_f32_16x16x32_bf16 v[56:59], v[80:83], v[160:163], 0
    buffer_store_dwordx4 v[88:91], v26, s[28:31], s69 offen sc1
    v_mfma_f32_16x16x32_bf16 v[44:47], v[64:67], v[164:167], 0
    v_mfma_f32_16x16x32_bf16 v[60:63], v[80:83], v[164:167], 0
    s_waitcnt lgkmcnt(0)
    v_mfma_f32_16x16x32_bf16 v[32:35], v[68:71], v[168:171], v[32:35]
    ds_read_b128 v[152:155], v22 offset:0
    buffer_store_dwordx4 v[76:79], v27, s[28:31], s68 offen sc1
    v_mfma_f32_16x16x32_bf16 v[48:51], v[84:87], v[168:171], v[48:51]
    ds_read_b128 v[156:159], v22 offset:2048
    v_mfma_f32_16x16x32_bf16 v[36:39], v[68:71], v[172:175], v[36:39]
    ds_read_b128 v[160:163], v22 offset:4096
    v_mfma_f32_16x16x32_bf16 v[52:55], v[84:87], v[172:175], v[52:55]
    ds_read_b128 v[164:167], v22 offset:6144
    v_mfma_f32_16x16x32_bf16 v[40:43], v[68:71], v[176:179], v[40:43]
    buffer_store_dwordx4 v[92:95], v27, s[28:31], s69 offen sc1
    v_mfma_f32_16x16x32_bf16 v[56:59], v[84:87], v[176:179], v[56:59]
    v_mfma_f32_16x16x32_bf16 v[44:47], v[68:71], v[180:183], v[44:47]
    v_mfma_f32_16x16x32_bf16 v[60:63], v[84:87], v[180:183], v[60:63]
    s_branch K_HFAR_RET
K_CODE_END:
.section .rodata,"a"
.p2align 6
.amdhsa_kernel gated_mix__spectral_gfnet__ssm_conv_s5__prompt_kernel
  .amdhsa_next_free_vgpr 512
  .amdhsa_next_free_sgpr 102
  .amdhsa_accum_offset 256
  .amdhsa_group_segment_fixed_size 0
  .amdhsa_kernarg_size 128
  .amdhsa_user_sgpr_count 2
  .amdhsa_user_sgpr_kernarg_segment_ptr 1
  .amdhsa_system_sgpr_workgroup_id_x 1
.end_amdhsa_kernel
```

```asm
; @launch grid=(256,1,1) block=(256,1,1) lds=163840
.amdgcn_target "amdgcn-amd-amdhsa--gfx950"
.text
.globl gated_mix__spectral_gfnet__ssm_conv_s5__prompt_kernel
.p2align 8
.type gated_mix__spectral_gfnet__ssm_conv_s5__prompt_kernel,@function
gated_mix__spectral_gfnet__ssm_conv_s5__prompt_kernel:
    s_load_dwordx2 s[8:9], s[0:1], 0
    s_load_dwordx2 s[60:61], s[0:1], 120
    s_cmp_ge_u32 s2, 256
    s_cbranch_scc1 K_END
    s_getpc_b64 s[28:29]
K_PC:
    s_mov_b32 s30, K_CODE_END-K_PC
    s_mov_b32 s31, 0x00020000
    s_lshr_b32 s38, s2, 3
    s_mul_i32 s38, s38, 1280
    v_lshl_add_u32 v4, v0, 3, s38
    v_lshrrev_b32 v3, 6, v0
    buffer_load_dword v255, v4, s[28:31], 0 offen
    s_load_dwordx8 s[52:59], s[0:1], 32
    s_load_dwordx4 s[44:47], s[0:1], 8
    s_load_dwordx8 s[80:87], s[0:1], 64
    s_load_dwordx4 s[88:91], s[0:1], 96
    v_readfirstlane_b32 s34, v3
    v_and_b32 v1, 15, v0
    v_bfe_u32 v2, v0, 4, 2
    s_and_b32 s38, s2, 3
    s_bfe_u32 s39, s2, 0x20003
    s_lshl2_add_u32 s32, s38, s39
    s_bfe_u32 s38, s2, 0x10002
    s_lshr_b32 s39, s2, 5
    s_lshl3_add_u32 s33, s38, s39
    s_and_b32 s6, s34, 1
    s_lshr_b32 s41, s34, 1
    s_lshl1_add_u32 s38, s32, s6
    s_lshl_b32 s38, s38, 5
    s_add_u32 s38, s38, s33
    s_lshl1_add_u32 s68, s38, s41
    s_lshl_b32 s68, s68, 11
    s_add_u32 s69, s68, 65536
    v_lshlrev_b32 v5, 9, v2
    v_lshl_add_u32 v29, v1, 3, v5
    s_mov_b32 s10, 0x400000
    s_mov_b32 s11, s31
    s_waitcnt lgkmcnt(0)
    buffer_load_dwordx2 v[96:97], v29, s[8:11], s68 offen offset:0
    buffer_load_dwordx2 v[98:99], v29, s[8:11], s68 offen offset:128
    v_cmp_gt_u32_e64 vcc, 16, v0
    buffer_load_dwordx2 v[100:101], v29, s[8:11], s68 offen offset:256
    v_lshlrev_b32 v30, 2, v0
    s_lshl4_add_u32 s4, s32, s33
    s_lshl_b32 s37, s34, 12
    v_cndmask_b32 v30, 2.0, v30, vcc
    v_and_b32 v0, 63, v0
    v_lshlrev_b32 v3, 4, v0
    buffer_load_dwordx2 v[102:103], v29, s[8:11], s68 offen offset:384
    s_lshl_b32 s63, s34, 4
    s_lshl2_add_u32 s94, s6, s41
    v_and_b32 v6, 7, v0
    v_xor_b32 v6, v6, v2
    v_lshlrev_b32 v6, 4, v6
    v_and_b32 v8, 32, v0
    v_bfe_u32 v9, v0, 3, 1
    buffer_load_dwordx2 v[104:105], v29, s[8:11], s69 offen offset:0
    v_lshl_add_u32 v8, v9, 4, v8
    v_bfe_u32 v9, v0, 4, 1
    s_lshl_b32 s38, s32, 5
    s_add_u32 s38, s38, s34
    s_lshl_b32 s38, s38, 2
    v_add3_u32 v8, v8, v9, s38
    v_lshl_add_u32 v16, v8, 11, v6
    buffer_load_dwordx2 v[106:107], v29, s[8:11], s69 offen offset:128
    v_lshrrev_b32 v9, 3, v0
    s_lshl1_add_u32 s38, s33, s6
    s_lshl_b32 s38, s38, 5
    v_add_u32_e64 v9, s38, v9
    v_lshl_add_u32 v20, v9, 11, v6
    v_xor_b32 v8, 64, v16
    v_xor_b32 v9, 64, v20
    buffer_load_dwordx2 v[108:109], v29, s[8:11], s69 offen offset:256
    v_add_u32 v17, 130048, v8
    v_add_u32 v18, 2048, v16
    v_add_u32 v19, 132096, v8
    v_add_u32 v21, 15360, v9
    v_add_u32 v22, 30720, v20
    v_add_u32 v23, 46080, v9
    s_add_u32 s38, s32, s33
    buffer_load_dwordx2 v[110:111], v29, s[8:11], s69 offen offset:384
    s_and_b32 s38, s38, 3
    s_mov_b32 s66, 2253603344
    s_mov_b32 s67, 4275817111
    s_cmp_eq_u32 s38, 1
    s_cselect_b32 s66, 2539672353, s66
    s_cselect_b32 s67, 3488144292, s67
    s_cmp_eq_u32 s38, 2
    s_cselect_b32 s66, 1417023538, s66
    s_cselect_b32 s67, 3707672762, s67
    s_cmp_eq_u32 s38, 3
    s_cselect_b32 s66, 1699160323, s66
    s_cselect_b32 s67, 3989809547, s67
    s_and_b32 s38, s2, 3
    s_mul_i32 s38, s38, 0x44444444
    s_xor_b32 s66, s66, s38
    s_xor_b32 s67, s67, s38
    s_mov_b32 s14, 0x200000
    s_mov_b32 s15, s31
    s_nop 0
    s_cmp_lt_u32 s34, 2
    s_cselect_b64 s[12:13], s[56:57], s[58:59]
    s_cselect_b64 s[28:29], s[88:89], s[86:87]
    s_mov_b32 s30, 2048
    s_lshl_b32 s39, s34, 10
    s_add_u32 m0, s39, 147712
    s_lshl_b32 s38, s6, 10
    buffer_load_dwordx4 v3, s[28:31], s38 offen lds
    v_cvt_f32_u32 v249, v1
    v_cvt_f32_u32_e64 v250, v2
    v_mul_f32 v251, 0x3d800000, v249
    v_mul_f32 v250, 4.0, v250
    v_mul_f32 v248, v250, v251
    v_fmamk_f32 v4, v251, 0x00000000, v248
    v_fmamk_f32 v5, v251, 0x3f800000, v248
    v_fmamk_f32 v6, v251, 0x40000000, v248
    s_bfe_u32 s36, s66, 262144
    s_add_u32 m0, s37, 16384
    s_lshl_b32 s36, s36, 7
    buffer_load_dwordx4 v20, s[12:15], s36 offen offset:0  lds
    buffer_load_dwordx4 v21, s[12:15], s36 offen offset:1024  lds
    buffer_load_dwordx4 v22, s[12:15], s36 offen offset:2048  lds
    buffer_load_dwordx4 v23, s[12:15], s36 offen offset:3072  lds
    v_fmamk_f32 v7, v251, 0x40400000, v248
    v_cos_f32 v8, v4
    v_cos_f32 v9, v5
    v_cos_f32 v10, v6
    v_cos_f32 v11, v7
    v_sin_f32 v12, v4
    v_sin_f32 v13, v5
    v_sin_f32 v14, v6
    v_sin_f32_e64 v15, v7
    v_cvt_pk_bf16_f32 v4, v8, v12
    v_cvt_pk_bf16_f32 v5, -v12, v8
    v_accvgpr_write_b32 a224, v4
    v_accvgpr_write_b32 a228, v5
    v_cvt_pk_bf16_f32 v4, v9, v13
    v_cvt_pk_bf16_f32 v5, -v13, v9
    v_accvgpr_write_b32 a225, v4
    v_accvgpr_write_b32 a229, v5
    v_cvt_pk_bf16_f32 v4, v10, v14
    v_cvt_pk_bf16_f32 v5, -v14, v10
    v_accvgpr_write_b32 a226, v4
    v_accvgpr_write_b32 a230, v5
    v_cvt_pk_bf16_f32 v4, v11, v15
    v_cvt_pk_bf16_f32 v5, -v15, v11
    v_accvgpr_write_b32 a227, v4
    v_accvgpr_write_b32 a231, v5
    v_fmamk_f32 v4, v251, 0x3f000000, v248
    v_fmamk_f32 v5, v251, 0x3fc00000, v248
    v_fmamk_f32 v6, v251, 0x40200000, v248
    v_fmamk_f32 v7, v251, 0x40600000, v248
    v_cos_f32 v8, v4
    v_cos_f32 v9, v5
    v_cos_f32_e64 v10, v6
    s_add_u32 s40, s60, 22446080
    s_addc_u32 s41, s61, 0
    s_load_dword s62, s[40:41], 0
    v_cos_f32 v11, v7
    v_sin_f32 v12, v4
    v_sin_f32 v13, v5
    v_sin_f32 v14, v6
    v_sin_f32 v15, v7
    v_cvt_pk_bf16_f32 v4, v8, v12
    v_cvt_pk_bf16_f32 v5, -v12, v8
    v_accvgpr_write_b32 a248, v4
    v_accvgpr_write_b32 a252, v5
    v_cvt_pk_bf16_f32 v4, v9, v13
    v_cvt_pk_bf16_f32 v5, -v13, v9
    v_accvgpr_write_b32 a249, v4
    v_accvgpr_write_b32 a253, v5
    v_cvt_pk_bf16_f32 v4, v10, v14
    v_cvt_pk_bf16_f32 v5, -v14, v10
    v_accvgpr_write_b32 a250, v4
    v_accvgpr_write_b32 a254, v5
    v_cvt_pk_bf16_f32 v4, v11, v15
    v_cvt_pk_bf16_f32 v5, -v15, v11
    v_accvgpr_write_b32 a251, v4
    v_accvgpr_write_b32 a255, v5
    v_mul_f32 v251, 0x3d800000, v251
    v_mul_f32 v248, 0x3d800000, v248
    v_fmamk_f32 v4, v251, 0x00000000, v248
    v_fmamk_f32 v5, v251, 0x3f800000, v248
    v_fmamk_f32 v6, v251, 0x40000000, v248
    v_fmamk_f32 v7, v251, 0x40400000, v248
    v_cos_f32 v232, v4
    v_cos_f32 v233, v5
    v_cos_f32 v234, v6
    v_cos_f32 v235, v7
    v_sin_f32 v240, v4
    v_sin_f32 v241, v5
    v_sin_f32 v242, v6
    v_sin_f32 v243, v7
    v_fmamk_f32 v4, v251, 0x3f000000, v248
    v_fmamk_f32 v5, v251, 0x3fc00000, v248
    v_fmamk_f32 v6, v251, 0x40200000, v248
    v_fmamk_f32 v7, v251, 0x40600000, v248
    v_cos_f32 v236, v4
    v_cos_f32 v237, v5
    v_cos_f32 v238, v6
    v_cos_f32 v239, v7
    v_sin_f32 v244, v4
    v_sin_f32 v245, v5
    v_sin_f32 v246, v6
    v_sin_f32 v247, v7
    s_mov_b64 s[24:25], s[60:61]
    s_mov_b32 s26, 33554432
    s_mov_b32 s27, 0x00020000
    v_lshrrev_b32 v15, 1, v1
    v_xor_b32 v15, v15, v2
    v_lshlrev_b32 v15, 4, v15
    v_lshl_add_u32 v24, v1, 7, v15
    v_xor_b32 v25, 64, v24
    s_lshl_b32 s76, s34, 11
    s_add_u32 s76, s76, 16384
    v_add_u32 v26, s76, v24
    v_add_u32 v27, s76, v25
    v_add_u32 v148, 0x10000, v24
    v_add_u32 v149, 0x10000, v25
    v_add_u32 v150, 0x10000, v26
    v_add_u32 v151, 0x10000, v27
    s_and_b32 s76, s34, 2
    s_lshl1_add_u32 s76, s76, s6
    s_mul_i32 s76, s76, 2080
    s_add_u32 s76, s76, 131072
    v_lshl_add_u32 v15, v2, 6, v1
    v_lshl_add_u32 v252, v15, 3, s76
    v_sub_u32 v15, 728, v15
    v_lshl_add_u32 v253, v15, 3, s76
    v_lshrrev_b32 v7, 2, v0
    v_add_u32 v7, s63, v7
    v_and_b32 v15, 3, v0
    v_lshlrev_b32 v12, 4, v15
    v_mul_u32_u24 v229, 4160, v15
    v_lshl_add_u32 v229, v7, 3, v229
    v_add_u32 v229, 131072, v229
    v_lshrrev_b32_e64 v14, 2, v0
    v_lshl_add_u32 v230, v14, 8, v12
    v_and_b32_e64 v14, 3, v14
    v_lshl_add_u32 v231, v14, 10, v12
    v_lshl_add_u32 v231, v2, 19, v231
    v_and_b32 v15, 1, v15
    v_lshlrev_b32 v15, 11, v15
    v_cmp_eq_u32_e64 vcc, 0, v7
    v_add_u32 v254, 147712, v29
    s_nop 0
    v_cndmask_b32 v15, 0, v15, vcc
    v_add_u32_e64 v228, v229, v15
    v_accvgpr_write_b32 a136, v232
    v_accvgpr_write_b32 a144, v240
    v_accvgpr_write_b32 a137, v233
    v_accvgpr_write_b32 a145, v241
    v_accvgpr_write_b32 a138, v234
    v_accvgpr_write_b32 a146, v242
    v_accvgpr_write_b32 a139, v235
    v_accvgpr_write_b32 a147, v243
    v_fma_f32 v251, v249, 2.0, 1.0
    v_mul_f32 v251, 0x3d000000, v251
    v_mul_f32_e64 v248, v250, v251
    v_fmamk_f32 v4, v251, 0x00000000, v248
    v_fmamk_f32 v5, v251, 0x3f800000, v248
    v_fmamk_f32 v6, v251, 0x40000000, v248
    v_fmamk_f32 v7, v251, 0x40400000, v248
    v_cos_f32 v8, v4
    v_cos_f32 v9, v5
    v_cos_f32 v10, v6
    v_cos_f32 v11, v7
    v_sin_f32 v12, v4
    v_sin_f32 v13, v5
    v_sin_f32 v14, v6
    v_sin_f32 v15, v7
    v_cvt_pk_bf16_f32 v4, v8, v12
    v_cvt_pk_bf16_f32 v5, -v12, v8
    v_accvgpr_write_b32 a232, v4
    v_accvgpr_write_b32 a236, v5
    v_cvt_pk_bf16_f32 v4, v9, v13
    v_cvt_pk_bf16_f32 v5, -v13, v9
    v_accvgpr_write_b32 a233, v4
    v_accvgpr_write_b32 a237, v5
    v_cvt_pk_bf16_f32 v4, v10, v14
    v_cvt_pk_bf16_f32 v5, -v14, v10
    v_accvgpr_write_b32 a234, v4
    v_accvgpr_write_b32 a238, v5
    v_cvt_pk_bf16_f32 v4, v11, v15
    v_cvt_pk_bf16_f32 v5, -v15, v11
    v_accvgpr_write_b32 a235, v4
    v_accvgpr_write_b32 a239, v5
    v_cvt_pk_bf16_f32 v4, -v8, -v12
    v_cvt_pk_bf16_f32 v5, v12, -v8
    v_accvgpr_write_b32 a240, v4
    v_accvgpr_write_b32 a244, v5
    v_cvt_pk_bf16_f32 v4, -v9, -v13
    v_cvt_pk_bf16_f32 v5, v13, -v9
    v_accvgpr_write_b32 a241, v4
    v_accvgpr_write_b32 a245, v5
    v_cvt_pk_bf16_f32 v4, -v10, -v14
    v_cvt_pk_bf16_f32 v5, v14, -v10
    v_accvgpr_write_b32 a242, v4
    v_accvgpr_write_b32 a246, v5
    v_cvt_pk_bf16_f32 v4, -v11, -v15
    v_cvt_pk_bf16_f32 v5, v15, -v11
    v_accvgpr_write_b32 a243, v4
    v_accvgpr_write_b32 a247, v5
    v_mul_f32 v251, 0x3d800000, v251
    v_mul_f32 v248, 0x3d800000, v248
    v_fmamk_f32 v4, v251, 0x00000000, v248
    v_fmamk_f32 v5, v251, 0x3f800000, v248
    v_fmamk_f32 v6, v251, 0x40000000, v248
    v_fmamk_f32 v7, v251, 0x40400000, v248
    v_cos_f32 v8, v4
    v_cos_f32 v9, v5
    v_cos_f32 v10, v6
    v_cos_f32 v11, v7
    v_sin_f32 v12, v4
    v_sin_f32 v13, v5
    v_sin_f32 v14, v6
    v_sin_f32 v15, v7
    v_accvgpr_write_b32 a140, v8
    v_accvgpr_write_b32 a148, v12
    v_accvgpr_write_b32 a141, v9
    v_accvgpr_write_b32 a149, v13
    v_accvgpr_write_b32 a142, v10
    v_accvgpr_write_b32 a150, v14
    v_accvgpr_write_b32 a143, v11
    v_accvgpr_write_b32 a151, v15
    v_add_u32 v251, s63, v1
    v_cvt_f32_u32 v251, v251
    v_and_b32_e64 v147, 1, v1
    v_mul_f32 v251, 0x3c800000, v251
    v_mul_u32_u24 v147, 0x8000, v147
    v_mul_f32_e64 v248, v250, v251
    v_lshl_or_b32 v147, v147, 16, v147
    v_fmamk_f32 v4, v251, 0x00000000, v248
    v_fmamk_f32 v5, v251, 0x3f800000, v248
    v_fmamk_f32 v6, v251, 0x40000000, v248
    v_fmamk_f32 v7, v251, 0x40400000, v248
    v_cos_f32 v8, v4
    v_cos_f32 v9, v5
    s_mov_b64 s[16:17], s[44:45]
    s_mov_b32 s18, 2101248
    s_mov_b32 s19, 0x00020000
    s_mov_b64 s[20:21], s[46:47]
    s_mov_b32 s22, 2101248
    s_mov_b32 s23, 0x00020000
    s_lshr_b32 s38, s2, 6
    s_and_b32 s39, s2, 3
    s_lshl2_add_u32 s38, s38, s39
    s_lshl2_add_u32 s38, s38, s34
    s_bfe_u32 s39, s2, 0x10005
    s_bfe_u32 s40, s2, 0x20002
    s_lshl2_add_u32 s39, s39, s40
    s_bfe_u32 s40, s2, 0x10004
    s_lshl1_add_u32 s39, s39, s40
    s_lshl_b32 s39, s39, 7
    s_add_u32 s38, s38, s39
    s_mul_i32 s44, s38, 1026
    s_andn2_b32 s44, s44, 3
    s_add_u32 s45, s44, 65664
    s_sub_u32 s38, 2048, s38
    s_and_b32 s39, s38, 2047
    s_mul_i32 s39, s39, 1026
    s_add_u32 s39, s39, 514
    s_andn2_b32 s46, s39, 3
    s_mul_i32 s39, s38, 1026
    s_sub_u32 s39, s39, 65150
    s_andn2_b32 s47, s39, 3
    v_lshlrev_b32 v192, 3, v0
    v_sub_u32 v193, 504, v192
    s_lshl_b32 s38, s34, 2
    v_add_u32 v184, s38, v1
    v_and_b32_e64 v184, 15, v184
    v_and_or_b32 v184, v0, 48, v184
    s_lshl_b32 s38, s34, 10
    s_add_u32 s38, s38, 131072
    v_lshl_add_u32 v194, v184, 4, s38
    v_lshrrev_b32 v185, 2, v0
    v_and_b32_e64 v186, 3, v0
    v_lshl_add_u32 v184, v186, 2, v185
    v_and_b32_e64 v184, 15, v184
    v_lshl_add_u32 v184, v186, 6, v184
    s_lshl_b32 s38, s34, 8
    s_add_u32 s38, s38, 131072
    v_lshl_add_u32 v195, v184, 4, s38
    s_mov_b32 s30, 0x800000
    s_add_u32 s28, s60, 25165824
    s_addc_u32 s29, s61, 0
    s_waitcnt vmcnt(9)
    v_swap_b32 v97, v98
    v_swap_b32 v101, v102
    v_swap_b32 v98, v100
    v_swap_b32 v99, v101
    s_waitcnt vmcnt(5)
    v_swap_b32 v105, v106
    v_swap_b32 v109, v110
    v_swap_b32 v106, v108
    v_swap_b32 v107, v109
    v_mfma_f32_16x16x32_bf16 v[32:35], v[96:99], a[224:227], 0
    buffer_load_dwordx3 v[196:198], v192, s[16:19], s44 offen
    buffer_load_dwordx3 v[200:202], v192, s[20:23], s44 offen
    s_and_b32 s38, s33, 3
    s_lshr_b32 s39, s32, 2
    v_mfma_f32_16x16x32_bf16 v[36:39], v[96:99], a[228:231], 0
    s_lshl2_add_u32 s38, s38, s39
    s_and_b32 s39, s32, 3
    v_mfma_f32_16x16x32_bf16 v[40:43], v[100:103], a[224:227], 0
    s_lshl2_add_u32 s38, s38, s39
    s_lshl_b32 s39, s34, 7
    v_mfma_f32_16x16x32_bf16 v[44:47], v[100:103], a[228:231], 0
    s_add_u32 s38, s38, s39
    s_lshl_b32 s38, s38, 6
    v_mfma_f32_16x16x32_bf16 v[48:51], v[104:107], a[224:227], 0
    s_lshr_b32 s39, s33, 2
    s_add_u32 s38, s38, s39
    v_mfma_f32_16x16x32_bf16 v[52:55], v[104:107], a[228:231], 0
    s_lshl_b32 s68, s38, 6
    s_lshr_b32 s39, s34, 1
    v_mfma_f32_16x16x32_bf16 v[56:59], v[108:111], a[224:227], 0
    s_lshl1_add_u32 s38, s33, s39
    s_lshr_b32 s39, s38, 4
    v_mfma_f32_16x16x32_bf16 v[60:63], v[108:111], a[228:231], 0
    s_lshl1_add_u32 s39, s39, s6
    s_lshl2_add_u32 s41, s32, s39
    buffer_load_dwordx3 v[204:206], v193, s[16:19], s46 offen
    buffer_load_dwordx3 v[208:210], v193, s[20:23], s46 offen
    s_and_b32 s40, s38, 15
    s_lshl4_add_u32 s41, s41, s40
    s_lshl_b32 s41, s41, 6
    s_nop 0
    v_pk_mul_f32 v[184:185], v[32:33], v[232:233]
    v_pk_mul_f32 v[186:187], v[36:37], v[232:233]
    v_pk_fma_f32 v[184:185], v[36:37], v[240:241], v[184:185]
    v_pk_fma_f32 v[186:187], v[32:33], v[240:241], v[186:187] neg_lo:[1,0,0] neg_hi:[1,0,0]
    v_pk_mul_f32 v[188:189], v[34:35], v[234:235]
    v_pk_mul_f32 v[190:191], v[38:39], v[234:235]
    v_pk_fma_f32 v[188:189], v[38:39], v[242:243], v[188:189]
    v_pk_fma_f32 v[190:191], v[34:35], v[242:243], v[190:191] neg_lo:[1,0,0] neg_hi:[1,0,0]
    v_cvt_pk_bf16_f32 v152, v184, v186
    v_cvt_pk_bf16_f32 v153, v185, v187
    v_cvt_pk_bf16_f32 v154, v188, v190
    v_cvt_pk_bf16_f32 v155, v189, v191
    v_pk_mul_f32 v[184:185], v[40:41], v[236:237]
    v_pk_mul_f32 v[186:187], v[44:45], v[236:237]
    v_pk_fma_f32 v[184:185], v[44:45], v[244:245], v[184:185]
    v_pk_fma_f32 v[186:187], v[40:41], v[244:245], v[186:187] neg_lo:[1,0,0] neg_hi:[1,0,0]
    v_pk_mul_f32 v[188:189], v[42:43], v[238:239]
    v_pk_mul_f32 v[190:191], v[46:47], v[238:239]
    v_pk_fma_f32 v[188:189], v[46:47], v[246:247], v[188:189]
    v_pk_fma_f32 v[190:191], v[42:43], v[246:247], v[190:191] neg_lo:[1,0,0] neg_hi:[1,0,0]
    v_cvt_pk_bf16_f32 v156, v184, v186
    v_cvt_pk_bf16_f32 v157, v185, v187
    v_cvt_pk_bf16_f32 v158, v188, v190
    v_cvt_pk_bf16_f32 v159, v189, v191
    v_pk_mul_f32 v[184:185], v[48:49], v[232:233]
    v_pk_mul_f32 v[186:187], v[52:53], v[232:233]
    v_pk_fma_f32 v[184:185], v[52:53], v[240:241], v[184:185]
    buffer_load_dwordx3 v[212:214], v192, s[16:19], s45 offen
    buffer_load_dwordx3 v[216:218], v192, s[20:23], s45 offen
    v_pk_fma_f32 v[186:187], v[48:49], v[240:241], v[186:187] neg_lo:[1,0,0] neg_hi:[1,0,0]
    v_pk_mul_f32 v[188:189], v[50:51], v[234:235]
    v_pk_mul_f32 v[190:191], v[54:55], v[234:235]
    v_pk_fma_f32 v[188:189], v[54:55], v[242:243], v[188:189]
    v_pk_fma_f32 v[190:191], v[50:51], v[242:243], v[190:191] neg_lo:[1,0,0] neg_hi:[1,0,0]
    v_cvt_pk_bf16_f32 v160, v184, v186
    v_cvt_pk_bf16_f32 v161, v185, v187
    v_cvt_pk_bf16_f32 v162, v188, v190
    v_cvt_pk_bf16_f32 v163, v189, v191
    v_pk_mul_f32 v[184:185], v[56:57], v[236:237]
    v_pk_mul_f32 v[186:187], v[60:61], v[236:237]
    v_pk_fma_f32 v[184:185], v[60:61], v[244:245], v[184:185]
    v_pk_fma_f32 v[186:187], v[56:57], v[244:245], v[186:187] neg_lo:[1,0,0] neg_hi:[1,0,0]
    v_pk_mul_f32 v[188:189], v[58:59], v[238:239]
    v_pk_mul_f32 v[190:191], v[62:63], v[238:239]
    v_pk_fma_f32 v[188:189], v[62:63], v[246:247], v[188:189]
    v_pk_fma_f32 v[190:191], v[58:59], v[246:247], v[190:191] neg_lo:[1,0,0] neg_hi:[1,0,0]
    v_cvt_pk_bf16_f32 v164, v184, v186
    v_cvt_pk_bf16_f32 v165, v185, v187
    v_cvt_pk_bf16_f32 v166, v188, v190
    v_cvt_pk_bf16_f32 v167, v189, v191
    v_mfma_f32_16x16x32_bf16 v[64:67], a[224:227], v[152:155], 0
    s_add_u32 s69, s41, 22282240
    s_lshl_b32 s41, s32, 6
    v_mfma_f32_16x16x32_bf16 v[68:71], a[228:231], v[152:155], 0
    s_add_u32 s39, s39, s41
    buffer_load_dwordx3 v[220:222], v193, s[16:19], s47 offen
    buffer_load_dwordx3 v[224:226], v193, s[20:23], s47 offen
    s_and_b32 s40, s38, 3
    v_mfma_f32_16x16x32_bf16 v[72:75], a[248:251], v[156:159], 0
    s_lshl2_add_u32 s39, s39, s40
    s_bfe_u32 s40, s38, 0x20002
    v_mfma_f32_16x16x32_bf16 v[76:79], a[252:255], v[156:159], 0
    s_lshl2_add_u32 s39, s39, s40
    s_lshl_b32 s39, s39, 8
    v_mfma_f32_16x16x32_bf16 v[80:83], a[224:227], v[160:163], 0
    s_add_u32 s75, s39, 13631488
    s_getreg_b32 s96, hwreg(HW_REG_XCC_ID, 0, 4)
    v_mfma_f32_16x16x32_bf16 v[84:87], a[228:231], v[160:163], 0
    s_and_b32 s38, s2, 31
    s_lshl_b32 s38, s38, 10
    v_mfma_f32_16x16x32_bf16 v[88:91], a[248:251], v[164:167], 0
    s_add_u32 s51, s38, 22364160
    s_and_b32 s38, s2, 0xe0
    v_mfma_f32_16x16x32_bf16 v[92:95], a[252:255], v[164:167], 0
    s_lshl2_add_u32 s70, s38, s51
    v_pk_add_f32 v[32:33], v[64:65], v[72:73]
    v_pk_add_f32 v[40:41], v[64:65], v[72:73] neg_lo:[0,1] neg_hi:[0,1]
    v_pk_add_f32 v[34:35], v[66:67], v[74:75]
    v_pk_add_f32 v[42:43], v[66:67], v[74:75] neg_lo:[0,1] neg_hi:[0,1]
    v_pk_add_f32 v[36:37], v[68:69], v[76:77]
    v_pk_add_f32 v[44:45], v[68:69], v[76:77] neg_lo:[0,1] neg_hi:[0,1]
    v_pk_add_f32 v[38:39], v[70:71], v[78:79]
    v_pk_add_f32 v[46:47], v[70:71], v[78:79] neg_lo:[0,1] neg_hi:[0,1]
    v_pk_add_f32 v[48:49], v[80:81], v[88:89]
    v_pk_add_f32 v[56:57], v[80:81], v[88:89] neg_lo:[0,1] neg_hi:[0,1]
    v_pk_add_f32 v[50:51], v[82:83], v[90:91]
    v_pk_add_f32 v[58:59], v[82:83], v[90:91] neg_lo:[0,1] neg_hi:[0,1]
    v_pk_add_f32 v[52:53], v[84:85], v[92:93]
    v_pk_add_f32 v[60:61], v[84:85], v[92:93] neg_lo:[0,1] neg_hi:[0,1]
    v_pk_add_f32 v[54:55], v[86:87], v[94:95]
    v_pk_add_f32 v[62:63], v[86:87], v[94:95] neg_lo:[0,1] neg_hi:[0,1]
    v_cvt_pk_bf16_f32 v168, v32, v36
    v_cvt_pk_bf16_f32 v169, v48, v52
    ds_write_b64 v252, v[168:169] offset:0
    v_cvt_pk_bf16_f32 v170, v33, v37
    v_cvt_pk_bf16_f32 v171, v49, v53
    ds_write_b64 v252, v[170:171] offset:128
    v_cvt_pk_bf16_f32 v172, v34, v38
    v_cvt_pk_bf16_f32 v173, v50, v54
    ds_write_b64 v252, v[172:173] offset:256
    v_cvt_pk_bf16_f32 v174, v35, v39
    v_cvt_pk_bf16_f32 v175, v51, v55
    ds_write_b64 v252, v[174:175] offset:384
    v_cvt_pk_bf16_f32 v176, v40, -v44
    v_cvt_pk_bf16_f32 v177, v56, -v60
    ds_write_b64 v253, v[176:177] offset:384
    v_cvt_pk_bf16_f32 v178, v41, -v45
    v_cvt_pk_bf16_f32 v179, v57, -v61
    ds_write_b64 v253, v[178:179] offset:256
    v_cvt_pk_bf16_f32 v180, v42, -v46
    v_cvt_pk_bf16_f32 v181, v58, -v62
    ds_write_b64 v253, v[180:181] offset:128
    v_cvt_pk_bf16_f32 v182, v43, -v47
    v_cvt_pk_bf16_f32 v183, v59, -v63
    ds_write_b64 v253, v[182:183] offset:0
    v_lshlrev_b32_e64 v64, 16, v96
    v_and_b32 v68, 0xffff0000, v96
    v_lshlrev_b32_e64 v65, 16, v97
    v_and_b32 v69, 0xffff0000, v97
    v_lshlrev_b32_e64 v66, 16, v98
    v_and_b32 v70, 0xffff0000, v98
    v_lshlrev_b32_e64 v67, 16, v99
    v_and_b32 v71, 0xffff0000, v99
    v_lshlrev_b32_e64 v72, 16, v100
    v_and_b32 v76, 0xffff0000, v100
    v_lshlrev_b32_e64 v73, 16, v101
    v_and_b32 v77, 0xffff0000, v101
    v_lshlrev_b32_e64 v74, 16, v102
    v_and_b32 v78, 0xffff0000, v102
    v_lshlrev_b32_e64 v75, 16, v103
    v_and_b32 v79, 0xffff0000, v103
    v_lshlrev_b32_e64 v80, 16, v104
    v_and_b32 v84, 0xffff0000, v104
    v_lshlrev_b32_e64 v81, 16, v105
    v_and_b32 v85, 0xffff0000, v105
    v_lshlrev_b32_e64 v82, 16, v106
    v_and_b32 v86, 0xffff0000, v106
    v_lshlrev_b32_e64 v83, 16, v107
    v_and_b32 v87, 0xffff0000, v107
    v_lshlrev_b32_e64 v88, 16, v108
    v_and_b32 v92, 0xffff0000, v108
    v_lshlrev_b32_e64 v89, 16, v109
    v_and_b32 v93, 0xffff0000, v109
    v_lshlrev_b32_e64 v90, 16, v110
    v_and_b32 v94, 0xffff0000, v110
    v_lshlrev_b32_e64 v91, 16, v111
    v_and_b32 v95, 0xffff0000, v111
    s_waitcnt lgkmcnt(0) vmcnt(12)
    s_barrier
    ds_read_b64 v[112:113], v254 offset:0
    ds_read_b64 v[114:115], v254 offset:128
    ds_read_b64 v[116:117], v254 offset:256
    ds_read_b64 v[118:119], v254 offset:384
    ds_read_b64 v[120:121], v254 offset:2048
    ds_read_b64 v[122:123], v254 offset:2176
    ds_read_b64 v[124:125], v254 offset:2304
    ds_read_b64 v[126:127], v254 offset:2432
    ds_read_b64 v[232:233], v228 offset:0
    ds_read_b64 v[234:235], v228 offset:2080
    ds_read_b64 v[236:237], v229 offset:512
    ds_read_b64 v[238:239], v229 offset:2592
    ds_read_b64 v[240:241], v229 offset:1024
    ds_read_b64 v[242:243], v229 offset:3104
    ds_read_b64 v[244:245], v229 offset:1536
    ds_read_b64 v[246:247], v229 offset:3616
    s_mul_i32 s35, s62, 2654435761
    s_add_u32 s35, s35, 2135587861
    s_cmp_eq_u32 s34, 0
    s_cselect_b32 s98, s35, 0
    s_cselect_b32 s99, 0, 2.0
    s_add_u32 m0, s37, 0
    s_nop 0
    buffer_load_dwordx4 v16, s[8:11], s36 offen offset:0  lds
    buffer_load_dwordx4 v17, s[8:11], s36 offen offset:1024  lds
    buffer_load_dwordx4 v18, s[8:11], s36 offen offset:2048  lds
    buffer_load_dwordx4 v19, s[8:11], s36 offen offset:3072  lds
    s_waitcnt lgkmcnt(12)
    v_dot2_f32_bf16 v184, v96, v112, 0
    v_dot2_f32_bf16 v185, v104, v112, 0
    v_dot2_f32_bf16 v184, v100, v113, v184
    v_dot2_f32_bf16 v185, v108, v113, v185
    v_dot2_f32_bf16 v184, v97, v114, v184
    v_dot2_f32_bf16 v185, v105, v114, v185
    v_dot2_f32_bf16 v184, v101, v115, v184
    v_dot2_f32_bf16 v185, v109, v115, v185
    v_dot2_f32_bf16 v184, v98, v116, v184
    v_dot2_f32_bf16 v185, v106, v116, v185
    v_dot2_f32_bf16 v184, v102, v117, v184
    v_dot2_f32_bf16 v185, v110, v117, v185
    v_dot2_f32_bf16 v184, v99, v118, v184
    v_dot2_f32_bf16 v185, v107, v118, v185
    v_dot2_f32_bf16 v184, v103, v119, v184
    v_dot2_f32_bf16 v185, v111, v119, v185
    s_waitcnt lgkmcnt(8)
    v_lshlrev_b32 v32, 16, v120
    v_and_b32 v36, 0xffff0000, v120
    v_add_f32_dpp v184, v184, v184 row_ror:8 row_mask:0xf bank_mask:0xf
    v_add_f32_dpp v185, v185, v185 row_ror:8 row_mask:0xf bank_mask:0xf
    v_lshlrev_b32_e64 v40, 16, v121
    v_add_f32_dpp v184, v184, v184 row_ror:4 row_mask:0xf bank_mask:0xf
    v_and_b32 v44, 0xffff0000, v121
    v_add_f32_dpp v185, v185, v185 row_ror:4 row_mask:0xf bank_mask:0xf
    v_lshlrev_b32_e64 v33, 16, v122
    v_add_f32_dpp v184, v184, v184 row_ror:2 row_mask:0xf bank_mask:0xf
    v_and_b32 v37, 0xffff0000, v122
    v_add_f32_dpp v185, v185, v185 row_ror:2 row_mask:0xf bank_mask:0xf
    v_lshlrev_b32_e64 v41, 16, v123
    v_add_f32_dpp v184, v184, v184 row_ror:1 row_mask:0xf bank_mask:0xf
    v_and_b32 v45, 0xffff0000, v123
    v_add_f32_dpp v185, v185, v185 row_ror:1 row_mask:0xf bank_mask:0xf
    v_lshlrev_b32 v34, 16, v124
    s_nop 0
    v_permlane32_swap_b32 v184, v185
    v_and_b32 v38, 0xffff0000, v124
    v_add_f32 v184, v184, v185
    v_lshlrev_b32 v42, 16, v125
    v_mov_b32 v185, v184
    v_and_b32 v46, 0xffff0000, v125
    s_nop 0
    v_permlane16_swap_b32 v184, v185
    v_lshlrev_b32 v35, 16, v126
    v_add_f32 v184, v184, v185
    v_and_b32 v39, 0xffff0000, v126
    v_cvt_pk_bf16_f32 v184, v184, v184
    v_lshlrev_b32 v43, 16, v127
    v_lshlrev_b32 v184, 16, v184
    v_and_b32 v47, 0xffff0000, v127
    v_mul_f32 v184, 0xbfb8aa3b, v184
    v_pk_mul_f32 v[64:65], v[64:65], v[32:33]
    v_exp_f32 v184, v184
    s_nop 0
    v_add_f32_e64 v184, 1.0, v184
    v_pk_mul_f32 v[66:67], v[66:67], v[34:35]
    v_rcp_f32_e64 v184, v184
    s_bfe_u32 s36, s66, 262148
    s_add_u32 m0, s37, 32768
    s_lshl_b32 s36, s36, 7
    s_nop 0
    buffer_load_dwordx4 v16, s[8:11], s36 offen offset:0  lds
    buffer_load_dwordx4 v17, s[8:11], s36 offen offset:1024  lds
    buffer_load_dwordx4 v18, s[8:11], s36 offen offset:2048  lds
    buffer_load_dwordx4 v19, s[8:11], s36 offen offset:3072  lds
    v_pk_mul_f32 v[68:69], v[68:69], v[36:37]
    v_cvt_pk_bf16_f32 v184, v184, v184
    v_pk_mul_f32 v[70:71], v[70:71], v[38:39]
    v_lshlrev_b32_e64 v184, 16, v184
    v_pk_mul_f32 v[72:73], v[72:73], v[40:41]
    v_sub_f32_e64 v252, 1.0, v184
    v_pk_mul_f32 v[74:75], v[74:75], v[42:43]
    v_cvt_pk_bf16_f32 v252, v252, v252
    v_pk_mul_f32 v[76:77], v[76:77], v[44:45]
    v_lshlrev_b32_e64 v252, 16, v252
    v_pk_mul_f32 v[78:79], v[78:79], v[46:47]
    v_mov_b32_e64 v185, v184
    v_pk_mul_f32 v[80:81], v[80:81], v[32:33]
    v_mov_b32_e64 v253, v252
    v_pk_mul_f32 v[82:83], v[82:83], v[34:35]
    v_permlane32_swap_b32 v184, v185
    v_pk_mul_f32 v[84:85], v[84:85], v[36:37]
    v_permlane32_swap_b32 v252, v253
    v_pk_mul_f32 v[86:87], v[86:87], v[38:39]
    v_cmp_gt_u32_e64 vcc, 8, v0
    v_pk_mul_f32 v[88:89], v[88:89], v[40:41]
    v_lshlrev_b32_e64 v254, 3, v0
    v_pk_mul_f32 v[90:91], v[90:91], v[42:43]
    v_accvgpr_write_b32 a168, v184
    v_pk_mul_f32 v[92:93], v[92:93], v[44:45]
    v_accvgpr_write_b32 a169, v185
    v_pk_mul_f32 v[94:95], v[94:95], v[46:47]
    v_cndmask_b32_e64 v254, 2.0, v254, vcc
    v_pk_mul_f32 v[64:65], v[64:65], v[252:253] op_sel_hi:[1,0]
    v_pk_mul_f32 v[66:67], v[66:67], v[252:253] op_sel_hi:[1,0]
    v_pk_mul_f32 v[68:69], v[68:69], v[252:253] op_sel_hi:[1,0]
    v_pk_mul_f32 v[70:71], v[70:71], v[252:253] op_sel_hi:[1,0]
    v_cvt_pk_bf16_f32 v190, v64, v68
    v_accvgpr_write_b32 a152, v190
    v_cvt_pk_bf16_f32 v191, v65, v69
    v_accvgpr_write_b32 a153, v191
    v_cvt_pk_bf16_f32 v190, v66, v70
    v_accvgpr_write_b32 a154, v190
    v_cvt_pk_bf16_f32 v191, v67, v71
    v_accvgpr_write_b32 a155, v191
    v_pk_mul_f32 v[72:73], v[72:73], v[252:253] op_sel_hi:[1,0]
    v_pk_mul_f32 v[74:75], v[74:75], v[252:253] op_sel_hi:[1,0]
    v_pk_mul_f32 v[76:77], v[76:77], v[252:253] op_sel_hi:[1,0]
    v_pk_mul_f32 v[78:79], v[78:79], v[252:253] op_sel_hi:[1,0]
    v_cvt_pk_bf16_f32 v190, v72, v76
    v_accvgpr_write_b32 a156, v190
    v_cvt_pk_bf16_f32 v191, v73, v77
    v_accvgpr_write_b32 a157, v191
    v_cvt_pk_bf16_f32 v190, v74, v78
    v_accvgpr_write_b32 a158, v190
    v_cvt_pk_bf16_f32 v191, v75, v79
    v_accvgpr_write_b32 a159, v191
    v_pk_mul_f32 v[80:81], v[80:81], v[252:253] op_sel:[0,1]
    v_pk_mul_f32 v[82:83], v[82:83], v[252:253] op_sel:[0,1]
    v_pk_mul_f32 v[84:85], v[84:85], v[252:253] op_sel:[0,1]
    s_add_u32 m0, s37, 49152
    s_nop 0
    s_nop 0
    buffer_load_dwordx4 v20, s[12:15], s36 offen offset:0  lds
    buffer_load_dwordx4 v21, s[12:15], s36 offen offset:1024  lds
    buffer_load_dwordx4 v22, s[12:15], s36 offen offset:2048  lds
    buffer_load_dwordx4 v23, s[12:15], s36 offen offset:3072  lds
    v_pk_mul_f32 v[86:87], v[86:87], v[252:253] op_sel:[0,1]
    v_cvt_pk_bf16_f32 v190, v80, v84
    v_accvgpr_write_b32 a160, v190
    v_cvt_pk_bf16_f32 v191, v81, v85
    v_accvgpr_write_b32 a161, v191
    v_cvt_pk_bf16_f32 v190, v82, v86
    v_accvgpr_write_b32 a162, v190
    v_cvt_pk_bf16_f32 v191, v83, v87
    v_accvgpr_write_b32 a163, v191
    v_pk_mul_f32 v[88:89], v[88:89], v[252:253] op_sel:[0,1]
    v_pk_mul_f32 v[90:91], v[90:91], v[252:253] op_sel:[0,1]
    v_pk_mul_f32 v[92:93], v[92:93], v[252:253] op_sel:[0,1]
    v_pk_mul_f32 v[94:95], v[94:95], v[252:253] op_sel:[0,1]
    v_cvt_pk_bf16_f32 v190, v88, v92
    v_accvgpr_write_b32 a164, v190
    v_cvt_pk_bf16_f32 v191, v89, v93
    v_accvgpr_write_b32 a165, v191
    v_cvt_pk_bf16_f32 v190, v90, v94
    v_accvgpr_write_b32 a166, v190
    v_cvt_pk_bf16_f32 v191, v91, v95
    v_accvgpr_write_b32 a167, v191
    v_cos_f32 v10, v6
    v_cos_f32 v11, v7
    v_sin_f32 v12, v4
    v_sin_f32 v13, v5
    v_sin_f32 v14, v6
    v_sin_f32 v15, v7
    v_cvt_pk_bf16_f32 v4, v8, v12
    v_cvt_pk_bf16_f32 v5, -v12, v8
    v_accvgpr_write_b32 a0, v4
    v_accvgpr_write_b32 a4, v5
    v_xor_b32 v4, v147, v4
    v_xor_b32 v5, v147, v5
    v_accvgpr_write_b32 a16, v4
    v_accvgpr_write_b32 a20, v5
    v_cvt_pk_bf16_f32 v4, v9, v13
    v_cvt_pk_bf16_f32 v5, -v13, v9
    v_accvgpr_write_b32 a1, v4
    v_accvgpr_write_b32 a5, v5
    v_xor_b32 v4, v147, v4
    v_xor_b32 v5, v147, v5
    v_accvgpr_write_b32 a17, v4
    v_accvgpr_write_b32 a21, v5
    v_cvt_pk_bf16_f32 v4, v10, v14
    v_cvt_pk_bf16_f32 v5, -v14, v10
    v_accvgpr_write_b32 a2, v4
    v_accvgpr_write_b32 a6, v5
    v_xor_b32 v4, v147, v4
    v_xor_b32 v5, v147, v5
    v_accvgpr_write_b32 a18, v4
    v_accvgpr_write_b32 a22, v5
    v_cvt_pk_bf16_f32 v4, v11, v15
    s_lshl2_add_u32 s3, s33, s34
    s_lshl_b32 s3, s3, 4
    v_add_lshl_u32 v145, v1, s3, 1
    s_nop 0
    global_load_ushort v142, v145, s[52:53]
    global_load_ushort v143, v145, s[54:55]
    global_load_ushort v144, v145, s[84:85]
    v_cvt_pk_bf16_f32 v5, -v15, v11
    v_accvgpr_write_b32 a3, v4
    v_accvgpr_write_b32 a7, v5
    v_xor_b32 v4, v147, v4
    v_xor_b32_e64 v5, v147, v5
    v_accvgpr_write_b32 a19, v4
    v_accvgpr_write_b32 a23, v5
    v_fmamk_f32 v4, v251, 0x41800000, v248
    v_fmamk_f32 v5, v251, 0x41880000, v248
    v_fmamk_f32 v6, v251, 0x41900000, v248
    v_fmamk_f32 v7, v251, 0x41980000, v248
    v_cos_f32 v8, v4
    v_cos_f32 v9, v5
    v_cos_f32 v10, v6
    v_cos_f32 v11, v7
    v_sin_f32 v12, v4
    v_sin_f32 v13, v5
    v_sin_f32 v14, v6
    v_sin_f32 v15, v7
    v_cvt_pk_bf16_f32 v4, v8, v12
    v_cvt_pk_bf16_f32 v5, -v12, v8
    v_accvgpr_write_b32 a8, v4
    v_accvgpr_write_b32 a12, v5
    v_xor_b32 v4, v147, v4
    v_xor_b32 v5, v147, v5
    v_accvgpr_write_b32 a24, v4
    v_accvgpr_write_b32 a28, v5
    v_cvt_pk_bf16_f32 v4, v9, v13
    v_cvt_pk_bf16_f32 v5, -v13, v9
    v_accvgpr_write_b32 a9, v4
    v_accvgpr_write_b32 a13, v5
    v_xor_b32_e64 v4, v147, v4
    s_bfe_u32 s36, s66, 262152
    s_add_u32 m0, s37, 65536
    s_lshl_b32 s36, s36, 7
    buffer_load_dwordx4 v16, s[8:11], s36 offen offset:0  lds
    buffer_load_dwordx4 v17, s[8:11], s36 offen offset:1024  lds
    buffer_load_dwordx4 v18, s[8:11], s36 offen offset:2048  lds
    buffer_load_dwordx4 v19, s[8:11], s36 offen offset:3072  lds
    v_xor_b32 v5, v147, v5
    v_accvgpr_write_b32 a25, v4
    v_accvgpr_write_b32 a29, v5
    v_cvt_pk_bf16_f32 v4, v10, v14
    v_cvt_pk_bf16_f32 v5, -v14, v10
    v_accvgpr_write_b32 a10, v4
    v_accvgpr_write_b32 a14, v5
    v_xor_b32 v4, v147, v4
    v_xor_b32 v5, v147, v5
    v_accvgpr_write_b32 a26, v4
    v_accvgpr_write_b32 a30, v5
    v_cvt_pk_bf16_f32 v4, v11, v15
    v_cvt_pk_bf16_f32 v5, -v15, v11
    v_accvgpr_write_b32 a11, v4
    v_accvgpr_write_b32 a15, v5
    v_xor_b32 v4, v147, v4
    v_xor_b32 v5, v147, v5
    v_accvgpr_write_b32 a27, v4
    v_accvgpr_write_b32 a31, v5
    s_add_u32 m0, s37, 81920
    s_nop 0
    buffer_load_dwordx4 v20, s[12:15], s36 offen offset:0  lds
    buffer_load_dwordx4 v21, s[12:15], s36 offen offset:1024  lds
    buffer_load_dwordx4 v22, s[12:15], s36 offen offset:2048  lds
    buffer_load_dwordx4 v23, s[12:15], s36 offen offset:3072  lds
    s_waitcnt lgkmcnt(0)
    s_waitcnt vmcnt(19)
    s_barrier
    ds_read_b128 a[64:67], v26 offset:0
    ds_read_b128 a[68:71], v26 offset:8192
    ds_read_b128 a[32:35], v24 offset:0
    ds_read_b128 a[36:39], v24 offset:2048
    ds_read_b128 a[40:43], v24 offset:4096
    ds_read_b128 a[44:47], v24 offset:6144
    ds_read_b128 a[48:51], v24 offset:8192
    ds_read_b128 a[52:55], v24 offset:10240
    ds_read_b128 a[56:59], v24 offset:12288
    ds_read_b128 a[60:63], v24 offset:14336
    s_bfe_u32 s36, s66, 262156
    s_add_u32 m0, s37, 98304
    s_lshl_b32 s36, s36, 7
    buffer_load_dwordx4 v16, s[8:11], s36 offen offset:0  lds
    buffer_load_dwordx4 v17, s[8:11], s36 offen offset:1024  lds
    buffer_load_dwordx4 v18, s[8:11], s36 offen offset:2048  lds
    s_waitcnt lgkmcnt(0)
    v_mfma_f32_16x16x32_bf16 v[32:35], a[32:35], a[64:67], 0
    ds_read_b128 a[104:107], v27 offset:0
    buffer_load_dwordx4 v19, s[8:11], s36 offen offset:3072  lds
    v_mfma_f32_16x16x32_bf16 v[36:39], a[32:35], a[68:71], 0
    ds_read_b128 a[108:111], v27 offset:8192
    v_mfma_f32_16x16x32_bf16 v[40:43], a[36:39], a[64:67], 0
    ds_read_b128 a[72:75], v25 offset:0
    s_add_u32 m0, s37, 114688
    v_mfma_f32_16x16x32_bf16 v[44:47], a[36:39], a[68:71], 0
    v_mfma_f32_16x16x32_bf16 v[48:51], a[40:43], a[64:67], 0
    ds_read_b128 a[76:79], v25 offset:2048
    v_mfma_f32_16x16x32_bf16 v[52:55], a[40:43], a[68:71], 0
    ds_read_b128 a[80:83], v25 offset:4096
    buffer_load_dwordx4 v20, s[12:15], s36 offen offset:0  lds
    v_mfma_f32_16x16x32_bf16 v[56:59], a[44:47], a[64:67], 0
    v_mfma_f32_16x16x32_bf16 v[60:63], a[44:47], a[68:71], 0
    ds_read_b128 a[84:87], v25 offset:6144
    v_mfma_f32_16x16x32_bf16 v[64:67], a[48:51], a[64:67], 0
    ds_read_b128 a[88:91], v25 offset:8192
    buffer_load_dwordx4 v21, s[12:15], s36 offen offset:1024  lds
    v_mfma_f32_16x16x32_bf16 v[68:71], a[48:51], a[68:71], 0
    ds_read_b128 a[92:95], v25 offset:10240
    v_mov_b32_e64 v28, s96
    v_mfma_f32_16x16x32_bf16 v[72:75], a[52:55], a[64:67], 0
    buffer_load_dwordx4 v22, s[12:15], s36 offen offset:2048  lds
    buffer_store_dword v28, v30, s[24:27], s70 offen sc1
    v_mfma_f32_16x16x32_bf16 v[76:79], a[52:55], a[68:71], 0
    ds_read_b128 a[96:99], v25 offset:12288
    buffer_store_dwordx2 v[252:253], v254, s[24:27], s69 offen sc1
    v_mfma_f32_16x16x32_bf16 v[80:83], a[56:59], a[64:67], 0
    ds_read_b128 a[100:103], v25 offset:14336
    v_mfma_f32_16x16x32_bf16 v[84:87], a[56:59], a[68:71], 0
    buffer_load_dwordx4 v23, s[12:15], s36 offen offset:3072  lds
    v_mfma_f32_16x16x32_bf16 v[88:91], a[60:63], a[64:67], 0
    v_mfma_f32_16x16x32_bf16 v[92:95], a[60:63], a[68:71], 0
    s_waitcnt lgkmcnt(0) vmcnt(21)
    s_barrier
    v_mfma_f32_16x16x32_bf16 v[32:35], a[72:75], a[104:107], v[32:35]
    ds_read_b128 a[64:67], v26 offset:32768
    s_bfe_u32 s36, s66, 262160
    s_mov_b32 s76, 0x05040100
    v_mfma_f32_16x16x32_bf16 v[36:39], a[72:75], a[108:111], v[36:39]
    ds_read_b128 a[68:71], v26 offset:40960
    s_mov_b32 s77, 0x07060302
    s_lshl_b32 s38, s6, 4
    v_mfma_f32_16x16x32_bf16 v[40:43], a[76:79], a[104:107], v[40:43]
    ds_read_b128 a[32:35], v24 offset:32768
    s_add_u32 m0, s37, 0
    s_xor_b32 s39, s38, 16
    v_alignbit_b32 v196, v197, v196, s38
    v_mfma_f32_16x16x32_bf16 v[44:47], a[76:79], a[108:111], v[44:47]
    v_alignbit_b32 v197, v198, v197, s38
    v_mfma_f32_16x16x32_bf16 v[48:51], a[80:83], a[104:107], v[48:51]
    ds_read_b128 a[36:39], v24 offset:34816
    v_lshrrev_b32 v198, s38, v198
    v_alignbit_b32 v200, v201, v200, s38
    v_mfma_f32_16x16x32_bf16 v[52:55], a[80:83], a[108:111], v[52:55]
    ds_read_b128 a[40:43], v24 offset:36864
    s_lshl_b32 s36, s36, 7
    v_alignbit_b32 v201, v202, v201, s38
    v_lshrrev_b32 v202, s38, v202
    v_mfma_f32_16x16x32_bf16 v[56:59], a[84:87], a[104:107], v[56:59]
    v_alignbit_b32 v204, v205, v204, s39
    v_alignbit_b32 v205, v206, v205, s39
    v_mfma_f32_16x16x32_bf16 v[60:63], a[84:87], a[108:111], v[60:63]
    ds_read_b128 a[44:47], v24 offset:38912
    v_alignbit_b32 v208, v209, v208, s39
    v_mfma_f32_16x16x32_bf16 v[64:67], a[88:91], a[104:107], v[64:67]
    ds_read_b128 a[48:51], v24 offset:40960
    buffer_load_dwordx4 v16, s[8:11], s36 offen offset:0  lds
    v_alignbit_b32 v209, v210, v209, s39
    v_alignbit_b32 v212, v213, v212, s38
    v_mfma_f32_16x16x32_bf16 v[68:71], a[88:91], a[108:111], v[68:71]
    ds_read_b128 a[52:55], v24 offset:43008
    buffer_store_dwordx4 v[232:235], v230, s[28:31], s68 offen sc1
    v_alignbit_b32 v213, v214, v213, s38
    v_lshrrev_b32_e64 v214, s38, v214
    v_mfma_f32_16x16x32_bf16 v[72:75], a[92:95], a[104:107], v[72:75]
    buffer_load_dwordx4 v17, s[8:11], s36 offen offset:1024  lds
    s_add_u32 s68, s68, 2097152
    v_alignbit_b32 v216, v217, v216, s38
    v_alignbit_b32 v217, v218, v217, s38
    v_mfma_f32_16x16x32_bf16 v[76:79], a[92:95], a[108:111], v[76:79]
    ds_read_b128 a[56:59], v24 offset:45056
    v_lshrrev_b32_e64 v218, s38, v218
    v_mfma_f32_16x16x32_bf16 v[80:83], a[96:99], a[104:107], v[80:83]
    ds_read_b128 a[60:63], v24 offset:47104
    v_alignbit_b32 v220, v221, v220, s39
    v_alignbit_b32 v221, v222, v221, s39
    v_mfma_f32_16x16x32_bf16 v[84:87], a[96:99], a[108:111], v[84:87]
    buffer_load_dwordx4 v18, s[8:11], s36 offen offset:2048  lds
    v_alignbit_b32 v224, v225, v224, s39
    v_alignbit_b32 v225, v226, v225, s39
    v_mfma_f32_16x16x32_bf16 v[88:91], a[100:103], a[104:107], v[88:91]
    v_perm_b32 v184, v202, v198, s76
    v_perm_b32 v186, v218, v214, s76
    v_mfma_f32_16x16x32_bf16 v[92:95], a[100:103], a[108:111], v[92:95]
    ds_write_b128 v194, v[184:187] offset:16384
    s_waitcnt lgkmcnt(1)
    v_mfma_f32_16x16x32_bf16 v[32:35], a[32:35], a[64:67], v[32:35]
    ds_read_b128 a[104:107], v27 offset:32768
    buffer_load_dwordx4 v19, s[8:11], s36 offen offset:3072  lds
    v_perm_b32 v152, v200, v196, s76
    v_perm_b32 v153, v209, v205, s77
    v_mfma_f32_16x16x32_bf16 v[36:39], a[32:35], a[68:71], v[36:39]
    ds_read_b128 a[108:111], v27 offset:40960
    v_perm_b32 v154, v216, v212, s76
    v_perm_b32 v155, v225, v221, s77
    v_mfma_f32_16x16x32_bf16 v[40:43], a[36:39], a[64:67], v[40:43]
    ds_read_b128 a[72:75], v25 offset:32768
    s_add_u32 m0, s37, 16384
    ds_write_b128 v194, v[152:155] offset:0
    v_perm_b32 v156, v200, v196, s77
    v_mfma_f32_16x16x32_bf16 v[44:47], a[36:39], a[68:71], v[44:47]
    v_perm_b32 v157, v209, v205, s76
    v_perm_b32 v158, v216, v212, s77
    v_mfma_f32_16x16x32_bf16 v[48:51], a[40:43], a[64:67], v[48:51]
    ds_read_b128 a[76:79], v25 offset:34816
    v_perm_b32 v159, v225, v221, s76
    ds_write_b128 v194, v[156:159] offset:4096
    v_mfma_f32_16x16x32_bf16 v[52:55], a[40:43], a[68:71], v[52:55]
    ds_read_b128 a[80:83], v25 offset:36864
    buffer_load_dwordx4 v20, s[12:15], s36 offen offset:0  lds
    v_perm_b32 v160, v201, v197, s76
    v_mfma_f32_16x16x32_bf16 v[56:59], a[44:47], a[64:67], v[56:59]
    v_perm_b32 v161, v208, v204, s77
    v_perm_b32 v162, v217, v213, s76
    v_mfma_f32_16x16x32_bf16 v[60:63], a[44:47], a[68:71], v[60:63]
    ds_read_b128 a[84:87], v25 offset:38912
    v_perm_b32 v163, v224, v220, s77
    ds_write_b128 v194, v[160:163] offset:8192
    v_mfma_f32_16x16x32_bf16 v[64:67], a[48:51], a[64:67], v[64:67]
    ds_read_b128 a[88:91], v25 offset:40960
    buffer_load_dwordx4 v21, s[12:15], s36 offen offset:1024  lds
    v_perm_b32 v164, v201, v197, s77
    v_perm_b32 v165, v208, v204, s76
    v_mfma_f32_16x16x32_bf16 v[68:71], a[48:51], a[68:71], v[68:71]
    ds_read_b128 a[92:95], v25 offset:43008
    buffer_store_dwordx4 v[236:239], v230, s[28:31], s68 offen sc1
    v_perm_b32 v166, v217, v213, s77
    v_perm_b32 v167, v224, v220, s76
    v_mfma_f32_16x16x32_bf16 v[72:75], a[52:55], a[64:67], v[72:75]
    buffer_load_dwordx4 v22, s[12:15], s36 offen offset:2048  lds
    s_add_u32 s68, s68, 2097152
    ds_write_b128 v194, v[164:167] offset:12288
    v_mfma_f32_16x16x32_bf16 v[76:79], a[52:55], a[68:71], v[76:79]
    ds_read_b128 a[96:99], v25 offset:45056
    v_bfe_u32 v189, v0, 2, 2
    v_lshl_add_u32 v228, v189, 8, v231
    v_mfma_f32_16x16x32_bf16 v[80:83], a[56:59], a[64:67], v[80:83]
    ds_read_b128 a[100:103], v25 offset:47104
    v_lshl_add_u32 v189, v189, 12, v195
    v_xor_b32 v190, 0x1000, v189
    v_mfma_f32_16x16x32_bf16 v[84:87], a[56:59], a[68:71], v[84:87]
    buffer_load_dwordx4 v23, s[12:15], s36 offen offset:3072  lds
    v_xor_b32 v191, 0x2000, v189
    v_xor_b32 v192, 0x3000, v189
    v_mfma_f32_16x16x32_bf16 v[88:91], a[60:63], a[64:67], v[88:91]
    v_xor_b32 v229, 0x100, v228
    v_xor_b32 v231, 0x200, v228
    v_mfma_f32_16x16x32_bf16 v[92:95], a[60:63], a[68:71], v[92:95]
    v_xor_b32 v193, 0x300, v228
    s_waitcnt lgkmcnt(0) vmcnt(20)
    s_barrier
    v_mfma_f32_16x16x32_bf16 v[32:35], a[72:75], a[104:107], v[32:35]
    ds_read_b128 a[64:67], v150 offset:0
    s_bfe_u32 s36, s66, 262164
    ds_read_b128 v[184:187], v195 offset:16384
    ds_read_b128 v[168:171], v189
    v_mfma_f32_16x16x32_bf16 v[36:39], a[72:75], a[108:111], v[36:39]
    ds_read_b128 a[68:71], v150 offset:8192
    ds_read_b128 v[172:175], v190
    v_mfma_f32_16x16x32_bf16 v[40:43], a[76:79], a[104:107], v[40:43]
    ds_read_b128 a[32:35], v148 offset:0
    s_add_u32 m0, s37, 32768
    ds_read_b128 v[176:179], v191
    v_mfma_f32_16x16x32_bf16 v[44:47], a[76:79], a[108:111], v[44:47]
    ds_read_b128 v[180:183], v192
    v_mfma_f32_16x16x32_bf16 v[48:51], a[80:83], a[104:107], v[48:51]
    ds_read_b128 a[36:39], v148 offset:2048
    s_lshr_b32 s40, s2, 2
    v_mfma_f32_16x16x32_bf16 v[52:55], a[80:83], a[108:111], v[52:55]
    ds_read_b128 a[40:43], v148 offset:4096
    s_lshl_b32 s36, s36, 7
    s_lshl_b32 s41, s34, 9
    v_mfma_f32_16x16x32_bf16 v[56:59], a[84:87], a[104:107], v[56:59]
    s_add_u32 s40, s40, s41
    v_mfma_f32_16x16x32_bf16 v[60:63], a[84:87], a[108:111], v[60:63]
    ds_read_b128 a[44:47], v148 offset:6144
    s_add_u32 s40, s40, 64
    v_mfma_f32_16x16x32_bf16 v[64:67], a[88:91], a[104:107], v[64:67]
    ds_read_b128 a[48:51], v148 offset:8192
    buffer_load_dwordx4 v16, s[8:11], s36 offen offset:0  lds
    s_lshl_b32 s40, s40, 6
    s_and_b32 s41, s2, 3
    v_mfma_f32_16x16x32_bf16 v[68:71], a[88:91], a[108:111], v[68:71]
    ds_read_b128 a[52:55], v148 offset:10240
    s_add_u32 s40, s40, s41
    v_mfma_f32_16x16x32_bf16 v[72:75], a[92:95], a[104:107], v[72:75]
    buffer_load_dwordx4 v17, s[8:11], s36 offen offset:1024  lds
    s_lshl_b32 s76, s40, 6
    v_mfma_f32_16x16x32_bf16 v[76:79], a[92:95], a[108:111], v[76:79]
    ds_read_b128 a[56:59], v148 offset:12288
    s_lshl_b32 s40, s34, 10
    v_mfma_f32_16x16x32_bf16 v[80:83], a[96:99], a[104:107], v[80:83]
    ds_read_b128 a[60:63], v148 offset:14336
    v_add_u32 v188, s40, v3
    v_mfma_f32_16x16x32_bf16 v[84:87], a[96:99], a[108:111], v[84:87]
    buffer_load_dwordx4 v18, s[8:11], s36 offen offset:2048  lds
    v_subrev_u32 v188, 4032, v188
    v_mfma_f32_16x16x32_bf16 v[88:91], a[100:103], a[104:107], v[88:91]
    v_min_u32_e64 v188, 2.0, v188
    v_mfma_f32_16x16x32_bf16 v[92:95], a[100:103], a[108:111], v[92:95]
    s_lshl_b32 s77, s2, 6
    s_waitcnt lgkmcnt(0)
    v_mfma_f32_16x16x32_bf16 v[32:35], a[32:35], a[64:67], v[32:35]
    ds_read_b128 a[104:107], v151 offset:0
    buffer_load_dwordx4 v19, s[8:11], s36 offen offset:3072  lds
    s_and_b32 s38, s32, 3
    v_mfma_f32_16x16x32_bf16 v[36:39], a[32:35], a[68:71], v[36:39]
    ds_read_b128 a[108:111], v151 offset:8192
    s_mov_b32 s97, 1985229328
    v_mfma_f32_16x16x32_bf16 v[40:43], a[36:39], a[64:67], v[40:43]
    ds_read_b128 a[72:75], v149 offset:0
    s_add_u32 m0, s37, 49152
    s_cmp_eq_u32 s38, 1
    s_cselect_b32 s97, 561402928, s97
    v_mfma_f32_16x16x32_bf16 v[44:47], a[36:39], a[68:71], v[44:47]
    v_mfma_f32_16x16x32_bf16 v[48:51], a[40:43], a[64:67], v[48:51]
    ds_read_b128 a[76:79], v149 offset:2048
    s_cmp_eq_u32 s38, 2
    s_cselect_b32 s97, 1126266448, s97
    v_mfma_f32_16x16x32_bf16 v[52:55], a[40:43], a[68:71], v[52:55]
    ds_read_b128 a[80:83], v149 offset:4096
    buffer_load_dwordx4 v20, s[12:15], s36 offen offset:0  lds
    s_cmp_eq_u32 s38, 3
    s_cselect_b32 s97, 1698898288, s97
    v_mfma_f32_16x16x32_bf16 v[56:59], a[44:47], a[64:67], v[56:59]
    v_mfma_f32_16x16x32_bf16 v[60:63], a[44:47], a[68:71], v[60:63]
    ds_read_b128 a[84:87], v149 offset:6144
    s_lshr_b32 s38, s2, 5
    v_mfma_f32_16x16x32_bf16 v[64:67], a[48:51], a[64:67], v[64:67]
    ds_read_b128 a[88:91], v149 offset:8192
    buffer_load_dwordx4 v21, s[12:15], s36 offen offset:1024  lds
    s_mul_i32 s38, s38, 0x11111111
    v_mfma_f32_16x16x32_bf16 v[68:71], a[48:51], a[68:71], v[68:71]
    ds_read_b128 a[92:95], v149 offset:10240
    buffer_store_dwordx4 v[240:243], v230, s[28:31], s68 offen sc1
    v_mfma_f32_16x16x32_bf16 v[72:75], a[52:55], a[64:67], v[72:75]
    buffer_load_dwordx4 v22, s[12:15], s36 offen offset:2048  lds
    s_add_u32 s68, s68, 2097152
    s_add_u32 s97, s97, s38
    v_mfma_f32_16x16x32_bf16 v[76:79], a[52:55], a[68:71], v[76:79]
    ds_read_b128 a[96:99], v149 offset:12288
    s_and_b32 s97, s97, 0x77777777
    v_mfma_f32_16x16x32_bf16 v[80:83], a[56:59], a[64:67], v[80:83]
    ds_read_b128 a[100:103], v149 offset:14336
    v_mfma_f32_16x16x32_bf16 v[84:87], a[56:59], a[68:71], v[84:87]
    buffer_load_dwordx4 v23, s[12:15], s36 offen offset:3072  lds
    s_lshl_b32 s38, s33, 6
    v_mfma_f32_16x16x32_bf16 v[88:91], a[60:63], a[64:67], v[88:91]
    s_add_u32 s38, s38, s34
    v_mfma_f32_16x16x32_bf16 v[92:95], a[60:63], a[68:71], v[92:95]
    s_waitcnt lgkmcnt(0) vmcnt(19)
    s_barrier
    v_mfma_f32_16x16x32_bf16 v[32:35], a[72:75], a[104:107], v[32:35]
    ds_read_b128 a[64:67], v150 offset:32768
    s_bfe_u32 s36, s66, 262168
    s_lshl_b32 s38, s38, 8
    v_mfma_f32_16x16x32_bf16 v[36:39], a[72:75], a[108:111], v[36:39]
    ds_read_b128 a[68:71], v150 offset:40960
    s_add_u32 s93, s38, 22020096
    v_mfma_f32_16x16x32_bf16 v[40:43], a[76:79], a[104:107], v[40:43]
    ds_read_b128 a[32:35], v148 offset:32768
    s_add_u32 m0, s37, 65536
    s_lshl_b32 s38, s32, 11
    v_mfma_f32_16x16x32_bf16 v[44:47], a[76:79], a[108:111], v[44:47]
    v_mfma_f32_16x16x32_bf16 v[48:51], a[80:83], a[104:107], v[48:51]
    ds_read_b128 a[36:39], v148 offset:34816
    s_add_u32 s38, s38, s33
    v_mfma_f32_16x16x32_bf16 v[52:55], a[80:83], a[108:111], v[52:55]
    ds_read_b128 a[40:43], v148 offset:36864
    s_lshl_b32 s36, s36, 7
    s_lshl_b32 s5, s38, 8
    v_mfma_f32_16x16x32_bf16 v[56:59], a[84:87], a[104:107], v[56:59]
    v_mfma_f32_16x16x32_bf16 v[60:63], a[84:87], a[108:111], v[60:63]
    ds_read_b128 a[44:47], v148 offset:38912
    s_lshl_b32 s38, s94, 16
    v_mfma_f32_16x16x32_bf16 v[64:67], a[88:91], a[104:107], v[64:67]
    ds_read_b128 a[48:51], v148 offset:40960
    buffer_load_dwordx4 v16, s[8:11], s36 offen offset:0  lds
    s_andn2_b32 s95, s5, 0x700
    v_mfma_f32_16x16x32_bf16 v[68:71], a[88:91], a[108:111], v[68:71]
    ds_read_b128 a[52:55], v148 offset:43008
    buffer_store_dwordx4 v[244:247], v230, s[28:31], s68 offen sc1
    v_mfma_f32_16x16x32_bf16 v[72:75], a[92:95], a[104:107], v[72:75]
    buffer_load_dwordx4 v17, s[8:11], s36 offen offset:1024  lds
    s_add_u32 s95, s95, s38
    v_mfma_f32_16x16x32_bf16 v[76:79], a[92:95], a[108:111], v[76:79]
    ds_read_b128 a[56:59], v148 offset:45056
    s_cmp_lt_u32 s34, 2
    s_cselect_b64 s[16:17], s[80:81], s[82:83]
    v_mfma_f32_16x16x32_bf16 v[80:83], a[96:99], a[104:107], v[80:83]
    ds_read_b128 a[60:63], v148 offset:47104
    v_mfma_f32_16x16x32_bf16 v[84:87], a[96:99], a[108:111], v[84:87]
    buffer_load_dwordx4 v18, s[8:11], s36 offen offset:2048  lds
    s_mov_b32 s18, 0x200000
    v_mfma_f32_16x16x32_bf16 v[88:91], a[100:103], a[104:107], v[88:91]
    v_mfma_f32_16x16x32_bf16 v[92:95], a[100:103], a[108:111], v[92:95]
    s_waitcnt lgkmcnt(0)
    v_mfma_f32_16x16x32_bf16 v[32:35], a[32:35], a[64:67], v[32:35]
    ds_read_b128 a[104:107], v151 offset:32768
    buffer_load_dwordx4 v19, s[8:11], s36 offen offset:3072  lds
    v_lshlrev_b32_e64 v144, 16, v144
    v_mfma_f32_16x16x32_bf16 v[36:39], a[32:35], a[68:71], v[36:39]
    ds_read_b128 a[108:111], v151 offset:40960
    v_lshlrev_b32_e64 v142, 16, v142
    v_mfma_f32_16x16x32_bf16 v[40:43], a[36:39], a[64:67], v[40:43]
    ds_read_b128 a[72:75], v149 offset:32768
    s_add_u32 m0, s37, 81920
    v_mul_f32 v144, 0x3fb8aa3b, v144
    v_mfma_f32_16x16x32_bf16 v[44:47], a[36:39], a[68:71], v[44:47]
    v_mfma_f32_16x16x32_bf16 v[48:51], a[40:43], a[64:67], v[48:51]
    ds_read_b128 a[76:79], v149 offset:34816
    v_exp_f32_e64 v144, v144
    v_mfma_f32_16x16x32_bf16 v[52:55], a[40:43], a[68:71], v[52:55]
    ds_read_b128 a[80:83], v149 offset:36864
    buffer_load_dwordx4 v20, s[12:15], s36 offen offset:0  lds
    v_lshlrev_b32_e64 v143, 16, v143
    v_mfma_f32_16x16x32_bf16 v[56:59], a[44:47], a[64:67], v[56:59]
    v_mfma_f32_16x16x32_bf16 v[60:63], a[44:47], a[68:71], v[60:63]
    ds_read_b128 a[84:87], v149 offset:38912
    v_cvt_pk_bf16_f32 v144, v144, v144
    v_mfma_f32_16x16x32_bf16 v[64:67], a[48:51], a[64:67], v[64:67]
    ds_read_b128 a[88:91], v149 offset:40960
    buffer_load_dwordx4 v21, s[12:15], s36 offen offset:1024  lds
    v_lshlrev_b32_e64 v144, 16, v144
    v_mfma_f32_16x16x32_bf16 v[68:71], a[48:51], a[68:71], v[68:71]
    ds_read_b128 a[92:95], v149 offset:43008
    v_mfma_f32_16x16x32_bf16 v[72:75], a[52:55], a[64:67], v[72:75]
    buffer_load_dwordx4 v22, s[12:15], s36 offen offset:2048  lds
    buffer_store_dwordx4 v[184:187], v188, s[24:27], s77 offen sc1
    v_mul_f32_e64 v14, v144, v142
    v_mfma_f32_16x16x32_bf16 v[76:79], a[52:55], a[68:71], v[76:79]
    ds_read_b128 a[96:99], v149 offset:45056
    v_mul_f32_e64 v4, v144, v143
    v_mfma_f32_16x16x32_bf16 v[80:83], a[56:59], a[64:67], v[80:83]
    ds_read_b128 a[100:103], v149 offset:47104
    v_mfma_f32_16x16x32_bf16 v[84:87], a[56:59], a[68:71], v[84:87]
    buffer_load_dwordx4 v23, s[12:15], s36 offen offset:3072  lds
    v_mul_f32 v14, 0x3fb8aa3b, v14
    v_mfma_f32_16x16x32_bf16 v[88:91], a[60:63], a[64:67], v[88:91]
    v_mul_f32_e64 v4, 0x3e22f983, v4
    v_mfma_f32_16x16x32_bf16 v[92:95], a[60:63], a[68:71], v[92:95]
    s_waitcnt lgkmcnt(0) vmcnt(19)
    s_barrier
    v_mfma_f32_16x16x32_bf16 v[32:35], a[72:75], a[104:107], v[32:35]
    ds_read_b128 a[64:67], v26 offset:0
    s_bfe_u32 s36, s66, 262172
    v_exp_f32_e64 v14, v14
    v_mfma_f32_16x16x32_bf16 v[36:39], a[72:75], a[108:111], v[36:39]
    ds_read_b128 a[68:71], v26 offset:8192
    v_fract_f32_e64 v4, v4
    v_mfma_f32_16x16x32_bf16 v[40:43], a[76:79], a[104:107], v[40:43]
    ds_read_b128 a[32:35], v24 offset:0
    s_add_u32 m0, s37, 98304
    v_cos_f32_e64 v5, v4
    v_mfma_f32_16x16x32_bf16 v[44:47], a[76:79], a[108:111], v[44:47]
    v_mfma_f32_16x16x32_bf16 v[48:51], a[80:83], a[104:107], v[48:51]
    ds_read_b128 a[36:39], v24 offset:2048
    v_sin_f32_e64 v6, v4
    v_mfma_f32_16x16x32_bf16 v[52:55], a[80:83], a[108:111], v[52:55]
    ds_read_b128 a[40:43], v24 offset:4096
    s_lshl_b32 s36, s36, 7
    v_mul_f32 v128, v14, v5
    v_mfma_f32_16x16x32_bf16 v[56:59], a[84:87], a[104:107], v[56:59]
    v_mfma_f32_16x16x32_bf16 v[60:63], a[84:87], a[108:111], v[60:63]
    ds_read_b128 a[44:47], v24 offset:6144
    v_mul_f32_e64 v129, v14, v6
    v_mfma_f32_16x16x32_bf16 v[64:67], a[88:91], a[104:107], v[64:67]
    ds_read_b128 a[48:51], v24 offset:8192
    buffer_load_dwordx4 v16, s[8:11], s36 offen offset:0  lds
    v_mul_f32_e64 v14, v142, v142
    v_mfma_f32_16x16x32_bf16 v[68:71], a[88:91], a[108:111], v[68:71]
    ds_read_b128 a[52:55], v24 offset:10240
    v_mfma_f32_16x16x32_bf16 v[72:75], a[92:95], a[104:107], v[72:75]
    buffer_load_dwordx4 v17, s[8:11], s36 offen offset:1024  lds
    v_fma_f32 v14, v143, v143, v14
    v_mfma_f32_16x16x32_bf16 v[76:79], a[92:95], a[108:111], v[76:79]
    ds_read_b128 a[56:59], v24 offset:12288
    v_rcp_f32_e64 v14, v14
    v_mfma_f32_16x16x32_bf16 v[80:83], a[96:99], a[104:107], v[80:83]
    ds_read_b128 a[60:63], v24 offset:14336
    v_mfma_f32_16x16x32_bf16 v[84:87], a[96:99], a[108:111], v[84:87]
    buffer_load_dwordx4 v18, s[8:11], s36 offen offset:2048  lds
    v_add_f32_e64 v4, -1.0, v128
    v_mfma_f32_16x16x32_bf16 v[88:91], a[100:103], a[104:107], v[88:91]
    v_add_f32_e64 v14, v14, v14
    v_mfma_f32_16x16x32_bf16 v[92:95], a[100:103], a[108:111], v[92:95]
    s_waitcnt lgkmcnt(0)
    v_mfma_f32_16x16x32_bf16 v[32:35], a[32:35], a[64:67], v[32:35]
    ds_read_b128 a[104:107], v27 offset:0
    buffer_load_dwordx4 v19, s[8:11], s36 offen offset:3072  lds
    v_mul_f32 v5, v4, v142
    v_mfma_f32_16x16x32_bf16 v[36:39], a[32:35], a[68:71], v[36:39]
    ds_read_b128 a[108:111], v27 offset:8192
    v_fma_f32 v5, v129, v143, v5
    v_mfma_f32_16x16x32_bf16 v[40:43], a[36:39], a[64:67], v[40:43]
    ds_read_b128 a[72:75], v25 offset:0
    s_add_u32 m0, s37, 114688
    v_mul_f32_e64 v6, v129, v142
    v_mfma_f32_16x16x32_bf16 v[44:47], a[36:39], a[68:71], v[44:47]
    v_mfma_f32_16x16x32_bf16 v[48:51], a[40:43], a[64:67], v[48:51]
    ds_read_b128 a[76:79], v25 offset:2048
    v_fma_f32 v6, -v4, v143, v6
    v_mfma_f32_16x16x32_bf16 v[52:55], a[40:43], a[68:71], v[52:55]
    ds_read_b128 a[80:83], v25 offset:4096
    buffer_load_dwordx4 v20, s[12:15], s36 offen offset:0  lds
    v_mul_f32_e64 v130, v5, v14
    v_mfma_f32_16x16x32_bf16 v[56:59], a[44:47], a[64:67], v[56:59]
    v_mfma_f32_16x16x32_bf16 v[60:63], a[44:47], a[68:71], v[60:63]
    ds_read_b128 a[84:87], v25 offset:6144
    v_mul_f32_e64 v131, v6, v14
    v_mfma_f32_16x16x32_bf16 v[64:67], a[48:51], a[64:67], v[64:67]
    ds_read_b128 a[88:91], v25 offset:8192
    buffer_load_dwordx4 v21, s[12:15], s36 offen offset:1024  lds
    v_mul_f32_e64 v4, v128, v128
    v_mfma_f32_16x16x32_bf16 v[68:71], a[48:51], a[68:71], v[68:71]
    ds_read_b128 a[92:95], v25 offset:10240
    v_mfma_f32_16x16x32_bf16 v[72:75], a[52:55], a[64:67], v[72:75]
    buffer_load_dwordx4 v22, s[12:15], s36 offen offset:2048  lds
    buffer_store_dwordx4 v[168:171], v228, s[28:31], s76 offen sc1
    v_mul_f32_e64 v5, v128, v129
    v_mfma_f32_16x16x32_bf16 v[76:79], a[52:55], a[68:71], v[76:79]
    ds_read_b128 a[96:99], v25 offset:12288
    v_fma_f32 v4, -v129, v129, v4
    v_mfma_f32_16x16x32_bf16 v[80:83], a[56:59], a[64:67], v[80:83]
    ds_read_b128 a[100:103], v25 offset:14336
    v_mfma_f32_16x16x32_bf16 v[84:87], a[56:59], a[68:71], v[84:87]
    buffer_load_dwordx4 v23, s[12:15], s36 offen offset:3072  lds
    v_add_f32_e64 v5, v5, v5
    v_mfma_f32_16x16x32_bf16 v[88:91], a[60:63], a[64:67], v[88:91]
    v_mul_f32_e64 v6, v4, v4
    v_mfma_f32_16x16x32_bf16 v[92:95], a[60:63], a[68:71], v[92:95]
    s_waitcnt lgkmcnt(0) vmcnt(19)
    s_barrier
    v_mfma_f32_16x16x32_bf16 v[32:35], a[72:75], a[104:107], v[32:35]
    ds_read_b128 a[64:67], v26 offset:32768
    s_bfe_u32 s36, s67, 262144
    v_mul_f32_e64 v7, v4, v5
    v_mfma_f32_16x16x32_bf16 v[36:39], a[72:75], a[108:111], v[36:39]
    ds_read_b128 a[68:71], v26 offset:40960
    v_fma_f32 v6, -v5, v5, v6
    v_mfma_f32_16x16x32_bf16 v[40:43], a[76:79], a[104:107], v[40:43]
    ds_read_b128 a[32:35], v24 offset:32768
    s_add_u32 m0, s37, 0
    v_add_f32 v7, v7, v7
    v_mfma_f32_16x16x32_bf16 v[44:47], a[76:79], a[108:111], v[44:47]
    v_mfma_f32_16x16x32_bf16 v[48:51], a[80:83], a[104:107], v[48:51]
    ds_read_b128 a[36:39], v24 offset:34816
    v_mul_f32_e64 v4, v6, v6
    v_mfma_f32_16x16x32_bf16 v[52:55], a[80:83], a[108:111], v[52:55]
    ds_read_b128 a[40:43], v24 offset:36864
    s_lshl_b32 s36, s36, 7
    v_mul_f32 v5, v6, v7
    v_mfma_f32_16x16x32_bf16 v[56:59], a[84:87], a[104:107], v[56:59]
    v_mfma_f32_16x16x32_bf16 v[60:63], a[84:87], a[108:111], v[60:63]
    ds_read_b128 a[44:47], v24 offset:38912
    v_fma_f32 v4, -v7, v7, v4
    v_mfma_f32_16x16x32_bf16 v[64:67], a[88:91], a[104:107], v[64:67]
    ds_read_b128 a[48:51], v24 offset:40960
    buffer_load_dwordx4 v16, s[8:11], s36 offen offset:0  lds
    v_add_f32_e64 v5, v5, v5
    v_mfma_f32_16x16x32_bf16 v[68:71], a[88:91], a[108:111], v[68:71]
    ds_read_b128 a[52:55], v24 offset:43008
    v_mfma_f32_16x16x32_bf16 v[72:75], a[92:95], a[104:107], v[72:75]
    buffer_load_dwordx4 v17, s[8:11], s36 offen offset:1024  lds
    buffer_store_dwordx4 v[172:175], v229, s[28:31], s76 offen sc1
    v_mul_f32_e64 v132, v4, v4
    v_mfma_f32_16x16x32_bf16 v[76:79], a[92:95], a[108:111], v[76:79]
    ds_read_b128 a[56:59], v24 offset:45056
    v_mul_f32_e64 v133, v4, v5
    v_mfma_f32_16x16x32_bf16 v[80:83], a[96:99], a[104:107], v[80:83]
    ds_read_b128 a[60:63], v24 offset:47104
    v_mfma_f32_16x16x32_bf16 v[84:87], a[96:99], a[108:111], v[84:87]
    buffer_load_dwordx4 v18, s[8:11], s36 offen offset:2048  lds
    v_fma_f32 v132, -v5, v5, v132
    v_mfma_f32_16x16x32_bf16 v[88:91], a[100:103], a[104:107], v[88:91]
    v_add_f32_e64 v133, v133, v133
    v_mfma_f32_16x16x32_bf16 v[92:95], a[100:103], a[108:111], v[92:95]
    s_waitcnt lgkmcnt(0)
    v_mfma_f32_16x16x32_bf16 v[32:35], a[32:35], a[64:67], v[32:35]
    ds_read_b128 a[104:107], v27 offset:32768
    buffer_load_dwordx4 v19, s[8:11], s36 offen offset:3072  lds
    v_mul_f32 v134, v132, v132
    v_mfma_f32_16x16x32_bf16 v[36:39], a[32:35], a[68:71], v[36:39]
    ds_read_b128 a[108:111], v27 offset:40960
    v_mul_f32_e64 v135, v132, v133
    v_mfma_f32_16x16x32_bf16 v[40:43], a[36:39], a[64:67], v[40:43]
    ds_read_b128 a[72:75], v25 offset:32768
    s_add_u32 m0, s37, 16384
    v_fma_f32 v134, -v133, v133, v134
    v_mfma_f32_16x16x32_bf16 v[44:47], a[36:39], a[68:71], v[44:47]
    v_mfma_f32_16x16x32_bf16 v[48:51], a[40:43], a[64:67], v[48:51]
    ds_read_b128 a[76:79], v25 offset:34816
    v_add_f32_e64 v135, v135, v135
    v_mfma_f32_16x16x32_bf16 v[52:55], a[40:43], a[68:71], v[52:55]
    ds_read_b128 a[80:83], v25 offset:36864
    buffer_load_dwordx4 v20, s[12:15], s36 offen offset:0  lds
    v_mul_f32_e64 v8, v134, v134
    v_mfma_f32_16x16x32_bf16 v[56:59], a[44:47], a[64:67], v[56:59]
    v_mfma_f32_16x16x32_bf16 v[60:63], a[44:47], a[68:71], v[60:63]
    ds_read_b128 a[84:87], v25 offset:38912
    v_mul_f32_e64 v9, v134, v135
    v_mfma_f32_16x16x32_bf16 v[64:67], a[48:51], a[64:67], v[64:67]
    ds_read_b128 a[88:91], v25 offset:40960
    buffer_load_dwordx4 v21, s[12:15], s36 offen offset:1024  lds
    v_fma_f32 v8, -v135, v135, v8
    v_mfma_f32_16x16x32_bf16 v[68:71], a[48:51], a[68:71], v[68:71]
    ds_read_b128 a[92:95], v25 offset:43008
    v_mfma_f32_16x16x32_bf16 v[72:75], a[52:55], a[64:67], v[72:75]
    buffer_load_dwordx4 v22, s[12:15], s36 offen offset:2048  lds
    buffer_store_dwordx4 v[176:179], v231, s[28:31], s76 offen sc1
    v_add_f32_e64 v9, v9, v9
    v_mfma_f32_16x16x32_bf16 v[76:79], a[52:55], a[68:71], v[76:79]
    ds_read_b128 a[96:99], v25 offset:45056
    v_mul_f32_e64 v136, v8, v8
    v_mfma_f32_16x16x32_bf16 v[80:83], a[56:59], a[64:67], v[80:83]
    ds_read_b128 a[100:103], v25 offset:47104
    v_mfma_f32_16x16x32_bf16 v[84:87], a[56:59], a[68:71], v[84:87]
    buffer_load_dwordx4 v23, s[12:15], s36 offen offset:3072  lds
    v_mul_f32_e64 v137, v8, v9
    v_mfma_f32_16x16x32_bf16 v[88:91], a[60:63], a[64:67], v[88:91]
    v_fma_f32 v136, -v9, v9, v136
    v_mfma_f32_16x16x32_bf16 v[92:95], a[60:63], a[68:71], v[92:95]
    s_waitcnt lgkmcnt(0) vmcnt(19)
    s_barrier
    v_mfma_f32_16x16x32_bf16 v[32:35], a[72:75], a[104:107], v[32:35]
    ds_read_b128 a[64:67], v150 offset:0
    s_bfe_u32 s36, s67, 262148
    v_add_f32_e64 v137, v137, v137
    v_mfma_f32_16x16x32_bf16 v[36:39], a[72:75], a[108:111], v[36:39]
    ds_read_b128 a[68:71], v150 offset:8192
    v_mul_f32_e64 v4, v136, v136
    v_mfma_f32_16x16x32_bf16 v[40:43], a[76:79], a[104:107], v[40:43]
    ds_read_b128 a[32:35], v148 offset:0
    s_add_u32 m0, s37, 32768
    v_mul_f32_e64 v5, v136, v137
    v_mfma_f32_16x16x32_bf16 v[44:47], a[76:79], a[108:111], v[44:47]
    v_mfma_f32_16x16x32_bf16 v[48:51], a[80:83], a[104:107], v[48:51]
    ds_read_b128 a[36:39], v148 offset:2048
    v_fma_f32 v4, -v137, v137, v4
    v_mfma_f32_16x16x32_bf16 v[52:55], a[80:83], a[108:111], v[52:55]
    ds_read_b128 a[40:43], v148 offset:4096
    s_lshl_b32 s36, s36, 7
    v_add_f32 v5, v5, v5
    v_mfma_f32_16x16x32_bf16 v[56:59], a[84:87], a[104:107], v[56:59]
    v_mfma_f32_16x16x32_bf16 v[60:63], a[84:87], a[108:111], v[60:63]
    ds_read_b128 a[44:47], v148 offset:6144
    v_mul_f32_e64 v10, v4, v4
    v_mfma_f32_16x16x32_bf16 v[64:67], a[88:91], a[104:107], v[64:67]
    ds_read_b128 a[48:51], v148 offset:8192
    buffer_load_dwordx4 v16, s[8:11], s36 offen offset:0  lds
    v_mul_f32_e64 v11, v4, v5
    v_mfma_f32_16x16x32_bf16 v[68:71], a[88:91], a[108:111], v[68:71]
    ds_read_b128 a[52:55], v148 offset:10240
    v_mfma_f32_16x16x32_bf16 v[72:75], a[92:95], a[104:107], v[72:75]
    buffer_load_dwordx4 v17, s[8:11], s36 offen offset:1024  lds
    v_fma_f32 v10, -v5, v5, v10
    v_mfma_f32_16x16x32_bf16 v[76:79], a[92:95], a[108:111], v[76:79]
    ds_read_b128 a[56:59], v148 offset:12288
    v_add_f32_e64 v11, v11, v11
    v_mfma_f32_16x16x32_bf16 v[80:83], a[96:99], a[104:107], v[80:83]
    ds_read_b128 a[60:63], v148 offset:14336
    v_mfma_f32_16x16x32_bf16 v[84:87], a[96:99], a[108:111], v[84:87]
    buffer_load_dwordx4 v18, s[8:11], s36 offen offset:2048  lds
    v_mul_f32_e64 v12, v10, v10
    v_mfma_f32_16x16x32_bf16 v[88:91], a[100:103], a[104:107], v[88:91]
    v_mul_f32_e64 v13, v10, v11
    v_mfma_f32_16x16x32_bf16 v[92:95], a[100:103], a[108:111], v[92:95]
    s_waitcnt lgkmcnt(0)
    v_mfma_f32_16x16x32_bf16 v[32:35], a[32:35], a[64:67], v[32:35]
    ds_read_b128 a[104:107], v151 offset:0
    buffer_load_dwordx4 v19, s[8:11], s36 offen offset:3072  lds
    v_fma_f32 v12, -v11, v11, v12
    v_mfma_f32_16x16x32_bf16 v[36:39], a[32:35], a[68:71], v[36:39]
    ds_read_b128 a[108:111], v151 offset:8192
    v_add_f32 v13, v13, v13
    v_mfma_f32_16x16x32_bf16 v[40:43], a[36:39], a[64:67], v[40:43]
    ds_read_b128 a[72:75], v149 offset:0
    s_add_u32 m0, s37, 49152
    v_and_b32_e64 v14, 1, v2
    v_mfma_f32_16x16x32_bf16 v[44:47], a[36:39], a[68:71], v[44:47]
    v_mfma_f32_16x16x32_bf16 v[48:51], a[40:43], a[64:67], v[48:51]
    ds_read_b128 a[76:79], v149 offset:2048
    v_cmp_eq_u32 s[78:79], 1, v14
    v_mfma_f32_16x16x32_bf16 v[52:55], a[40:43], a[68:71], v[52:55]
    ds_read_b128 a[80:83], v149 offset:4096
    buffer_load_dwordx4 v20, s[12:15], s36 offen offset:0  lds
    v_cndmask_b32 v4, 1.0, v134, s[78:79]
    v_mfma_f32_16x16x32_bf16 v[56:59], a[44:47], a[64:67], v[56:59]
    v_mfma_f32_16x16x32_bf16 v[60:63], a[44:47], a[68:71], v[60:63]
    ds_read_b128 a[84:87], v149 offset:6144
    v_cndmask_b32 v5, 0, v135, s[78:79]
    v_mfma_f32_16x16x32_bf16 v[64:67], a[48:51], a[64:67], v[64:67]
    ds_read_b128 a[88:91], v149 offset:8192
    buffer_load_dwordx4 v21, s[12:15], s36 offen offset:1024  lds
    v_cndmask_b32 v10, 1.0, v10, s[78:79]
    v_mfma_f32_16x16x32_bf16 v[68:71], a[48:51], a[68:71], v[68:71]
    ds_read_b128 a[92:95], v149 offset:10240
    v_mfma_f32_16x16x32_bf16 v[72:75], a[52:55], a[64:67], v[72:75]
    buffer_load_dwordx4 v22, s[12:15], s36 offen offset:2048  lds
    buffer_store_dwordx4 v[180:183], v193, s[28:31], s76 offen sc1
    v_cndmask_b32 v11, 0, v11, s[78:79]
    v_mfma_f32_16x16x32_bf16 v[76:79], a[52:55], a[68:71], v[76:79]
    ds_read_b128 a[96:99], v149 offset:12288
    v_cmp_lt_u32 s[78:79], 1, v2
    v_mfma_f32_16x16x32_bf16 v[80:83], a[56:59], a[64:67], v[80:83]
    ds_read_b128 a[100:103], v149 offset:14336
    v_mfma_f32_16x16x32_bf16 v[84:87], a[56:59], a[68:71], v[84:87]
    buffer_load_dwordx4 v23, s[12:15], s36 offen offset:3072  lds
    v_cndmask_b32 v8, 1.0, v8, s[78:79]
    v_mfma_f32_16x16x32_bf16 v[88:91], a[60:63], a[64:67], v[88:91]
    v_cndmask_b32 v9, 0, v9, s[78:79]
    v_mfma_f32_16x16x32_bf16 v[92:95], a[60:63], a[68:71], v[92:95]
    s_waitcnt lgkmcnt(0) vmcnt(19)
    s_barrier
    v_mfma_f32_16x16x32_bf16 v[32:35], a[72:75], a[104:107], v[32:35]
    ds_read_b128 a[64:67], v150 offset:32768
    s_bfe_u32 s36, s67, 262152
    v_cndmask_b32 v12, 1.0, v12, s[78:79]
    v_mfma_f32_16x16x32_bf16 v[36:39], a[72:75], a[108:111], v[36:39]
    ds_read_b128 a[68:71], v150 offset:40960
    v_cndmask_b32 v13, 0, v13, s[78:79]
    v_mfma_f32_16x16x32_bf16 v[40:43], a[76:79], a[104:107], v[40:43]
    ds_read_b128 a[32:35], v148 offset:32768
    s_add_u32 m0, s37, 65536
    v_mul_f32_e64 v138, v4, v8
    v_mfma_f32_16x16x32_bf16 v[44:47], a[76:79], a[108:111], v[44:47]
    v_mfma_f32_16x16x32_bf16 v[48:51], a[80:83], a[104:107], v[48:51]
    ds_read_b128 a[36:39], v148 offset:34816
    v_mul_f32_e64 v139, v4, v9
    v_mfma_f32_16x16x32_bf16 v[52:55], a[80:83], a[108:111], v[52:55]
    ds_read_b128 a[40:43], v148 offset:36864
    s_lshl_b32 s36, s36, 7
    v_fma_f32 v138, -v5, v9, v138
    v_mfma_f32_16x16x32_bf16 v[56:59], a[84:87], a[104:107], v[56:59]
    v_mfma_f32_16x16x32_bf16 v[60:63], a[84:87], a[108:111], v[60:63]
    ds_read_b128 a[44:47], v148 offset:38912
    v_fma_f32 v139, v5, v8, v139
    v_mfma_f32_16x16x32_bf16 v[64:67], a[88:91], a[104:107], v[64:67]
    ds_read_b128 a[48:51], v148 offset:40960
    buffer_load_dwordx4 v16, s[8:11], s36 offen offset:0  lds
    v_mul_f32 v140, v10, v12
    v_mfma_f32_16x16x32_bf16 v[68:71], a[88:91], a[108:111], v[68:71]
    ds_read_b128 a[52:55], v148 offset:43008
    v_mfma_f32_16x16x32_bf16 v[72:75], a[92:95], a[104:107], v[72:75]
    buffer_load_dwordx4 v17, s[8:11], s36 offen offset:1024  lds
    v_mul_f32_e64 v141, v10, v13
    v_mfma_f32_16x16x32_bf16 v[76:79], a[92:95], a[108:111], v[76:79]
    ds_read_b128 a[56:59], v148 offset:45056
    v_fma_f32 v140, -v11, v13, v140
    v_mfma_f32_16x16x32_bf16 v[80:83], a[96:99], a[104:107], v[80:83]
    ds_read_b128 a[60:63], v148 offset:47104
    v_mfma_f32_16x16x32_bf16 v[84:87], a[96:99], a[108:111], v[84:87]
    buffer_load_dwordx4 v18, s[8:11], s36 offen offset:2048  lds
    v_fma_f32 v141, v11, v12, v141
    v_mfma_f32_16x16x32_bf16 v[88:91], a[100:103], a[104:107], v[88:91]
    v_add_u32_e64 v251, s63, v1
    v_mfma_f32_16x16x32_bf16 v[92:95], a[100:103], a[108:111], v[92:95]
    s_waitcnt lgkmcnt(0)
    v_mfma_f32_16x16x32_bf16 v[32:35], a[32:35], a[64:67], v[32:35]
    ds_read_b128 a[104:107], v151 offset:32768
    buffer_load_dwordx4 v19, s[8:11], s36 offen offset:3072  lds
    v_cvt_f32_u32 v251, v251
    v_mfma_f32_16x16x32_bf16 v[36:39], a[32:35], a[68:71], v[36:39]
    ds_read_b128 a[108:111], v151 offset:40960
    v_mul_f32 v251, 0x3a800000, v251
    v_mfma_f32_16x16x32_bf16 v[40:43], a[36:39], a[64:67], v[40:43]
    ds_read_b128 a[72:75], v149 offset:32768
    s_add_u32 m0, s37, 81920
    v_mul_f32_e64 v248, v250, v251
    v_mfma_f32_16x16x32_bf16 v[44:47], a[36:39], a[68:71], v[44:47]
    v_mfma_f32_16x16x32_bf16 v[48:51], a[40:43], a[64:67], v[48:51]
    ds_read_b128 a[76:79], v149 offset:34816
    v_fmamk_f32 v4, v251, 0x00000000, v248
    v_mfma_f32_16x16x32_bf16 v[52:55], a[40:43], a[68:71], v[52:55]
    ds_read_b128 a[80:83], v149 offset:36864
    buffer_load_dwordx4 v20, s[12:15], s36 offen offset:0  lds
    v_fmamk_f32 v5, v251, 0x3f000000, v248
    v_mfma_f32_16x16x32_bf16 v[56:59], a[44:47], a[64:67], v[56:59]
    v_mfma_f32_16x16x32_bf16 v[60:63], a[44:47], a[68:71], v[60:63]
    ds_read_b128 a[84:87], v149 offset:38912
    v_fmamk_f32 v6, v251, 0x3f800000, v248
    v_mfma_f32_16x16x32_bf16 v[64:67], a[48:51], a[64:67], v[64:67]
    ds_read_b128 a[88:91], v149 offset:40960
    buffer_load_dwordx4 v21, s[12:15], s36 offen offset:1024  lds
    v_fmamk_f32 v7, v251, 0x3fc00000, v248
    v_mfma_f32_16x16x32_bf16 v[68:71], a[48:51], a[68:71], v[68:71]
    ds_read_b128 a[92:95], v149 offset:43008
    v_mfma_f32_16x16x32_bf16 v[72:75], a[52:55], a[64:67], v[72:75]
    buffer_load_dwordx4 v22, s[12:15], s36 offen offset:2048  lds
    v_cos_f32_e64 v96, v4
    v_mfma_f32_16x16x32_bf16 v[76:79], a[52:55], a[68:71], v[76:79]
    ds_read_b128 a[96:99], v149 offset:45056
    v_cos_f32_e64 v98, v5
    v_mfma_f32_16x16x32_bf16 v[80:83], a[56:59], a[64:67], v[80:83]
    ds_read_b128 a[100:103], v149 offset:47104
    v_mfma_f32_16x16x32_bf16 v[84:87], a[56:59], a[68:71], v[84:87]
    buffer_load_dwordx4 v23, s[12:15], s36 offen offset:3072  lds
    v_cos_f32_e64 v100, v6
    v_mfma_f32_16x16x32_bf16 v[88:91], a[60:63], a[64:67], v[88:91]
    v_cos_f32_e64 v102, v7
    v_mfma_f32_16x16x32_bf16 v[92:95], a[60:63], a[68:71], v[92:95]
    s_waitcnt lgkmcnt(0) vmcnt(9)
    s_barrier
    v_mfma_f32_16x16x32_bf16 v[32:35], a[72:75], a[104:107], v[32:35]
    ds_read_b128 a[64:67], v26 offset:0
    s_lshl_b32 s69, s2, 3
    v_sin_f32 v97, v4
    v_mfma_f32_16x16x32_bf16 v[36:39], a[72:75], a[108:111], v[36:39]
    ds_read_b128 a[68:71], v26 offset:8192
    s_add_u32 s69, s69, 22347776
    v_sin_f32_e64 v99, v5
    v_mfma_f32_16x16x32_bf16 v[40:43], a[76:79], a[104:107], v[40:43]
    ds_read_b128 a[32:35], v24 offset:0
    v_sin_f32_e64 v101, v6
    v_mfma_f32_16x16x32_bf16 v[44:47], a[76:79], a[108:111], v[44:47]
    v_mov_b32_e64 v28, s35
    v_mfma_f32_16x16x32_bf16 v[48:51], a[80:83], a[104:107], v[48:51]
    ds_read_b128 a[36:39], v24 offset:2048
    v_sin_f32_e64 v103, v7
    v_mfma_f32_16x16x32_bf16 v[52:55], a[80:83], a[108:111], v[52:55]
    ds_read_b128 a[40:43], v24 offset:4096
    v_and_b32 v255, 1073741831, v30
    v_fmamk_f32 v4, v251, 0x40000000, v248
    v_mfma_f32_16x16x32_bf16 v[56:59], a[84:87], a[104:107], v[56:59]
    v_mfma_f32_16x16x32_bf16 v[60:63], a[84:87], a[108:111], v[60:63]
    ds_read_b128 a[44:47], v24 offset:6144
    buffer_store_dword v28, v255, s[24:27], s69 offen sc1
    v_fmamk_f32 v5, v251, 0x40200000, v248
    v_mfma_f32_16x16x32_bf16 v[64:67], a[88:91], a[104:107], v[64:67]
    ds_read_b128 a[48:51], v24 offset:8192
    s_bfe_u32 s36, s67, 262156
    v_fmamk_f32 v6, v251, 0x40400000, v248
    v_mfma_f32_16x16x32_bf16 v[68:71], a[88:91], a[108:111], v[68:71]
    ds_read_b128 a[52:55], v24 offset:10240
    v_mfma_f32_16x16x32_bf16 v[72:75], a[92:95], a[104:107], v[72:75]
    s_add_u32 m0, s37, 98304
    v_fmamk_f32 v7, v251, 0x40600000, v248
    v_mfma_f32_16x16x32_bf16 v[76:79], a[92:95], a[108:111], v[76:79]
    ds_read_b128 a[56:59], v24 offset:12288
    v_cos_f32_e64 v104, v4
    v_mfma_f32_16x16x32_bf16 v[80:83], a[96:99], a[104:107], v[80:83]
    ds_read_b128 a[60:63], v24 offset:14336
    s_lshl_b32 s36, s36, 7
    v_mfma_f32_16x16x32_bf16 v[84:87], a[96:99], a[108:111], v[84:87]
    v_cos_f32 v106, v5
    v_mfma_f32_16x16x32_bf16 v[88:91], a[100:103], a[104:107], v[88:91]
    buffer_load_dwordx4 v16, s[8:11], s36 offen offset:0  lds
    v_cos_f32_e64 v108, v6
    v_mfma_f32_16x16x32_bf16 v[92:95], a[100:103], a[108:111], v[92:95]
    s_waitcnt lgkmcnt(0)
    v_mfma_f32_16x16x32_bf16 v[32:35], a[32:35], a[64:67], v[32:35]
    ds_read_b128 a[104:107], v27 offset:0
    buffer_load_dwordx4 v17, s[8:11], s36 offen offset:1024  lds
    v_cos_f32 v110, v7
    v_mfma_f32_16x16x32_bf16 v[36:39], a[32:35], a[68:71], v[36:39]
    ds_read_b128 a[108:111], v27 offset:8192
    v_sin_f32_e64 v105, v4
    v_mfma_f32_16x16x32_bf16 v[40:43], a[36:39], a[64:67], v[40:43]
    ds_read_b128 a[72:75], v25 offset:0
    buffer_load_dwordx4 v18, s[8:11], s36 offen offset:2048  lds
    v_sin_f32_e64 v107, v5
    v_mfma_f32_16x16x32_bf16 v[44:47], a[36:39], a[68:71], v[44:47]
    v_mfma_f32_16x16x32_bf16 v[48:51], a[40:43], a[64:67], v[48:51]
    ds_read_b128 a[76:79], v25 offset:2048
    buffer_load_dwordx4 v19, s[8:11], s36 offen offset:3072  lds
    v_sin_f32_e64 v109, v6
    v_mfma_f32_16x16x32_bf16 v[52:55], a[40:43], a[68:71], v[52:55]
    ds_read_b128 a[80:83], v25 offset:4096
    v_sin_f32_e64 v111, v7
    v_mfma_f32_16x16x32_bf16 v[56:59], a[44:47], a[64:67], v[56:59]
    s_add_u32 m0, s37, 114688
    v_mfma_f32_16x16x32_bf16 v[60:63], a[44:47], a[68:71], v[60:63]
    ds_read_b128 a[84:87], v25 offset:6144
    v_cvt_f32_u32_e64 v9, s4
    v_mfma_f32_16x16x32_bf16 v[64:67], a[48:51], a[64:67], v[64:67]
    ds_read_b128 a[88:91], v25 offset:8192
    buffer_load_dwordx4 v20, s[12:15], s36 offen offset:0  lds
    v_mul_f32 v9, 0x3a800000, v9
    v_mfma_f32_16x16x32_bf16 v[68:71], a[48:51], a[68:71], v[68:71]
    ds_read_b128 a[92:95], v25 offset:10240
    v_mfma_f32_16x16x32_bf16 v[72:75], a[52:55], a[64:67], v[72:75]
    buffer_load_dwordx4 v21, s[12:15], s36 offen offset:1024  lds
    v_sin_f32_e64 v11, v9
    v_mfma_f32_16x16x32_bf16 v[76:79], a[52:55], a[68:71], v[76:79]
    ds_read_b128 a[96:99], v25 offset:12288
    v_cos_f32_e64 v10, v9
    v_mfma_f32_16x16x32_bf16 v[80:83], a[56:59], a[64:67], v[80:83]
    ds_read_b128 a[100:103], v25 offset:14336
    buffer_load_dwordx4 v22, s[12:15], s36 offen offset:2048  lds
    v_mfma_f32_16x16x32_bf16 v[84:87], a[56:59], a[68:71], v[84:87]
    v_add_f32_e64 v11, 1.0, v11
    v_mfma_f32_16x16x32_bf16 v[88:91], a[60:63], a[64:67], v[88:91]
    buffer_load_dwordx4 v23, s[12:15], s36 offen offset:3072  lds
    v_rcp_f32_e64 v9, v11
    v_mfma_f32_16x16x32_bf16 v[92:95], a[60:63], a[68:71], v[92:95]
    s_waitcnt lgkmcnt(0) vmcnt(17)
    s_barrier
    v_mfma_f32_16x16x32_bf16 v[32:35], a[72:75], a[104:107], v[32:35]
    ds_read_b128 a[64:67], v26 offset:32768
    s_bfe_u32 s36, s67, 262160
    s_mov_b32 s39, 0x35000000
    v_mfma_f32_16x16x32_bf16 v[36:39], a[72:75], a[108:111], v[36:39]
    ds_read_b128 a[68:71], v26 offset:40960
    s_cmp_eq_u32 s2, 0
    s_cselect_b32 s39, 0x34800000, s39
    v_mfma_f32_16x16x32_bf16 v[40:43], a[76:79], a[104:107], v[40:43]
    ds_read_b128 a[32:35], v24 offset:32768
    s_add_u32 m0, s37, 0
    v_mul_f32_e64 v15, s39, v11
    v_mfma_f32_16x16x32_bf16 v[44:47], a[76:79], a[108:111], v[44:47]
    v_mfma_f32_16x16x32_bf16 v[48:51], a[80:83], a[104:107], v[48:51]
    ds_read_b128 a[36:39], v24 offset:34816
    v_mul_f32_e64 v10, -v10, v9
    v_mfma_f32_16x16x32_bf16 v[52:55], a[80:83], a[108:111], v[52:55]
    ds_read_b128 a[40:43], v24 offset:36864
    s_lshl_b32 s36, s36, 7
    v_cvt_f32_u32 v14, s63
    v_mfma_f32_16x16x32_bf16 v[56:59], a[84:87], a[104:107], v[56:59]
    v_mfma_f32_16x16x32_bf16 v[60:63], a[84:87], a[108:111], v[60:63]
    ds_read_b128 a[44:47], v24 offset:38912
    v_readfirstlane_b32 s42, v10
    v_mfma_f32_16x16x32_bf16 v[64:67], a[88:91], a[104:107], v[64:67]
    ds_read_b128 a[48:51], v24 offset:40960
    buffer_load_dwordx4 v16, s[8:11], s36 offen offset:0  lds
    v_add_f32 v14, v14, v250
    v_mfma_f32_16x16x32_bf16 v[68:71], a[88:91], a[108:111], v[68:71]
    ds_read_b128 a[52:55], v24 offset:43008
    v_mfma_f32_16x16x32_bf16 v[72:75], a[92:95], a[104:107], v[72:75]
    buffer_load_dwordx4 v17, s[8:11], s36 offen offset:1024  lds
    v_fma_f32 v251, v249, 2.0, 0
    v_mfma_f32_16x16x32_bf16 v[76:79], a[92:95], a[108:111], v[76:79]
    ds_read_b128 a[56:59], v24 offset:45056
    v_mul_f32 v251, 0x3a000000, v251
    v_mfma_f32_16x16x32_bf16 v[80:83], a[96:99], a[104:107], v[80:83]
    ds_read_b128 a[60:63], v24 offset:47104
    v_mfma_f32_16x16x32_bf16 v[84:87], a[96:99], a[108:111], v[84:87]
    buffer_load_dwordx4 v18, s[8:11], s36 offen offset:2048  lds
    v_mul_f32_e64 v248, v14, v251
    v_mfma_f32_16x16x32_bf16 v[88:91], a[100:103], a[104:107], v[88:91]
    v_fmamk_f32 v4, v251, 0x00000000, v248
    v_mfma_f32_16x16x32_bf16 v[92:95], a[100:103], a[108:111], v[92:95]
    s_waitcnt lgkmcnt(0)
    v_mfma_f32_16x16x32_bf16 v[32:35], a[32:35], a[64:67], v[32:35]
    ds_read_b128 a[104:107], v27 offset:32768
    buffer_load_dwordx4 v19, s[8:11], s36 offen offset:3072  lds
    v_fmamk_f32 v5, v251, 0x3f800000, v248
    v_mfma_f32_16x16x32_bf16 v[36:39], a[32:35], a[68:71], v[36:39]
    ds_read_b128 a[108:111], v27 offset:40960
    v_fmamk_f32 v6, v251, 0x40000000, v248
    v_mfma_f32_16x16x32_bf16 v[40:43], a[36:39], a[64:67], v[40:43]
    ds_read_b128 a[72:75], v25 offset:32768
    s_add_u32 m0, s37, 16384
    v_fmamk_f32 v7, v251, 0x40400000, v248
    v_mfma_f32_16x16x32_bf16 v[44:47], a[36:39], a[68:71], v[44:47]
    v_mfma_f32_16x16x32_bf16 v[48:51], a[40:43], a[64:67], v[48:51]
    ds_read_b128 a[76:79], v25 offset:34816
    v_cos_f32 v112, v4
    v_mfma_f32_16x16x32_bf16 v[52:55], a[40:43], a[68:71], v[52:55]
    ds_read_b128 a[80:83], v25 offset:36864
    buffer_load_dwordx4 v20, s[12:15], s36 offen offset:0  lds
    v_cos_f32_e64 v113, v5
    v_mfma_f32_16x16x32_bf16 v[56:59], a[44:47], a[64:67], v[56:59]
    v_mfma_f32_16x16x32_bf16 v[60:63], a[44:47], a[68:71], v[60:63]
    ds_read_b128 a[84:87], v25 offset:38912
    v_cos_f32_e64 v114, v6
    v_mfma_f32_16x16x32_bf16 v[64:67], a[48:51], a[64:67], v[64:67]
    ds_read_b128 a[88:91], v25 offset:40960
    buffer_load_dwordx4 v21, s[12:15], s36 offen offset:1024  lds
    v_cos_f32_e64 v115, v7
    v_mfma_f32_16x16x32_bf16 v[68:71], a[48:51], a[68:71], v[68:71]
    ds_read_b128 a[92:95], v25 offset:43008
    v_mfma_f32_16x16x32_bf16 v[72:75], a[52:55], a[64:67], v[72:75]
    buffer_load_dwordx4 v22, s[12:15], s36 offen offset:2048  lds
    v_sin_f32_e64 v116, v4
    v_mfma_f32_16x16x32_bf16 v[76:79], a[52:55], a[68:71], v[76:79]
    ds_read_b128 a[96:99], v25 offset:45056
    v_sin_f32_e64 v117, v5
    v_mfma_f32_16x16x32_bf16 v[80:83], a[56:59], a[64:67], v[80:83]
    ds_read_b128 a[100:103], v25 offset:47104
    v_mfma_f32_16x16x32_bf16 v[84:87], a[56:59], a[68:71], v[84:87]
    buffer_load_dwordx4 v23, s[12:15], s36 offen offset:3072  lds
    v_sin_f32_e64 v118, v6
    v_mfma_f32_16x16x32_bf16 v[88:91], a[60:63], a[64:67], v[88:91]
    v_sin_f32_e64 v119, v7
    v_mfma_f32_16x16x32_bf16 v[92:95], a[60:63], a[68:71], v[92:95]
    s_waitcnt lgkmcnt(0) vmcnt(17)
    s_barrier
    v_mfma_f32_16x16x32_bf16 v[32:35], a[72:75], a[104:107], v[32:35]
    ds_read_b128 a[64:67], v150 offset:0
    s_bfe_u32 s36, s67, 262164
    v_mul_f32_e64 v112, v15, v112
    v_mfma_f32_16x16x32_bf16 v[36:39], a[72:75], a[108:111], v[36:39]
    ds_read_b128 a[68:71], v150 offset:8192
    v_mul_f32_e64 v113, v15, v113
    v_mfma_f32_16x16x32_bf16 v[40:43], a[76:79], a[104:107], v[40:43]
    ds_read_b128 a[32:35], v148 offset:0
    s_add_u32 m0, s37, 32768
    v_mul_f32_e64 v114, v15, v114
    v_mfma_f32_16x16x32_bf16 v[44:47], a[76:79], a[108:111], v[44:47]
    v_mfma_f32_16x16x32_bf16 v[48:51], a[80:83], a[104:107], v[48:51]
    ds_read_b128 a[36:39], v148 offset:2048
    v_mul_f32_e64 v115, v15, v115
    v_mfma_f32_16x16x32_bf16 v[52:55], a[80:83], a[108:111], v[52:55]
    ds_read_b128 a[40:43], v148 offset:4096
    s_lshl_b32 s36, s36, 7
    v_mul_f32 v116, v15, v116
    v_mfma_f32_16x16x32_bf16 v[56:59], a[84:87], a[104:107], v[56:59]
    v_mfma_f32_16x16x32_bf16 v[60:63], a[84:87], a[108:111], v[60:63]
    ds_read_b128 a[44:47], v148 offset:6144
    v_mul_f32_e64 v117, v15, v117
    v_mfma_f32_16x16x32_bf16 v[64:67], a[88:91], a[104:107], v[64:67]
    ds_read_b128 a[48:51], v148 offset:8192
    buffer_load_dwordx4 v16, s[8:11], s36 offen offset:0  lds
    v_mul_f32_e64 v118, v15, v118
    v_mfma_f32_16x16x32_bf16 v[68:71], a[88:91], a[108:111], v[68:71]
    ds_read_b128 a[52:55], v148 offset:10240
    v_mfma_f32_16x16x32_bf16 v[72:75], a[92:95], a[104:107], v[72:75]
    buffer_load_dwordx4 v17, s[8:11], s36 offen offset:1024  lds
    v_mul_f32_e64 v119, v15, v119
    v_mfma_f32_16x16x32_bf16 v[76:79], a[92:95], a[108:111], v[76:79]
    ds_read_b128 a[56:59], v148 offset:12288
    v_fma_f32 v251, v249, 2.0, 1.0
    v_mfma_f32_16x16x32_bf16 v[80:83], a[96:99], a[104:107], v[80:83]
    ds_read_b128 a[60:63], v148 offset:14336
    v_mfma_f32_16x16x32_bf16 v[84:87], a[96:99], a[108:111], v[84:87]
    buffer_load_dwordx4 v18, s[8:11], s36 offen offset:2048  lds
    v_mul_f32 v251, 0x3a000000, v251
    v_mfma_f32_16x16x32_bf16 v[88:91], a[100:103], a[104:107], v[88:91]
    v_mul_f32_e64 v248, v14, v251
    v_mfma_f32_16x16x32_bf16 v[92:95], a[100:103], a[108:111], v[92:95]
    s_waitcnt lgkmcnt(0)
    v_mfma_f32_16x16x32_bf16 v[32:35], a[32:35], a[64:67], v[32:35]
    ds_read_b128 a[104:107], v151 offset:0
    buffer_load_dwordx4 v19, s[8:11], s36 offen offset:3072  lds
    v_fmamk_f32 v4, v251, 0x00000000, v248
    v_mfma_f32_16x16x32_bf16 v[36:39], a[32:35], a[68:71], v[36:39]
    ds_read_b128 a[108:111], v151 offset:8192
    v_fmamk_f32 v5, v251, 0x3f800000, v248
    v_mfma_f32_16x16x32_bf16 v[40:43], a[36:39], a[64:67], v[40:43]
    ds_read_b128 a[72:75], v149 offset:0
    s_add_u32 m0, s37, 49152
    v_fmamk_f32 v6, v251, 0x40000000, v248
    v_mfma_f32_16x16x32_bf16 v[44:47], a[36:39], a[68:71], v[44:47]
    v_mfma_f32_16x16x32_bf16 v[48:51], a[40:43], a[64:67], v[48:51]
    ds_read_b128 a[76:79], v149 offset:2048
    v_fmamk_f32 v7, v251, 0x40400000, v248
    v_mfma_f32_16x16x32_bf16 v[52:55], a[40:43], a[68:71], v[52:55]
    ds_read_b128 a[80:83], v149 offset:4096
    buffer_load_dwordx4 v20, s[12:15], s36 offen offset:0  lds
    v_cos_f32 v120, v4
    v_mfma_f32_16x16x32_bf16 v[56:59], a[44:47], a[64:67], v[56:59]
    v_mfma_f32_16x16x32_bf16 v[60:63], a[44:47], a[68:71], v[60:63]
    ds_read_b128 a[84:87], v149 offset:6144
    v_cos_f32_e64 v121, v5
    v_mfma_f32_16x16x32_bf16 v[64:67], a[48:51], a[64:67], v[64:67]
    ds_read_b128 a[88:91], v149 offset:8192
    buffer_load_dwordx4 v21, s[12:15], s36 offen offset:1024  lds
    v_cos_f32_e64 v122, v6
    v_mfma_f32_16x16x32_bf16 v[68:71], a[48:51], a[68:71], v[68:71]
    ds_read_b128 a[92:95], v149 offset:10240
    v_mfma_f32_16x16x32_bf16 v[72:75], a[52:55], a[64:67], v[72:75]
    buffer_load_dwordx4 v22, s[12:15], s36 offen offset:2048  lds
    v_cos_f32_e64 v123, v7
    v_mfma_f32_16x16x32_bf16 v[76:79], a[52:55], a[68:71], v[76:79]
    ds_read_b128 a[96:99], v149 offset:12288
    v_sin_f32_e64 v124, v4
    v_mfma_f32_16x16x32_bf16 v[80:83], a[56:59], a[64:67], v[80:83]
    ds_read_b128 a[100:103], v149 offset:14336
    v_mfma_f32_16x16x32_bf16 v[84:87], a[56:59], a[68:71], v[84:87]
    buffer_load_dwordx4 v23, s[12:15], s36 offen offset:3072  lds
    v_sin_f32_e64 v125, v5
    v_mfma_f32_16x16x32_bf16 v[88:91], a[60:63], a[64:67], v[88:91]
    v_sin_f32_e64 v126, v6
    v_mfma_f32_16x16x32_bf16 v[92:95], a[60:63], a[68:71], v[92:95]
    s_waitcnt lgkmcnt(0) vmcnt(16)
    s_barrier
    v_mfma_f32_16x16x32_bf16 v[32:35], a[72:75], a[104:107], v[32:35]
    ds_read_b128 a[64:67], v150 offset:32768
    s_bfe_u32 s36, s67, 262168
    v_sin_f32_e64 v127, v7
    v_mfma_f32_16x16x32_bf16 v[36:39], a[72:75], a[108:111], v[36:39]
    ds_read_b128 a[68:71], v150 offset:40960
    v_mul_f32_e64 v120, v15, v120
    v_mfma_f32_16x16x32_bf16 v[40:43], a[76:79], a[104:107], v[40:43]
    ds_read_b128 a[32:35], v148 offset:32768
    s_add_u32 m0, s37, 65536
    v_mfma_f32_16x16x32_bf16 v[44:47], a[76:79], a[108:111], v[44:47]
    v_mul_f32_e64 v121, v15, v121
    v_mfma_f32_16x16x32_bf16 v[48:51], a[80:83], a[104:107], v[48:51]
    ds_read_b128 a[36:39], v148 offset:34816
    v_mfma_f32_16x16x32_bf16 v[52:55], a[80:83], a[108:111], v[52:55]
    ds_read_b128 a[40:43], v148 offset:36864
    s_lshl_b32 s36, s36, 7
    v_mul_f32 v122, v15, v122
    v_mfma_f32_16x16x32_bf16 v[56:59], a[84:87], a[104:107], v[56:59]
    v_mfma_f32_16x16x32_bf16 v[60:63], a[84:87], a[108:111], v[60:63]
    ds_read_b128 a[44:47], v148 offset:38912
    v_mul_f32_e64 v123, v15, v123
    v_mfma_f32_16x16x32_bf16 v[64:67], a[88:91], a[104:107], v[64:67]
    ds_read_b128 a[48:51], v148 offset:40960
    buffer_load_dwordx4 v16, s[8:11], s36 offen offset:0  lds
    v_mul_f32_e64 v124, v15, v124
    v_mfma_f32_16x16x32_bf16 v[68:71], a[88:91], a[108:111], v[68:71]
    ds_read_b128 a[52:55], v148 offset:43008
    v_mfma_f32_16x16x32_bf16 v[72:75], a[92:95], a[104:107], v[72:75]
    buffer_load_dwordx4 v17, s[8:11], s36 offen offset:1024  lds
    v_mul_f32_e64 v125, v15, v125
    v_mfma_f32_16x16x32_bf16 v[76:79], a[92:95], a[108:111], v[76:79]
    ds_read_b128 a[56:59], v148 offset:45056
    v_mfma_f32_16x16x32_bf16 v[80:83], a[96:99], a[104:107], v[80:83]
    ds_read_b128 a[60:63], v148 offset:47104
    v_mul_f32_e64 v126, v15, v126
    v_mfma_f32_16x16x32_bf16 v[84:87], a[96:99], a[108:111], v[84:87]
    buffer_load_dwordx4 v18, s[8:11], s36 offen offset:2048  lds
    v_mfma_f32_16x16x32_bf16 v[88:91], a[100:103], a[104:107], v[88:91]
    v_mul_f32_e64 v127, v15, v127
    v_mfma_f32_16x16x32_bf16 v[92:95], a[100:103], a[108:111], v[92:95]
    s_waitcnt lgkmcnt(0)
    v_mfma_f32_16x16x32_bf16 v[32:35], a[32:35], a[64:67], v[32:35]
    ds_read_b128 a[104:107], v151 offset:32768
    buffer_load_dwordx4 v19, s[8:11], s36 offen offset:3072  lds
    v_mfma_f32_16x16x32_bf16 v[36:39], a[32:35], a[68:71], v[36:39]
    ds_read_b128 a[108:111], v151 offset:40960
    v_mfma_f32_16x16x32_bf16 v[40:43], a[36:39], a[64:67], v[40:43]
    ds_read_b128 a[72:75], v149 offset:32768
    s_add_u32 m0, s37, 81920
    v_mfma_f32_16x16x32_bf16 v[44:47], a[36:39], a[68:71], v[44:47]
    v_mfma_f32_16x16x32_bf16 v[48:51], a[40:43], a[64:67], v[48:51]
    ds_read_b128 a[76:79], v149 offset:34816
    v_mfma_f32_16x16x32_bf16 v[52:55], a[40:43], a[68:71], v[52:55]
    ds_read_b128 a[80:83], v149 offset:36864
    buffer_load_dwordx4 v20, s[12:15], s36 offen offset:0  lds
    v_mfma_f32_16x16x32_bf16 v[56:59], a[44:47], a[64:67], v[56:59]
    v_mfma_f32_16x16x32_bf16 v[60:63], a[44:47], a[68:71], v[60:63]
    ds_read_b128 a[84:87], v149 offset:38912
    v_mfma_f32_16x16x32_bf16 v[64:67], a[48:51], a[64:67], v[64:67]
    ds_read_b128 a[88:91], v149 offset:40960
    buffer_load_dwordx4 v21, s[12:15], s36 offen offset:1024  lds
    v_mfma_f32_16x16x32_bf16 v[68:71], a[48:51], a[68:71], v[68:71]
    ds_read_b128 a[92:95], v149 offset:43008
    v_mfma_f32_16x16x32_bf16 v[72:75], a[52:55], a[64:67], v[72:75]
    buffer_load_dwordx4 v22, s[12:15], s36 offen offset:2048  lds
    v_mfma_f32_16x16x32_bf16 v[76:79], a[52:55], a[68:71], v[76:79]
    ds_read_b128 a[96:99], v149 offset:45056
    v_mfma_f32_16x16x32_bf16 v[80:83], a[56:59], a[64:67], v[80:83]
    ds_read_b128 a[100:103], v149 offset:47104
    v_mfma_f32_16x16x32_bf16 v[84:87], a[56:59], a[68:71], v[84:87]
    buffer_load_dwordx4 v23, s[12:15], s36 offen offset:3072  lds
    v_mfma_f32_16x16x32_bf16 v[88:91], a[60:63], a[64:67], v[88:91]
    v_mfma_f32_16x16x32_bf16 v[92:95], a[60:63], a[68:71], v[92:95]
    s_waitcnt lgkmcnt(0) vmcnt(16)
    s_barrier
    v_mfma_f32_16x16x32_bf16 v[32:35], a[72:75], a[104:107], v[32:35]
    ds_read_b128 a[64:67], v26 offset:0
    v_lshlrev_b32 v217, 3, v0
    v_mfma_f32_16x16x32_bf16 v[36:39], a[72:75], a[108:111], v[36:39]
    ds_read_b128 a[68:71], v26 offset:8192
    s_lshl_b32 s68, s34, 9
    v_mfma_f32_16x16x32_bf16 v[40:43], a[76:79], a[104:107], v[40:43]
    ds_read_b128 a[32:35], v24 offset:0
    s_add_u32 s68, s68, 22347776
    v_mfma_f32_16x16x32_bf16 v[44:47], a[76:79], a[108:111], v[44:47]
    v_mfma_f32_16x16x32_bf16 v[48:51], a[80:83], a[104:107], v[48:51]
    ds_read_b128 a[36:39], v24 offset:2048
    buffer_load_dword v216, v217, s[24:27], s68 offen sc1
    v_mfma_f32_16x16x32_bf16 v[52:55], a[80:83], a[108:111], v[52:55]
    ds_read_b128 a[40:43], v24 offset:4096
    s_bfe_u32 s36, s67, 262172
    v_mfma_f32_16x16x32_bf16 v[56:59], a[84:87], a[104:107], v[56:59]
    v_mfma_f32_16x16x32_bf16 v[60:63], a[84:87], a[108:111], v[60:63]
    ds_read_b128 a[44:47], v24 offset:6144
    s_add_u32 m0, s37, 98304
    v_mfma_f32_16x16x32_bf16 v[64:67], a[88:91], a[104:107], v[64:67]
    ds_read_b128 a[48:51], v24 offset:8192
    s_lshl_b32 s36, s36, 7
    v_mfma_f32_16x16x32_bf16 v[68:71], a[88:91], a[108:111], v[68:71]
    ds_read_b128 a[52:55], v24 offset:10240
    v_mfma_f32_16x16x32_bf16 v[72:75], a[92:95], a[104:107], v[72:75]
    buffer_load_dwordx4 v16, s[8:11], s36 offen offset:0  lds
    v_mfma_f32_16x16x32_bf16 v[76:79], a[92:95], a[108:111], v[76:79]
    ds_read_b128 a[56:59], v24 offset:12288
    buffer_load_dwordx4 v17, s[8:11], s36 offen offset:1024  lds
    v_mfma_f32_16x16x32_bf16 v[80:83], a[96:99], a[104:107], v[80:83]
    ds_read_b128 a[60:63], v24 offset:14336
    v_mfma_f32_16x16x32_bf16 v[84:87], a[96:99], a[108:111], v[84:87]
    buffer_load_dwordx4 v18, s[8:11], s36 offen offset:2048  lds
    v_mfma_f32_16x16x32_bf16 v[88:91], a[100:103], a[104:107], v[88:91]
    buffer_load_dwordx4 v19, s[8:11], s36 offen offset:3072  lds
    v_mfma_f32_16x16x32_bf16 v[92:95], a[100:103], a[108:111], v[92:95]
    s_waitcnt lgkmcnt(0)
    v_mfma_f32_16x16x32_bf16 v[32:35], a[32:35], a[64:67], v[32:35]
    ds_read_b128 a[104:107], v27 offset:0
    s_add_u32 m0, s37, 114688
    v_and_b32 v6, 7, v0
    v_xor_b32_e64 v6, v6, v2
    v_mfma_f32_16x16x32_bf16 v[36:39], a[32:35], a[68:71], v[36:39]
    ds_read_b128 a[108:111], v27 offset:8192
    buffer_load_dwordx4 v20, s[12:15], s36 offen offset:0  lds
    s_and_b32 s38, s33, 8
    s_lshl_b32 s38, s38, 7
    v_mfma_f32_16x16x32_bf16 v[40:43], a[36:39], a[64:67], v[40:43]
    ds_read_b128 a[72:75], v25 offset:0
    buffer_load_dwordx4 v21, s[12:15], s36 offen offset:1024  lds
    v_lshl_add_u32 v6, v6, 4, s38
    v_lshrrev_b32_e64 v8, 3, v0
    v_mfma_f32_16x16x32_bf16 v[44:47], a[36:39], a[68:71], v[44:47]
    s_xor_b32 s38, s33, 8
    v_mfma_f32_16x16x32_bf16 v[48:51], a[40:43], a[64:67], v[48:51]
    ds_read_b128 a[76:79], v25 offset:2048
    buffer_load_dwordx4 v22, s[12:15], s36 offen offset:2048  lds
    s_lshl_b32 s38, s38, 5
    s_add_u32 s38, s38, s6
    v_mfma_f32_16x16x32_bf16 v[52:55], a[40:43], a[68:71], v[52:55]
    ds_read_b128 a[80:83], v25 offset:4096
    buffer_load_dwordx4 v23, s[12:15], s36 offen offset:3072  lds
    s_lshl_b32 s38, s38, 1
    v_lshl_add_u32 v8, v8, 2, s38
    v_mfma_f32_16x16x32_bf16 v[56:59], a[44:47], a[64:67], v[56:59]
    v_lshl_add_u32 v16, v8, 11, v6
    v_mfma_f32_16x16x32_bf16 v[60:63], a[44:47], a[68:71], v[60:63]
    ds_read_b128 a[84:87], v25 offset:6144
    s_getpc_b64 s[20:21]
K_PC2:
    s_mov_b32 s22, K_CODE_END-K_PC2
    v_xor_b32 v8, 64, v16
    v_add_u32 v17, 64512, v8
    v_mfma_f32_16x16x32_bf16 v[64:67], a[48:51], a[64:67], v[64:67]
    ds_read_b128 a[88:91], v25 offset:8192
    s_bfe_u32 s3, s2, 0x20003
    v_mov_b32_e64 v18, v16
    v_add_u32 v19, 64512, v8
    v_mfma_f32_16x16x32_bf16 v[68:71], a[48:51], a[68:71], v[68:71]
    ds_read_b128 a[92:95], v25 offset:10240
    s_lshl1_add_u32 s40, s33, s6
    v_mfma_f32_16x16x32_bf16 v[72:75], a[52:55], a[64:67], v[72:75]
    s_lshl2_add_u32 s3, s3, s34
    s_lshl_b32 s40, s40, 6
    s_lshr_b32 s41, s33, 3
    v_mfma_f32_16x16x32_bf16 v[76:79], a[52:55], a[68:71], v[76:79]
    ds_read_b128 a[96:99], v25 offset:12288
    s_lshl_b32 s3, s3, 11
    s_add_u32 s40, s40, s41
    s_and_b32 s41, s32, 3
    v_mfma_f32_16x16x32_bf16 v[80:83], a[56:59], a[64:67], v[80:83]
    ds_read_b128 a[100:103], v25 offset:14336
    s_lshl2_add_u32 s40, s40, s41
    v_mfma_f32_16x16x32_bf16 v[84:87], a[56:59], a[68:71], v[84:87]
    v_lshl_add_u32 v28, v0, 5, s3
    s_and_b32 s41, s2, 1
    s_lshl1_add_u32 s40, s40, s41
    v_mfma_f32_16x16x32_bf16 v[88:91], a[60:63], a[64:67], v[88:91]
    buffer_load_dword a221, v28, s[20:23], 0 offen
    s_lshl_b32 s92, s40, 7
    v_lshrrev_b32 v29, 1, v0
    v_mfma_f32_16x16x32_bf16 v[92:95], a[60:63], a[68:71], v[92:95]
    v_lshlrev_b32 v29, 11, v29
    s_waitcnt lgkmcnt(0) vmcnt(9)
    v_cmp_ne_u32 vcc, s35, v216
    s_nop 0
    s_cbranch_vccnz K_POLL1
K_POLL1_OK:
    s_barrier
    v_mfma_f32_16x16x32_bf16 v[32:35], a[72:75], a[104:107], v[32:35]
    ds_read_b128 a[64:67], v26 offset:32768
    v_lshlrev_b32_e64 v28, 12, v2
    v_mfma_f32_16x16x32_bf16 v[36:39], a[72:75], a[108:111], v[36:39]
    ds_read_b128 a[68:71], v26 offset:40960
    v_lshl_add_u32 v28, v1, 4, v28
    v_mfma_f32_16x16x32_bf16 v[40:43], a[76:79], a[104:107], v[40:43]
    ds_read_b128 a[32:35], v24 offset:32768
    s_lshl4_add_u32 s68, s37, s5
    v_mfma_f32_16x16x32_bf16 v[44:47], a[76:79], a[108:111], v[44:47]
    s_add_u32 m0, s37, 131072
    v_mfma_f32_16x16x32_bf16 v[48:51], a[80:83], a[104:107], v[48:51]
    ds_read_b128 a[36:39], v24 offset:34816
    s_add_u32 s69, s68, 0
    v_mfma_f32_16x16x32_bf16 v[52:55], a[80:83], a[108:111], v[52:55]
    ds_read_b128 a[40:43], v24 offset:36864
    v_mfma_f32_16x16x32_bf16 v[56:59], a[84:87], a[104:107], v[56:59]
    buffer_load_dwordx4 v28, s[28:31], s69 offen sc1 lds
    v_mfma_f32_16x16x32_bf16 v[60:63], a[84:87], a[108:111], v[60:63]
    ds_read_b128 a[44:47], v24 offset:38912
    s_add_u32 m0, s37, 132096
    v_mfma_f32_16x16x32_bf16 v[64:67], a[88:91], a[104:107], v[64:67]
    ds_read_b128 a[48:51], v24 offset:40960
    s_add_u32 s69, s68, 16384
    v_mfma_f32_16x16x32_bf16 v[68:71], a[88:91], a[108:111], v[68:71]
    ds_read_b128 a[52:55], v24 offset:43008
    buffer_load_dwordx4 v28, s[28:31], s69 offen sc1 lds
    v_mfma_f32_16x16x32_bf16 v[72:75], a[92:95], a[104:107], v[72:75]
    v_mfma_f32_16x16x32_bf16 v[76:79], a[92:95], a[108:111], v[76:79]
    ds_read_b128 a[56:59], v24 offset:45056
    s_add_u32 m0, s37, 133120
    v_mfma_f32_16x16x32_bf16 v[80:83], a[96:99], a[104:107], v[80:83]
    ds_read_b128 a[60:63], v24 offset:47104
    s_add_u32 s69, s68, 32768
    v_mfma_f32_16x16x32_bf16 v[84:87], a[96:99], a[108:111], v[84:87]
    buffer_load_dwordx4 v28, s[28:31], s69 offen sc1 lds
    v_mfma_f32_16x16x32_bf16 v[88:91], a[100:103], a[104:107], v[88:91]
    s_add_u32 m0, s37, 134144
    v_mfma_f32_16x16x32_bf16 v[92:95], a[100:103], a[108:111], v[92:95]
    s_waitcnt lgkmcnt(0)
    v_mfma_f32_16x16x32_bf16 v[32:35], a[32:35], a[64:67], v[32:35]
    ds_read_b128 a[104:107], v27 offset:32768
    s_add_u32 s69, s68, 49152
    v_mfma_f32_16x16x32_bf16 v[36:39], a[32:35], a[68:71], v[36:39]
    ds_read_b128 a[108:111], v27 offset:40960
    buffer_load_dwordx4 v28, s[28:31], s69 offen sc1 lds
    v_mfma_f32_16x16x32_bf16 v[40:43], a[36:39], a[64:67], v[40:43]
    ds_read_b128 a[72:75], v25 offset:32768
    s_add_u32 s69, s68, 262144
    v_mfma_f32_16x16x32_bf16 v[44:47], a[36:39], a[68:71], v[44:47]
    buffer_load_dwordx4 v[200:203], v28, s[28:31], s69 offen sc1
    v_mfma_f32_16x16x32_bf16 v[48:51], a[40:43], a[64:67], v[48:51]
    ds_read_b128 a[76:79], v25 offset:34816
    s_add_u32 s69, s68, 278528
    v_mfma_f32_16x16x32_bf16 v[52:55], a[40:43], a[68:71], v[52:55]
    ds_read_b128 a[80:83], v25 offset:36864
    v_mfma_f32_16x16x32_bf16 v[56:59], a[44:47], a[64:67], v[56:59]
    buffer_load_dwordx4 v[204:207], v28, s[28:31], s69 offen sc1
    v_mfma_f32_16x16x32_bf16 v[60:63], a[44:47], a[68:71], v[60:63]
    ds_read_b128 a[84:87], v25 offset:38912
    s_add_u32 s69, s68, 294912
    v_mfma_f32_16x16x32_bf16 v[64:67], a[48:51], a[64:67], v[64:67]
    ds_read_b128 a[88:91], v25 offset:40960
    buffer_load_dwordx4 v[208:211], v28, s[28:31], s69 offen sc1
    v_mfma_f32_16x16x32_bf16 v[68:71], a[48:51], a[68:71], v[68:71]
    ds_read_b128 a[92:95], v25 offset:43008
    s_add_u32 s69, s68, 311296
    v_mfma_f32_16x16x32_bf16 v[72:75], a[52:55], a[64:67], v[72:75]
    v_mfma_f32_16x16x32_bf16 v[76:79], a[52:55], a[68:71], v[76:79]
    ds_read_b128 a[96:99], v25 offset:45056
    buffer_load_dwordx4 v[212:215], v28, s[28:31], s69 offen sc1
    v_mfma_f32_16x16x32_bf16 v[80:83], a[56:59], a[64:67], v[80:83]
    ds_read_b128 a[100:103], v25 offset:47104
    s_cmp_eq_u32 s2, 0
    s_cbranch_scc1 K_W256
K_W256_RET:
    v_mfma_f32_16x16x32_bf16 v[84:87], a[56:59], a[68:71], v[84:87]
    v_lshlrev_b32 v28, 6, v1
    v_mfma_f32_16x16x32_bf16 v[88:91], a[60:63], a[64:67], v[88:91]
    buffer_load_dword a222, v28, s[24:27], s51 offen sc1
    v_mfma_f32_16x16x32_bf16 v[92:95], a[60:63], a[68:71], v[92:95]
    s_waitcnt lgkmcnt(0)
    s_barrier
    v_mfma_f32_16x16x32_bf16 v[32:35], a[72:75], a[104:107], v[32:35]
    ds_read_b128 a[64:67], v150 offset:0
    v_and_b32_e64 v14, 8, v1
    v_mfma_f32_16x16x32_bf16 v[36:39], a[72:75], a[108:111], v[36:39]
    ds_read_b128 a[68:71], v150 offset:8192
    v_and_b32_e64 v15, 3, v1
    v_mfma_f32_16x16x32_bf16 v[40:43], a[76:79], a[104:107], v[40:43]
    ds_read_b128 a[32:35], v148 offset:0
    v_lshl_or_b32 v14, v15, 1, v14
    v_mfma_f32_16x16x32_bf16 v[44:47], a[76:79], a[108:111], v[44:47]
    v_bfe_u32 v15, v1, 2, 1
    v_mfma_f32_16x16x32_bf16 v[48:51], a[80:83], a[104:107], v[48:51]
    ds_read_b128 a[36:39], v148 offset:2048
    v_lshlrev_b32_e64 v13, 2, v2
    v_mfma_f32_16x16x32_bf16 v[52:55], a[80:83], a[108:111], v[52:55]
    ds_read_b128 a[40:43], v148 offset:4096
    v_or_b32_e64 v14, v14, v15
    v_mfma_f32_16x16x32_bf16 v[56:59], a[84:87], a[104:107], v[56:59]
    v_xor_b32_e64 v14, v14, v13
    v_mfma_f32_16x16x32_bf16 v[60:63], a[84:87], a[108:111], v[60:63]
    ds_read_b128 a[44:47], v148 offset:6144
    v_lshl_add_u32 v14, v1, 4, v14
    v_mfma_f32_16x16x32_bf16 v[64:67], a[88:91], a[104:107], v[64:67]
    ds_read_b128 a[48:51], v148 offset:8192
    s_lshl1_add_u32 s38, s37, 131072
    v_mfma_f32_16x16x32_bf16 v[68:71], a[88:91], a[108:111], v[68:71]
    ds_read_b128 a[52:55], v148 offset:10240
    v_lshl_add_u32 v216, v14, 4, s38
    v_mfma_f32_16x16x32_bf16 v[72:75], a[92:95], a[104:107], v[72:75]
    v_xor_b32_e64 v217, 16, v216
    v_mfma_f32_16x16x32_bf16 v[76:79], a[92:95], a[108:111], v[76:79]
    ds_read_b128 a[56:59], v148 offset:12288
    v_xor_b32_e64 v218, 32, v216
    v_mfma_f32_16x16x32_bf16 v[80:83], a[96:99], a[104:107], v[80:83]
    ds_read_b128 a[60:63], v148 offset:14336
    v_xor_b32_e64 v219, 48, v216
    v_mfma_f32_16x16x32_bf16 v[84:87], a[96:99], a[108:111], v[84:87]
    v_and_b32_e64 v14, 1, v2
    v_mfma_f32_16x16x32_bf16 v[88:91], a[100:103], a[104:107], v[88:91]
    v_lshrrev_b32_e64 v15, 2, v1
    v_mfma_f32_16x16x32_bf16 v[92:95], a[100:103], a[108:111], v[92:95]
    s_waitcnt lgkmcnt(0)
    v_mfma_f32_16x16x32_bf16 v[32:35], a[32:35], a[64:67], v[32:35]
    ds_read_b128 a[104:107], v151 offset:0
    v_lshl_add_u32 v12, v2, 3, v15
    v_mfma_f32_16x16x32_bf16 v[36:39], a[32:35], a[68:71], v[36:39]
    ds_read_b128 a[108:111], v151 offset:8192
    v_lshlrev_b32 v14, 3, v14
    v_mfma_f32_16x16x32_bf16 v[40:43], a[36:39], a[64:67], v[40:43]
    ds_read_b128 a[72:75], v149 offset:0
    v_lshl_or_b32 v14, v15, 1, v14
    v_mfma_f32_16x16x32_bf16 v[44:47], a[36:39], a[68:71], v[44:47]
    v_bfe_u32 v15, v1, 1, 1
    v_mfma_f32_16x16x32_bf16 v[48:51], a[40:43], a[64:67], v[48:51]
    ds_read_b128 a[76:79], v149 offset:2048
    v_xor_b32_e64 v14, v14, v15
    v_mfma_f32_16x16x32_bf16 v[52:55], a[40:43], a[68:71], v[52:55]
    ds_read_b128 a[80:83], v149 offset:4096
    v_lshl_add_u32 v12, v12, 4, v14
    v_mfma_f32_16x16x32_bf16 v[56:59], a[44:47], a[64:67], v[56:59]
    v_and_b32_e64 v15, 1, v1
    v_mfma_f32_16x16x32_bf16 v[60:63], a[44:47], a[68:71], v[60:63]
    ds_read_b128 a[84:87], v149 offset:6144
    v_lshl_add_u32 v12, v12, 1, v15
    v_mfma_f32_16x16x32_bf16 v[64:67], a[48:51], a[64:67], v[64:67]
    ds_read_b128 a[88:91], v149 offset:8192
    s_lshl_b32 s38, s94, 5
    v_mfma_f32_16x16x32_bf16 v[68:71], a[48:51], a[68:71], v[68:71]
    ds_read_b128 a[92:95], v149 offset:10240
    s_add_u32 s38, s38, 131072
    v_mfma_f32_16x16x32_bf16 v[72:75], a[52:55], a[64:67], v[72:75]
    v_lshlrev_b32 v12, 3, v12
    v_mfma_f32_16x16x32_bf16 v[76:79], a[52:55], a[68:71], v[76:79]
    ds_read_b128 a[96:99], v149 offset:12288
    v_xor_b32_e64 v220, s38, v12
    v_mfma_f32_16x16x32_bf16 v[80:83], a[56:59], a[64:67], v[80:83]
    ds_read_b128 a[100:103], v149 offset:14336
    v_xor_b32_e64 v221, 16, v220
    v_mfma_f32_16x16x32_bf16 v[84:87], a[56:59], a[68:71], v[84:87]
    v_xor_b32_e64 v222, 64, v220
    v_mfma_f32_16x16x32_bf16 v[88:91], a[60:63], a[64:67], v[88:91]
    v_xor_b32 v223, 80, v220
    v_mfma_f32_16x16x32_bf16 v[92:95], a[60:63], a[68:71], v[92:95]
    s_waitcnt lgkmcnt(0) vmcnt(10)
    s_barrier
    v_mfma_f32_16x16x32_bf16 v[32:35], a[72:75], a[104:107], v[32:35]
    ds_read_b128 a[64:67], v150 offset:32768
    s_bfe_u32 s72, s97, 262148
    v_and_b32_e64 v8, 1, v2
    v_mfma_f32_16x16x32_bf16 v[36:39], a[72:75], a[108:111], v[36:39]
    ds_read_b128 a[68:71], v150 offset:40960
    v_lshrrev_b32_e64 v9, 1, v1
    v_mfma_f32_16x16x32_bf16 v[40:43], a[76:79], a[104:107], v[40:43]
    ds_read_b128 a[32:35], v148 offset:32768
    v_xor_b32_e64 v8, v8, v9
    v_mfma_f32_16x16x32_bf16 v[44:47], a[76:79], a[108:111], v[44:47]
    v_lshlrev_b32_e64 v8, 4, v8
    v_mfma_f32_16x16x32_bf16 v[48:51], a[80:83], a[104:107], v[48:51]
    ds_read_b128 a[36:39], v148 offset:34816
    s_add_u32 m0, s37, 16384
    v_lshl_add_u32 v8, v1, 7, v8
    v_mfma_f32_16x16x32_bf16 v[52:55], a[80:83], a[108:111], v[52:55]
    ds_read_b128 a[40:43], v148 offset:36864
    v_lshrrev_b32_e64 v9, 1, v2
    v_mfma_f32_16x16x32_bf16 v[56:59], a[84:87], a[104:107], v[56:59]
    v_lshl_add_u32 v20, v9, 13, v8
    v_mfma_f32_16x16x32_bf16 v[60:63], a[84:87], a[108:111], v[60:63]
    ds_read_b128 a[44:47], v148 offset:38912
    v_lshlrev_b32_e64 v9, 12, v2
    v_mfma_f32_16x16x32_bf16 v[64:67], a[88:91], a[104:107], v[64:67]
    ds_read_b128 a[48:51], v148 offset:40960
    s_lshl_b32 s72, s72, 7
    v_lshl_add_u32 v24, v1, 4, v9
    v_mfma_f32_16x16x32_bf16 v[68:71], a[88:91], a[108:111], v[68:71]
    ds_read_b128 a[52:55], v148 offset:43008
    v_xor_b32 v21, 32, v20
    v_mfma_f32_16x16x32_bf16 v[72:75], a[92:95], a[104:107], v[72:75]
    v_add_u32 v25, 16384, v24
    v_mfma_f32_16x16x32_bf16 v[76:79], a[92:95], a[108:111], v[76:79]
    ds_read_b128 a[56:59], v148 offset:45056
    v_xor_b32_e64 v22, 64, v20
    v_mfma_f32_16x16x32_bf16 v[80:83], a[96:99], a[104:107], v[80:83]
    ds_read_b128 a[60:63], v148 offset:47104
    buffer_load_dwordx4 v16, s[16:19], s72 offen offset:0  lds
    v_add_u32 v26, 32768, v24
    v_mfma_f32_16x16x32_bf16 v[84:87], a[96:99], a[108:111], v[84:87]
    v_xor_b32 v23, 96, v20
    v_mfma_f32_16x16x32_bf16 v[88:91], a[100:103], a[104:107], v[88:91]
    v_add_u32 v27, 49152, v24
    v_mfma_f32_16x16x32_bf16 v[92:95], a[100:103], a[108:111], v[92:95]
    s_waitcnt lgkmcnt(0)
    v_mfma_f32_16x16x32_bf16 v[32:35], a[32:35], a[64:67], v[32:35]
    ds_read_b128 a[104:107], v151 offset:32768
    buffer_load_dwordx4 v17, s[16:19], s72 offen offset:1024  lds
    v_add_u32 v28, 131072, v3
    v_mfma_f32_16x16x32_bf16 v[36:39], a[32:35], a[68:71], v[36:39]
    ds_read_b128 a[108:111], v151 offset:40960
    v_mfma_f32_16x16x32_bf16 v[40:43], a[36:39], a[64:67], v[40:43]
    ds_read_b128 a[72:75], v149 offset:32768
    v_mfma_f32_16x16x32_bf16 v[44:47], a[36:39], a[68:71], v[44:47]
    v_mfma_f32_16x16x32_bf16 v[48:51], a[40:43], a[64:67], v[48:51]
    ds_read_b128 a[76:79], v149 offset:34816
    v_mfma_f32_16x16x32_bf16 v[52:55], a[40:43], a[68:71], v[52:55]
    ds_read_b128 a[80:83], v149 offset:36864
    buffer_load_dwordx4 v18, s[16:19], s72 offen offset:2048  lds
    v_mfma_f32_16x16x32_bf16 v[56:59], a[44:47], a[64:67], v[56:59]
    v_mfma_f32_16x16x32_bf16 v[60:63], a[44:47], a[68:71], v[60:63]
    ds_read_b128 a[84:87], v149 offset:38912
    v_mfma_f32_16x16x32_bf16 v[64:67], a[48:51], a[64:67], v[64:67]
    ds_read_b128 a[88:91], v149 offset:40960
    v_mfma_f32_16x16x32_bf16 v[68:71], a[48:51], a[68:71], v[68:71]
    ds_read_b128 a[92:95], v149 offset:43008
    v_mfma_f32_16x16x32_bf16 v[72:75], a[52:55], a[64:67], v[72:75]
    buffer_load_dwordx4 v19, s[16:19], s72 offen offset:3072  lds
    v_mfma_f32_16x16x32_bf16 v[76:79], a[52:55], a[68:71], v[76:79]
    ds_read_b128 a[96:99], v149 offset:45056
    v_mfma_f32_16x16x32_bf16 v[80:83], a[56:59], a[64:67], v[80:83]
    ds_read_b128 a[100:103], v149 offset:47104
    v_mfma_f32_16x16x32_bf16 v[84:87], a[56:59], a[68:71], v[84:87]
    v_mfma_f32_16x16x32_bf16 v[88:91], a[60:63], a[64:67], v[88:91]
    v_mfma_f32_16x16x32_bf16 v[92:95], a[60:63], a[68:71], v[92:95]
    s_waitcnt lgkmcnt(0) vmcnt(9)
    s_barrier
    v_mfma_f32_16x16x32_bf16 v[32:35], a[72:75], a[104:107], v[32:35]
    ds_read_b128 a[32:35], v28 offset:0
    v_lshlrev_b32 v12, 2, v2
    v_sub_u32_e64 v12, s32, v12
    v_mfma_f32_16x16x32_bf16 v[36:39], a[72:75], a[108:111], v[36:39]
    ds_read_b128 a[36:39], v28 offset:1024
    v_lshlrev_b32_e64 v12, 10, v12
    v_mfma_f32_16x16x32_bf16 v[40:43], a[76:79], a[104:107], v[40:43]
    ds_read_b128 a[40:43], v28 offset:2048
    v_lshl_add_u32 v12, v1, 4, v12
    v_subrev_u32 v148, 1024, v12
    v_mfma_f32_16x16x32_bf16 v[44:47], a[76:79], a[108:111], v[44:47]
    v_min_u32_e64 v148, 2.0, v148
    v_mfma_f32_16x16x32_bf16 v[48:51], a[80:83], a[104:107], v[48:51]
    ds_read_b128 a[44:47], v28 offset:3072
    v_subrev_u32 v149, 2048, v12
    v_min_u32_e64 v149, 2.0, v149
    v_mfma_f32_16x16x32_bf16 v[52:55], a[80:83], a[108:111], v[52:55]
    ds_read_b128 a[48:51], v28 offset:4096
    v_subrev_u32 v150, 3072, v12
    v_mfma_f32_16x16x32_bf16 v[56:59], a[84:87], a[104:107], v[56:59]
    ds_read_b128 a[52:55], v28 offset:5120
    v_min_u32_e64 v150, 2.0, v150
    v_subrev_u32 v151, 4096, v12
    v_mfma_f32_16x16x32_bf16 v[60:63], a[84:87], a[108:111], v[60:63]
    v_min_u32_e64 v151, 2.0, v151
    v_mfma_f32_16x16x32_bf16 v[64:67], a[88:91], a[104:107], v[64:67]
    ds_read_b128 a[56:59], v28 offset:6144
    v_mov_b32 v186, s35
    v_mov_b32 v187, s35
    v_mfma_f32_16x16x32_bf16 v[68:71], a[88:91], a[108:111], v[68:71]
    ds_read_b128 a[60:63], v28 offset:7168
    s_lshl_b32 s38, s32, 10
    v_mfma_f32_16x16x32_bf16 v[72:75], a[92:95], a[104:107], v[72:75]
    s_add_u32 s38, s38, s93
    v_cmp_gt_u32 s[78:79], 16, v0
    v_mfma_f32_16x16x32_bf16 v[76:79], a[92:95], a[108:111], v[76:79]
    v_cmp_eq_u32 s[46:47], 2, v2
    v_mfma_f32_16x16x32_bf16 v[80:83], a[96:99], a[104:107], v[80:83]
    v_cmp_eq_u32 s[44:45], 3, v2
    v_cndmask_b32 v188, 2.0, v3, s[78:79]
    v_mfma_f32_16x16x32_bf16 v[84:87], a[96:99], a[108:111], v[84:87]
    v_cmp_ne_u32 s[80:81], 2.0, v148
    v_mfma_f32_16x16x32_bf16 v[88:91], a[100:103], a[104:107], v[88:91]
    v_cmp_ne_u32 s[82:83], 2.0, v149
    v_cmp_ne_u32 s[84:85], 2.0, v150
    v_mfma_f32_16x16x32_bf16 v[92:95], a[100:103], a[108:111], v[92:95]
    v_cmp_ne_u32 s[86:87], 2.0, v151
    v_pk_fma_f32 v[4:5], v[32:33], v[128:129], v[34:35] op_sel_hi:[1,0,1]
    v_pk_fma_f32 v[6:7], v[36:37], v[128:129], v[38:39] op_sel_hi:[1,0,1]
    v_pk_fma_f32 v[4:5], v[36:37], v[128:129], v[4:5] op_sel:[0,1,0] neg_lo:[1,0,0] neg_hi:[1,0,0]
    v_pk_fma_f32 v[6:7], v[32:33], v[128:129], v[6:7] op_sel:[0,1,0]
    v_pk_fma_f32 v[8:9], v[4:5], v[128:129], v[40:41] op_sel_hi:[1,0,1]
    v_pk_fma_f32 v[10:11], v[6:7], v[128:129], v[44:45] op_sel_hi:[1,0,1]
    v_pk_fma_f32 v[8:9], v[6:7], v[128:129], v[8:9] op_sel:[0,1,0] neg_lo:[1,0,0] neg_hi:[1,0,0]
    v_pk_fma_f32 v[10:11], v[4:5], v[128:129], v[10:11] op_sel:[0,1,0]
    v_pk_fma_f32 v[4:5], v[8:9], v[128:129], v[42:43] op_sel_hi:[1,0,1]
    v_pk_fma_f32 v[6:7], v[10:11], v[128:129], v[46:47] op_sel_hi:[1,0,1]
    v_pk_fma_f32 v[4:5], v[10:11], v[128:129], v[4:5] op_sel:[0,1,0] neg_lo:[1,0,0] neg_hi:[1,0,0]
    v_pk_fma_f32 v[6:7], v[8:9], v[128:129], v[6:7] op_sel:[0,1,0]
    v_pk_fma_f32 v[8:9], v[4:5], v[128:129], v[48:49] op_sel_hi:[1,0,1]
    v_pk_fma_f32 v[10:11], v[6:7], v[128:129], v[52:53] op_sel_hi:[1,0,1]
    v_pk_fma_f32 v[8:9], v[6:7], v[128:129], v[8:9] op_sel:[0,1,0] neg_lo:[1,0,0] neg_hi:[1,0,0]
    v_pk_fma_f32 v[10:11], v[4:5], v[128:129], v[10:11] op_sel:[0,1,0]
    v_pk_fma_f32 v[4:5], v[8:9], v[128:129], v[50:51] op_sel_hi:[1,0,1]
    v_pk_fma_f32 v[6:7], v[10:11], v[128:129], v[54:55] op_sel_hi:[1,0,1]
    v_pk_fma_f32 v[4:5], v[10:11], v[128:129], v[4:5] op_sel:[0,1,0] neg_lo:[1,0,0] neg_hi:[1,0,0]
    v_pk_fma_f32 v[6:7], v[8:9], v[128:129], v[6:7] op_sel:[0,1,0]
    v_pk_fma_f32 v[8:9], v[4:5], v[128:129], v[56:57] op_sel_hi:[1,0,1]
    v_pk_fma_f32 v[10:11], v[6:7], v[128:129], v[60:61] op_sel_hi:[1,0,1]
    v_pk_fma_f32 v[8:9], v[6:7], v[128:129], v[8:9] op_sel:[0,1,0] neg_lo:[1,0,0] neg_hi:[1,0,0]
    v_pk_fma_f32 v[10:11], v[4:5], v[128:129], v[10:11] op_sel:[0,1,0]
    v_pk_fma_f32 v[4:5], v[8:9], v[128:129], v[58:59] op_sel_hi:[1,0,1]
    v_pk_fma_f32 v[6:7], v[10:11], v[128:129], v[62:63] op_sel_hi:[1,0,1]
    v_pk_fma_f32 v[4:5], v[10:11], v[128:129], v[4:5] op_sel:[0,1,0] neg_lo:[1,0,0] neg_hi:[1,0,0]
    v_pk_fma_f32 v[6:7], v[8:9], v[128:129], v[6:7] op_sel:[0,1,0]
    v_pk_fma_f32 v[8:9], v[4:5], v[128:129], v[64:65] op_sel_hi:[1,0,1]
    v_pk_fma_f32 v[10:11], v[6:7], v[128:129], v[68:69] op_sel_hi:[1,0,1]
    v_pk_fma_f32 v[8:9], v[6:7], v[128:129], v[8:9] op_sel:[0,1,0] neg_lo:[1,0,0] neg_hi:[1,0,0]
    v_pk_fma_f32 v[10:11], v[4:5], v[128:129], v[10:11] op_sel:[0,1,0]
    v_pk_fma_f32 v[4:5], v[8:9], v[128:129], v[66:67] op_sel_hi:[1,0,1]
    v_pk_fma_f32 v[6:7], v[10:11], v[128:129], v[70:71] op_sel_hi:[1,0,1]
    v_pk_fma_f32 v[4:5], v[10:11], v[128:129], v[4:5] op_sel:[0,1,0] neg_lo:[1,0,0] neg_hi:[1,0,0]
    v_pk_fma_f32 v[6:7], v[8:9], v[128:129], v[6:7] op_sel:[0,1,0]
    v_pk_fma_f32 v[8:9], v[4:5], v[128:129], v[72:73] op_sel_hi:[1,0,1]
    v_pk_fma_f32 v[10:11], v[6:7], v[128:129], v[76:77] op_sel_hi:[1,0,1]
    v_pk_fma_f32 v[8:9], v[6:7], v[128:129], v[8:9] op_sel:[0,1,0] neg_lo:[1,0,0] neg_hi:[1,0,0]
    v_pk_fma_f32 v[10:11], v[4:5], v[128:129], v[10:11] op_sel:[0,1,0]
    v_pk_fma_f32 v[4:5], v[8:9], v[128:129], v[74:75] op_sel_hi:[1,0,1]
    v_pk_fma_f32 v[6:7], v[10:11], v[128:129], v[78:79] op_sel_hi:[1,0,1]
    v_pk_fma_f32 v[4:5], v[10:11], v[128:129], v[4:5] op_sel:[0,1,0] neg_lo:[1,0,0] neg_hi:[1,0,0]
    v_pk_fma_f32 v[6:7], v[8:9], v[128:129], v[6:7] op_sel:[0,1,0]
    v_pk_fma_f32 v[8:9], v[4:5], v[128:129], v[80:81] op_sel_hi:[1,0,1]
    v_pk_fma_f32 v[10:11], v[6:7], v[128:129], v[84:85] op_sel_hi:[1,0,1]
    v_pk_fma_f32 v[8:9], v[6:7], v[128:129], v[8:9] op_sel:[0,1,0] neg_lo:[1,0,0] neg_hi:[1,0,0]
    v_pk_fma_f32 v[10:11], v[4:5], v[128:129], v[10:11] op_sel:[0,1,0]
    v_pk_fma_f32 v[4:5], v[8:9], v[128:129], v[82:83] op_sel_hi:[1,0,1]
    v_pk_fma_f32 v[6:7], v[10:11], v[128:129], v[86:87] op_sel_hi:[1,0,1]
    v_pk_fma_f32 v[4:5], v[10:11], v[128:129], v[4:5] op_sel:[0,1,0] neg_lo:[1,0,0] neg_hi:[1,0,0]
    v_pk_fma_f32 v[6:7], v[8:9], v[128:129], v[6:7] op_sel:[0,1,0]
    v_pk_fma_f32 v[8:9], v[4:5], v[128:129], v[88:89] op_sel_hi:[1,0,1]
    v_pk_fma_f32 v[10:11], v[6:7], v[128:129], v[92:93] op_sel_hi:[1,0,1]
    v_pk_fma_f32 v[8:9], v[6:7], v[128:129], v[8:9] op_sel:[0,1,0] neg_lo:[1,0,0] neg_hi:[1,0,0]
    v_pk_fma_f32 v[10:11], v[4:5], v[128:129], v[10:11] op_sel:[0,1,0]
    v_pk_fma_f32 v[4:5], v[8:9], v[128:129], v[90:91] op_sel_hi:[1,0,1]
    v_pk_fma_f32 v[6:7], v[10:11], v[128:129], v[94:95] op_sel_hi:[1,0,1]
    v_pk_fma_f32 v[4:5], v[10:11], v[128:129], v[4:5] op_sel:[0,1,0] neg_lo:[1,0,0] neg_hi:[1,0,0]
    v_pk_fma_f32 v[6:7], v[8:9], v[128:129], v[6:7] op_sel:[0,1,0]
    v_pk_mul_f32 v[142:143], v[4:5], v[130:131] op_sel_hi:[1,0]
    v_pk_mul_f32 v[144:145], v[6:7], v[130:131] op_sel_hi:[1,0]
    v_pk_fma_f32 v[142:143], v[6:7], v[130:131], v[142:143] op_sel:[0,1,0] neg_lo:[1,0,0] neg_hi:[1,0,0]
    v_pk_fma_f32 v[144:145], v[4:5], v[130:131], v[144:145] op_sel:[0,1,0]
    s_waitcnt lgkmcnt(4)
    v_mfma_f32_16x16x32_bf16 v[224:227], a[32:35], a[0:3], 0
    ds_read_b128 a[64:67], v28 offset:8192
    v_fma_f32 v4, v142, v132, v143
    v_fma_f32 v8, v142, v133, v145
    v_mfma_f32_16x16x32_bf16 v[228:231], a[32:35], a[4:7], 0
    ds_read_b128 a[68:71], v28 offset:9216
    v_fma_f32 v4, -v144, v133, v4
    v_mfma_f32_16x16x32_bf16 v[224:227], a[36:39], a[8:11], v[224:227]
    ds_read_b128 a[72:75], v28 offset:10240
    v_fma_f32 v8, v144, v132, v8
    v_mov_b32 v6, v4
    v_mfma_f32_16x16x32_bf16 v[228:231], a[36:39], a[12:15], v[228:231]
    ds_read_b128 a[76:79], v28 offset:11264
    v_mov_b32_e64 v10, v8
    v_mfma_f32_16x16x32_bf16 v[224:227], a[40:43], a[16:19], v[224:227]
    ds_read_b128 a[80:83], v28 offset:12288
    v_permlane32_swap_b32 v4, v6
    v_mfma_f32_16x16x32_bf16 v[228:231], a[40:43], a[20:23], v[228:231]
    ds_read_b128 a[84:87], v28 offset:13312
    v_permlane32_swap_b32 v8, v10
    v_mov_b32_e64 v5, v4
    v_mfma_f32_16x16x32_bf16 v[224:227], a[44:47], a[24:27], v[224:227]
    ds_read_b128 a[88:91], v28 offset:14336
    v_mov_b32_e64 v7, v6
    v_mfma_f32_16x16x32_bf16 v[228:231], a[44:47], a[28:31], v[228:231]
    ds_read_b128 a[92:95], v28 offset:15360
    v_mov_b32 v9, v8
    v_mov_b32 v11, v10
    s_waitcnt lgkmcnt(8)
    s_bfe_u32 s72, s97, 262152
    v_permlane16_swap_b32 v4, v5
    v_mfma_f32_16x16x32_bf16 v[232:235], a[48:51], a[0:3], 0
    s_add_u32 m0, s37, 32768
    v_permlane16_swap_b32 v6, v7
    v_mfma_f32_16x16x32_bf16 v[236:239], a[48:51], a[4:7], 0
    v_permlane16_swap_b32 v8, v9
    v_permlane16_swap_b32 v10, v11
    v_mfma_f32_16x16x32_bf16 v[232:235], a[52:55], a[8:11], v[232:235]
    s_lshl_b32 s72, s72, 7
    v_fma_f32 v12, v4, v134, v5
    v_mfma_f32_16x16x32_bf16 v[236:239], a[52:55], a[12:15], v[236:239]
    v_fma_f32 v13, v4, v135, v9
    v_mfma_f32_16x16x32_bf16 v[232:235], a[56:59], a[16:19], v[232:235]
    buffer_load_dwordx4 v16, s[16:19], s72 offen offset:0  lds
    v_fma_f32 v12, -v8, v135, v12
    v_fma_f32 v13, v8, v134, v13
    v_mfma_f32_16x16x32_bf16 v[236:239], a[56:59], a[20:23], v[236:239]
    v_fma_f32 v14, v12, v134, v6
    v_mfma_f32_16x16x32_bf16 v[232:235], a[60:63], a[24:27], v[232:235]
    buffer_load_dwordx4 v17, s[16:19], s72 offen offset:1024  lds
    v_fma_f32 v15, v12, v135, v10
    v_fma_f32 v14, -v13, v135, v14
    v_mfma_f32_16x16x32_bf16 v[236:239], a[60:63], a[28:31], v[236:239]
    v_fma_f32 v15, v13, v134, v15
    s_waitcnt lgkmcnt(4)
    buffer_load_dwordx4 v18, s[16:19], s72 offen offset:2048  lds
    v_fma_f32 v184, v14, v134, v7
    v_mfma_f32_16x16x32_bf16 v[240:243], a[64:67], a[0:3], 0
    v_fma_f32 v185, v14, v135, v11
    v_fma_f32 v184, -v15, v135, v184
    v_mfma_f32_16x16x32_bf16 v[244:247], a[64:67], a[4:7], 0
    buffer_load_dwordx4 v19, s[16:19], s72 offen offset:3072  lds
    v_fma_f32 v185, v15, v134, v185
    v_mfma_f32_16x16x32_bf16 v[240:243], a[68:71], a[8:11], v[240:243]
    buffer_store_dwordx4 v[184:187], v188, s[24:27], s38 offen sc1
    v_mfma_f32_16x16x32_bf16 v[244:247], a[68:71], a[12:15], v[244:247]
    s_bfe_u32 s72, s97, 262144
    v_cndmask_b32 v146, v4, 0, s[78:79]
    v_mfma_f32_16x16x32_bf16 v[240:243], a[72:75], a[16:19], v[240:243]
    v_cndmask_b32 v147, v8, 0, s[78:79]
    v_mfma_f32_16x16x32_bf16 v[244:247], a[72:75], a[20:23], v[244:247]
    s_add_u32 m0, s37, 0
    v_cndmask_b32 v146, v146, v12, s[46:47]
    v_cndmask_b32 v147, v147, v13, s[46:47]
    v_mfma_f32_16x16x32_bf16 v[240:243], a[76:79], a[24:27], v[240:243]
    v_cndmask_b32 v146, v146, v14, s[44:45]
    v_mfma_f32_16x16x32_bf16 v[244:247], a[76:79], a[28:31], v[244:247]
    s_lshl_b32 s72, s72, 7
    v_cndmask_b32 v147, v147, v15, s[44:45]
    s_waitcnt lgkmcnt(0) vmcnt(9)
    v_lshlrev_b32_e64 v152, 16, v200
    v_mfma_f32_16x16x32_bf16 v[248:251], a[80:83], a[0:3], 0
    buffer_load_dwordx4 v16, s[16:19], s72 offen offset:0  lds
    v_and_b32 v160, 0xffff0000, v200
    v_lshlrev_b32_e64 v168, 16, v201
    v_mfma_f32_16x16x32_bf16 v[252:255], a[80:83], a[4:7], 0
    v_and_b32 v176, 0xffff0000, v201
    v_lshlrev_b32_e64 v153, 16, v202
    v_mfma_f32_16x16x32_bf16 v[248:251], a[84:87], a[8:11], v[248:251]
    buffer_load_dwordx4 v17, s[16:19], s72 offen offset:1024  lds
    v_and_b32 v161, 0xffff0000, v202
    v_lshlrev_b32_e64 v169, 16, v203
    v_mfma_f32_16x16x32_bf16 v[252:255], a[84:87], a[12:15], v[252:255]
    v_and_b32 v177, 0xffff0000, v203
    v_lshlrev_b32_e64 v154, 16, v204
    v_mfma_f32_16x16x32_bf16 v[248:251], a[88:91], a[16:19], v[248:251]
    buffer_load_dwordx4 v18, s[16:19], s72 offen offset:2048  lds
    v_and_b32 v162, 0xffff0000, v204
    v_lshlrev_b32_e64 v170, 16, v205
    v_mfma_f32_16x16x32_bf16 v[252:255], a[88:91], a[20:23], v[252:255]
    v_and_b32 v178, 0xffff0000, v205
    v_lshlrev_b32_e64 v155, 16, v206
    v_mfma_f32_16x16x32_bf16 v[248:251], a[92:95], a[24:27], v[248:251]
    buffer_load_dwordx4 v19, s[16:19], s72 offen offset:3072  lds
    v_and_b32 v163, 0xffff0000, v206
    v_lshlrev_b32_e64 v171, 16, v207
    v_mfma_f32_16x16x32_bf16 v[252:255], a[92:95], a[28:31], v[252:255]
    v_and_b32 v179, 0xffff0000, v207
    v_pk_mul_f32 v[4:5], v[224:225], v[96:97] op_sel_hi:[1,0]
    v_pk_mul_f32 v[6:7], v[228:229], v[96:97] op_sel_hi:[1,0]
    v_pk_fma_f32 v[4:5], v[228:229], v[96:97], v[4:5] op_sel:[0,1,0]
    v_pk_fma_f32 v[6:7], v[224:225], v[96:97], v[6:7] op_sel:[0,1,0] neg_lo:[1,0,0] neg_hi:[1,0,0]
    v_pk_mul_f32 v[8:9], v[226:227], v[98:99] op_sel_hi:[1,0]
    v_pk_mul_f32 v[10:11], v[230:231], v[98:99] op_sel_hi:[1,0]
    v_pk_fma_f32 v[8:9], v[230:231], v[98:99], v[8:9] op_sel:[0,1,0]
    v_pk_fma_f32 v[10:11], v[226:227], v[98:99], v[10:11] op_sel:[0,1,0] neg_lo:[1,0,0] neg_hi:[1,0,0]
    v_cvt_pk_bf16_f32 v184, v4, v6
    v_cvt_pk_bf16_f32 v192, v5, v7
    v_cvt_pk_bf16_f32 v188, v8, v10
    v_cvt_pk_bf16_f32 v196, v9, v11
    v_pk_mul_f32 v[4:5], v[232:233], v[100:101] op_sel_hi:[1,0]
    v_pk_mul_f32 v[6:7], v[236:237], v[100:101] op_sel_hi:[1,0]
    v_pk_fma_f32 v[4:5], v[236:237], v[100:101], v[4:5] op_sel:[0,1,0]
    v_pk_fma_f32 v[6:7], v[232:233], v[100:101], v[6:7] op_sel:[0,1,0] neg_lo:[1,0,0] neg_hi:[1,0,0]
    v_pk_mul_f32 v[8:9], v[234:235], v[102:103] op_sel_hi:[1,0]
    v_pk_mul_f32 v[10:11], v[238:239], v[102:103] op_sel_hi:[1,0]
    v_pk_fma_f32 v[8:9], v[238:239], v[102:103], v[8:9] op_sel:[0,1,0]
    v_pk_fma_f32 v[10:11], v[234:235], v[102:103], v[10:11] op_sel:[0,1,0] neg_lo:[1,0,0] neg_hi:[1,0,0]
    v_cvt_pk_bf16_f32 v185, v4, v6
    v_cvt_pk_bf16_f32 v193, v5, v7
    v_cvt_pk_bf16_f32 v189, v8, v10
    v_cvt_pk_bf16_f32 v197, v9, v11
    v_pk_mul_f32 v[4:5], v[240:241], v[104:105] op_sel_hi:[1,0]
    v_pk_mul_f32 v[6:7], v[244:245], v[104:105] op_sel_hi:[1,0]
    v_pk_fma_f32 v[4:5], v[244:245], v[104:105], v[4:5] op_sel:[0,1,0]
    v_pk_fma_f32 v[6:7], v[240:241], v[104:105], v[6:7] op_sel:[0,1,0] neg_lo:[1,0,0] neg_hi:[1,0,0]
    v_pk_mul_f32 v[8:9], v[242:243], v[106:107] op_sel_hi:[1,0]
    v_pk_mul_f32 v[10:11], v[246:247], v[106:107] op_sel_hi:[1,0]
    v_pk_fma_f32 v[8:9], v[246:247], v[106:107], v[8:9] op_sel:[0,1,0]
    v_pk_fma_f32 v[10:11], v[242:243], v[106:107], v[10:11] op_sel:[0,1,0] neg_lo:[1,0,0] neg_hi:[1,0,0]
    v_cvt_pk_bf16_f32 v186, v4, v6
    v_cvt_pk_bf16_f32 v194, v5, v7
    v_cvt_pk_bf16_f32 v190, v8, v10
    v_cvt_pk_bf16_f32 v198, v9, v11
    v_pk_mul_f32 v[4:5], v[248:249], v[108:109] op_sel_hi:[1,0]
    v_pk_mul_f32 v[6:7], v[252:253], v[108:109] op_sel_hi:[1,0]
    v_pk_fma_f32 v[4:5], v[252:253], v[108:109], v[4:5] op_sel:[0,1,0]
    v_pk_fma_f32 v[6:7], v[248:249], v[108:109], v[6:7] op_sel:[0,1,0] neg_lo:[1,0,0] neg_hi:[1,0,0]
    v_pk_mul_f32 v[8:9], v[250:251], v[110:111] op_sel_hi:[1,0]
    v_pk_mul_f32 v[10:11], v[254:255], v[110:111] op_sel_hi:[1,0]
    v_pk_fma_f32 v[8:9], v[254:255], v[110:111], v[8:9] op_sel:[0,1,0]
    v_pk_fma_f32 v[10:11], v[250:251], v[110:111], v[10:11] op_sel:[0,1,0] neg_lo:[1,0,0] neg_hi:[1,0,0]
    v_cvt_pk_bf16_f32 v187, v4, v6
    v_cvt_pk_bf16_f32 v195, v5, v7
    v_cvt_pk_bf16_f32 v191, v8, v10
    v_cvt_pk_bf16_f32 v199, v9, v11
    v_mfma_f32_16x16x32_bf16 v[224:227], a[224:227], v[184:187], 0
    s_xor_b32 s40, s92, 0
    v_lshlrev_b32 v156, 16, v208
    v_and_b32 v164, 0xffff0000, v208
    v_mfma_f32_16x16x32_bf16 v[228:231], a[228:231], v[184:187], 0
    v_lshlrev_b32_e64 v172, 16, v209
    v_and_b32 v180, 0xffff0000, v209
    v_mfma_f32_16x16x32_bf16 v[232:235], a[248:251], v[188:191], 0
    v_lshlrev_b32_e64 v157, 16, v210
    v_and_b32 v165, 0xffff0000, v210
    v_mfma_f32_16x16x32_bf16 v[236:239], a[252:255], v[188:191], 0
    v_lshlrev_b32_e64 v173, 16, v211
    v_and_b32 v181, 0xffff0000, v211
    v_mfma_f32_16x16x32_bf16 v[240:243], a[224:227], v[192:195], 0
    buffer_load_dword a223, v29, s[16:19], s40 offen
    v_lshlrev_b32_e64 v158, 16, v212
    v_and_b32 v166, 0xffff0000, v212
    v_mfma_f32_16x16x32_bf16 v[244:247], a[228:231], v[192:195], 0
    v_lshlrev_b32_e64 v174, 16, v213
    v_and_b32 v182, 0xffff0000, v213
    v_mfma_f32_16x16x32_bf16 v[248:251], a[248:251], v[196:199], 0
    v_lshlrev_b32_e64 v159, 16, v214
    v_and_b32 v167, 0xffff0000, v214
    v_mfma_f32_16x16x32_bf16 v[252:255], a[252:255], v[196:199], 0
    v_lshlrev_b32_e64 v175, 16, v215
    v_and_b32 v183, 0xffff0000, v215
    v_accvgpr_read_b32 v28, a222
    v_cmp_ne_u32 s[78:79], s96, v28
    s_nop 0
    s_and_b32 s78, s78, 0x5555
    s_cmp_eq_u32 s78, 0
    s_cselect_b32 s50, 0, 2.0
    s_cselect_b32 s7, 2.0, 0
    v_pk_add_f32 v[224:225], v[224:225], v[232:233]
    v_pk_add_f32 v[226:227], v[226:227], v[234:235]
    v_pk_add_f32 v[228:229], v[228:229], v[236:237]
    v_pk_add_f32 v[230:231], v[230:231], v[238:239]
    v_pk_fma_f32 v[232:233], v[232:233], -2.0, v[224:225] op_sel_hi:[1,0,1]
    v_pk_fma_f32 v[234:235], v[234:235], -2.0, v[226:227] op_sel_hi:[1,0,1]
    v_pk_fma_f32 v[236:237], v[236:237], -2.0, v[228:229] op_sel_hi:[1,0,1]
    v_pk_fma_f32 v[238:239], v[238:239], -2.0, v[230:231] op_sel_hi:[1,0,1]
    v_pk_add_f32 v[240:241], v[240:241], v[248:249]
    v_pk_add_f32 v[242:243], v[242:243], v[250:251]
    v_pk_add_f32 v[244:245], v[244:245], v[252:253]
    v_pk_add_f32 v[246:247], v[246:247], v[254:255]
    v_pk_fma_f32 v[248:249], v[248:249], -2.0, v[240:241] op_sel_hi:[1,0,1]
    v_pk_fma_f32 v[250:251], v[250:251], -2.0, v[242:243] op_sel_hi:[1,0,1]
    v_pk_fma_f32 v[252:253], v[252:253], -2.0, v[244:245] op_sel_hi:[1,0,1]
    v_pk_fma_f32 v[254:255], v[254:255], -2.0, v[246:247] op_sel_hi:[1,0,1]
    s_cmp_eq_u32 s2, 0
    s_cbranch_scc1 K_SPECIAL
    v_pk_fma_f32 v[4:5], v[224:225], s[42:43], v[244:245] op_sel_hi:[1,0,1]
    v_pk_fma_f32 v[6:7], v[228:229], s[42:43], v[240:241] op_sel_hi:[1,0,1] neg_lo:[0,0,1] neg_hi:[0,0,1]
    v_pk_fma_f32 v[8:9], v[240:241], s[42:43], v[228:229] op_sel_hi:[1,0,1]
    v_pk_fma_f32 v[10:11], v[244:245], s[42:43], v[224:225] op_sel_hi:[1,0,1] neg_lo:[0,0,1] neg_hi:[0,0,1]
    v_pk_mul_f32 v[224:225], v[4:5], v[152:153]
    v_pk_mul_f32 v[228:229], v[6:7], v[152:153]
    v_pk_mul_f32 v[240:241], v[8:9], v[168:169]
    v_pk_mul_f32 v[244:245], v[10:11], v[168:169]
    v_pk_fma_f32 v[152:153], v[6:7], v[160:161], v[224:225] neg_lo:[1,0,0] neg_hi:[1,0,0]
    v_pk_fma_f32 v[160:161], v[4:5], v[160:161], v[228:229]
    v_pk_fma_f32 v[168:169], v[10:11], v[176:177], v[240:241]
    v_pk_fma_f32 v[176:177], v[8:9], v[176:177], v[244:245] neg_lo:[1,0,0] neg_hi:[1,0,0]
    v_pk_fma_f32 v[224:225], v[152:153], s[42:43], v[176:177] op_sel_hi:[1,0,1] neg_lo:[0,0,1] neg_hi:[0,0,1]
    v_pk_fma_f32 v[228:229], v[160:161], s[42:43], v[168:169] op_sel_hi:[1,0,1]
    v_pk_fma_f32 v[240:241], v[168:169], s[42:43], v[160:161] op_sel_hi:[1,0,1] neg_lo:[0,0,1] neg_hi:[0,0,1]
    v_pk_fma_f32 v[244:245], v[176:177], s[42:43], v[152:153] op_sel_hi:[1,0,1]
    v_pk_fma_f32 v[4:5], v[226:227], s[42:43], v[246:247] op_sel_hi:[1,0,1]
    v_pk_fma_f32 v[6:7], v[230:231], s[42:43], v[242:243] op_sel_hi:[1,0,1] neg_lo:[0,0,1] neg_hi:[0,0,1]
    v_pk_fma_f32 v[8:9], v[242:243], s[42:43], v[230:231] op_sel_hi:[1,0,1]
    v_pk_fma_f32 v[10:11], v[246:247], s[42:43], v[226:227] op_sel_hi:[1,0,1] neg_lo:[0,0,1] neg_hi:[0,0,1]
    v_pk_mul_f32 v[226:227], v[4:5], v[154:155]
    v_pk_mul_f32 v[230:231], v[6:7], v[154:155]
    v_pk_mul_f32 v[242:243], v[8:9], v[170:171]
    v_pk_mul_f32 v[246:247], v[10:11], v[170:171]
    v_pk_fma_f32 v[154:155], v[6:7], v[162:163], v[226:227] neg_lo:[1,0,0] neg_hi:[1,0,0]
    v_pk_fma_f32 v[162:163], v[4:5], v[162:163], v[230:231]
    v_pk_fma_f32 v[170:171], v[10:11], v[178:179], v[242:243]
    v_pk_fma_f32 v[178:179], v[8:9], v[178:179], v[246:247] neg_lo:[1,0,0] neg_hi:[1,0,0]
    v_pk_fma_f32 v[226:227], v[154:155], s[42:43], v[178:179] op_sel_hi:[1,0,1] neg_lo:[0,0,1] neg_hi:[0,0,1]
    v_pk_fma_f32 v[230:231], v[162:163], s[42:43], v[170:171] op_sel_hi:[1,0,1]
    v_pk_fma_f32 v[242:243], v[170:171], s[42:43], v[162:163] op_sel_hi:[1,0,1] neg_lo:[0,0,1] neg_hi:[0,0,1]
    v_pk_fma_f32 v[246:247], v[178:179], s[42:43], v[154:155] op_sel_hi:[1,0,1]
    v_pk_fma_f32 v[4:5], v[232:233], s[42:43], v[252:253] op_sel_hi:[1,0,1]
    v_pk_fma_f32 v[6:7], v[236:237], s[42:43], v[248:249] op_sel_hi:[1,0,1] neg_lo:[0,0,1] neg_hi:[0,0,1]
    v_pk_fma_f32 v[8:9], v[248:249], s[42:43], v[236:237] op_sel_hi:[1,0,1]
    v_pk_fma_f32 v[10:11], v[252:253], s[42:43], v[232:233] op_sel_hi:[1,0,1] neg_lo:[0,0,1] neg_hi:[0,0,1]
    v_pk_mul_f32 v[232:233], v[4:5], v[156:157]
    v_pk_mul_f32 v[236:237], v[6:7], v[156:157]
    v_pk_mul_f32 v[248:249], v[8:9], v[172:173]
    v_pk_mul_f32 v[252:253], v[10:11], v[172:173]
    v_pk_fma_f32 v[156:157], v[6:7], v[164:165], v[232:233] neg_lo:[1,0,0] neg_hi:[1,0,0]
    v_pk_fma_f32 v[164:165], v[4:5], v[164:165], v[236:237]
    v_pk_fma_f32 v[172:173], v[10:11], v[180:181], v[248:249]
    v_pk_fma_f32 v[180:181], v[8:9], v[180:181], v[252:253] neg_lo:[1,0,0] neg_hi:[1,0,0]
    v_pk_fma_f32 v[232:233], v[156:157], s[42:43], v[180:181] op_sel_hi:[1,0,1] neg_lo:[0,0,1] neg_hi:[0,0,1]
    v_pk_fma_f32 v[236:237], v[164:165], s[42:43], v[172:173] op_sel_hi:[1,0,1]
    v_pk_fma_f32 v[248:249], v[172:173], s[42:43], v[164:165] op_sel_hi:[1,0,1] neg_lo:[0,0,1] neg_hi:[0,0,1]
    v_pk_fma_f32 v[252:253], v[180:181], s[42:43], v[156:157] op_sel_hi:[1,0,1]
    v_pk_fma_f32 v[4:5], v[234:235], s[42:43], v[254:255] op_sel_hi:[1,0,1]
    v_pk_fma_f32 v[6:7], v[238:239], s[42:43], v[250:251] op_sel_hi:[1,0,1] neg_lo:[0,0,1] neg_hi:[0,0,1]
    v_pk_fma_f32 v[8:9], v[250:251], s[42:43], v[238:239] op_sel_hi:[1,0,1]
    v_pk_fma_f32 v[10:11], v[254:255], s[42:43], v[234:235] op_sel_hi:[1,0,1] neg_lo:[0,0,1] neg_hi:[0,0,1]
    v_pk_mul_f32 v[234:235], v[4:5], v[158:159]
    v_pk_mul_f32 v[238:239], v[6:7], v[158:159]
    v_pk_mul_f32 v[250:251], v[8:9], v[174:175]
    v_pk_mul_f32 v[254:255], v[10:11], v[174:175]
    v_pk_fma_f32 v[158:159], v[6:7], v[166:167], v[234:235] neg_lo:[1,0,0] neg_hi:[1,0,0]
    v_pk_fma_f32 v[166:167], v[4:5], v[166:167], v[238:239]
    v_pk_fma_f32 v[174:175], v[10:11], v[182:183], v[250:251]
    v_pk_fma_f32 v[182:183], v[8:9], v[182:183], v[254:255] neg_lo:[1,0,0] neg_hi:[1,0,0]
    v_pk_fma_f32 v[234:235], v[158:159], s[42:43], v[182:183] op_sel_hi:[1,0,1] neg_lo:[0,0,1] neg_hi:[0,0,1]
    v_pk_fma_f32 v[238:239], v[166:167], s[42:43], v[174:175] op_sel_hi:[1,0,1]
    v_pk_fma_f32 v[250:251], v[174:175], s[42:43], v[166:167] op_sel_hi:[1,0,1] neg_lo:[0,0,1] neg_hi:[0,0,1]
    v_pk_fma_f32 v[254:255], v[182:183], s[42:43], v[158:159] op_sel_hi:[1,0,1]
K_SPECIAL2_RET:
    v_pk_add_f32 v[224:225], v[224:225], v[232:233]
    v_pk_add_f32 v[226:227], v[226:227], v[234:235]
    v_pk_add_f32 v[228:229], v[228:229], v[236:237]
    v_pk_add_f32 v[230:231], v[230:231], v[238:239]
    v_pk_fma_f32 v[232:233], v[232:233], -2.0, v[224:225] op_sel_hi:[1,0,1]
    v_pk_fma_f32 v[234:235], v[234:235], -2.0, v[226:227] op_sel_hi:[1,0,1]
    v_pk_fma_f32 v[236:237], v[236:237], -2.0, v[228:229] op_sel_hi:[1,0,1]
    v_pk_fma_f32 v[238:239], v[238:239], -2.0, v[230:231] op_sel_hi:[1,0,1]
    v_cvt_pk_bf16_f32 v184, v224, -v228
    v_cvt_pk_bf16_f32 v185, v225, -v229
    v_cvt_pk_bf16_f32 v186, v226, -v230
    v_cvt_pk_bf16_f32 v187, v227, -v231
    v_cvt_pk_bf16_f32 v188, v232, -v236
    v_cvt_pk_bf16_f32 v189, v233, -v237
    v_cvt_pk_bf16_f32 v190, v234, -v238
    v_cvt_pk_bf16_f32 v191, v235, -v239
    v_pk_add_f32 v[240:241], v[240:241], v[248:249]
    v_pk_add_f32 v[242:243], v[242:243], v[250:251]
    v_pk_add_f32 v[244:245], v[244:245], v[252:253]
    v_pk_add_f32 v[246:247], v[246:247], v[254:255]
    v_pk_fma_f32 v[248:249], v[248:249], -2.0, v[240:241] op_sel_hi:[1,0,1]
    v_pk_fma_f32 v[250:251], v[250:251], -2.0, v[242:243] op_sel_hi:[1,0,1]
    v_pk_fma_f32 v[252:253], v[252:253], -2.0, v[244:245] op_sel_hi:[1,0,1]
    v_pk_fma_f32 v[254:255], v[254:255], -2.0, v[246:247] op_sel_hi:[1,0,1]
    v_cvt_pk_bf16_f32 v192, v240, -v244
    v_cvt_pk_bf16_f32 v193, v241, -v245
    v_cvt_pk_bf16_f32 v194, v242, -v246
    v_cvt_pk_bf16_f32 v195, v243, -v247
    v_cvt_pk_bf16_f32 v196, v248, -v252
    v_cvt_pk_bf16_f32 v197, v249, -v253
    v_cvt_pk_bf16_f32 v198, v250, -v254
    v_cvt_pk_bf16_f32 v199, v251, -v255
    v_mfma_f32_16x16x32_bf16 v[224:227], v[184:187], a[224:227], 0
    v_and_b32_e64 v12, 3, v1
    v_mul_u32_u24 v13, 4112, v12
    v_mfma_f32_16x16x32_bf16 v[228:231], v[184:187], a[228:231], 0
    v_and_b32_e64 v14, 60, v0
    v_lshl_add_u32 v13, v14, 4, v13
    v_mfma_f32_16x16x32_bf16 v[232:235], v[188:191], a[232:235], 0
    s_lshl_b32 s38, s34, 10
    s_add_u32 s38, s38, 114624
    v_mfma_f32_16x16x32_bf16 v[236:239], v[188:191], a[236:239], 0
    v_add_u32 v204, s38, v13
    v_add_u32 v205, 114624, v3
    v_lshlrev_b32_e64 v12, 4, v12
    v_lshl_add_u32 v206, v14, 14, v12
    v_lshlrev_b32_e64 v207, 31, v1
    v_pk_mul_f32 v[4:5], v[36:37], v[130:131] op_sel:[0,1]
    v_pk_mul_f32 v[6:7], v[32:33], v[130:131] op_sel:[0,1]
    v_pk_fma_f32 v[32:33], v[32:33], v[130:131], v[4:5] op_sel_hi:[1,0,1] neg_lo:[0,0,1] neg_hi:[0,0,1]
    v_pk_fma_f32 v[36:37], v[36:37], v[130:131], v[6:7] op_sel_hi:[1,0,1]
    v_pk_mul_f32 v[8:9], v[38:39], v[130:131] op_sel:[0,1]
    v_pk_mul_f32 v[10:11], v[34:35], v[130:131] op_sel:[0,1]
    v_pk_fma_f32 v[34:35], v[34:35], v[130:131], v[8:9] op_sel_hi:[1,0,1] neg_lo:[0,0,1] neg_hi:[0,0,1]
    v_pk_fma_f32 v[38:39], v[38:39], v[130:131], v[10:11] op_sel_hi:[1,0,1]
    v_pk_mul_f32 v[4:5], v[44:45], v[130:131] op_sel:[0,1]
    v_pk_mul_f32 v[6:7], v[40:41], v[130:131] op_sel:[0,1]
    v_pk_fma_f32 v[40:41], v[40:41], v[130:131], v[4:5] op_sel_hi:[1,0,1] neg_lo:[0,0,1] neg_hi:[0,0,1]
    v_pk_fma_f32 v[44:45], v[44:45], v[130:131], v[6:7] op_sel_hi:[1,0,1]
    v_pk_mul_f32 v[8:9], v[46:47], v[130:131] op_sel:[0,1]
    v_pk_mul_f32 v[10:11], v[42:43], v[130:131] op_sel:[0,1]
    v_pk_fma_f32 v[42:43], v[42:43], v[130:131], v[8:9] op_sel_hi:[1,0,1] neg_lo:[0,0,1] neg_hi:[0,0,1]
    v_pk_fma_f32 v[46:47], v[46:47], v[130:131], v[10:11] op_sel_hi:[1,0,1]
    v_pk_mul_f32 v[4:5], v[52:53], v[130:131] op_sel:[0,1]
    v_pk_mul_f32 v[6:7], v[48:49], v[130:131] op_sel:[0,1]
    v_pk_fma_f32 v[48:49], v[48:49], v[130:131], v[4:5] op_sel_hi:[1,0,1] neg_lo:[0,0,1] neg_hi:[0,0,1]
    v_pk_fma_f32 v[52:53], v[52:53], v[130:131], v[6:7] op_sel_hi:[1,0,1]
    v_pk_mul_f32 v[8:9], v[54:55], v[130:131] op_sel:[0,1]
    v_pk_mul_f32 v[10:11], v[50:51], v[130:131] op_sel:[0,1]
    v_pk_fma_f32 v[50:51], v[50:51], v[130:131], v[8:9] op_sel_hi:[1,0,1] neg_lo:[0,0,1] neg_hi:[0,0,1]
    v_pk_fma_f32 v[54:55], v[54:55], v[130:131], v[10:11] op_sel_hi:[1,0,1]
    v_pk_mul_f32 v[4:5], v[60:61], v[130:131] op_sel:[0,1]
    v_pk_mul_f32 v[6:7], v[56:57], v[130:131] op_sel:[0,1]
    v_pk_fma_f32 v[56:57], v[56:57], v[130:131], v[4:5] op_sel_hi:[1,0,1] neg_lo:[0,0,1] neg_hi:[0,0,1]
    v_pk_fma_f32 v[60:61], v[60:61], v[130:131], v[6:7] op_sel_hi:[1,0,1]
    v_pk_mul_f32 v[8:9], v[62:63], v[130:131] op_sel:[0,1]
    v_pk_mul_f32 v[10:11], v[58:59], v[130:131] op_sel:[0,1]
    v_pk_fma_f32 v[58:59], v[58:59], v[130:131], v[8:9] op_sel_hi:[1,0,1] neg_lo:[0,0,1] neg_hi:[0,0,1]
    v_pk_fma_f32 v[62:63], v[62:63], v[130:131], v[10:11] op_sel_hi:[1,0,1]
    v_pk_mul_f32 v[4:5], v[68:69], v[130:131] op_sel:[0,1]
    v_pk_mul_f32 v[6:7], v[64:65], v[130:131] op_sel:[0,1]
    v_pk_fma_f32 v[64:65], v[64:65], v[130:131], v[4:5] op_sel_hi:[1,0,1] neg_lo:[0,0,1] neg_hi:[0,0,1]
    v_pk_fma_f32 v[68:69], v[68:69], v[130:131], v[6:7] op_sel_hi:[1,0,1]
    v_pk_mul_f32 v[8:9], v[70:71], v[130:131] op_sel:[0,1]
    v_pk_mul_f32 v[10:11], v[66:67], v[130:131] op_sel:[0,1]
    v_pk_fma_f32 v[66:67], v[66:67], v[130:131], v[8:9] op_sel_hi:[1,0,1] neg_lo:[0,0,1] neg_hi:[0,0,1]
    v_pk_fma_f32 v[70:71], v[70:71], v[130:131], v[10:11] op_sel_hi:[1,0,1]
    v_pk_mul_f32 v[4:5], v[76:77], v[130:131] op_sel:[0,1]
    v_pk_mul_f32 v[6:7], v[72:73], v[130:131] op_sel:[0,1]
    v_pk_fma_f32 v[72:73], v[72:73], v[130:131], v[4:5] op_sel_hi:[1,0,1] neg_lo:[0,0,1] neg_hi:[0,0,1]
    v_pk_fma_f32 v[76:77], v[76:77], v[130:131], v[6:7] op_sel_hi:[1,0,1]
    v_pk_mul_f32 v[8:9], v[78:79], v[130:131] op_sel:[0,1]
    v_pk_mul_f32 v[10:11], v[74:75], v[130:131] op_sel:[0,1]
    v_pk_fma_f32 v[74:75], v[74:75], v[130:131], v[8:9] op_sel_hi:[1,0,1] neg_lo:[0,0,1] neg_hi:[0,0,1]
    v_pk_fma_f32 v[78:79], v[78:79], v[130:131], v[10:11] op_sel_hi:[1,0,1]
    v_pk_mul_f32 v[4:5], v[84:85], v[130:131] op_sel:[0,1]
    v_pk_mul_f32 v[6:7], v[80:81], v[130:131] op_sel:[0,1]
    v_pk_fma_f32 v[80:81], v[80:81], v[130:131], v[4:5] op_sel_hi:[1,0,1] neg_lo:[0,0,1] neg_hi:[0,0,1]
    v_pk_fma_f32 v[84:85], v[84:85], v[130:131], v[6:7] op_sel_hi:[1,0,1]
    v_pk_mul_f32 v[8:9], v[86:87], v[130:131] op_sel:[0,1]
    v_pk_mul_f32 v[10:11], v[82:83], v[130:131] op_sel:[0,1]
    v_pk_fma_f32 v[82:83], v[82:83], v[130:131], v[8:9] op_sel_hi:[1,0,1] neg_lo:[0,0,1] neg_hi:[0,0,1]
    v_pk_fma_f32 v[86:87], v[86:87], v[130:131], v[10:11] op_sel_hi:[1,0,1]
    v_pk_mul_f32 v[4:5], v[92:93], v[130:131] op_sel:[0,1]
    v_pk_mul_f32 v[6:7], v[88:89], v[130:131] op_sel:[0,1]
    v_pk_fma_f32 v[88:89], v[88:89], v[130:131], v[4:5] op_sel_hi:[1,0,1] neg_lo:[0,0,1] neg_hi:[0,0,1]
    v_pk_fma_f32 v[92:93], v[92:93], v[130:131], v[6:7] op_sel_hi:[1,0,1]
    v_pk_mul_f32 v[8:9], v[94:95], v[130:131] op_sel:[0,1]
    v_pk_mul_f32 v[10:11], v[90:91], v[130:131] op_sel:[0,1]
    v_pk_fma_f32 v[90:91], v[90:91], v[130:131], v[8:9] op_sel_hi:[1,0,1] neg_lo:[0,0,1] neg_hi:[0,0,1]
    v_pk_fma_f32 v[94:95], v[94:95], v[130:131], v[10:11] op_sel_hi:[1,0,1]
    v_pk_mul_f32 v[4:5], v[224:225], v[112:113]
    v_pk_mul_f32 v[6:7], v[228:229], v[112:113]
    v_pk_fma_f32 v[4:5], v[228:229], v[116:117], v[4:5]
    v_pk_fma_f32 v[6:7], v[224:225], v[116:117], v[6:7] neg_lo:[1,0,0] neg_hi:[1,0,0]
    v_pk_mul_f32 v[8:9], v[226:227], v[114:115]
    v_pk_mul_f32 v[10:11], v[230:231], v[114:115]
    v_pk_fma_f32 v[8:9], v[230:231], v[118:119], v[8:9]
    v_pk_fma_f32 v[10:11], v[226:227], v[118:119], v[10:11] neg_lo:[1,0,0] neg_hi:[1,0,0]
    v_cvt_pk_bf16_f32 v184, v4, v6
    v_cvt_pk_bf16_f32 v185, v5, v7
    v_cvt_pk_bf16_f32 v186, v8, v10
    v_cvt_pk_bf16_f32 v187, v9, v11
    v_pk_mul_f32 v[4:5], v[232:233], v[120:121]
    v_pk_mul_f32 v[6:7], v[236:237], v[120:121]
    v_pk_fma_f32 v[4:5], v[236:237], v[124:125], v[4:5]
    v_pk_fma_f32 v[6:7], v[232:233], v[124:125], v[6:7] neg_lo:[1,0,0] neg_hi:[1,0,0]
    v_pk_mul_f32 v[8:9], v[234:235], v[122:123]
    v_pk_mul_f32 v[10:11], v[238:239], v[122:123]
    v_pk_fma_f32 v[8:9], v[238:239], v[126:127], v[8:9]
    v_pk_fma_f32 v[10:11], v[234:235], v[126:127], v[10:11] neg_lo:[1,0,0] neg_hi:[1,0,0]
    v_cvt_pk_bf16_f32 v188, v4, v6
    v_cvt_pk_bf16_f32 v189, v5, v7
    v_cvt_pk_bf16_f32 v190, v8, v10
    v_cvt_pk_bf16_f32 v191, v9, v11
    v_mfma_f32_16x16x32_bf16 v[240:243], v[192:195], a[224:227], 0
    ds_write_b128 v204, v[184:187] offset:0
    v_mfma_f32_16x16x32_bf16 v[244:247], v[192:195], a[228:231], 0
    ds_write_b128 v204, v[188:191] offset:32
    v_mfma_f32_16x16x32_bf16 v[248:251], v[196:199], a[232:235], 0
    v_mfma_f32_16x16x32_bf16 v[252:255], v[196:199], a[236:239], 0
    s_lshl_b32 s68, s94, 16
    s_add_u32 s68, s68, s5
    s_add_u32 s69, s68, 0x20000
    s_lshl_b32 s38, s34, 14
    s_nop 0
    v_pk_mul_f32 v[4:5], v[240:241], v[112:113]
    v_pk_mul_f32 v[6:7], v[244:245], v[112:113]
    v_pk_fma_f32 v[4:5], v[244:245], v[116:117], v[4:5]
    v_pk_fma_f32 v[6:7], v[240:241], v[116:117], v[6:7] neg_lo:[1,0,0] neg_hi:[1,0,0]
    v_pk_mul_f32 v[8:9], v[242:243], v[114:115]
    v_pk_mul_f32 v[10:11], v[246:247], v[114:115]
    v_pk_fma_f32 v[8:9], v[246:247], v[118:119], v[8:9]
    v_pk_fma_f32 v[10:11], v[242:243], v[118:119], v[10:11] neg_lo:[1,0,0] neg_hi:[1,0,0]
    v_cvt_pk_bf16_f32 v192, v4, v6
    v_cvt_pk_bf16_f32 v193, v5, v7
    v_cvt_pk_bf16_f32 v194, v8, v10
    v_cvt_pk_bf16_f32 v195, v9, v11
    v_pk_mul_f32 v[4:5], v[248:249], v[120:121]
    v_pk_mul_f32 v[6:7], v[252:253], v[120:121]
    v_pk_fma_f32 v[4:5], v[252:253], v[124:125], v[4:5]
    v_pk_fma_f32 v[6:7], v[248:249], v[124:125], v[6:7] neg_lo:[1,0,0] neg_hi:[1,0,0]
    v_pk_mul_f32 v[8:9], v[250:251], v[122:123]
    v_pk_mul_f32 v[10:11], v[254:255], v[122:123]
    v_pk_fma_f32 v[8:9], v[254:255], v[126:127], v[8:9]
    v_pk_fma_f32 v[10:11], v[250:251], v[126:127], v[10:11] neg_lo:[1,0,0] neg_hi:[1,0,0]
    v_cvt_pk_bf16_f32 v196, v4, v6
    v_cvt_pk_bf16_f32 v197, v5, v7
    v_cvt_pk_bf16_f32 v198, v8, v10
    v_cvt_pk_bf16_f32 v199, v9, v11
    s_add_u32 s38, s38, s4
    s_lshl_b32 s38, s38, 6
    ds_write_b128 v204, v[192:195] offset:16
    ds_write_b128 v204, v[196:199] offset:48
    s_add_u32 s38, s38, 9437184
    s_and_b32 s70, s2, 0xe0
    s_lshl2_add_u32 s70, s70, s51
    s_waitcnt lgkmcnt(0)
    s_barrier
    s_nop 0
    ds_read_b128 a[32:35], v205 offset:0
    ds_read_b128 a[36:39], v205 offset:1024
    ds_read_b128 a[40:43], v205 offset:2048
    ds_read_b128 a[44:47], v205 offset:3072
    buffer_load_dwordx4 v[96:99], v148, s[24:27], s93 offen sc1
    buffer_load_dwordx4 v[100:103], v149, s[24:27], s93 offen sc1
    buffer_load_dwordx4 v[104:107], v150, s[24:27], s93 offen sc1
    buffer_load_dwordx4 v[108:111], v151, s[24:27], s93 offen sc1
    s_bfe_u32 s72, s97, 262156
    s_add_u32 m0, s37, 49152
    s_lshl_b32 s72, s72, 7
    buffer_load_dwordx4 v16, s[16:19], s72 offen offset:0  lds
    buffer_load_dwordx4 v17, s[16:19], s72 offen offset:1024  lds
    buffer_load_dwordx4 v18, s[16:19], s72 offen offset:2048  lds
    buffer_load_dwordx4 v19, s[16:19], s72 offen offset:3072  lds
    s_waitcnt lgkmcnt(0)
    v_mfma_f32_16x16x32_bf16 v[224:227], a[0:3], a[32:35], 0
    ds_read_b128 a[48:51], v205 offset:4112
    v_accvgpr_read_b32 v112, a152
    v_mfma_f32_16x16x32_bf16 v[228:231], a[4:7], a[32:35], 0
    ds_read_b128 a[52:55], v205 offset:5136
    v_accvgpr_read_b32 v113, a153
    v_mfma_f32_16x16x32_bf16 v[224:227], a[8:11], a[36:39], v[224:227]
    ds_read_b128 a[56:59], v205 offset:6160
    v_accvgpr_read_b32 v114, a154
    v_mfma_f32_16x16x32_bf16 v[228:231], a[12:15], a[36:39], v[228:231]
    ds_read_b128 a[60:63], v205 offset:7184
    v_mfma_f32_16x16x32_bf16 v[224:227], a[16:19], a[40:43], v[224:227]
    ds_read_b128 a[64:67], v205 offset:8224
    v_accvgpr_read_b32 v115, a155
    v_mfma_f32_16x16x32_bf16 v[228:231], a[20:23], a[40:43], v[228:231]
    ds_read_b128 a[68:71], v205 offset:9248
    v_accvgpr_read_b32 v116, a156
    v_mfma_f32_16x16x32_bf16 v[224:227], a[24:27], a[44:47], v[224:227]
    ds_read_b128 a[72:75], v205 offset:10272
    v_accvgpr_read_b32 v117, a157
    v_mfma_f32_16x16x32_bf16 v[228:231], a[28:31], a[44:47], v[228:231]
    ds_read_b128 a[76:79], v205 offset:11296
    s_waitcnt lgkmcnt(4)
    v_mfma_f32_16x16x32_bf16 v[232:235], a[0:3], a[48:51], 0
    ds_read_b128 a[80:83], v205 offset:12336
    s_bfe_u32 s72, s97, 262160
    v_accvgpr_read_b32 v118, a158
    v_mfma_f32_16x16x32_bf16 v[236:239], a[4:7], a[48:51], 0
    ds_read_b128 a[84:87], v205 offset:13360
    v_accvgpr_read_b32 v119, a159
    v_mfma_f32_16x16x32_bf16 v[232:235], a[8:11], a[52:55], v[232:235]
    ds_read_b128 a[88:91], v205 offset:14384
    s_add_u32 m0, s37, 65536
    v_mfma_f32_16x16x32_bf16 v[236:239], a[12:15], a[52:55], v[236:239]
    ds_read_b128 a[92:95], v205 offset:15408
    v_cvt_pk_bf16_f32 v184, v224, v228
    v_cvt_pk_bf16_f32 v185, v225, v229
    v_mfma_f32_16x16x32_bf16 v[232:235], a[16:19], a[56:59], v[232:235]
    s_lshl_b32 s72, s72, 7
    v_cvt_pk_bf16_f32 v186, v226, v230
    v_cvt_pk_bf16_f32 v187, v227, v231
    v_mfma_f32_16x16x32_bf16 v[236:239], a[20:23], a[56:59], v[236:239]
    v_xor_b32 v184, v207, v184
    v_xor_b32 v185, v207, v185
    v_mfma_f32_16x16x32_bf16 v[232:235], a[24:27], a[60:63], v[232:235]
    v_xor_b32 v186, v207, v186
    v_xor_b32 v187, v207, v187
    v_mfma_f32_16x16x32_bf16 v[236:239], a[28:31], a[60:63], v[236:239]
    buffer_store_dwordx4 v[184:187], v206, s[24:27], s38 offen sc1
    s_add_u32 s38, s38, 16384
    s_waitcnt lgkmcnt(4)
    v_mfma_f32_16x16x32_bf16 v[240:243], a[0:3], a[64:67], 0
    buffer_load_dwordx4 v16, s[16:19], s72 offen offset:0  lds
    v_accvgpr_read_b32 v120, a160
    v_mfma_f32_16x16x32_bf16 v[244:247], a[4:7], a[64:67], 0
    v_accvgpr_read_b32 v121, a161
    v_mfma_f32_16x16x32_bf16 v[240:243], a[8:11], a[68:71], v[240:243]
    buffer_load_dwordx4 v17, s[16:19], s72 offen offset:1024  lds
    v_mfma_f32_16x16x32_bf16 v[244:247], a[12:15], a[68:71], v[244:247]
    v_cvt_pk_bf16_f32 v188, v232, v236
    v_cvt_pk_bf16_f32 v189, v233, v237
    v_mfma_f32_16x16x32_bf16 v[240:243], a[16:19], a[72:75], v[240:243]
    buffer_load_dwordx4 v18, s[16:19], s72 offen offset:2048  lds
    v_cvt_pk_bf16_f32 v190, v234, v238
    v_cvt_pk_bf16_f32 v191, v235, v239
    v_mfma_f32_16x16x32_bf16 v[244:247], a[20:23], a[72:75], v[244:247]
    v_xor_b32 v188, v207, v188
    v_xor_b32_e64 v189, v207, v189
    v_mfma_f32_16x16x32_bf16 v[240:243], a[24:27], a[76:79], v[240:243]
    v_xor_b32 v190, v207, v190
    v_xor_b32 v191, v207, v191
    v_mfma_f32_16x16x32_bf16 v[244:247], a[28:31], a[76:79], v[244:247]
    buffer_store_dwordx4 v[188:191], v206, s[24:27], s38 offen sc1
    s_add_u32 s38, s38, 16384
    s_waitcnt lgkmcnt(0)
    v_mfma_f32_16x16x32_bf16 v[248:251], a[0:3], a[80:83], 0
    buffer_load_dwordx4 v19, s[16:19], s72 offen offset:3072  lds
    v_accvgpr_read_b32 v122, a162
    v_mfma_f32_16x16x32_bf16 v[252:255], a[4:7], a[80:83], 0
    v_accvgpr_read_b32 v123, a163
    v_mfma_f32_16x16x32_bf16 v[248:251], a[8:11], a[84:87], v[248:251]
    v_mfma_f32_16x16x32_bf16 v[252:255], a[12:15], a[84:87], v[252:255]
    v_cvt_pk_bf16_f32 v192, v240, v244
    v_cvt_pk_bf16_f32 v193, v241, v245
    v_mfma_f32_16x16x32_bf16 v[248:251], a[16:19], a[88:91], v[248:251]
    v_cvt_pk_bf16_f32 v194, v242, v246
    v_cvt_pk_bf16_f32 v195, v243, v247
    v_mfma_f32_16x16x32_bf16 v[252:255], a[20:23], a[88:91], v[252:255]
    v_xor_b32 v192, v207, v192
    v_xor_b32_e64 v193, v207, v193
    v_mfma_f32_16x16x32_bf16 v[248:251], a[24:27], a[92:95], v[248:251]
    v_xor_b32 v194, v207, v194
    v_xor_b32 v195, v207, v195
    v_mfma_f32_16x16x32_bf16 v[252:255], a[28:31], a[92:95], v[252:255]
    buffer_store_dwordx4 v[192:195], v206, s[24:27], s38 offen sc1
    s_add_u32 s38, s38, 16384
    v_accvgpr_read_b32 v124, a164
    v_accvgpr_read_b32 v125, a165
    v_accvgpr_read_b32 v126, a166
    v_accvgpr_read_b32 v127, a167
    s_nop 1
    v_cvt_pk_bf16_f32 v196, v248, v252
    v_cvt_pk_bf16_f32 v197, v249, v253
    v_cvt_pk_bf16_f32 v198, v250, v254
    v_cvt_pk_bf16_f32 v199, v251, v255
    v_xor_b32 v196, v207, v196
    v_xor_b32 v197, v207, v197
    v_xor_b32 v198, v207, v198
    v_xor_b32_e64 v199, v207, v199
    buffer_store_dwordx4 v[196:199], v206, s[24:27], s38 offen sc1
    s_waitcnt vmcnt(12)
    v_cmp_ne_u32 s[52:53], s35, v98
    v_cmp_ne_u32 s[54:55], s35, v102
    v_cmp_ne_u32 s[56:57], s35, v106
    v_cmp_ne_u32 s[58:59], s35, v110
    s_and_b64 s[52:53], s[52:53], s[80:81]
    s_and_b64 s[54:55], s[54:55], s[82:83]
    s_and_b64 s[56:57], s[56:57], s[84:85]
    s_and_b64 s[58:59], s[58:59], s[86:87]
    s_or_b64 s[52:53], s[52:53], s[54:55]
    s_or_b64 s[56:57], s[56:57], s[58:59]
    s_or_b64 vcc, s[52:53], s[56:57]
    s_cbranch_vccnz K_POLL2
K_POLL2_OK:
    s_nop 0
    s_xor_b32 s40, s92, 128
    buffer_load_dword a223, v29, s[16:19], s40 offen
    v_fma_f32 v4, v108, v136, v104
    v_fma_f32 v5, v108, v137, v105
    v_fma_f32 v4, -v109, v137, v4
    v_fma_f32 v5, v109, v136, v5
    v_fma_f32 v6, v4, v136, v100
    v_fma_f32 v7, v4, v137, v101
    v_fma_f32 v6, -v5, v137, v6
    v_fma_f32 v7, v5, v136, v7
    v_fma_f32 v4, v6, v136, v96
    v_fma_f32 v5, v6, v137, v97
    v_fma_f32 v4, -v7, v137, v4
    v_fma_f32 v5, v7, v136, v5
    v_mul_f32 v6, v4, v140
    v_mul_f32 v8, v4, v141
    v_fma_f32 v6, -v5, v141, v6
    v_fma_f32 v8, v5, v140, v8
    v_and_b32 v210, 7, v0
    v_lshlrev_b32 v210, 2, v210
    v_permlane32_swap_b32 v6, v8
    v_add_f32 v6, v6, v8
    v_mov_b32_e64 v8, v6
    v_bfe_u32 v210, s97, v210, 3
    v_lshl_add_u32 v210, v210, 7, s63
    v_permlane16_swap_b32 v6, v8
    v_add_f32 v6, v6, v8
    v_mov_b32 v8, v6
    v_mov_b32 v28, s35
    v_cmp_gt_u32 s[44:45], 4, v0
    v_permlane32_swap_b32 v6, v8
    s_nop 0
    v_fma_f32 v10, v6, v138, v146
    v_fma_f32 v12, v6, v139, v147
    v_fma_f32 v10, -v8, v139, v10
    v_fma_f32 v12, v8, v138, v12
    v_fma_f32 v11, v10, v132, v142
    v_fma_f32 v13, v10, v133, v144
    v_fma_f32 v11, -v12, v133, v11
    v_fma_f32 v13, v12, v132, v13
    v_pk_fma_f32 v[32:33], v[10:11], v[128:129], v[32:33] op_sel_hi:[1,0,1]
    v_pk_fma_f32 v[36:37], v[12:13], v[128:129], v[36:37] op_sel_hi:[1,0,1]
    v_pk_fma_f32 v[32:33], v[12:13], v[128:129], v[32:33] op_sel:[0,1,0] neg_lo:[1,0,0] neg_hi:[1,0,0]
    v_pk_fma_f32 v[36:37], v[10:11], v[128:129], v[36:37] op_sel:[0,1,0]
    v_pk_fma_f32 v[34:35], v[32:33], v[128:129], v[34:35] op_sel_hi:[1,0,1]
    v_pk_fma_f32 v[38:39], v[36:37], v[128:129], v[38:39] op_sel_hi:[1,0,1]
    v_pk_fma_f32 v[34:35], v[36:37], v[128:129], v[34:35] op_sel:[0,1,0] neg_lo:[1,0,0] neg_hi:[1,0,0]
    v_pk_fma_f32 v[38:39], v[32:33], v[128:129], v[38:39] op_sel:[0,1,0]
    v_cvt_pk_bf16_f32 v224, v32, v34
    v_cvt_pk_bf16_f32 v232, v33, v35
    v_cvt_pk_bf16_f32 v240, -v36, -v38
    v_cvt_pk_bf16_f32 v248, -v37, -v39
    v_pk_fma_f32 v[40:41], v[34:35], v[128:129], v[40:41] op_sel_hi:[1,0,1]
    v_pk_fma_f32 v[44:45], v[38:39], v[128:129], v[44:45] op_sel_hi:[1,0,1]
    v_pk_fma_f32 v[40:41], v[38:39], v[128:129], v[40:41] op_sel:[0,1,0] neg_lo:[1,0,0] neg_hi:[1,0,0]
    v_pk_fma_f32 v[44:45], v[34:35], v[128:129], v[44:45] op_sel:[0,1,0]
    v_pk_fma_f32 v[42:43], v[40:41], v[128:129], v[42:43] op_sel_hi:[1,0,1]
    v_pk_fma_f32 v[46:47], v[44:45], v[128:129], v[46:47] op_sel_hi:[1,0,1]
    v_pk_fma_f32 v[42:43], v[44:45], v[128:129], v[42:43] op_sel:[0,1,0] neg_lo:[1,0,0] neg_hi:[1,0,0]
    v_pk_fma_f32 v[46:47], v[40:41], v[128:129], v[46:47] op_sel:[0,1,0]
    v_cvt_pk_bf16_f32 v225, v40, v42
    v_cvt_pk_bf16_f32 v233, v41, v43
    v_cvt_pk_bf16_f32 v241, -v44, -v46
    v_cvt_pk_bf16_f32 v249, -v45, -v47
    v_pk_fma_f32 v[48:49], v[42:43], v[128:129], v[48:49] op_sel_hi:[1,0,1]
    v_pk_fma_f32 v[52:53], v[46:47], v[128:129], v[52:53] op_sel_hi:[1,0,1]
    v_pk_fma_f32 v[48:49], v[46:47], v[128:129], v[48:49] op_sel:[0,1,0] neg_lo:[1,0,0] neg_hi:[1,0,0]
    v_pk_fma_f32 v[52:53], v[42:43], v[128:129], v[52:53] op_sel:[0,1,0]
    v_pk_fma_f32 v[50:51], v[48:49], v[128:129], v[50:51] op_sel_hi:[1,0,1]
    v_pk_fma_f32 v[54:55], v[52:53], v[128:129], v[54:55] op_sel_hi:[1,0,1]
    v_pk_fma_f32 v[50:51], v[52:53], v[128:129], v[50:51] op_sel:[0,1,0] neg_lo:[1,0,0] neg_hi:[1,0,0]
    v_pk_fma_f32 v[54:55], v[48:49], v[128:129], v[54:55] op_sel:[0,1,0]
    v_cvt_pk_bf16_f32 v226, v48, v50
    v_cvt_pk_bf16_f32 v234, v49, v51
    v_cvt_pk_bf16_f32 v242, -v52, -v54
    v_cvt_pk_bf16_f32 v250, -v53, -v55
    v_pk_fma_f32 v[56:57], v[50:51], v[128:129], v[56:57] op_sel_hi:[1,0,1]
    v_pk_fma_f32 v[60:61], v[54:55], v[128:129], v[60:61] op_sel_hi:[1,0,1]
    v_pk_fma_f32 v[56:57], v[54:55], v[128:129], v[56:57] op_sel:[0,1,0] neg_lo:[1,0,0] neg_hi:[1,0,0]
    v_pk_fma_f32 v[60:61], v[50:51], v[128:129], v[60:61] op_sel:[0,1,0]
    v_pk_fma_f32 v[58:59], v[56:57], v[128:129], v[58:59] op_sel_hi:[1,0,1]
    v_pk_fma_f32 v[62:63], v[60:61], v[128:129], v[62:63] op_sel_hi:[1,0,1]
    v_pk_fma_f32 v[58:59], v[60:61], v[128:129], v[58:59] op_sel:[0,1,0] neg_lo:[1,0,0] neg_hi:[1,0,0]
    v_pk_fma_f32 v[62:63], v[56:57], v[128:129], v[62:63] op_sel:[0,1,0]
    v_cvt_pk_bf16_f32 v227, v56, v58
    v_cvt_pk_bf16_f32 v235, v57, v59
    v_cvt_pk_bf16_f32 v243, -v60, -v62
    v_cvt_pk_bf16_f32 v251, -v61, -v63
    v_pk_fma_f32 v[64:65], v[58:59], v[128:129], v[64:65] op_sel_hi:[1,0,1]
    ds_write_b128 v216, v[224:227] offset:0
    v_pk_fma_f32 v[68:69], v[62:63], v[128:129], v[68:69] op_sel_hi:[1,0,1]
    v_pk_fma_f32 v[64:65], v[62:63], v[128:129], v[64:65] op_sel:[0,1,0] neg_lo:[1,0,0] neg_hi:[1,0,0]
    v_pk_fma_f32 v[68:69], v[58:59], v[128:129], v[68:69] op_sel:[0,1,0]
    v_pk_fma_f32 v[66:67], v[64:65], v[128:129], v[66:67] op_sel_hi:[1,0,1]
    v_pk_fma_f32 v[70:71], v[68:69], v[128:129], v[70:71] op_sel_hi:[1,0,1]
    v_pk_fma_f32 v[66:67], v[68:69], v[128:129], v[66:67] op_sel:[0,1,0] neg_lo:[1,0,0] neg_hi:[1,0,0]
    v_pk_fma_f32 v[70:71], v[64:65], v[128:129], v[70:71] op_sel:[0,1,0]
    v_cvt_pk_bf16_f32 v228, v64, v66
    v_cvt_pk_bf16_f32 v236, v65, v67
    v_cvt_pk_bf16_f32 v244, -v68, -v70
    ds_write_b128 v218, v[232:235] offset:0
    v_cvt_pk_bf16_f32 v252, -v69, -v71
    v_pk_fma_f32 v[72:73], v[66:67], v[128:129], v[72:73] op_sel_hi:[1,0,1]
    v_pk_fma_f32 v[76:77], v[70:71], v[128:129], v[76:77] op_sel_hi:[1,0,1]
    v_pk_fma_f32 v[72:73], v[70:71], v[128:129], v[72:73] op_sel:[0,1,0] neg_lo:[1,0,0] neg_hi:[1,0,0]
    v_pk_fma_f32 v[76:77], v[66:67], v[128:129], v[76:77] op_sel:[0,1,0]
    v_pk_fma_f32 v[74:75], v[72:73], v[128:129], v[74:75] op_sel_hi:[1,0,1]
    v_pk_fma_f32 v[78:79], v[76:77], v[128:129], v[78:79] op_sel_hi:[1,0,1]
    v_pk_fma_f32 v[74:75], v[76:77], v[128:129], v[74:75] op_sel:[0,1,0] neg_lo:[1,0,0] neg_hi:[1,0,0]
    v_pk_fma_f32 v[78:79], v[72:73], v[128:129], v[78:79] op_sel:[0,1,0]
    v_cvt_pk_bf16_f32 v229, v72, v74
    ds_write_b128 v216, v[240:243] offset:4096
    v_cvt_pk_bf16_f32 v237, v73, v75
    v_cvt_pk_bf16_f32 v245, -v76, -v78
    v_cvt_pk_bf16_f32 v253, -v77, -v79
    v_pk_fma_f32 v[80:81], v[74:75], v[128:129], v[80:81] op_sel_hi:[1,0,1]
    v_pk_fma_f32 v[84:85], v[78:79], v[128:129], v[84:85] op_sel_hi:[1,0,1]
    v_pk_fma_f32 v[80:81], v[78:79], v[128:129], v[80:81] op_sel:[0,1,0] neg_lo:[1,0,0] neg_hi:[1,0,0]
    v_pk_fma_f32 v[84:85], v[74:75], v[128:129], v[84:85] op_sel:[0,1,0]
    v_pk_fma_f32 v[82:83], v[80:81], v[128:129], v[82:83] op_sel_hi:[1,0,1]
    v_pk_fma_f32 v[86:87], v[84:85], v[128:129], v[86:87] op_sel_hi:[1,0,1]
    v_pk_fma_f32 v[82:83], v[84:85], v[128:129], v[82:83] op_sel:[0,1,0] neg_lo:[1,0,0] neg_hi:[1,0,0]
    ds_write_b128 v218, v[248:251] offset:4096
    v_pk_fma_f32 v[86:87], v[80:81], v[128:129], v[86:87] op_sel:[0,1,0]
    v_cvt_pk_bf16_f32 v230, v80, v82
    v_cvt_pk_bf16_f32 v238, v81, v83
    v_cvt_pk_bf16_f32 v246, -v84, -v86
    v_cvt_pk_bf16_f32 v254, -v85, -v87
    v_pk_fma_f32 v[88:89], v[82:83], v[128:129], v[88:89] op_sel_hi:[1,0,1]
    v_pk_fma_f32 v[92:93], v[86:87], v[128:129], v[92:93] op_sel_hi:[1,0,1]
    v_pk_fma_f32 v[88:89], v[86:87], v[128:129], v[88:89] op_sel:[0,1,0] neg_lo:[1,0,0] neg_hi:[1,0,0]
    v_pk_fma_f32 v[92:93], v[82:83], v[128:129], v[92:93] op_sel:[0,1,0]
    v_pk_fma_f32 v[90:91], v[88:89], v[128:129], v[90:91] op_sel_hi:[1,0,1]
    v_pk_fma_f32 v[94:95], v[92:93], v[128:129], v[94:95] op_sel_hi:[1,0,1]
    v_pk_fma_f32 v[90:91], v[92:93], v[128:129], v[90:91] op_sel:[0,1,0] neg_lo:[1,0,0] neg_hi:[1,0,0]
    v_pk_fma_f32 v[94:95], v[88:89], v[128:129], v[94:95] op_sel:[0,1,0]
    v_cvt_pk_bf16_f32 v231, v88, v90
    v_cvt_pk_bf16_f32 v239, v89, v91
    v_cvt_pk_bf16_f32 v247, -v92, -v94
    v_cvt_pk_bf16_f32 v255, -v93, -v95
    ds_write_b128 v217, v[228:231] offset:0
    ds_write_b128 v219, v[236:239] offset:0
    ds_write_b128 v217, v[244:247] offset:4096
    ds_write_b128 v219, v[252:255] offset:4096
    v_lshl_add_u32 v209, v0, 2, s63
    v_cndmask_b32 v209, 2.0, v209, s[44:45]
    v_add_u32 v208, s50, v209
    v_add_u32 v209, s7, v209
    v_accvgpr_read_b32 v96, a136
    v_accvgpr_read_b32 v97, a137
    v_accvgpr_read_b32 v98, a138
    v_accvgpr_read_b32 v99, a139
    v_accvgpr_read_b32 v100, a140
    v_accvgpr_read_b32 v101, a141
    v_accvgpr_read_b32 v102, a142
    v_accvgpr_read_b32 v103, a143
    v_accvgpr_read_b32 v104, a144
    v_accvgpr_read_b32 v105, a145
    v_accvgpr_read_b32 v106, a146
    v_accvgpr_read_b32 v107, a147
    v_accvgpr_read_b32 v108, a148
    v_accvgpr_read_b32 v109, a149
    v_accvgpr_read_b32 v110, a150
    v_accvgpr_read_b32 v111, a151
    v_accvgpr_read_b32 v128, a168
    v_accvgpr_read_b32 v129, a169
    s_waitcnt lgkmcnt(0) vmcnt(3)
    s_barrier
    s_cmp_lg_u32 s50, 0
    s_cbranch_scc1 K_HFAR
    ds_read_b64_tr_b16 v[64:65], v220 offset:0
    ds_read_b64_tr_b16 v[66:67], v221 offset:1024
    ds_read_b64_tr_b16 v[80:81], v222 offset:0
    ds_read_b64_tr_b16 v[82:83], v223 offset:1024
    ds_read_b64_tr_b16 v[68:69], v220 offset:8192
    ds_read_b64_tr_b16 v[70:71], v221 offset:9216
    ds_read_b64_tr_b16 v[84:85], v222 offset:8192
    ds_read_b64_tr_b16 v[86:87], v223 offset:9216
    ds_read_b64_tr_b16 v[72:73], v220 offset:16384
    ds_read_b64_tr_b16 v[74:75], v221 offset:17408
    ds_read_b64_tr_b16 v[88:89], v222 offset:16384
    ds_read_b64_tr_b16 v[90:91], v223 offset:17408
    s_waitcnt lgkmcnt(8)
    s_nop 0
    buffer_store_dwordx4 v[64:67], v24, s[28:31], s68 offen
    buffer_store_dwordx4 v[80:83], v24, s[28:31], s69 offen
    ds_read_b64_tr_b16 v[76:77], v220 offset:24576
    ds_read_b64_tr_b16 v[78:79], v221 offset:25600
    ds_read_b64_tr_b16 v[92:93], v222 offset:24576
    ds_read_b64_tr_b16 v[94:95], v223 offset:25600
    ds_read_b128 v[152:155], v20 offset:0
    ds_read_b128 v[156:159], v20 offset:2048
    ds_read_b128 v[160:163], v20 offset:4096
    ds_read_b128 v[164:167], v20 offset:6144
    s_waitcnt lgkmcnt(12)
    buffer_store_dwordx4 v[68:71], v25, s[28:31], s68 offen
    s_waitcnt lgkmcnt(0)
    v_mfma_f32_16x16x32_bf16 v[32:35], v[64:67], v[152:155], 0
    ds_read_b128 v[168:171], v21 offset:0
    buffer_store_dwordx4 v[84:87], v25, s[28:31], s69 offen
    v_mfma_f32_16x16x32_bf16 v[48:51], v[80:83], v[152:155], 0
    ds_read_b128 v[172:175], v21 offset:2048
    v_mfma_f32_16x16x32_bf16 v[36:39], v[64:67], v[156:159], 0
    ds_read_b128 v[176:179], v21 offset:4096
    buffer_store_dwordx4 v[72:75], v26, s[28:31], s68 offen
    v_mfma_f32_16x16x32_bf16 v[52:55], v[80:83], v[156:159], 0
    ds_read_b128 v[180:183], v21 offset:6144
    v_mfma_f32_16x16x32_bf16 v[40:43], v[64:67], v[160:163], 0
    v_mfma_f32_16x16x32_bf16 v[56:59], v[80:83], v[160:163], 0
    buffer_store_dwordx4 v[88:91], v26, s[28:31], s69 offen
    v_mfma_f32_16x16x32_bf16 v[44:47], v[64:67], v[164:167], 0
    v_mfma_f32_16x16x32_bf16 v[60:63], v[80:83], v[164:167], 0
    s_waitcnt lgkmcnt(0)
    v_mfma_f32_16x16x32_bf16 v[32:35], v[68:71], v[168:171], v[32:35]
    ds_read_b128 v[152:155], v22 offset:0
    buffer_store_dwordx4 v[76:79], v27, s[28:31], s68 offen
    v_mfma_f32_16x16x32_bf16 v[48:51], v[84:87], v[168:171], v[48:51]
    ds_read_b128 v[156:159], v22 offset:2048
    v_mfma_f32_16x16x32_bf16 v[36:39], v[68:71], v[172:175], v[36:39]
    ds_read_b128 v[160:163], v22 offset:4096
    v_mfma_f32_16x16x32_bf16 v[52:55], v[84:87], v[172:175], v[52:55]
    ds_read_b128 v[164:167], v22 offset:6144
    v_mfma_f32_16x16x32_bf16 v[40:43], v[68:71], v[176:179], v[40:43]
    buffer_store_dwordx4 v[92:95], v27, s[28:31], s69 offen
    v_mfma_f32_16x16x32_bf16 v[56:59], v[84:87], v[176:179], v[56:59]
    v_mfma_f32_16x16x32_bf16 v[44:47], v[68:71], v[180:183], v[44:47]
    v_mfma_f32_16x16x32_bf16 v[60:63], v[84:87], v[180:183], v[60:63]
K_HFAR_RET:
    s_bfe_u32 s72, s97, 262164
    s_add_u32 m0, s37, 81920
    s_lshl_b32 s72, s72, 7
    buffer_load_dwordx4 v16, s[16:19], s72 offen offset:0  lds
    buffer_load_dwordx4 v17, s[16:19], s72 offen offset:1024  lds
    buffer_load_dwordx4 v18, s[16:19], s72 offen offset:2048  lds
    buffer_load_dwordx4 v19, s[16:19], s72 offen offset:3072  lds
    s_bfe_u32 s72, s97, 262168
    s_add_u32 m0, s37, 98304
    s_lshl_b32 s72, s72, 7
    buffer_load_dwordx4 v16, s[16:19], s72 offen offset:0  lds
    buffer_load_dwordx4 v17, s[16:19], s72 offen offset:1024  lds
    buffer_load_dwordx4 v18, s[16:19], s72 offen offset:2048  lds
    buffer_load_dwordx4 v19, s[16:19], s72 offen offset:3072  lds
    v_sub_u32 v14, v0, v2
    v_and_b32_e64 v14, 3, v14
    v_and_or_b32 v14, v0, 60, v14
    v_lshlrev_b32 v133, 4, v14
    s_and_b32 s38, s34, 2
    s_lshl3_add_u32 s39, s6, 131072
    v_lshl_add_u32 v14, v2, 6, v1
    v_lshrrev_b32 v15, 2, v1
    v_add_u32 v15, s38, v15
    v_and_b32_e64 v15, 3, v15
    v_lshl_add_u32 v15, v14, 2, v15
    v_lshl_add_u32 v130, v15, 4, s39
    v_sub_u32 v14, 256, v14
    v_lshrrev_b32_e64 v15, 2, v14
    v_add3_u32 v15, v15, s38, 1
    v_and_b32_e64 v15, 3, v15
    v_lshl_add_u32 v15, v14, 2, v15
    v_lshl_add_u32 v131, v15, 4, s39
    v_and_b32 v15, 1023, v15
    v_lshl_add_u32 v132, v15, 4, s39
    v_subrev_u32 v131, 3072, v131
    s_waitcnt vmcnt(8)
    buffer_store_dword v28, v208, s[24:27], s70 offen offset:64
    buffer_store_dword v28, v209, s[24:27], s70 offen offset:64 sc1
    s_barrier
    s_waitcnt lgkmcnt(0)
    v_mfma_f32_16x16x32_bf16 v[32:35], v[72:75], v[152:155], v[32:35]
    ds_read_b128 v[168:171], v23 offset:0
    s_bfe_u32 s72, s97, 262172
    s_add_u32 m0, s37, 114688
    v_mfma_f32_16x16x32_bf16 v[48:51], v[88:91], v[152:155], v[48:51]
    ds_read_b128 v[172:175], v23 offset:2048
    s_lshl_b32 s72, s72, 7
    buffer_load_dwordx4 v16, s[16:19], s72 offen offset:0  lds
    v_mfma_f32_16x16x32_bf16 v[36:39], v[72:75], v[156:159], v[36:39]
    ds_read_b128 v[176:179], v23 offset:4096
    buffer_load_dwordx4 v17, s[16:19], s72 offen offset:1024  lds
    v_mfma_f32_16x16x32_bf16 v[52:55], v[88:91], v[156:159], v[52:55]
    ds_read_b128 v[180:183], v23 offset:6144
    buffer_load_dwordx4 v18, s[16:19], s72 offen offset:2048  lds
    buffer_load_dwordx4 v19, s[16:19], s72 offen offset:3072  lds
    v_mfma_f32_16x16x32_bf16 v[40:43], v[72:75], v[160:163], v[40:43]
    buffer_load_dword v4, v210, s[24:27], s51 offen offset:64 sc1
    s_lshl_b32 s3, s2, 3
    v_mfma_f32_16x16x32_bf16 v[56:59], v[88:91], v[160:163], v[56:59]
    s_add_u32 s3, s3, 22396928
    v_mfma_f32_16x16x32_bf16 v[44:47], v[72:75], v[164:167], v[44:47]
    v_mov_b32 v28, s35
    v_and_b32 v255, 1073741831, v30
    v_mfma_f32_16x16x32_bf16 v[60:63], v[88:91], v[164:167], v[60:63]
    buffer_store_dword v28, v255, s[24:27], s3 offen sc1
    s_waitcnt lgkmcnt(0) vmcnt(1)
    v_cmp_ne_u32 vcc, s35, v4
    s_nop 0
    s_and_b32 s59, vcc_lo, 254
    s_cmp_lg_u32 s59, 0
    s_cbranch_scc1 K_POLL31
K_POLL31_OK:
    v_mfma_f32_16x16x32_bf16 v[32:35], v[76:79], v[168:171], v[32:35]
    ds_read_b128 v[152:155], v20 offset:16384
    s_bfe_u32 s73, s97, 262148
    s_lshl_b32 s73, s73, 8
    s_add_u32 s73, s73, s95
    s_add_u32 s74, s73, 0x20000
    v_mfma_f32_16x16x32_bf16 v[48:51], v[92:95], v[168:171], v[48:51]
    ds_read_b128 v[156:159], v20 offset:18432
    buffer_load_dwordx4 a[0:3], v24, s[28:31], s73 offen sc1
    buffer_load_dwordx4 a[16:19], v24, s[28:31], s74 offen sc1
    buffer_load_dwordx4 a[4:7], v25, s[28:31], s73 offen sc1
    v_mfma_f32_16x16x32_bf16 v[36:39], v[76:79], v[172:175], v[36:39]
    ds_read_b128 v[160:163], v20 offset:20480
    buffer_load_dwordx4 a[20:23], v25, s[28:31], s74 offen sc1
    buffer_load_dwordx4 a[8:11], v26, s[28:31], s73 offen sc1
    buffer_load_dwordx4 a[24:27], v26, s[28:31], s74 offen sc1
    buffer_load_dwordx4 a[12:15], v27, s[28:31], s73 offen sc1
    v_mfma_f32_16x16x32_bf16 v[52:55], v[92:95], v[172:175], v[52:55]
    ds_read_b128 v[164:167], v20 offset:22528
    buffer_load_dwordx4 a[28:31], v27, s[28:31], s74 offen sc1
    s_bfe_u32 s73, s97, 262152
    s_lshl_b32 s73, s73, 8
    v_mfma_f32_16x16x32_bf16 v[40:43], v[76:79], v[176:179], v[40:43]
    s_add_u32 s73, s73, s95
    s_add_u32 s74, s73, 0x20000
    buffer_load_dwordx4 a[32:35], v24, s[28:31], s73 offen sc1
    buffer_load_dwordx4 a[48:51], v24, s[28:31], s74 offen sc1
    v_mfma_f32_16x16x32_bf16 v[56:59], v[92:95], v[176:179], v[56:59]
    buffer_load_dwordx4 a[36:39], v25, s[28:31], s73 offen sc1
    buffer_load_dwordx4 a[52:55], v25, s[28:31], s74 offen sc1
    buffer_load_dwordx4 a[40:43], v26, s[28:31], s73 offen sc1
    v_mfma_f32_16x16x32_bf16 v[44:47], v[76:79], v[180:183], v[44:47]
    buffer_load_dwordx4 a[56:59], v26, s[28:31], s74 offen sc1
    buffer_load_dwordx4 a[44:47], v27, s[28:31], s73 offen sc1
    buffer_load_dwordx4 a[60:63], v27, s[28:31], s74 offen sc1
    s_bfe_u32 s73, s97, 262156
    v_mfma_f32_16x16x32_bf16 v[60:63], v[92:95], v[180:183], v[60:63]
    s_lshl_b32 s73, s73, 8
    s_add_u32 s73, s73, s95
    s_add_u32 s74, s73, 0x20000
    s_waitcnt lgkmcnt(0) vmcnt(14)
    v_mfma_f32_16x16x32_bf16 v[32:35], a[0:3], v[152:155], v[32:35]
    ds_read_b128 v[168:171], v21 offset:16384
    buffer_load_dwordx4 a[64:67], v24, s[28:31], s73 offen sc1
    v_mfma_f32_16x16x32_bf16 v[48:51], a[16:19], v[152:155], v[48:51]
    ds_read_b128 v[172:175], v21 offset:18432
    v_mfma_f32_16x16x32_bf16 v[36:39], a[0:3], v[156:159], v[36:39]
    ds_read_b128 v[176:179], v21 offset:20480
    buffer_load_dwordx4 a[80:83], v24, s[28:31], s74 offen sc1
    v_mfma_f32_16x16x32_bf16 v[52:55], a[16:19], v[156:159], v[52:55]
    ds_read_b128 v[180:183], v21 offset:22528
    v_mfma_f32_16x16x32_bf16 v[40:43], a[0:3], v[160:163], v[40:43]
    v_mfma_f32_16x16x32_bf16 v[56:59], a[16:19], v[160:163], v[56:59]
    buffer_load_dwordx4 a[68:71], v25, s[28:31], s73 offen sc1
    v_mfma_f32_16x16x32_bf16 v[44:47], a[0:3], v[164:167], v[44:47]
    v_mfma_f32_16x16x32_bf16 v[60:63], a[16:19], v[164:167], v[60:63]
    s_waitcnt lgkmcnt(0) vmcnt(15)
    v_mfma_f32_16x16x32_bf16 v[32:35], a[4:7], v[168:171], v[32:35]
    ds_read_b128 v[152:155], v22 offset:16384
    buffer_load_dwordx4 a[84:87], v25, s[28:31], s74 offen sc1
    v_mfma_f32_16x16x32_bf16 v[48:51], a[20:23], v[168:171], v[48:51]
    ds_read_b128 v[156:159], v22 offset:18432
    v_mfma_f32_16x16x32_bf16 v[36:39], a[4:7], v[172:175], v[36:39]
    ds_read_b128 v[160:163], v22 offset:20480
    buffer_load_dwordx4 a[72:75], v26, s[28:31], s73 offen sc1
    v_mfma_f32_16x16x32_bf16 v[52:55], a[20:23], v[172:175], v[52:55]
    ds_read_b128 v[164:167], v22 offset:22528
    v_mfma_f32_16x16x32_bf16 v[40:43], a[4:7], v[176:179], v[40:43]
    v_mfma_f32_16x16x32_bf16 v[56:59], a[20:23], v[176:179], v[56:59]
    buffer_load_dwordx4 a[88:91], v26, s[28:31], s74 offen sc1
    v_mfma_f32_16x16x32_bf16 v[44:47], a[4:7], v[180:183], v[44:47]
    v_mfma_f32_16x16x32_bf16 v[60:63], a[20:23], v[180:183], v[60:63]
    s_waitcnt lgkmcnt(0) vmcnt(16)
    v_mfma_f32_16x16x32_bf16 v[32:35], a[8:11], v[152:155], v[32:35]
    ds_read_b128 v[168:171], v23 offset:16384
    buffer_load_dwordx4 a[76:79], v27, s[28:31], s73 offen sc1
    v_mfma_f32_16x16x32_bf16 v[48:51], a[24:27], v[152:155], v[48:51]
    ds_read_b128 v[172:175], v23 offset:18432
    v_mfma_f32_16x16x32_bf16 v[36:39], a[8:11], v[156:159], v[36:39]
    ds_read_b128 v[176:179], v23 offset:20480
    v_mfma_f32_16x16x32_bf16 v[52:55], a[24:27], v[156:159], v[52:55]
    ds_read_b128 v[180:183], v23 offset:22528
    v_mfma_f32_16x16x32_bf16 v[40:43], a[8:11], v[160:163], v[40:43]
    buffer_load_dwordx4 a[92:95], v27, s[28:31], s74 offen sc1
    v_mfma_f32_16x16x32_bf16 v[56:59], a[24:27], v[160:163], v[56:59]
    v_mfma_f32_16x16x32_bf16 v[44:47], a[8:11], v[164:167], v[44:47]
    v_mfma_f32_16x16x32_bf16 v[60:63], a[24:27], v[164:167], v[60:63]
    s_waitcnt lgkmcnt(0) vmcnt(16)
    v_mfma_f32_16x16x32_bf16 v[32:35], a[12:15], v[168:171], v[32:35]
    ds_read_b128 v[152:155], v20 offset:32768
    s_bfe_u32 s73, s97, 262160
    v_lshlrev_b32 v216, 16, v112
    v_mfma_f32_16x16x32_bf16 v[48:51], a[28:31], v[168:171], v[48:51]
    ds_read_b128 v[156:159], v20 offset:34816
    s_lshl_b32 s73, s73, 8
    v_and_b32 v220, 0xffff0000, v112
    v_mfma_f32_16x16x32_bf16 v[36:39], a[12:15], v[172:175], v[36:39]
    ds_read_b128 v[160:163], v20 offset:36864
    s_add_u32 s73, s73, s95
    v_lshlrev_b32_e64 v217, 16, v113
    v_mfma_f32_16x16x32_bf16 v[52:55], a[28:31], v[172:175], v[52:55]
    ds_read_b128 v[164:167], v20 offset:38912
    v_and_b32 v221, 0xffff0000, v113
    v_mfma_f32_16x16x32_bf16 v[40:43], a[12:15], v[176:179], v[40:43]
    s_add_u32 s74, s73, 0x20000
    v_lshlrev_b32_e64 v218, 16, v114
    v_mfma_f32_16x16x32_bf16 v[56:59], a[28:31], v[176:179], v[56:59]
    buffer_load_dwordx4 a[96:99], v24, s[28:31], s73 offen sc1
    v_and_b32 v222, 0xffff0000, v114
    v_mfma_f32_16x16x32_bf16 v[44:47], a[12:15], v[180:183], v[44:47]
    buffer_load_dwordx4 a[112:115], v24, s[28:31], s74 offen sc1
    v_lshlrev_b32_e64 v219, 16, v115
    v_mfma_f32_16x16x32_bf16 v[60:63], a[28:31], v[180:183], v[60:63]
    s_waitcnt lgkmcnt(0) vmcnt(16)
    v_mfma_f32_16x16x32_bf16 v[32:35], a[32:35], v[152:155], v[32:35]
    ds_read_b128 v[168:171], v21 offset:32768
    buffer_load_dwordx4 a[100:103], v25, s[28:31], s73 offen sc1
    v_and_b32 v223, 0xffff0000, v115
    v_mfma_f32_16x16x32_bf16 v[48:51], a[48:51], v[152:155], v[48:51]
    ds_read_b128 v[172:175], v21 offset:34816
    v_lshlrev_b32 v224, 16, v116
    v_mfma_f32_16x16x32_bf16 v[36:39], a[32:35], v[156:159], v[36:39]
    ds_read_b128 v[176:179], v21 offset:36864
    v_and_b32 v228, 0xffff0000, v116
    v_mfma_f32_16x16x32_bf16 v[52:55], a[48:51], v[156:159], v[52:55]
    ds_read_b128 v[180:183], v21 offset:38912
    v_lshlrev_b32_e64 v225, 16, v117
    v_mfma_f32_16x16x32_bf16 v[40:43], a[32:35], v[160:163], v[40:43]
    buffer_load_dwordx4 a[116:119], v25, s[28:31], s74 offen sc1
    v_and_b32 v229, 0xffff0000, v117
    v_mfma_f32_16x16x32_bf16 v[56:59], a[48:51], v[160:163], v[56:59]
    v_lshlrev_b32_e64 v226, 16, v118
    v_mfma_f32_16x16x32_bf16 v[44:47], a[32:35], v[164:167], v[44:47]
    v_and_b32 v230, 0xffff0000, v118
    v_mfma_f32_16x16x32_bf16 v[60:63], a[48:51], v[164:167], v[60:63]
    s_waitcnt lgkmcnt(0) vmcnt(16)
    v_mfma_f32_16x16x32_bf16 v[32:35], a[36:39], v[168:171], v[32:35]
    ds_read_b128 v[152:155], v22 offset:32768
    buffer_load_dwordx4 a[104:107], v26, s[28:31], s73 offen sc1
    v_lshlrev_b32 v227, 16, v119
    v_mfma_f32_16x16x32_bf16 v[48:51], a[52:55], v[168:171], v[48:51]
    ds_read_b128 v[156:159], v22 offset:34816
    buffer_load_dwordx4 a[120:123], v26, s[28:31], s74 offen sc1
    v_and_b32 v231, 0xffff0000, v119
    v_mfma_f32_16x16x32_bf16 v[36:39], a[36:39], v[172:175], v[36:39]
    ds_read_b128 v[160:163], v22 offset:36864
    s_getpc_b64 s[20:21]
K_PC3:
    s_mov_b32 s22, K_CODE_END-K_PC3
    v_lshlrev_b32 v232, 16, v120
    v_mfma_f32_16x16x32_bf16 v[52:55], a[52:55], v[172:175], v[52:55]
    ds_read_b128 v[164:167], v22 offset:38912
    s_bfe_u32 s3, s2, 0x20003
    v_and_b32 v236, 0xffff0000, v120
    v_mfma_f32_16x16x32_bf16 v[40:43], a[36:39], v[176:179], v[40:43]
    s_lshl2_add_u32 s3, s3, s34
    v_lshlrev_b32 v233, 16, v121
    v_mfma_f32_16x16x32_bf16 v[56:59], a[52:55], v[176:179], v[56:59]
    s_lshl_b32 s3, s3, 11
    v_and_b32 v237, 0xffff0000, v121
    v_mfma_f32_16x16x32_bf16 v[44:47], a[36:39], v[180:183], v[44:47]
    v_lshl_add_u32 v28, v0, 5, s3
    v_lshlrev_b32 v234, 16, v122
    v_mfma_f32_16x16x32_bf16 v[60:63], a[52:55], v[180:183], v[60:63]
    buffer_load_dword v11, v28, s[20:23], 0 offen
    s_waitcnt lgkmcnt(0) vmcnt(17)
    v_mfma_f32_16x16x32_bf16 v[32:35], a[40:43], v[152:155], v[32:35]
    ds_read_b128 v[168:171], v23 offset:32768
    buffer_load_dwordx4 a[108:111], v27, s[28:31], s73 offen sc1
    v_and_b32 v238, 0xffff0000, v122
    v_mfma_f32_16x16x32_bf16 v[48:51], a[56:59], v[152:155], v[48:51]
    ds_read_b128 v[172:175], v23 offset:34816
    v_lshlrev_b32 v235, 16, v123
    v_mfma_f32_16x16x32_bf16 v[36:39], a[40:43], v[156:159], v[36:39]
    ds_read_b128 v[176:179], v23 offset:36864
    v_and_b32 v239, 0xffff0000, v123
    v_mfma_f32_16x16x32_bf16 v[52:55], a[56:59], v[156:159], v[52:55]
    ds_read_b128 v[180:183], v23 offset:38912
    v_lshlrev_b32_e64 v240, 16, v124
    v_mfma_f32_16x16x32_bf16 v[40:43], a[40:43], v[160:163], v[40:43]
    buffer_load_dwordx4 a[124:127], v27, s[28:31], s74 offen sc1
    v_and_b32 v244, 0xffff0000, v124
    v_mfma_f32_16x16x32_bf16 v[56:59], a[56:59], v[160:163], v[56:59]
    v_lshlrev_b32_e64 v241, 16, v125
    v_mfma_f32_16x16x32_bf16 v[44:47], a[40:43], v[164:167], v[44:47]
    v_and_b32 v245, 0xffff0000, v125
    v_mfma_f32_16x16x32_bf16 v[60:63], a[56:59], v[164:167], v[60:63]
    s_waitcnt lgkmcnt(0) vmcnt(17)
    v_mfma_f32_16x16x32_bf16 v[32:35], a[44:47], v[168:171], v[32:35]
    ds_read_b128 v[152:155], v20 offset:49152
    s_bfe_u32 s73, s97, 262164
    v_lshlrev_b32 v242, 16, v126
    v_mfma_f32_16x16x32_bf16 v[48:51], a[60:63], v[168:171], v[48:51]
    ds_read_b128 v[156:159], v20 offset:51200
    s_lshl_b32 s73, s73, 8
    v_and_b32 v246, 0xffff0000, v126
    v_mfma_f32_16x16x32_bf16 v[36:39], a[44:47], v[172:175], v[36:39]
    ds_read_b128 v[160:163], v20 offset:53248
    s_add_u32 s73, s73, s95
    v_lshlrev_b32_e64 v243, 16, v127
    v_mfma_f32_16x16x32_bf16 v[52:55], a[60:63], v[172:175], v[52:55]
    ds_read_b128 v[164:167], v20 offset:55296
    v_and_b32 v247, 0xffff0000, v127
    v_mfma_f32_16x16x32_bf16 v[40:43], a[44:47], v[176:179], v[40:43]
    s_add_u32 s74, s73, 0x20000
    v_xor_b32 v16, 0x100000, v16
    v_mfma_f32_16x16x32_bf16 v[56:59], a[60:63], v[176:179], v[56:59]
    buffer_load_dwordx4 a[128:131], v24, s[28:31], s73 offen sc1
    v_xor_b32 v17, 0x100000, v17
    v_mfma_f32_16x16x32_bf16 v[44:47], a[44:47], v[180:183], v[44:47]
    buffer_load_dwordx4 a[144:147], v24, s[28:31], s74 offen sc1
    v_xor_b32 v18, 0x100000, v18
    v_xor_b32 v20, 0x10000, v20
    v_mfma_f32_16x16x32_bf16 v[60:63], a[60:63], v[180:183], v[60:63]
    s_waitcnt lgkmcnt(0) vmcnt(17)
    v_mfma_f32_16x16x32_bf16 v[32:35], a[64:67], v[152:155], v[32:35]
    ds_read_b128 v[168:171], v21 offset:49152
    buffer_load_dwordx4 a[132:135], v25, s[28:31], s73 offen sc1
    v_xor_b32 v19, 0x100000, v19
    v_mfma_f32_16x16x32_bf16 v[48:51], a[80:83], v[152:155], v[48:51]
    ds_read_b128 v[172:175], v21 offset:51200
    v_lshlrev_b32 v29, 16, v2
    v_mfma_f32_16x16x32_bf16 v[36:39], a[64:67], v[156:159], v[36:39]
    ds_read_b128 v[176:179], v21 offset:53248
    v_lshl_add_u32 v29, v1, 4, v29
    v_mfma_f32_16x16x32_bf16 v[52:55], a[80:83], v[156:159], v[52:55]
    ds_read_b128 v[180:183], v21 offset:55296
    s_lshl_b32 s38, s2, 14
    v_mfma_f32_16x16x32_bf16 v[40:43], a[64:67], v[160:163], v[40:43]
    buffer_load_dwordx4 a[148:151], v25, s[28:31], s74 offen sc1
    s_add_u32 s38, s38, s37
    v_mfma_f32_16x16x32_bf16 v[56:59], a[80:83], v[160:163], v[56:59]
    s_add_u32 s52, s38, 17825792
    v_mfma_f32_16x16x32_bf16 v[44:47], a[64:67], v[164:167], v[44:47]
    s_xor_b32 s38, s38, 65536
    v_xor_b32 v21, 0x10000, v21
    v_mfma_f32_16x16x32_bf16 v[60:63], a[80:83], v[164:167], v[60:63]
    s_waitcnt lgkmcnt(0) vmcnt(17)
    v_mfma_f32_16x16x32_bf16 v[32:35], a[68:71], v[168:171], v[32:35]
    ds_read_b128 v[152:155], v22 offset:49152
    v_lshlrev_b32 v13, 3, v0
    s_add_u32 s54, s38, 17825792
    v_mfma_f32_16x16x32_bf16 v[48:51], a[84:87], v[168:171], v[48:51]
    ds_read_b128 v[156:159], v22 offset:51200
    s_lshl_b32 s70, s34, 9
    s_lshl_b32 s38, s4, 14
    v_mfma_f32_16x16x32_bf16 v[36:39], a[68:71], v[172:175], v[36:39]
    ds_read_b128 v[160:163], v22 offset:53248
    s_add_u32 s70, s70, 22396928
    s_add_u32 s38, s38, s37
    v_mfma_f32_16x16x32_bf16 v[52:55], a[84:87], v[172:175], v[52:55]
    ds_read_b128 v[164:167], v22 offset:55296
    s_add_u32 s53, s38, 13631488
    v_mfma_f32_16x16x32_bf16 v[40:43], a[68:71], v[176:179], v[40:43]
    buffer_load_dword v8, v13, s[24:27], s70 offen sc1
    s_lshl2_add_u32 s38, s32, s34
    v_mfma_f32_16x16x32_bf16 v[56:59], a[84:87], v[176:179], v[56:59]
    buffer_load_dwordx4 a[136:139], v26, s[28:31], s73 offen sc1
    s_lshl_b32 s38, s38, 10
    v_mfma_f32_16x16x32_bf16 v[44:47], a[68:71], v[180:183], v[44:47]
    buffer_load_dwordx4 a[152:155], v26, s[28:31], s74 offen sc1
    s_add_u32 s55, s38, 22282240
    v_xor_b32 v22, 0x10000, v22
    v_mfma_f32_16x16x32_bf16 v[60:63], a[84:87], v[180:183], v[60:63]
    s_waitcnt lgkmcnt(0) vmcnt(18)
    v_mfma_f32_16x16x32_bf16 v[32:35], a[72:75], v[152:155], v[32:35]
    ds_read_b128 v[168:171], v23 offset:49152
    buffer_load_dwordx4 a[140:143], v27, s[28:31], s73 offen sc1
    v_lshlrev_b32_e64 v7, 8, v2
    v_mfma_f32_16x16x32_bf16 v[48:51], a[88:91], v[152:155], v[48:51]
    ds_read_b128 v[172:175], v23 offset:51200
    s_lshl_b32 s38, s94, 16
    v_mfma_f32_16x16x32_bf16 v[36:39], a[72:75], v[156:159], v[36:39]
    ds_read_b128 v[176:179], v23 offset:53248
    s_add_u32 s56, s38, s5
    v_mfma_f32_16x16x32_bf16 v[52:55], a[88:91], v[156:159], v[52:55]
    ds_read_b128 v[180:183], v23 offset:55296
    v_lshlrev_b32_e64 v12, 14, v2
    v_mfma_f32_16x16x32_bf16 v[40:43], a[72:75], v[160:163], v[40:43]
    buffer_load_dwordx4 a[156:159], v27, s[28:31], s74 offen sc1
    v_lshl_add_u32 v12, v1, 4, v12
    v_mfma_f32_16x16x32_bf16 v[56:59], a[88:91], v[160:163], v[56:59]
    s_lshl_b32 s38, s4, 6
    v_mfma_f32_16x16x32_bf16 v[44:47], a[72:75], v[164:167], v[44:47]
    s_add_u32 s58, s38, 22429696
    v_xor_b32 v23, 0x10000, v23
    v_mfma_f32_16x16x32_bf16 v[60:63], a[88:91], v[164:167], v[60:63]
    s_waitcnt lgkmcnt(0) vmcnt(18)
    v_mfma_f32_16x16x32_bf16 v[32:35], a[76:79], v[168:171], v[32:35]
    ds_read_b128 v[152:155], v20 offset:0
    s_bfe_u32 s73, s97, 262168
    s_add_u32 s57, s38, 22413312
    v_mfma_f32_16x16x32_bf16 v[48:51], a[92:95], v[168:171], v[48:51]
    ds_read_b128 v[156:159], v20 offset:2048
    s_lshl_b32 s73, s73, 8
    v_lshl_add_u32 v5, v1, 6, s99
    v_mfma_f32_16x16x32_bf16 v[36:39], a[76:79], v[172:175], v[36:39]
    ds_read_b128 v[160:163], v20 offset:4096
    s_add_u32 s73, s73, s95
    s_xor_b32 s38, s33, 264
    v_mfma_f32_16x16x32_bf16 v[52:55], a[92:95], v[172:175], v[52:55]
    ds_read_b128 v[164:167], v20 offset:6144
    v_mfma_f32_16x16x32_bf16 v[40:43], a[76:79], v[176:179], v[40:43]
    s_add_u32 s74, s73, 0x20000
    s_lshl_b32 s38, s38, 6
    v_mfma_f32_16x16x32_bf16 v[56:59], a[92:95], v[176:179], v[56:59]
    buffer_load_dwordx4 a[160:163], v24, s[28:31], s73 offen sc1
    s_add_u32 s38, s38, s99
    v_mfma_f32_16x16x32_bf16 v[44:47], a[76:79], v[180:183], v[44:47]
    buffer_load_dwordx4 a[176:179], v24, s[28:31], s74 offen sc1
    v_mov_b32_e64 v9, s38
    v_mfma_f32_16x16x32_bf16 v[60:63], a[92:95], v[180:183], v[60:63]
    s_waitcnt lgkmcnt(0) vmcnt(18)
    v_mfma_f32_16x16x32_bf16 v[32:35], a[96:99], v[152:155], v[32:35]
    ds_read_b128 v[168:171], v21 offset:0
    buffer_load_dwordx4 a[164:167], v25, s[28:31], s73 offen sc1
    v_mfma_f32_16x16x32_bf16 v[48:51], a[112:115], v[152:155], v[48:51]
    ds_read_b128 v[172:175], v21 offset:2048
    v_mfma_f32_16x16x32_bf16 v[36:39], a[96:99], v[156:159], v[36:39]
    ds_read_b128 v[176:179], v21 offset:4096
    v_mfma_f32_16x16x32_bf16 v[52:55], a[112:115], v[156:159], v[52:55]
    ds_read_b128 v[180:183], v21 offset:6144
    v_mfma_f32_16x16x32_bf16 v[40:43], a[96:99], v[160:163], v[40:43]
    buffer_load_dwordx4 a[180:183], v25, s[28:31], s74 offen sc1
    v_mfma_f32_16x16x32_bf16 v[56:59], a[112:115], v[160:163], v[56:59]
    v_mfma_f32_16x16x32_bf16 v[44:47], a[96:99], v[164:167], v[44:47]
    v_mfma_f32_16x16x32_bf16 v[60:63], a[112:115], v[164:167], v[60:63]
    s_waitcnt lgkmcnt(0) vmcnt(18)
    v_mfma_f32_16x16x32_bf16 v[32:35], a[100:103], v[168:171], v[32:35]
    ds_read_b128 v[152:155], v22 offset:0
    buffer_load_dwordx4 a[168:171], v26, s[28:31], s73 offen sc1
    v_mfma_f32_16x16x32_bf16 v[48:51], a[116:119], v[168:171], v[48:51]
    ds_read_b128 v[156:159], v22 offset:2048
    v_mfma_f32_16x16x32_bf16 v[36:39], a[100:103], v[172:175], v[36:39]
    ds_read_b128 v[160:163], v22 offset:4096
    v_mfma_f32_16x16x32_bf16 v[52:55], a[116:119], v[172:175], v[52:55]
    ds_read_b128 v[164:167], v22 offset:6144
    v_mfma_f32_16x16x32_bf16 v[40:43], a[100:103], v[176:179], v[40:43]
    buffer_load_dwordx4 a[184:187], v26, s[28:31], s74 offen sc1
    v_mfma_f32_16x16x32_bf16 v[56:59], a[116:119], v[176:179], v[56:59]
    v_mfma_f32_16x16x32_bf16 v[44:47], a[100:103], v[180:183], v[44:47]
    v_mfma_f32_16x16x32_bf16 v[60:63], a[116:119], v[180:183], v[60:63]
    s_waitcnt lgkmcnt(0) vmcnt(18)
    v_mfma_f32_16x16x32_bf16 v[32:35], a[104:107], v[152:155], v[32:35]
    ds_read_b128 v[168:171], v23 offset:0
    buffer_load_dwordx4 a[172:175], v27, s[28:31], s73 offen sc1
    v_mfma_f32_16x16x32_bf16 v[48:51], a[120:123], v[152:155], v[48:51]
    ds_read_b128 v[172:175], v23 offset:2048
    v_mfma_f32_16x16x32_bf16 v[36:39], a[104:107], v[156:159], v[36:39]
    ds_read_b128 v[176:179], v23 offset:4096
    v_mfma_f32_16x16x32_bf16 v[52:55], a[120:123], v[156:159], v[52:55]
    ds_read_b128 v[180:183], v23 offset:6144
    v_mfma_f32_16x16x32_bf16 v[40:43], a[104:107], v[160:163], v[40:43]
    buffer_load_dwordx4 a[188:191], v27, s[28:31], s74 offen sc1
    v_mfma_f32_16x16x32_bf16 v[56:59], a[120:123], v[160:163], v[56:59]
    v_mfma_f32_16x16x32_bf16 v[44:47], a[104:107], v[164:167], v[44:47]
    v_mfma_f32_16x16x32_bf16 v[60:63], a[120:123], v[164:167], v[60:63]
    s_waitcnt lgkmcnt(0) vmcnt(12)
    v_cmp_ne_u32 vcc, s35, v8
    s_nop 0
    s_cbranch_vccnz K_POLL4
K_POLL4_OK:
    s_barrier
    v_mfma_f32_16x16x32_bf16 v[32:35], a[108:111], v[168:171], v[32:35]
    ds_read_b128 v[152:155], v20 offset:16384
    s_bfe_u32 s73, s97, 262172
    v_mfma_f32_16x16x32_bf16 v[48:51], a[124:127], v[168:171], v[48:51]
    ds_read_b128 v[156:159], v20 offset:18432
    s_lshl_b32 s73, s73, 8
    v_mfma_f32_16x16x32_bf16 v[36:39], a[108:111], v[172:175], v[36:39]
    ds_read_b128 v[160:163], v20 offset:20480
    s_add_u32 s73, s73, s95
    v_mfma_f32_16x16x32_bf16 v[52:55], a[124:127], v[172:175], v[52:55]
    ds_read_b128 v[164:167], v20 offset:22528
    v_mfma_f32_16x16x32_bf16 v[40:43], a[108:111], v[176:179], v[40:43]
    s_add_u32 s74, s73, 0x20000
    v_mfma_f32_16x16x32_bf16 v[56:59], a[124:127], v[176:179], v[56:59]
    buffer_load_dwordx4 a[192:195], v24, s[28:31], s73 offen sc1 nt
    v_mfma_f32_16x16x32_bf16 v[44:47], a[108:111], v[180:183], v[44:47]
    buffer_load_dwordx4 a[208:211], v24, s[28:31], s74 offen sc1 nt
    v_mfma_f32_16x16x32_bf16 v[60:63], a[124:127], v[180:183], v[60:63]
    s_waitcnt lgkmcnt(0)
    v_mfma_f32_16x16x32_bf16 v[32:35], a[128:131], v[152:155], v[32:35]
    ds_read_b128 v[168:171], v21 offset:16384
    s_lshl2_add_u32 s70, s4, s34
    v_mfma_f32_16x16x32_bf16 v[48:51], a[144:147], v[152:155], v[48:51]
    ds_read_b128 v[172:175], v21 offset:18432
    s_lshl_b32 s70, s70, 12
    v_mfma_f32_16x16x32_bf16 v[36:39], a[128:131], v[156:159], v[36:39]
    ds_read_b128 v[176:179], v21 offset:20480
    s_add_u32 m0, s37, 131072
    v_mfma_f32_16x16x32_bf16 v[52:55], a[144:147], v[156:159], v[52:55]
    ds_read_b128 v[180:183], v21 offset:22528
    s_add_u32 s70, s70, 9437184
    v_mfma_f32_16x16x32_bf16 v[40:43], a[128:131], v[160:163], v[40:43]
    buffer_load_dwordx4 v133, s[24:27], s70 offen offset:0 sc1 lds
    v_mfma_f32_16x16x32_bf16 v[56:59], a[144:147], v[160:163], v[56:59]
    buffer_load_dwordx4 v133, s[24:27], s70 offen offset:1024 sc1 lds
    v_mfma_f32_16x16x32_bf16 v[44:47], a[128:131], v[164:167], v[44:47]
    buffer_load_dwordx4 a[196:199], v25, s[28:31], s73 offen sc1 nt
    v_mfma_f32_16x16x32_bf16 v[60:63], a[144:147], v[164:167], v[60:63]
    buffer_load_dwordx4 a[212:215], v25, s[28:31], s74 offen sc1 nt
    s_waitcnt lgkmcnt(0)
    v_mfma_f32_16x16x32_bf16 v[32:35], a[132:135], v[168:171], v[32:35]
    ds_read_b128 v[152:155], v22 offset:16384
    buffer_load_dwordx4 v133, s[24:27], s70 offen offset:2048 sc1 lds
    v_mfma_f32_16x16x32_bf16 v[48:51], a[148:151], v[168:171], v[48:51]
    ds_read_b128 v[156:159], v22 offset:18432
    v_mfma_f32_16x16x32_bf16 v[36:39], a[132:135], v[172:175], v[36:39]
    ds_read_b128 v[160:163], v22 offset:20480
    buffer_load_dwordx4 v133, s[24:27], s70 offen offset:3072 sc1 lds
    v_mfma_f32_16x16x32_bf16 v[52:55], a[148:151], v[172:175], v[52:55]
    ds_read_b128 v[164:167], v22 offset:22528
    v_mfma_f32_16x16x32_bf16 v[40:43], a[132:135], v[176:179], v[40:43]
    buffer_load_dwordx4 a[200:203], v26, s[28:31], s73 offen sc1 nt
    v_mfma_f32_16x16x32_bf16 v[56:59], a[148:151], v[176:179], v[56:59]
    v_mfma_f32_16x16x32_bf16 v[44:47], a[132:135], v[180:183], v[44:47]
    buffer_load_dwordx4 a[216:219], v26, s[28:31], s74 offen sc1 nt
    v_mfma_f32_16x16x32_bf16 v[60:63], a[148:151], v[180:183], v[60:63]
    s_waitcnt lgkmcnt(0) vmcnt(20)
    v_mfma_f32_16x16x32_bf16 v[32:35], a[136:139], v[152:155], v[32:35]
    ds_read_b128 v[168:171], v23 offset:16384
    buffer_load_dwordx4 a[204:207], v27, s[28:31], s73 offen sc1 nt
    v_mfma_f32_16x16x32_bf16 v[48:51], a[152:155], v[152:155], v[48:51]
    ds_read_b128 v[172:175], v23 offset:18432
    v_mfma_f32_16x16x32_bf16 v[36:39], a[136:139], v[156:159], v[36:39]
    ds_read_b128 v[176:179], v23 offset:20480
    v_mfma_f32_16x16x32_bf16 v[52:55], a[152:155], v[156:159], v[52:55]
    ds_read_b128 v[180:183], v23 offset:22528
    v_mfma_f32_16x16x32_bf16 v[40:43], a[136:139], v[160:163], v[40:43]
    buffer_load_dwordx4 a[220:223], v27, s[28:31], s74 offen sc1 nt
    v_mfma_f32_16x16x32_bf16 v[56:59], a[152:155], v[160:163], v[56:59]
    v_mfma_f32_16x16x32_bf16 v[44:47], a[136:139], v[164:167], v[44:47]
    v_mfma_f32_16x16x32_bf16 v[60:63], a[152:155], v[164:167], v[60:63]
    s_waitcnt lgkmcnt(0) vmcnt(20)
    v_mfma_f32_16x16x32_bf16 v[32:35], a[140:143], v[168:171], v[32:35]
    ds_read_b128 v[152:155], v20 offset:32768
    v_mfma_f32_16x16x32_bf16 v[48:51], a[156:159], v[168:171], v[48:51]
    ds_read_b128 v[156:159], v20 offset:34816
    v_mfma_f32_16x16x32_bf16 v[36:39], a[140:143], v[172:175], v[36:39]
    ds_read_b128 v[160:163], v20 offset:36864
    v_mfma_f32_16x16x32_bf16 v[52:55], a[156:159], v[172:175], v[52:55]
    ds_read_b128 v[164:167], v20 offset:38912
    v_mfma_f32_16x16x32_bf16 v[40:43], a[140:143], v[176:179], v[40:43]
    v_mfma_f32_16x16x32_bf16 v[56:59], a[156:159], v[176:179], v[56:59]
    v_mfma_f32_16x16x32_bf16 v[44:47], a[140:143], v[180:183], v[44:47]
    v_mfma_f32_16x16x32_bf16 v[60:63], a[156:159], v[180:183], v[60:63]
    s_waitcnt lgkmcnt(0) vmcnt(18)
    v_mfma_f32_16x16x32_bf16 v[32:35], a[160:163], v[152:155], v[32:35]
    ds_read_b128 v[168:171], v21 offset:32768
    s_bfe_u32 s72, s97, 262144
    v_mfma_f32_16x16x32_bf16 v[48:51], a[176:179], v[152:155], v[48:51]
    ds_read_b128 v[172:175], v21 offset:34816
    s_add_u32 m0, s37, 0
    v_mfma_f32_16x16x32_bf16 v[36:39], a[160:163], v[156:159], v[36:39]
    ds_read_b128 v[176:179], v21 offset:36864
    v_mfma_f32_16x16x32_bf16 v[52:55], a[176:179], v[156:159], v[52:55]
    ds_read_b128 v[180:183], v21 offset:38912
    s_lshl_b32 s72, s72, 7
    v_mfma_f32_16x16x32_bf16 v[40:43], a[160:163], v[160:163], v[40:43]
    buffer_load_dwordx4 v16, s[16:19], s72 offen offset:0  lds
    v_mfma_f32_16x16x32_bf16 v[56:59], a[176:179], v[160:163], v[56:59]
    v_mfma_f32_16x16x32_bf16 v[44:47], a[160:163], v[164:167], v[44:47]
    buffer_load_dwordx4 v17, s[16:19], s72 offen offset:1024  lds
    v_mfma_f32_16x16x32_bf16 v[60:63], a[176:179], v[164:167], v[60:63]
    s_waitcnt lgkmcnt(0) vmcnt(18)
    v_mfma_f32_16x16x32_bf16 v[32:35], a[164:167], v[168:171], v[32:35]
    ds_read_b128 v[152:155], v22 offset:32768
    buffer_load_dwordx4 v18, s[16:19], s72 offen offset:2048  lds
    v_mfma_f32_16x16x32_bf16 v[48:51], a[180:183], v[168:171], v[48:51]
    ds_read_b128 v[156:159], v22 offset:34816
    v_mfma_f32_16x16x32_bf16 v[36:39], a[164:167], v[172:175], v[36:39]
    ds_read_b128 v[160:163], v22 offset:36864
    v_mfma_f32_16x16x32_bf16 v[52:55], a[180:183], v[172:175], v[52:55]
    ds_read_b128 v[164:167], v22 offset:38912
    v_mfma_f32_16x16x32_bf16 v[40:43], a[164:167], v[176:179], v[40:43]
    buffer_load_dwordx4 v19, s[16:19], s72 offen offset:3072  lds
    v_mfma_f32_16x16x32_bf16 v[56:59], a[180:183], v[176:179], v[56:59]
    v_mfma_f32_16x16x32_bf16 v[44:47], a[164:167], v[180:183], v[44:47]
    v_mfma_f32_16x16x32_bf16 v[60:63], a[180:183], v[180:183], v[60:63]
    s_waitcnt lgkmcnt(0) vmcnt(8)
    s_barrier
    v_mfma_f32_16x16x32_bf16 v[32:35], a[168:171], v[152:155], v[32:35]
    ds_read_b128 v[168:171], v23 offset:32768
    s_bfe_u32 s72, s97, 262148
    v_mfma_f32_16x16x32_bf16 v[48:51], a[184:187], v[152:155], v[48:51]
    ds_read_b128 v[172:175], v23 offset:34816
    s_add_u32 m0, s37, 16384
    v_mfma_f32_16x16x32_bf16 v[36:39], a[168:171], v[156:159], v[36:39]
    ds_read_b128 v[176:179], v23 offset:36864
    v_mfma_f32_16x16x32_bf16 v[52:55], a[184:187], v[156:159], v[52:55]
    ds_read_b128 v[180:183], v23 offset:38912
    s_lshl_b32 s72, s72, 7
    v_mfma_f32_16x16x32_bf16 v[40:43], a[168:171], v[160:163], v[40:43]
    ds_read_b64 v[184:185], v130 offset:0
    buffer_load_dwordx4 v16, s[16:19], s72 offen offset:0  lds
    v_mfma_f32_16x16x32_bf16 v[56:59], a[184:187], v[160:163], v[56:59]
    ds_read_b64 v[186:187], v130 offset:1024
    v_mfma_f32_16x16x32_bf16 v[44:47], a[168:171], v[164:167], v[44:47]
    ds_read_b64 v[188:189], v130 offset:2048
    buffer_load_dwordx4 v17, s[16:19], s72 offen offset:1024  lds
    v_mfma_f32_16x16x32_bf16 v[60:63], a[184:187], v[164:167], v[60:63]
    ds_read_b64 v[190:191], v130 offset:3072
    s_waitcnt lgkmcnt(4)
    v_mfma_f32_16x16x32_bf16 v[32:35], a[172:175], v[168:171], v[32:35]
    ds_read_b128 v[152:155], v20 offset:49152
    buffer_load_dwordx4 v18, s[16:19], s72 offen offset:2048  lds
    s_waitcnt lgkmcnt(1)
    v_mfma_f32_16x16x32_bf16 v[48:51], a[188:191], v[168:171], v[48:51]
    ds_read_b128 v[156:159], v20 offset:51200
    v_swap_b32 v185, v186
    v_mfma_f32_16x16x32_bf16 v[36:39], a[172:175], v[172:175], v[36:39]
    ds_read_b128 v[160:163], v20 offset:53248
    v_mfma_f32_16x16x32_bf16 v[52:55], a[188:191], v[172:175], v[52:55]
    ds_read_b128 v[164:167], v20 offset:55296
    v_swap_b32 v189, v190
    v_mfma_f32_16x16x32_bf16 v[40:43], a[172:175], v[176:179], v[40:43]
    ds_read_b64 v[192:193], v132 offset:0
    buffer_load_dwordx4 v19, s[16:19], s72 offen offset:3072  lds
    v_swap_b32 v186, v188
    v_mfma_f32_16x16x32_bf16 v[56:59], a[188:191], v[176:179], v[56:59]
    ds_read_b64 v[194:195], v131 offset:2048
    v_mfma_f32_16x16x32_bf16 v[44:47], a[172:175], v[180:183], v[44:47]
    ds_read_b64 v[196:197], v131 offset:1024
    v_swap_b32 v187, v189
    v_xor_b32 v20, 0x10000, v20
    v_mfma_f32_16x16x32_bf16 v[60:63], a[188:191], v[180:183], v[60:63]
    ds_read_b64 v[198:199], v131 offset:0
    v_mfma_f32_16x16x32_bf16 v[112:115], v[184:187], a[224:227], 0
    s_bfe_u32 s72, s97, 262152
    v_mfma_f32_16x16x32_bf16 v[116:119], v[184:187], a[228:231], 0
    s_add_u32 m0, s37, 32768
    s_waitcnt lgkmcnt(0)
    v_swap_b32 v193, v194
    v_mfma_f32_16x16x32_bf16 v[120:123], v[184:187], a[232:235], 0
    v_swap_b32 v197, v198
    v_swap_b32 v194, v196
    v_mfma_f32_16x16x32_bf16 v[124:127], v[184:187], a[236:239], 0
    s_lshl_b32 s72, s72, 7
    v_swap_b32 v195, v197
    v_mfma_f32_16x16x32_bf16 v[144:147], v[188:191], a[224:227], 0
    buffer_load_dwordx4 v16, s[16:19], s72 offen offset:0  lds
    v_mfma_f32_16x16x32_bf16 v[148:151], v[188:191], a[228:231], 0
    v_mfma_f32_16x16x32_bf16 v[248:251], v[188:191], a[232:235], 0
    buffer_load_dwordx4 v17, s[16:19], s72 offen offset:1024  lds
    v_mfma_f32_16x16x32_bf16 v[252:255], v[188:191], a[236:239], 0
    buffer_load_dwordx4 v18, s[16:19], s72 offen offset:2048  lds
    v_mfma_f32_16x16x32_bf16 v[112:115], v[192:195], a[224:227], v[112:115]
    v_mfma_f32_16x16x32_bf16 v[116:119], v[192:195], a[228:231], v[116:119]
    buffer_load_dwordx4 v19, s[16:19], s72 offen offset:3072  lds
    v_mfma_f32_16x16x32_bf16 v[120:123], v[192:195], a[240:243], v[120:123]
    s_bfe_u32 s72, s97, 262156
    v_mfma_f32_16x16x32_bf16 v[124:127], v[192:195], a[244:247], v[124:127]
    v_mfma_f32_16x16x32_bf16 v[144:147], v[196:199], a[224:227], v[144:147]
    s_add_u32 m0, s37, 49152
    v_mfma_f32_16x16x32_bf16 v[148:151], v[196:199], a[228:231], v[148:151]
    s_lshl_b32 s72, s72, 7
    v_mfma_f32_16x16x32_bf16 v[248:251], v[196:199], a[240:243], v[248:251]
    v_mfma_f32_16x16x32_bf16 v[252:255], v[196:199], a[244:247], v[252:255]
    v_pk_mul_f32 v[134:135], v[112:113], v[96:97]
    v_pk_mul_f32 v[136:137], v[116:117], v[96:97]
    v_pk_fma_f32 v[134:135], v[116:117], v[104:105], v[134:135]
    v_pk_fma_f32 v[136:137], v[112:113], v[104:105], v[136:137] neg_lo:[1,0,0] neg_hi:[1,0,0]
    v_pk_mul_f32 v[138:139], v[114:115], v[98:99]
    v_pk_mul_f32 v[140:141], v[118:119], v[98:99]
    v_pk_fma_f32 v[138:139], v[118:119], v[106:107], v[138:139]
    v_pk_fma_f32 v[140:141], v[114:115], v[106:107], v[140:141] neg_lo:[1,0,0] neg_hi:[1,0,0]
    v_cvt_pk_bf16_f32 v184, v134, v136
    v_cvt_pk_bf16_f32 v185, v135, v137
    v_cvt_pk_bf16_f32 v186, v138, v140
    v_cvt_pk_bf16_f32 v187, v139, v141
    v_pk_mul_f32 v[134:135], v[120:121], v[100:101]
    v_pk_mul_f32 v[136:137], v[124:125], v[100:101]
    v_pk_fma_f32 v[134:135], v[124:125], v[108:109], v[134:135]
    v_pk_fma_f32 v[136:137], v[120:121], v[108:109], v[136:137] neg_lo:[1,0,0] neg_hi:[1,0,0]
    v_pk_mul_f32 v[138:139], v[122:123], v[102:103]
    v_pk_mul_f32 v[140:141], v[126:127], v[102:103]
    v_pk_fma_f32 v[138:139], v[126:127], v[110:111], v[138:139]
    v_pk_fma_f32 v[140:141], v[122:123], v[110:111], v[140:141] neg_lo:[1,0,0] neg_hi:[1,0,0]
    v_cvt_pk_bf16_f32 v188, v134, v136
    v_cvt_pk_bf16_f32 v189, v135, v137
    v_cvt_pk_bf16_f32 v190, v138, v140
    v_cvt_pk_bf16_f32 v191, v139, v141
    v_pk_mul_f32 v[134:135], v[144:145], v[96:97]
    v_pk_mul_f32 v[136:137], v[148:149], v[96:97]
    v_pk_fma_f32 v[134:135], v[148:149], v[104:105], v[134:135]
    v_pk_fma_f32 v[136:137], v[144:145], v[104:105], v[136:137] neg_lo:[1,0,0] neg_hi:[1,0,0]
    v_pk_mul_f32 v[138:139], v[146:147], v[98:99]
    v_pk_mul_f32 v[140:141], v[150:151], v[98:99]
    v_pk_fma_f32 v[138:139], v[150:151], v[106:107], v[138:139]
    v_pk_fma_f32 v[140:141], v[146:147], v[106:107], v[140:141] neg_lo:[1,0,0] neg_hi:[1,0,0]
    v_cvt_pk_bf16_f32 v192, v134, v136
    v_cvt_pk_bf16_f32 v193, v135, v137
    v_cvt_pk_bf16_f32 v194, v138, v140
    v_cvt_pk_bf16_f32 v195, v139, v141
    v_pk_mul_f32 v[134:135], v[248:249], v[100:101]
    v_pk_mul_f32 v[136:137], v[252:253], v[100:101]
    v_pk_fma_f32 v[134:135], v[252:253], v[108:109], v[134:135]
    v_pk_fma_f32 v[136:137], v[248:249], v[108:109], v[136:137] neg_lo:[1,0,0] neg_hi:[1,0,0]
    v_pk_mul_f32 v[138:139], v[250:251], v[102:103]
    v_pk_mul_f32 v[140:141], v[254:255], v[102:103]
    v_pk_fma_f32 v[138:139], v[254:255], v[110:111], v[138:139]
    v_pk_fma_f32 v[140:141], v[250:251], v[110:111], v[140:141] neg_lo:[1,0,0] neg_hi:[1,0,0]
    v_cvt_pk_bf16_f32 v196, v134, v136
    v_cvt_pk_bf16_f32 v197, v135, v137
    v_cvt_pk_bf16_f32 v198, v138, v140
    v_cvt_pk_bf16_f32 v199, v139, v141
    v_mfma_f32_16x16x32_bf16 v[112:115], a[224:227], v[184:187], 0
    buffer_load_dwordx4 v16, s[16:19], s72 offen offset:0  lds
    v_mfma_f32_16x16x32_bf16 v[116:119], a[228:231], v[184:187], 0
    buffer_load_dwordx4 v17, s[16:19], s72 offen offset:1024  lds
    v_mfma_f32_16x16x32_bf16 v[120:123], a[224:227], v[188:191], 0
    v_mfma_f32_16x16x32_bf16 v[124:127], a[228:231], v[188:191], 0
    buffer_load_dwordx4 v18, s[16:19], s72 offen offset:2048  lds
    v_mfma_f32_16x16x32_bf16 v[144:147], a[224:227], v[192:195], 0
    buffer_load_dwordx4 v19, s[16:19], s72 offen offset:3072  lds
    v_mfma_f32_16x16x32_bf16 v[148:151], a[228:231], v[192:195], 0
    v_mfma_f32_16x16x32_bf16 v[248:251], a[224:227], v[196:199], 0
    v_mfma_f32_16x16x32_bf16 v[252:255], a[228:231], v[196:199], 0
    v_pk_fma_f32 v[216:217], v[112:113], v[128:129], v[216:217] op_sel_hi:[1,0,1]
    v_pk_fma_f32 v[218:219], v[114:115], v[128:129], v[218:219] op_sel_hi:[1,0,1]
    v_pk_fma_f32 v[220:221], v[116:117], v[128:129], v[220:221] op_sel_hi:[1,0,1] neg_lo:[1,0,0] neg_hi:[1,0,0]
    v_pk_fma_f32 v[222:223], v[118:119], v[128:129], v[222:223] op_sel_hi:[1,0,1] neg_lo:[1,0,0] neg_hi:[1,0,0]
    v_pk_fma_f32 v[224:225], v[120:121], v[128:129], v[224:225] op_sel_hi:[1,0,1]
    v_pk_fma_f32 v[226:227], v[122:123], v[128:129], v[226:227] op_sel_hi:[1,0,1]
    v_pk_fma_f32 v[228:229], v[124:125], v[128:129], v[228:229] op_sel_hi:[1,0,1] neg_lo:[1,0,0] neg_hi:[1,0,0]
    v_pk_fma_f32 v[230:231], v[126:127], v[128:129], v[230:231] op_sel_hi:[1,0,1] neg_lo:[1,0,0] neg_hi:[1,0,0]
    v_pk_fma_f32 v[232:233], v[144:145], v[128:129], v[232:233] op_sel:[0,1,0]
    v_pk_fma_f32 v[234:235], v[146:147], v[128:129], v[234:235] op_sel:[0,1,0]
    v_pk_fma_f32 v[236:237], v[148:149], v[128:129], v[236:237] op_sel:[0,1,0] neg_lo:[1,0,0] neg_hi:[1,0,0]
    v_pk_fma_f32 v[238:239], v[150:151], v[128:129], v[238:239] op_sel:[0,1,0] neg_lo:[1,0,0] neg_hi:[1,0,0]
    v_pk_fma_f32 v[240:241], v[248:249], v[128:129], v[240:241] op_sel:[0,1,0]
    v_pk_fma_f32 v[242:243], v[250:251], v[128:129], v[242:243] op_sel:[0,1,0]
    v_pk_fma_f32 v[244:245], v[252:253], v[128:129], v[244:245] op_sel:[0,1,0] neg_lo:[1,0,0] neg_hi:[1,0,0]
    v_pk_fma_f32 v[246:247], v[254:255], v[128:129], v[246:247] op_sel:[0,1,0] neg_lo:[1,0,0] neg_hi:[1,0,0]
    v_mfma_f32_16x16x32_bf16 v[32:35], a[192:195], v[152:155], v[32:35]
    ds_read_b128 v[168:171], v21 offset:49152
    s_lshl_b32 s70, s32, 10
    v_cvt_pk_bf16_f32 v184, v216, v220
    v_mfma_f32_16x16x32_bf16 v[48:51], a[208:211], v[152:155], v[48:51]
    ds_read_b128 v[172:175], v21 offset:51200
    v_cvt_pk_bf16_f32 v185, v224, v228
    v_mfma_f32_16x16x32_bf16 v[36:39], a[192:195], v[156:159], v[36:39]
    ds_read_b128 v[176:179], v21 offset:53248
    v_cvt_pk_bf16_f32 v186, v232, v236
    v_mfma_f32_16x16x32_bf16 v[52:55], a[208:211], v[156:159], v[52:55]
    ds_read_b128 v[180:183], v21 offset:55296
    v_cvt_pk_bf16_f32 v187, v240, v244
    v_mfma_f32_16x16x32_bf16 v[40:43], a[192:195], v[160:163], v[40:43]
    s_add_u32 s70, s70, 22413312
    v_cvt_pk_bf16_f32 v188, v217, v221
    v_mfma_f32_16x16x32_bf16 v[56:59], a[208:211], v[160:163], v[56:59]
    v_cvt_pk_bf16_f32 v189, v225, v229
    v_mfma_f32_16x16x32_bf16 v[44:47], a[192:195], v[164:167], v[44:47]
    v_cvt_pk_bf16_f32 v190, v233, v237
    v_xor_b32 v21, 0x10000, v21
    v_mfma_f32_16x16x32_bf16 v[60:63], a[208:211], v[164:167], v[60:63]
    v_cvt_pk_bf16_f32 v191, v241, v245
    s_waitcnt lgkmcnt(0)
    v_mfma_f32_16x16x32_bf16 v[32:35], a[196:199], v[168:171], v[32:35]
    ds_read_b128 v[152:155], v22 offset:49152
    buffer_store_dwordx4 v[184:187], v29, s[24:27], s75 offen sc1
    v_cvt_pk_bf16_f32 v192, v218, v222
    v_mfma_f32_16x16x32_bf16 v[48:51], a[212:215], v[168:171], v[48:51]
    ds_read_b128 v[156:159], v22 offset:51200
    v_cvt_pk_bf16_f32 v193, v226, v230
    v_mfma_f32_16x16x32_bf16 v[36:39], a[196:199], v[172:175], v[36:39]
    ds_read_b128 v[160:163], v22 offset:53248
    v_cvt_pk_bf16_f32 v194, v234, v238
    v_mfma_f32_16x16x32_bf16 v[52:55], a[212:215], v[172:175], v[52:55]
    ds_read_b128 v[164:167], v22 offset:55296
    v_cvt_pk_bf16_f32 v195, v242, v246
    v_mfma_f32_16x16x32_bf16 v[40:43], a[196:199], v[176:179], v[40:43]
    s_add_u32 s75, s75, 16384
    v_cvt_pk_bf16_f32 v196, v219, v223
    v_mfma_f32_16x16x32_bf16 v[56:59], a[212:215], v[176:179], v[56:59]
    v_cvt_pk_bf16_f32 v197, v227, v231
    v_mfma_f32_16x16x32_bf16 v[44:47], a[196:199], v[180:183], v[44:47]
    v_cvt_pk_bf16_f32 v198, v235, v239
    v_xor_b32 v22, 0x10000, v22
    v_mfma_f32_16x16x32_bf16 v[60:63], a[212:215], v[180:183], v[60:63]
    v_cvt_pk_bf16_f32 v199, v243, v247
    s_waitcnt lgkmcnt(0) vmcnt(19)
    v_mfma_f32_16x16x32_bf16 v[32:35], a[200:203], v[152:155], v[32:35]
    ds_read_b128 v[168:171], v23 offset:49152
    buffer_store_dwordx4 v[188:191], v29, s[24:27], s75 offen sc1
    v_mfma_f32_16x16x32_bf16 v[48:51], a[216:219], v[152:155], v[48:51]
    ds_read_b128 v[172:175], v23 offset:51200
    v_mfma_f32_16x16x32_bf16 v[36:39], a[200:203], v[156:159], v[36:39]
    ds_read_b128 v[176:179], v23 offset:53248
    v_mfma_f32_16x16x32_bf16 v[52:55], a[216:219], v[156:159], v[52:55]
    ds_read_b128 v[180:183], v23 offset:55296
    v_mfma_f32_16x16x32_bf16 v[40:43], a[200:203], v[160:163], v[40:43]
    s_add_u32 s75, s75, 16384
    v_mfma_f32_16x16x32_bf16 v[56:59], a[216:219], v[160:163], v[56:59]
    v_mfma_f32_16x16x32_bf16 v[44:47], a[200:203], v[164:167], v[44:47]
    v_xor_b32 v23, 0x10000, v23
    v_mfma_f32_16x16x32_bf16 v[60:63], a[216:219], v[164:167], v[60:63]
    s_waitcnt lgkmcnt(0) vmcnt(14)
    s_barrier
    v_mfma_f32_16x16x32_bf16 v[32:35], a[204:207], v[168:171], v[32:35]
    ds_read_b128 v[152:155], v20 offset:0
    buffer_store_dwordx4 v[192:195], v29, s[24:27], s75 offen sc1
    v_mfma_f32_16x16x32_bf16 v[48:51], a[220:223], v[168:171], v[48:51]
    ds_read_b128 v[156:159], v20 offset:2048
    v_mfma_f32_16x16x32_bf16 v[36:39], a[204:207], v[172:175], v[36:39]
    ds_read_b128 v[160:163], v20 offset:4096
    v_mfma_f32_16x16x32_bf16 v[52:55], a[220:223], v[172:175], v[52:55]
    ds_read_b128 v[164:167], v20 offset:6144
    v_mfma_f32_16x16x32_bf16 v[40:43], a[204:207], v[176:179], v[40:43]
    s_add_u32 s75, s75, 16384
    v_mfma_f32_16x16x32_bf16 v[56:59], a[220:223], v[176:179], v[56:59]
    v_mfma_f32_16x16x32_bf16 v[44:47], a[204:207], v[180:183], v[44:47]
    v_mfma_f32_16x16x32_bf16 v[60:63], a[220:223], v[180:183], v[60:63]
    s_waitcnt lgkmcnt(0)
    v_mfma_f32_16x16x32_bf16 v[216:219], v[64:67], v[152:155], 0
    ds_read_b128 v[168:171], v21 offset:0
    buffer_store_dwordx4 v[196:199], v29, s[24:27], s75 offen sc1
    v_mfma_f32_16x16x32_bf16 v[232:235], v[80:83], v[152:155], 0
    ds_read_b128 v[172:175], v21 offset:2048
    v_mfma_f32_16x16x32_bf16 v[220:223], v[64:67], v[156:159], 0
    ds_read_b128 v[176:179], v21 offset:4096
    v_cvt_pk_bf16_f32 v200, v32, v36
    v_cvt_pk_bf16_f32 v201, v40, v44
    v_mfma_f32_16x16x32_bf16 v[236:239], v[80:83], v[156:159], 0
    ds_read_b128 v[180:183], v21 offset:6144
    v_cvt_pk_bf16_f32 v202, v48, v52
    v_mfma_f32_16x16x32_bf16 v[224:227], v[64:67], v[160:163], 0
    v_cvt_pk_bf16_f32 v203, v56, v60
    v_mfma_f32_16x16x32_bf16 v[240:243], v[80:83], v[160:163], 0
    v_cvt_pk_bf16_f32 v204, v33, v37
    v_cvt_pk_bf16_f32 v205, v41, v45
    v_mfma_f32_16x16x32_bf16 v[228:231], v[64:67], v[164:167], 0
    v_cvt_pk_bf16_f32 v206, v49, v53
    v_mfma_f32_16x16x32_bf16 v[244:247], v[80:83], v[164:167], 0
    v_cvt_pk_bf16_f32 v207, v57, v61
    s_waitcnt lgkmcnt(0)
    v_mfma_f32_16x16x32_bf16 v[216:219], v[68:71], v[168:171], v[216:219]
    ds_read_b128 v[152:155], v22 offset:0
    buffer_store_dwordx4 v[200:203], v3, s[24:27], s52 offen offset:0 sc1
    v_cvt_pk_bf16_f32 v208, v34, v38
    v_mfma_f32_16x16x32_bf16 v[232:235], v[84:87], v[168:171], v[232:235]
    ds_read_b128 v[156:159], v22 offset:2048
    v_cvt_pk_bf16_f32 v209, v42, v46
    v_mfma_f32_16x16x32_bf16 v[220:223], v[68:71], v[172:175], v[220:223]
    ds_read_b128 v[160:163], v22 offset:4096
    v_cvt_pk_bf16_f32 v210, v50, v54
    v_mfma_f32_16x16x32_bf16 v[236:239], v[84:87], v[172:175], v[236:239]
    ds_read_b128 v[164:167], v22 offset:6144
    v_cvt_pk_bf16_f32 v211, v58, v62
    v_mfma_f32_16x16x32_bf16 v[224:227], v[68:71], v[176:179], v[224:227]
    buffer_store_dwordx4 v[204:207], v3, s[24:27], s52 offen offset:1024 sc1
    v_cvt_pk_bf16_f32 v212, v35, v39
    v_mfma_f32_16x16x32_bf16 v[240:243], v[84:87], v[176:179], v[240:243]
    v_cvt_pk_bf16_f32 v213, v43, v47
    v_mfma_f32_16x16x32_bf16 v[228:231], v[68:71], v[180:183], v[228:231]
    v_cvt_pk_bf16_f32 v214, v51, v55
    v_mfma_f32_16x16x32_bf16 v[244:247], v[84:87], v[180:183], v[244:247]
    v_cvt_pk_bf16_f32 v215, v59, v63
    s_waitcnt lgkmcnt(0)
    v_mfma_f32_16x16x32_bf16 v[216:219], v[72:75], v[152:155], v[216:219]
    ds_read_b128 v[168:171], v23 offset:0
    buffer_store_dwordx4 v[208:211], v3, s[24:27], s52 offen offset:2048 sc1
    v_mfma_f32_16x16x32_bf16 v[232:235], v[88:91], v[152:155], v[232:235]
    ds_read_b128 v[172:175], v23 offset:2048
    v_mfma_f32_16x16x32_bf16 v[220:223], v[72:75], v[156:159], v[220:223]
    ds_read_b128 v[176:179], v23 offset:4096
    v_mfma_f32_16x16x32_bf16 v[236:239], v[88:91], v[156:159], v[236:239]
    ds_read_b128 v[180:183], v23 offset:6144
    v_mfma_f32_16x16x32_bf16 v[224:227], v[72:75], v[160:163], v[224:227]
    buffer_store_dwordx4 v[212:215], v3, s[24:27], s52 offen offset:3072 sc1
    v_mfma_f32_16x16x32_bf16 v[240:243], v[88:91], v[160:163], v[240:243]
    v_mfma_f32_16x16x32_bf16 v[228:231], v[72:75], v[164:167], v[228:231]
    v_mfma_f32_16x16x32_bf16 v[244:247], v[88:91], v[164:167], v[244:247]
    s_waitcnt lgkmcnt(0) vmcnt(8)
    s_barrier
    v_mfma_f32_16x16x32_bf16 v[216:219], v[76:79], v[168:171], v[216:219]
    ds_read_b128 v[152:155], v20 offset:16384
    v_mfma_f32_16x16x32_bf16 v[232:235], v[92:95], v[168:171], v[232:235]
    ds_read_b128 v[156:159], v20 offset:18432
    v_mfma_f32_16x16x32_bf16 v[220:223], v[76:79], v[172:175], v[220:223]
    ds_read_b128 v[160:163], v20 offset:20480
    v_mfma_f32_16x16x32_bf16 v[236:239], v[92:95], v[172:175], v[236:239]
    ds_read_b128 v[164:167], v20 offset:22528
    v_mfma_f32_16x16x32_bf16 v[224:227], v[76:79], v[176:179], v[224:227]
    v_mfma_f32_16x16x32_bf16 v[240:243], v[92:95], v[176:179], v[240:243]
    v_mfma_f32_16x16x32_bf16 v[228:231], v[76:79], v[180:183], v[228:231]
    v_mfma_f32_16x16x32_bf16 v[244:247], v[92:95], v[180:183], v[244:247]
    s_waitcnt lgkmcnt(0)
    v_mfma_f32_16x16x32_bf16 v[216:219], a[0:3], v[152:155], v[216:219]
    ds_read_b128 v[168:171], v21 offset:16384
    v_mfma_f32_16x16x32_bf16 v[232:235], a[16:19], v[152:155], v[232:235]
    ds_read_b128 v[172:175], v21 offset:18432
    v_mfma_f32_16x16x32_bf16 v[220:223], a[0:3], v[156:159], v[220:223]
    ds_read_b128 v[176:179], v21 offset:20480
    v_mfma_f32_16x16x32_bf16 v[236:239], a[16:19], v[156:159], v[236:239]
    ds_read_b128 v[180:183], v21 offset:22528
    v_mfma_f32_16x16x32_bf16 v[224:227], a[0:3], v[160:163], v[224:227]
    v_mfma_f32_16x16x32_bf16 v[240:243], a[16:19], v[160:163], v[240:243]
    v_mfma_f32_16x16x32_bf16 v[228:231], a[0:3], v[164:167], v[228:231]
    v_mfma_f32_16x16x32_bf16 v[244:247], a[16:19], v[164:167], v[244:247]
    s_waitcnt lgkmcnt(0)
    v_mfma_f32_16x16x32_bf16 v[216:219], a[4:7], v[168:171], v[216:219]
    ds_read_b128 v[152:155], v22 offset:16384
    v_mfma_f32_16x16x32_bf16 v[232:235], a[20:23], v[168:171], v[232:235]
    ds_read_b128 v[156:159], v22 offset:18432
    v_mfma_f32_16x16x32_bf16 v[220:223], a[4:7], v[172:175], v[220:223]
    ds_read_b128 v[160:163], v22 offset:20480
    v_mfma_f32_16x16x32_bf16 v[236:239], a[20:23], v[172:175], v[236:239]
    ds_read_b128 v[164:167], v22 offset:22528
    v_mfma_f32_16x16x32_bf16 v[224:227], a[4:7], v[176:179], v[224:227]
    v_mfma_f32_16x16x32_bf16 v[240:243], a[20:23], v[176:179], v[240:243]
    v_mfma_f32_16x16x32_bf16 v[228:231], a[4:7], v[180:183], v[228:231]
    v_mfma_f32_16x16x32_bf16 v[244:247], a[20:23], v[180:183], v[244:247]
    s_waitcnt lgkmcnt(0)
    v_mfma_f32_16x16x32_bf16 v[216:219], a[8:11], v[152:155], v[216:219]
    ds_read_b128 v[168:171], v23 offset:16384
    v_mfma_f32_16x16x32_bf16 v[232:235], a[24:27], v[152:155], v[232:235]
    ds_read_b128 v[172:175], v23 offset:18432
    v_mfma_f32_16x16x32_bf16 v[220:223], a[8:11], v[156:159], v[220:223]
    ds_read_b128 v[176:179], v23 offset:20480
    v_mfma_f32_16x16x32_bf16 v[236:239], a[24:27], v[156:159], v[236:239]
    ds_read_b128 v[180:183], v23 offset:22528
    v_mfma_f32_16x16x32_bf16 v[224:227], a[8:11], v[160:163], v[224:227]
    v_mfma_f32_16x16x32_bf16 v[240:243], a[24:27], v[160:163], v[240:243]
    v_mfma_f32_16x16x32_bf16 v[228:231], a[8:11], v[164:167], v[228:231]
    v_mfma_f32_16x16x32_bf16 v[244:247], a[24:27], v[164:167], v[244:247]
    s_waitcnt lgkmcnt(0) vmcnt(4)
    s_barrier
    v_mfma_f32_16x16x32_bf16 v[216:219], a[12:15], v[168:171], v[216:219]
    ds_read_b128 v[152:155], v20 offset:32768
    v_mov_b32 v28, s35
    v_mfma_f32_16x16x32_bf16 v[232:235], a[28:31], v[168:171], v[232:235]
    ds_read_b128 v[156:159], v20 offset:34816
    v_mfma_f32_16x16x32_bf16 v[220:223], a[12:15], v[172:175], v[220:223]
    ds_read_b128 v[160:163], v20 offset:36864
    buffer_store_dword v28, v30, s[24:27], s57 offen sc1
    v_mfma_f32_16x16x32_bf16 v[236:239], a[28:31], v[172:175], v[236:239]
    ds_read_b128 v[164:167], v20 offset:38912
    v_mfma_f32_16x16x32_bf16 v[224:227], a[12:15], v[176:179], v[224:227]
    v_mfma_f32_16x16x32_bf16 v[240:243], a[28:31], v[176:179], v[240:243]
    s_mov_b64 s[28:29], s[90:91]
    v_mfma_f32_16x16x32_bf16 v[228:231], a[12:15], v[180:183], v[228:231]
    v_mfma_f32_16x16x32_bf16 v[244:247], a[28:31], v[180:183], v[244:247]
    s_waitcnt lgkmcnt(0)
    v_mfma_f32_16x16x32_bf16 v[216:219], a[32:35], v[152:155], v[216:219]
    ds_read_b128 v[168:171], v21 offset:32768
    v_mfma_f32_16x16x32_bf16 v[232:235], a[48:51], v[152:155], v[232:235]
    ds_read_b128 v[172:175], v21 offset:34816
    v_mfma_f32_16x16x32_bf16 v[220:223], a[32:35], v[156:159], v[220:223]
    ds_read_b128 v[176:179], v21 offset:36864
    v_mfma_f32_16x16x32_bf16 v[236:239], a[48:51], v[156:159], v[236:239]
    ds_read_b128 v[180:183], v21 offset:38912
    v_mfma_f32_16x16x32_bf16 v[224:227], a[32:35], v[160:163], v[224:227]
    v_mfma_f32_16x16x32_bf16 v[240:243], a[48:51], v[160:163], v[240:243]
    v_mfma_f32_16x16x32_bf16 v[228:231], a[32:35], v[164:167], v[228:231]
    v_mfma_f32_16x16x32_bf16 v[244:247], a[48:51], v[164:167], v[244:247]
    s_waitcnt lgkmcnt(0) vmcnt(1)
    s_barrier
    v_mfma_f32_16x16x32_bf16 v[216:219], a[36:39], v[168:171], v[216:219]
    ds_read_b128 v[152:155], v22 offset:32768
    v_mov_b32_e64 v28, s35
    v_mfma_f32_16x16x32_bf16 v[232:235], a[52:55], v[168:171], v[232:235]
    ds_read_b128 v[156:159], v22 offset:34816
    v_mfma_f32_16x16x32_bf16 v[220:223], a[36:39], v[172:175], v[220:223]
    ds_read_b128 v[160:163], v22 offset:36864
    v_mfma_f32_16x16x32_bf16 v[236:239], a[52:55], v[172:175], v[236:239]
    ds_read_b128 v[164:167], v22 offset:38912
    v_mfma_f32_16x16x32_bf16 v[224:227], a[36:39], v[176:179], v[224:227]
    buffer_store_dword v28, v30, s[24:27], s58 offen sc1
    v_mfma_f32_16x16x32_bf16 v[240:243], a[52:55], v[176:179], v[240:243]
    v_mfma_f32_16x16x32_bf16 v[228:231], a[36:39], v[180:183], v[228:231]
    v_mfma_f32_16x16x32_bf16 v[244:247], a[52:55], v[180:183], v[244:247]
    s_waitcnt lgkmcnt(0)
    v_mfma_f32_16x16x32_bf16 v[216:219], a[40:43], v[152:155], v[216:219]
    ds_read_b128 v[168:171], v23 offset:32768
    s_bfe_u32 s72, s97, 262160
    v_mfma_f32_16x16x32_bf16 v[232:235], a[56:59], v[152:155], v[232:235]
    ds_read_b128 v[172:175], v23 offset:34816
    s_add_u32 m0, s37, 65536
    v_mfma_f32_16x16x32_bf16 v[220:223], a[40:43], v[156:159], v[220:223]
    ds_read_b128 v[176:179], v23 offset:36864
    v_mfma_f32_16x16x32_bf16 v[236:239], a[56:59], v[156:159], v[236:239]
    ds_read_b128 v[180:183], v23 offset:38912
    s_lshl_b32 s72, s72, 7
    v_mfma_f32_16x16x32_bf16 v[224:227], a[40:43], v[160:163], v[224:227]
    buffer_load_dwordx4 v16, s[16:19], s72 offen offset:0  lds
    v_mfma_f32_16x16x32_bf16 v[240:243], a[56:59], v[160:163], v[240:243]
    v_mfma_f32_16x16x32_bf16 v[228:231], a[40:43], v[164:167], v[228:231]
    buffer_load_dwordx4 v17, s[16:19], s72 offen offset:1024  lds
    v_mfma_f32_16x16x32_bf16 v[244:247], a[56:59], v[164:167], v[244:247]
    s_waitcnt lgkmcnt(0)
    v_mfma_f32_16x16x32_bf16 v[216:219], a[44:47], v[168:171], v[216:219]
    ds_read_b128 v[152:155], v20 offset:49152
    buffer_load_dwordx4 v18, s[16:19], s72 offen offset:2048  lds
    v_mfma_f32_16x16x32_bf16 v[232:235], a[60:63], v[168:171], v[232:235]
    ds_read_b128 v[156:159], v20 offset:51200
    v_mfma_f32_16x16x32_bf16 v[220:223], a[44:47], v[172:175], v[220:223]
    ds_read_b128 v[160:163], v20 offset:53248
    v_mfma_f32_16x16x32_bf16 v[236:239], a[60:63], v[172:175], v[236:239]
    ds_read_b128 v[164:167], v20 offset:55296
    v_mfma_f32_16x16x32_bf16 v[224:227], a[44:47], v[176:179], v[224:227]
    buffer_load_dwordx4 v19, s[16:19], s72 offen offset:3072  lds
    v_mfma_f32_16x16x32_bf16 v[240:243], a[60:63], v[176:179], v[240:243]
    v_mfma_f32_16x16x32_bf16 v[228:231], a[44:47], v[180:183], v[228:231]
    v_xor_b32 v20, 0x10000, v20
    v_mfma_f32_16x16x32_bf16 v[244:247], a[60:63], v[180:183], v[244:247]
    s_waitcnt lgkmcnt(0)
    v_mfma_f32_16x16x32_bf16 v[216:219], a[64:67], v[152:155], v[216:219]
    ds_read_b128 v[168:171], v21 offset:49152
    s_bfe_u32 s72, s97, 262164
    v_mfma_f32_16x16x32_bf16 v[232:235], a[80:83], v[152:155], v[232:235]
    ds_read_b128 v[172:175], v21 offset:51200
    s_add_u32 m0, s37, 81920
    v_mfma_f32_16x16x32_bf16 v[220:223], a[64:67], v[156:159], v[220:223]
    ds_read_b128 v[176:179], v21 offset:53248
    s_lshl_b32 s72, s72, 7
    v_mfma_f32_16x16x32_bf16 v[236:239], a[80:83], v[156:159], v[236:239]
    ds_read_b128 v[180:183], v21 offset:55296
    buffer_load_dwordx4 v16, s[16:19], s72 offen offset:0  lds
    v_mfma_f32_16x16x32_bf16 v[224:227], a[64:67], v[160:163], v[224:227]
    buffer_load_dwordx4 v17, s[16:19], s72 offen offset:1024  lds
    v_mfma_f32_16x16x32_bf16 v[240:243], a[80:83], v[160:163], v[240:243]
    buffer_load_dwordx2 v[128:129], v7, s[24:27], s55 offen offset:0 sc1
    v_mfma_f32_16x16x32_bf16 v[228:231], a[64:67], v[164:167], v[228:231]
    buffer_load_dwordx2 v[130:131], v7, s[24:27], s55 offen offset:64 sc1
    v_xor_b32 v21, 0x10000, v21
    v_mfma_f32_16x16x32_bf16 v[244:247], a[80:83], v[164:167], v[244:247]
    s_waitcnt lgkmcnt(0)
    v_mfma_f32_16x16x32_bf16 v[216:219], a[68:71], v[168:171], v[216:219]
    ds_read_b128 v[152:155], v22 offset:49152
    buffer_load_dwordx4 v18, s[16:19], s72 offen offset:2048  lds
    v_mfma_f32_16x16x32_bf16 v[232:235], a[84:87], v[168:171], v[232:235]
    ds_read_b128 v[156:159], v22 offset:51200
    v_mfma_f32_16x16x32_bf16 v[220:223], a[68:71], v[172:175], v[220:223]
    ds_read_b128 v[160:163], v22 offset:53248
    buffer_load_dwordx4 v19, s[16:19], s72 offen offset:3072  lds
    v_mfma_f32_16x16x32_bf16 v[236:239], a[84:87], v[172:175], v[236:239]
    ds_read_b128 v[164:167], v22 offset:55296
    v_mfma_f32_16x16x32_bf16 v[224:227], a[68:71], v[176:179], v[224:227]
    buffer_load_dwordx2 v[132:133], v7, s[24:27], s55 offen offset:128 sc1
    v_mfma_f32_16x16x32_bf16 v[240:243], a[84:87], v[176:179], v[240:243]
    v_mfma_f32_16x16x32_bf16 v[228:231], a[68:71], v[180:183], v[228:231]
    buffer_load_dwordx2 v[134:135], v7, s[24:27], s55 offen offset:192 sc1
    v_xor_b32 v22, 0x10000, v22
    v_mfma_f32_16x16x32_bf16 v[244:247], a[84:87], v[180:183], v[244:247]
    s_waitcnt lgkmcnt(0)
    v_mfma_f32_16x16x32_bf16 v[216:219], a[72:75], v[152:155], v[216:219]
    ds_read_b128 v[168:171], v23 offset:49152
    s_bfe_u32 s72, s97, 262168
    v_mfma_f32_16x16x32_bf16 v[232:235], a[88:91], v[152:155], v[232:235]
    ds_read_b128 v[172:175], v23 offset:51200
    s_add_u32 m0, s37, 98304
    v_mfma_f32_16x16x32_bf16 v[220:223], a[72:75], v[156:159], v[220:223]
    ds_read_b128 v[176:179], v23 offset:53248
    s_lshl_b32 s72, s72, 7
    v_mfma_f32_16x16x32_bf16 v[236:239], a[88:91], v[156:159], v[236:239]
    ds_read_b128 v[180:183], v23 offset:55296
    v_mfma_f32_16x16x32_bf16 v[224:227], a[72:75], v[160:163], v[224:227]
    buffer_load_dwordx4 v16, s[16:19], s72 offen offset:0  lds
    v_mfma_f32_16x16x32_bf16 v[240:243], a[88:91], v[160:163], v[240:243]
    buffer_load_dwordx4 v17, s[16:19], s72 offen offset:1024  lds
    v_mfma_f32_16x16x32_bf16 v[228:231], a[72:75], v[164:167], v[228:231]
    buffer_load_dword v10, v5, s[24:27], s70 offen sc1
    v_xor_b32 v23, 0x10000, v23
    v_mfma_f32_16x16x32_bf16 v[244:247], a[88:91], v[164:167], v[244:247]
    s_waitcnt lgkmcnt(0) vmcnt(11)
    s_barrier
    v_mfma_f32_16x16x32_bf16 v[216:219], a[76:79], v[168:171], v[216:219]
    ds_read_b128 v[152:155], v20 offset:0
    buffer_load_dwordx4 v18, s[16:19], s72 offen offset:2048  lds
    v_mfma_f32_16x16x32_bf16 v[232:235], a[92:95], v[168:171], v[232:235]
    ds_read_b128 v[156:159], v20 offset:2048
    v_mfma_f32_16x16x32_bf16 v[220:223], a[76:79], v[172:175], v[220:223]
    ds_read_b128 v[160:163], v20 offset:4096
    v_mfma_f32_16x16x32_bf16 v[236:239], a[92:95], v[172:175], v[236:239]
    ds_read_b128 v[164:167], v20 offset:6144
    v_mfma_f32_16x16x32_bf16 v[224:227], a[76:79], v[176:179], v[224:227]
    buffer_load_dwordx4 v19, s[16:19], s72 offen offset:3072  lds
    v_mfma_f32_16x16x32_bf16 v[240:243], a[92:95], v[176:179], v[240:243]
    v_mfma_f32_16x16x32_bf16 v[228:231], a[76:79], v[180:183], v[228:231]
    v_mfma_f32_16x16x32_bf16 v[244:247], a[92:95], v[180:183], v[244:247]
    s_waitcnt lgkmcnt(0)
    v_mfma_f32_16x16x32_bf16 v[216:219], a[96:99], v[152:155], v[216:219]
    ds_read_b128 v[168:171], v21 offset:0
    s_bfe_u32 s72, s97, 262172
    v_mfma_f32_16x16x32_bf16 v[232:235], a[112:115], v[152:155], v[232:235]
    ds_read_b128 v[172:175], v21 offset:2048
    s_add_u32 m0, s37, 114688
    v_mfma_f32_16x16x32_bf16 v[220:223], a[96:99], v[156:159], v[220:223]
    ds_read_b128 v[176:179], v21 offset:4096
    v_mfma_f32_16x16x32_bf16 v[236:239], a[112:115], v[156:159], v[236:239]
    ds_read_b128 v[180:183], v21 offset:6144
    s_lshl_b32 s72, s72, 7
    v_mfma_f32_16x16x32_bf16 v[224:227], a[96:99], v[160:163], v[224:227]
    buffer_load_dwordx4 v16, s[16:19], s72 offen offset:0  lds
    v_mfma_f32_16x16x32_bf16 v[240:243], a[112:115], v[160:163], v[240:243]
    v_mfma_f32_16x16x32_bf16 v[228:231], a[96:99], v[164:167], v[228:231]
    buffer_load_dwordx4 v17, s[16:19], s72 offen offset:1024  lds
    v_mfma_f32_16x16x32_bf16 v[244:247], a[112:115], v[164:167], v[244:247]
    s_waitcnt lgkmcnt(0)
    v_mfma_f32_16x16x32_bf16 v[216:219], a[100:103], v[168:171], v[216:219]
    ds_read_b128 v[152:155], v22 offset:0
    buffer_load_dwordx4 v18, s[16:19], s72 offen offset:2048  lds
    v_mfma_f32_16x16x32_bf16 v[232:235], a[116:119], v[168:171], v[232:235]
    ds_read_b128 v[156:159], v22 offset:2048
    v_mfma_f32_16x16x32_bf16 v[220:223], a[100:103], v[172:175], v[220:223]
    ds_read_b128 v[160:163], v22 offset:4096
    v_mfma_f32_16x16x32_bf16 v[236:239], a[116:119], v[172:175], v[236:239]
    ds_read_b128 v[164:167], v22 offset:6144
    v_mfma_f32_16x16x32_bf16 v[224:227], a[100:103], v[176:179], v[224:227]
    buffer_load_dwordx4 v19, s[16:19], s72 offen offset:3072  lds
    v_mfma_f32_16x16x32_bf16 v[240:243], a[116:119], v[176:179], v[240:243]
    v_mfma_f32_16x16x32_bf16 v[228:231], a[100:103], v[180:183], v[228:231]
    v_mfma_f32_16x16x32_bf16 v[244:247], a[116:119], v[180:183], v[244:247]
    s_waitcnt lgkmcnt(0)
    v_mfma_f32_16x16x32_bf16 v[216:219], a[104:107], v[152:155], v[216:219]
    ds_read_b128 v[168:171], v23 offset:0
    v_mfma_f32_16x16x32_bf16 v[232:235], a[120:123], v[152:155], v[232:235]
    ds_read_b128 v[172:175], v23 offset:2048
    v_mfma_f32_16x16x32_bf16 v[220:223], a[104:107], v[156:159], v[220:223]
    ds_read_b128 v[176:179], v23 offset:4096
    v_mfma_f32_16x16x32_bf16 v[236:239], a[120:123], v[156:159], v[236:239]
    ds_read_b128 v[180:183], v23 offset:6144
    v_mfma_f32_16x16x32_bf16 v[224:227], a[104:107], v[160:163], v[224:227]
    v_mfma_f32_16x16x32_bf16 v[240:243], a[120:123], v[160:163], v[240:243]
    v_mfma_f32_16x16x32_bf16 v[228:231], a[104:107], v[164:167], v[228:231]
    v_mfma_f32_16x16x32_bf16 v[244:247], a[120:123], v[164:167], v[244:247]
    s_waitcnt lgkmcnt(0) vmcnt(6)
    v_cmp_ne_u32 vcc, s98, v10
    s_nop 0
    s_cbranch_vccnz K_POLL5
K_POLL5_OK:
    s_barrier
    v_mfma_f32_16x16x32_bf16 v[216:219], a[108:111], v[168:171], v[216:219]
    ds_read_b128 v[152:155], v20 offset:16384
    buffer_load_dword v6, v9, s[24:27], s70 offen sc1
    v_mfma_f32_16x16x32_bf16 v[232:235], a[124:127], v[168:171], v[232:235]
    ds_read_b128 v[156:159], v20 offset:18432
    v_mfma_f32_16x16x32_bf16 v[220:223], a[108:111], v[172:175], v[220:223]
    ds_read_b128 v[160:163], v20 offset:20480
    buffer_load_dwordx4 v[96:99], v3, s[24:27], s53 offen offset:0 sc1
    v_mfma_f32_16x16x32_bf16 v[236:239], a[124:127], v[172:175], v[236:239]
    ds_read_b128 v[164:167], v20 offset:22528
    v_mfma_f32_16x16x32_bf16 v[224:227], a[108:111], v[176:179], v[224:227]
    v_mfma_f32_16x16x32_bf16 v[240:243], a[124:127], v[176:179], v[240:243]
    buffer_load_dwordx4 v[100:103], v3, s[24:27], s53 offen offset:1024 sc1
    v_mfma_f32_16x16x32_bf16 v[228:231], a[108:111], v[180:183], v[228:231]
    v_mfma_f32_16x16x32_bf16 v[244:247], a[124:127], v[180:183], v[244:247]
    s_waitcnt lgkmcnt(0)
    v_mfma_f32_16x16x32_bf16 v[216:219], a[128:131], v[152:155], v[216:219]
    ds_read_b128 v[168:171], v21 offset:16384
    buffer_load_dwordx4 v[104:107], v3, s[24:27], s53 offen offset:2048 sc1
    v_mfma_f32_16x16x32_bf16 v[232:235], a[144:147], v[152:155], v[232:235]
    ds_read_b128 v[172:175], v21 offset:18432
    v_mfma_f32_16x16x32_bf16 v[220:223], a[128:131], v[156:159], v[220:223]
    ds_read_b128 v[176:179], v21 offset:20480
    v_mfma_f32_16x16x32_bf16 v[236:239], a[144:147], v[156:159], v[236:239]
    ds_read_b128 v[180:183], v21 offset:22528
    v_mfma_f32_16x16x32_bf16 v[224:227], a[128:131], v[160:163], v[224:227]
    buffer_load_dwordx4 v[108:111], v3, s[24:27], s53 offen offset:3072 sc1
    v_mfma_f32_16x16x32_bf16 v[240:243], a[144:147], v[160:163], v[240:243]
    v_mfma_f32_16x16x32_bf16 v[228:231], a[128:131], v[164:167], v[228:231]
    v_mfma_f32_16x16x32_bf16 v[244:247], a[144:147], v[164:167], v[244:247]
    s_waitcnt lgkmcnt(0)
    v_mfma_f32_16x16x32_bf16 v[216:219], a[132:135], v[168:171], v[216:219]
    ds_read_b128 v[152:155], v22 offset:16384
    v_mfma_f32_16x16x32_bf16 v[232:235], a[148:151], v[168:171], v[232:235]
    ds_read_b128 v[156:159], v22 offset:18432
    v_mfma_f32_16x16x32_bf16 v[220:223], a[132:135], v[172:175], v[220:223]
    ds_read_b128 v[160:163], v22 offset:20480
    v_mfma_f32_16x16x32_bf16 v[236:239], a[148:151], v[172:175], v[236:239]
    ds_read_b128 v[164:167], v22 offset:22528
    v_mfma_f32_16x16x32_bf16 v[224:227], a[132:135], v[176:179], v[224:227]
    v_mfma_f32_16x16x32_bf16 v[240:243], a[148:151], v[176:179], v[240:243]
    v_mfma_f32_16x16x32_bf16 v[228:231], a[132:135], v[180:183], v[228:231]
    v_mfma_f32_16x16x32_bf16 v[244:247], a[148:151], v[180:183], v[244:247]
    s_waitcnt lgkmcnt(0) vmcnt(4)
    v_cmp_ne_u32 vcc, s98, v6
    s_nop 0
    s_cbranch_vccnz K_POLL6
K_POLL6_OK:
    s_barrier
    v_mfma_f32_16x16x32_bf16 v[216:219], a[136:139], v[152:155], v[216:219]
    ds_read_b128 v[168:171], v23 offset:16384
    buffer_load_dwordx4 v[112:115], v3, s[24:27], s54 offen offset:0 sc1
    v_mfma_f32_16x16x32_bf16 v[232:235], a[152:155], v[152:155], v[232:235]
    ds_read_b128 v[172:175], v23 offset:18432
    v_mfma_f32_16x16x32_bf16 v[220:223], a[136:139], v[156:159], v[220:223]
    ds_read_b128 v[176:179], v23 offset:20480
    v_mfma_f32_16x16x32_bf16 v[236:239], a[152:155], v[156:159], v[236:239]
    ds_read_b128 v[180:183], v23 offset:22528
    v_mfma_f32_16x16x32_bf16 v[224:227], a[136:139], v[160:163], v[224:227]
    buffer_load_dwordx4 v[116:119], v3, s[24:27], s54 offen offset:1024 sc1
    v_mfma_f32_16x16x32_bf16 v[240:243], a[152:155], v[160:163], v[240:243]
    v_mfma_f32_16x16x32_bf16 v[228:231], a[136:139], v[164:167], v[228:231]
    v_mfma_f32_16x16x32_bf16 v[244:247], a[152:155], v[164:167], v[244:247]
    s_waitcnt lgkmcnt(0)
    s_barrier
    v_mfma_f32_16x16x32_bf16 v[216:219], a[140:143], v[168:171], v[216:219]
    ds_read_b128 v[152:155], v20 offset:32768
    buffer_load_dwordx4 v[120:123], v3, s[24:27], s54 offen offset:2048 sc1
    v_mfma_f32_16x16x32_bf16 v[232:235], a[156:159], v[168:171], v[232:235]
    ds_read_b128 v[156:159], v20 offset:34816
    v_mfma_f32_16x16x32_bf16 v[220:223], a[140:143], v[172:175], v[220:223]
    ds_read_b128 v[160:163], v20 offset:36864
    v_mfma_f32_16x16x32_bf16 v[236:239], a[156:159], v[172:175], v[236:239]
    ds_read_b128 v[164:167], v20 offset:38912
    v_mfma_f32_16x16x32_bf16 v[224:227], a[140:143], v[176:179], v[224:227]
    buffer_load_dwordx4 v[124:127], v3, s[24:27], s54 offen offset:3072 sc1
    v_mfma_f32_16x16x32_bf16 v[240:243], a[156:159], v[176:179], v[240:243]
    v_mfma_f32_16x16x32_bf16 v[228:231], a[140:143], v[180:183], v[228:231]
    v_mfma_f32_16x16x32_bf16 v[244:247], a[156:159], v[180:183], v[244:247]
    s_waitcnt lgkmcnt(0)
    v_mfma_f32_16x16x32_bf16 v[216:219], a[160:163], v[152:155], v[216:219]
    ds_read_b128 v[168:171], v21 offset:32768
    v_mfma_f32_16x16x32_bf16 v[232:235], a[176:179], v[152:155], v[232:235]
    ds_read_b128 v[172:175], v21 offset:34816
    v_mfma_f32_16x16x32_bf16 v[220:223], a[160:163], v[156:159], v[220:223]
    ds_read_b128 v[176:179], v21 offset:36864
    v_mfma_f32_16x16x32_bf16 v[236:239], a[176:179], v[156:159], v[236:239]
    ds_read_b128 v[180:183], v21 offset:38912
    v_mfma_f32_16x16x32_bf16 v[224:227], a[160:163], v[160:163], v[224:227]
    v_mfma_f32_16x16x32_bf16 v[240:243], a[176:179], v[160:163], v[240:243]
    v_mfma_f32_16x16x32_bf16 v[228:231], a[160:163], v[164:167], v[228:231]
    v_mfma_f32_16x16x32_bf16 v[244:247], a[176:179], v[164:167], v[244:247]
    s_waitcnt lgkmcnt(0)
    v_mfma_f32_16x16x32_bf16 v[216:219], a[164:167], v[168:171], v[216:219]
    ds_read_b128 v[152:155], v22 offset:32768
    v_mfma_f32_16x16x32_bf16 v[232:235], a[180:183], v[168:171], v[232:235]
    ds_read_b128 v[156:159], v22 offset:34816
    v_mfma_f32_16x16x32_bf16 v[220:223], a[164:167], v[172:175], v[220:223]
    ds_read_b128 v[160:163], v22 offset:36864
    v_mfma_f32_16x16x32_bf16 v[236:239], a[180:183], v[172:175], v[236:239]
    ds_read_b128 v[164:167], v22 offset:38912
    v_mfma_f32_16x16x32_bf16 v[224:227], a[164:167], v[176:179], v[224:227]
    v_mfma_f32_16x16x32_bf16 v[240:243], a[180:183], v[176:179], v[240:243]
    v_mfma_f32_16x16x32_bf16 v[228:231], a[164:167], v[180:183], v[228:231]
    v_mfma_f32_16x16x32_bf16 v[244:247], a[180:183], v[180:183], v[244:247]
    s_waitcnt lgkmcnt(0)
    v_mfma_f32_16x16x32_bf16 v[216:219], a[168:171], v[152:155], v[216:219]
    ds_read_b128 v[168:171], v23 offset:32768
    v_mfma_f32_16x16x32_bf16 v[232:235], a[184:187], v[152:155], v[232:235]
    ds_read_b128 v[172:175], v23 offset:34816
    v_mfma_f32_16x16x32_bf16 v[220:223], a[168:171], v[156:159], v[220:223]
    ds_read_b128 v[176:179], v23 offset:36864
    v_mfma_f32_16x16x32_bf16 v[236:239], a[184:187], v[156:159], v[236:239]
    ds_read_b128 v[180:183], v23 offset:38912
    v_mfma_f32_16x16x32_bf16 v[224:227], a[168:171], v[160:163], v[224:227]
    v_mfma_f32_16x16x32_bf16 v[240:243], a[184:187], v[160:163], v[240:243]
    v_mfma_f32_16x16x32_bf16 v[228:231], a[168:171], v[164:167], v[228:231]
    v_mfma_f32_16x16x32_bf16 v[244:247], a[184:187], v[164:167], v[244:247]
    s_waitcnt lgkmcnt(0)
    v_mfma_f32_16x16x32_bf16 v[216:219], a[172:175], v[168:171], v[216:219]
    ds_read_b128 v[152:155], v20 offset:49152
    v_mfma_f32_16x16x32_bf16 v[232:235], a[188:191], v[168:171], v[232:235]
    ds_read_b128 v[156:159], v20 offset:51200
    v_mfma_f32_16x16x32_bf16 v[220:223], a[172:175], v[172:175], v[220:223]
    ds_read_b128 v[160:163], v20 offset:53248
    v_mfma_f32_16x16x32_bf16 v[236:239], a[188:191], v[172:175], v[236:239]
    ds_read_b128 v[164:167], v20 offset:55296
    v_mfma_f32_16x16x32_bf16 v[224:227], a[172:175], v[176:179], v[224:227]
    v_mfma_f32_16x16x32_bf16 v[240:243], a[188:191], v[176:179], v[240:243]
    v_mfma_f32_16x16x32_bf16 v[228:231], a[172:175], v[180:183], v[228:231]
    v_mfma_f32_16x16x32_bf16 v[244:247], a[188:191], v[180:183], v[244:247]
    s_waitcnt lgkmcnt(0)
    v_mfma_f32_16x16x32_bf16 v[216:219], a[192:195], v[152:155], v[216:219]
    ds_read_b128 v[168:171], v21 offset:49152
    s_waitcnt vmcnt(7)
    v_lshlrev_b32_e64 v184, 16, v96
    v_mfma_f32_16x16x32_bf16 v[232:235], a[208:211], v[152:155], v[232:235]
    ds_read_b128 v[172:175], v21 offset:51200
    v_and_b32 v185, 0xffff0000, v96
    v_mfma_f32_16x16x32_bf16 v[220:223], a[192:195], v[156:159], v[220:223]
    ds_read_b128 v[176:179], v21 offset:53248
    v_lshlrev_b32_e64 v186, 16, v97
    v_mfma_f32_16x16x32_bf16 v[236:239], a[208:211], v[156:159], v[236:239]
    ds_read_b128 v[180:183], v21 offset:55296
    v_and_b32 v187, 0xffff0000, v97
    v_mfma_f32_16x16x32_bf16 v[224:227], a[192:195], v[160:163], v[224:227]
    v_lshlrev_b32_e64 v188, 16, v98
    v_mfma_f32_16x16x32_bf16 v[240:243], a[208:211], v[160:163], v[240:243]
    v_and_b32 v189, 0xffff0000, v98
    v_mfma_f32_16x16x32_bf16 v[228:231], a[192:195], v[164:167], v[228:231]
    v_lshlrev_b32_e64 v190, 16, v99
    v_mfma_f32_16x16x32_bf16 v[244:247], a[208:211], v[164:167], v[244:247]
    v_and_b32 v191, 0xffff0000, v99
    s_waitcnt lgkmcnt(0)
    v_mfma_f32_16x16x32_bf16 v[216:219], a[196:199], v[168:171], v[216:219]
    ds_read_b128 v[152:155], v22 offset:49152
    s_waitcnt vmcnt(6)
    v_lshlrev_b32_e64 v192, 16, v100
    v_mfma_f32_16x16x32_bf16 v[232:235], a[212:215], v[168:171], v[232:235]
    ds_read_b128 v[156:159], v22 offset:51200
    v_and_b32 v193, 0xffff0000, v100
    v_mfma_f32_16x16x32_bf16 v[220:223], a[196:199], v[172:175], v[220:223]
    ds_read_b128 v[160:163], v22 offset:53248
    v_lshlrev_b32_e64 v194, 16, v101
    v_mfma_f32_16x16x32_bf16 v[236:239], a[212:215], v[172:175], v[236:239]
    ds_read_b128 v[164:167], v22 offset:55296
    v_and_b32 v195, 0xffff0000, v101
    v_mfma_f32_16x16x32_bf16 v[224:227], a[196:199], v[176:179], v[224:227]
    v_lshlrev_b32_e64 v196, 16, v102
    v_mfma_f32_16x16x32_bf16 v[240:243], a[212:215], v[176:179], v[240:243]
    v_and_b32 v197, 0xffff0000, v102
    v_mfma_f32_16x16x32_bf16 v[228:231], a[196:199], v[180:183], v[228:231]
    v_lshlrev_b32_e64 v198, 16, v103
    v_mfma_f32_16x16x32_bf16 v[244:247], a[212:215], v[180:183], v[244:247]
    v_and_b32 v199, 0xffff0000, v103
    s_waitcnt lgkmcnt(0)
    v_mfma_f32_16x16x32_bf16 v[216:219], a[200:203], v[152:155], v[216:219]
    ds_read_b128 v[168:171], v23 offset:49152
    s_waitcnt vmcnt(5)
    v_lshlrev_b32_e64 v200, 16, v104
    v_mfma_f32_16x16x32_bf16 v[232:235], a[216:219], v[152:155], v[232:235]
    ds_read_b128 v[172:175], v23 offset:51200
    v_and_b32 v201, 0xffff0000, v104
    v_mfma_f32_16x16x32_bf16 v[220:223], a[200:203], v[156:159], v[220:223]
    ds_read_b128 v[176:179], v23 offset:53248
    v_lshlrev_b32_e64 v202, 16, v105
    v_mfma_f32_16x16x32_bf16 v[236:239], a[216:219], v[156:159], v[236:239]
    ds_read_b128 v[180:183], v23 offset:55296
    v_and_b32 v203, 0xffff0000, v105
    v_mfma_f32_16x16x32_bf16 v[224:227], a[200:203], v[160:163], v[224:227]
    v_lshlrev_b32_e64 v204, 16, v106
    v_mfma_f32_16x16x32_bf16 v[240:243], a[216:219], v[160:163], v[240:243]
    v_and_b32 v205, 0xffff0000, v106
    v_mfma_f32_16x16x32_bf16 v[228:231], a[200:203], v[164:167], v[228:231]
    v_lshlrev_b32_e64 v206, 16, v107
    v_mfma_f32_16x16x32_bf16 v[244:247], a[216:219], v[164:167], v[244:247]
    v_and_b32 v207, 0xffff0000, v107
    s_waitcnt lgkmcnt(0)
    v_mfma_f32_16x16x32_bf16 v[216:219], a[204:207], v[168:171], v[216:219]
    s_waitcnt vmcnt(4)
    v_lshlrev_b32_e64 v208, 16, v108
    v_mfma_f32_16x16x32_bf16 v[232:235], a[220:223], v[168:171], v[232:235]
    v_and_b32 v209, 0xffff0000, v108
    v_mfma_f32_16x16x32_bf16 v[220:223], a[204:207], v[172:175], v[220:223]
    v_lshlrev_b32_e64 v210, 16, v109
    v_mfma_f32_16x16x32_bf16 v[236:239], a[220:223], v[172:175], v[236:239]
    v_and_b32 v211, 0xffff0000, v109
    v_mfma_f32_16x16x32_bf16 v[224:227], a[204:207], v[176:179], v[224:227]
    v_lshlrev_b32_e64 v212, 16, v110
    v_mfma_f32_16x16x32_bf16 v[240:243], a[220:223], v[176:179], v[240:243]
    v_and_b32 v213, 0xffff0000, v110
    v_mfma_f32_16x16x32_bf16 v[228:231], a[204:207], v[180:183], v[228:231]
    v_lshlrev_b32_e64 v214, 16, v111
    v_mfma_f32_16x16x32_bf16 v[244:247], a[220:223], v[180:183], v[244:247]
    v_and_b32 v215, 0xffff0000, v111
    s_waitcnt vmcnt(3)
    v_lshlrev_b32 v32, 16, v112
    v_and_b32 v33, 0xffff0000, v112
    v_lshlrev_b32_e64 v34, 16, v113
    v_and_b32 v35, 0xffff0000, v113
    v_lshlrev_b32_e64 v36, 16, v114
    v_and_b32 v37, 0xffff0000, v114
    v_lshlrev_b32_e64 v38, 16, v115
    v_and_b32 v39, 0xffff0000, v115
    v_add_f32 v32, v32, v216
    v_add_f32 v33, v33, v220
    v_add_f32 v34, v34, v224
    v_add_f32 v35, v35, v228
    v_pk_fma_f32 v[184:185], v[32:33], v[128:129], v[184:185] op_sel_hi:[1,0,1]
    v_pk_fma_f32 v[186:187], v[34:35], v[128:129], v[186:187] op_sel_hi:[1,0,1]
    s_add_u32 s39, s56, 0
    buffer_store_dwordx4 v[184:187], v12, s[28:31], s39 offen nt
    v_add_f32 v36, v36, v232
    v_add_f32 v37, v37, v236
    v_add_f32 v38, v38, v240
    v_add_f32_e64 v39, v39, v244
    v_pk_fma_f32 v[188:189], v[36:37], v[128:129], v[188:189] op_sel:[0,1,0]
    v_pk_fma_f32 v[190:191], v[38:39], v[128:129], v[190:191] op_sel:[0,1,0]
    s_add_u32 s39, s56, 131072
    buffer_store_dwordx4 v[188:191], v12, s[28:31], s39 offen nt
    s_waitcnt vmcnt(4)
    v_lshlrev_b32 v40, 16, v116
    v_and_b32 v41, 0xffff0000, v116
    v_lshlrev_b32_e64 v42, 16, v117
    v_and_b32 v43, 0xffff0000, v117
    v_lshlrev_b32_e64 v44, 16, v118
    v_and_b32 v45, 0xffff0000, v118
    v_lshlrev_b32_e64 v46, 16, v119
    v_and_b32 v47, 0xffff0000, v119
    v_add_f32 v40, v40, v217
    v_add_f32 v41, v41, v221
    v_add_f32 v42, v42, v225
    v_add_f32 v43, v43, v229
    v_pk_fma_f32 v[192:193], v[40:41], v[130:131], v[192:193] op_sel_hi:[1,0,1]
    v_pk_fma_f32 v[194:195], v[42:43], v[130:131], v[194:195] op_sel_hi:[1,0,1]
    s_add_u32 s39, s56, 4096
    buffer_store_dwordx4 v[192:195], v12, s[28:31], s39 offen nt
    v_add_f32 v44, v44, v233
    v_add_f32 v45, v45, v237
    v_add_f32 v46, v46, v241
    v_add_f32 v47, v47, v245
    v_pk_fma_f32 v[196:197], v[44:45], v[130:131], v[196:197] op_sel:[0,1,0]
    v_pk_fma_f32 v[198:199], v[46:47], v[130:131], v[198:199] op_sel:[0,1,0]
    s_add_u32 s39, s56, 135168
    buffer_store_dwordx4 v[196:199], v12, s[28:31], s39 offen nt
    s_waitcnt vmcnt(5)
    v_lshlrev_b32 v48, 16, v120
    v_and_b32 v49, 0xffff0000, v120
    v_lshlrev_b32_e64 v50, 16, v121
    v_and_b32 v51, 0xffff0000, v121
    v_lshlrev_b32_e64 v52, 16, v122
    v_and_b32 v53, 0xffff0000, v122
    v_lshlrev_b32_e64 v54, 16, v123
    v_and_b32 v55, 0xffff0000, v123
    v_add_f32 v48, v48, v218
    v_add_f32 v49, v49, v222
    v_add_f32 v50, v50, v226
    v_add_f32 v51, v51, v230
    v_pk_fma_f32 v[200:201], v[48:49], v[132:133], v[200:201] op_sel_hi:[1,0,1]
    v_pk_fma_f32 v[202:203], v[50:51], v[132:133], v[202:203] op_sel_hi:[1,0,1]
    s_add_u32 s39, s56, 8192
    buffer_store_dwordx4 v[200:203], v12, s[28:31], s39 offen nt
    v_add_f32 v52, v52, v234
    v_add_f32 v53, v53, v238
    v_add_f32 v54, v54, v242
    v_add_f32 v55, v55, v246
    v_pk_fma_f32 v[204:205], v[52:53], v[132:133], v[204:205] op_sel:[0,1,0]
    v_pk_fma_f32 v[206:207], v[54:55], v[132:133], v[206:207] op_sel:[0,1,0]
    s_add_u32 s39, s56, 139264
    buffer_store_dwordx4 v[204:207], v12, s[28:31], s39 offen nt
    s_waitcnt vmcnt(6)
    v_lshlrev_b32 v56, 16, v124
    v_and_b32 v57, 0xffff0000, v124
    v_lshlrev_b32_e64 v58, 16, v125
    v_and_b32 v59, 0xffff0000, v125
    v_lshlrev_b32_e64 v60, 16, v126
    v_and_b32 v61, 0xffff0000, v126
    v_lshlrev_b32_e64 v62, 16, v127
    v_and_b32 v63, 0xffff0000, v127
    v_add_f32 v56, v56, v219
    v_add_f32 v57, v57, v223
    v_add_f32 v58, v58, v227
    v_add_f32 v59, v59, v231
    v_pk_fma_f32 v[208:209], v[56:57], v[134:135], v[208:209] op_sel_hi:[1,0,1]
    v_pk_fma_f32 v[210:211], v[58:59], v[134:135], v[210:211] op_sel_hi:[1,0,1]
    s_add_u32 s39, s56, 12288
    buffer_store_dwordx4 v[208:211], v12, s[28:31], s39 offen nt
    v_add_f32 v60, v60, v235
    v_add_f32 v61, v61, v239
    v_add_f32 v62, v62, v243
    v_add_f32 v63, v63, v247
    v_pk_fma_f32 v[212:213], v[60:61], v[134:135], v[212:213] op_sel:[0,1,0]
    v_pk_fma_f32 v[214:215], v[62:63], v[134:135], v[214:215] op_sel:[0,1,0]
    s_add_u32 s39, s56, 143360
    buffer_store_dwordx4 v[212:215], v12, s[28:31], s39 offen nt
K_END:
    s_endpgm
K_W256:
    buffer_load_dwordx4 a[120:123], v3, s[24:27], s37 offen offset:0 sc1
    buffer_load_dwordx4 a[124:127], v3, s[24:27], s37 offen offset:1024 sc1
    buffer_load_dwordx4 a[128:131], v3, s[24:27], s37 offen offset:2048 sc1
    buffer_load_dwordx4 a[132:135], v3, s[24:27], s37 offen offset:3072 sc1
    s_add_u32 s69, s62, 1
    v_mov_b32_e64 v28, s69
    s_mov_b32 s69, 22446080
    buffer_store_dword v28, v30, s[24:27], s69 offen sc1
    s_branch K_W256_RET
K_POLL1:
    s_mov_b32 s71, 0
K_POLL1_L:
    s_sleep 1
    buffer_load_dword v216, v217, s[24:27], s68 offen sc1
    s_add_u32 s71, s71, 1
    s_waitcnt vmcnt(0)
    v_cmp_ne_u32 vcc, s35, v216
    s_nop 0
    s_cbranch_vccz K_POLL1_OK
    s_cmp_lt_u32 s71, 200000
    s_cbranch_scc1 K_POLL1_L
    s_branch K_POLL1_OK
K_SPECIAL:
    v_add_u32 v14, s63, v1
    v_sub_u32 v13, 64, v14
    v_cmp_eq_u32 s[44:45], 0, v14
    v_and_b32_e64 v13, 63, v13
    v_mul_u32_u24 v14, 144, v14
    v_mul_u32_u24 v13, 144, v13
    v_add_u32 v14, 81920, v14
    v_lshl_add_u32 v12, v2, 4, v14
    v_lshl_add_u32 v14, v2, 2, v14
    v_sub_u32_e64 v15, 3, v2
    v_add_u32 v14, 128, v14
    v_lshl_add_u32 v13, v15, 4, v13
    v_add_u32 v13, 81920, v13
    v_accvgpr_read_b32 v8, a120
    v_accvgpr_read_b32 v9, a122
    v_lshlrev_b32 v4, 16, v8
    v_lshlrev_b32 v5, 16, v9
    v_and_b32 v6, 0xffff0000, v8
    v_and_b32 v7, 0xffff0000, v9
    v_pk_mul_f32 v[184:185], v[240:241], v[4:5]
    v_pk_mul_f32 v[188:189], v[244:245], v[4:5]
    v_pk_fma_f32 v[184:185], v[244:245], v[6:7], v[184:185] neg_lo:[1,0,0] neg_hi:[1,0,0]
    v_pk_fma_f32 v[188:189], v[240:241], v[6:7], v[188:189]
    ds_write_b128 v12, v[224:227] offset:0
    v_accvgpr_read_b32 v8, a124
    v_accvgpr_read_b32 v9, a126
    v_lshlrev_b32 v4, 16, v8
    v_lshlrev_b32 v5, 16, v9
    v_and_b32 v6, 0xffff0000, v8
    v_and_b32 v7, 0xffff0000, v9
    v_pk_mul_f32 v[186:187], v[242:243], v[4:5]
    v_pk_mul_f32 v[190:191], v[246:247], v[4:5]
    v_pk_fma_f32 v[186:187], v[246:247], v[6:7], v[186:187] neg_lo:[1,0,0] neg_hi:[1,0,0]
    v_pk_fma_f32 v[190:191], v[242:243], v[6:7], v[190:191]
    ds_write_b128 v12, v[228:231] offset:9216
    v_accvgpr_read_b32 v8, a128
    v_accvgpr_read_b32 v9, a130
    v_lshlrev_b32 v4, 16, v8
    v_lshlrev_b32 v5, 16, v9
    v_and_b32 v6, 0xffff0000, v8
    v_and_b32 v7, 0xffff0000, v9
    v_pk_mul_f32 v[192:193], v[248:249], v[4:5]
    v_pk_mul_f32 v[196:197], v[252:253], v[4:5]
    v_pk_fma_f32 v[192:193], v[252:253], v[6:7], v[192:193] neg_lo:[1,0,0] neg_hi:[1,0,0]
    v_pk_fma_f32 v[196:197], v[248:249], v[6:7], v[196:197]
    ds_write_b128 v12, v[232:235] offset:64
    v_accvgpr_read_b32 v8, a132
    v_accvgpr_read_b32 v9, a134
    v_lshlrev_b32 v4, 16, v8
    v_lshlrev_b32 v5, 16, v9
    v_and_b32 v6, 0xffff0000, v8
    v_and_b32 v7, 0xffff0000, v9
    v_pk_mul_f32 v[194:195], v[250:251], v[4:5]
    v_pk_mul_f32 v[198:199], v[254:255], v[4:5]
    v_pk_fma_f32 v[194:195], v[254:255], v[6:7], v[194:195] neg_lo:[1,0,0] neg_hi:[1,0,0]
    v_pk_fma_f32 v[198:199], v[250:251], v[6:7], v[198:199]
    ds_write_b128 v12, v[236:239] offset:9280
    ds_write2st64_b32 v14, v224, v228 offset0:0 offset1:36
    s_waitcnt lgkmcnt(0)
    s_barrier
    ds_read_b128 v[96:99], v13 offset:64
    ds_read_b128 v[100:103], v13 offset:9280
    ds_read_b128 v[104:107], v13 offset:0
    ds_read_b128 v[108:111], v13 offset:9216
    ds_read_b32 v4, v13 offset:80
    ds_read_b32 v5, v13 offset:9296
    ds_read_b32 v6, v13 offset:16
    ds_read_b32 v7, v13 offset:9232
    s_waitcnt lgkmcnt(0)
    s_nop 0
    v_cndmask_b32 v96, v96, v97, s[44:45]
    v_cndmask_b32 v97, v97, v98, s[44:45]
    v_cndmask_b32 v98, v98, v99, s[44:45]
    v_cndmask_b32 v99, v99, v4, s[44:45]
    v_cndmask_b32 v100, v100, v101, s[44:45]
    v_cndmask_b32 v101, v101, v102, s[44:45]
    v_cndmask_b32 v102, v102, v103, s[44:45]
    v_cndmask_b32 v103, v103, v5, s[44:45]
    v_cndmask_b32 v104, v104, v105, s[44:45]
    v_cndmask_b32 v105, v105, v106, s[44:45]
    v_cndmask_b32 v106, v106, v107, s[44:45]
    v_cndmask_b32 v107, v107, v6, s[44:45]
    v_cndmask_b32 v108, v108, v109, s[44:45]
    v_cndmask_b32 v109, v109, v110, s[44:45]
    v_cndmask_b32 v110, v110, v111, s[44:45]
    v_cndmask_b32 v111, v111, v7, s[44:45]
    v_pk_mul_f32 v[240:241], v[98:99], 1.0 op_sel:[1,0] op_sel_hi:[0,0]
    v_pk_mul_f32 v[242:243], v[96:97], 1.0 op_sel:[1,0] op_sel_hi:[0,0]
    v_pk_mul_f32 v[244:245], v[102:103], -1.0 op_sel:[1,0] op_sel_hi:[0,0]
    v_pk_mul_f32 v[246:247], v[100:101], -1.0 op_sel:[1,0] op_sel_hi:[0,0]
    v_pk_mul_f32 v[248:249], v[106:107], 1.0 op_sel:[1,0] op_sel_hi:[0,0]
    v_pk_mul_f32 v[250:251], v[104:105], 1.0 op_sel:[1,0] op_sel_hi:[0,0]
    v_pk_mul_f32 v[252:253], v[110:111], -1.0 op_sel:[1,0] op_sel_hi:[0,0]
    v_pk_mul_f32 v[254:255], v[108:109], -1.0 op_sel:[1,0] op_sel_hi:[0,0]
    v_pk_fma_f32 v[4:5], v[224:225], s[42:43], v[244:245] op_sel_hi:[1,0,1]
    v_pk_fma_f32 v[6:7], v[228:229], s[42:43], v[240:241] op_sel_hi:[1,0,1] neg_lo:[0,0,1] neg_hi:[0,0,1]
    v_pk_fma_f32 v[8:9], v[240:241], s[42:43], v[228:229] op_sel_hi:[1,0,1]
    v_pk_fma_f32 v[10:11], v[244:245], s[42:43], v[224:225] op_sel_hi:[1,0,1] neg_lo:[0,0,1] neg_hi:[0,0,1]
    v_pk_mul_f32 v[224:225], v[4:5], v[152:153]
    v_pk_mul_f32 v[228:229], v[6:7], v[152:153]
    v_pk_mul_f32 v[240:241], v[8:9], v[168:169]
    v_pk_mul_f32 v[244:245], v[10:11], v[168:169]
    v_pk_fma_f32 v[152:153], v[6:7], v[160:161], v[224:225] neg_lo:[1,0,0] neg_hi:[1,0,0]
    v_pk_fma_f32 v[160:161], v[4:5], v[160:161], v[228:229]
    v_pk_fma_f32 v[168:169], v[10:11], v[176:177], v[240:241]
    v_pk_fma_f32 v[176:177], v[8:9], v[176:177], v[244:245] neg_lo:[1,0,0] neg_hi:[1,0,0]
    v_pk_fma_f32 v[224:225], v[152:153], s[42:43], v[176:177] op_sel_hi:[1,0,1] neg_lo:[0,0,1] neg_hi:[0,0,1]
    v_pk_fma_f32 v[228:229], v[160:161], s[42:43], v[168:169] op_sel_hi:[1,0,1]
    v_pk_fma_f32 v[240:241], v[168:169], s[42:43], v[160:161] op_sel_hi:[1,0,1] neg_lo:[0,0,1] neg_hi:[0,0,1]
    v_pk_fma_f32 v[244:245], v[176:177], s[42:43], v[152:153] op_sel_hi:[1,0,1]
    v_pk_fma_f32 v[4:5], v[226:227], s[42:43], v[246:247] op_sel_hi:[1,0,1]
    v_pk_fma_f32 v[6:7], v[230:231], s[42:43], v[242:243] op_sel_hi:[1,0,1] neg_lo:[0,0,1] neg_hi:[0,0,1]
    v_pk_fma_f32 v[8:9], v[242:243], s[42:43], v[230:231] op_sel_hi:[1,0,1]
    v_pk_fma_f32 v[10:11], v[246:247], s[42:43], v[226:227] op_sel_hi:[1,0,1] neg_lo:[0,0,1] neg_hi:[0,0,1]
    v_pk_mul_f32 v[226:227], v[4:5], v[154:155]
    v_pk_mul_f32 v[230:231], v[6:7], v[154:155]
    v_pk_mul_f32 v[242:243], v[8:9], v[170:171]
    v_pk_mul_f32 v[246:247], v[10:11], v[170:171]
    v_pk_fma_f32 v[154:155], v[6:7], v[162:163], v[226:227] neg_lo:[1,0,0] neg_hi:[1,0,0]
    v_pk_fma_f32 v[162:163], v[4:5], v[162:163], v[230:231]
    v_pk_fma_f32 v[170:171], v[10:11], v[178:179], v[242:243]
    v_pk_fma_f32 v[178:179], v[8:9], v[178:179], v[246:247] neg_lo:[1,0,0] neg_hi:[1,0,0]
    v_pk_fma_f32 v[226:227], v[154:155], s[42:43], v[178:179] op_sel_hi:[1,0,1] neg_lo:[0,0,1] neg_hi:[0,0,1]
    v_pk_fma_f32 v[230:231], v[162:163], s[42:43], v[170:171] op_sel_hi:[1,0,1]
    v_pk_fma_f32 v[242:243], v[170:171], s[42:43], v[162:163] op_sel_hi:[1,0,1] neg_lo:[0,0,1] neg_hi:[0,0,1]
    v_pk_fma_f32 v[246:247], v[178:179], s[42:43], v[154:155] op_sel_hi:[1,0,1]
    v_pk_fma_f32 v[4:5], v[232:233], s[42:43], v[252:253] op_sel_hi:[1,0,1]
    v_pk_fma_f32 v[6:7], v[236:237], s[42:43], v[248:249] op_sel_hi:[1,0,1] neg_lo:[0,0,1] neg_hi:[0,0,1]
    v_pk_fma_f32 v[8:9], v[248:249], s[42:43], v[236:237] op_sel_hi:[1,0,1]
    v_pk_fma_f32 v[10:11], v[252:253], s[42:43], v[232:233] op_sel_hi:[1,0,1] neg_lo:[0,0,1] neg_hi:[0,0,1]
    v_pk_mul_f32 v[232:233], v[4:5], v[156:157]
    v_pk_mul_f32 v[236:237], v[6:7], v[156:157]
    v_pk_mul_f32 v[248:249], v[8:9], v[172:173]
    v_pk_mul_f32 v[252:253], v[10:11], v[172:173]
    v_pk_fma_f32 v[156:157], v[6:7], v[164:165], v[232:233] neg_lo:[1,0,0] neg_hi:[1,0,0]
    v_pk_fma_f32 v[164:165], v[4:5], v[164:165], v[236:237]
    v_pk_fma_f32 v[172:173], v[10:11], v[180:181], v[248:249]
    v_pk_fma_f32 v[180:181], v[8:9], v[180:181], v[252:253] neg_lo:[1,0,0] neg_hi:[1,0,0]
    v_pk_fma_f32 v[232:233], v[156:157], s[42:43], v[180:181] op_sel_hi:[1,0,1] neg_lo:[0,0,1] neg_hi:[0,0,1]
    v_pk_fma_f32 v[236:237], v[164:165], s[42:43], v[172:173] op_sel_hi:[1,0,1]
    v_pk_fma_f32 v[248:249], v[172:173], s[42:43], v[164:165] op_sel_hi:[1,0,1] neg_lo:[0,0,1] neg_hi:[0,0,1]
    v_pk_fma_f32 v[252:253], v[180:181], s[42:43], v[156:157] op_sel_hi:[1,0,1]
    v_pk_fma_f32 v[4:5], v[234:235], s[42:43], v[254:255] op_sel_hi:[1,0,1]
    v_pk_fma_f32 v[6:7], v[238:239], s[42:43], v[250:251] op_sel_hi:[1,0,1] neg_lo:[0,0,1] neg_hi:[0,0,1]
    v_pk_fma_f32 v[8:9], v[250:251], s[42:43], v[238:239] op_sel_hi:[1,0,1]
    v_pk_fma_f32 v[10:11], v[254:255], s[42:43], v[234:235] op_sel_hi:[1,0,1] neg_lo:[0,0,1] neg_hi:[0,0,1]
    v_pk_mul_f32 v[234:235], v[4:5], v[158:159]
    v_pk_mul_f32 v[238:239], v[6:7], v[158:159]
    v_pk_mul_f32 v[250:251], v[8:9], v[174:175]
    v_pk_mul_f32 v[254:255], v[10:11], v[174:175]
    v_pk_fma_f32 v[158:159], v[6:7], v[166:167], v[234:235] neg_lo:[1,0,0] neg_hi:[1,0,0]
    v_pk_fma_f32 v[166:167], v[4:5], v[166:167], v[238:239]
    v_pk_fma_f32 v[174:175], v[10:11], v[182:183], v[250:251]
    v_pk_fma_f32 v[182:183], v[8:9], v[182:183], v[254:255] neg_lo:[1,0,0] neg_hi:[1,0,0]
    v_pk_fma_f32 v[234:235], v[158:159], s[42:43], v[182:183] op_sel_hi:[1,0,1] neg_lo:[0,0,1] neg_hi:[0,0,1]
    v_pk_fma_f32 v[238:239], v[166:167], s[42:43], v[174:175] op_sel_hi:[1,0,1]
    v_pk_fma_f32 v[250:251], v[174:175], s[42:43], v[166:167] op_sel_hi:[1,0,1] neg_lo:[0,0,1] neg_hi:[0,0,1]
    v_pk_fma_f32 v[254:255], v[182:183], s[42:43], v[158:159] op_sel_hi:[1,0,1]
    ds_write_b128 v12, v[240:243] offset:18432
    ds_write_b128 v12, v[244:247] offset:27648
    ds_write_b128 v12, v[248:251] offset:18496
    ds_write_b128 v12, v[252:255] offset:27712
    ds_write2st64_b32 v14, v240, v244 offset0:72 offset1:108
    s_waitcnt lgkmcnt(0)
    s_barrier
    ds_read_b128 v[96:99], v13 offset:18496
    ds_read_b128 v[100:103], v13 offset:27712
    ds_read_b128 v[104:107], v13 offset:18432
    ds_read_b128 v[108:111], v13 offset:27648
    ds_read_b32 v4, v13 offset:18512
    ds_read_b32 v5, v13 offset:27728
    ds_read_b32 v6, v13 offset:18448
    ds_read_b32 v7, v13 offset:27664
    s_waitcnt lgkmcnt(0)
    s_nop 0
    v_cndmask_b32 v96, v96, v97, s[44:45]
    v_cndmask_b32 v97, v97, v98, s[44:45]
    v_cndmask_b32 v98, v98, v99, s[44:45]
    v_cndmask_b32 v99, v99, v4, s[44:45]
    v_cndmask_b32 v100, v100, v101, s[44:45]
    v_cndmask_b32 v101, v101, v102, s[44:45]
    v_cndmask_b32 v102, v102, v103, s[44:45]
    v_cndmask_b32 v103, v103, v5, s[44:45]
    v_cndmask_b32 v104, v104, v105, s[44:45]
    v_cndmask_b32 v105, v105, v106, s[44:45]
    v_cndmask_b32 v106, v106, v107, s[44:45]
    v_cndmask_b32 v107, v107, v6, s[44:45]
    v_cndmask_b32 v108, v108, v109, s[44:45]
    v_cndmask_b32 v109, v109, v110, s[44:45]
    v_cndmask_b32 v110, v110, v111, s[44:45]
    v_cndmask_b32 v111, v111, v7, s[44:45]
    v_pk_add_f32 v[224:225], v[224:225], v[98:99] op_sel:[0,1] op_sel_hi:[1,0]
    v_pk_mul_f32 v[240:241], v[184:185], 4.0 op_sel_hi:[1,0]
    v_pk_add_f32 v[226:227], v[226:227], v[96:97] op_sel:[0,1] op_sel_hi:[1,0]
    v_pk_mul_f32 v[242:243], v[186:187], 4.0 op_sel_hi:[1,0]
    v_pk_add_f32 v[228:229], v[228:229], v[102:103] op_sel:[0,1] op_sel_hi:[1,0] neg_lo:[0,1] neg_hi:[0,1]
    v_pk_mul_f32 v[244:245], v[188:189], 4.0 op_sel_hi:[1,0]
    v_pk_add_f32 v[230:231], v[230:231], v[100:101] op_sel:[0,1] op_sel_hi:[1,0] neg_lo:[0,1] neg_hi:[0,1]
    v_pk_mul_f32 v[246:247], v[190:191], 4.0 op_sel_hi:[1,0]
    v_pk_add_f32 v[232:233], v[232:233], v[106:107] op_sel:[0,1] op_sel_hi:[1,0]
    v_pk_mul_f32 v[248:249], v[192:193], 4.0 op_sel_hi:[1,0]
    v_pk_add_f32 v[234:235], v[234:235], v[104:105] op_sel:[0,1] op_sel_hi:[1,0]
    v_pk_mul_f32 v[250:251], v[194:195], 4.0 op_sel_hi:[1,0]
    v_pk_add_f32 v[236:237], v[236:237], v[110:111] op_sel:[0,1] op_sel_hi:[1,0] neg_lo:[0,1] neg_hi:[0,1]
    v_pk_mul_f32 v[252:253], v[196:197], 4.0 op_sel_hi:[1,0]
    v_pk_add_f32 v[238:239], v[238:239], v[108:109] op_sel:[0,1] op_sel_hi:[1,0] neg_lo:[0,1] neg_hi:[0,1]
    v_pk_mul_f32 v[254:255], v[198:199], 4.0 op_sel_hi:[1,0]
    s_barrier
    s_branch K_SPECIAL2_RET
K_POLL2:
    s_mov_b32 s71, 0
K_POLL2_L:
    buffer_load_dwordx4 v[96:99], v148, s[24:27], s93 offen sc1
    buffer_load_dwordx4 v[100:103], v149, s[24:27], s93 offen sc1
    buffer_load_dwordx4 v[104:107], v150, s[24:27], s93 offen sc1
    buffer_load_dwordx4 v[108:111], v151, s[24:27], s93 offen sc1
    s_add_u32 s71, s71, 1
    s_waitcnt vmcnt(0)
    v_cmp_ne_u32 s[52:53], s35, v98
    v_cmp_ne_u32 s[54:55], s35, v102
    v_cmp_ne_u32 s[56:57], s35, v106
    v_cmp_ne_u32 s[58:59], s35, v110
    s_and_b64 s[52:53], s[52:53], s[80:81]
    s_and_b64 s[54:55], s[54:55], s[82:83]
    s_and_b64 s[56:57], s[56:57], s[84:85]
    s_and_b64 s[58:59], s[58:59], s[86:87]
    s_or_b64 s[52:53], s[52:53], s[54:55]
    s_or_b64 s[56:57], s[56:57], s[58:59]
    s_or_b64 vcc, s[52:53], s[56:57]
    s_cbranch_vccz K_POLL2_OK
    s_cmp_lt_u32 s71, 200000
    s_cbranch_scc1 K_POLL2_L
    s_branch K_POLL2_OK
K_POLL31:
    s_mov_b32 s71, 0
K_POLL31_L:
    buffer_load_dword v4, v210, s[24:27], s51 offen offset:64 sc1
    s_add_u32 s71, s71, 1
    s_waitcnt vmcnt(0)
    v_cmp_ne_u32 vcc, s35, v4
    s_nop 0
    s_and_b32 s59, vcc_lo, 254
    s_cmp_lg_u32 s59, 0
    s_cbranch_scc0 K_POLL31_OK
    s_cmp_lt_u32 s71, 200000
    s_cbranch_scc1 K_POLL31_L
    s_branch K_POLL31_OK
K_POLL4:
    s_mov_b32 s71, 0
K_POLL4_L:
    s_sleep 1
    buffer_load_dword v8, v13, s[24:27], s70 offen sc1
    s_add_u32 s71, s71, 1
    s_waitcnt vmcnt(0)
    v_cmp_ne_u32 vcc, s35, v8
    s_nop 0
    s_cbranch_vccz K_POLL4_OK
    s_cmp_lt_u32 s71, 200000
    s_cbranch_scc1 K_POLL4_L
    s_branch K_POLL4_OK
K_POLL5:
    s_mov_b32 s71, 0
K_POLL5_L:
    s_sleep 1
    buffer_load_dword v10, v5, s[24:27], s70 offen sc1
    s_add_u32 s71, s71, 1
    s_waitcnt vmcnt(0)
    v_cmp_ne_u32 vcc, s98, v10
    s_nop 0
    s_cbranch_vccz K_POLL5_OK
    s_cmp_lt_u32 s71, 200000
    s_cbranch_scc1 K_POLL5_L
    s_branch K_POLL5_OK
K_POLL6:
    s_mov_b32 s71, 0
K_POLL6_L:
    s_sleep 1
    buffer_load_dword v6, v9, s[24:27], s70 offen sc1
    s_add_u32 s71, s71, 1
    s_waitcnt vmcnt(0)
    v_cmp_ne_u32 vcc, s98, v6
    s_nop 0
    s_cbranch_vccz K_POLL6_OK
    s_cmp_lt_u32 s71, 200000
    s_cbranch_scc1 K_POLL6_L
    s_branch K_POLL6_OK
K_HFAR:
    s_nop 0
    ds_read_b64_tr_b16 v[64:65], v220 offset:0
    ds_read_b64_tr_b16 v[66:67], v221 offset:1024
    ds_read_b64_tr_b16 v[80:81], v222 offset:0
    ds_read_b64_tr_b16 v[82:83], v223 offset:1024
    ds_read_b64_tr_b16 v[68:69], v220 offset:8192
    ds_read_b64_tr_b16 v[70:71], v221 offset:9216
    ds_read_b64_tr_b16 v[84:85], v222 offset:8192
    ds_read_b64_tr_b16 v[86:87], v223 offset:9216
    ds_read_b64_tr_b16 v[72:73], v220 offset:16384
    ds_read_b64_tr_b16 v[74:75], v221 offset:17408
    ds_read_b64_tr_b16 v[88:89], v222 offset:16384
    ds_read_b64_tr_b16 v[90:91], v223 offset:17408
    s_waitcnt lgkmcnt(8)
    s_nop 0
    buffer_store_dwordx4 v[64:67], v24, s[28:31], s68 offen sc1
    buffer_store_dwordx4 v[80:83], v24, s[28:31], s69 offen sc1
    ds_read_b64_tr_b16 v[76:77], v220 offset:24576
    ds_read_b64_tr_b16 v[78:79], v221 offset:25600
    ds_read_b64_tr_b16 v[92:93], v222 offset:24576
    ds_read_b64_tr_b16 v[94:95], v223 offset:25600
    ds_read_b128 v[152:155], v20 offset:0
    ds_read_b128 v[156:159], v20 offset:2048
    ds_read_b128 v[160:163], v20 offset:4096
    ds_read_b128 v[164:167], v20 offset:6144
    s_waitcnt lgkmcnt(12)
    buffer_store_dwordx4 v[68:71], v25, s[28:31], s68 offen sc1
    s_waitcnt lgkmcnt(0)
    v_mfma_f32_16x16x32_bf16 v[32:35], v[64:67], v[152:155], 0
    ds_read_b128 v[168:171], v21 offset:0
    buffer_store_dwordx4 v[84:87], v25, s[28:31], s69 offen sc1
    v_mfma_f32_16x16x32_bf16 v[48:51], v[80:83], v[152:155], 0
    ds_read_b128 v[172:175], v21 offset:2048
    v_mfma_f32_16x16x32_bf16 v[36:39], v[64:67], v[156:159], 0
    ds_read_b128 v[176:179], v21 offset:4096
    buffer_store_dwordx4 v[72:75], v26, s[28:31], s68 offen sc1
    v_mfma_f32_16x16x32_bf16 v[52:55], v[80:83], v[156:159], 0
    ds_read_b128 v[180:183], v21 offset:6144
    v_mfma_f32_16x16x32_bf16 v[40:43], v[64:67], v[160:163], 0
    v_mfma_f32_16x16x32_bf16 v[56:59], v[80:83], v[160:163], 0
    buffer_store_dwordx4 v[88:91], v26, s[28:31], s69 offen sc1
    v_mfma_f32_16x16x32_bf16 v[44:47], v[64:67], v[164:167], 0
    v_mfma_f32_16x16x32_bf16 v[60:63], v[80:83], v[164:167], 0
    s_waitcnt lgkmcnt(0)
    v_mfma_f32_16x16x32_bf16 v[32:35], v[68:71], v[168:171], v[32:35]
    ds_read_b128 v[152:155], v22 offset:0
    buffer_store_dwordx4 v[76:79], v27, s[28:31], s68 offen sc1
    v_mfma_f32_16x16x32_bf16 v[48:51], v[84:87], v[168:171], v[48:51]
    ds_read_b128 v[156:159], v22 offset:2048
    v_mfma_f32_16x16x32_bf16 v[36:39], v[68:71], v[172:175], v[36:39]
    ds_read_b128 v[160:163], v22 offset:4096
    v_mfma_f32_16x16x32_bf16 v[52:55], v[84:87], v[172:175], v[52:55]
    ds_read_b128 v[164:167], v22 offset:6144
    v_mfma_f32_16x16x32_bf16 v[40:43], v[68:71], v[176:179], v[40:43]
    buffer_store_dwordx4 v[92:95], v27, s[28:31], s69 offen sc1
    v_mfma_f32_16x16x32_bf16 v[56:59], v[84:87], v[176:179], v[56:59]
    v_mfma_f32_16x16x32_bf16 v[44:47], v[68:71], v[180:183], v[44:47]
    v_mfma_f32_16x16x32_bf16 v[60:63], v[84:87], v[180:183], v[60:63]
    s_branch K_HFAR_RET
K_CODE_END:
.section .rodata,"a"
.p2align 6
.amdhsa_kernel gated_mix__spectral_gfnet__ssm_conv_s5__prompt_kernel
  .amdhsa_next_free_vgpr 512
  .amdhsa_next_free_sgpr 102
  .amdhsa_accum_offset 256
  .amdhsa_group_segment_fixed_size 0
  .amdhsa_kernarg_size 128
  .amdhsa_user_sgpr_count 2
  .amdhsa_user_sgpr_kernarg_segment_ptr 1
  .amdhsa_system_sgpr_workgroup_id_x 1
.end_amdhsa_kernel
```
